```python
import torch

def _softmax(x, axis=-1):
    return torch.softmax(x, dim=axis)
def _gelu(x):
    return torch.nn.functional.gelu(x, approximate="tanh")
def _silu(x):
    return torch.nn.functional.silu(x)
def _sigmoid(x):
    return torch.sigmoid(x)
def _layernorm(x, axis=-1, eps=1e-5):
    m = x.mean(dim=axis, keepdim=True)
    v = x.var(dim=axis, keepdim=True, unbiased=False)
    return (x - m) / torch.sqrt(v + eps)
def _scatter_add(tgt, idx, src, axis=0):
    return tgt.clone().index_add_(axis, idx, src)
def _segment_sum(src, seg, n):
    out = torch.zeros((n,) + src.shape[1:], dtype=src.dtype)
    return out.index_add_(0, seg, src)
def _pad(x, pw):
    flat = tuple(v for pair in reversed(pw) for v in pair)
    return torch.nn.functional.pad(x, flat)

kernel_name = 'standalone__structured_sparse_n_m__ragged'

def setup_inputs():

    _w = (lambda a: (lambda t: t.to(torch.bfloat16) if t.is_floating_point() else t)(torch.as_tensor(a)))
    B, S, D = 16, 4096, 576
    assert D % 4 == 0, "d_model must be divisible by M=4 for 2:4 sparsity"
    return {
        "x": _w((lambda *s: torch.randn(*s, dtype=torch.bfloat16) * 0.05)(B, S, D)),
        "w": _w((lambda *s: torch.randn(*s, dtype=torch.bfloat16) * 0.05)(D, D)),
        "b": _w((lambda *s: torch.randn(*s, dtype=torch.bfloat16) * 0.05)(D)),
    }

def reference(x, w, b):
    B, S, D = x.shape
    N, M = 2, 4
    G = D // M
    wg = w.reshape(G, M, D)
    mag = torch.abs(wg)
    order = torch.argsort(mag, 1)
    thr = (lambda x, i, axis: torch.take_along_dim(x, i, dim=axis))(mag, order[:, M - N:M - N + 1, :], 1)
    mask = (lambda x, dt: x.to(dt))(mag >= thr, w.dtype)
    wp = (wg * mask).reshape(D, D)
    return torch.einsum("bsd,df->bsf", x, wp) + b
```

```asm
; @launch kernel=prep_kernel grid=(36,1,1) block=(576,1,1) lds=64
; @launch kernel=main_kernel grid=(256,1,1) block=(256,1,1) lds=162944
.amdgcn_target "amdgcn-amd-amdhsa--gfx950"
.text
.globl prep_kernel
.globl main_kernel
.p2align 8
.type prep_kernel,@function
prep_kernel:
    s_cmp_ge_u32 s2, 36
    s_cbranch_scc1 P_end
    s_load_dwordx4 s[4:7], s[0:1], 8
    s_load_dwordx2 s[16:17], s[0:1], 40
    v_lshrrev_b32 v1, 6, v0
    v_and_b32 v2, 63, v0
    v_readfirstlane_b32 s20, v1
    v_lshrrev_b32 v3, 4, v2
    v_and_b32 v4, 15, v2
    s_mul_i32 s21, s2, 57
    s_lshr_b32 s21, s21, 9
    s_mul_i32 s22, s21, 9
    s_sub_u32 s22, s2, s22
    s_lshr_b32 s23, s22, 1
    s_lshl_b32 s23, s23, 5
    s_and_b32 s24, s22, 1
    s_lshl_b32 s24, s24, 2
    s_add_u32 s23, s23, s24
    s_lshl_b32 s24, s21, 7
    s_add_u32 s23, s23, s24
    s_lshl_b32 s24, s21, 4
    s_add_u32 s24, s24, 512
    s_cmp_lt_u32 s22, 8
    s_cselect_b32 s23, s23, s24
    s_cselect_b32 s24, 8, 4
    v_lshrrev_b32 v5, 2, v4
    v_mul_lo_u32 v5, v5, s24
    v_and_b32 v6, 3, v4
    v_add3_u32 v5, v5, v6, s23
    v_lshlrev_b32 v5, 1, v5
    v_lshrrev_b32 v6, 4, v0
    v_mul_u32_u24 v6, 18432, v6
    v_add_u32 v6, v6, v5
    s_mov_b32 s25, 4608
    s_mov_b32 s26, 9216
    s_mov_b32 s27, 13824
    s_mov_b32 s18, 731904
    s_mov_b32 s19, 0x20000
    s_waitcnt lgkmcnt(0)
    s_mov_b32 s8, s4
    s_mov_b32 s9, s5
    s_mov_b32 s10, 663552
    s_mov_b32 s11, 0x20000
    s_mov_b32 s12, s6
    s_mov_b32 s13, s7
    s_mov_b32 s14, 1152
    s_mov_b32 s15, 0x20000
    buffer_load_ushort v16, v6, s[8:11], 0 offen offset:0
    buffer_load_ushort v17, v6, s[8:11], 0 offen offset:1152
    buffer_load_ushort v18, v6, s[8:11], 0 offen offset:2304
    buffer_load_ushort v19, v6, s[8:11], 0 offen offset:3456
    buffer_load_ushort v20, v6, s[8:11], s25 offen offset:0
    buffer_load_ushort v21, v6, s[8:11], s25 offen offset:1152
    buffer_load_ushort v22, v6, s[8:11], s25 offen offset:2304
    buffer_load_ushort v23, v6, s[8:11], s25 offen offset:3456
    buffer_load_ushort v24, v6, s[8:11], s26 offen offset:0
    buffer_load_ushort v25, v6, s[8:11], s26 offen offset:1152
    buffer_load_ushort v26, v6, s[8:11], s26 offen offset:2304
    buffer_load_ushort v27, v6, s[8:11], s26 offen offset:3456
    buffer_load_ushort v28, v6, s[8:11], s27 offen offset:0
    buffer_load_ushort v29, v6, s[8:11], s27 offen offset:1152
    buffer_load_ushort v30, v6, s[8:11], s27 offen offset:2304
    buffer_load_ushort v31, v6, s[8:11], s27 offen offset:3456
    buffer_load_ushort v15, v5, s[12:15], 0 offen
    s_mov_b32 s28, 3437096686
    s_mov_b32 s29, 1150609561
    s_mov_b32 s30, 65819
    s_mov_b32 s31, 0x0202
    s_mov_b32 s33, 0xffff
    v_mov_b32 v14, 0x01000100
    v_mov_b32 v40, 0
    v_mov_b32 v41, 0
    v_and_b32 v13, 48, v2
    s_waitcnt vmcnt(13)
    v_and_b32 v44, 0x7fff, v16
    v_and_b32 v45, 0x7fff, v17
    v_and_b32 v46, 0x7fff, v18
    v_and_b32 v47, 0x7fff, v19
    v_max_u32 v48, v44, v45
    v_min_u32 v49, v44, v45
    v_max_u32 v50, v46, v47
    v_min_u32 v51, v46, v47
    v_min_u32 v48, v48, v50
    v_max3_u32 v48, v48, v49, v51
    v_max_u32 v48, 1, v48
    v_sub_u32 v47, v47, v48
    v_sub_u32 v46, v46, v48
    v_sub_u32 v45, v45, v48
    v_sub_u32 v44, v44, v48
    v_lshrrev_b32 v49, 31, v47
    v_alignbit_b32 v49, v49, v46, 31
    v_alignbit_b32 v49, v49, v45, 31
    v_alignbit_b32 v49, v49, v44, 31
    v_lshlrev_b32 v50, 2, v49
    v_lshrrev_b64 v[52:53], v50, s[28:29]
    v_and_b32 v52, 15, v52
    v_lshl_or_b32 v40, v52, 0, v40
    v_lshl_or_b32 v44, v17, 16, v16
    v_lshl_or_b32 v45, v19, 16, v18
    v_and_b32 v46, 3, v52
    v_lshrrev_b32 v47, 2, v52
    v_lshl_or_b32 v46, v47, 16, v46
    v_mad_u32_u24 v46, v46, s31, v14
    v_perm_b32 v32, v45, v44, v46
    v_lshlrev_b32 v50, 1, v49
    v_lshrrev_b32 v50, v50, s30
    v_and_b32 v46, 1, v50
    v_bfe_u32 v47, v50, 1, 1
    v_lshl_or_b32 v46, v47, 16, v46
    v_mul_u32_u24 v46, s33, v46
    v_and_b32 v36, v44, v46
    v_cmp_ne_u32 s[34:35], 0, v36
    s_nop 1
    v_lshrrev_b64 v[52:53], v13, s[34:35]
    v_and_b32 v52, 0xffff, v52
    v_min_u32 v52, 1, v52
    v_lshl_or_b32 v41, v52, 0, v41
    s_waitcnt vmcnt(9)
    v_and_b32 v44, 0x7fff, v20
    v_and_b32 v45, 0x7fff, v21
    v_and_b32 v46, 0x7fff, v22
    v_and_b32 v47, 0x7fff, v23
    v_max_u32 v48, v44, v45
    v_min_u32 v49, v44, v45
    v_max_u32 v50, v46, v47
    v_min_u32 v51, v46, v47
    v_min_u32 v48, v48, v50
    v_max3_u32 v48, v48, v49, v51
    v_max_u32 v48, 1, v48
    v_sub_u32 v47, v47, v48
    v_sub_u32 v46, v46, v48
    v_sub_u32 v45, v45, v48
    v_sub_u32 v44, v44, v48
    v_lshrrev_b32 v49, 31, v47
    v_alignbit_b32 v49, v49, v46, 31
    v_alignbit_b32 v49, v49, v45, 31
    v_alignbit_b32 v49, v49, v44, 31
    v_lshlrev_b32 v50, 2, v49
    v_lshrrev_b64 v[52:53], v50, s[28:29]
    v_and_b32 v52, 15, v52
    v_lshl_or_b32 v40, v52, 4, v40
    v_lshl_or_b32 v44, v21, 16, v20
    v_lshl_or_b32 v45, v23, 16, v22
    v_and_b32 v46, 3, v52
    v_lshrrev_b32 v47, 2, v52
    v_lshl_or_b32 v46, v47, 16, v46
    v_mad_u32_u24 v46, v46, s31, v14
    v_perm_b32 v33, v45, v44, v46
    v_lshlrev_b32 v50, 1, v49
    v_lshrrev_b32 v50, v50, s30
    v_and_b32 v46, 1, v50
    v_bfe_u32 v47, v50, 1, 1
    v_lshl_or_b32 v46, v47, 16, v46
    v_mul_u32_u24 v46, s33, v46
    v_and_b32 v37, v44, v46
    v_cmp_ne_u32 s[34:35], 0, v37
    s_nop 1
    v_lshrrev_b64 v[52:53], v13, s[34:35]
    v_and_b32 v52, 0xffff, v52
    v_min_u32 v52, 1, v52
    v_lshl_or_b32 v41, v52, 1, v41
    s_waitcnt vmcnt(5)
    v_and_b32 v44, 0x7fff, v24
    v_and_b32 v45, 0x7fff, v25
    v_and_b32 v46, 0x7fff, v26
    v_and_b32 v47, 0x7fff, v27
    v_max_u32 v48, v44, v45
    v_min_u32 v49, v44, v45
    v_max_u32 v50, v46, v47
    v_min_u32 v51, v46, v47
    v_min_u32 v48, v48, v50
    v_max3_u32 v48, v48, v49, v51
    v_max_u32 v48, 1, v48
    v_sub_u32 v47, v47, v48
    v_sub_u32 v46, v46, v48
    v_sub_u32 v45, v45, v48
    v_sub_u32 v44, v44, v48
    v_lshrrev_b32 v49, 31, v47
    v_alignbit_b32 v49, v49, v46, 31
    v_alignbit_b32 v49, v49, v45, 31
    v_alignbit_b32 v49, v49, v44, 31
    v_lshlrev_b32 v50, 2, v49
    v_lshrrev_b64 v[52:53], v50, s[28:29]
    v_and_b32 v52, 15, v52
    v_lshl_or_b32 v40, v52, 8, v40
    v_lshl_or_b32 v44, v25, 16, v24
    v_lshl_or_b32 v45, v27, 16, v26
    v_and_b32 v46, 3, v52
    v_lshrrev_b32 v47, 2, v52
    v_lshl_or_b32 v46, v47, 16, v46
    v_mad_u32_u24 v46, v46, s31, v14
    v_perm_b32 v34, v45, v44, v46
    v_lshlrev_b32 v50, 1, v49
    v_lshrrev_b32 v50, v50, s30
    v_and_b32 v46, 1, v50
    v_bfe_u32 v47, v50, 1, 1
    v_lshl_or_b32 v46, v47, 16, v46
    v_mul_u32_u24 v46, s33, v46
    v_and_b32 v38, v44, v46
    v_cmp_ne_u32 s[34:35], 0, v38
    s_nop 1
    v_lshrrev_b64 v[52:53], v13, s[34:35]
    v_and_b32 v52, 0xffff, v52
    v_min_u32 v52, 1, v52
    v_lshl_or_b32 v41, v52, 2, v41
    s_waitcnt vmcnt(1)
    v_and_b32 v44, 0x7fff, v28
    v_and_b32 v45, 0x7fff, v29
    v_and_b32 v46, 0x7fff, v30
    v_and_b32 v47, 0x7fff, v31
    v_max_u32 v48, v44, v45
    v_min_u32 v49, v44, v45
    v_max_u32 v50, v46, v47
    v_min_u32 v51, v46, v47
    v_min_u32 v48, v48, v50
    v_max3_u32 v48, v48, v49, v51
    v_max_u32 v48, 1, v48
    v_sub_u32 v47, v47, v48
    v_sub_u32 v46, v46, v48
    v_sub_u32 v45, v45, v48
    v_sub_u32 v44, v44, v48
    v_lshrrev_b32 v49, 31, v47
    v_alignbit_b32 v49, v49, v46, 31
    v_alignbit_b32 v49, v49, v45, 31
    v_alignbit_b32 v49, v49, v44, 31
    v_lshlrev_b32 v50, 2, v49
    v_lshrrev_b64 v[52:53], v50, s[28:29]
    v_and_b32 v52, 15, v52
    v_lshl_or_b32 v40, v52, 12, v40
    v_lshl_or_b32 v44, v29, 16, v28
    v_lshl_or_b32 v45, v31, 16, v30
    v_and_b32 v46, 3, v52
    v_lshrrev_b32 v47, 2, v52
    v_lshl_or_b32 v46, v47, 16, v46
    v_mad_u32_u24 v46, v46, s31, v14
    v_perm_b32 v35, v45, v44, v46
    v_lshlrev_b32 v50, 1, v49
    v_lshrrev_b32 v50, v50, s30
    v_and_b32 v46, 1, v50
    v_bfe_u32 v47, v50, 1, 1
    v_lshl_or_b32 v46, v47, 16, v46
    v_mul_u32_u24 v46, s33, v46
    v_and_b32 v39, v44, v46
    v_cmp_ne_u32 s[34:35], 0, v39
    s_nop 1
    v_lshrrev_b64 v[52:53], v13, s[34:35]
    v_and_b32 v52, 0xffff, v52
    v_min_u32 v52, 1, v52
    v_lshl_or_b32 v41, v52, 3, v41
    s_mul_i32 s36, s20, 9
    s_add_u32 s36, s36, s22
    s_mul_i32 s37, s21, 81
    s_add_u32 s37, s37, s36
    s_lshl_b32 s37, s37, 10
    v_lshlrev_b32 v7, 4, v2
    buffer_store_dwordx4 v[32:35], v7, s[16:19], s37 offen
    s_lshr_b32 s37, s36, 3
    s_mul_i32 s38, s21, 11
    s_add_u32 s37, s37, s38
    s_lshl_b32 s37, s37, 10
    s_and_b32 s38, s36, 7
    s_lshl_b32 s38, s38, 1
    s_add_u32 s37, s37, s38
    s_add_u32 s37, s37, 331776
    buffer_store_short v40, v7, s[16:19], s37 offen
    v_readlane_b32 s36, v41, 0
    v_readlane_b32 s37, v41, 16
    v_readlane_b32 s38, v41, 32
    v_readlane_b32 s39, v41, 48
    s_nop 3
    s_lshl_b32 s37, s37, 4
    s_lshl_b32 s38, s38, 8
    s_lshl_b32 s39, s39, 12
    s_or_b32 s36, s36, s37
    s_or_b32 s38, s38, s39
    s_or_b32 s36, s36, s38
    s_lshl_b32 s37, s20, 2
    v_mov_b32 v8, s36
    v_mov_b32 v9, s37
    ds_write_b32 v9, v8
    v_mov_b32 v9, 0
    s_waitcnt lgkmcnt(0)
    s_barrier
    ds_read_b128 v[44:47], v9
    ds_read_b128 v[48:51], v9 offset:16
    ds_read_b32 v52, v9 offset:32
    s_mov_b32 s40, 0
    s_mov_b32 s41, 0
    s_waitcnt lgkmcnt(0)
    v_readfirstlane_b32 s37, v44
    s_nop 3
    s_bcnt1_i32_b32 s37, s37
    s_add_u32 s41, s41, s37
    s_cmp_gt_u32 s20, 0
    s_cselect_b32 s37, s37, 0
    s_add_u32 s40, s40, s37
    v_readfirstlane_b32 s37, v45
    s_nop 3
    s_bcnt1_i32_b32 s37, s37
    s_add_u32 s41, s41, s37
    s_cmp_gt_u32 s20, 1
    s_cselect_b32 s37, s37, 0
    s_add_u32 s40, s40, s37
    v_readfirstlane_b32 s37, v46
    s_nop 3
    s_bcnt1_i32_b32 s37, s37
    s_add_u32 s41, s41, s37
    s_cmp_gt_u32 s20, 2
    s_cselect_b32 s37, s37, 0
    s_add_u32 s40, s40, s37
    v_readfirstlane_b32 s37, v47
    s_nop 3
    s_bcnt1_i32_b32 s37, s37
    s_add_u32 s41, s41, s37
    s_cmp_gt_u32 s20, 3
    s_cselect_b32 s37, s37, 0
    s_add_u32 s40, s40, s37
    v_readfirstlane_b32 s37, v48
    s_nop 3
    s_bcnt1_i32_b32 s37, s37
    s_add_u32 s41, s41, s37
    s_cmp_gt_u32 s20, 4
    s_cselect_b32 s37, s37, 0
    s_add_u32 s40, s40, s37
    v_readfirstlane_b32 s37, v49
    s_nop 3
    s_bcnt1_i32_b32 s37, s37
    s_add_u32 s41, s41, s37
    s_cmp_gt_u32 s20, 5
    s_cselect_b32 s37, s37, 0
    s_add_u32 s40, s40, s37
    v_readfirstlane_b32 s37, v50
    s_nop 3
    s_bcnt1_i32_b32 s37, s37
    s_add_u32 s41, s41, s37
    s_cmp_gt_u32 s20, 6
    s_cselect_b32 s37, s37, 0
    s_add_u32 s40, s40, s37
    v_readfirstlane_b32 s37, v51
    s_nop 3
    s_bcnt1_i32_b32 s37, s37
    s_add_u32 s41, s41, s37
    s_cmp_gt_u32 s20, 7
    s_cselect_b32 s37, s37, 0
    s_add_u32 s40, s40, s37
    v_readfirstlane_b32 s37, v52
    s_nop 3
    s_bcnt1_i32_b32 s37, s37
    s_add_u32 s41, s41, s37
    s_cmp_gt_u32 s20, 8
    s_cselect_b32 s37, s37, 0
    s_add_u32 s40, s40, s37
    s_mul_i32 s42, s21, 10368
    s_add_u32 s42, s42, 376832
    s_lshl_b32 s37, s22, 6
    s_add_u32 s43, s42, s37
    s_add_u32 s43, s43, 9216
    s_add_u32 s46, s43, 576
    s_lshl_b32 s37, s22, 10
    s_add_u32 s42, s42, s37
    s_mul_i32 s44, s2, 8704
    s_add_u32 s44, s44, 418304
    s_mov_b32 s47, 544
    s_add_u32 s45, s41, 7
    s_and_b32 s45, s45, -8
    s_max_u32 s45, s45, 16
    v_lshl_add_u32 v57, v3, 2, 0
    v_bfm_b32 v57, v57, 0
    v_and_b32 v57, s36, v57
    v_bcnt_u32_b32 v54, v57, s40
    v_mov_b32 v55, v36
    s_lshl_b32 s37, s20, 10
    v_lshl_add_u32 v56, v3, 5, s37
    v_add_u32 v56, 0, v56
    v_and_b32 v57, 1, v41
    v_cmp_ne_u32 vcc, 0, v57
    s_and_saveexec_b64 s[48:49], vcc
    s_cbranch_execz P_skip0
    v_lshrrev_b32 v57, 2, v54
    v_and_b32 v58, 3, v54
    v_lshl_add_u32 v59, v57, 4, v4
    v_lshlrev_b32 v59, 4, v59
    v_lshl_add_u32 v59, v58, 2, v59
    v_add_u32 v59, s42, v59
    v_and_b32 v60, 1, v57
    v_lshlrev_b32 v60, 1, v60
    v_lshrrev_b32 v61, 1, v58
    v_add_u32 v60, v60, v61
    v_lshrrev_b32 v61, 1, v57
    v_lshlrev_b32 v61, 1, v61
    v_and_b32 v62, 1, v58
    v_add_u32 v61, v61, v62
    v_lshl_add_u32 v60, v60, 2, v61
    v_lshl_add_u32 v60, v60, 2, s43
    v_subrev_u32 v61, 16, v54
    v_lshrrev_b32 v62, 3, v61
    v_and_b32 v62, 15, v62
    v_mul_lo_u32 v62, v62, s47
    v_add_u32 v62, s44, v62
    v_and_b32 v61, 7, v61
    v_lshrrev_b32 v57, 1, v61
    v_lshl_add_u32 v57, v57, 4, v4
    v_lshlrev_b32 v57, 3, v57
    v_and_b32 v58, 1, v61
    v_lshl_add_u32 v57, v58, 2, v57
    v_add_u32 v57, v57, v62
    v_lshl_add_u32 v58, v61, 2, v62
    v_add_u32 v58, 512, v58
    v_cmp_gt_u32 vcc, 16, v54
    s_nop 1
    v_cndmask_b32 v59, v57, v59, vcc
    v_cndmask_b32 v60, v58, v60, vcc
    buffer_store_dword v55, v59, s[16:19], 0 offen
    buffer_store_dword v56, v60, s[16:19], 0 offen
P_skip0:
    s_mov_b64 exec, s[48:49]
    v_lshl_add_u32 v57, v3, 2, 1
    v_bfm_b32 v57, v57, 0
    v_and_b32 v57, s36, v57
    v_bcnt_u32_b32 v54, v57, s40
    v_mov_b32 v55, v37
    s_lshl_b32 s37, s20, 10
    v_lshl_add_u32 v56, v3, 5, s37
    v_add_u32 v56, 8, v56
    v_and_b32 v57, 2, v41
    v_cmp_ne_u32 vcc, 0, v57
    s_and_saveexec_b64 s[48:49], vcc
    s_cbranch_execz P_skip1
    v_lshrrev_b32 v57, 2, v54
    v_and_b32 v58, 3, v54
    v_lshl_add_u32 v59, v57, 4, v4
    v_lshlrev_b32 v59, 4, v59
    v_lshl_add_u32 v59, v58, 2, v59
    v_add_u32 v59, s42, v59
    v_and_b32 v60, 1, v57
    v_lshlrev_b32 v60, 1, v60
    v_lshrrev_b32 v61, 1, v58
    v_add_u32 v60, v60, v61
    v_lshrrev_b32 v61, 1, v57
    v_lshlrev_b32 v61, 1, v61
    v_and_b32 v62, 1, v58
    v_add_u32 v61, v61, v62
    v_lshl_add_u32 v60, v60, 2, v61
    v_lshl_add_u32 v60, v60, 2, s43
    v_subrev_u32 v61, 16, v54
    v_lshrrev_b32 v62, 3, v61
    v_and_b32 v62, 15, v62
    v_mul_lo_u32 v62, v62, s47
    v_add_u32 v62, s44, v62
    v_and_b32 v61, 7, v61
    v_lshrrev_b32 v57, 1, v61
    v_lshl_add_u32 v57, v57, 4, v4
    v_lshlrev_b32 v57, 3, v57
    v_and_b32 v58, 1, v61
    v_lshl_add_u32 v57, v58, 2, v57
    v_add_u32 v57, v57, v62
    v_lshl_add_u32 v58, v61, 2, v62
    v_add_u32 v58, 512, v58
    v_cmp_gt_u32 vcc, 16, v54
    s_nop 1
    v_cndmask_b32 v59, v57, v59, vcc
    v_cndmask_b32 v60, v58, v60, vcc
    buffer_store_dword v55, v59, s[16:19], 0 offen
    buffer_store_dword v56, v60, s[16:19], 0 offen
P_skip1:
    s_mov_b64 exec, s[48:49]
    v_lshl_add_u32 v57, v3, 2, 2
    v_bfm_b32 v57, v57, 0
    v_and_b32 v57, s36, v57
    v_bcnt_u32_b32 v54, v57, s40
    v_mov_b32 v55, v38
    s_lshl_b32 s37, s20, 10
    v_lshl_add_u32 v56, v3, 5, s37
    v_add_u32 v56, 16, v56
    v_and_b32 v57, 4, v41
    v_cmp_ne_u32 vcc, 0, v57
    s_and_saveexec_b64 s[48:49], vcc
    s_cbranch_execz P_skip2
    v_lshrrev_b32 v57, 2, v54
    v_and_b32 v58, 3, v54
    v_lshl_add_u32 v59, v57, 4, v4
    v_lshlrev_b32 v59, 4, v59
    v_lshl_add_u32 v59, v58, 2, v59
    v_add_u32 v59, s42, v59
    v_and_b32 v60, 1, v57
    v_lshlrev_b32 v60, 1, v60
    v_lshrrev_b32 v61, 1, v58
    v_add_u32 v60, v60, v61
    v_lshrrev_b32 v61, 1, v57
    v_lshlrev_b32 v61, 1, v61
    v_and_b32 v62, 1, v58
    v_add_u32 v61, v61, v62
    v_lshl_add_u32 v60, v60, 2, v61
    v_lshl_add_u32 v60, v60, 2, s43
    v_subrev_u32 v61, 16, v54
    v_lshrrev_b32 v62, 3, v61
    v_and_b32 v62, 15, v62
    v_mul_lo_u32 v62, v62, s47
    v_add_u32 v62, s44, v62
    v_and_b32 v61, 7, v61
    v_lshrrev_b32 v57, 1, v61
    v_lshl_add_u32 v57, v57, 4, v4
    v_lshlrev_b32 v57, 3, v57
    v_and_b32 v58, 1, v61
    v_lshl_add_u32 v57, v58, 2, v57
    v_add_u32 v57, v57, v62
    v_lshl_add_u32 v58, v61, 2, v62
    v_add_u32 v58, 512, v58
    v_cmp_gt_u32 vcc, 16, v54
    s_nop 1
    v_cndmask_b32 v59, v57, v59, vcc
    v_cndmask_b32 v60, v58, v60, vcc
    buffer_store_dword v55, v59, s[16:19], 0 offen
    buffer_store_dword v56, v60, s[16:19], 0 offen
P_skip2:
    s_mov_b64 exec, s[48:49]
    v_lshl_add_u32 v57, v3, 2, 3
    v_bfm_b32 v57, v57, 0
    v_and_b32 v57, s36, v57
    v_bcnt_u32_b32 v54, v57, s40
    v_mov_b32 v55, v39
    s_lshl_b32 s37, s20, 10
    v_lshl_add_u32 v56, v3, 5, s37
    v_add_u32 v56, 24, v56
    v_and_b32 v57, 8, v41
    v_cmp_ne_u32 vcc, 0, v57
    s_and_saveexec_b64 s[48:49], vcc
    s_cbranch_execz P_skip3
    v_lshrrev_b32 v57, 2, v54
    v_and_b32 v58, 3, v54
    v_lshl_add_u32 v59, v57, 4, v4
    v_lshlrev_b32 v59, 4, v59
    v_lshl_add_u32 v59, v58, 2, v59
    v_add_u32 v59, s42, v59
    v_and_b32 v60, 1, v57
    v_lshlrev_b32 v60, 1, v60
    v_lshrrev_b32 v61, 1, v58
    v_add_u32 v60, v60, v61
    v_lshrrev_b32 v61, 1, v57
    v_lshlrev_b32 v61, 1, v61
    v_and_b32 v62, 1, v58
    v_add_u32 v61, v61, v62
    v_lshl_add_u32 v60, v60, 2, v61
    v_lshl_add_u32 v60, v60, 2, s43
    v_subrev_u32 v61, 16, v54
    v_lshrrev_b32 v62, 3, v61
    v_and_b32 v62, 15, v62
    v_mul_lo_u32 v62, v62, s47
    v_add_u32 v62, s44, v62
    v_and_b32 v61, 7, v61
    v_lshrrev_b32 v57, 1, v61
    v_lshl_add_u32 v57, v57, 4, v4
    v_lshlrev_b32 v57, 3, v57
    v_and_b32 v58, 1, v61
    v_lshl_add_u32 v57, v58, 2, v57
    v_add_u32 v57, v57, v62
    v_lshl_add_u32 v58, v61, 2, v62
    v_add_u32 v58, 512, v58
    v_cmp_gt_u32 vcc, 16, v54
    s_nop 1
    v_cndmask_b32 v59, v57, v59, vcc
    v_cndmask_b32 v60, v58, v60, vcc
    buffer_store_dword v55, v59, s[16:19], 0 offen
    buffer_store_dword v56, v60, s[16:19], 0 offen
P_skip3:
    s_mov_b64 exec, s[48:49]
    v_lshrrev_b32 v54, 4, v0
    v_add_u32 v54, s41, v54
    v_mov_b32 v55, 0
    v_mov_b32 v56, 0
    v_cmp_gt_u32 vcc, s45, v54
    s_and_saveexec_b64 s[48:49], vcc
    s_cbranch_execz P_skip4
    v_lshrrev_b32 v57, 2, v54
    v_and_b32 v58, 3, v54
    v_lshl_add_u32 v59, v57, 4, v4
    v_lshlrev_b32 v59, 4, v59
    v_lshl_add_u32 v59, v58, 2, v59
    v_add_u32 v59, s42, v59
    v_and_b32 v60, 1, v57
    v_lshlrev_b32 v60, 1, v60
    v_lshrrev_b32 v61, 1, v58
    v_add_u32 v60, v60, v61
    v_lshrrev_b32 v61, 1, v57
    v_lshlrev_b32 v61, 1, v61
    v_and_b32 v62, 1, v58
    v_add_u32 v61, v61, v62
    v_lshl_add_u32 v60, v60, 2, v61
    v_lshl_add_u32 v60, v60, 2, s43
    v_subrev_u32 v61, 16, v54
    v_lshrrev_b32 v62, 3, v61
    v_and_b32 v62, 15, v62
    v_mul_lo_u32 v62, v62, s47
    v_add_u32 v62, s44, v62
    v_and_b32 v61, 7, v61
    v_lshrrev_b32 v57, 1, v61
    v_lshl_add_u32 v57, v57, 4, v4
    v_lshlrev_b32 v57, 3, v57
    v_and_b32 v58, 1, v61
    v_lshl_add_u32 v57, v58, 2, v57
    v_add_u32 v57, v57, v62
    v_lshl_add_u32 v58, v61, 2, v62
    v_add_u32 v58, 512, v58
    v_cmp_gt_u32 vcc, 16, v54
    s_nop 1
    v_cndmask_b32 v59, v57, v59, vcc
    v_cndmask_b32 v60, v58, v60, vcc
    buffer_store_dword v55, v59, s[16:19], 0 offen
    buffer_store_dword v56, v60, s[16:19], 0 offen
P_skip4:
    s_mov_b64 exec, s[48:49]
    v_cmp_gt_u32 vcc, 16, v0
    s_and_saveexec_b64 s[48:49], vcc
    s_cbranch_execz P_end
    s_waitcnt vmcnt(0)
    v_lshlrev_b32 v15, 16, v15
    v_lshlrev_b32 v8, 2, v4
    buffer_store_dword v15, v8, s[16:19], s46 offen
    s_sub_u32 s45, s45, 16
    s_lshr_b32 s45, s45, 3
    s_lshl_b32 s37, s2, 2
    s_add_u32 s37, s37, 731648
    v_mov_b32 v8, 0
    v_mov_b32 v9, s45
    buffer_store_dword v9, v8, s[16:19], s37 offen
P_end:
    s_endpgm
.p2align 8
.type main_kernel,@function
main_kernel:
    s_cmp_ge_u32 s2, 256
    s_cbranch_scc1 M_end
    s_load_dwordx2 s[8:9], s[0:1], 0
    s_load_dwordx2 s[12:13], s[0:1], 24
    s_load_dwordx2 s[16:17], s[0:1], 40
    v_lshrrev_b32 v20, 6, v0
    v_and_b32 v21, 63, v0
    v_readfirstlane_b32 s20, v20
    s_mov_b32 s10, 75497472
    s_mov_b32 s11, 0x20000
    s_mov_b32 s14, 0
    s_mov_b32 s15, 0x20000
    s_mov_b32 s18, 731904
    s_mov_b32 s19, 0x20000
    s_mul_i32 s22, s2, 36864
    v_lshrrev_b32 v22, 3, v0
    v_mul_u32_u24 v22, 1152, v22
    v_lshrrev_b32 v23, 4, v0
    v_xor_b32 v23, v23, v0
    v_and_b32 v23, 7, v23
    v_lshl_add_u32 v5, v23, 4, v22
    v_lshlrev_b32 v11, 4, v21
    s_mul_i32 s26, s20, 9216
    s_mul_i32 s28, s20, 36
    s_add_u32 s28, s28, 731648
    s_waitcnt lgkmcnt(0)
    s_mov_b32 m0, s26
    s_nop 0
    buffer_load_dwordx4 v5, s[8:11], s22 offen offset:0 nt lds
    s_add_u32 m0, m0, 896
    s_nop 0
    buffer_load_dwordx4 v5, s[8:11], s22 offen offset:128 nt lds
    s_add_u32 m0, m0, 896
    s_nop 0
    buffer_load_dwordx4 v5, s[8:11], s22 offen offset:256 nt lds
    s_add_u32 m0, m0, 896
    s_nop 0
    buffer_load_dwordx4 v5, s[8:11], s22 offen offset:384 nt lds
    s_add_u32 m0, m0, 896
    s_nop 0
    buffer_load_dwordx4 v5, s[8:11], s22 offen offset:512 nt lds
    s_add_u32 m0, m0, 896
    s_nop 0
    buffer_load_dwordx4 v5, s[8:11], s22 offen offset:640 nt lds
    s_add_u32 m0, m0, 896
    s_nop 0
    buffer_load_dwordx4 v5, s[8:11], s22 offen offset:768 nt lds
    s_add_u32 m0, m0, 896
    s_nop 0
    buffer_load_dwordx4 v5, s[8:11], s22 offen offset:896 nt lds
    s_add_u32 m0, m0, 896
    s_nop 0
    buffer_load_dwordx4 v5, s[8:11], s22 offen offset:1024 nt lds
    s_add_u32 s30, s16, s28
    s_addc_u32 s31, s17, 0
    s_load_dwordx8 s[32:39], s[30:31], 0
    s_load_dword s40, s[30:31], 32
    s_mul_i32 s29, s20, 13088
    s_add_u32 s29, s29, 110592
    s_mul_i32 s28, s20, 10368
    s_add_u32 s28, s28, 376832
    s_mov_b32 m0, s29
    s_nop 0
    buffer_load_dwordx4 v11, s[16:19], s28 offen offset:0 lds
    s_nop 0
    buffer_load_dwordx4 v11, s[16:19], s28 offen offset:1024 lds
    s_nop 0
    buffer_load_dwordx4 v11, s[16:19], s28 offen offset:2048 lds
    s_nop 0
    buffer_load_dwordx4 v11, s[16:19], s28 offen offset:3072 lds
    s_add_u32 s28, s28, 4096
    s_add_u32 m0, m0, 4096
    s_nop 0
    buffer_load_dwordx4 v11, s[16:19], s28 offen offset:0 lds
    s_nop 0
    buffer_load_dwordx4 v11, s[16:19], s28 offen offset:1024 lds
    s_nop 0
    buffer_load_dwordx4 v11, s[16:19], s28 offen offset:2048 lds
    s_nop 0
    buffer_load_dwordx4 v11, s[16:19], s28 offen offset:3072 lds
    s_add_u32 s28, s28, 4096
    s_add_u32 m0, m0, 4096
    s_nop 0
    buffer_load_dwordx4 v11, s[16:19], s28 offen offset:0 lds
    s_nop 0
    buffer_load_dwordx4 v11, s[16:19], s28 offen offset:1024 lds
    s_mov_b64 exec, 0xff
    s_nop 0
    buffer_load_dwordx4 v11, s[16:19], s28 offen offset:2048 lds
    s_mov_b64 exec, -1
    v_lshrrev_b32 v22, 4, v21
    v_and_b32 v23, 15, v21
    v_lshrrev_b32 v24, 1, v23
    v_and_b32 v25, 7, v23
    v_lshlrev_b32 v25, 7, v25
    v_lshl_or_b32 v3, v24, 4, v25
    v_lshrrev_b32 v25, 3, v23
    v_mul_u32_u24 v4, 9216, v25
    v_lshlrev_b32 v25, 4, v22
    v_xad_u32 v1, v25, v3, v4
    v_xor_b32 v2, 64, v1
    v_add_u32 v9, s29, v25
    v_add_u32 v8, s29, v11
    v_mul_u32_u24 v24, 1152, v23
    s_lshl_b32 s28, s20, 8
    v_add3_u32 v6, v24, v25, s28
    s_lshl_b32 s28, s20, 5
    s_add_u32 s28, s28, 1024
    v_lshlrev_b32 v25, 3, v22
    v_add3_u32 v7, v24, v25, s28
    v_add_u32 v54, 512, v25
    v_lshlrev_b32 v53, 3, v21
    v_mov_b32 v10, 0xeeee4444
    s_mov_b32 s24, s22
    s_mov_b32 s23, s22
    s_mul_i32 s28, s20, 82944
    s_mul_i32 s30, s20, 11264
    s_add_u32 s30, s30, 331776
    buffer_load_dwordx4 v[12:15], v11, s[16:19], s30 offen offset:0
    buffer_load_dwordx4 v[16:19], v11, s[16:19], s30 offen offset:1024
    buffer_load_dwordx4 v[20:23], v11, s[16:19], s30 offen offset:2048
    buffer_load_dwordx4 v[24:27], v11, s[16:19], s30 offen offset:3072
    s_add_u32 s30, s30, 4096
    buffer_load_dwordx4 v[28:31], v11, s[16:19], s30 offen offset:0
    buffer_load_dwordx4 v[32:35], v11, s[16:19], s30 offen offset:1024
    buffer_load_dwordx4 v[36:39], v11, s[16:19], s30 offen offset:2048
    buffer_load_dwordx4 v[40:43], v11, s[16:19], s30 offen offset:3072
    s_add_u32 s30, s30, 4096
    buffer_load_dwordx4 v[44:47], v11, s[16:19], s30 offen offset:0
    buffer_load_dwordx4 v[48:51], v11, s[16:19], s30 offen offset:1024
    buffer_load_dword v52, v11, s[16:19], s30 offen offset:2048
    buffer_load_dwordx4 a[0:3], v11, s[16:19], s28 offen offset:0
    buffer_load_dwordx4 a[4:7], v11, s[16:19], s28 offen offset:1024
    buffer_load_dwordx4 a[8:11], v11, s[16:19], s28 offen offset:2048
    buffer_load_dwordx4 a[12:15], v11, s[16:19], s28 offen offset:3072
    s_add_u32 s28, s28, 4096
    buffer_load_dwordx4 a[16:19], v11, s[16:19], s28 offen offset:0
    buffer_load_dwordx4 a[20:23], v11, s[16:19], s28 offen offset:1024
    buffer_load_dwordx4 a[24:27], v11, s[16:19], s28 offen offset:2048
    buffer_load_dwordx4 a[28:31], v11, s[16:19], s28 offen offset:3072
    s_add_u32 s28, s28, 4096
    buffer_load_dwordx4 a[32:35], v11, s[16:19], s28 offen offset:0
    buffer_load_dwordx4 a[36:39], v11, s[16:19], s28 offen offset:1024
    buffer_load_dwordx4 a[40:43], v11, s[16:19], s28 offen offset:2048
    buffer_load_dwordx4 a[44:47], v11, s[16:19], s28 offen offset:3072
    s_add_u32 s28, s28, 4096
    buffer_load_dwordx4 a[48:51], v11, s[16:19], s28 offen offset:0
    buffer_load_dwordx4 a[52:55], v11, s[16:19], s28 offen offset:1024
    buffer_load_dwordx4 a[56:59], v11, s[16:19], s28 offen offset:2048
    buffer_load_dwordx4 a[60:63], v11, s[16:19], s28 offen offset:3072
    s_add_u32 s28, s28, 4096
    buffer_load_dwordx4 a[64:67], v11, s[16:19], s28 offen offset:0
    buffer_load_dwordx4 a[68:71], v11, s[16:19], s28 offen offset:1024
    buffer_load_dwordx4 a[72:75], v11, s[16:19], s28 offen offset:2048
    buffer_load_dwordx4 a[76:79], v11, s[16:19], s28 offen offset:3072
    s_add_u32 s22, s22, 9437184
    s_add_u32 s26, s26, 36864
    s_mov_b32 m0, s26
    s_nop 0
    buffer_load_dwordx4 v5, s[8:11], s22 offen offset:0 nt lds
    s_add_u32 m0, m0, 896
    s_nop 0
    buffer_load_dwordx4 v5, s[8:11], s22 offen offset:128 nt lds
    s_add_u32 m0, m0, 896
    s_nop 0
    buffer_load_dwordx4 v5, s[8:11], s22 offen offset:256 nt lds
    s_add_u32 m0, m0, 896
    s_nop 0
    buffer_load_dwordx4 v5, s[8:11], s22 offen offset:384 nt lds
    s_add_u32 m0, m0, 896
    s_nop 0
    buffer_load_dwordx4 v5, s[8:11], s22 offen offset:512 nt lds
    s_add_u32 m0, m0, 896
    s_nop 0
    buffer_load_dwordx4 v5, s[8:11], s22 offen offset:640 nt lds
    s_add_u32 m0, m0, 896
    s_nop 0
    buffer_load_dwordx4 v5, s[8:11], s22 offen offset:768 nt lds
    s_add_u32 m0, m0, 896
    s_nop 0
    buffer_load_dwordx4 v5, s[8:11], s22 offen offset:896 nt lds
    s_add_u32 m0, m0, 896
    s_nop 0
    buffer_load_dwordx4 v5, s[8:11], s22 offen offset:1024 nt lds
    s_add_u32 s28, s28, 4096
    buffer_load_dwordx4 a[80:83], v11, s[16:19], s28 offen offset:0
    buffer_load_dwordx4 a[84:87], v11, s[16:19], s28 offen offset:1024
    buffer_load_dwordx4 a[88:91], v11, s[16:19], s28 offen offset:2048
    buffer_load_dwordx4 a[92:95], v11, s[16:19], s28 offen offset:3072
    s_add_u32 s28, s28, 4096
    buffer_load_dwordx4 a[96:99], v11, s[16:19], s28 offen offset:0
    buffer_load_dwordx4 a[100:103], v11, s[16:19], s28 offen offset:1024
    buffer_load_dwordx4 a[104:107], v11, s[16:19], s28 offen offset:2048
    buffer_load_dwordx4 a[108:111], v11, s[16:19], s28 offen offset:3072
    s_add_u32 s28, s28, 4096
    buffer_load_dwordx4 a[112:115], v11, s[16:19], s28 offen offset:0
    buffer_load_dwordx4 a[116:119], v11, s[16:19], s28 offen offset:1024
    buffer_load_dwordx4 a[120:123], v11, s[16:19], s28 offen offset:2048
    buffer_load_dwordx4 a[124:127], v11, s[16:19], s28 offen offset:3072
    s_add_u32 s28, s28, 4096
    buffer_load_dwordx4 a[128:131], v11, s[16:19], s28 offen offset:0
    buffer_load_dwordx4 a[132:135], v11, s[16:19], s28 offen offset:1024
    buffer_load_dwordx4 a[136:139], v11, s[16:19], s28 offen offset:2048
    buffer_load_dwordx4 a[140:143], v11, s[16:19], s28 offen offset:3072
    s_add_u32 s28, s28, 4096
    buffer_load_dwordx4 a[144:147], v11, s[16:19], s28 offen offset:0
    buffer_load_dwordx4 a[148:151], v11, s[16:19], s28 offen offset:1024
    buffer_load_dwordx4 a[152:155], v11, s[16:19], s28 offen offset:2048
    buffer_load_dwordx4 a[156:159], v11, s[16:19], s28 offen offset:3072
    s_add_u32 s28, s28, 4096
    buffer_load_dwordx4 a[160:163], v11, s[16:19], s28 offen offset:0
    buffer_load_dwordx4 a[164:167], v11, s[16:19], s28 offen offset:1024
    buffer_load_dwordx4 a[168:171], v11, s[16:19], s28 offen offset:2048
    buffer_load_dwordx4 a[172:175], v11, s[16:19], s28 offen offset:3072
    s_add_u32 s28, s28, 4096
    buffer_load_dwordx4 a[176:179], v11, s[16:19], s28 offen offset:0
    buffer_load_dwordx4 a[180:183], v11, s[16:19], s28 offen offset:1024
    buffer_load_dwordx4 a[184:187], v11, s[16:19], s28 offen offset:2048
    buffer_load_dwordx4 a[188:191], v11, s[16:19], s28 offen offset:3072
    s_add_u32 s28, s28, 4096
    buffer_load_dwordx4 a[192:195], v11, s[16:19], s28 offen offset:0
    buffer_load_dwordx4 a[196:199], v11, s[16:19], s28 offen offset:1024
    s_waitcnt lgkmcnt(0)
    s_mov_b32 s27, 0
    s_add_u32 s54, s29, 10368
    s_mul_i32 s55, s20, 78336
    s_add_u32 s55, s55, 418304
    s_mov_b32 exec_lo, -1
    s_mov_b32 exec_hi, 3
    s_min_u32 s32, s32, 16
    s_mov_b32 s44, s27
    s_mov_b32 s56, 0
M_pool0:
    s_cmp_lt_u32 s56, s32
    s_cbranch_scc0 M_poole0
    s_add_u32 s57, s27, s56
    s_cmp_lt_u32 s57, 5
    s_cbranch_scc0 M_poole0
    s_mul_i32 s57, s57, 544
    s_add_u32 m0, s57, s54
    s_add_u32 s57, s56, 0
    s_mul_i32 s57, s57, 544
    s_add_u32 s57, s57, s55
    buffer_load_dwordx4 v11, s[16:19], s57 offen lds
    s_add_u32 s56, s56, 1
    s_branch M_pool0
M_poole0:
    s_add_u32 s27, s27, s32
    s_min_u32 s33, s33, 16
    s_mov_b32 s45, s27
    s_mov_b32 s56, 0
M_pool1:
    s_cmp_lt_u32 s56, s33
    s_cbranch_scc0 M_poole1
    s_add_u32 s57, s27, s56
    s_cmp_lt_u32 s57, 5
    s_cbranch_scc0 M_poole1
    s_mul_i32 s57, s57, 544
    s_add_u32 m0, s57, s54
    s_add_u32 s57, s56, 16
    s_mul_i32 s57, s57, 544
    s_add_u32 s57, s57, s55
    buffer_load_dwordx4 v11, s[16:19], s57 offen lds
    s_add_u32 s56, s56, 1
    s_branch M_pool1
M_poole1:
    s_add_u32 s27, s27, s33
    s_min_u32 s34, s34, 16
    s_mov_b32 s46, s27
    s_mov_b32 s56, 0
M_pool2:
    s_cmp_lt_u32 s56, s34
    s_cbranch_scc0 M_poole2
    s_add_u32 s57, s27, s56
    s_cmp_lt_u32 s57, 5
    s_cbranch_scc0 M_poole2
    s_mul_i32 s57, s57, 544
    s_add_u32 m0, s57, s54
    s_add_u32 s57, s56, 32
    s_mul_i32 s57, s57, 544
    s_add_u32 s57, s57, s55
    buffer_load_dwordx4 v11, s[16:19], s57 offen lds
    s_add_u32 s56, s56, 1
    s_branch M_pool2
M_poole2:
    s_add_u32 s27, s27, s34
    s_min_u32 s35, s35, 16
    s_mov_b32 s47, s27
    s_mov_b32 s56, 0
M_pool3:
    s_cmp_lt_u32 s56, s35
    s_cbranch_scc0 M_poole3
    s_add_u32 s57, s27, s56
    s_cmp_lt_u32 s57, 5
    s_cbranch_scc0 M_poole3
    s_mul_i32 s57, s57, 544
    s_add_u32 m0, s57, s54
    s_add_u32 s57, s56, 48
    s_mul_i32 s57, s57, 544
    s_add_u32 s57, s57, s55
    buffer_load_dwordx4 v11, s[16:19], s57 offen lds
    s_add_u32 s56, s56, 1
    s_branch M_pool3
M_poole3:
    s_add_u32 s27, s27, s35
    s_min_u32 s36, s36, 16
    s_mov_b32 s48, s27
    s_mov_b32 s56, 0
M_pool4:
    s_cmp_lt_u32 s56, s36
    s_cbranch_scc0 M_poole4
    s_add_u32 s57, s27, s56
    s_cmp_lt_u32 s57, 5
    s_cbranch_scc0 M_poole4
    s_mul_i32 s57, s57, 544
    s_add_u32 m0, s57, s54
    s_add_u32 s57, s56, 64
    s_mul_i32 s57, s57, 544
    s_add_u32 s57, s57, s55
    buffer_load_dwordx4 v11, s[16:19], s57 offen lds
    s_add_u32 s56, s56, 1
    s_branch M_pool4
M_poole4:
    s_add_u32 s27, s27, s36
    s_min_u32 s37, s37, 16
    s_mov_b32 s49, s27
    s_mov_b32 s56, 0
M_pool5:
    s_cmp_lt_u32 s56, s37
    s_cbranch_scc0 M_poole5
    s_add_u32 s57, s27, s56
    s_cmp_lt_u32 s57, 5
    s_cbranch_scc0 M_poole5
    s_mul_i32 s57, s57, 544
    s_add_u32 m0, s57, s54
    s_add_u32 s57, s56, 80
    s_mul_i32 s57, s57, 544
    s_add_u32 s57, s57, s55
    buffer_load_dwordx4 v11, s[16:19], s57 offen lds
    s_add_u32 s56, s56, 1
    s_branch M_pool5
M_poole5:
    s_add_u32 s27, s27, s37
    s_min_u32 s38, s38, 16
    s_mov_b32 s50, s27
    s_mov_b32 s56, 0
M_pool6:
    s_cmp_lt_u32 s56, s38
    s_cbranch_scc0 M_poole6
    s_add_u32 s57, s27, s56
    s_cmp_lt_u32 s57, 5
    s_cbranch_scc0 M_poole6
    s_mul_i32 s57, s57, 544
    s_add_u32 m0, s57, s54
    s_add_u32 s57, s56, 96
    s_mul_i32 s57, s57, 544
    s_add_u32 s57, s57, s55
    buffer_load_dwordx4 v11, s[16:19], s57 offen lds
    s_add_u32 s56, s56, 1
    s_branch M_pool6
M_poole6:
    s_add_u32 s27, s27, s38
    s_min_u32 s39, s39, 16
    s_mov_b32 s51, s27
    s_mov_b32 s56, 0
M_pool7:
    s_cmp_lt_u32 s56, s39
    s_cbranch_scc0 M_poole7
    s_add_u32 s57, s27, s56
    s_cmp_lt_u32 s57, 5
    s_cbranch_scc0 M_poole7
    s_mul_i32 s57, s57, 544
    s_add_u32 m0, s57, s54
    s_add_u32 s57, s56, 112
    s_mul_i32 s57, s57, 544
    s_add_u32 s57, s57, s55
    buffer_load_dwordx4 v11, s[16:19], s57 offen lds
    s_add_u32 s56, s56, 1
    s_branch M_pool7
M_poole7:
    s_add_u32 s27, s27, s39
    s_min_u32 s40, s40, 16
    s_mov_b32 s52, s27
    s_mov_b32 s56, 0
M_pool8:
    s_cmp_lt_u32 s56, s40
    s_cbranch_scc0 M_poole8
    s_add_u32 s57, s27, s56
    s_cmp_lt_u32 s57, 5
    s_cbranch_scc0 M_poole8
    s_mul_i32 s57, s57, 544
    s_add_u32 m0, s57, s54
    s_add_u32 s57, s56, 128
    s_mul_i32 s57, s57, 544
    s_add_u32 s57, s57, s55
    buffer_load_dwordx4 v11, s[16:19], s57 offen lds
    s_add_u32 s56, s56, 1
    s_branch M_pool8
M_poole8:
    s_add_u32 s27, s27, s40
    s_mov_b64 exec, -1
    s_add_u32 s22, s22, 9437184
    s_add_u32 s26, s26, 36864
    s_mov_b32 m0, s26
    s_nop 0
    buffer_load_dwordx4 v5, s[8:11], s22 offen offset:0 nt lds
    s_add_u32 m0, m0, 896
    s_nop 0
    buffer_load_dwordx4 v5, s[8:11], s22 offen offset:128 nt lds
    s_add_u32 m0, m0, 896
    s_nop 0
    buffer_load_dwordx4 v5, s[8:11], s22 offen offset:256 nt lds
    s_add_u32 m0, m0, 896
    s_nop 0
    buffer_load_dwordx4 v5, s[8:11], s22 offen offset:384 nt lds
    s_add_u32 m0, m0, 896
    s_nop 0
    buffer_load_dwordx4 v5, s[8:11], s22 offen offset:512 nt lds
    s_add_u32 m0, m0, 896
    s_nop 0
    buffer_load_dwordx4 v5, s[8:11], s22 offen offset:640 nt lds
    s_add_u32 m0, m0, 896
    s_nop 0
    buffer_load_dwordx4 v5, s[8:11], s22 offen offset:768 nt lds
    s_add_u32 m0, m0, 896
    s_nop 0
    buffer_load_dwordx4 v5, s[8:11], s22 offen offset:896 nt lds
    s_add_u32 m0, m0, 896
    s_nop 0
    buffer_load_dwordx4 v5, s[8:11], s22 offen offset:1024 nt lds
    buffer_load_dwordx4 a[200:203], v11, s[16:19], s28 offen offset:2048
    buffer_load_dwordx4 a[204:207], v11, s[16:19], s28 offen offset:3072
    s_add_u32 s28, s28, 4096
    buffer_load_dwordx4 a[208:211], v11, s[16:19], s28 offen offset:0
    buffer_load_dwordx4 a[212:215], v11, s[16:19], s28 offen offset:1024
    buffer_load_dwordx4 a[216:219], v11, s[16:19], s28 offen offset:2048
    buffer_load_dwordx4 a[220:223], v11, s[16:19], s28 offen offset:3072
    s_add_u32 s28, s28, 4096
    buffer_load_dwordx4 a[224:227], v11, s[16:19], s28 offen offset:0
    buffer_load_dwordx4 a[228:231], v11, s[16:19], s28 offen offset:1024
    buffer_load_dwordx4 a[232:235], v11, s[16:19], s28 offen offset:2048
    buffer_load_dwordx4 a[236:239], v11, s[16:19], s28 offen offset:3072
    s_add_u32 s28, s28, 4096
    buffer_load_dwordx4 a[240:243], v11, s[16:19], s28 offen offset:0
    buffer_load_dwordx4 a[244:247], v11, s[16:19], s28 offen offset:1024
    buffer_load_dwordx4 a[248:251], v11, s[16:19], s28 offen offset:2048
    buffer_load_dwordx4 a[252:255], v11, s[16:19], s28 offen offset:3072
    s_add_u32 s28, s28, 4096
    buffer_load_dwordx4 v[56:59], v11, s[16:19], s28 offen offset:0
    buffer_load_dwordx4 v[60:63], v11, s[16:19], s28 offen offset:1024
    buffer_load_dwordx4 v[64:67], v11, s[16:19], s28 offen offset:2048
    buffer_load_dwordx4 v[68:71], v11, s[16:19], s28 offen offset:3072
    s_add_u32 s28, s28, 4096
    buffer_load_dwordx4 v[72:75], v11, s[16:19], s28 offen offset:0
    buffer_load_dwordx4 v[76:79], v11, s[16:19], s28 offen offset:1024
    buffer_load_dwordx4 v[80:83], v11, s[16:19], s28 offen offset:2048
    buffer_load_dwordx4 v[84:87], v11, s[16:19], s28 offen offset:3072
    s_add_u32 s28, s28, 4096
    buffer_load_dwordx4 v[88:91], v11, s[16:19], s28 offen offset:0
    buffer_load_dwordx4 v[92:95], v11, s[16:19], s28 offen offset:1024
    buffer_load_dwordx4 v[96:99], v11, s[16:19], s28 offen offset:2048
    buffer_load_dwordx4 v[100:103], v11, s[16:19], s28 offen offset:3072
    s_add_u32 s28, s28, 4096
    buffer_load_dwordx4 v[104:107], v11, s[16:19], s28 offen offset:0
    buffer_load_dwordx4 v[108:111], v11, s[16:19], s28 offen offset:1024
    buffer_load_dwordx4 v[112:115], v11, s[16:19], s28 offen offset:2048
    buffer_load_dwordx4 v[116:119], v11, s[16:19], s28 offen offset:3072
    s_add_u32 s28, s28, 4096
    buffer_load_dwordx4 v[120:123], v11, s[16:19], s28 offen offset:0
    s_mov_b32 s21, 0
    s_mov_b32 s25, 0
    s_mul_i32 s26, s20, 9216
    s_waitcnt vmcnt(0)
    s_barrier
    ds_read_b128 v[196:199], v1 offset:0
    ds_read_b128 v[200:203], v2 offset:0
    ds_read_b128 v[204:207], v1 offset:1024
    ds_read_b128 v[208:211], v2 offset:1024
    ds_read_b128 v[124:127], v9 offset:9792
    ds_read_b128 v[128:131], v9 offset:9856
    ds_read_b128 v[132:135], v9 offset:9920
    ds_read_b128 v[136:139], v9 offset:9984
    ds_read_b128 v[140:143], v9 offset:10048
    ds_read_b128 v[144:147], v9 offset:10112
    ds_read_b128 v[148:151], v9 offset:10176
    ds_read_b128 v[152:155], v9 offset:10240
    ds_read_b128 v[156:159], v9 offset:10304
    s_waitcnt lgkmcnt(0)
    s_branch M_mid
M_top:
    s_cmp_eq_u32 s21, 7
    s_cbranch_scc1 M_w7
    s_waitcnt vmcnt(29) lgkmcnt(0)
M_w7r:
    s_barrier
    s_add_u32 s28, s25, s26
    s_add_u32 s30, s25, 36864
    s_cmp_eq_u32 s30, 110592
    s_cselect_b32 s30, 0, s30
    s_sub_u32 s31, s30, s25
    s_mov_b32 s25, s30
    v_add_u32 v1, s31, v1
    v_add_u32 v2, s31, v2
    v_add_u32 v4, s31, v4
    ds_read_b128 v[196:199], v1 offset:0
    ds_read_b128 v[200:203], v2 offset:0
    s_add_u32 s22, s22, 9437184
    s_add_u32 s23, s24, 18432
    s_add_u32 s24, s24, 9437184
    s_cmp_gt_u32 s21, 5
    s_cbranch_scc1 M_nodma
    s_mov_b32 m0, s28
    s_nop 0
    buffer_load_dwordx4 v5, s[8:11], s22 offen offset:0 nt lds
    s_add_u32 m0, m0, 896
    s_nop 0
    buffer_load_dwordx4 v5, s[8:11], s22 offen offset:128 nt lds
    s_add_u32 m0, m0, 896
    s_nop 0
    buffer_load_dwordx4 v5, s[8:11], s22 offen offset:256 nt lds
    s_add_u32 m0, m0, 896
    s_nop 0
    buffer_load_dwordx4 v5, s[8:11], s22 offen offset:384 nt lds
    s_add_u32 m0, m0, 896
    s_nop 0
    buffer_load_dwordx4 v5, s[8:11], s22 offen offset:512 nt lds
    s_add_u32 m0, m0, 896
    s_nop 0
    buffer_load_dwordx4 v5, s[8:11], s22 offen offset:640 nt lds
    s_add_u32 m0, m0, 896
    s_nop 0
    buffer_load_dwordx4 v5, s[8:11], s22 offen offset:768 nt lds
    s_add_u32 m0, m0, 896
    s_nop 0
    buffer_load_dwordx4 v5, s[8:11], s22 offen offset:896 nt lds
    s_add_u32 m0, m0, 896
    s_nop 0
    buffer_load_dwordx4 v5, s[8:11], s22 offen offset:1024 nt lds
M_nodma:
    v_smfmac_f32_16x16x64_bf16 v[160:163], a[252:255], v[204:211], v43 abid:1
    v_smfmac_f32_16x16x64_bf16 v[164:167], v[56:59], v[204:211], v44
    v_smfmac_f32_16x16x64_bf16 v[168:171], v[60:63], v[204:211], v44 abid:1
    v_smfmac_f32_16x16x64_bf16 v[172:175], v[64:67], v[204:211], v45
    v_smfmac_f32_16x16x64_bf16 v[176:179], v[68:71], v[204:211], v45 abid:1
    v_smfmac_f32_16x16x64_bf16 v[180:183], v[72:75], v[204:211], v46
    v_smfmac_f32_16x16x64_bf16 v[184:187], v[76:79], v[204:211], v46 abid:1
    v_smfmac_f32_16x16x64_bf16 v[188:191], v[80:83], v[204:211], v47
    v_smfmac_f32_16x16x64_bf16 v[192:195], v[84:87], v[204:211], v47 abid:1
    ds_read_b128 v[204:207], v1 offset:1024
    ds_read_b128 v[208:211], v2 offset:1024
    v_smfmac_f32_16x16x64_bf16 v[160:163], v[88:91], v[212:219], v48
    v_smfmac_f32_16x16x64_bf16 v[164:167], v[92:95], v[212:219], v48 abid:1
    v_smfmac_f32_16x16x64_bf16 v[168:171], v[96:99], v[212:219], v49
    v_smfmac_f32_16x16x64_bf16 v[172:175], v[100:103], v[212:219], v49 abid:1
    v_smfmac_f32_16x16x64_bf16 v[176:179], v[104:107], v[212:219], v50
    v_smfmac_f32_16x16x64_bf16 v[180:183], v[108:111], v[212:219], v50 abid:1
    v_smfmac_f32_16x16x64_bf16 v[184:187], v[112:115], v[212:219], v51
    v_smfmac_f32_16x16x64_bf16 v[188:191], v[116:119], v[212:219], v51 abid:1
    v_smfmac_f32_16x16x64_bf16 v[192:195], v[120:123], v[212:219], v52
M_mid:
    ds_read_b128 v[212:215], v1 offset:2048
    ds_read_b128 v[216:219], v2 offset:2048
    s_waitcnt lgkmcnt(4)
    v_smfmac_f32_16x16x64_bf16 v[124:127], a[0:3], v[196:203], v12
    v_cvt_pk_bf16_f32 v160, v160, v161
    ds_read_b128 v[220:223], v9 offset:9216
    v_smfmac_f32_16x16x64_bf16 v[128:131], a[4:7], v[196:203], v12 abid:1
    v_cvt_pk_bf16_f32 v161, v162, v163
    v_smfmac_f32_16x16x64_bf16 v[132:135], a[8:11], v[196:203], v13
    v_cvt_pk_bf16_f32 v162, v164, v165
    v_cvt_pk_bf16_f32 v163, v166, v167
    v_smfmac_f32_16x16x64_bf16 v[136:139], a[12:15], v[196:203], v13 abid:1
    buffer_store_dwordx4 v[160:163], v6, s[12:15], s23 offen offset:0
    v_smfmac_f32_16x16x64_bf16 v[140:143], a[16:19], v[196:203], v14
    ds_read_b128 v[164:167], v9 offset:9856
    ds_read_b128 v[160:163], v9 offset:9792
    s_waitcnt lgkmcnt(2)
    v_xad_u32 v220, v220, v3, v4
    v_smfmac_f32_16x16x64_bf16 v[144:147], a[20:23], v[196:203], v14 abid:1
    v_cvt_pk_bf16_f32 v168, v168, v169
    ds_read2st64_b32 v[236:237], v220 offset0:0 offset1:72
    v_xad_u32 v221, v221, v3, v4
    v_smfmac_f32_16x16x64_bf16 v[148:151], a[24:27], v[196:203], v15
    v_cvt_pk_bf16_f32 v169, v170, v171
    v_cvt_pk_bf16_f32 v170, v172, v173
    ds_read2st64_b32 v[238:239], v221 offset0:0 offset1:72
    v_xad_u32 v222, v222, v3, v4
    v_smfmac_f32_16x16x64_bf16 v[152:155], a[28:31], v[196:203], v15 abid:1
    v_cvt_pk_bf16_f32 v171, v174, v175
    ds_read2st64_b32 v[240:241], v222 offset0:0 offset1:72
    v_xad_u32 v223, v223, v3, v4
    v_smfmac_f32_16x16x64_bf16 v[156:159], a[32:35], v[196:203], v16
    ds_read_b128 v[196:199], v1 offset:3072
    ds_read_b128 v[200:203], v2 offset:3072
    buffer_store_dwordx4 v[168:171], v6, s[12:15], s23 offen offset:64
    ds_read_b128 v[172:175], v9 offset:9984
    ds_read2st64_b32 v[242:243], v223 offset0:0 offset1:72
    ds_read_b128 v[224:227], v9 offset:9280
    v_smfmac_f32_16x16x64_bf16 v[124:127], a[36:39], v[204:211], v16 abid:1
    ds_read_b128 v[168:171], v9 offset:9920
    ds_read_b128 v[228:231], v8 offset:0
    v_smfmac_f32_16x16x64_bf16 v[128:131], a[40:43], v[204:211], v17
    v_cvt_pk_bf16_f32 v176, v176, v177
    v_cvt_pk_bf16_f32 v177, v178, v179
    v_smfmac_f32_16x16x64_bf16 v[132:135], a[44:47], v[204:211], v17 abid:1
    v_cvt_pk_bf16_f32 v178, v180, v181
    v_smfmac_f32_16x16x64_bf16 v[136:139], a[48:51], v[204:211], v18
    v_cvt_pk_bf16_f32 v179, v182, v183
    buffer_store_dwordx4 v[176:179], v6, s[12:15], s23 offen offset:128
    s_waitcnt lgkmcnt(2)
    v_xad_u32 v224, v224, v3, v4
    v_smfmac_f32_16x16x64_bf16 v[140:143], a[52:55], v[204:211], v18 abid:1
    ds_read_b128 v[180:183], v9 offset:10112
    ds_read2st64_b32 v[244:245], v224 offset0:0 offset1:72
    v_xad_u32 v225, v225, v3, v4
    v_smfmac_f32_16x16x64_bf16 v[144:147], a[56:59], v[204:211], v19
    ds_read_b128 v[176:179], v9 offset:10048
    v_cvt_pk_bf16_f32 v184, v184, v185
    ds_read2st64_b32 v[246:247], v225 offset0:0 offset1:72
    v_xad_u32 v226, v226, v3, v4
    v_smfmac_f32_16x16x64_bf16 v[148:151], a[60:63], v[204:211], v19 abid:1
    v_cvt_pk_bf16_f32 v185, v186, v187
    s_waitcnt lgkmcnt(4)
    v_smfmac_f32_16x16x64_bf16 v[124:127], v[228:231], v[236:243], v10
    ds_read2st64_b32 v[248:249], v226 offset0:0 offset1:72
    v_xad_u32 v227, v227, v3, v4
    v_smfmac_f32_16x16x64_bf16 v[152:155], a[64:67], v[204:211], v20
    v_cvt_pk_bf16_f32 v186, v188, v189
    v_cvt_pk_bf16_f32 v187, v190, v191
    v_smfmac_f32_16x16x64_bf16 v[160:163], v[228:231], v[236:243], v10 abid:1
    ds_read2st64_b32 v[250:251], v227 offset0:0 offset1:72
    ds_read_b128 v[220:223], v9 offset:9344
    v_smfmac_f32_16x16x64_bf16 v[156:159], a[68:71], v[204:211], v20 abid:1
    ds_read_b128 v[204:207], v1 offset:4096
    ds_read_b128 v[208:211], v2 offset:4096
    buffer_store_dwordx4 v[184:187], v6, s[12:15], s23 offen offset:192
    ds_read_b128 v[232:235], v8 offset:1024
    v_smfmac_f32_16x16x64_bf16 v[124:127], a[72:75], v[212:219], v21
    ds_read_b128 v[188:191], v9 offset:10240
    ds_read_b128 v[184:187], v9 offset:10176
    v_smfmac_f32_16x16x64_bf16 v[128:131], a[76:79], v[212:219], v21 abid:1
    v_cvt_pk_bf16_f32 v192, v192, v193
    v_smfmac_f32_16x16x64_bf16 v[132:135], a[80:83], v[212:219], v22
    v_cvt_pk_bf16_f32 v193, v194, v195
    buffer_store_dwordx2 v[192:193], v7, s[12:15], s23 offen
    s_waitcnt lgkmcnt(5)
    v_xad_u32 v220, v220, v3, v4
    v_smfmac_f32_16x16x64_bf16 v[136:139], a[84:87], v[212:219], v22 abid:1
    ds_read_b128 v[192:195], v9 offset:10304
    ds_read2st64_b32 v[236:237], v220 offset0:0 offset1:72
    v_xad_u32 v221, v221, v3, v4
    v_smfmac_f32_16x16x64_bf16 v[140:143], a[88:91], v[212:219], v23
    s_mov_b32 s14, 75497472
    ds_read2st64_b32 v[238:239], v221 offset0:0 offset1:72
    v_xad_u32 v222, v222, v3, v4
    v_smfmac_f32_16x16x64_bf16 v[144:147], a[92:95], v[212:219], v23 abid:1
    s_waitcnt lgkmcnt(5)
    v_smfmac_f32_16x16x64_bf16 v[128:131], v[232:235], v[244:251], v10
    ds_read2st64_b32 v[240:241], v222 offset0:0 offset1:72
    v_xad_u32 v223, v223, v3, v4
    v_smfmac_f32_16x16x64_bf16 v[148:151], a[96:99], v[212:219], v24
    v_smfmac_f32_16x16x64_bf16 v[164:167], v[232:235], v[244:251], v10 abid:1
    ds_read2st64_b32 v[242:243], v223 offset0:0 offset1:72
    ds_read_b128 v[224:227], v9 offset:9408
    v_smfmac_f32_16x16x64_bf16 v[152:155], a[100:103], v[212:219], v24 abid:1
    ds_read_b128 v[228:231], v8 offset:2048
    v_smfmac_f32_16x16x64_bf16 v[156:159], a[104:107], v[212:219], v25
    ds_read_b128 v[212:215], v1 offset:5120
    ds_read_b128 v[216:219], v2 offset:5120
    v_smfmac_f32_16x16x64_bf16 v[124:127], a[108:111], v[196:203], v25 abid:1
    v_smfmac_f32_16x16x64_bf16 v[128:131], a[112:115], v[196:203], v26
    s_waitcnt lgkmcnt(3)
    v_xad_u32 v224, v224, v3, v4
    v_smfmac_f32_16x16x64_bf16 v[132:135], a[116:119], v[196:203], v26 abid:1
    ds_read2st64_b32 v[244:245], v224 offset0:0 offset1:72
    v_xad_u32 v225, v225, v3, v4
    v_smfmac_f32_16x16x64_bf16 v[136:139], a[120:123], v[196:203], v27
    ds_read2st64_b32 v[246:247], v225 offset0:0 offset1:72
    v_xad_u32 v226, v226, v3, v4
    v_smfmac_f32_16x16x64_bf16 v[140:143], a[124:127], v[196:203], v27 abid:1
    s_waitcnt lgkmcnt(4)
    v_smfmac_f32_16x16x64_bf16 v[132:135], v[228:231], v[236:243], v10
    ds_read2st64_b32 v[248:249], v226 offset0:0 offset1:72
    v_xad_u32 v227, v227, v3, v4
    v_smfmac_f32_16x16x64_bf16 v[144:147], a[128:131], v[196:203], v28
    v_smfmac_f32_16x16x64_bf16 v[168:171], v[228:231], v[236:243], v10 abid:1
    ds_read2st64_b32 v[250:251], v227 offset0:0 offset1:72
    ds_read_b128 v[220:223], v9 offset:9472
    v_smfmac_f32_16x16x64_bf16 v[148:151], a[132:135], v[196:203], v28 abid:1
    ds_read_b128 v[232:235], v8 offset:3072
    v_smfmac_f32_16x16x64_bf16 v[152:155], a[136:139], v[196:203], v29
    v_smfmac_f32_16x16x64_bf16 v[156:159], a[140:143], v[196:203], v29 abid:1
    ds_read_b128 v[196:199], v1 offset:6144
    ds_read_b128 v[200:203], v2 offset:6144
    v_smfmac_f32_16x16x64_bf16 v[124:127], a[144:147], v[204:211], v30
    s_waitcnt lgkmcnt(3)
    v_xad_u32 v220, v220, v3, v4
    v_smfmac_f32_16x16x64_bf16 v[128:131], a[148:151], v[204:211], v30 abid:1
    ds_read2st64_b32 v[236:237], v220 offset0:0 offset1:72
    v_xad_u32 v221, v221, v3, v4
    v_smfmac_f32_16x16x64_bf16 v[132:135], a[152:155], v[204:211], v31
    ds_read2st64_b32 v[238:239], v221 offset0:0 offset1:72
    v_xad_u32 v222, v222, v3, v4
    v_smfmac_f32_16x16x64_bf16 v[136:139], a[156:159], v[204:211], v31 abid:1
    s_waitcnt lgkmcnt(4)
    v_smfmac_f32_16x16x64_bf16 v[136:139], v[232:235], v[244:251], v10
    ds_read2st64_b32 v[240:241], v222 offset0:0 offset1:72
    v_xad_u32 v223, v223, v3, v4
    v_smfmac_f32_16x16x64_bf16 v[140:143], a[160:163], v[204:211], v32
    v_smfmac_f32_16x16x64_bf16 v[172:175], v[232:235], v[244:251], v10 abid:1
    ds_read2st64_b32 v[242:243], v223 offset0:0 offset1:72
    ds_read_b128 v[224:227], v9 offset:9536
    v_smfmac_f32_16x16x64_bf16 v[144:147], a[164:167], v[204:211], v32 abid:1
    ds_read_b128 v[228:231], v8 offset:4096
    v_smfmac_f32_16x16x64_bf16 v[148:151], a[168:171], v[204:211], v33
    v_smfmac_f32_16x16x64_bf16 v[152:155], a[172:175], v[204:211], v33 abid:1
    v_smfmac_f32_16x16x64_bf16 v[156:159], a[176:179], v[204:211], v34
    ds_read_b128 v[204:207], v1 offset:7168
    ds_read_b128 v[208:211], v2 offset:7168
    s_waitcnt lgkmcnt(3)
    v_xad_u32 v224, v224, v3, v4
    v_smfmac_f32_16x16x64_bf16 v[124:127], a[180:183], v[212:219], v34 abid:1
    ds_read2st64_b32 v[244:245], v224 offset0:0 offset1:72
    v_xad_u32 v225, v225, v3, v4
    v_smfmac_f32_16x16x64_bf16 v[128:131], a[184:187], v[212:219], v35
    ds_read2st64_b32 v[246:247], v225 offset0:0 offset1:72
    v_xad_u32 v226, v226, v3, v4
    v_smfmac_f32_16x16x64_bf16 v[132:135], a[188:191], v[212:219], v35 abid:1
    s_waitcnt lgkmcnt(4)
    v_smfmac_f32_16x16x64_bf16 v[140:143], v[228:231], v[236:243], v10
    ds_read2st64_b32 v[248:249], v226 offset0:0 offset1:72
    v_xad_u32 v227, v227, v3, v4
    v_smfmac_f32_16x16x64_bf16 v[136:139], a[192:195], v[212:219], v36
    v_smfmac_f32_16x16x64_bf16 v[176:179], v[228:231], v[236:243], v10 abid:1
    ds_read2st64_b32 v[250:251], v227 offset0:0 offset1:72
    ds_read_b128 v[220:223], v9 offset:9600
    v_smfmac_f32_16x16x64_bf16 v[140:143], a[196:199], v[212:219], v36 abid:1
    ds_read_b128 v[232:235], v8 offset:5120
    v_smfmac_f32_16x16x64_bf16 v[144:147], a[200:203], v[212:219], v37
    v_smfmac_f32_16x16x64_bf16 v[148:151], a[204:207], v[212:219], v37 abid:1
    v_smfmac_f32_16x16x64_bf16 v[152:155], a[208:211], v[212:219], v38
    s_waitcnt lgkmcnt(1)
    v_xad_u32 v220, v220, v3, v4
    v_smfmac_f32_16x16x64_bf16 v[156:159], a[212:215], v[212:219], v38 abid:1
    ds_read_b128 v[212:215], v1 offset:8192
    ds_read_b128 v[216:219], v2 offset:8192
    ds_read2st64_b32 v[236:237], v220 offset0:0 offset1:72
    v_xad_u32 v221, v221, v3, v4
    v_smfmac_f32_16x16x64_bf16 v[124:127], a[216:219], v[196:203], v39
    ds_read2st64_b32 v[238:239], v221 offset0:0 offset1:72
    v_xad_u32 v222, v222, v3, v4
    v_smfmac_f32_16x16x64_bf16 v[128:131], a[220:223], v[196:203], v39 abid:1
    s_waitcnt lgkmcnt(4)
    v_smfmac_f32_16x16x64_bf16 v[144:147], v[232:235], v[244:251], v10
    ds_read2st64_b32 v[240:241], v222 offset0:0 offset1:72
    v_xad_u32 v223, v223, v3, v4
    v_smfmac_f32_16x16x64_bf16 v[132:135], a[224:227], v[196:203], v40
    v_smfmac_f32_16x16x64_bf16 v[180:183], v[232:235], v[244:251], v10 abid:1
    ds_read2st64_b32 v[242:243], v223 offset0:0 offset1:72
    ds_read_b128 v[224:227], v9 offset:9664
    v_smfmac_f32_16x16x64_bf16 v[136:139], a[228:231], v[196:203], v40 abid:1
    ds_read_b128 v[228:231], v8 offset:6144
    v_smfmac_f32_16x16x64_bf16 v[140:143], a[232:235], v[196:203], v41
    v_smfmac_f32_16x16x64_bf16 v[144:147], a[236:239], v[196:203], v41 abid:1
    v_smfmac_f32_16x16x64_bf16 v[148:151], a[240:243], v[196:203], v42
    s_waitcnt lgkmcnt(1)
    v_xad_u32 v224, v224, v3, v4
    v_smfmac_f32_16x16x64_bf16 v[152:155], a[244:247], v[196:203], v42 abid:1
    ds_read2st64_b32 v[244:245], v224 offset0:0 offset1:72
    v_xad_u32 v225, v225, v3, v4
    v_smfmac_f32_16x16x64_bf16 v[156:159], a[248:251], v[196:203], v43
    ds_read_b128 v[196:199], v1 offset:18432
    ds_read_b128 v[200:203], v2 offset:18432
    ds_read2st64_b32 v[246:247], v225 offset0:0 offset1:72
    v_xad_u32 v226, v226, v3, v4
    v_smfmac_f32_16x16x64_bf16 v[124:127], a[252:255], v[204:211], v43 abid:1
    s_waitcnt lgkmcnt(4)
    v_smfmac_f32_16x16x64_bf16 v[148:151], v[228:231], v[236:243], v10
    ds_read2st64_b32 v[248:249], v226 offset0:0 offset1:72
    v_xad_u32 v227, v227, v3, v4
    v_smfmac_f32_16x16x64_bf16 v[128:131], v[56:59], v[204:211], v44
    v_smfmac_f32_16x16x64_bf16 v[184:187], v[228:231], v[236:243], v10 abid:1
    ds_read2st64_b32 v[250:251], v227 offset0:0 offset1:72
    ds_read_b128 v[220:223], v9 offset:9728
    v_smfmac_f32_16x16x64_bf16 v[132:135], v[60:63], v[204:211], v44 abid:1
    ds_read_b128 v[232:235], v8 offset:7168
    v_smfmac_f32_16x16x64_bf16 v[136:139], v[64:67], v[204:211], v45
    v_smfmac_f32_16x16x64_bf16 v[140:143], v[68:71], v[204:211], v45 abid:1
    v_smfmac_f32_16x16x64_bf16 v[144:147], v[72:75], v[204:211], v46
    s_waitcnt lgkmcnt(1)
    v_xad_u32 v220, v220, v3, v4
    v_smfmac_f32_16x16x64_bf16 v[148:151], v[76:79], v[204:211], v46 abid:1
    ds_read2st64_b32 v[236:237], v220 offset0:0 offset1:72
    v_xad_u32 v221, v221, v3, v4
    v_smfmac_f32_16x16x64_bf16 v[152:155], v[80:83], v[204:211], v47
    ds_read2st64_b32 v[238:239], v221 offset0:0 offset1:72
    v_xad_u32 v222, v222, v3, v4
    v_smfmac_f32_16x16x64_bf16 v[156:159], v[84:87], v[204:211], v47 abid:1
    ds_read_b128 v[204:207], v1 offset:19456
    ds_read_b128 v[208:211], v2 offset:19456
    s_waitcnt lgkmcnt(4)
    v_smfmac_f32_16x16x64_bf16 v[152:155], v[232:235], v[244:251], v10
    ds_read2st64_b32 v[240:241], v222 offset0:0 offset1:72
    v_xad_u32 v223, v223, v3, v4
    v_smfmac_f32_16x16x64_bf16 v[124:127], v[88:91], v[212:219], v48
    v_smfmac_f32_16x16x64_bf16 v[188:191], v[232:235], v[244:251], v10 abid:1
    ds_read2st64_b32 v[242:243], v223 offset0:0 offset1:72
    v_smfmac_f32_16x16x64_bf16 v[128:131], v[92:95], v[212:219], v48 abid:1
    ds_read_b128 v[228:231], v8 offset:8192
    v_smfmac_f32_16x16x64_bf16 v[132:135], v[96:99], v[212:219], v49
    v_smfmac_f32_16x16x64_bf16 v[136:139], v[100:103], v[212:219], v49 abid:1
    v_smfmac_f32_16x16x64_bf16 v[140:143], v[104:107], v[212:219], v50
    v_smfmac_f32_16x16x64_bf16 v[144:147], v[108:111], v[212:219], v50 abid:1
    v_smfmac_f32_16x16x64_bf16 v[148:151], v[112:115], v[212:219], v51
    v_smfmac_f32_16x16x64_bf16 v[152:155], v[116:119], v[212:219], v51 abid:1
    s_waitcnt lgkmcnt(0)
    v_smfmac_f32_16x16x64_bf16 v[156:159], v[228:231], v[236:243], v10
    v_smfmac_f32_16x16x64_bf16 v[156:159], v[120:123], v[212:219], v52
    ds_read_b128 v[212:215], v1 offset:20480
    ds_read_b128 v[216:219], v2 offset:20480
    v_smfmac_f32_16x16x64_bf16 v[192:195], v[228:231], v[236:243], v10 abid:1
    s_cmp_lg_u32 s27, 0
    s_cbranch_scc1 M_slow
M_slowr:
    v_smfmac_f32_16x16x64_bf16 v[160:163], a[0:3], v[196:203], v12
    v_smfmac_f32_16x16x64_bf16 v[164:167], a[4:7], v[196:203], v12 abid:1
    v_smfmac_f32_16x16x64_bf16 v[168:171], a[8:11], v[196:203], v13
    v_smfmac_f32_16x16x64_bf16 v[172:175], a[12:15], v[196:203], v13 abid:1
    v_smfmac_f32_16x16x64_bf16 v[176:179], a[16:19], v[196:203], v14
    v_cvt_pk_bf16_f32 v124, v124, v125
    v_smfmac_f32_16x16x64_bf16 v[180:183], a[20:23], v[196:203], v14 abid:1
    v_cvt_pk_bf16_f32 v125, v126, v127
    v_smfmac_f32_16x16x64_bf16 v[184:187], a[24:27], v[196:203], v15
    v_cvt_pk_bf16_f32 v126, v128, v129
    v_smfmac_f32_16x16x64_bf16 v[188:191], a[28:31], v[196:203], v15 abid:1
    v_cvt_pk_bf16_f32 v127, v130, v131
    v_smfmac_f32_16x16x64_bf16 v[192:195], a[32:35], v[196:203], v16
    ds_read_b128 v[196:199], v1 offset:21504
    ds_read_b128 v[200:203], v2 offset:21504
    buffer_store_dwordx4 v[124:127], v6, s[12:15], s24 offen offset:0
    v_smfmac_f32_16x16x64_bf16 v[160:163], a[36:39], v[204:211], v16 abid:1
    ds_read_b128 v[128:131], v9 offset:9856
    v_smfmac_f32_16x16x64_bf16 v[164:167], a[40:43], v[204:211], v17
    ds_read_b128 v[124:127], v9 offset:9792
    v_smfmac_f32_16x16x64_bf16 v[168:171], a[44:47], v[204:211], v17 abid:1
    v_cvt_pk_bf16_f32 v132, v132, v133
    v_smfmac_f32_16x16x64_bf16 v[172:175], a[48:51], v[204:211], v18
    v_cvt_pk_bf16_f32 v133, v134, v135
    v_smfmac_f32_16x16x64_bf16 v[176:179], a[52:55], v[204:211], v18 abid:1
    v_cvt_pk_bf16_f32 v134, v136, v137
    v_smfmac_f32_16x16x64_bf16 v[180:183], a[56:59], v[204:211], v19
    v_cvt_pk_bf16_f32 v135, v138, v139
    v_smfmac_f32_16x16x64_bf16 v[184:187], a[60:63], v[204:211], v19 abid:1
    buffer_store_dwordx4 v[132:135], v6, s[12:15], s24 offen offset:64
    v_smfmac_f32_16x16x64_bf16 v[188:191], a[64:67], v[204:211], v20
    ds_read_b128 v[136:139], v9 offset:9984
    v_smfmac_f32_16x16x64_bf16 v[192:195], a[68:71], v[204:211], v20 abid:1
    ds_read_b128 v[204:207], v1 offset:22528
    ds_read_b128 v[208:211], v2 offset:22528
    ds_read_b128 v[132:135], v9 offset:9920
    s_waitcnt lgkmcnt(8)
    v_smfmac_f32_16x16x64_bf16 v[160:163], a[72:75], v[212:219], v21
    v_cvt_pk_bf16_f32 v140, v140, v141
    v_smfmac_f32_16x16x64_bf16 v[164:167], a[76:79], v[212:219], v21 abid:1
    v_cvt_pk_bf16_f32 v141, v142, v143
    v_smfmac_f32_16x16x64_bf16 v[168:171], a[80:83], v[212:219], v22
    v_cvt_pk_bf16_f32 v142, v144, v145
    v_smfmac_f32_16x16x64_bf16 v[172:175], a[84:87], v[212:219], v22 abid:1
    v_cvt_pk_bf16_f32 v143, v146, v147
    v_smfmac_f32_16x16x64_bf16 v[176:179], a[88:91], v[212:219], v23
    buffer_store_dwordx4 v[140:143], v6, s[12:15], s24 offen offset:128
    v_smfmac_f32_16x16x64_bf16 v[180:183], a[92:95], v[212:219], v23 abid:1
    ds_read_b128 v[144:147], v9 offset:10112
    v_smfmac_f32_16x16x64_bf16 v[184:187], a[96:99], v[212:219], v24
    ds_read_b128 v[140:143], v9 offset:10048
    v_smfmac_f32_16x16x64_bf16 v[188:191], a[100:103], v[212:219], v24 abid:1
    v_cvt_pk_bf16_f32 v148, v148, v149
    v_smfmac_f32_16x16x64_bf16 v[192:195], a[104:107], v[212:219], v25
    ds_read_b128 v[212:215], v1 offset:23552
    ds_read_b128 v[216:219], v2 offset:23552
    v_cvt_pk_bf16_f32 v149, v150, v151
    s_waitcnt lgkmcnt(10)
    v_smfmac_f32_16x16x64_bf16 v[160:163], a[108:111], v[196:203], v25 abid:1
    v_cvt_pk_bf16_f32 v150, v152, v153
    v_smfmac_f32_16x16x64_bf16 v[164:167], a[112:115], v[196:203], v26
    v_cvt_pk_bf16_f32 v151, v154, v155
    v_smfmac_f32_16x16x64_bf16 v[168:171], a[116:119], v[196:203], v26 abid:1
    buffer_store_dwordx4 v[148:151], v6, s[12:15], s24 offen offset:192
    v_smfmac_f32_16x16x64_bf16 v[172:175], a[120:123], v[196:203], v27
    ds_read_b128 v[152:155], v9 offset:10240
    v_smfmac_f32_16x16x64_bf16 v[176:179], a[124:127], v[196:203], v27 abid:1
    ds_read_b128 v[148:151], v9 offset:10176
    v_smfmac_f32_16x16x64_bf16 v[180:183], a[128:131], v[196:203], v28
    v_cvt_pk_bf16_f32 v156, v156, v157
    v_smfmac_f32_16x16x64_bf16 v[184:187], a[132:135], v[196:203], v28 abid:1
    v_cvt_pk_bf16_f32 v157, v158, v159
    v_smfmac_f32_16x16x64_bf16 v[188:191], a[136:139], v[196:203], v29
    buffer_store_dwordx2 v[156:157], v7, s[12:15], s24 offen
    v_smfmac_f32_16x16x64_bf16 v[192:195], a[140:143], v[196:203], v29 abid:1
    ds_read_b128 v[196:199], v1 offset:24576
    ds_read_b128 v[200:203], v2 offset:24576
    ds_read_b128 v[156:159], v9 offset:10304
    s_waitcnt lgkmcnt(10)
    v_smfmac_f32_16x16x64_bf16 v[160:163], a[144:147], v[204:211], v30
    v_smfmac_f32_16x16x64_bf16 v[164:167], a[148:151], v[204:211], v30 abid:1
    v_smfmac_f32_16x16x64_bf16 v[168:171], a[152:155], v[204:211], v31
    v_smfmac_f32_16x16x64_bf16 v[172:175], a[156:159], v[204:211], v31 abid:1
    v_smfmac_f32_16x16x64_bf16 v[176:179], a[160:163], v[204:211], v32
    v_smfmac_f32_16x16x64_bf16 v[180:183], a[164:167], v[204:211], v32 abid:1
    v_smfmac_f32_16x16x64_bf16 v[184:187], a[168:171], v[204:211], v33
    v_smfmac_f32_16x16x64_bf16 v[188:191], a[172:175], v[204:211], v33 abid:1
    v_smfmac_f32_16x16x64_bf16 v[192:195], a[176:179], v[204:211], v34
    ds_read_b128 v[204:207], v1 offset:25600
    ds_read_b128 v[208:211], v2 offset:25600
    s_waitcnt lgkmcnt(7)
    v_smfmac_f32_16x16x64_bf16 v[160:163], a[180:183], v[212:219], v34 abid:1
    v_smfmac_f32_16x16x64_bf16 v[164:167], a[184:187], v[212:219], v35
    v_smfmac_f32_16x16x64_bf16 v[168:171], a[188:191], v[212:219], v35 abid:1
    v_smfmac_f32_16x16x64_bf16 v[172:175], a[192:195], v[212:219], v36
    v_smfmac_f32_16x16x64_bf16 v[176:179], a[196:199], v[212:219], v36 abid:1
    v_smfmac_f32_16x16x64_bf16 v[180:183], a[200:203], v[212:219], v37
    v_smfmac_f32_16x16x64_bf16 v[184:187], a[204:207], v[212:219], v37 abid:1
    v_smfmac_f32_16x16x64_bf16 v[188:191], a[208:211], v[212:219], v38
    v_smfmac_f32_16x16x64_bf16 v[192:195], a[212:215], v[212:219], v38 abid:1
    ds_read_b128 v[212:215], v1 offset:26624
    ds_read_b128 v[216:219], v2 offset:26624
    s_waitcnt lgkmcnt(5)
    v_smfmac_f32_16x16x64_bf16 v[160:163], a[216:219], v[196:203], v39
    v_smfmac_f32_16x16x64_bf16 v[164:167], a[220:223], v[196:203], v39 abid:1
    v_smfmac_f32_16x16x64_bf16 v[168:171], a[224:227], v[196:203], v40
    v_smfmac_f32_16x16x64_bf16 v[172:175], a[228:231], v[196:203], v40 abid:1
    v_smfmac_f32_16x16x64_bf16 v[176:179], a[232:235], v[196:203], v41
    v_smfmac_f32_16x16x64_bf16 v[180:183], a[236:239], v[196:203], v41 abid:1
    v_smfmac_f32_16x16x64_bf16 v[184:187], a[240:243], v[196:203], v42
    v_smfmac_f32_16x16x64_bf16 v[188:191], a[244:247], v[196:203], v42 abid:1
    v_smfmac_f32_16x16x64_bf16 v[192:195], a[248:251], v[196:203], v43
    s_add_u32 s21, s21, 1
    s_cmp_lt_u32 s21, 8
    s_cbranch_scc1 M_top
    s_add_u32 s23, s24, 18432
    s_waitcnt lgkmcnt(2)
    v_smfmac_f32_16x16x64_bf16 v[160:163], a[252:255], v[204:211], v43 abid:1
    v_smfmac_f32_16x16x64_bf16 v[164:167], v[56:59], v[204:211], v44
    v_smfmac_f32_16x16x64_bf16 v[168:171], v[60:63], v[204:211], v44 abid:1
    v_smfmac_f32_16x16x64_bf16 v[172:175], v[64:67], v[204:211], v45
    v_smfmac_f32_16x16x64_bf16 v[176:179], v[68:71], v[204:211], v45 abid:1
    v_smfmac_f32_16x16x64_bf16 v[180:183], v[72:75], v[204:211], v46
    v_smfmac_f32_16x16x64_bf16 v[184:187], v[76:79], v[204:211], v46 abid:1
    v_smfmac_f32_16x16x64_bf16 v[188:191], v[80:83], v[204:211], v47
    v_smfmac_f32_16x16x64_bf16 v[192:195], v[84:87], v[204:211], v47 abid:1
    s_waitcnt lgkmcnt(0)
    v_smfmac_f32_16x16x64_bf16 v[160:163], v[88:91], v[212:219], v48
    v_smfmac_f32_16x16x64_bf16 v[164:167], v[92:95], v[212:219], v48 abid:1
    v_smfmac_f32_16x16x64_bf16 v[168:171], v[96:99], v[212:219], v49
    v_smfmac_f32_16x16x64_bf16 v[172:175], v[100:103], v[212:219], v49 abid:1
    v_smfmac_f32_16x16x64_bf16 v[176:179], v[104:107], v[212:219], v50
    v_smfmac_f32_16x16x64_bf16 v[180:183], v[108:111], v[212:219], v50 abid:1
    v_smfmac_f32_16x16x64_bf16 v[184:187], v[112:115], v[212:219], v51
    v_smfmac_f32_16x16x64_bf16 v[188:191], v[116:119], v[212:219], v51 abid:1
    v_smfmac_f32_16x16x64_bf16 v[192:195], v[120:123], v[212:219], v52
    v_cvt_pk_bf16_f32 v160, v160, v161
    v_cvt_pk_bf16_f32 v161, v162, v163
    v_cvt_pk_bf16_f32 v162, v164, v165
    v_cvt_pk_bf16_f32 v163, v166, v167
    buffer_store_dwordx4 v[160:163], v6, s[12:15], s23 offen offset:0
    v_cvt_pk_bf16_f32 v168, v168, v169
    v_cvt_pk_bf16_f32 v169, v170, v171
    v_cvt_pk_bf16_f32 v170, v172, v173
    v_cvt_pk_bf16_f32 v171, v174, v175
    buffer_store_dwordx4 v[168:171], v6, s[12:15], s23 offen offset:64
    v_cvt_pk_bf16_f32 v176, v176, v177
    v_cvt_pk_bf16_f32 v177, v178, v179
    v_cvt_pk_bf16_f32 v178, v180, v181
    v_cvt_pk_bf16_f32 v179, v182, v183
    buffer_store_dwordx4 v[176:179], v6, s[12:15], s23 offen offset:128
    v_cvt_pk_bf16_f32 v184, v184, v185
    v_cvt_pk_bf16_f32 v185, v186, v187
    v_cvt_pk_bf16_f32 v186, v188, v189
    v_cvt_pk_bf16_f32 v187, v190, v191
    buffer_store_dwordx4 v[184:187], v6, s[12:15], s23 offen offset:192
    v_cvt_pk_bf16_f32 v192, v192, v193
    v_cvt_pk_bf16_f32 v193, v194, v195
    buffer_store_dwordx2 v[192:193], v7, s[12:15], s23 offen
M_end:
    s_endpgm
M_w7:
    s_waitcnt vmcnt(20) lgkmcnt(0)
    s_branch M_w7r
M_slow:
    s_mov_b32 s56, 0
M_sl0:
    s_cmp_lt_u32 s56, s32
    s_cbranch_scc0 M_sle0
    s_add_u32 s57, s44, s56
    s_cmp_lt_u32 s57, 5
    s_cbranch_scc0 M_slg0
    s_mul_i32 s57, s57, 544
    s_add_u32 s57, s57, s54
    v_add_u32 v252, s57, v54
    v_add_u32 v253, s57, v53
    ds_read_b64 v[220:221], v252
    ds_read_b64 v[228:229], v253
    s_waitcnt lgkmcnt(0)
    s_branch M_slc0
M_slg0:
    s_add_u32 s57, s56, 0
    s_mul_i32 s57, s57, 544
    s_add_u32 s57, s57, s55
    buffer_load_dwordx2 v[220:221], v54, s[16:19], s57 offen
    buffer_load_dwordx2 v[228:229], v53, s[16:19], s57 offen
    s_waitcnt vmcnt(0)
M_slc0:
    v_xad_u32 v220, v220, v3, v4
    v_xad_u32 v221, v221, v3, v4
    ds_read2st64_b32 v[236:237], v220 offset0:0 offset1:72
    ds_read2st64_b32 v[238:239], v221 offset0:0 offset1:72
    s_add_u32 s56, s56, 1
    s_nop 7
    s_waitcnt lgkmcnt(0)
    v_smfmac_f32_16x16x32_bf16 v[124:127], v[228:229], v[236:239], v10
    v_smfmac_f32_16x16x32_bf16 v[160:163], v[228:229], v[236:239], v10 abid:2
    s_branch M_sl0
M_sle0:
    s_mov_b32 s56, 0
M_sl1:
    s_cmp_lt_u32 s56, s33
    s_cbranch_scc0 M_sle1
    s_add_u32 s57, s45, s56
    s_cmp_lt_u32 s57, 5
    s_cbranch_scc0 M_slg1
    s_mul_i32 s57, s57, 544
    s_add_u32 s57, s57, s54
    v_add_u32 v252, s57, v54
    v_add_u32 v253, s57, v53
    ds_read_b64 v[220:221], v252
    ds_read_b64 v[228:229], v253
    s_waitcnt lgkmcnt(0)
    s_branch M_slc1
M_slg1:
    s_add_u32 s57, s56, 16
    s_mul_i32 s57, s57, 544
    s_add_u32 s57, s57, s55
    buffer_load_dwordx2 v[220:221], v54, s[16:19], s57 offen
    buffer_load_dwordx2 v[228:229], v53, s[16:19], s57 offen
    s_waitcnt vmcnt(0)
M_slc1:
    v_xad_u32 v220, v220, v3, v4
    v_xad_u32 v221, v221, v3, v4
    ds_read2st64_b32 v[236:237], v220 offset0:0 offset1:72
    ds_read2st64_b32 v[238:239], v221 offset0:0 offset1:72
    s_add_u32 s56, s56, 1
    s_nop 7
    s_waitcnt lgkmcnt(0)
    v_smfmac_f32_16x16x32_bf16 v[128:131], v[228:229], v[236:239], v10
    v_smfmac_f32_16x16x32_bf16 v[164:167], v[228:229], v[236:239], v10 abid:2
    s_branch M_sl1
M_sle1:
    s_mov_b32 s56, 0
M_sl2:
    s_cmp_lt_u32 s56, s34
    s_cbranch_scc0 M_sle2
    s_add_u32 s57, s46, s56
    s_cmp_lt_u32 s57, 5
    s_cbranch_scc0 M_slg2
    s_mul_i32 s57, s57, 544
    s_add_u32 s57, s57, s54
    v_add_u32 v252, s57, v54
    v_add_u32 v253, s57, v53
    ds_read_b64 v[220:221], v252
    ds_read_b64 v[228:229], v253
    s_waitcnt lgkmcnt(0)
    s_branch M_slc2
M_slg2:
    s_add_u32 s57, s56, 32
    s_mul_i32 s57, s57, 544
    s_add_u32 s57, s57, s55
    buffer_load_dwordx2 v[220:221], v54, s[16:19], s57 offen
    buffer_load_dwordx2 v[228:229], v53, s[16:19], s57 offen
    s_waitcnt vmcnt(0)
M_slc2:
    v_xad_u32 v220, v220, v3, v4
    v_xad_u32 v221, v221, v3, v4
    ds_read2st64_b32 v[236:237], v220 offset0:0 offset1:72
    ds_read2st64_b32 v[238:239], v221 offset0:0 offset1:72
    s_add_u32 s56, s56, 1
    s_nop 7
    s_waitcnt lgkmcnt(0)
    v_smfmac_f32_16x16x32_bf16 v[132:135], v[228:229], v[236:239], v10
    v_smfmac_f32_16x16x32_bf16 v[168:171], v[228:229], v[236:239], v10 abid:2
    s_branch M_sl2
M_sle2:
    s_mov_b32 s56, 0
M_sl3:
    s_cmp_lt_u32 s56, s35
    s_cbranch_scc0 M_sle3
    s_add_u32 s57, s47, s56
    s_cmp_lt_u32 s57, 5
    s_cbranch_scc0 M_slg3
    s_mul_i32 s57, s57, 544
    s_add_u32 s57, s57, s54
    v_add_u32 v252, s57, v54
    v_add_u32 v253, s57, v53
    ds_read_b64 v[220:221], v252
    ds_read_b64 v[228:229], v253
    s_waitcnt lgkmcnt(0)
    s_branch M_slc3
M_slg3:
    s_add_u32 s57, s56, 48
    s_mul_i32 s57, s57, 544
    s_add_u32 s57, s57, s55
    buffer_load_dwordx2 v[220:221], v54, s[16:19], s57 offen
    buffer_load_dwordx2 v[228:229], v53, s[16:19], s57 offen
    s_waitcnt vmcnt(0)
M_slc3:
    v_xad_u32 v220, v220, v3, v4
    v_xad_u32 v221, v221, v3, v4
    ds_read2st64_b32 v[236:237], v220 offset0:0 offset1:72
    ds_read2st64_b32 v[238:239], v221 offset0:0 offset1:72
    s_add_u32 s56, s56, 1
    s_nop 7
    s_waitcnt lgkmcnt(0)
    v_smfmac_f32_16x16x32_bf16 v[136:139], v[228:229], v[236:239], v10
    v_smfmac_f32_16x16x32_bf16 v[172:175], v[228:229], v[236:239], v10 abid:2
    s_branch M_sl3
M_sle3:
    s_mov_b32 s56, 0
M_sl4:
    s_cmp_lt_u32 s56, s36
    s_cbranch_scc0 M_sle4
    s_add_u32 s57, s48, s56
    s_cmp_lt_u32 s57, 5
    s_cbranch_scc0 M_slg4
    s_mul_i32 s57, s57, 544
    s_add_u32 s57, s57, s54
    v_add_u32 v252, s57, v54
    v_add_u32 v253, s57, v53
    ds_read_b64 v[220:221], v252
    ds_read_b64 v[228:229], v253
    s_waitcnt lgkmcnt(0)
    s_branch M_slc4
M_slg4:
    s_add_u32 s57, s56, 64
    s_mul_i32 s57, s57, 544
    s_add_u32 s57, s57, s55
    buffer_load_dwordx2 v[220:221], v54, s[16:19], s57 offen
    buffer_load_dwordx2 v[228:229], v53, s[16:19], s57 offen
    s_waitcnt vmcnt(0)
M_slc4:
    v_xad_u32 v220, v220, v3, v4
    v_xad_u32 v221, v221, v3, v4
    ds_read2st64_b32 v[236:237], v220 offset0:0 offset1:72
    ds_read2st64_b32 v[238:239], v221 offset0:0 offset1:72
    s_add_u32 s56, s56, 1
    s_nop 7
    s_waitcnt lgkmcnt(0)
    v_smfmac_f32_16x16x32_bf16 v[140:143], v[228:229], v[236:239], v10
    v_smfmac_f32_16x16x32_bf16 v[176:179], v[228:229], v[236:239], v10 abid:2
    s_branch M_sl4
M_sle4:
    s_mov_b32 s56, 0
M_sl5:
    s_cmp_lt_u32 s56, s37
    s_cbranch_scc0 M_sle5
    s_add_u32 s57, s49, s56
    s_cmp_lt_u32 s57, 5
    s_cbranch_scc0 M_slg5
    s_mul_i32 s57, s57, 544
    s_add_u32 s57, s57, s54
    v_add_u32 v252, s57, v54
    v_add_u32 v253, s57, v53
    ds_read_b64 v[220:221], v252
    ds_read_b64 v[228:229], v253
    s_waitcnt lgkmcnt(0)
    s_branch M_slc5
M_slg5:
    s_add_u32 s57, s56, 80
    s_mul_i32 s57, s57, 544
    s_add_u32 s57, s57, s55
    buffer_load_dwordx2 v[220:221], v54, s[16:19], s57 offen
    buffer_load_dwordx2 v[228:229], v53, s[16:19], s57 offen
    s_waitcnt vmcnt(0)
M_slc5:
    v_xad_u32 v220, v220, v3, v4
    v_xad_u32 v221, v221, v3, v4
    ds_read2st64_b32 v[236:237], v220 offset0:0 offset1:72
    ds_read2st64_b32 v[238:239], v221 offset0:0 offset1:72
    s_add_u32 s56, s56, 1
    s_nop 7
    s_waitcnt lgkmcnt(0)
    v_smfmac_f32_16x16x32_bf16 v[144:147], v[228:229], v[236:239], v10
    v_smfmac_f32_16x16x32_bf16 v[180:183], v[228:229], v[236:239], v10 abid:2
    s_branch M_sl5
M_sle5:
    s_mov_b32 s56, 0
M_sl6:
    s_cmp_lt_u32 s56, s38
    s_cbranch_scc0 M_sle6
    s_add_u32 s57, s50, s56
    s_cmp_lt_u32 s57, 5
    s_cbranch_scc0 M_slg6
    s_mul_i32 s57, s57, 544
    s_add_u32 s57, s57, s54
    v_add_u32 v252, s57, v54
    v_add_u32 v253, s57, v53
    ds_read_b64 v[220:221], v252
    ds_read_b64 v[228:229], v253
    s_waitcnt lgkmcnt(0)
    s_branch M_slc6
M_slg6:
    s_add_u32 s57, s56, 96
    s_mul_i32 s57, s57, 544
    s_add_u32 s57, s57, s55
    buffer_load_dwordx2 v[220:221], v54, s[16:19], s57 offen
    buffer_load_dwordx2 v[228:229], v53, s[16:19], s57 offen
    s_waitcnt vmcnt(0)
M_slc6:
    v_xad_u32 v220, v220, v3, v4
    v_xad_u32 v221, v221, v3, v4
    ds_read2st64_b32 v[236:237], v220 offset0:0 offset1:72
    ds_read2st64_b32 v[238:239], v221 offset0:0 offset1:72
    s_add_u32 s56, s56, 1
    s_nop 7
    s_waitcnt lgkmcnt(0)
    v_smfmac_f32_16x16x32_bf16 v[148:151], v[228:229], v[236:239], v10
    v_smfmac_f32_16x16x32_bf16 v[184:187], v[228:229], v[236:239], v10 abid:2
    s_branch M_sl6
M_sle6:
    s_mov_b32 s56, 0
M_sl7:
    s_cmp_lt_u32 s56, s39
    s_cbranch_scc0 M_sle7
    s_add_u32 s57, s51, s56
    s_cmp_lt_u32 s57, 5
    s_cbranch_scc0 M_slg7
    s_mul_i32 s57, s57, 544
    s_add_u32 s57, s57, s54
    v_add_u32 v252, s57, v54
    v_add_u32 v253, s57, v53
    ds_read_b64 v[220:221], v252
    ds_read_b64 v[228:229], v253
    s_waitcnt lgkmcnt(0)
    s_branch M_slc7
M_slg7:
    s_add_u32 s57, s56, 112
    s_mul_i32 s57, s57, 544
    s_add_u32 s57, s57, s55
    buffer_load_dwordx2 v[220:221], v54, s[16:19], s57 offen
    buffer_load_dwordx2 v[228:229], v53, s[16:19], s57 offen
    s_waitcnt vmcnt(0)
M_slc7:
    v_xad_u32 v220, v220, v3, v4
    v_xad_u32 v221, v221, v3, v4
    ds_read2st64_b32 v[236:237], v220 offset0:0 offset1:72
    ds_read2st64_b32 v[238:239], v221 offset0:0 offset1:72
    s_add_u32 s56, s56, 1
    s_nop 7
    s_waitcnt lgkmcnt(0)
    v_smfmac_f32_16x16x32_bf16 v[152:155], v[228:229], v[236:239], v10
    v_smfmac_f32_16x16x32_bf16 v[188:191], v[228:229], v[236:239], v10 abid:2
    s_branch M_sl7
M_sle7:
    s_mov_b32 s56, 0
M_sl8:
    s_cmp_lt_u32 s56, s40
    s_cbranch_scc0 M_sle8
    s_add_u32 s57, s52, s56
    s_cmp_lt_u32 s57, 5
    s_cbranch_scc0 M_slg8
    s_mul_i32 s57, s57, 544
    s_add_u32 s57, s57, s54
    v_add_u32 v252, s57, v54
    v_add_u32 v253, s57, v53
    ds_read_b64 v[220:221], v252
    ds_read_b64 v[228:229], v253
    s_waitcnt lgkmcnt(0)
    s_branch M_slc8
M_slg8:
    s_add_u32 s57, s56, 128
    s_mul_i32 s57, s57, 544
    s_add_u32 s57, s57, s55
    buffer_load_dwordx2 v[220:221], v54, s[16:19], s57 offen
    buffer_load_dwordx2 v[228:229], v53, s[16:19], s57 offen
    s_waitcnt vmcnt(0)
M_slc8:
    v_xad_u32 v220, v220, v3, v4
    v_xad_u32 v221, v221, v3, v4
    ds_read2st64_b32 v[236:237], v220 offset0:0 offset1:72
    ds_read2st64_b32 v[238:239], v221 offset0:0 offset1:72
    s_add_u32 s56, s56, 1
    s_nop 7
    s_waitcnt lgkmcnt(0)
    v_smfmac_f32_16x16x32_bf16 v[156:159], v[228:229], v[236:239], v10
    v_smfmac_f32_16x16x32_bf16 v[192:195], v[228:229], v[236:239], v10 abid:2
    s_branch M_sl8
M_sle8:
    s_nop 7
    s_branch M_slowr
.section .rodata,"a"
.p2align 6
.amdhsa_kernel prep_kernel
  .amdhsa_next_free_vgpr 64
  .amdhsa_next_free_sgpr 64
  .amdhsa_accum_offset 64
  .amdhsa_group_segment_fixed_size 0
  .amdhsa_kernarg_size 48
  .amdhsa_user_sgpr_count 2
  .amdhsa_user_sgpr_kernarg_segment_ptr 1
  .amdhsa_system_sgpr_workgroup_id_x 1
  .amdhsa_float_denorm_mode_32 3
.end_amdhsa_kernel
.p2align 6
.amdhsa_kernel main_kernel
  .amdhsa_next_free_vgpr 512
  .amdhsa_next_free_sgpr 64
  .amdhsa_accum_offset 256
  .amdhsa_group_segment_fixed_size 0
  .amdhsa_kernarg_size 48
  .amdhsa_user_sgpr_count 2
  .amdhsa_user_sgpr_kernarg_segment_ptr 1
  .amdhsa_system_sgpr_workgroup_id_x 1
  .amdhsa_float_denorm_mode_32 3
.end_amdhsa_kernel
```

```asm
; @launch grid=(256,1,1) block=(256,1,1) lds=163136
.amdgcn_target "amdgcn-amd-amdhsa--gfx950"
.text
.globl standalone__structured_sparse_n_m__ragged_kernel
.p2align 8
.type standalone__structured_sparse_n_m__ragged_kernel,@function
standalone__structured_sparse_n_m__ragged_kernel:
    s_cmp_ge_u32 s2, 256
    s_cbranch_scc1 M_end
    s_load_dwordx8 s[72:79], s[0:1], 0
    s_load_dwordx4 s[80:83], s[0:1], 32
    v_lshrrev_b32 v20, 6, v0
    v_and_b32 v12, 63, v0
    v_readfirstlane_b32 s20, v20
    v_lshrrev_b32 v13, 4, v12
    v_and_b32 v14, 15, v12
    v_lshlrev_b32 v11, 4, v12
    v_lshlrev_b32 v54, 3, v12
    s_mov_b32 s6, 663552
    s_mov_b32 s7, 0x20000
    s_mov_b32 s18, 727552
    s_mov_b32 s19, 0x20000
    s_mov_b32 s70, 256
    s_mov_b32 s71, 0x20000
    s_cmp_lt_u32 s2, 84
    s_cbranch_scc1 F_task
    s_cmp_lt_u32 s2, 120
    s_cbranch_scc1 C_task
    s_mov_b32 s41, 3
M_x:
    v_lshrrev_b32 v22, 3, v0
    v_mul_u32_u24 v22, 1152, v22
    v_lshrrev_b32 v23, 4, v0
    v_xor_b32 v23, v23, v0
    v_and_b32 v23, 7, v23
    v_lshl_add_u32 v5, v23, 4, v22
    s_mov_b32 s10, 75497472
    s_mov_b32 s11, 0x20000
    s_mov_b32 s86, 1152
    s_mov_b32 s87, 0x20000
    s_mul_i32 s22, s2, 36864
    s_mul_i32 s26, s20, 9216
    s_mov_b32 s24, s22
    s_mov_b32 s42, s26
    s_lshl_b32 s28, s20, 8
    s_lshl_b32 s30, s20, 5
    v_lshlrev_b32 v25, 4, v13
    v_lshlrev_b32 v26, 3, v13
    s_mov_b32 s21, 0
    s_waitcnt lgkmcnt(0)
    s_mov_b32 s8, s72
    s_mov_b32 s9, s73
    s_mov_b32 s84, s76
    s_mov_b32 s85, s77
    s_mov_b32 s68, s80
    s_mov_b32 s69, s81
    buffer_load_dwordx4 v[196:199], v25, s[84:87], s28 offen offset:0
    buffer_load_dwordx4 v[200:203], v25, s[84:87], s28 offen offset:64
    buffer_load_dwordx4 v[204:207], v25, s[84:87], s28 offen offset:128
    buffer_load_dwordx4 v[208:211], v25, s[84:87], s28 offen offset:192
    buffer_load_dwordx2 v[212:213], v26, s[84:87], s30 offen offset:1024
M_xl:
    s_add_u32 s21, s21, 1
    s_cmp_lt_u32 s21, s41
    s_cbranch_scc1 M_xn
    buffer_load_dword v0, off, s[68:71], 0 offset:128 sc1
M_xn:
    s_mov_b32 m0, s42
    s_nop 0
    buffer_load_dwordx4 v5, s[8:11], s22 offen offset:0 nt lds
    s_add_u32 m0, m0, 896
    s_nop 0
    buffer_load_dwordx4 v5, s[8:11], s22 offen offset:128 nt lds
    s_add_u32 m0, m0, 896
    s_nop 0
    buffer_load_dwordx4 v5, s[8:11], s22 offen offset:256 nt lds
    s_add_u32 m0, m0, 896
    s_nop 0
    buffer_load_dwordx4 v5, s[8:11], s22 offen offset:384 nt lds
    s_add_u32 m0, m0, 896
    s_nop 0
    buffer_load_dwordx4 v5, s[8:11], s22 offen offset:512 nt lds
    s_add_u32 m0, m0, 896
    s_nop 0
    buffer_load_dwordx4 v5, s[8:11], s22 offen offset:640 nt lds
    s_add_u32 m0, m0, 896
    s_nop 0
    buffer_load_dwordx4 v5, s[8:11], s22 offen offset:768 nt lds
    s_add_u32 m0, m0, 896
    s_nop 0
    buffer_load_dwordx4 v5, s[8:11], s22 offen offset:896 nt lds
    s_add_u32 m0, m0, 896
    s_nop 0
    buffer_load_dwordx4 v5, s[8:11], s22 offen offset:1024 nt lds
    s_add_u32 s22, s22, 9437184
    s_add_u32 s42, s42, 36864
    s_cmp_lt_u32 s21, s41
    s_cbranch_scc1 M_xl
    s_mov_b32 s12, s78
    s_mov_b32 s13, s79
    s_mov_b32 s14, 75497472
    s_mov_b32 s15, 0x20000
    s_mov_b32 s16, s82
    s_mov_b32 s17, s83
    s_mul_i32 s29, s20, 13136
    s_add_u32 s29, s29, 110592
    v_lshrrev_b32 v24, 1, v14
    v_and_b32 v27, 7, v14
    v_lshlrev_b32 v22, 7, v27
    v_lshl_or_b32 v3, v24, 4, v22
    v_lshrrev_b32 v23, 3, v14
    v_mul_u32_u24 v4, 9216, v23
    v_xad_u32 v1, v25, v3, v4
    v_xor_b32 v2, 64, v1
    v_add_u32 v9, s29, v25
    v_add_u32 v8, s29, v11
    v_mul_u32_u24 v24, 1152, v27
    v_lshl_add_u32 v24, v23, 6, v24
    v_add3_u32 v6, v24, v25, s28
    v_mul_u32_u24 v24, 1152, v14
    s_add_u32 s30, s30, 1024
    v_add3_u32 v7, v24, v26, s30
    v_add_u32 v55, 512, v26
    v_mov_b32 v10, 0xeeee4444
    s_mov_b32 vcc_lo, 0xff00ff00
    s_mov_b32 vcc_hi, 0xff00ff00
    s_add_u32 s59, s24, 9216
    s_mul_i32 s43, s20, 82944
    s_mul_i32 s53, s20, 10752
    s_add_u32 s53, s53, 331776
    s_mul_i32 s67, s20, 9856
    s_add_u32 s67, s67, 374784
    s_waitcnt vmcnt(9)
    v_lshlrev_b32 v124, 16, v196
    v_and_b32 v125, 0xffff0000, v196
    v_lshlrev_b32 v126, 16, v197
    v_and_b32 v127, 0xffff0000, v197
    v_lshlrev_b32 v128, 16, v198
    v_and_b32 v129, 0xffff0000, v198
    v_lshlrev_b32 v130, 16, v199
    v_and_b32 v131, 0xffff0000, v199
    v_lshlrev_b32 v132, 16, v200
    v_and_b32 v133, 0xffff0000, v200
    v_lshlrev_b32 v134, 16, v201
    v_and_b32 v135, 0xffff0000, v201
    v_lshlrev_b32 v136, 16, v202
    v_and_b32 v137, 0xffff0000, v202
    v_lshlrev_b32 v138, 16, v203
    v_and_b32 v139, 0xffff0000, v203
    v_lshlrev_b32 v140, 16, v204
    v_and_b32 v141, 0xffff0000, v204
    v_lshlrev_b32 v142, 16, v205
    v_and_b32 v143, 0xffff0000, v205
    v_lshlrev_b32 v144, 16, v206
    v_and_b32 v145, 0xffff0000, v206
    v_lshlrev_b32 v146, 16, v207
    v_and_b32 v147, 0xffff0000, v207
    v_lshlrev_b32 v148, 16, v208
    v_and_b32 v149, 0xffff0000, v208
    v_lshlrev_b32 v150, 16, v209
    v_and_b32 v151, 0xffff0000, v209
    v_lshlrev_b32 v152, 16, v210
    v_and_b32 v153, 0xffff0000, v210
    v_lshlrev_b32 v154, 16, v211
    v_and_b32 v155, 0xffff0000, v211
    v_lshlrev_b32 v156, 16, v212
    v_and_b32 v157, 0xffff0000, v212
    v_lshlrev_b32 v158, 16, v213
    v_and_b32 v159, 0xffff0000, v213
    s_mov_b32 exec_lo, 0x00010001
    s_mov_b32 exec_hi, 0x00010001
    ds_write_b128 v9, v[124:127] offset:9840
    ds_write_b128 v9, v[128:131] offset:9904
    ds_write_b128 v9, v[132:135] offset:9968
    ds_write_b128 v9, v[136:139] offset:10032
    ds_write_b128 v9, v[140:143] offset:10096
    ds_write_b128 v9, v[144:147] offset:10160
    ds_write_b128 v9, v[148:151] offset:10224
    ds_write_b128 v9, v[152:155] offset:10288
    ds_write_b128 v9, v[156:159] offset:10352
    s_mov_b64 exec, -1
    v_readfirstlane_b32 s30, v0
    s_mov_b32 s31, 131072
    s_cmp_ge_u32 s30, 1
    s_cbranch_scc0 M_pf_spin
M_pf_ok:
    buffer_load_dwordx2 v[12:13], v54, s[16:19], s53 offen offset:0 sc1
    buffer_load_dwordx4 a[0:3], v11, s[16:19], s43 offen offset:0 sc1
    buffer_load_dwordx4 a[4:7], v11, s[16:19], s43 offen offset:1024 sc1
    buffer_load_dwordx4 a[8:11], v11, s[16:19], s43 offen offset:2048 sc1
    buffer_load_dwordx4 a[12:15], v11, s[16:19], s43 offen offset:3072 sc1
    buffer_load_dwordx2 v[14:15], v54, s[16:19], s53 offen offset:512 sc1
    s_add_u32 s43, s43, 4096
    buffer_load_dwordx4 a[16:19], v11, s[16:19], s43 offen offset:0 sc1
    buffer_load_dwordx4 a[20:23], v11, s[16:19], s43 offen offset:1024 sc1
    buffer_load_dwordx4 a[24:27], v11, s[16:19], s43 offen offset:2048 sc1
    buffer_load_dwordx4 a[28:31], v11, s[16:19], s43 offen offset:3072 sc1
    ds_read_b128 v[160:163], v9 offset:9840
    ds_read_b128 v[164:167], v9 offset:9904
    ds_read_b128 v[168:171], v9 offset:9968
    ds_read_b128 v[172:175], v9 offset:10032
    ds_read_b128 v[176:179], v9 offset:10096
    ds_read_b128 v[180:183], v9 offset:10160
    ds_read_b128 v[184:187], v9 offset:10224
    ds_read_b128 v[188:191], v9 offset:10288
    ds_read_b128 v[192:195], v9 offset:10352
    s_waitcnt vmcnt(8)
    s_barrier
    ds_read_b128 v[196:199], v1 offset:0
    ds_read_b128 v[200:203], v2 offset:0
    ds_read_b128 v[212:215], v1 offset:18432
    ds_read_b128 v[216:219], v2 offset:18432
    buffer_load_dwordx2 v[16:17], v54, s[16:19], s53 offen offset:1024 sc1
    s_add_u32 s43, s43, 4096
    buffer_load_dwordx4 a[32:35], v11, s[16:19], s43 offen offset:0 sc1
    s_waitcnt lgkmcnt(2)
    v_smfmac_f32_16x16x64_bf16 v[124:127], a[0:3], v[196:203], v12
    s_waitcnt lgkmcnt(0)
    v_smfmac_f32_16x16x64_bf16 v[160:163], a[0:3], v[212:219], v12
    buffer_load_dwordx4 a[36:39], v11, s[16:19], s43 offen offset:1024 sc1
    ds_read_b128 v[244:247], v1 offset:1024
    ds_read_b128 v[248:251], v2 offset:1024
    s_waitcnt vmcnt(10)
    v_smfmac_f32_16x16x64_bf16 v[128:131], a[4:7], v[196:203], v12 abid:1
    v_smfmac_f32_16x16x64_bf16 v[164:167], a[4:7], v[212:219], v12 abid:1
    buffer_load_dwordx4 a[40:43], v11, s[16:19], s43 offen offset:2048 sc1
    ds_read_b128 v[204:207], v1 offset:19456
    ds_read_b128 v[208:211], v2 offset:19456
    s_waitcnt vmcnt(10)
    v_smfmac_f32_16x16x64_bf16 v[132:135], a[8:11], v[196:203], v13
    v_smfmac_f32_16x16x64_bf16 v[168:171], a[8:11], v[212:219], v13
    buffer_load_dwordx4 a[44:47], v11, s[16:19], s43 offen offset:3072 sc1
    s_waitcnt vmcnt(10)
    v_smfmac_f32_16x16x64_bf16 v[136:139], a[12:15], v[196:203], v13 abid:1
    v_smfmac_f32_16x16x64_bf16 v[172:175], a[12:15], v[212:219], v13 abid:1
    buffer_load_dwordx2 v[18:19], v54, s[16:19], s53 offen offset:1536 sc1
    s_add_u32 s43, s43, 4096
    buffer_load_dwordx4 a[48:51], v11, s[16:19], s43 offen offset:0 sc1
    s_waitcnt vmcnt(10)
    v_smfmac_f32_16x16x64_bf16 v[140:143], a[16:19], v[196:203], v14
    v_smfmac_f32_16x16x64_bf16 v[176:179], a[16:19], v[212:219], v14
    buffer_load_dwordx4 a[52:55], v11, s[16:19], s43 offen offset:1024 sc1
    s_waitcnt vmcnt(10)
    v_smfmac_f32_16x16x64_bf16 v[144:147], a[20:23], v[196:203], v14 abid:1
    v_smfmac_f32_16x16x64_bf16 v[180:183], a[20:23], v[212:219], v14 abid:1
    buffer_load_dwordx4 a[56:59], v11, s[16:19], s43 offen offset:2048 sc1
    s_waitcnt vmcnt(10)
    v_smfmac_f32_16x16x64_bf16 v[148:151], a[24:27], v[196:203], v15
    v_smfmac_f32_16x16x64_bf16 v[184:187], a[24:27], v[212:219], v15
    buffer_load_dwordx4 a[60:63], v11, s[16:19], s43 offen offset:3072 sc1
    s_waitcnt vmcnt(10)
    v_smfmac_f32_16x16x64_bf16 v[152:155], a[28:31], v[196:203], v15 abid:1
    v_smfmac_f32_16x16x64_bf16 v[188:191], a[28:31], v[212:219], v15 abid:1
    buffer_load_dwordx2 v[20:21], v54, s[16:19], s53 offen offset:2048 sc1
    s_add_u32 s43, s43, 4096
    buffer_load_dwordx4 a[64:67], v11, s[16:19], s43 offen offset:0 sc1
    s_waitcnt vmcnt(10)
    v_smfmac_f32_16x16x64_bf16 v[156:159], a[32:35], v[196:203], v16
    v_smfmac_f32_16x16x64_bf16 v[192:195], a[32:35], v[212:219], v16
    buffer_load_dwordx4 a[68:71], v11, s[16:19], s43 offen offset:1024 sc1
    s_waitcnt vmcnt(10)
    s_waitcnt lgkmcnt(2)
    v_smfmac_f32_16x16x64_bf16 v[124:127], a[36:39], v[244:251], v16 abid:1
    s_waitcnt lgkmcnt(0)
    v_smfmac_f32_16x16x64_bf16 v[160:163], a[36:39], v[204:211], v16 abid:1
    buffer_load_dwordx4 a[72:75], v11, s[16:19], s43 offen offset:2048 sc1
    ds_read_b128 v[196:199], v1 offset:2048
    ds_read_b128 v[200:203], v2 offset:2048
    s_waitcnt vmcnt(10)
    v_smfmac_f32_16x16x64_bf16 v[128:131], a[40:43], v[244:251], v17
    v_smfmac_f32_16x16x64_bf16 v[164:167], a[40:43], v[204:211], v17
    buffer_load_dwordx4 a[76:79], v11, s[16:19], s43 offen offset:3072 sc1
    ds_read_b128 v[212:215], v1 offset:20480
    ds_read_b128 v[216:219], v2 offset:20480
    s_waitcnt vmcnt(10)
    v_smfmac_f32_16x16x64_bf16 v[132:135], a[44:47], v[244:251], v17 abid:1
    v_smfmac_f32_16x16x64_bf16 v[168:171], a[44:47], v[204:211], v17 abid:1
    buffer_load_dwordx2 v[22:23], v54, s[16:19], s53 offen offset:2560 sc1
    s_add_u32 s43, s43, 4096
    buffer_load_dwordx4 a[80:83], v11, s[16:19], s43 offen offset:0 sc1
    s_waitcnt vmcnt(10)
    v_smfmac_f32_16x16x64_bf16 v[136:139], a[48:51], v[244:251], v18
    v_smfmac_f32_16x16x64_bf16 v[172:175], a[48:51], v[204:211], v18
    buffer_load_dwordx4 a[84:87], v11, s[16:19], s43 offen offset:1024 sc1
    s_waitcnt vmcnt(10)
    v_smfmac_f32_16x16x64_bf16 v[140:143], a[52:55], v[244:251], v18 abid:1
    v_smfmac_f32_16x16x64_bf16 v[176:179], a[52:55], v[204:211], v18 abid:1
    buffer_load_dwordx4 a[88:91], v11, s[16:19], s43 offen offset:2048 sc1
    s_waitcnt vmcnt(10)
    v_smfmac_f32_16x16x64_bf16 v[144:147], a[56:59], v[244:251], v19
    v_smfmac_f32_16x16x64_bf16 v[180:183], a[56:59], v[204:211], v19
    buffer_load_dword v0, off, s[68:71], 0 offset:192 sc1
    buffer_load_dwordx4 a[92:95], v11, s[16:19], s43 offen offset:3072 sc1
    s_waitcnt vmcnt(11)
    v_smfmac_f32_16x16x64_bf16 v[148:151], a[60:63], v[244:251], v19 abid:1
    v_smfmac_f32_16x16x64_bf16 v[184:187], a[60:63], v[204:211], v19 abid:1
    buffer_load_dwordx2 v[24:25], v54, s[16:19], s53 offen offset:3072 sc1
    s_add_u32 s43, s43, 4096
    buffer_load_dwordx4 a[96:99], v11, s[16:19], s43 offen offset:0 sc1
    s_waitcnt vmcnt(11)
    v_smfmac_f32_16x16x64_bf16 v[152:155], a[64:67], v[244:251], v20
    v_smfmac_f32_16x16x64_bf16 v[188:191], a[64:67], v[204:211], v20
    buffer_load_dwordx4 a[100:103], v11, s[16:19], s43 offen offset:1024 sc1
    s_waitcnt vmcnt(11)
    v_smfmac_f32_16x16x64_bf16 v[156:159], a[68:71], v[244:251], v20 abid:1
    v_smfmac_f32_16x16x64_bf16 v[192:195], a[68:71], v[204:211], v20 abid:1
    buffer_load_dwordx4 a[104:107], v11, s[16:19], s43 offen offset:2048 sc1
    s_waitcnt vmcnt(11)
    s_waitcnt lgkmcnt(2)
    v_smfmac_f32_16x16x64_bf16 v[124:127], a[72:75], v[196:203], v21
    s_waitcnt lgkmcnt(0)
    v_smfmac_f32_16x16x64_bf16 v[160:163], a[72:75], v[212:219], v21
    buffer_load_dwordx4 a[108:111], v11, s[16:19], s43 offen offset:3072 sc1
    ds_read_b128 v[244:247], v1 offset:3072
    ds_read_b128 v[248:251], v2 offset:3072
    s_waitcnt vmcnt(11)
    v_smfmac_f32_16x16x64_bf16 v[128:131], a[76:79], v[196:203], v21 abid:1
    v_smfmac_f32_16x16x64_bf16 v[164:167], a[76:79], v[212:219], v21 abid:1
    buffer_load_dwordx2 v[26:27], v54, s[16:19], s53 offen offset:3584 sc1
    s_add_u32 s43, s43, 4096
    buffer_load_dwordx4 a[112:115], v11, s[16:19], s43 offen offset:0 sc1
    ds_read_b128 v[204:207], v1 offset:21504
    ds_read_b128 v[208:211], v2 offset:21504
    s_waitcnt vmcnt(11)
    v_smfmac_f32_16x16x64_bf16 v[132:135], a[80:83], v[196:203], v22
    v_smfmac_f32_16x16x64_bf16 v[168:171], a[80:83], v[212:219], v22
    buffer_load_dwordx4 a[116:119], v11, s[16:19], s43 offen offset:1024 sc1
    s_waitcnt vmcnt(11)
    v_smfmac_f32_16x16x64_bf16 v[136:139], a[84:87], v[196:203], v22 abid:1
    v_smfmac_f32_16x16x64_bf16 v[172:175], a[84:87], v[212:219], v22 abid:1
    buffer_load_dwordx4 a[120:123], v11, s[16:19], s43 offen offset:2048 sc1
    s_waitcnt vmcnt(11)
    v_smfmac_f32_16x16x64_bf16 v[140:143], a[88:91], v[196:203], v23
    v_smfmac_f32_16x16x64_bf16 v[176:179], a[88:91], v[212:219], v23
    buffer_load_dwordx4 a[124:127], v11, s[16:19], s43 offen offset:3072 sc1
    s_waitcnt vmcnt(10)
    v_smfmac_f32_16x16x64_bf16 v[144:147], a[92:95], v[196:203], v23 abid:1
    v_smfmac_f32_16x16x64_bf16 v[180:183], a[92:95], v[212:219], v23 abid:1
    v_readfirstlane_b32 s30, v0
    s_mov_b32 s31, 131072
    s_cmp_ge_u32 s30, 1
    s_cbranch_scc0 M_pc_spin
M_pc_ok:
    s_mov_b32 m0, s29
    s_nop 0
    buffer_load_dwordx4 v11, s[16:19], s67 offen offset:0 sc1 lds
    buffer_load_dwordx4 v11, s[16:19], s67 offen offset:1024 sc1 lds
    buffer_load_dwordx4 v11, s[16:19], s67 offen offset:2048 sc1 lds
    buffer_load_dwordx4 v11, s[16:19], s67 offen offset:3072 sc1 lds
    s_add_u32 s67, s67, 4096
    s_add_u32 m0, m0, 4096
    s_nop 0
    buffer_load_dwordx4 v11, s[16:19], s67 offen offset:0 sc1 lds
    buffer_load_dwordx4 v11, s[16:19], s67 offen offset:1024 sc1 lds
    buffer_load_dwordx4 v11, s[16:19], s67 offen offset:2048 sc1 lds
    buffer_load_dwordx4 v11, s[16:19], s67 offen offset:3072 sc1 lds
    s_add_u32 s67, s67, 4096
    s_add_u32 m0, m0, 4096
    s_nop 0
    buffer_load_dwordx4 v11, s[16:19], s67 offen offset:0 sc1 lds
    s_mov_b32 exec_hi, 0x7f
    buffer_load_dwordx4 v11, s[16:19], s67 offen offset:1024 sc1 lds
    s_mov_b32 exec_hi, -1
    s_add_u32 s53, s53, 4096
    buffer_load_dwordx2 v[28:29], v54, s[16:19], s53 offen offset:0 sc1
    s_add_u32 s43, s43, 4096
    buffer_load_dwordx4 a[128:131], v11, s[16:19], s43 offen offset:0 sc1
    s_waitcnt vmcnt(20)
    v_smfmac_f32_16x16x64_bf16 v[148:151], a[96:99], v[196:203], v24
    v_smfmac_f32_16x16x64_bf16 v[184:187], a[96:99], v[212:219], v24
    buffer_load_dwordx4 a[132:135], v11, s[16:19], s43 offen offset:1024 sc1
    s_waitcnt vmcnt(20)
    v_smfmac_f32_16x16x64_bf16 v[152:155], a[100:103], v[196:203], v24 abid:1
    v_smfmac_f32_16x16x64_bf16 v[188:191], a[100:103], v[212:219], v24 abid:1
    buffer_load_dwordx4 a[136:139], v11, s[16:19], s43 offen offset:2048 sc1
    s_waitcnt vmcnt(20)
    v_smfmac_f32_16x16x64_bf16 v[156:159], a[104:107], v[196:203], v25
    v_smfmac_f32_16x16x64_bf16 v[192:195], a[104:107], v[212:219], v25
    buffer_load_dwordx4 a[140:143], v11, s[16:19], s43 offen offset:3072 sc1
    s_waitcnt vmcnt(20)
    s_waitcnt lgkmcnt(2)
    v_smfmac_f32_16x16x64_bf16 v[124:127], a[108:111], v[244:251], v25 abid:1
    s_waitcnt lgkmcnt(0)
    v_smfmac_f32_16x16x64_bf16 v[160:163], a[108:111], v[204:211], v25 abid:1
    buffer_load_dwordx2 v[30:31], v54, s[16:19], s53 offen offset:512 sc1
    s_add_u32 s43, s43, 4096
    buffer_load_dwordx4 a[144:147], v11, s[16:19], s43 offen offset:0 sc1
    ds_read_b128 v[196:199], v1 offset:4096
    ds_read_b128 v[200:203], v2 offset:4096
    s_waitcnt vmcnt(20)
    v_smfmac_f32_16x16x64_bf16 v[128:131], a[112:115], v[244:251], v26
    v_smfmac_f32_16x16x64_bf16 v[164:167], a[112:115], v[204:211], v26
    buffer_load_dwordx4 a[148:151], v11, s[16:19], s43 offen offset:1024 sc1
    ds_read_b128 v[212:215], v1 offset:22528
    ds_read_b128 v[216:219], v2 offset:22528
    s_waitcnt vmcnt(20)
    v_smfmac_f32_16x16x64_bf16 v[132:135], a[116:119], v[244:251], v26 abid:1
    v_smfmac_f32_16x16x64_bf16 v[168:171], a[116:119], v[204:211], v26 abid:1
    buffer_load_dwordx4 a[152:155], v11, s[16:19], s43 offen offset:2048 sc1
    s_waitcnt vmcnt(20)
    v_smfmac_f32_16x16x64_bf16 v[136:139], a[120:123], v[244:251], v27
    v_smfmac_f32_16x16x64_bf16 v[172:175], a[120:123], v[204:211], v27
    buffer_load_dwordx4 a[156:159], v11, s[16:19], s43 offen offset:3072 sc1
    s_waitcnt vmcnt(20)
    v_smfmac_f32_16x16x64_bf16 v[140:143], a[124:127], v[244:251], v27 abid:1
    v_smfmac_f32_16x16x64_bf16 v[176:179], a[124:127], v[204:211], v27 abid:1
    buffer_load_dwordx2 v[32:33], v54, s[16:19], s53 offen offset:1024 sc1
    s_add_u32 s43, s43, 4096
    buffer_load_dwordx4 a[160:163], v11, s[16:19], s43 offen offset:0 sc1
    s_waitcnt vmcnt(10)
    v_smfmac_f32_16x16x64_bf16 v[144:147], a[128:131], v[244:251], v28
    v_smfmac_f32_16x16x64_bf16 v[180:183], a[128:131], v[204:211], v28
    v_mov_b32 v0, s29
    ds_read_b128 v[236:239], v0 offset:9792
    ds_read_b128 v[240:243], v0 offset:9808
    ds_read_b32 v228, v0 offset:9824
    ds_read_b128 v[220:223], v9 offset:9728
    buffer_load_dwordx4 a[164:167], v11, s[16:19], s43 offen offset:1024 sc1
    s_waitcnt vmcnt(10)
    v_smfmac_f32_16x16x64_bf16 v[148:151], a[132:135], v[244:251], v28 abid:1
    v_smfmac_f32_16x16x64_bf16 v[184:187], a[132:135], v[204:211], v28 abid:1
    s_waitcnt lgkmcnt(3)
    v_or3_b32 v0, v236, v237, v238
    s_waitcnt lgkmcnt(2)
    v_or3_b32 v0, v0, v239, v240
    v_or3_b32 v0, v0, v241, v242
    s_waitcnt lgkmcnt(1)
    v_or3_b32 v0, v0, v243, v228
    s_nop 0
    v_readfirstlane_b32 s27, v0
    s_nop 0
    s_cmp_lg_u32 s27, 0
    s_cbranch_scc1 M_pool
M_poolr:
    buffer_load_dwordx4 a[168:171], v11, s[16:19], s43 offen offset:2048 sc1
    s_waitcnt vmcnt(10)
    v_smfmac_f32_16x16x64_bf16 v[152:155], a[136:139], v[244:251], v29
    v_smfmac_f32_16x16x64_bf16 v[188:191], a[136:139], v[204:211], v29
    s_waitcnt lgkmcnt(0)
    v_xad_u32 v220, v220, v3, v4
    v_xad_u32 v221, v221, v3, v4
    ds_read2st64_b32 v[236:237], v220 offset0:0 offset1:72
    ds_read2st64_b32 v[238:239], v221 offset0:0 offset1:72
    ds_read_b128 v[228:231], v8 offset:8192
    buffer_load_dwordx4 a[172:175], v11, s[16:19], s43 offen offset:3072 sc1
    s_waitcnt vmcnt(10)
    v_smfmac_f32_16x16x64_bf16 v[156:159], a[140:143], v[244:251], v29 abid:1
    v_smfmac_f32_16x16x64_bf16 v[192:195], a[140:143], v[204:211], v29 abid:1
    v_xad_u32 v222, v222, v3, v4
    v_xad_u32 v223, v223, v3, v4
    ds_read2st64_b32 v[240:241], v222 offset0:0 offset1:72
    ds_read2st64_b32 v[242:243], v223 offset0:0 offset1:72
    ds_read_b128 v[220:223], v9 offset:9216
    buffer_load_dwordx2 v[34:35], v54, s[16:19], s53 offen offset:1536 sc1
    s_add_u32 s43, s43, 4096
    buffer_load_dwordx4 a[176:179], v11, s[16:19], s43 offen offset:0 sc1
    s_waitcnt vmcnt(10)
    v_smfmac_f32_16x16x64_bf16 v[124:127], a[144:147], v[196:203], v30
    v_smfmac_f32_16x16x64_bf16 v[160:163], a[144:147], v[212:219], v30
    buffer_load_dwordx4 a[180:183], v11, s[16:19], s43 offen offset:1024 sc1
    ds_read_b128 v[244:247], v1 offset:5120
    ds_read_b128 v[248:251], v2 offset:5120
    s_waitcnt vmcnt(10)
    v_smfmac_f32_16x16x64_bf16 v[128:131], a[148:151], v[196:203], v30 abid:1
    v_smfmac_f32_16x16x64_bf16 v[164:167], a[148:151], v[212:219], v30 abid:1
    buffer_load_dwordx4 a[184:187], v11, s[16:19], s43 offen offset:2048 sc1
    ds_read_b128 v[204:207], v1 offset:23552
    ds_read_b128 v[208:211], v2 offset:23552
    s_waitcnt vmcnt(10)
    v_smfmac_f32_16x16x64_bf16 v[132:135], a[152:155], v[196:203], v31
    v_smfmac_f32_16x16x64_bf16 v[168:171], a[152:155], v[212:219], v31
    s_waitcnt lgkmcnt(5)
    v_smfmac_f32_16x16x64_bf16 v[156:159], v[228:231], v[236:243], v10
    v_smfmac_f32_16x16x64_bf16 v[192:195], v[228:231], v[236:243], v10 abid:1
    buffer_load_dwordx4 a[188:191], v11, s[16:19], s43 offen offset:3072 sc1
    s_waitcnt vmcnt(10)
    v_smfmac_f32_16x16x64_bf16 v[136:139], a[156:159], v[196:203], v31 abid:1
    v_smfmac_f32_16x16x64_bf16 v[172:175], a[156:159], v[212:219], v31 abid:1
    s_waitcnt lgkmcnt(4)
    v_xad_u32 v220, v220, v3, v4
    v_xad_u32 v221, v221, v3, v4
    ds_read2st64_b32 v[236:237], v220 offset0:0 offset1:72
    ds_read2st64_b32 v[238:239], v221 offset0:0 offset1:72
    ds_read_b128 v[228:231], v8 offset:0
    buffer_load_dwordx2 v[36:37], v54, s[16:19], s53 offen offset:2048 sc1
    s_add_u32 s43, s43, 4096
    buffer_load_dwordx4 a[192:195], v11, s[16:19], s43 offen offset:0 sc1
    s_waitcnt vmcnt(10)
    v_smfmac_f32_16x16x64_bf16 v[140:143], a[160:163], v[196:203], v32
    v_smfmac_f32_16x16x64_bf16 v[176:179], a[160:163], v[212:219], v32
    v_xad_u32 v222, v222, v3, v4
    v_xad_u32 v223, v223, v3, v4
    ds_read2st64_b32 v[240:241], v222 offset0:0 offset1:72
    ds_read2st64_b32 v[242:243], v223 offset0:0 offset1:72
    ds_read_b128 v[220:223], v9 offset:9280
    buffer_load_dwordx4 a[196:199], v11, s[16:19], s43 offen offset:1024 sc1
    s_waitcnt vmcnt(10)
    v_smfmac_f32_16x16x64_bf16 v[144:147], a[164:167], v[196:203], v32 abid:1
    v_smfmac_f32_16x16x64_bf16 v[180:183], a[164:167], v[212:219], v32 abid:1
    buffer_load_dwordx4 a[200:203], v11, s[16:19], s43 offen offset:2048 sc1
    s_waitcnt vmcnt(10)
    v_smfmac_f32_16x16x64_bf16 v[148:151], a[168:171], v[196:203], v33
    v_smfmac_f32_16x16x64_bf16 v[184:187], a[168:171], v[212:219], v33
    buffer_load_dwordx4 a[204:207], v11, s[16:19], s43 offen offset:3072 sc1
    s_waitcnt vmcnt(10)
    v_smfmac_f32_16x16x64_bf16 v[152:155], a[172:175], v[196:203], v33 abid:1
    v_smfmac_f32_16x16x64_bf16 v[188:191], a[172:175], v[212:219], v33 abid:1
    s_waitcnt lgkmcnt(1)
    v_smfmac_f32_16x16x64_bf16 v[124:127], v[228:231], v[236:243], v10
    v_smfmac_f32_16x16x64_bf16 v[160:163], v[228:231], v[236:243], v10 abid:1
    buffer_load_dwordx2 v[38:39], v54, s[16:19], s53 offen offset:2560 sc1
    s_add_u32 s43, s43, 4096
    buffer_load_dwordx4 a[208:211], v11, s[16:19], s43 offen offset:0 sc1
    s_waitcnt vmcnt(10)
    v_smfmac_f32_16x16x64_bf16 v[156:159], a[176:179], v[196:203], v34
    v_smfmac_f32_16x16x64_bf16 v[192:195], a[176:179], v[212:219], v34
    s_waitcnt lgkmcnt(0)
    v_xad_u32 v220, v220, v3, v4
    v_xad_u32 v221, v221, v3, v4
    ds_read2st64_b32 v[236:237], v220 offset0:0 offset1:72
    ds_read2st64_b32 v[238:239], v221 offset0:0 offset1:72
    ds_read_b128 v[228:231], v8 offset:1024
    buffer_load_dwordx4 a[212:215], v11, s[16:19], s43 offen offset:1024 sc1
    s_waitcnt vmcnt(10)
    v_smfmac_f32_16x16x64_bf16 v[124:127], a[180:183], v[244:251], v34 abid:1
    v_smfmac_f32_16x16x64_bf16 v[160:163], a[180:183], v[204:211], v34 abid:1
    v_xad_u32 v222, v222, v3, v4
    v_xad_u32 v223, v223, v3, v4
    ds_read2st64_b32 v[240:241], v222 offset0:0 offset1:72
    ds_read2st64_b32 v[242:243], v223 offset0:0 offset1:72
    ds_read_b128 v[220:223], v9 offset:9344
    buffer_load_dwordx4 a[216:219], v11, s[16:19], s43 offen offset:2048 sc1
    ds_read_b128 v[196:199], v1 offset:6144
    ds_read_b128 v[200:203], v2 offset:6144
    s_waitcnt vmcnt(10)
    v_smfmac_f32_16x16x64_bf16 v[128:131], a[184:187], v[244:251], v35
    v_smfmac_f32_16x16x64_bf16 v[164:167], a[184:187], v[204:211], v35
    buffer_load_dwordx4 a[220:223], v11, s[16:19], s43 offen offset:3072 sc1
    ds_read_b128 v[212:215], v1 offset:24576
    ds_read_b128 v[216:219], v2 offset:24576
    s_waitcnt vmcnt(10)
    v_smfmac_f32_16x16x64_bf16 v[132:135], a[188:191], v[244:251], v35 abid:1
    v_smfmac_f32_16x16x64_bf16 v[168:171], a[188:191], v[204:211], v35 abid:1
    buffer_load_dwordx2 v[40:41], v54, s[16:19], s53 offen offset:3072 sc1
    s_add_u32 s43, s43, 4096
    buffer_load_dwordx4 a[224:227], v11, s[16:19], s43 offen offset:0 sc1
    s_waitcnt vmcnt(10)
    v_smfmac_f32_16x16x64_bf16 v[136:139], a[192:195], v[244:251], v36
    v_smfmac_f32_16x16x64_bf16 v[172:175], a[192:195], v[204:211], v36
    s_waitcnt lgkmcnt(5)
    v_smfmac_f32_16x16x64_bf16 v[128:131], v[228:231], v[236:243], v10
    v_smfmac_f32_16x16x64_bf16 v[164:167], v[228:231], v[236:243], v10 abid:1
    buffer_load_dwordx4 a[228:231], v11, s[16:19], s43 offen offset:1024 sc1
    s_waitcnt vmcnt(10)
    v_smfmac_f32_16x16x64_bf16 v[140:143], a[196:199], v[244:251], v36 abid:1
    v_smfmac_f32_16x16x64_bf16 v[176:179], a[196:199], v[204:211], v36 abid:1
    s_waitcnt lgkmcnt(4)
    v_xad_u32 v220, v220, v3, v4
    v_xad_u32 v221, v221, v3, v4
    ds_read2st64_b32 v[236:237], v220 offset0:0 offset1:72
    ds_read2st64_b32 v[238:239], v221 offset0:0 offset1:72
    ds_read_b128 v[228:231], v8 offset:2048
    buffer_load_dwordx4 a[232:235], v11, s[16:19], s43 offen offset:2048 sc1
    s_waitcnt vmcnt(10)
    v_smfmac_f32_16x16x64_bf16 v[144:147], a[200:203], v[244:251], v37
    v_smfmac_f32_16x16x64_bf16 v[180:183], a[200:203], v[204:211], v37
    v_xad_u32 v222, v222, v3, v4
    v_xad_u32 v223, v223, v3, v4
    ds_read2st64_b32 v[240:241], v222 offset0:0 offset1:72
    ds_read2st64_b32 v[242:243], v223 offset0:0 offset1:72
    ds_read_b128 v[220:223], v9 offset:9408
    buffer_load_dwordx4 a[236:239], v11, s[16:19], s43 offen offset:3072 sc1
    s_waitcnt vmcnt(10)
    v_smfmac_f32_16x16x64_bf16 v[148:151], a[204:207], v[244:251], v37 abid:1
    v_smfmac_f32_16x16x64_bf16 v[184:187], a[204:207], v[204:211], v37 abid:1
    buffer_load_dwordx2 v[42:43], v54, s[16:19], s53 offen offset:3584 sc1
    s_add_u32 s43, s43, 4096
    buffer_load_dwordx4 a[240:243], v11, s[16:19], s43 offen offset:0 sc1
    s_waitcnt vmcnt(10)
    v_smfmac_f32_16x16x64_bf16 v[152:155], a[208:211], v[244:251], v38
    v_smfmac_f32_16x16x64_bf16 v[188:191], a[208:211], v[204:211], v38
    buffer_load_dwordx4 a[244:247], v11, s[16:19], s43 offen offset:1024 sc1
    s_waitcnt vmcnt(10)
    v_smfmac_f32_16x16x64_bf16 v[156:159], a[212:215], v[244:251], v38 abid:1
    v_smfmac_f32_16x16x64_bf16 v[192:195], a[212:215], v[204:211], v38 abid:1
    s_waitcnt lgkmcnt(1)
    v_smfmac_f32_16x16x64_bf16 v[132:135], v[228:231], v[236:243], v10
    v_smfmac_f32_16x16x64_bf16 v[168:171], v[228:231], v[236:243], v10 abid:1
    buffer_load_dwordx4 a[248:251], v11, s[16:19], s43 offen offset:2048 sc1
    s_waitcnt vmcnt(10)
    v_smfmac_f32_16x16x64_bf16 v[124:127], a[216:219], v[196:203], v39
    v_smfmac_f32_16x16x64_bf16 v[160:163], a[216:219], v[212:219], v39
    s_waitcnt lgkmcnt(0)
    v_xad_u32 v220, v220, v3, v4
    v_xad_u32 v221, v221, v3, v4
    ds_read2st64_b32 v[236:237], v220 offset0:0 offset1:72
    ds_read2st64_b32 v[238:239], v221 offset0:0 offset1:72
    ds_read_b128 v[228:231], v8 offset:3072
    buffer_load_dwordx4 a[252:255], v11, s[16:19], s43 offen offset:3072 sc1
    ds_read_b128 v[244:247], v1 offset:7168
    ds_read_b128 v[248:251], v2 offset:7168
    s_waitcnt vmcnt(10)
    v_smfmac_f32_16x16x64_bf16 v[128:131], a[220:223], v[196:203], v39 abid:1
    v_smfmac_f32_16x16x64_bf16 v[164:167], a[220:223], v[212:219], v39 abid:1
    v_xad_u32 v222, v222, v3, v4
    v_xad_u32 v223, v223, v3, v4
    ds_read2st64_b32 v[240:241], v222 offset0:0 offset1:72
    ds_read2st64_b32 v[242:243], v223 offset0:0 offset1:72
    ds_read_b128 v[220:223], v9 offset:9472
    s_add_u32 s53, s53, 4096
    buffer_load_dwordx2 v[44:45], v54, s[16:19], s53 offen offset:0 sc1
    s_add_u32 s43, s43, 4096
    buffer_load_dwordx4 v[56:59], v11, s[16:19], s43 offen offset:0 sc1
    ds_read_b128 v[204:207], v1 offset:25600
    ds_read_b128 v[208:211], v2 offset:25600
    s_waitcnt vmcnt(10)
    v_smfmac_f32_16x16x64_bf16 v[132:135], a[224:227], v[196:203], v40
    v_smfmac_f32_16x16x64_bf16 v[168:171], a[224:227], v[212:219], v40
    buffer_load_dwordx4 v[60:63], v11, s[16:19], s43 offen offset:1024 sc1
    s_waitcnt vmcnt(10)
    v_smfmac_f32_16x16x64_bf16 v[136:139], a[228:231], v[196:203], v40 abid:1
    v_smfmac_f32_16x16x64_bf16 v[172:175], a[228:231], v[212:219], v40 abid:1
    buffer_load_dwordx4 v[64:67], v11, s[16:19], s43 offen offset:2048 sc1
    s_waitcnt vmcnt(10)
    v_smfmac_f32_16x16x64_bf16 v[140:143], a[232:235], v[196:203], v41
    v_smfmac_f32_16x16x64_bf16 v[176:179], a[232:235], v[212:219], v41
    s_waitcnt lgkmcnt(3)
    v_smfmac_f32_16x16x64_bf16 v[136:139], v[228:231], v[236:243], v10
    v_smfmac_f32_16x16x64_bf16 v[172:175], v[228:231], v[236:243], v10 abid:1
    buffer_load_dwordx4 v[68:71], v11, s[16:19], s43 offen offset:3072 sc1
    s_waitcnt vmcnt(10)
    v_smfmac_f32_16x16x64_bf16 v[144:147], a[236:239], v[196:203], v41 abid:1
    v_smfmac_f32_16x16x64_bf16 v[180:183], a[236:239], v[212:219], v41 abid:1
    s_waitcnt lgkmcnt(2)
    v_xad_u32 v220, v220, v3, v4
    v_xad_u32 v221, v221, v3, v4
    ds_read2st64_b32 v[236:237], v220 offset0:0 offset1:72
    ds_read2st64_b32 v[238:239], v221 offset0:0 offset1:72
    ds_read_b128 v[228:231], v8 offset:4096
    buffer_load_dwordx2 v[46:47], v54, s[16:19], s53 offen offset:512 sc1
    s_add_u32 s43, s43, 4096
    buffer_load_dwordx4 v[72:75], v11, s[16:19], s43 offen offset:0 sc1
    s_waitcnt vmcnt(10)
    v_smfmac_f32_16x16x64_bf16 v[148:151], a[240:243], v[196:203], v42
    v_smfmac_f32_16x16x64_bf16 v[184:187], a[240:243], v[212:219], v42
    v_xad_u32 v222, v222, v3, v4
    v_xad_u32 v223, v223, v3, v4
    ds_read2st64_b32 v[240:241], v222 offset0:0 offset1:72
    ds_read2st64_b32 v[242:243], v223 offset0:0 offset1:72
    ds_read_b128 v[220:223], v9 offset:9536
    buffer_load_dwordx4 v[76:79], v11, s[16:19], s43 offen offset:1024 sc1
    s_waitcnt vmcnt(10)
    v_smfmac_f32_16x16x64_bf16 v[152:155], a[244:247], v[196:203], v42 abid:1
    v_smfmac_f32_16x16x64_bf16 v[188:191], a[244:247], v[212:219], v42 abid:1
    buffer_load_dwordx4 v[80:83], v11, s[16:19], s43 offen offset:2048 sc1
    s_waitcnt vmcnt(10)
    v_smfmac_f32_16x16x64_bf16 v[156:159], a[248:251], v[196:203], v43
    v_smfmac_f32_16x16x64_bf16 v[192:195], a[248:251], v[212:219], v43
    buffer_load_dwordx4 v[84:87], v11, s[16:19], s43 offen offset:3072 sc1
    s_waitcnt vmcnt(10)
    v_smfmac_f32_16x16x64_bf16 v[124:127], a[252:255], v[244:251], v43 abid:1
    s_waitcnt lgkmcnt(1)
    v_smfmac_f32_16x16x64_bf16 v[140:143], v[228:231], v[236:243], v10
    v_smfmac_f32_16x16x64_bf16 v[176:179], v[228:231], v[236:243], v10 abid:1
    buffer_load_dwordx2 v[48:49], v54, s[16:19], s53 offen offset:1024 sc1
    s_add_u32 s43, s43, 4096
    buffer_load_dwordx4 v[88:91], v11, s[16:19], s43 offen offset:0 sc1
    ds_read_b128 v[196:199], v1 offset:8192
    ds_read_b128 v[200:203], v2 offset:8192
    s_waitcnt vmcnt(10)
    v_smfmac_f32_16x16x64_bf16 v[128:131], v[56:59], v[244:251], v44
    s_waitcnt lgkmcnt(2)
    v_xad_u32 v220, v220, v3, v4
    v_xad_u32 v221, v221, v3, v4
    ds_read2st64_b32 v[236:237], v220 offset0:0 offset1:72
    ds_read2st64_b32 v[238:239], v221 offset0:0 offset1:72
    ds_read_b128 v[228:231], v8 offset:5120
    buffer_load_dwordx4 v[92:95], v11, s[16:19], s43 offen offset:1024 sc1
    ds_read_b128 v[212:215], v1 offset:26624
    ds_read_b128 v[216:219], v2 offset:26624
    s_waitcnt vmcnt(10)
    v_smfmac_f32_16x16x64_bf16 v[132:135], v[60:63], v[244:251], v44 abid:1
    v_xad_u32 v222, v222, v3, v4
    v_xad_u32 v223, v223, v3, v4
    ds_read2st64_b32 v[240:241], v222 offset0:0 offset1:72
    ds_read2st64_b32 v[242:243], v223 offset0:0 offset1:72
    ds_read_b128 v[220:223], v9 offset:9600
    buffer_load_dwordx4 v[96:99], v11, s[16:19], s43 offen offset:2048 sc1
    s_waitcnt vmcnt(10)
    v_smfmac_f32_16x16x64_bf16 v[136:139], v[64:67], v[244:251], v45
    buffer_load_dwordx4 v[100:103], v11, s[16:19], s43 offen offset:3072 sc1
    s_waitcnt vmcnt(10)
    v_smfmac_f32_16x16x64_bf16 v[140:143], v[68:71], v[244:251], v45 abid:1
    buffer_load_dwordx2 v[50:51], v54, s[16:19], s53 offen offset:1536 sc1
    s_add_u32 s43, s43, 4096
    buffer_load_dwordx4 v[104:107], v11, s[16:19], s43 offen offset:0 sc1
    s_waitcnt vmcnt(10)
    v_smfmac_f32_16x16x64_bf16 v[144:147], v[72:75], v[244:251], v46
    s_waitcnt lgkmcnt(1)
    v_smfmac_f32_16x16x64_bf16 v[144:147], v[228:231], v[236:243], v10
    v_smfmac_f32_16x16x64_bf16 v[180:183], v[228:231], v[236:243], v10 abid:1
    buffer_load_dwordx4 v[108:111], v11, s[16:19], s43 offen offset:1024 sc1
    s_waitcnt vmcnt(10)
    v_smfmac_f32_16x16x64_bf16 v[148:151], v[76:79], v[244:251], v46 abid:1
    s_waitcnt lgkmcnt(0)
    v_xad_u32 v220, v220, v3, v4
    v_xad_u32 v221, v221, v3, v4
    ds_read2st64_b32 v[236:237], v220 offset0:0 offset1:72
    ds_read2st64_b32 v[238:239], v221 offset0:0 offset1:72
    ds_read_b128 v[228:231], v8 offset:6144
    buffer_load_dwordx4 v[112:115], v11, s[16:19], s43 offen offset:2048 sc1
    s_waitcnt vmcnt(10)
    v_smfmac_f32_16x16x64_bf16 v[152:155], v[80:83], v[244:251], v47
    v_xad_u32 v222, v222, v3, v4
    v_xad_u32 v223, v223, v3, v4
    ds_read2st64_b32 v[240:241], v222 offset0:0 offset1:72
    ds_read2st64_b32 v[242:243], v223 offset0:0 offset1:72
    ds_read_b128 v[220:223], v9 offset:9664
    buffer_load_dwordx4 v[116:119], v11, s[16:19], s43 offen offset:3072 sc1
    s_waitcnt vmcnt(10)
    v_smfmac_f32_16x16x64_bf16 v[156:159], v[84:87], v[244:251], v47 abid:1
    buffer_load_dwordx2 v[52:53], v54, s[16:19], s53 offen offset:2048 sc1
    s_add_u32 s43, s43, 4096
    buffer_load_dwordx4 v[120:123], v11, s[16:19], s43 offen offset:0 sc1
    s_waitcnt vmcnt(10)
    v_smfmac_f32_16x16x64_bf16 v[124:127], v[88:91], v[196:203], v48
    s_waitcnt vmcnt(9)
    v_smfmac_f32_16x16x64_bf16 v[128:131], v[92:95], v[196:203], v48 abid:1
    s_waitcnt lgkmcnt(1)
    v_smfmac_f32_16x16x64_bf16 v[148:151], v[228:231], v[236:243], v10
    v_smfmac_f32_16x16x64_bf16 v[184:187], v[228:231], v[236:243], v10 abid:1
    s_waitcnt vmcnt(8)
    v_smfmac_f32_16x16x64_bf16 v[132:135], v[96:99], v[196:203], v49
    s_waitcnt lgkmcnt(0)
    v_xad_u32 v220, v220, v3, v4
    v_xad_u32 v221, v221, v3, v4
    ds_read2st64_b32 v[236:237], v220 offset0:0 offset1:72
    ds_read2st64_b32 v[238:239], v221 offset0:0 offset1:72
    ds_read_b128 v[228:231], v8 offset:7168
    s_waitcnt vmcnt(7)
    v_smfmac_f32_16x16x64_bf16 v[136:139], v[100:103], v[196:203], v49 abid:1
    v_xad_u32 v222, v222, v3, v4
    v_xad_u32 v223, v223, v3, v4
    ds_read2st64_b32 v[240:241], v222 offset0:0 offset1:72
    ds_read2st64_b32 v[242:243], v223 offset0:0 offset1:72
    s_waitcnt vmcnt(5)
    v_smfmac_f32_16x16x64_bf16 v[140:143], v[104:107], v[196:203], v50
    s_waitcnt vmcnt(4)
    v_smfmac_f32_16x16x64_bf16 v[144:147], v[108:111], v[196:203], v50 abid:1
    s_waitcnt vmcnt(3)
    v_smfmac_f32_16x16x64_bf16 v[148:151], v[112:115], v[196:203], v51
    s_waitcnt lgkmcnt(0)
    v_smfmac_f32_16x16x64_bf16 v[152:155], v[228:231], v[236:243], v10
    v_smfmac_f32_16x16x64_bf16 v[188:191], v[228:231], v[236:243], v10 abid:1
    s_waitcnt vmcnt(2)
    v_smfmac_f32_16x16x64_bf16 v[152:155], v[116:119], v[196:203], v51 abid:1
    s_waitcnt vmcnt(0)
    v_smfmac_f32_16x16x64_bf16 v[156:159], v[120:123], v[196:203], v52
    s_cmp_lt_u32 s21, 3
    s_cbranch_scc1 M_xlate
M_xlater:
    s_mov_b32 s21, 0
    s_cmp_lg_u32 s27, 0
    s_cbranch_scc1 M_slow
M_slowr0:
    v_cvt_pk_bf16_f32 v124, v124, v125
    v_cvt_pk_bf16_f32 v125, v126, v127
    v_cvt_pk_bf16_f32 v126, v128, v129
    v_cvt_pk_bf16_f32 v127, v130, v131
    v_cvt_pk_bf16_f32 v132, v132, v133
    v_cvt_pk_bf16_f32 v133, v134, v135
    v_cvt_pk_bf16_f32 v134, v136, v137
    v_cvt_pk_bf16_f32 v135, v138, v139
    ds_read_b128 v[136:139], v9 offset:10032
    v_cndmask_b32_dpp v128, v124, v132, vcc row_ror:8 row_mask:0xf bank_mask:0xf
    v_cndmask_b32_dpp v129, v125, v133, vcc row_ror:8 row_mask:0xf bank_mask:0xf
    v_cndmask_b32_dpp v130, v126, v134, vcc row_ror:8 row_mask:0xf bank_mask:0xf
    v_cndmask_b32_dpp v131, v127, v135, vcc row_ror:8 row_mask:0xf bank_mask:0xf
    buffer_store_dwordx4 v[128:131], v6, s[12:15], s59 offen offset:0
    v_mov_b32_dpp v124, v132 row_ror:8 row_mask:0xf bank_mask:0xc
    v_mov_b32_dpp v125, v133 row_ror:8 row_mask:0xf bank_mask:0xc
    v_mov_b32_dpp v126, v134 row_ror:8 row_mask:0xf bank_mask:0xc
    v_mov_b32_dpp v127, v135 row_ror:8 row_mask:0xf bank_mask:0xc
    buffer_store_dwordx4 v[124:127], v6, s[12:15], s24 offen offset:0
    ds_read_b128 v[128:131], v9 offset:9904
    ds_read_b128 v[132:135], v9 offset:9968
    ds_read_b128 v[124:127], v9 offset:9840
    v_cvt_pk_bf16_f32 v140, v140, v141
    v_cvt_pk_bf16_f32 v141, v142, v143
    v_cvt_pk_bf16_f32 v142, v144, v145
    v_cvt_pk_bf16_f32 v143, v146, v147
    v_cvt_pk_bf16_f32 v148, v148, v149
    v_cvt_pk_bf16_f32 v149, v150, v151
    v_cvt_pk_bf16_f32 v150, v152, v153
    v_cvt_pk_bf16_f32 v151, v154, v155
    ds_read_b128 v[152:155], v9 offset:10288
    v_cndmask_b32_dpp v144, v140, v148, vcc row_ror:8 row_mask:0xf bank_mask:0xf
    v_cndmask_b32_dpp v145, v141, v149, vcc row_ror:8 row_mask:0xf bank_mask:0xf
    v_cndmask_b32_dpp v146, v142, v150, vcc row_ror:8 row_mask:0xf bank_mask:0xf
    v_cndmask_b32_dpp v147, v143, v151, vcc row_ror:8 row_mask:0xf bank_mask:0xf
    buffer_store_dwordx4 v[144:147], v6, s[12:15], s59 offen offset:128
    v_mov_b32_dpp v140, v148 row_ror:8 row_mask:0xf bank_mask:0xc
    v_mov_b32_dpp v141, v149 row_ror:8 row_mask:0xf bank_mask:0xc
    v_mov_b32_dpp v142, v150 row_ror:8 row_mask:0xf bank_mask:0xc
    v_mov_b32_dpp v143, v151 row_ror:8 row_mask:0xf bank_mask:0xc
    buffer_store_dwordx4 v[140:143], v6, s[12:15], s24 offen offset:128
    ds_read_b128 v[144:147], v9 offset:10160
    ds_read_b128 v[148:151], v9 offset:10224
    ds_read_b128 v[140:143], v9 offset:10096
    v_cvt_pk_bf16_f32 v156, v156, v157
    v_cvt_pk_bf16_f32 v157, v158, v159
    buffer_store_dwordx2 v[156:157], v7, s[12:15], s24 offen
    s_nop 1
    ds_read_b128 v[156:159], v9 offset:10352
    s_mov_b32 s21, 1
    s_mov_b32 s28, s26
    s_mov_b32 s25, 36864
    v_add_u32 v4, 36864, v4
    v_add_u32 v1, 36864, v1
    v_add_u32 v2, 36864, v2
    s_waitcnt vmcnt(14)
M_top:
    s_add_u32 s23, s24, 18432
    s_add_u32 s58, s24, 27648
    s_add_u32 s24, s24, 9437184
    s_add_u32 s59, s24, 9216
    s_waitcnt vmcnt(21) lgkmcnt(0)
    s_barrier
    ds_read_b128 v[196:199], v1 offset:0
    ds_read_b128 v[200:203], v2 offset:0
    v_smfmac_f32_16x16x64_bf16 v[160:163], a[252:255], v[204:211], v43 abid:1
    v_smfmac_f32_16x16x64_bf16 v[164:167], v[56:59], v[204:211], v44
    s_mov_b32 m0, s28
    v_smfmac_f32_16x16x64_bf16 v[168:171], v[60:63], v[204:211], v44 abid:1
    buffer_load_dwordx4 v5, s[8:11], s22 offen offset:0 nt lds
    v_smfmac_f32_16x16x64_bf16 v[172:175], v[64:67], v[204:211], v45
    v_smfmac_f32_16x16x64_bf16 v[176:179], v[68:71], v[204:211], v45 abid:1
    ds_read_b128 v[220:223], v9 offset:9728
    v_smfmac_f32_16x16x64_bf16 v[180:183], v[72:75], v[204:211], v46
    v_smfmac_f32_16x16x64_bf16 v[184:187], v[76:79], v[204:211], v46 abid:1
    v_smfmac_f32_16x16x64_bf16 v[188:191], v[80:83], v[204:211], v47
    v_smfmac_f32_16x16x64_bf16 v[192:195], v[84:87], v[204:211], v47 abid:1
    ds_read_b128 v[204:207], v1 offset:1024
    v_smfmac_f32_16x16x64_bf16 v[160:163], v[88:91], v[212:219], v48
    ds_read_b128 v[208:211], v2 offset:1024
    v_smfmac_f32_16x16x64_bf16 v[164:167], v[92:95], v[212:219], v48 abid:1
    v_smfmac_f32_16x16x64_bf16 v[168:171], v[96:99], v[212:219], v49
    s_add_u32 m0, m0, 896
    v_smfmac_f32_16x16x64_bf16 v[172:175], v[100:103], v[212:219], v49 abid:1
    buffer_load_dwordx4 v5, s[8:11], s22 offen offset:128 nt lds
    v_smfmac_f32_16x16x64_bf16 v[176:179], v[104:107], v[212:219], v50
    v_smfmac_f32_16x16x64_bf16 v[180:183], v[108:111], v[212:219], v50 abid:1
    v_smfmac_f32_16x16x64_bf16 v[184:187], v[112:115], v[212:219], v51
    v_smfmac_f32_16x16x64_bf16 v[188:191], v[116:119], v[212:219], v51 abid:1
    v_smfmac_f32_16x16x64_bf16 v[192:195], v[120:123], v[212:219], v52
    ds_read_b128 v[212:215], v1 offset:2048
    s_waitcnt lgkmcnt(4)
    v_smfmac_f32_16x16x64_bf16 v[124:127], a[0:3], v[196:203], v12
    ds_read_b128 v[216:219], v2 offset:2048
    s_nop 3
    v_cvt_pk_bf16_f32 v192, v192, v193
    v_smfmac_f32_16x16x64_bf16 v[128:131], a[4:7], v[196:203], v12 abid:1
    v_cvt_pk_bf16_f32 v193, v194, v195
    v_smfmac_f32_16x16x64_bf16 v[132:135], a[8:11], v[196:203], v13
    buffer_store_dwordx2 v[192:193], v7, s[12:15], s23 offen
    s_nop 1
    ds_read_b128 v[192:195], v9 offset:10352
    v_smfmac_f32_16x16x64_bf16 v[136:139], a[12:15], v[196:203], v13 abid:1
    v_cvt_pk_bf16_f32 v160, v160, v161
    v_smfmac_f32_16x16x64_bf16 v[140:143], a[16:19], v[196:203], v14
    v_cvt_pk_bf16_f32 v161, v162, v163
    v_smfmac_f32_16x16x64_bf16 v[144:147], a[20:23], v[196:203], v14 abid:1
    s_waitcnt lgkmcnt(5)
    v_xad_u32 v220, v220, v3, v4
    v_smfmac_f32_16x16x64_bf16 v[148:151], a[24:27], v[196:203], v15
    ds_read2st64_b32 v[236:237], v220 offset0:0 offset1:72
    v_xad_u32 v221, v221, v3, v4
    v_smfmac_f32_16x16x64_bf16 v[152:155], a[28:31], v[196:203], v15 abid:1
    ds_read2st64_b32 v[238:239], v221 offset0:0 offset1:72
    v_xad_u32 v222, v222, v3, v4
    v_smfmac_f32_16x16x64_bf16 v[156:159], a[32:35], v[196:203], v16
    ds_read_b128 v[196:199], v1 offset:3072
    ds_read2st64_b32 v[240:241], v222 offset0:0 offset1:72
    s_waitcnt lgkmcnt(7)
    v_xad_u32 v223, v223, v3, v4
    v_smfmac_f32_16x16x64_bf16 v[124:127], a[36:39], v[204:211], v16 abid:1
    ds_read_b128 v[200:203], v2 offset:3072
    ds_read2st64_b32 v[242:243], v223 offset0:0 offset1:72
    v_cvt_pk_bf16_f32 v162, v164, v165
    v_smfmac_f32_16x16x64_bf16 v[128:131], a[40:43], v[204:211], v17
    ds_read_b128 v[220:223], v9 offset:9216
    ds_read_b128 v[228:231], v8 offset:8192
    v_cvt_pk_bf16_f32 v163, v166, v167
    v_smfmac_f32_16x16x64_bf16 v[132:135], a[44:47], v[204:211], v17 abid:1
    s_add_u32 m0, m0, 896
    v_cvt_pk_bf16_f32 v168, v168, v169
    v_smfmac_f32_16x16x64_bf16 v[136:139], a[48:51], v[204:211], v18
    buffer_load_dwordx4 v5, s[8:11], s22 offen offset:256 nt lds
    v_cvt_pk_bf16_f32 v169, v170, v171
    v_smfmac_f32_16x16x64_bf16 v[140:143], a[52:55], v[204:211], v18 abid:1
    v_cvt_pk_bf16_f32 v170, v172, v173
    v_smfmac_f32_16x16x64_bf16 v[144:147], a[56:59], v[204:211], v19
    v_cvt_pk_bf16_f32 v171, v174, v175
    v_smfmac_f32_16x16x64_bf16 v[148:151], a[60:63], v[204:211], v19 abid:1
    ds_read_b128 v[172:175], v9 offset:10032
    v_cndmask_b32_dpp v164, v160, v168, vcc row_ror:8 row_mask:0xf bank_mask:0xf
    v_smfmac_f32_16x16x64_bf16 v[152:155], a[64:67], v[204:211], v20
    s_waitcnt lgkmcnt(1)
    v_cndmask_b32_dpp v165, v161, v169, vcc row_ror:8 row_mask:0xf bank_mask:0xf
    v_smfmac_f32_16x16x64_bf16 v[156:159], v[228:231], v[236:243], v10
    v_xad_u32 v220, v220, v3, v4
    v_smfmac_f32_16x16x64_bf16 v[156:159], a[68:71], v[204:211], v20 abid:1
    ds_read_b128 v[204:207], v1 offset:4096
    v_xad_u32 v221, v221, v3, v4
    v_smfmac_f32_16x16x64_bf16 v[192:195], v[228:231], v[236:243], v10 abid:1
    ds_read_b128 v[208:211], v2 offset:4096
    ds_read2st64_b32 v[236:237], v220 offset0:0 offset1:72
    v_xad_u32 v222, v222, v3, v4
    v_smfmac_f32_16x16x64_bf16 v[124:127], a[72:75], v[212:219], v21
    ds_read2st64_b32 v[238:239], v221 offset0:0 offset1:72
    v_xad_u32 v223, v223, v3, v4
    v_smfmac_f32_16x16x64_bf16 v[128:131], a[76:79], v[212:219], v21 abid:1
    ds_read2st64_b32 v[240:241], v222 offset0:0 offset1:72
    v_cndmask_b32_dpp v166, v162, v170, vcc row_ror:8 row_mask:0xf bank_mask:0xf
    v_smfmac_f32_16x16x64_bf16 v[132:135], a[80:83], v[212:219], v22
    ds_read2st64_b32 v[242:243], v223 offset0:0 offset1:72
    v_cndmask_b32_dpp v167, v163, v171, vcc row_ror:8 row_mask:0xf bank_mask:0xf
    v_smfmac_f32_16x16x64_bf16 v[136:139], a[84:87], v[212:219], v22 abid:1
    ds_read_b128 v[220:223], v9 offset:9280
    ds_read_b128 v[228:231], v8 offset:0
    buffer_store_dwordx4 v[164:167], v6, s[12:15], s58 offen offset:0
    v_smfmac_f32_16x16x64_bf16 v[140:143], a[88:91], v[212:219], v23
    v_mov_b32_dpp v160, v168 row_ror:8 row_mask:0xf bank_mask:0xc
    v_smfmac_f32_16x16x64_bf16 v[144:147], a[92:95], v[212:219], v23 abid:1
    v_mov_b32_dpp v161, v169 row_ror:8 row_mask:0xf bank_mask:0xc
    v_smfmac_f32_16x16x64_bf16 v[148:151], a[96:99], v[212:219], v24
    v_mov_b32_dpp v162, v170 row_ror:8 row_mask:0xf bank_mask:0xc
    v_smfmac_f32_16x16x64_bf16 v[152:155], a[100:103], v[212:219], v24 abid:1
    v_mov_b32_dpp v163, v171 row_ror:8 row_mask:0xf bank_mask:0xc
    v_smfmac_f32_16x16x64_bf16 v[156:159], a[104:107], v[212:219], v25
    ds_read_b128 v[212:215], v1 offset:5120
    buffer_store_dwordx4 v[160:163], v6, s[12:15], s23 offen offset:0
    ds_read_b128 v[164:167], v9 offset:9904
    v_smfmac_f32_16x16x64_bf16 v[124:127], a[108:111], v[196:203], v25 abid:1
    ds_read_b128 v[216:219], v2 offset:5120
    ds_read_b128 v[168:171], v9 offset:9968
    ds_read_b128 v[160:163], v9 offset:9840
    v_smfmac_f32_16x16x64_bf16 v[128:131], a[112:115], v[196:203], v26
    s_add_u32 m0, m0, 896
    s_waitcnt lgkmcnt(5)
    v_smfmac_f32_16x16x64_bf16 v[124:127], v[228:231], v[236:243], v10
    buffer_load_dwordx4 v5, s[8:11], s22 offen offset:384 nt lds
    v_xad_u32 v220, v220, v3, v4
    v_smfmac_f32_16x16x64_bf16 v[132:135], a[116:119], v[196:203], v26 abid:1
    s_waitcnt lgkmcnt(0)
    v_xad_u32 v221, v221, v3, v4
    v_smfmac_f32_16x16x64_bf16 v[160:163], v[228:231], v[236:243], v10 abid:1
    ds_read2st64_b32 v[236:237], v220 offset0:0 offset1:72
    v_xad_u32 v222, v222, v3, v4
    v_smfmac_f32_16x16x64_bf16 v[136:139], a[120:123], v[196:203], v27
    ds_read2st64_b32 v[238:239], v221 offset0:0 offset1:72
    v_xad_u32 v223, v223, v3, v4
    v_smfmac_f32_16x16x64_bf16 v[140:143], a[124:127], v[196:203], v27 abid:1
    ds_read2st64_b32 v[240:241], v222 offset0:0 offset1:72
    v_smfmac_f32_16x16x64_bf16 v[144:147], a[128:131], v[196:203], v28
    ds_read2st64_b32 v[242:243], v223 offset0:0 offset1:72
    v_cvt_pk_bf16_f32 v176, v176, v177
    v_smfmac_f32_16x16x64_bf16 v[148:151], a[132:135], v[196:203], v28 abid:1
    ds_read_b128 v[220:223], v9 offset:9344
    ds_read_b128 v[228:231], v8 offset:1024
    v_cvt_pk_bf16_f32 v177, v178, v179
    v_smfmac_f32_16x16x64_bf16 v[152:155], a[136:139], v[196:203], v29
    v_cvt_pk_bf16_f32 v178, v180, v181
    v_smfmac_f32_16x16x64_bf16 v[156:159], a[140:143], v[196:203], v29 abid:1
    ds_read_b128 v[196:199], v1 offset:6144
    v_cvt_pk_bf16_f32 v179, v182, v183
    v_smfmac_f32_16x16x64_bf16 v[124:127], a[144:147], v[204:211], v30
    ds_read_b128 v[200:203], v2 offset:6144
    v_cvt_pk_bf16_f32 v184, v184, v185
    v_smfmac_f32_16x16x64_bf16 v[128:131], a[148:151], v[204:211], v30 abid:1
    v_cvt_pk_bf16_f32 v185, v186, v187
    v_smfmac_f32_16x16x64_bf16 v[132:135], a[152:155], v[204:211], v31
    v_cvt_pk_bf16_f32 v186, v188, v189
    v_smfmac_f32_16x16x64_bf16 v[136:139], a[156:159], v[204:211], v31 abid:1
    v_cvt_pk_bf16_f32 v187, v190, v191
    v_smfmac_f32_16x16x64_bf16 v[140:143], a[160:163], v[204:211], v32
    ds_read_b128 v[188:191], v9 offset:10288
    s_waitcnt lgkmcnt(3)
    v_cndmask_b32_dpp v180, v176, v184, vcc row_ror:8 row_mask:0xf bank_mask:0xf
    v_smfmac_f32_16x16x64_bf16 v[128:131], v[228:231], v[236:243], v10
    v_xad_u32 v220, v220, v3, v4
    v_smfmac_f32_16x16x64_bf16 v[144:147], a[164:167], v[204:211], v32 abid:1
    v_xad_u32 v221, v221, v3, v4
    v_smfmac_f32_16x16x64_bf16 v[164:167], v[228:231], v[236:243], v10 abid:1
    ds_read2st64_b32 v[236:237], v220 offset0:0 offset1:72
    v_xad_u32 v222, v222, v3, v4
    v_smfmac_f32_16x16x64_bf16 v[148:151], a[168:171], v[204:211], v33
    ds_read2st64_b32 v[238:239], v221 offset0:0 offset1:72
    v_xad_u32 v223, v223, v3, v4
    v_smfmac_f32_16x16x64_bf16 v[152:155], a[172:175], v[204:211], v33 abid:1
    ds_read2st64_b32 v[240:241], v222 offset0:0 offset1:72
    v_cndmask_b32_dpp v181, v177, v185, vcc row_ror:8 row_mask:0xf bank_mask:0xf
    v_smfmac_f32_16x16x64_bf16 v[156:159], a[176:179], v[204:211], v34
    ds_read_b128 v[204:207], v1 offset:7168
    ds_read2st64_b32 v[242:243], v223 offset0:0 offset1:72
    v_cndmask_b32_dpp v182, v178, v186, vcc row_ror:8 row_mask:0xf bank_mask:0xf
    v_smfmac_f32_16x16x64_bf16 v[124:127], a[180:183], v[212:219], v34 abid:1
    ds_read_b128 v[208:211], v2 offset:7168
    ds_read_b128 v[220:223], v9 offset:9408
    v_cndmask_b32_dpp v183, v179, v187, vcc row_ror:8 row_mask:0xf bank_mask:0xf
    v_smfmac_f32_16x16x64_bf16 v[128:131], a[184:187], v[212:219], v35
    ds_read_b128 v[228:231], v8 offset:2048
    buffer_store_dwordx4 v[180:183], v6, s[12:15], s58 offen offset:128
    v_mov_b32_dpp v176, v184 row_ror:8 row_mask:0xf bank_mask:0xc
    v_smfmac_f32_16x16x64_bf16 v[132:135], a[188:191], v[212:219], v35 abid:1
    s_add_u32 m0, m0, 896
    v_mov_b32_dpp v177, v185 row_ror:8 row_mask:0xf bank_mask:0xc
    v_smfmac_f32_16x16x64_bf16 v[136:139], a[192:195], v[212:219], v36
    buffer_load_dwordx4 v5, s[8:11], s22 offen offset:512 nt lds
    v_mov_b32_dpp v178, v186 row_ror:8 row_mask:0xf bank_mask:0xc
    v_smfmac_f32_16x16x64_bf16 v[140:143], a[196:199], v[212:219], v36 abid:1
    v_mov_b32_dpp v179, v187 row_ror:8 row_mask:0xf bank_mask:0xc
    v_smfmac_f32_16x16x64_bf16 v[144:147], a[200:203], v[212:219], v37
    buffer_store_dwordx4 v[176:179], v6, s[12:15], s23 offen offset:128
    ds_read_b128 v[180:183], v9 offset:10160
    ds_read_b128 v[184:187], v9 offset:10224
    v_smfmac_f32_16x16x64_bf16 v[148:151], a[204:207], v[212:219], v37 abid:1
    ds_read_b128 v[176:179], v9 offset:10096
    v_smfmac_f32_16x16x64_bf16 v[152:155], a[208:211], v[212:219], v38
    s_waitcnt lgkmcnt(3)
    v_smfmac_f32_16x16x64_bf16 v[132:135], v[228:231], v[236:243], v10
    v_xad_u32 v220, v220, v3, v4
    v_smfmac_f32_16x16x64_bf16 v[156:159], a[212:215], v[212:219], v38 abid:1
    ds_read_b128 v[212:215], v1 offset:8192
    v_xad_u32 v221, v221, v3, v4
    v_smfmac_f32_16x16x64_bf16 v[168:171], v[228:231], v[236:243], v10 abid:1
    ds_read_b128 v[216:219], v2 offset:8192
    ds_read2st64_b32 v[236:237], v220 offset0:0 offset1:72
    v_xad_u32 v222, v222, v3, v4
    v_smfmac_f32_16x16x64_bf16 v[124:127], a[216:219], v[196:203], v39
    ds_read2st64_b32 v[238:239], v221 offset0:0 offset1:72
    v_xad_u32 v223, v223, v3, v4
    v_smfmac_f32_16x16x64_bf16 v[128:131], a[220:223], v[196:203], v39 abid:1
    ds_read2st64_b32 v[240:241], v222 offset0:0 offset1:72
    v_smfmac_f32_16x16x64_bf16 v[132:135], a[224:227], v[196:203], v40
    ds_read2st64_b32 v[242:243], v223 offset0:0 offset1:72
    v_smfmac_f32_16x16x64_bf16 v[136:139], a[228:231], v[196:203], v40 abid:1
    ds_read_b128 v[220:223], v9 offset:9472
    ds_read_b128 v[228:231], v8 offset:3072
    v_smfmac_f32_16x16x64_bf16 v[140:143], a[232:235], v[196:203], v41
    v_smfmac_f32_16x16x64_bf16 v[144:147], a[236:239], v[196:203], v41 abid:1
    v_smfmac_f32_16x16x64_bf16 v[148:151], a[240:243], v[196:203], v42
    s_add_u32 m0, m0, 896
    v_smfmac_f32_16x16x64_bf16 v[152:155], a[244:247], v[196:203], v42 abid:1
    buffer_load_dwordx4 v5, s[8:11], s22 offen offset:640 nt lds
    v_smfmac_f32_16x16x64_bf16 v[156:159], a[248:251], v[196:203], v43
    ds_read_b128 v[196:199], v1 offset:18432
    v_smfmac_f32_16x16x64_bf16 v[124:127], a[252:255], v[204:211], v43 abid:1
    ds_read_b128 v[200:203], v2 offset:18432
    v_smfmac_f32_16x16x64_bf16 v[128:131], v[56:59], v[204:211], v44
    s_waitcnt lgkmcnt(2)
    v_smfmac_f32_16x16x64_bf16 v[136:139], v[228:231], v[236:243], v10
    v_xad_u32 v220, v220, v3, v4
    v_smfmac_f32_16x16x64_bf16 v[132:135], v[60:63], v[204:211], v44 abid:1
    v_xad_u32 v221, v221, v3, v4
    v_smfmac_f32_16x16x64_bf16 v[172:175], v[228:231], v[236:243], v10 abid:1
    ds_read2st64_b32 v[236:237], v220 offset0:0 offset1:72
    v_xad_u32 v222, v222, v3, v4
    v_smfmac_f32_16x16x64_bf16 v[136:139], v[64:67], v[204:211], v45
    ds_read2st64_b32 v[238:239], v221 offset0:0 offset1:72
    v_xad_u32 v223, v223, v3, v4
    v_smfmac_f32_16x16x64_bf16 v[140:143], v[68:71], v[204:211], v45 abid:1
    ds_read2st64_b32 v[240:241], v222 offset0:0 offset1:72
    v_smfmac_f32_16x16x64_bf16 v[144:147], v[72:75], v[204:211], v46
    ds_read2st64_b32 v[242:243], v223 offset0:0 offset1:72
    v_smfmac_f32_16x16x64_bf16 v[148:151], v[76:79], v[204:211], v46 abid:1
    ds_read_b128 v[220:223], v9 offset:9536
    ds_read_b128 v[228:231], v8 offset:4096
    v_smfmac_f32_16x16x64_bf16 v[152:155], v[80:83], v[204:211], v47
    v_smfmac_f32_16x16x64_bf16 v[156:159], v[84:87], v[204:211], v47 abid:1
    ds_read_b128 v[204:207], v1 offset:19456
    v_smfmac_f32_16x16x64_bf16 v[124:127], v[88:91], v[212:219], v48
    ds_read_b128 v[208:211], v2 offset:19456
    v_smfmac_f32_16x16x64_bf16 v[128:131], v[92:95], v[212:219], v48 abid:1
    v_smfmac_f32_16x16x64_bf16 v[132:135], v[96:99], v[212:219], v49
    s_add_u32 m0, m0, 896
    v_smfmac_f32_16x16x64_bf16 v[136:139], v[100:103], v[212:219], v49 abid:1
    buffer_load_dwordx4 v5, s[8:11], s22 offen offset:768 nt lds
    v_smfmac_f32_16x16x64_bf16 v[140:143], v[104:107], v[212:219], v50
    s_waitcnt lgkmcnt(2)
    v_smfmac_f32_16x16x64_bf16 v[140:143], v[228:231], v[236:243], v10
    v_xad_u32 v220, v220, v3, v4
    v_smfmac_f32_16x16x64_bf16 v[144:147], v[108:111], v[212:219], v50 abid:1
    v_xad_u32 v221, v221, v3, v4
    v_smfmac_f32_16x16x64_bf16 v[176:179], v[228:231], v[236:243], v10 abid:1
    ds_read2st64_b32 v[236:237], v220 offset0:0 offset1:72
    v_xad_u32 v222, v222, v3, v4
    v_smfmac_f32_16x16x64_bf16 v[148:151], v[112:115], v[212:219], v51
    ds_read2st64_b32 v[238:239], v221 offset0:0 offset1:72
    v_xad_u32 v223, v223, v3, v4
    v_smfmac_f32_16x16x64_bf16 v[152:155], v[116:119], v[212:219], v51 abid:1
    ds_read2st64_b32 v[240:241], v222 offset0:0 offset1:72
    v_smfmac_f32_16x16x64_bf16 v[156:159], v[120:123], v[212:219], v52
    ds_read_b128 v[212:215], v1 offset:20480
    s_cmp_lg_u32 s27, 0
    s_cbranch_scc1 M_slow
M_slowr:
    v_smfmac_f32_16x16x64_bf16 v[160:163], a[0:3], v[196:203], v12
    ds_read_b128 v[216:219], v2 offset:20480
    ds_read2st64_b32 v[242:243], v223 offset0:0 offset1:72
    v_smfmac_f32_16x16x64_bf16 v[164:167], a[4:7], v[196:203], v12 abid:1
    ds_read_b128 v[220:223], v9 offset:9600
    ds_read_b128 v[228:231], v8 offset:5120
    v_smfmac_f32_16x16x64_bf16 v[168:171], a[8:11], v[196:203], v13
    v_smfmac_f32_16x16x64_bf16 v[172:175], a[12:15], v[196:203], v13 abid:1
    v_cvt_pk_bf16_f32 v156, v156, v157
    v_smfmac_f32_16x16x64_bf16 v[176:179], a[16:19], v[196:203], v14
    v_cvt_pk_bf16_f32 v157, v158, v159
    v_smfmac_f32_16x16x64_bf16 v[180:183], a[20:23], v[196:203], v14 abid:1
    buffer_store_dwordx2 v[156:157], v7, s[12:15], s24 offen
    s_nop 1
    ds_read_b128 v[156:159], v9 offset:10352
    v_smfmac_f32_16x16x64_bf16 v[184:187], a[24:27], v[196:203], v15
    v_smfmac_f32_16x16x64_bf16 v[188:191], a[28:31], v[196:203], v15 abid:1
    s_waitcnt lgkmcnt(1)
    v_cvt_pk_bf16_f32 v124, v124, v125
    v_smfmac_f32_16x16x64_bf16 v[144:147], v[228:231], v[236:243], v10
    v_xad_u32 v220, v220, v3, v4
    v_smfmac_f32_16x16x64_bf16 v[192:195], a[32:35], v[196:203], v16
    ds_read_b128 v[196:199], v1 offset:21504
    v_xad_u32 v221, v221, v3, v4
    v_smfmac_f32_16x16x64_bf16 v[180:183], v[228:231], v[236:243], v10 abid:1
    ds_read_b128 v[200:203], v2 offset:21504
    ds_read2st64_b32 v[236:237], v220 offset0:0 offset1:72
    v_xad_u32 v222, v222, v3, v4
    v_smfmac_f32_16x16x64_bf16 v[160:163], a[36:39], v[204:211], v16 abid:1
    ds_read2st64_b32 v[238:239], v221 offset0:0 offset1:72
    v_xad_u32 v223, v223, v3, v4
    v_smfmac_f32_16x16x64_bf16 v[164:167], a[40:43], v[204:211], v17
    ds_read2st64_b32 v[240:241], v222 offset0:0 offset1:72
    v_cvt_pk_bf16_f32 v125, v126, v127
    v_smfmac_f32_16x16x64_bf16 v[168:171], a[44:47], v[204:211], v17 abid:1
    ds_read2st64_b32 v[242:243], v223 offset0:0 offset1:72
    v_cvt_pk_bf16_f32 v126, v128, v129
    v_smfmac_f32_16x16x64_bf16 v[172:175], a[48:51], v[204:211], v18
    ds_read_b128 v[220:223], v9 offset:9664
    ds_read_b128 v[228:231], v8 offset:6144
    v_cvt_pk_bf16_f32 v127, v130, v131
    v_smfmac_f32_16x16x64_bf16 v[176:179], a[52:55], v[204:211], v18 abid:1
    s_add_u32 m0, m0, 896
    v_cvt_pk_bf16_f32 v132, v132, v133
    v_smfmac_f32_16x16x64_bf16 v[180:183], a[56:59], v[204:211], v19
    buffer_load_dwordx4 v5, s[8:11], s22 offen offset:896 nt lds
    v_cvt_pk_bf16_f32 v133, v134, v135
    v_smfmac_f32_16x16x64_bf16 v[184:187], a[60:63], v[204:211], v19 abid:1
    v_cvt_pk_bf16_f32 v134, v136, v137
    v_smfmac_f32_16x16x64_bf16 v[188:191], a[64:67], v[204:211], v20
    v_cvt_pk_bf16_f32 v135, v138, v139
    v_smfmac_f32_16x16x64_bf16 v[192:195], a[68:71], v[204:211], v20 abid:1
    ds_read_b128 v[204:207], v1 offset:22528
    ds_read_b128 v[136:139], v9 offset:10032
    v_cndmask_b32_dpp v128, v124, v132, vcc row_ror:8 row_mask:0xf bank_mask:0xf
    v_smfmac_f32_16x16x64_bf16 v[160:163], a[72:75], v[212:219], v21
    ds_read_b128 v[208:211], v2 offset:22528
    v_cndmask_b32_dpp v129, v125, v133, vcc row_ror:8 row_mask:0xf bank_mask:0xf
    v_smfmac_f32_16x16x64_bf16 v[164:167], a[76:79], v[212:219], v21 abid:1
    s_waitcnt lgkmcnt(3)
    v_cndmask_b32_dpp v130, v126, v134, vcc row_ror:8 row_mask:0xf bank_mask:0xf
    v_smfmac_f32_16x16x64_bf16 v[148:151], v[228:231], v[236:243], v10
    v_xad_u32 v220, v220, v3, v4
    v_smfmac_f32_16x16x64_bf16 v[168:171], a[80:83], v[212:219], v22
    v_xad_u32 v221, v221, v3, v4
    v_smfmac_f32_16x16x64_bf16 v[184:187], v[228:231], v[236:243], v10 abid:1
    ds_read2st64_b32 v[236:237], v220 offset0:0 offset1:72
    v_xad_u32 v222, v222, v3, v4
    v_smfmac_f32_16x16x64_bf16 v[172:175], a[84:87], v[212:219], v22 abid:1
    ds_read2st64_b32 v[238:239], v221 offset0:0 offset1:72
    v_xad_u32 v223, v223, v3, v4
    v_smfmac_f32_16x16x64_bf16 v[176:179], a[88:91], v[212:219], v23
    ds_read2st64_b32 v[240:241], v222 offset0:0 offset1:72
    v_cndmask_b32_dpp v131, v127, v135, vcc row_ror:8 row_mask:0xf bank_mask:0xf
    v_smfmac_f32_16x16x64_bf16 v[180:183], a[92:95], v[212:219], v23 abid:1
    ds_read2st64_b32 v[242:243], v223 offset0:0 offset1:72
    buffer_store_dwordx4 v[128:131], v6, s[12:15], s59 offen offset:0
    v_mov_b32_dpp v124, v132 row_ror:8 row_mask:0xf bank_mask:0xc
    v_smfmac_f32_16x16x64_bf16 v[184:187], a[96:99], v[212:219], v24
    ds_read_b128 v[228:231], v8 offset:7168
    v_mov_b32_dpp v125, v133 row_ror:8 row_mask:0xf bank_mask:0xc
    v_smfmac_f32_16x16x64_bf16 v[188:191], a[100:103], v[212:219], v24 abid:1
    v_mov_b32_dpp v126, v134 row_ror:8 row_mask:0xf bank_mask:0xc
    v_smfmac_f32_16x16x64_bf16 v[192:195], a[104:107], v[212:219], v25
    ds_read_b128 v[212:215], v1 offset:23552
    v_mov_b32_dpp v127, v135 row_ror:8 row_mask:0xf bank_mask:0xc
    v_smfmac_f32_16x16x64_bf16 v[160:163], a[108:111], v[196:203], v25 abid:1
    ds_read_b128 v[216:219], v2 offset:23552
    buffer_store_dwordx4 v[124:127], v6, s[12:15], s24 offen offset:0
    ds_read_b128 v[128:131], v9 offset:9904
    v_smfmac_f32_16x16x64_bf16 v[164:167], a[112:115], v[196:203], v26
    ds_read_b128 v[132:135], v9 offset:9968
    ds_read_b128 v[124:127], v9 offset:9840
    v_smfmac_f32_16x16x64_bf16 v[168:171], a[116:119], v[196:203], v26 abid:1
    s_add_u32 m0, m0, 896
    v_smfmac_f32_16x16x64_bf16 v[172:175], a[120:123], v[196:203], v27
    buffer_load_dwordx4 v5, s[8:11], s22 offen offset:1024 nt lds
    v_smfmac_f32_16x16x64_bf16 v[176:179], a[124:127], v[196:203], v27 abid:1
    s_waitcnt lgkmcnt(5)
    v_smfmac_f32_16x16x64_bf16 v[152:155], v[228:231], v[236:243], v10
    v_smfmac_f32_16x16x64_bf16 v[180:183], a[128:131], v[196:203], v28
    v_smfmac_f32_16x16x64_bf16 v[188:191], v[228:231], v[236:243], v10 abid:1
    v_smfmac_f32_16x16x64_bf16 v[184:187], a[132:135], v[196:203], v28 abid:1
    v_smfmac_f32_16x16x64_bf16 v[188:191], a[136:139], v[196:203], v29
    v_smfmac_f32_16x16x64_bf16 v[192:195], a[140:143], v[196:203], v29 abid:1
    ds_read_b128 v[196:199], v1 offset:24576
    v_smfmac_f32_16x16x64_bf16 v[160:163], a[144:147], v[204:211], v30
    ds_read_b128 v[200:203], v2 offset:24576
    v_smfmac_f32_16x16x64_bf16 v[164:167], a[148:151], v[204:211], v30 abid:1
    v_smfmac_f32_16x16x64_bf16 v[168:171], a[152:155], v[204:211], v31
    v_cvt_pk_bf16_f32 v140, v140, v141
    v_smfmac_f32_16x16x64_bf16 v[172:175], a[156:159], v[204:211], v31 abid:1
    v_cvt_pk_bf16_f32 v141, v142, v143
    v_smfmac_f32_16x16x64_bf16 v[176:179], a[160:163], v[204:211], v32
    v_cvt_pk_bf16_f32 v142, v144, v145
    v_smfmac_f32_16x16x64_bf16 v[180:183], a[164:167], v[204:211], v32 abid:1
    s_add_u32 s21, s21, 1
    s_add_u32 s28, s25, s26
    v_cvt_pk_bf16_f32 v143, v146, v147
    v_smfmac_f32_16x16x64_bf16 v[184:187], a[168:171], v[204:211], v33
    s_add_u32 s30, s25, 36864
    s_cmp_eq_u32 s30, 110592
    v_cvt_pk_bf16_f32 v148, v148, v149
    v_smfmac_f32_16x16x64_bf16 v[188:191], a[172:175], v[204:211], v33 abid:1
    s_cselect_b32 s30, 0, s30
    s_sub_u32 s31, s30, s25
    v_cvt_pk_bf16_f32 v149, v150, v151
    v_smfmac_f32_16x16x64_bf16 v[192:195], a[176:179], v[204:211], v34
    ds_read_b128 v[204:207], v1 offset:25600
    s_mov_b32 s25, s30
    s_waitcnt lgkmcnt(6)
    v_cvt_pk_bf16_f32 v150, v152, v153
    v_smfmac_f32_16x16x64_bf16 v[160:163], a[180:183], v[212:219], v34 abid:1
    ds_read_b128 v[208:211], v2 offset:25600
    s_add_u32 s22, s22, 9437184
    v_cvt_pk_bf16_f32 v151, v154, v155
    v_smfmac_f32_16x16x64_bf16 v[164:167], a[184:187], v[212:219], v35
    ds_read_b128 v[152:155], v9 offset:10288
    s_cmp_gt_u32 s21, 5
    v_cndmask_b32_dpp v144, v140, v148, vcc row_ror:8 row_mask:0xf bank_mask:0xf
    v_smfmac_f32_16x16x64_bf16 v[168:171], a[188:191], v[212:219], v35 abid:1
    s_cselect_b32 s10, 0, 75497472
    v_cndmask_b32_dpp v145, v141, v149, vcc row_ror:8 row_mask:0xf bank_mask:0xf
    v_smfmac_f32_16x16x64_bf16 v[172:175], a[192:195], v[212:219], v36
    v_cndmask_b32_dpp v146, v142, v150, vcc row_ror:8 row_mask:0xf bank_mask:0xf
    v_smfmac_f32_16x16x64_bf16 v[176:179], a[196:199], v[212:219], v36 abid:1
    v_cndmask_b32_dpp v147, v143, v151, vcc row_ror:8 row_mask:0xf bank_mask:0xf
    v_smfmac_f32_16x16x64_bf16 v[180:183], a[200:203], v[212:219], v37
    buffer_store_dwordx4 v[144:147], v6, s[12:15], s59 offen offset:128
    v_mov_b32_dpp v140, v148 row_ror:8 row_mask:0xf bank_mask:0xc
    v_smfmac_f32_16x16x64_bf16 v[184:187], a[204:207], v[212:219], v37 abid:1
    v_mov_b32_dpp v141, v149 row_ror:8 row_mask:0xf bank_mask:0xc
    v_smfmac_f32_16x16x64_bf16 v[188:191], a[208:211], v[212:219], v38
    v_mov_b32_dpp v142, v150 row_ror:8 row_mask:0xf bank_mask:0xc
    v_smfmac_f32_16x16x64_bf16 v[192:195], a[212:215], v[212:219], v38 abid:1
    ds_read_b128 v[212:215], v1 offset:26624
    s_waitcnt lgkmcnt(4)
    v_mov_b32_dpp v143, v151 row_ror:8 row_mask:0xf bank_mask:0xc
    v_smfmac_f32_16x16x64_bf16 v[160:163], a[216:219], v[196:203], v39
    ds_read_b128 v[216:219], v2 offset:26624
    buffer_store_dwordx4 v[140:143], v6, s[12:15], s24 offen offset:128
    ds_read_b128 v[144:147], v9 offset:10160
    v_smfmac_f32_16x16x64_bf16 v[164:167], a[220:223], v[196:203], v39 abid:1
    ds_read_b128 v[148:151], v9 offset:10224
    ds_read_b128 v[140:143], v9 offset:10096
    v_smfmac_f32_16x16x64_bf16 v[168:171], a[224:227], v[196:203], v40
    v_add_u32 v4, s31, v4
    v_smfmac_f32_16x16x64_bf16 v[172:175], a[228:231], v[196:203], v40 abid:1
    v_add_u32 v1, s31, v1
    v_smfmac_f32_16x16x64_bf16 v[176:179], a[232:235], v[196:203], v41
    v_add_u32 v2, s31, v2
    v_smfmac_f32_16x16x64_bf16 v[180:183], a[236:239], v[196:203], v41 abid:1
    v_smfmac_f32_16x16x64_bf16 v[184:187], a[240:243], v[196:203], v42
    v_smfmac_f32_16x16x64_bf16 v[188:191], a[244:247], v[196:203], v42 abid:1
    v_smfmac_f32_16x16x64_bf16 v[192:195], a[248:251], v[196:203], v43
    s_cmp_lt_u32 s21, 8
    s_cbranch_scc1 M_top
    s_add_u32 s23, s24, 18432
    s_add_u32 s58, s24, 27648
    s_waitcnt lgkmcnt(6)
    v_smfmac_f32_16x16x64_bf16 v[160:163], a[252:255], v[204:211], v43 abid:1
    v_smfmac_f32_16x16x64_bf16 v[164:167], v[56:59], v[204:211], v44
    v_smfmac_f32_16x16x64_bf16 v[168:171], v[60:63], v[204:211], v44 abid:1
    v_smfmac_f32_16x16x64_bf16 v[172:175], v[64:67], v[204:211], v45
    v_smfmac_f32_16x16x64_bf16 v[176:179], v[68:71], v[204:211], v45 abid:1
    v_smfmac_f32_16x16x64_bf16 v[180:183], v[72:75], v[204:211], v46
    v_smfmac_f32_16x16x64_bf16 v[184:187], v[76:79], v[204:211], v46 abid:1
    v_smfmac_f32_16x16x64_bf16 v[188:191], v[80:83], v[204:211], v47
    v_smfmac_f32_16x16x64_bf16 v[192:195], v[84:87], v[204:211], v47 abid:1
    s_waitcnt lgkmcnt(3)
    v_smfmac_f32_16x16x64_bf16 v[160:163], v[88:91], v[212:219], v48
    v_smfmac_f32_16x16x64_bf16 v[164:167], v[92:95], v[212:219], v48 abid:1
    v_smfmac_f32_16x16x64_bf16 v[168:171], v[96:99], v[212:219], v49
    v_smfmac_f32_16x16x64_bf16 v[172:175], v[100:103], v[212:219], v49 abid:1
    v_smfmac_f32_16x16x64_bf16 v[176:179], v[104:107], v[212:219], v50
    v_smfmac_f32_16x16x64_bf16 v[180:183], v[108:111], v[212:219], v50 abid:1
    v_smfmac_f32_16x16x64_bf16 v[184:187], v[112:115], v[212:219], v51
    v_smfmac_f32_16x16x64_bf16 v[188:191], v[116:119], v[212:219], v51 abid:1
    v_smfmac_f32_16x16x64_bf16 v[192:195], v[120:123], v[212:219], v52
    v_cvt_pk_bf16_f32 v160, v160, v161
    v_cvt_pk_bf16_f32 v161, v162, v163
    v_cvt_pk_bf16_f32 v162, v164, v165
    v_cvt_pk_bf16_f32 v163, v166, v167
    v_cvt_pk_bf16_f32 v168, v168, v169
    v_cvt_pk_bf16_f32 v169, v170, v171
    v_cvt_pk_bf16_f32 v170, v172, v173
    v_cvt_pk_bf16_f32 v171, v174, v175
    v_cndmask_b32_dpp v164, v160, v168, vcc row_ror:8 row_mask:0xf bank_mask:0xf
    v_cndmask_b32_dpp v165, v161, v169, vcc row_ror:8 row_mask:0xf bank_mask:0xf
    v_cndmask_b32_dpp v166, v162, v170, vcc row_ror:8 row_mask:0xf bank_mask:0xf
    v_cndmask_b32_dpp v167, v163, v171, vcc row_ror:8 row_mask:0xf bank_mask:0xf
    buffer_store_dwordx4 v[164:167], v6, s[12:15], s58 offen offset:0
    v_mov_b32_dpp v160, v168 row_ror:8 row_mask:0xf bank_mask:0xc
    v_mov_b32_dpp v161, v169 row_ror:8 row_mask:0xf bank_mask:0xc
    v_mov_b32_dpp v162, v170 row_ror:8 row_mask:0xf bank_mask:0xc
    v_mov_b32_dpp v163, v171 row_ror:8 row_mask:0xf bank_mask:0xc
    buffer_store_dwordx4 v[160:163], v6, s[12:15], s23 offen offset:0
    v_cvt_pk_bf16_f32 v176, v176, v177
    v_cvt_pk_bf16_f32 v177, v178, v179
    v_cvt_pk_bf16_f32 v178, v180, v181
    v_cvt_pk_bf16_f32 v179, v182, v183
    v_cvt_pk_bf16_f32 v184, v184, v185
    v_cvt_pk_bf16_f32 v185, v186, v187
    v_cvt_pk_bf16_f32 v186, v188, v189
    v_cvt_pk_bf16_f32 v187, v190, v191
    v_cndmask_b32_dpp v180, v176, v184, vcc row_ror:8 row_mask:0xf bank_mask:0xf
    v_cndmask_b32_dpp v181, v177, v185, vcc row_ror:8 row_mask:0xf bank_mask:0xf
    v_cndmask_b32_dpp v182, v178, v186, vcc row_ror:8 row_mask:0xf bank_mask:0xf
    v_cndmask_b32_dpp v183, v179, v187, vcc row_ror:8 row_mask:0xf bank_mask:0xf
    buffer_store_dwordx4 v[180:183], v6, s[12:15], s58 offen offset:128
    v_mov_b32_dpp v176, v184 row_ror:8 row_mask:0xf bank_mask:0xc
    v_mov_b32_dpp v177, v185 row_ror:8 row_mask:0xf bank_mask:0xc
    v_mov_b32_dpp v178, v186 row_ror:8 row_mask:0xf bank_mask:0xc
    v_mov_b32_dpp v179, v187 row_ror:8 row_mask:0xf bank_mask:0xc
    buffer_store_dwordx4 v[176:179], v6, s[12:15], s23 offen offset:128
    v_cvt_pk_bf16_f32 v192, v192, v193
    v_cvt_pk_bf16_f32 v193, v194, v195
    buffer_store_dwordx2 v[192:193], v7, s[12:15], s23 offen
M_end:
    s_endpgm
M_pf_spin:
    s_sleep 2
    buffer_load_dword v0, off, s[68:71], 0 offset:128 sc1
    s_sub_u32 s31, s31, 1
    s_cbranch_scc1 M_end
    s_waitcnt vmcnt(0)
    v_readfirstlane_b32 s30, v0
    s_nop 0
    s_cmp_ge_u32 s30, 1
    s_cbranch_scc0 M_pf_spin
    s_branch M_pf_ok
M_pc_spin:
    s_sleep 2
    buffer_load_dword v0, off, s[68:71], 0 offset:192 sc1
    s_sub_u32 s31, s31, 1
    s_cbranch_scc1 M_end
    s_waitcnt vmcnt(0)
    v_readfirstlane_b32 s30, v0
    s_nop 0
    s_cmp_ge_u32 s30, 1
    s_cbranch_scc0 M_pc_spin
    s_branch M_pc_ok
M_xlate:
    s_mov_b32 m0, s42
    s_nop 0
    buffer_load_dwordx4 v5, s[8:11], s22 offen offset:0 nt lds
    s_add_u32 m0, m0, 896
    s_nop 0
    buffer_load_dwordx4 v5, s[8:11], s22 offen offset:128 nt lds
    s_add_u32 m0, m0, 896
    s_nop 0
    buffer_load_dwordx4 v5, s[8:11], s22 offen offset:256 nt lds
    s_add_u32 m0, m0, 896
    s_nop 0
    buffer_load_dwordx4 v5, s[8:11], s22 offen offset:384 nt lds
    s_add_u32 m0, m0, 896
    s_nop 0
    buffer_load_dwordx4 v5, s[8:11], s22 offen offset:512 nt lds
    s_add_u32 m0, m0, 896
    s_nop 0
    buffer_load_dwordx4 v5, s[8:11], s22 offen offset:640 nt lds
    s_add_u32 m0, m0, 896
    s_nop 0
    buffer_load_dwordx4 v5, s[8:11], s22 offen offset:768 nt lds
    s_add_u32 m0, m0, 896
    s_nop 0
    buffer_load_dwordx4 v5, s[8:11], s22 offen offset:896 nt lds
    s_add_u32 m0, m0, 896
    s_nop 0
    buffer_load_dwordx4 v5, s[8:11], s22 offen offset:1024 nt lds
    s_add_u32 s22, s22, 9437184
    s_add_u32 s42, s42, 36864
    s_add_u32 s21, s21, 1
    s_cmp_lt_u32 s21, 3
    s_cbranch_scc1 M_xlate
    s_branch M_xlater
M_pool:
    v_readfirstlane_b32 s32, v236
    v_readfirstlane_b32 s33, v237
    v_readfirstlane_b32 s34, v238
    v_readfirstlane_b32 s35, v239
    v_readfirstlane_b32 s36, v240
    v_readfirstlane_b32 s37, v241
    v_readfirstlane_b32 s38, v242
    v_readfirstlane_b32 s39, v243
    v_readfirstlane_b32 s40, v228
    s_mov_b32 s27, 0
    s_add_u32 s54, s29, 10416
    s_mul_i32 s55, s20, 78336
    s_add_u32 s55, s55, 414208
    s_mov_b32 exec_hi, 3
    s_min_u32 s32, s32, 16
    s_mov_b32 s44, s27
    s_mov_b32 s56, 0
M_pool0:
    s_cmp_lt_u32 s56, s32
    s_cbranch_scc0 M_poole0
    s_add_u32 s57, s27, s56
    s_cmp_lt_u32 s57, 5
    s_cbranch_scc0 M_poole0
    s_mul_i32 s57, s57, 544
    s_add_u32 m0, s57, s54
    s_add_u32 s57, s56, 0
    s_mul_i32 s57, s57, 544
    s_add_u32 s57, s57, s55
    buffer_load_dwordx4 v11, s[16:19], s57 offen sc1 lds
    s_add_u32 s56, s56, 1
    s_branch M_pool0
M_poole0:
    s_add_u32 s27, s27, s32
    s_min_u32 s33, s33, 16
    s_mov_b32 s45, s27
    s_mov_b32 s56, 0
M_pool1:
    s_cmp_lt_u32 s56, s33
    s_cbranch_scc0 M_poole1
    s_add_u32 s57, s27, s56
    s_cmp_lt_u32 s57, 5
    s_cbranch_scc0 M_poole1
    s_mul_i32 s57, s57, 544
    s_add_u32 m0, s57, s54
    s_add_u32 s57, s56, 16
    s_mul_i32 s57, s57, 544
    s_add_u32 s57, s57, s55
    buffer_load_dwordx4 v11, s[16:19], s57 offen sc1 lds
    s_add_u32 s56, s56, 1
    s_branch M_pool1
M_poole1:
    s_add_u32 s27, s27, s33
    s_min_u32 s34, s34, 16
    s_mov_b32 s46, s27
    s_mov_b32 s56, 0
M_pool2:
    s_cmp_lt_u32 s56, s34
    s_cbranch_scc0 M_poole2
    s_add_u32 s57, s27, s56
    s_cmp_lt_u32 s57, 5
    s_cbranch_scc0 M_poole2
    s_mul_i32 s57, s57, 544
    s_add_u32 m0, s57, s54
    s_add_u32 s57, s56, 32
    s_mul_i32 s57, s57, 544
    s_add_u32 s57, s57, s55
    buffer_load_dwordx4 v11, s[16:19], s57 offen sc1 lds
    s_add_u32 s56, s56, 1
    s_branch M_pool2
M_poole2:
    s_add_u32 s27, s27, s34
    s_min_u32 s35, s35, 16
    s_mov_b32 s47, s27
    s_mov_b32 s56, 0
M_pool3:
    s_cmp_lt_u32 s56, s35
    s_cbranch_scc0 M_poole3
    s_add_u32 s57, s27, s56
    s_cmp_lt_u32 s57, 5
    s_cbranch_scc0 M_poole3
    s_mul_i32 s57, s57, 544
    s_add_u32 m0, s57, s54
    s_add_u32 s57, s56, 48
    s_mul_i32 s57, s57, 544
    s_add_u32 s57, s57, s55
    buffer_load_dwordx4 v11, s[16:19], s57 offen sc1 lds
    s_add_u32 s56, s56, 1
    s_branch M_pool3
M_poole3:
    s_add_u32 s27, s27, s35
    s_min_u32 s36, s36, 16
    s_mov_b32 s48, s27
    s_mov_b32 s56, 0
M_pool4:
    s_cmp_lt_u32 s56, s36
    s_cbranch_scc0 M_poole4
    s_add_u32 s57, s27, s56
    s_cmp_lt_u32 s57, 5
    s_cbranch_scc0 M_poole4
    s_mul_i32 s57, s57, 544
    s_add_u32 m0, s57, s54
    s_add_u32 s57, s56, 64
    s_mul_i32 s57, s57, 544
    s_add_u32 s57, s57, s55
    buffer_load_dwordx4 v11, s[16:19], s57 offen sc1 lds
    s_add_u32 s56, s56, 1
    s_branch M_pool4
M_poole4:
    s_add_u32 s27, s27, s36
    s_min_u32 s37, s37, 16
    s_mov_b32 s49, s27
    s_mov_b32 s56, 0
M_pool5:
    s_cmp_lt_u32 s56, s37
    s_cbranch_scc0 M_poole5
    s_add_u32 s57, s27, s56
    s_cmp_lt_u32 s57, 5
    s_cbranch_scc0 M_poole5
    s_mul_i32 s57, s57, 544
    s_add_u32 m0, s57, s54
    s_add_u32 s57, s56, 80
    s_mul_i32 s57, s57, 544
    s_add_u32 s57, s57, s55
    buffer_load_dwordx4 v11, s[16:19], s57 offen sc1 lds
    s_add_u32 s56, s56, 1
    s_branch M_pool5
M_poole5:
    s_add_u32 s27, s27, s37
    s_min_u32 s38, s38, 16
    s_mov_b32 s50, s27
    s_mov_b32 s56, 0
M_pool6:
    s_cmp_lt_u32 s56, s38
    s_cbranch_scc0 M_poole6
    s_add_u32 s57, s27, s56
    s_cmp_lt_u32 s57, 5
    s_cbranch_scc0 M_poole6
    s_mul_i32 s57, s57, 544
    s_add_u32 m0, s57, s54
    s_add_u32 s57, s56, 96
    s_mul_i32 s57, s57, 544
    s_add_u32 s57, s57, s55
    buffer_load_dwordx4 v11, s[16:19], s57 offen sc1 lds
    s_add_u32 s56, s56, 1
    s_branch M_pool6
M_poole6:
    s_add_u32 s27, s27, s38
    s_min_u32 s39, s39, 16
    s_mov_b32 s51, s27
    s_mov_b32 s56, 0
M_pool7:
    s_cmp_lt_u32 s56, s39
    s_cbranch_scc0 M_poole7
    s_add_u32 s57, s27, s56
    s_cmp_lt_u32 s57, 5
    s_cbranch_scc0 M_poole7
    s_mul_i32 s57, s57, 544
    s_add_u32 m0, s57, s54
    s_add_u32 s57, s56, 112
    s_mul_i32 s57, s57, 544
    s_add_u32 s57, s57, s55
    buffer_load_dwordx4 v11, s[16:19], s57 offen sc1 lds
    s_add_u32 s56, s56, 1
    s_branch M_pool7
M_poole7:
    s_add_u32 s27, s27, s39
    s_min_u32 s40, s40, 16
    s_mov_b32 s52, s27
    s_mov_b32 s56, 0
M_pool8:
    s_cmp_lt_u32 s56, s40
    s_cbranch_scc0 M_poole8
    s_add_u32 s57, s27, s56
    s_cmp_lt_u32 s57, 5
    s_cbranch_scc0 M_poole8
    s_mul_i32 s57, s57, 544
    s_add_u32 m0, s57, s54
    s_add_u32 s57, s56, 128
    s_mul_i32 s57, s57, 544
    s_add_u32 s57, s57, s55
    buffer_load_dwordx4 v11, s[16:19], s57 offen sc1 lds
    s_add_u32 s56, s56, 1
    s_branch M_pool8
M_poole8:
    s_add_u32 s27, s27, s40
    s_mov_b32 exec_hi, -1
    s_branch M_poolr
M_slow:
    s_mov_b32 s56, 0
M_sl0:
    s_cmp_lt_u32 s56, s32
    s_cbranch_scc0 M_sle0
    s_add_u32 s57, s44, s56
    s_cmp_lt_u32 s57, 5
    s_cbranch_scc0 M_slg0
    s_mul_i32 s57, s57, 544
    s_add_u32 s57, s57, s54
    v_add_u32 v252, s57, v55
    v_add_u32 v253, s57, v54
    ds_read_b64 v[224:225], v252
    ds_read_b64 v[226:227], v253
    s_waitcnt lgkmcnt(0)
    s_branch M_slc0
M_slg0:
    s_add_u32 s57, s56, 0
    s_mul_i32 s57, s57, 544
    s_add_u32 s57, s57, s55
    buffer_load_dwordx2 v[224:225], v55, s[16:19], s57 offen sc1
    buffer_load_dwordx2 v[226:227], v54, s[16:19], s57 offen sc1
    s_waitcnt vmcnt(0)
M_slc0:
    v_xad_u32 v224, v224, v3, v4
    v_xad_u32 v225, v225, v3, v4
    ds_read2st64_b32 v[232:233], v224 offset0:0 offset1:72
    ds_read2st64_b32 v[234:235], v225 offset0:0 offset1:72
    s_add_u32 s56, s56, 1
    s_nop 7
    s_waitcnt lgkmcnt(0)
    v_smfmac_f32_16x16x32_bf16 v[124:127], v[226:227], v[232:235], v10
    v_smfmac_f32_16x16x32_bf16 v[160:163], v[226:227], v[232:235], v10 abid:2
    s_branch M_sl0
M_sle0:
    s_mov_b32 s56, 0
M_sl1:
    s_cmp_lt_u32 s56, s33
    s_cbranch_scc0 M_sle1
    s_add_u32 s57, s45, s56
    s_cmp_lt_u32 s57, 5
    s_cbranch_scc0 M_slg1
    s_mul_i32 s57, s57, 544
    s_add_u32 s57, s57, s54
    v_add_u32 v252, s57, v55
    v_add_u32 v253, s57, v54
    ds_read_b64 v[224:225], v252
    ds_read_b64 v[226:227], v253
    s_waitcnt lgkmcnt(0)
    s_branch M_slc1
M_slg1:
    s_add_u32 s57, s56, 16
    s_mul_i32 s57, s57, 544
    s_add_u32 s57, s57, s55
    buffer_load_dwordx2 v[224:225], v55, s[16:19], s57 offen sc1
    buffer_load_dwordx2 v[226:227], v54, s[16:19], s57 offen sc1
    s_waitcnt vmcnt(0)
M_slc1:
    v_xad_u32 v224, v224, v3, v4
    v_xad_u32 v225, v225, v3, v4
    ds_read2st64_b32 v[232:233], v224 offset0:0 offset1:72
    ds_read2st64_b32 v[234:235], v225 offset0:0 offset1:72
    s_add_u32 s56, s56, 1
    s_nop 7
    s_waitcnt lgkmcnt(0)
    v_smfmac_f32_16x16x32_bf16 v[128:131], v[226:227], v[232:235], v10
    v_smfmac_f32_16x16x32_bf16 v[164:167], v[226:227], v[232:235], v10 abid:2
    s_branch M_sl1
M_sle1:
    s_mov_b32 s56, 0
M_sl2:
    s_cmp_lt_u32 s56, s34
    s_cbranch_scc0 M_sle2
    s_add_u32 s57, s46, s56
    s_cmp_lt_u32 s57, 5
    s_cbranch_scc0 M_slg2
    s_mul_i32 s57, s57, 544
    s_add_u32 s57, s57, s54
    v_add_u32 v252, s57, v55
    v_add_u32 v253, s57, v54
    ds_read_b64 v[224:225], v252
    ds_read_b64 v[226:227], v253
    s_waitcnt lgkmcnt(0)
    s_branch M_slc2
M_slg2:
    s_add_u32 s57, s56, 32
    s_mul_i32 s57, s57, 544
    s_add_u32 s57, s57, s55
    buffer_load_dwordx2 v[224:225], v55, s[16:19], s57 offen sc1
    buffer_load_dwordx2 v[226:227], v54, s[16:19], s57 offen sc1
    s_waitcnt vmcnt(0)
M_slc2:
    v_xad_u32 v224, v224, v3, v4
    v_xad_u32 v225, v225, v3, v4
    ds_read2st64_b32 v[232:233], v224 offset0:0 offset1:72
    ds_read2st64_b32 v[234:235], v225 offset0:0 offset1:72
    s_add_u32 s56, s56, 1
    s_nop 7
    s_waitcnt lgkmcnt(0)
    v_smfmac_f32_16x16x32_bf16 v[132:135], v[226:227], v[232:235], v10
    v_smfmac_f32_16x16x32_bf16 v[168:171], v[226:227], v[232:235], v10 abid:2
    s_branch M_sl2
M_sle2:
    s_mov_b32 s56, 0
M_sl3:
    s_cmp_lt_u32 s56, s35
    s_cbranch_scc0 M_sle3
    s_add_u32 s57, s47, s56
    s_cmp_lt_u32 s57, 5
    s_cbranch_scc0 M_slg3
    s_mul_i32 s57, s57, 544
    s_add_u32 s57, s57, s54
    v_add_u32 v252, s57, v55
    v_add_u32 v253, s57, v54
    ds_read_b64 v[224:225], v252
    ds_read_b64 v[226:227], v253
    s_waitcnt lgkmcnt(0)
    s_branch M_slc3
M_slg3:
    s_add_u32 s57, s56, 48
    s_mul_i32 s57, s57, 544
    s_add_u32 s57, s57, s55
    buffer_load_dwordx2 v[224:225], v55, s[16:19], s57 offen sc1
    buffer_load_dwordx2 v[226:227], v54, s[16:19], s57 offen sc1
    s_waitcnt vmcnt(0)
M_slc3:
    v_xad_u32 v224, v224, v3, v4
    v_xad_u32 v225, v225, v3, v4
    ds_read2st64_b32 v[232:233], v224 offset0:0 offset1:72
    ds_read2st64_b32 v[234:235], v225 offset0:0 offset1:72
    s_add_u32 s56, s56, 1
    s_nop 7
    s_waitcnt lgkmcnt(0)
    v_smfmac_f32_16x16x32_bf16 v[136:139], v[226:227], v[232:235], v10
    v_smfmac_f32_16x16x32_bf16 v[172:175], v[226:227], v[232:235], v10 abid:2
    s_branch M_sl3
M_sle3:
    s_mov_b32 s56, 0
M_sl4:
    s_cmp_lt_u32 s56, s36
    s_cbranch_scc0 M_sle4
    s_add_u32 s57, s48, s56
    s_cmp_lt_u32 s57, 5
    s_cbranch_scc0 M_slg4
    s_mul_i32 s57, s57, 544
    s_add_u32 s57, s57, s54
    v_add_u32 v252, s57, v55
    v_add_u32 v253, s57, v54
    ds_read_b64 v[224:225], v252
    ds_read_b64 v[226:227], v253
    s_waitcnt lgkmcnt(0)
    s_branch M_slc4
M_slg4:
    s_add_u32 s57, s56, 64
    s_mul_i32 s57, s57, 544
    s_add_u32 s57, s57, s55
    buffer_load_dwordx2 v[224:225], v55, s[16:19], s57 offen sc1
    buffer_load_dwordx2 v[226:227], v54, s[16:19], s57 offen sc1
    s_waitcnt vmcnt(0)
M_slc4:
    v_xad_u32 v224, v224, v3, v4
    v_xad_u32 v225, v225, v3, v4
    ds_read2st64_b32 v[232:233], v224 offset0:0 offset1:72
    ds_read2st64_b32 v[234:235], v225 offset0:0 offset1:72
    s_add_u32 s56, s56, 1
    s_nop 7
    s_waitcnt lgkmcnt(0)
    v_smfmac_f32_16x16x32_bf16 v[140:143], v[226:227], v[232:235], v10
    v_smfmac_f32_16x16x32_bf16 v[176:179], v[226:227], v[232:235], v10 abid:2
    s_branch M_sl4
M_sle4:
    s_mov_b32 s56, 0
M_sl5:
    s_cmp_lt_u32 s56, s37
    s_cbranch_scc0 M_sle5
    s_add_u32 s57, s49, s56
    s_cmp_lt_u32 s57, 5
    s_cbranch_scc0 M_slg5
    s_mul_i32 s57, s57, 544
    s_add_u32 s57, s57, s54
    v_add_u32 v252, s57, v55
    v_add_u32 v253, s57, v54
    ds_read_b64 v[224:225], v252
    ds_read_b64 v[226:227], v253
    s_waitcnt lgkmcnt(0)
    s_branch M_slc5
M_slg5:
    s_add_u32 s57, s56, 80
    s_mul_i32 s57, s57, 544
    s_add_u32 s57, s57, s55
    buffer_load_dwordx2 v[224:225], v55, s[16:19], s57 offen sc1
    buffer_load_dwordx2 v[226:227], v54, s[16:19], s57 offen sc1
    s_waitcnt vmcnt(0)
M_slc5:
    v_xad_u32 v224, v224, v3, v4
    v_xad_u32 v225, v225, v3, v4
    ds_read2st64_b32 v[232:233], v224 offset0:0 offset1:72
    ds_read2st64_b32 v[234:235], v225 offset0:0 offset1:72
    s_add_u32 s56, s56, 1
    s_nop 7
    s_waitcnt lgkmcnt(0)
    v_smfmac_f32_16x16x32_bf16 v[144:147], v[226:227], v[232:235], v10
    v_smfmac_f32_16x16x32_bf16 v[180:183], v[226:227], v[232:235], v10 abid:2
    s_branch M_sl5
M_sle5:
    s_mov_b32 s56, 0
M_sl6:
    s_cmp_lt_u32 s56, s38
    s_cbranch_scc0 M_sle6
    s_add_u32 s57, s50, s56
    s_cmp_lt_u32 s57, 5
    s_cbranch_scc0 M_slg6
    s_mul_i32 s57, s57, 544
    s_add_u32 s57, s57, s54
    v_add_u32 v252, s57, v55
    v_add_u32 v253, s57, v54
    ds_read_b64 v[224:225], v252
    ds_read_b64 v[226:227], v253
    s_waitcnt lgkmcnt(0)
    s_branch M_slc6
M_slg6:
    s_add_u32 s57, s56, 96
    s_mul_i32 s57, s57, 544
    s_add_u32 s57, s57, s55
    buffer_load_dwordx2 v[224:225], v55, s[16:19], s57 offen sc1
    buffer_load_dwordx2 v[226:227], v54, s[16:19], s57 offen sc1
    s_waitcnt vmcnt(0)
M_slc6:
    v_xad_u32 v224, v224, v3, v4
    v_xad_u32 v225, v225, v3, v4
    ds_read2st64_b32 v[232:233], v224 offset0:0 offset1:72
    ds_read2st64_b32 v[234:235], v225 offset0:0 offset1:72
    s_add_u32 s56, s56, 1
    s_nop 7
    s_waitcnt lgkmcnt(0)
    v_smfmac_f32_16x16x32_bf16 v[148:151], v[226:227], v[232:235], v10
    v_smfmac_f32_16x16x32_bf16 v[184:187], v[226:227], v[232:235], v10 abid:2
    s_branch M_sl6
M_sle6:
    s_mov_b32 s56, 0
M_sl7:
    s_cmp_lt_u32 s56, s39
    s_cbranch_scc0 M_sle7
    s_add_u32 s57, s51, s56
    s_cmp_lt_u32 s57, 5
    s_cbranch_scc0 M_slg7
    s_mul_i32 s57, s57, 544
    s_add_u32 s57, s57, s54
    v_add_u32 v252, s57, v55
    v_add_u32 v253, s57, v54
    ds_read_b64 v[224:225], v252
    ds_read_b64 v[226:227], v253
    s_waitcnt lgkmcnt(0)
    s_branch M_slc7
M_slg7:
    s_add_u32 s57, s56, 112
    s_mul_i32 s57, s57, 544
    s_add_u32 s57, s57, s55
    buffer_load_dwordx2 v[224:225], v55, s[16:19], s57 offen sc1
    buffer_load_dwordx2 v[226:227], v54, s[16:19], s57 offen sc1
    s_waitcnt vmcnt(0)
M_slc7:
    v_xad_u32 v224, v224, v3, v4
    v_xad_u32 v225, v225, v3, v4
    ds_read2st64_b32 v[232:233], v224 offset0:0 offset1:72
    ds_read2st64_b32 v[234:235], v225 offset0:0 offset1:72
    s_add_u32 s56, s56, 1
    s_nop 7
    s_waitcnt lgkmcnt(0)
    v_smfmac_f32_16x16x32_bf16 v[152:155], v[226:227], v[232:235], v10
    v_smfmac_f32_16x16x32_bf16 v[188:191], v[226:227], v[232:235], v10 abid:2
    s_branch M_sl7
M_sle7:
    s_mov_b32 s56, 0
M_sl8:
    s_cmp_lt_u32 s56, s40
    s_cbranch_scc0 M_sle8
    s_add_u32 s57, s52, s56
    s_cmp_lt_u32 s57, 5
    s_cbranch_scc0 M_slg8
    s_mul_i32 s57, s57, 544
    s_add_u32 s57, s57, s54
    v_add_u32 v252, s57, v55
    v_add_u32 v253, s57, v54
    ds_read_b64 v[224:225], v252
    ds_read_b64 v[226:227], v253
    s_waitcnt lgkmcnt(0)
    s_branch M_slc8
M_slg8:
    s_add_u32 s57, s56, 128
    s_mul_i32 s57, s57, 544
    s_add_u32 s57, s57, s55
    buffer_load_dwordx2 v[224:225], v55, s[16:19], s57 offen sc1
    buffer_load_dwordx2 v[226:227], v54, s[16:19], s57 offen sc1
    s_waitcnt vmcnt(0)
M_slc8:
    v_xad_u32 v224, v224, v3, v4
    v_xad_u32 v225, v225, v3, v4
    ds_read2st64_b32 v[232:233], v224 offset0:0 offset1:72
    ds_read2st64_b32 v[234:235], v225 offset0:0 offset1:72
    s_add_u32 s56, s56, 1
    s_nop 7
    s_waitcnt lgkmcnt(0)
    v_smfmac_f32_16x16x32_bf16 v[156:159], v[226:227], v[232:235], v10
    v_smfmac_f32_16x16x32_bf16 v[192:195], v[226:227], v[232:235], v10 abid:2
    s_branch M_sl8
M_sle8:
    s_nop 7
    s_cmp_eq_u32 s21, 0
    s_cbranch_scc1 M_slowr0
    s_branch M_slowr
F_task:
    s_mul_i32 s30, s2, 49
    s_lshr_b32 s30, s30, 10
    s_mul_i32 s31, s30, 21
    s_sub_u32 s35, s2, s31
    s_lshl_b32 s35, s35, 2
    s_add_u32 s35, s35, s20
    s_min_u32 s35, s35, 80
    s_mul_i32 s32, s35, 57
    s_lshr_b32 s32, s32, 9
    s_mul_i32 s31, s32, 9
    s_sub_u32 s31, s35, s31
    s_lshr_b32 s33, s31, 1
    s_lshl_b32 s33, s33, 5
    s_and_b32 s34, s31, 1
    s_lshl_b32 s34, s34, 2
    s_add_u32 s33, s33, s34
    s_lshl_b32 s34, s30, 7
    s_add_u32 s33, s33, s34
    s_lshl_b32 s34, s30, 4
    s_add_u32 s34, s34, 512
    s_cmp_lt_u32 s31, 8
    s_cselect_b32 s33, s33, s34
    s_cselect_b32 s34, 3, 2
    v_lshrrev_b32 v15, 2, v14
    v_lshlrev_b32 v15, s34, v15
    v_and_b32 v16, 3, v14
    v_add3_u32 v15, v15, v16, s33
    v_lshlrev_b32 v15, 1, v15
    v_mul_u32_u24 v16, 18432, v13
    v_add_u32 v15, v15, v16
    s_mul_i32 s36, s32, 73728
    s_add_u32 s37, s36, 4608
    s_add_u32 s38, s36, 9216
    s_add_u32 s39, s36, 13824
    s_waitcnt lgkmcnt(0)
    s_mov_b32 s4, s74
    s_mov_b32 s5, s75
    buffer_load_ushort v16, v15, s[4:7], s36 offen offset:0
    buffer_load_ushort v17, v15, s[4:7], s36 offen offset:1152
    buffer_load_ushort v18, v15, s[4:7], s36 offen offset:2304
    buffer_load_ushort v19, v15, s[4:7], s36 offen offset:3456
    buffer_load_ushort v20, v15, s[4:7], s37 offen offset:0
    buffer_load_ushort v21, v15, s[4:7], s37 offen offset:1152
    buffer_load_ushort v22, v15, s[4:7], s37 offen offset:2304
    buffer_load_ushort v23, v15, s[4:7], s37 offen offset:3456
    buffer_load_ushort v24, v15, s[4:7], s38 offen offset:0
    buffer_load_ushort v25, v15, s[4:7], s38 offen offset:1152
    buffer_load_ushort v26, v15, s[4:7], s38 offen offset:2304
    buffer_load_ushort v27, v15, s[4:7], s38 offen offset:3456
    buffer_load_ushort v28, v15, s[4:7], s39 offen offset:0
    buffer_load_ushort v29, v15, s[4:7], s39 offen offset:1152
    buffer_load_ushort v30, v15, s[4:7], s39 offen offset:2304
    buffer_load_ushort v31, v15, s[4:7], s39 offen offset:3456
    s_mov_b32 s16, s82
    s_mov_b32 s17, s83
    s_mov_b32 s68, s80
    s_mov_b32 s69, s81
    s_mov_b32 s36, 3437096686
    s_mov_b32 s37, 1150609561
    s_mov_b32 s38, 0x0202
    v_mov_b32 v41, 0x01000100
    v_mov_b32 v40, 0
    s_mul_i32 s39, s30, 81
    s_add_u32 s39, s39, s35
    s_lshl_b32 s39, s39, 10
    s_lshl_b32 s40, s2, 9
    s_add_u32 s40, s40, 331776
    s_lshl_b32 s33, s20, 1
    v_add_u32 v42, s33, v54
    s_mov_b32 s41, 3
    s_waitcnt vmcnt(12)
    v_and_b32 v44, 0x7fff, v16
    v_and_b32 v45, 0x7fff, v17
    v_and_b32 v46, 0x7fff, v18
    v_and_b32 v47, 0x7fff, v19
    v_max_u32 v48, v44, v45
    v_min_u32 v49, v44, v45
    v_max_u32 v50, v46, v47
    v_min_u32 v51, v46, v47
    v_min_u32 v48, v48, v50
    v_max3_u32 v48, v48, v49, v51
    v_max_u32 v48, 1, v48
    v_sub_u32 v47, v47, v48
    v_sub_u32 v46, v46, v48
    v_sub_u32 v45, v45, v48
    v_sub_u32 v44, v44, v48
    v_lshrrev_b32 v49, 31, v47
    v_alignbit_b32 v49, v49, v46, 31
    v_alignbit_b32 v49, v49, v45, 31
    v_alignbit_b32 v49, v49, v44, 31
    v_lshlrev_b32 v50, 2, v49
    v_lshrrev_b64 v[52:53], v50, s[36:37]
    v_lshl_or_b32 v44, v17, 16, v16
    v_lshl_or_b32 v45, v19, 16, v18
    v_and_b32 v46, 3, v52
    v_bfe_u32 v47, v52, 2, 2
    v_and_b32 v52, 15, v52
    v_lshl_or_b32 v46, v47, 16, v46
    v_lshl_or_b32 v40, v52, 0, v40
    v_mad_u32_u24 v46, v46, s38, v41
    v_perm_b32 v32, v45, v44, v46
    s_waitcnt vmcnt(8)
    v_and_b32 v44, 0x7fff, v20
    v_and_b32 v45, 0x7fff, v21
    v_and_b32 v46, 0x7fff, v22
    v_and_b32 v47, 0x7fff, v23
    v_max_u32 v48, v44, v45
    v_min_u32 v49, v44, v45
    v_max_u32 v50, v46, v47
    v_min_u32 v51, v46, v47
    v_min_u32 v48, v48, v50
    v_max3_u32 v48, v48, v49, v51
    v_max_u32 v48, 1, v48
    v_sub_u32 v47, v47, v48
    v_sub_u32 v46, v46, v48
    v_sub_u32 v45, v45, v48
    v_sub_u32 v44, v44, v48
    v_lshrrev_b32 v49, 31, v47
    v_alignbit_b32 v49, v49, v46, 31
    v_alignbit_b32 v49, v49, v45, 31
    v_alignbit_b32 v49, v49, v44, 31
    v_lshlrev_b32 v50, 2, v49
    v_lshrrev_b64 v[52:53], v50, s[36:37]
    v_lshl_or_b32 v44, v21, 16, v20
    v_lshl_or_b32 v45, v23, 16, v22
    v_and_b32 v46, 3, v52
    v_bfe_u32 v47, v52, 2, 2
    v_and_b32 v52, 15, v52
    v_lshl_or_b32 v46, v47, 16, v46
    v_lshl_or_b32 v40, v52, 4, v40
    v_mad_u32_u24 v46, v46, s38, v41
    v_perm_b32 v33, v45, v44, v46
    s_waitcnt vmcnt(4)
    v_and_b32 v44, 0x7fff, v24
    v_and_b32 v45, 0x7fff, v25
    v_and_b32 v46, 0x7fff, v26
    v_and_b32 v47, 0x7fff, v27
    v_max_u32 v48, v44, v45
    v_min_u32 v49, v44, v45
    v_max_u32 v50, v46, v47
    v_min_u32 v51, v46, v47
    v_min_u32 v48, v48, v50
    v_max3_u32 v48, v48, v49, v51
    v_max_u32 v48, 1, v48
    v_sub_u32 v47, v47, v48
    v_sub_u32 v46, v46, v48
    v_sub_u32 v45, v45, v48
    v_sub_u32 v44, v44, v48
    v_lshrrev_b32 v49, 31, v47
    v_alignbit_b32 v49, v49, v46, 31
    v_alignbit_b32 v49, v49, v45, 31
    v_alignbit_b32 v49, v49, v44, 31
    v_lshlrev_b32 v50, 2, v49
    v_lshrrev_b64 v[52:53], v50, s[36:37]
    v_lshl_or_b32 v44, v25, 16, v24
    v_lshl_or_b32 v45, v27, 16, v26
    v_and_b32 v46, 3, v52
    v_bfe_u32 v47, v52, 2, 2
    v_and_b32 v52, 15, v52
    v_lshl_or_b32 v46, v47, 16, v46
    v_lshl_or_b32 v40, v52, 8, v40
    v_mad_u32_u24 v46, v46, s38, v41
    v_perm_b32 v34, v45, v44, v46
    s_waitcnt vmcnt(0)
    v_and_b32 v44, 0x7fff, v28
    v_and_b32 v45, 0x7fff, v29
    v_and_b32 v46, 0x7fff, v30
    v_and_b32 v47, 0x7fff, v31
    v_max_u32 v48, v44, v45
    v_min_u32 v49, v44, v45
    v_max_u32 v50, v46, v47
    v_min_u32 v51, v46, v47
    v_min_u32 v48, v48, v50
    v_max3_u32 v48, v48, v49, v51
    v_max_u32 v48, 1, v48
    v_sub_u32 v47, v47, v48
    v_sub_u32 v46, v46, v48
    v_sub_u32 v45, v45, v48
    v_sub_u32 v44, v44, v48
    v_lshrrev_b32 v49, 31, v47
    v_alignbit_b32 v49, v49, v46, 31
    v_alignbit_b32 v49, v49, v45, 31
    v_alignbit_b32 v49, v49, v44, 31
    v_lshlrev_b32 v50, 2, v49
    v_lshrrev_b64 v[52:53], v50, s[36:37]
    v_lshl_or_b32 v44, v29, 16, v28
    v_lshl_or_b32 v45, v31, 16, v30
    v_and_b32 v46, 3, v52
    v_bfe_u32 v47, v52, 2, 2
    v_and_b32 v52, 15, v52
    v_lshl_or_b32 v46, v47, 16, v46
    v_lshl_or_b32 v40, v52, 12, v40
    v_mad_u32_u24 v46, v46, s38, v41
    v_perm_b32 v35, v45, v44, v46
    ds_write_b16 v42, v40
    buffer_store_dwordx4 v[32:35], v11, s[16:19], s39 offen sc1
    s_waitcnt lgkmcnt(0)
    s_barrier
    s_cmp_lg_u32 s20, 0
    s_cbranch_scc1 F_sig
    s_mov_b32 exec_hi, 0
    ds_read_b128 v[36:39], v11
    s_waitcnt lgkmcnt(0)
    buffer_store_dwordx4 v[36:39], v11, s[16:19], s40 offen sc1
    s_mov_b64 exec, -1
F_sig:
    s_waitcnt vmcnt(0)
    s_barrier
    s_cmp_lg_u32 s20, 0
    s_cbranch_scc1 F_done
    v_mov_b32 v16, 1
    v_mov_b32 v17, 1
    s_mov_b64 exec, 1
    buffer_atomic_add v16, off, s[68:71], 0 offset:0 sc0 sc1
    s_waitcnt vmcnt(0)
    v_cmp_eq_u32 vcc, 83, v16
    s_and_b64 exec, exec, vcc
    s_cbranch_execz F_nf
    buffer_store_dword v17, off, s[68:71], 0 offset:128 sc1
F_nf:
    s_mov_b64 exec, -1
F_done:
    s_barrier
    s_branch M_x
C_task:
    s_sub_u32 s35, s2, 84
    s_mul_i32 s30, s35, 57
    s_lshr_b32 s30, s30, 9
    s_mul_i32 s31, s30, 9
    s_sub_u32 s31, s35, s31
    s_lshr_b32 s33, s31, 1
    s_lshl_b32 s33, s33, 5
    s_and_b32 s34, s31, 1
    s_lshl_b32 s34, s34, 2
    s_add_u32 s33, s33, s34
    s_lshl_b32 s34, s30, 7
    s_add_u32 s33, s33, s34
    s_lshl_b32 s34, s30, 4
    s_add_u32 s34, s34, 512
    s_cmp_lt_u32 s31, 8
    s_cselect_b32 s33, s33, s34
    s_cselect_b32 s34, 3, 2
    v_lshrrev_b32 v15, 2, v14
    v_lshlrev_b32 v15, s34, v15
    v_and_b32 v16, 3, v14
    v_add3_u32 v15, v15, v16, s33
    v_lshlrev_b32 v15, 1, v15
    v_lshrrev_b32 v17, 4, v0
    v_mul_u32_u24 v16, 4608, v17
    v_add_u32 v15, v15, v16
    s_mov_b32 s36, 0
    s_waitcnt lgkmcnt(0)
    s_mov_b32 s4, s74
    s_mov_b32 s5, s75
    buffer_load_ushort v60, v15, s[4:7], s36 offen offset:0
    buffer_load_ushort v61, v15, s[4:7], s36 offen offset:1152
    buffer_load_ushort v62, v15, s[4:7], s36 offen offset:2304
    buffer_load_ushort v63, v15, s[4:7], s36 offen offset:3456
    s_add_u32 s36, s36, 73728
    buffer_load_ushort v64, v15, s[4:7], s36 offen offset:0
    buffer_load_ushort v65, v15, s[4:7], s36 offen offset:1152
    buffer_load_ushort v66, v15, s[4:7], s36 offen offset:2304
    buffer_load_ushort v67, v15, s[4:7], s36 offen offset:3456
    s_add_u32 s36, s36, 73728
    buffer_load_ushort v68, v15, s[4:7], s36 offen offset:0
    buffer_load_ushort v69, v15, s[4:7], s36 offen offset:1152
    buffer_load_ushort v70, v15, s[4:7], s36 offen offset:2304
    buffer_load_ushort v71, v15, s[4:7], s36 offen offset:3456
    s_add_u32 s36, s36, 73728
    buffer_load_ushort v72, v15, s[4:7], s36 offen offset:0
    buffer_load_ushort v73, v15, s[4:7], s36 offen offset:1152
    buffer_load_ushort v74, v15, s[4:7], s36 offen offset:2304
    buffer_load_ushort v75, v15, s[4:7], s36 offen offset:3456
    s_add_u32 s36, s36, 73728
    buffer_load_ushort v76, v15, s[4:7], s36 offen offset:0
    buffer_load_ushort v77, v15, s[4:7], s36 offen offset:1152
    buffer_load_ushort v78, v15, s[4:7], s36 offen offset:2304
    buffer_load_ushort v79, v15, s[4:7], s36 offen offset:3456
    s_add_u32 s36, s36, 73728
    buffer_load_ushort v80, v15, s[4:7], s36 offen offset:0
    buffer_load_ushort v81, v15, s[4:7], s36 offen offset:1152
    buffer_load_ushort v82, v15, s[4:7], s36 offen offset:2304
    buffer_load_ushort v83, v15, s[4:7], s36 offen offset:3456
    s_add_u32 s36, s36, 73728
    buffer_load_ushort v84, v15, s[4:7], s36 offen offset:0
    buffer_load_ushort v85, v15, s[4:7], s36 offen offset:1152
    buffer_load_ushort v86, v15, s[4:7], s36 offen offset:2304
    buffer_load_ushort v87, v15, s[4:7], s36 offen offset:3456
    s_add_u32 s36, s36, 73728
    buffer_load_ushort v88, v15, s[4:7], s36 offen offset:0
    buffer_load_ushort v89, v15, s[4:7], s36 offen offset:1152
    buffer_load_ushort v90, v15, s[4:7], s36 offen offset:2304
    buffer_load_ushort v91, v15, s[4:7], s36 offen offset:3456
    s_add_u32 s36, s36, 73728
    buffer_load_ushort v92, v15, s[4:7], s36 offen offset:0
    buffer_load_ushort v93, v15, s[4:7], s36 offen offset:1152
    buffer_load_ushort v94, v15, s[4:7], s36 offen offset:2304
    buffer_load_ushort v95, v15, s[4:7], s36 offen offset:3456
    s_mov_b32 s16, s82
    s_mov_b32 s17, s83
    s_mov_b32 s68, s80
    s_mov_b32 s69, s81
    s_mov_b32 s41, 2
    v_lshlrev_b32 v18, 2, v0
    v_mov_b32 v19, 0
    ds_write_b32 v18, v19 offset:9216
    ds_write_b32 v18, v19 offset:9728
    v_mov_b32 v19, 144
    v_lshlrev_b32 v20, 1, v0
    v_and_b32 v20, 8, v20
    s_cmp_eq_u32 s20, 3
    s_cbranch_scc1 C_a
    ds_write_b32 v18, v19 offset:10752
    ds_write_b32 v18, v20 offset:11520
C_a:
    s_mov_b32 s37, 65819
    s_mov_b32 s38, 0xffff
    v_lshlrev_b32 v17, 2, v17
    s_waitcnt lgkmcnt(0)
    s_barrier
    s_waitcnt vmcnt(32)
    v_and_b32 v44, 0x7fff, v60
    v_and_b32 v45, 0x7fff, v61
    v_and_b32 v46, 0x7fff, v62
    v_and_b32 v47, 0x7fff, v63
    v_max_u32 v48, v44, v45
    v_min_u32 v49, v44, v45
    v_max_u32 v50, v46, v47
    v_min_u32 v51, v46, v47
    v_min_u32 v48, v48, v50
    v_max3_u32 v48, v48, v49, v51
    v_max_u32 v48, 1, v48
    v_sub_u32 v47, v47, v48
    v_sub_u32 v46, v46, v48
    v_sub_u32 v45, v45, v48
    v_sub_u32 v44, v44, v48
    v_lshrrev_b32 v49, 31, v47
    v_alignbit_b32 v49, v49, v46, 31
    v_alignbit_b32 v49, v49, v45, 31
    v_alignbit_b32 v49, v49, v44, 31
    v_lshlrev_b32 v50, 1, v49
    v_lshrrev_b32 v50, v50, s37
    v_lshl_or_b32 v44, v61, 16, v60
    v_and_b32 v46, 1, v50
    v_bfe_u32 v47, v50, 1, 1
    v_lshl_or_b32 v46, v47, 16, v46
    v_mul_u32_u24 v46, s38, v46
    v_and_b32 v44, v44, v46
    ds_write_b32 v18, v44 offset:0
    ds_or_b32 v17, v44 offset:9728
    s_waitcnt vmcnt(28)
    v_and_b32 v44, 0x7fff, v64
    v_and_b32 v45, 0x7fff, v65
    v_and_b32 v46, 0x7fff, v66
    v_and_b32 v47, 0x7fff, v67
    v_max_u32 v48, v44, v45
    v_min_u32 v49, v44, v45
    v_max_u32 v50, v46, v47
    v_min_u32 v51, v46, v47
    v_min_u32 v48, v48, v50
    v_max3_u32 v48, v48, v49, v51
    v_max_u32 v48, 1, v48
    v_sub_u32 v47, v47, v48
    v_sub_u32 v46, v46, v48
    v_sub_u32 v45, v45, v48
    v_sub_u32 v44, v44, v48
    v_lshrrev_b32 v49, 31, v47
    v_alignbit_b32 v49, v49, v46, 31
    v_alignbit_b32 v49, v49, v45, 31
    v_alignbit_b32 v49, v49, v44, 31
    v_lshlrev_b32 v50, 1, v49
    v_lshrrev_b32 v50, v50, s37
    v_lshl_or_b32 v44, v65, 16, v64
    v_and_b32 v46, 1, v50
    v_bfe_u32 v47, v50, 1, 1
    v_lshl_or_b32 v46, v47, 16, v46
    v_mul_u32_u24 v46, s38, v46
    v_and_b32 v44, v44, v46
    ds_write_b32 v18, v44 offset:1024
    ds_or_b32 v17, v44 offset:9792
    s_waitcnt vmcnt(24)
    v_and_b32 v44, 0x7fff, v68
    v_and_b32 v45, 0x7fff, v69
    v_and_b32 v46, 0x7fff, v70
    v_and_b32 v47, 0x7fff, v71
    v_max_u32 v48, v44, v45
    v_min_u32 v49, v44, v45
    v_max_u32 v50, v46, v47
    v_min_u32 v51, v46, v47
    v_min_u32 v48, v48, v50
    v_max3_u32 v48, v48, v49, v51
    v_max_u32 v48, 1, v48
    v_sub_u32 v47, v47, v48
    v_sub_u32 v46, v46, v48
    v_sub_u32 v45, v45, v48
    v_sub_u32 v44, v44, v48
    v_lshrrev_b32 v49, 31, v47
    v_alignbit_b32 v49, v49, v46, 31
    v_alignbit_b32 v49, v49, v45, 31
    v_alignbit_b32 v49, v49, v44, 31
    v_lshlrev_b32 v50, 1, v49
    v_lshrrev_b32 v50, v50, s37
    v_lshl_or_b32 v44, v69, 16, v68
    v_and_b32 v46, 1, v50
    v_bfe_u32 v47, v50, 1, 1
    v_lshl_or_b32 v46, v47, 16, v46
    v_mul_u32_u24 v46, s38, v46
    v_and_b32 v44, v44, v46
    ds_write_b32 v18, v44 offset:2048
    ds_or_b32 v17, v44 offset:9856
    s_waitcnt vmcnt(20)
    v_and_b32 v44, 0x7fff, v72
    v_and_b32 v45, 0x7fff, v73
    v_and_b32 v46, 0x7fff, v74
    v_and_b32 v47, 0x7fff, v75
    v_max_u32 v48, v44, v45
    v_min_u32 v49, v44, v45
    v_max_u32 v50, v46, v47
    v_min_u32 v51, v46, v47
    v_min_u32 v48, v48, v50
    v_max3_u32 v48, v48, v49, v51
    v_max_u32 v48, 1, v48
    v_sub_u32 v47, v47, v48
    v_sub_u32 v46, v46, v48
    v_sub_u32 v45, v45, v48
    v_sub_u32 v44, v44, v48
    v_lshrrev_b32 v49, 31, v47
    v_alignbit_b32 v49, v49, v46, 31
    v_alignbit_b32 v49, v49, v45, 31
    v_alignbit_b32 v49, v49, v44, 31
    v_lshlrev_b32 v50, 1, v49
    v_lshrrev_b32 v50, v50, s37
    v_lshl_or_b32 v44, v73, 16, v72
    v_and_b32 v46, 1, v50
    v_bfe_u32 v47, v50, 1, 1
    v_lshl_or_b32 v46, v47, 16, v46
    v_mul_u32_u24 v46, s38, v46
    v_and_b32 v44, v44, v46
    ds_write_b32 v18, v44 offset:3072
    ds_or_b32 v17, v44 offset:9920
    s_waitcnt vmcnt(16)
    v_and_b32 v44, 0x7fff, v76
    v_and_b32 v45, 0x7fff, v77
    v_and_b32 v46, 0x7fff, v78
    v_and_b32 v47, 0x7fff, v79
    v_max_u32 v48, v44, v45
    v_min_u32 v49, v44, v45
    v_max_u32 v50, v46, v47
    v_min_u32 v51, v46, v47
    v_min_u32 v48, v48, v50
    v_max3_u32 v48, v48, v49, v51
    v_max_u32 v48, 1, v48
    v_sub_u32 v47, v47, v48
    v_sub_u32 v46, v46, v48
    v_sub_u32 v45, v45, v48
    v_sub_u32 v44, v44, v48
    v_lshrrev_b32 v49, 31, v47
    v_alignbit_b32 v49, v49, v46, 31
    v_alignbit_b32 v49, v49, v45, 31
    v_alignbit_b32 v49, v49, v44, 31
    v_lshlrev_b32 v50, 1, v49
    v_lshrrev_b32 v50, v50, s37
    v_lshl_or_b32 v44, v77, 16, v76
    v_and_b32 v46, 1, v50
    v_bfe_u32 v47, v50, 1, 1
    v_lshl_or_b32 v46, v47, 16, v46
    v_mul_u32_u24 v46, s38, v46
    v_and_b32 v44, v44, v46
    ds_write_b32 v18, v44 offset:4096
    ds_or_b32 v17, v44 offset:9984
    s_waitcnt vmcnt(12)
    v_and_b32 v44, 0x7fff, v80
    v_and_b32 v45, 0x7fff, v81
    v_and_b32 v46, 0x7fff, v82
    v_and_b32 v47, 0x7fff, v83
    v_max_u32 v48, v44, v45
    v_min_u32 v49, v44, v45
    v_max_u32 v50, v46, v47
    v_min_u32 v51, v46, v47
    v_min_u32 v48, v48, v50
    v_max3_u32 v48, v48, v49, v51
    v_max_u32 v48, 1, v48
    v_sub_u32 v47, v47, v48
    v_sub_u32 v46, v46, v48
    v_sub_u32 v45, v45, v48
    v_sub_u32 v44, v44, v48
    v_lshrrev_b32 v49, 31, v47
    v_alignbit_b32 v49, v49, v46, 31
    v_alignbit_b32 v49, v49, v45, 31
    v_alignbit_b32 v49, v49, v44, 31
    v_lshlrev_b32 v50, 1, v49
    v_lshrrev_b32 v50, v50, s37
    v_lshl_or_b32 v44, v81, 16, v80
    v_and_b32 v46, 1, v50
    v_bfe_u32 v47, v50, 1, 1
    v_lshl_or_b32 v46, v47, 16, v46
    v_mul_u32_u24 v46, s38, v46
    v_and_b32 v44, v44, v46
    ds_write_b32 v18, v44 offset:5120
    ds_or_b32 v17, v44 offset:10048
    s_waitcnt vmcnt(8)
    v_and_b32 v44, 0x7fff, v84
    v_and_b32 v45, 0x7fff, v85
    v_and_b32 v46, 0x7fff, v86
    v_and_b32 v47, 0x7fff, v87
    v_max_u32 v48, v44, v45
    v_min_u32 v49, v44, v45
    v_max_u32 v50, v46, v47
    v_min_u32 v51, v46, v47
    v_min_u32 v48, v48, v50
    v_max3_u32 v48, v48, v49, v51
    v_max_u32 v48, 1, v48
    v_sub_u32 v47, v47, v48
    v_sub_u32 v46, v46, v48
    v_sub_u32 v45, v45, v48
    v_sub_u32 v44, v44, v48
    v_lshrrev_b32 v49, 31, v47
    v_alignbit_b32 v49, v49, v46, 31
    v_alignbit_b32 v49, v49, v45, 31
    v_alignbit_b32 v49, v49, v44, 31
    v_lshlrev_b32 v50, 1, v49
    v_lshrrev_b32 v50, v50, s37
    v_lshl_or_b32 v44, v85, 16, v84
    v_and_b32 v46, 1, v50
    v_bfe_u32 v47, v50, 1, 1
    v_lshl_or_b32 v46, v47, 16, v46
    v_mul_u32_u24 v46, s38, v46
    v_and_b32 v44, v44, v46
    ds_write_b32 v18, v44 offset:6144
    ds_or_b32 v17, v44 offset:10112
    s_waitcnt vmcnt(4)
    v_and_b32 v44, 0x7fff, v88
    v_and_b32 v45, 0x7fff, v89
    v_and_b32 v46, 0x7fff, v90
    v_and_b32 v47, 0x7fff, v91
    v_max_u32 v48, v44, v45
    v_min_u32 v49, v44, v45
    v_max_u32 v50, v46, v47
    v_min_u32 v51, v46, v47
    v_min_u32 v48, v48, v50
    v_max3_u32 v48, v48, v49, v51
    v_max_u32 v48, 1, v48
    v_sub_u32 v47, v47, v48
    v_sub_u32 v46, v46, v48
    v_sub_u32 v45, v45, v48
    v_sub_u32 v44, v44, v48
    v_lshrrev_b32 v49, 31, v47
    v_alignbit_b32 v49, v49, v46, 31
    v_alignbit_b32 v49, v49, v45, 31
    v_alignbit_b32 v49, v49, v44, 31
    v_lshlrev_b32 v50, 1, v49
    v_lshrrev_b32 v50, v50, s37
    v_lshl_or_b32 v44, v89, 16, v88
    v_and_b32 v46, 1, v50
    v_bfe_u32 v47, v50, 1, 1
    v_lshl_or_b32 v46, v47, 16, v46
    v_mul_u32_u24 v46, s38, v46
    v_and_b32 v44, v44, v46
    ds_write_b32 v18, v44 offset:7168
    ds_or_b32 v17, v44 offset:10176
    s_waitcnt vmcnt(0)
    v_and_b32 v44, 0x7fff, v92
    v_and_b32 v45, 0x7fff, v93
    v_and_b32 v46, 0x7fff, v94
    v_and_b32 v47, 0x7fff, v95
    v_max_u32 v48, v44, v45
    v_min_u32 v49, v44, v45
    v_max_u32 v50, v46, v47
    v_min_u32 v51, v46, v47
    v_min_u32 v48, v48, v50
    v_max3_u32 v48, v48, v49, v51
    v_max_u32 v48, 1, v48
    v_sub_u32 v47, v47, v48
    v_sub_u32 v46, v46, v48
    v_sub_u32 v45, v45, v48
    v_sub_u32 v44, v44, v48
    v_lshrrev_b32 v49, 31, v47
    v_alignbit_b32 v49, v49, v46, 31
    v_alignbit_b32 v49, v49, v45, 31
    v_alignbit_b32 v49, v49, v44, 31
    v_lshlrev_b32 v50, 1, v49
    v_lshrrev_b32 v50, v50, s37
    v_lshl_or_b32 v44, v93, 16, v92
    v_and_b32 v46, 1, v50
    v_bfe_u32 v47, v50, 1, 1
    v_lshl_or_b32 v46, v47, 16, v46
    v_mul_u32_u24 v46, s38, v46
    v_and_b32 v44, v44, v46
    ds_write_b32 v18, v44 offset:8192
    ds_or_b32 v17, v44 offset:10240
    v_lshlrev_b32 v19, 2, v12
    s_waitcnt lgkmcnt(0)
    s_barrier
    ds_read_b32 v20, v19 offset:9728
    ds_read_b32 v21, v19 offset:9984
    ds_read_b32 v22, v19 offset:10240
    s_mov_b32 s56, 0x55555555
    s_mov_b32 s57, 0x55555555
    s_waitcnt lgkmcnt(0)
    v_cmp_ne_u32 s[44:45], 0, v20
    v_cmp_ne_u32 s[46:47], 0, v21
    v_cmp_ne_u32 s[48:49], 0, v22
    s_nop 3
    s_bcnt1_i32_b64 s36, s[44:45]
    s_bcnt1_i32_b64 s37, s[46:47]
    s_bcnt1_i32_b64 s38, s[48:49]
    s_add_u32 s37, s37, s36
    s_add_u32 s38, s38, s37
    s_and_b64 s[50:51], s[44:45], s[56:57]
    s_bcnt1_i32_b64 s39, s[50:51]
    s_and_b64 s[50:51], s[46:47], s[56:57]
    s_bcnt1_i32_b64 s40, s[50:51]
    s_add_u32 s40, s40, s39
    s_cmp_eq_u32 s20, 0
    s_cselect_b32 s36, 0, s36
    s_cselect_b32 s39, 0, s39
    s_cselect_b64 s[44:45], s[44:45], s[46:47]
    s_cmp_ge_u32 s20, 2
    s_cselect_b32 s36, s37, s36
    s_cselect_b32 s39, s40, s39
    s_cselect_b64 s[44:45], s[48:49], s[44:45]
    s_cmp_eq_u32 s20, 3
    s_cselect_b64 s[44:45], 0, s[44:45]
    s_and_b64 s[50:51], s[44:45], s[56:57]
    v_mov_b32 v20, s36
    v_mbcnt_lo_u32_b32 v20, s44, v20
    v_mbcnt_hi_u32_b32 v20, s45, v20
    v_mov_b32 v21, s39
    v_mbcnt_lo_u32_b32 v21, s50, v21
    v_mbcnt_hi_u32_b32 v21, s51, v21
    v_sub_u32 v22, v20, v21
    v_sub_u32 v22, 15, v22
    v_cndmask_b32 v21, v22, v21, s[56:57]
    v_sub_u32 v22, 15, v21
    v_lshrrev_b32 v23, 3, v21
    v_min_u32 v21, v21, v22
    v_and_b32 v22, 1, v21
    v_lshl_or_b32 v24, v22, 1, v23
    v_lshrrev_b32 v21, 1, v21
    v_lshl_or_b32 v25, v24, 2, v21
    v_and_b32 v26, 2, v21
    v_or_b32 v26, v26, v22
    v_and_b32 v21, 1, v21
    v_lshl_or_b32 v21, v23, 1, v21
    v_lshl_or_b32 v26, v26, 2, v21
    v_cmp_gt_u32 vcc, 16, v20
    v_lshrrev_b32 v27, 4, v0
    v_and_b32 v28, 15, v0
    v_cndmask_b32 v25, v20, v25, vcc
    v_cndmask_b32 v26, v20, v26, vcc
    v_lshlrev_b32 v25, 2, v25
    v_lshlrev_b32 v26, 2, v26
    v_lshlrev_b32 v27, 10, v27
    v_lshl_or_b32 v27, v28, 3, v27
    s_mov_b64 exec, s[44:45]
    ds_write_b32 v26, v0 offset:10752
    ds_write_b32 v25, v27 offset:11520
    s_mov_b64 exec, -1
    s_add_u32 s38, s38, 7
    s_lshr_b32 s38, s38, 3
    s_max_u32 s38, s38, 2
    s_sub_u32 s38, s38, 2
    s_mul_i32 s36, s30, 9856
    s_add_u32 s36, s36, 374784
    v_lshlrev_b32 v20, 4, v13
    v_lshlrev_b32 v21, 2, v14
    s_waitcnt lgkmcnt(0)
    s_barrier
    s_cmp_eq_u32 s20, 0
    s_cbranch_scc0 C_ov
    ds_read_b128 v[24:27], v20 offset:10752
    ds_read_b128 v[32:35], v11 offset:11520
    s_lshl_b32 s37, s31, 10
    s_add_u32 s37, s37, s36
    s_lshl_b32 s39, s31, 6
    s_add_u32 s39, s39, s36
    s_add_u32 s39, s39, 9216
    s_lshl_b32 s40, s31, 2
    s_add_u32 s40, s40, s36
    s_add_u32 s40, s40, 9792
    s_waitcnt lgkmcnt(1)
    v_lshl_add_u32 v24, v24, 6, v21
    v_lshl_add_u32 v25, v25, 6, v21
    v_lshl_add_u32 v26, v26, 6, v21
    v_lshl_add_u32 v27, v27, 6, v21
    ds_read_b32 v28, v24
    ds_read_b32 v29, v25
    ds_read_b32 v30, v26
    ds_read_b32 v31, v27
    v_mov_b32 v22, s38
    s_waitcnt lgkmcnt(0)
    buffer_store_dwordx4 v[28:31], v11, s[16:19], s37 offen sc1
    s_mov_b64 exec, 15
    buffer_store_dwordx4 v[32:35], v11, s[16:19], s39 offen sc1
    s_mov_b64 exec, 1
    buffer_store_dword v22, off, s[16:19], s40 sc1
    s_mov_b64 exec, -1
    s_branch C_sig
C_ov:
    s_sub_u32 s39, s20, 1
    v_lshlrev_b32 v20, 3, v13
C_ovl:
    s_cmp_lt_u32 s39, s38
    s_cbranch_scc0 C_sig
    s_lshl_b32 s40, s39, 5
    v_add_u32 v22, s40, v20
    v_add_u32 v23, s40, v11
    ds_read_b64 v[24:25], v22 offset:10816
    ds_read_b128 v[32:35], v23 offset:11584
    s_lshl_b32 s37, s35, 4
    s_add_u32 s37, s37, s39
    s_mul_i32 s37, s37, 544
    s_add_u32 s37, s37, 414208
    s_waitcnt lgkmcnt(1)
    v_lshl_add_u32 v24, v24, 6, v21
    v_lshl_add_u32 v25, v25, 6, v21
    ds_read_b32 v28, v24
    ds_read_b32 v29, v25
    s_waitcnt lgkmcnt(0)
    buffer_store_dwordx2 v[28:29], v54, s[16:19], s37 offen sc1
    s_mov_b64 exec, 3
    buffer_store_dwordx4 v[32:35], v11, s[16:19], s37 offen offset:512 sc1
    s_mov_b64 exec, -1
    s_add_u32 s39, s39, 3
    s_branch C_ovl
C_sig:
    s_waitcnt vmcnt(0)
    s_barrier
    s_cmp_lg_u32 s20, 0
    s_cbranch_scc1 C_done
    v_mov_b32 v16, 1
    v_mov_b32 v17, 1
    s_mov_b64 exec, 1
    buffer_atomic_add v16, off, s[68:71], 0 offset:64 sc0 sc1
    s_waitcnt vmcnt(0)
    v_cmp_eq_u32 vcc, 35, v16
    s_and_b64 exec, exec, vcc
    s_cbranch_execz C_nf
    buffer_store_dword v17, off, s[68:71], 0 offset:192 sc1
C_nf:
    s_mov_b64 exec, -1
C_done:
    s_barrier
    s_branch M_x
.section .rodata,"a"
.p2align 6
.amdhsa_kernel standalone__structured_sparse_n_m__ragged_kernel
  .amdhsa_next_free_vgpr 512
  .amdhsa_next_free_sgpr 96
  .amdhsa_accum_offset 256
  .amdhsa_group_segment_fixed_size 0
  .amdhsa_kernarg_size 48
  .amdhsa_user_sgpr_count 2
  .amdhsa_user_sgpr_kernarg_segment_ptr 1
  .amdhsa_system_sgpr_workgroup_id_x 1
  .amdhsa_float_denorm_mode_32 3
.end_amdhsa_kernel
```

```asm
; @launch grid=(256,1,1) block=(256,1,1) lds=162896
.amdgcn_target "amdgcn-amd-amdhsa--gfx950"
.text
.globl standalone__structured_sparse_n_m__ragged_kernel
.p2align 8
.type standalone__structured_sparse_n_m__ragged_kernel,@function
standalone__structured_sparse_n_m__ragged_kernel:
    s_cmp_ge_u32 s2, 256
    s_cbranch_scc1 M_end
    s_load_dwordx8 s[72:79], s[0:1], 0
    s_load_dwordx4 s[80:83], s[0:1], 32
    v_lshrrev_b32 v20, 6, v0
    v_and_b32 v12, 63, v0
    v_readfirstlane_b32 s20, v20
    v_lshrrev_b32 v13, 4, v12
    v_and_b32 v14, 15, v12
    v_lshlrev_b32 v11, 4, v12
    v_lshlrev_b32 v54, 3, v12
    s_getpc_b64 s[84:85]
    s_lshr_b32 s30, s2, 3
    s_and_b32 s30, s30, 15
    s_lshl_b32 s30, s30, 11
    s_and_b32 s84, s84, 0xffffff00
    s_mov_b32 s86, M_codeend-standalone__structured_sparse_n_m__ragged_kernel
    s_mov_b32 s87, 0x20000
    v_lshlrev_b32 v254, 3, v0
    s_mov_b32 exec_lo, 0x00010001
    s_mov_b32 exec_hi, 0x00010001
    buffer_load_dword v254, v254, s[84:87], s30 offen
    s_mov_b64 exec, -1
    s_mov_b32 s6, 663552
    s_mov_b32 s7, 0x20000
    s_mov_b32 s18, 763904
    s_mov_b32 s19, 0x20000
    s_mov_b32 s70, 256
    s_mov_b32 s71, 0x20000
    s_lshl_b32 s96, s20, 4
    s_and_b32 s97, s2, 15
    s_add_u32 s96, s96, s97
    s_lshl_b32 s96, s96, 8
    s_add_u32 s96, s96, 731136
    s_add_u32 s97, s96, 16384
    v_lshlrev_b32 v253, 14, v12
    s_mov_b32 s98, -1
    s_mov_b32 s99, 0
    v_mov_b32 v252, 0
    s_cmp_lt_u32 s2, 84
    s_cbranch_scc1 F_task
    s_cmp_lt_u32 s2, 120
    s_cbranch_scc1 C_task
    s_mov_b32 s41, 3
M_x:
    v_lshrrev_b32 v22, 3, v0
    v_mul_u32_u24 v22, 1152, v22
    v_lshrrev_b32 v23, 4, v0
    v_xor_b32 v23, v23, v0
    v_and_b32 v23, 7, v23
    v_lshl_add_u32 v5, v23, 4, v22
    s_mov_b32 s10, 75497472
    s_mov_b32 s11, 0x20000
    s_mov_b32 s86, 1152
    s_mov_b32 s87, 0x20000
    s_mul_i32 s22, s2, 36864
    s_mul_i32 s26, s20, 9216
    s_mov_b32 s24, s22
    s_mov_b32 s42, s26
    s_lshl_b32 s28, s20, 8
    s_lshl_b32 s30, s20, 5
    v_lshlrev_b32 v25, 4, v13
    v_lshlrev_b32 v26, 3, v13
    s_mov_b32 s21, 0
    s_waitcnt lgkmcnt(0)
    s_mov_b32 s8, s72
    s_mov_b32 s9, s73
    s_mov_b32 s84, s76
    s_mov_b32 s85, s77
    s_mov_b32 s68, s80
    s_mov_b32 s69, s81
    s_mov_b32 s16, s82
    s_mov_b32 s17, s83
    s_cmp_lt_u32 s2, 120
    s_cbranch_scc1 M_x1
    s_mov_b32 s16, s82
    s_mov_b32 s17, s83
    s_mov_b64 exec, 3
    buffer_load_dword v253, v253, s[16:19], s96 offen sc1
    s_mov_b64 exec, -1
M_x1:
    buffer_load_dwordx4 v[196:199], v25, s[84:87], s28 offen offset:0
    buffer_load_dwordx4 v[200:203], v25, s[84:87], s28 offen offset:64
    buffer_load_dwordx4 v[204:207], v25, s[84:87], s28 offen offset:128
    buffer_load_dwordx4 v[208:211], v25, s[84:87], s28 offen offset:192
    buffer_load_dwordx2 v[212:213], v26, s[84:87], s30 offen offset:1024
M_xl:
    s_add_u32 s21, s21, 1
    s_mov_b32 m0, s42
    s_nop 0
    buffer_load_dwordx4 v5, s[8:11], s22 offen offset:0 nt lds
    s_add_u32 m0, m0, 896
    s_nop 0
    buffer_load_dwordx4 v5, s[8:11], s22 offen offset:128 nt lds
    s_add_u32 m0, m0, 896
    s_nop 0
    buffer_load_dwordx4 v5, s[8:11], s22 offen offset:256 nt lds
    s_add_u32 m0, m0, 896
    s_nop 0
    buffer_load_dwordx4 v5, s[8:11], s22 offen offset:384 nt lds
    s_add_u32 m0, m0, 896
    s_nop 0
    buffer_load_dwordx4 v5, s[8:11], s22 offen offset:512 nt lds
    s_add_u32 m0, m0, 896
    s_nop 0
    buffer_load_dwordx4 v5, s[8:11], s22 offen offset:640 nt lds
    s_add_u32 m0, m0, 896
    s_nop 0
    buffer_load_dwordx4 v5, s[8:11], s22 offen offset:768 nt lds
    s_add_u32 m0, m0, 896
    s_nop 0
    buffer_load_dwordx4 v5, s[8:11], s22 offen offset:896 nt lds
    s_add_u32 m0, m0, 896
    s_nop 0
    buffer_load_dwordx4 v5, s[8:11], s22 offen offset:1024 nt lds
    s_cmp_lt_u32 s21, s41
    s_cbranch_scc1 M_xn
    buffer_load_dword v0, off, s[16:19], s96 sc1
M_xn:
    s_add_u32 s22, s22, 9437184
    s_add_u32 s42, s42, 36864
    s_cmp_lt_u32 s21, s41
    s_cbranch_scc1 M_xl
    s_mov_b32 s12, s78
    s_mov_b32 s13, s79
    s_mov_b32 s14, 75497472
    s_mov_b32 s15, 0x20000
    s_waitcnt vmcnt(10)
    v_readlane_b32 s100, v253, 0
    v_readlane_b32 s101, v253, 1
    v_readlane_b32 s30, v252, 0
    s_nop 0
    s_cmp_lg_u32 s30, s98
    s_cbranch_scc1 M_nf
    v_mov_b32 v22, 1
    s_mov_b64 exec, 1
    buffer_store_dword v22, off, s[68:71], s99 sc1
    s_mov_b64 exec, -1
M_nf:
    s_mul_i32 s29, s20, 13072
    s_add_u32 s29, s29, 110592
    v_lshrrev_b32 v24, 1, v14
    v_and_b32 v27, 7, v14
    v_lshlrev_b32 v22, 7, v27
    v_lshl_or_b32 v3, v24, 4, v22
    v_lshrrev_b32 v23, 3, v14
    v_mul_u32_u24 v4, 9216, v23
    v_xad_u32 v1, v25, v3, v4
    v_xor_b32 v2, 64, v1
    v_add_u32 v9, s29, v25
    v_add_u32 v8, s29, v11
    v_mul_u32_u24 v24, 1152, v27
    v_lshl_add_u32 v24, v23, 6, v24
    v_add3_u32 v6, v24, v25, s28
    v_lshrrev_b32 v24, 3, v12
    v_xor_b32 v28, v24, v12
    v_and_b32 v28, 7, v28
    v_mul_u32_u24 v24, 1152, v24
    v_lshl_add_u32 v24, v28, 4, v24
    v_add_u32 v7, 1024, v24
    s_lshl_b32 s30, s20, 1
    v_lshrrev_b32 v24, 1, v13
    v_add_u32 v24, s30, v24
    v_xor_b32 v24, v24, v27
    v_lshl_add_u32 v24, v24, 4, v22
    v_and_b32 v28, 8, v26
    v_mul_u32_u24 v29, 13072, v23
    v_add3_u32 v24, v24, v28, v29
    v_add_u32 v252, 122640, v24
    s_cmp_eq_u32 s20, 0
    s_mov_b32 s31, 1073904712
    s_cselect_b32 s30, 162880, s31
    v_mov_b32 v253, s31
    v_writelane_b32 v253, s30, 0
    s_lshr_b32 s30, s2, 3
    s_and_b32 s30, s30, 3
    s_lshl_b32 s92, s30, 8
    s_add_u32 s92, s92, 567232
    s_add_u32 s30, s30, 768
    s_mul_i32 s93, s30, 36864
    s_mov_b32 s94, 147456
    s_and_b32 s95, s20, 1
    s_mul_i32 s95, s95, 9216
    v_add_u32 v55, 512, v26
    v_mov_b32 v10, 0xeeee4444
    s_mov_b32 vcc_lo, 0xff00ff00
    s_mov_b32 vcc_hi, 0xff00ff00
    s_add_u32 s59, s24, 9216
    s_mul_i32 s43, s20, 82944
    s_mul_i32 s53, s20, 11264
    s_add_u32 s53, s53, 331776
    s_mul_i32 s67, s20, 9856
    s_add_u32 s67, s67, 376832
    v_lshlrev_b32 v124, 16, v196
    v_and_b32 v125, 0xffff0000, v196
    v_lshlrev_b32 v126, 16, v197
    v_and_b32 v127, 0xffff0000, v197
    v_lshlrev_b32 v128, 16, v198
    v_and_b32 v129, 0xffff0000, v198
    v_lshlrev_b32 v130, 16, v199
    v_and_b32 v131, 0xffff0000, v199
    v_lshlrev_b32 v132, 16, v200
    v_and_b32 v133, 0xffff0000, v200
    v_lshlrev_b32 v134, 16, v201
    v_and_b32 v135, 0xffff0000, v201
    v_lshlrev_b32 v136, 16, v202
    v_and_b32 v137, 0xffff0000, v202
    v_lshlrev_b32 v138, 16, v203
    v_and_b32 v139, 0xffff0000, v203
    v_lshlrev_b32 v140, 16, v204
    v_and_b32 v141, 0xffff0000, v204
    v_lshlrev_b32 v142, 16, v205
    v_and_b32 v143, 0xffff0000, v205
    v_lshlrev_b32 v144, 16, v206
    v_and_b32 v145, 0xffff0000, v206
    v_lshlrev_b32 v146, 16, v207
    v_and_b32 v147, 0xffff0000, v207
    v_lshlrev_b32 v148, 16, v208
    v_and_b32 v149, 0xffff0000, v208
    v_lshlrev_b32 v150, 16, v209
    v_and_b32 v151, 0xffff0000, v209
    v_lshlrev_b32 v152, 16, v210
    v_and_b32 v153, 0xffff0000, v210
    v_lshlrev_b32 v154, 16, v211
    v_and_b32 v155, 0xffff0000, v211
    v_lshlrev_b32 v156, 16, v212
    v_and_b32 v157, 0xffff0000, v212
    v_lshlrev_b32 v158, 16, v213
    v_and_b32 v159, 0xffff0000, v213
    s_mov_b32 exec_lo, 0x00010001
    s_mov_b32 exec_hi, 0x00010001
    ds_write_b128 v9, v[124:127] offset:9840
    ds_write_b128 v9, v[128:131] offset:9904
    ds_write_b128 v9, v[132:135] offset:9968
    ds_write_b128 v9, v[136:139] offset:10032
    ds_write_b128 v9, v[140:143] offset:10096
    ds_write_b128 v9, v[144:147] offset:10160
    ds_write_b128 v9, v[148:151] offset:10224
    ds_write_b128 v9, v[152:155] offset:10288
    ds_write_b128 v9, v[156:159] offset:10352
    s_mov_b64 exec, -1
    s_cmp_lt_u32 s2, 120
    s_cbranch_scc1 M_nt
    s_mul_i32 s30, s20, 136
    s_add_u32 s30, s30, s2
    s_sub_u32 s30, s30, 120
    s_lshl_b32 s30, s30, 1
    s_cmp_ge_u32 s30, 900
    s_cbranch_scc1 M_nt
    v_lshrrev_b32 v244, 5, v12
    v_add_u32 v244, s30, v244
    v_mul_u32_u24 v245, 5826, v244
    v_lshrrev_b32 v245, 20, v245
    v_mul_u32_u24 v246, 180, v245
    v_sub_u32 v244, v244, v246
    v_mul_u32_u24 v246, 20, v245
    v_sub_u32 v247, v244, v246
    v_cmp_lt_u32 s[30:31], v244, v246
    v_subrev_u32 v246, 1, v245
    v_sub_u32 v245, 8, v245
    v_cndmask_b32 v244, v247, v244, s[30:31]
    v_cndmask_b32 v245, v245, v246, s[30:31]
    v_sub_u32 v244, 2047, v244
    v_mul_u32_u24 v244, 36864, v244
    v_lshl_add_u32 v244, v245, 7, v244
    v_and_b32 v245, 31, v12
    v_mul_u32_u24 v245, 1152, v245
    v_add_u32 v244, v244, v245
    buffer_load_dword v244, v244, s[8:11], 0 offen
M_nt:
    s_waitcnt vmcnt(0)
    v_readfirstlane_b32 s30, v0
    s_mov_b32 s31, 0
    s_sub_u32 s30, s30, s100
    s_cmp_eq_u32 s30, 21
    s_cbranch_scc0 M_pf_spin
M_pf_ok:
    buffer_load_dwordx4 v[12:15], v11, s[16:19], s53 offen offset:0 sc1
    buffer_load_dwordx4 a[0:3], v11, s[16:19], s43 offen offset:0 sc1
    buffer_load_dwordx4 a[4:7], v11, s[16:19], s43 offen offset:1024 sc1
    buffer_load_dwordx4 a[8:11], v11, s[16:19], s43 offen offset:2048 sc1
    buffer_load_dwordx4 a[12:15], v11, s[16:19], s43 offen offset:3072 sc1
    s_add_u32 s43, s43, 4096
    buffer_load_dwordx4 a[16:19], v11, s[16:19], s43 offen offset:0 sc1
    buffer_load_dwordx4 a[20:23], v11, s[16:19], s43 offen offset:1024 sc1
    buffer_load_dwordx4 a[24:27], v11, s[16:19], s43 offen offset:2048 sc1
    buffer_load_dwordx4 a[28:31], v11, s[16:19], s43 offen offset:3072 sc1
    buffer_load_dwordx4 v[16:19], v11, s[16:19], s53 offen offset:1024 sc1
    s_add_u32 s43, s43, 4096
    buffer_load_dwordx4 a[32:35], v11, s[16:19], s43 offen offset:0 sc1
    buffer_load_dwordx4 a[36:39], v11, s[16:19], s43 offen offset:1024 sc1
    buffer_load_dwordx4 a[40:43], v11, s[16:19], s43 offen offset:2048 sc1
    buffer_load_dwordx4 a[44:47], v11, s[16:19], s43 offen offset:3072 sc1
    ds_read_b128 v[160:163], v9 offset:9840
    ds_read_b128 v[164:167], v9 offset:9904
    ds_read_b128 v[168:171], v9 offset:9968
    ds_read_b128 v[172:175], v9 offset:10032
    ds_read_b128 v[176:179], v9 offset:10096
    ds_read_b128 v[180:183], v9 offset:10160
    ds_read_b128 v[184:187], v9 offset:10224
    ds_read_b128 v[188:191], v9 offset:10288
    ds_read_b128 v[192:195], v9 offset:10352
    s_waitcnt vmcnt(12)
    s_barrier
    ds_read_b128 v[196:199], v1 offset:0
    ds_read_b128 v[200:203], v2 offset:0
    ds_read_b128 v[228:231], v1 offset:18432
    ds_read_b128 v[232:235], v2 offset:18432
    s_add_u32 s43, s43, 4096
    buffer_load_dwordx4 a[48:51], v11, s[16:19], s43 offen offset:0 sc1
    s_waitcnt lgkmcnt(2)
    v_smfmac_f32_16x16x64_bf16 v[124:127], a[0:3], v[196:203], v12
    s_waitcnt lgkmcnt(0)
    v_smfmac_f32_16x16x64_bf16 v[160:163], a[0:3], v[228:235], v12
    buffer_load_dwordx4 a[52:55], v11, s[16:19], s43 offen offset:1024 sc1
    ds_read_b128 v[204:207], v1 offset:1024
    ds_read_b128 v[208:211], v2 offset:1024
    s_waitcnt vmcnt(13)
    v_smfmac_f32_16x16x64_bf16 v[128:131], a[4:7], v[196:203], v12 abid:1
    v_smfmac_f32_16x16x64_bf16 v[164:167], a[4:7], v[228:235], v12 abid:1
    buffer_load_dwordx4 a[56:59], v11, s[16:19], s43 offen offset:2048 sc1
    ds_read_b128 v[220:223], v1 offset:19456
    ds_read_b128 v[224:227], v2 offset:19456
    s_waitcnt vmcnt(13)
    v_smfmac_f32_16x16x64_bf16 v[132:135], a[8:11], v[196:203], v13
    v_smfmac_f32_16x16x64_bf16 v[168:171], a[8:11], v[228:235], v13
    buffer_load_dwordx4 a[60:63], v11, s[16:19], s43 offen offset:3072 sc1
    s_waitcnt vmcnt(13)
    v_smfmac_f32_16x16x64_bf16 v[136:139], a[12:15], v[196:203], v13 abid:1
    v_smfmac_f32_16x16x64_bf16 v[172:175], a[12:15], v[228:235], v13 abid:1
    buffer_load_dwordx4 v[20:23], v11, s[16:19], s53 offen offset:2048 sc1
    s_add_u32 s43, s43, 4096
    buffer_load_dwordx4 a[64:67], v11, s[16:19], s43 offen offset:0 sc1
    s_waitcnt vmcnt(14)
    v_smfmac_f32_16x16x64_bf16 v[140:143], a[16:19], v[196:203], v14
    v_smfmac_f32_16x16x64_bf16 v[176:179], a[16:19], v[228:235], v14
    buffer_load_dwordx4 a[68:71], v11, s[16:19], s43 offen offset:1024 sc1
    s_waitcnt vmcnt(14)
    v_smfmac_f32_16x16x64_bf16 v[144:147], a[20:23], v[196:203], v14 abid:1
    v_smfmac_f32_16x16x64_bf16 v[180:183], a[20:23], v[228:235], v14 abid:1
    buffer_load_dwordx4 a[72:75], v11, s[16:19], s43 offen offset:2048 sc1
    s_waitcnt vmcnt(14)
    v_smfmac_f32_16x16x64_bf16 v[148:151], a[24:27], v[196:203], v15
    v_smfmac_f32_16x16x64_bf16 v[184:187], a[24:27], v[228:235], v15
    buffer_load_dwordx4 a[76:79], v11, s[16:19], s43 offen offset:3072 sc1
    s_waitcnt vmcnt(14)
    v_smfmac_f32_16x16x64_bf16 v[152:155], a[28:31], v[196:203], v15 abid:1
    v_smfmac_f32_16x16x64_bf16 v[188:191], a[28:31], v[228:235], v15 abid:1
    s_add_u32 s43, s43, 4096
    buffer_load_dwordx4 a[80:83], v11, s[16:19], s43 offen offset:0 sc1
    s_waitcnt vmcnt(13)
    v_smfmac_f32_16x16x64_bf16 v[156:159], a[32:35], v[196:203], v16
    v_smfmac_f32_16x16x64_bf16 v[192:195], a[32:35], v[228:235], v16
    buffer_load_dwordx4 a[84:87], v11, s[16:19], s43 offen offset:1024 sc1
    s_waitcnt vmcnt(13)
    s_waitcnt lgkmcnt(2)
    v_smfmac_f32_16x16x64_bf16 v[124:127], a[36:39], v[204:211], v16 abid:1
    s_waitcnt lgkmcnt(0)
    v_smfmac_f32_16x16x64_bf16 v[160:163], a[36:39], v[220:227], v16 abid:1
    buffer_load_dwordx4 a[88:91], v11, s[16:19], s43 offen offset:2048 sc1
    ds_read_b128 v[196:199], v1 offset:2048
    ds_read_b128 v[200:203], v2 offset:2048
    s_waitcnt vmcnt(13)
    v_smfmac_f32_16x16x64_bf16 v[128:131], a[40:43], v[204:211], v17
    v_smfmac_f32_16x16x64_bf16 v[164:167], a[40:43], v[220:227], v17
    buffer_load_dword v0, off, s[16:19], s97 sc1
    buffer_load_dwordx4 a[92:95], v11, s[16:19], s43 offen offset:3072 sc1
    ds_read_b128 v[228:231], v1 offset:20480
    ds_read_b128 v[232:235], v2 offset:20480
    s_waitcnt vmcnt(14)
    v_smfmac_f32_16x16x64_bf16 v[132:135], a[44:47], v[204:211], v17 abid:1
    v_smfmac_f32_16x16x64_bf16 v[168:171], a[44:47], v[220:227], v17 abid:1
    buffer_load_dwordx4 v[24:27], v11, s[16:19], s53 offen offset:3072 sc1
    s_add_u32 s43, s43, 4096
    buffer_load_dwordx4 a[96:99], v11, s[16:19], s43 offen offset:0 sc1
    s_waitcnt vmcnt(15)
    v_smfmac_f32_16x16x64_bf16 v[136:139], a[48:51], v[204:211], v18
    v_smfmac_f32_16x16x64_bf16 v[172:175], a[48:51], v[220:227], v18
    buffer_load_dwordx4 a[100:103], v11, s[16:19], s43 offen offset:1024 sc1
    s_waitcnt vmcnt(15)
    v_smfmac_f32_16x16x64_bf16 v[140:143], a[52:55], v[204:211], v18 abid:1
    v_smfmac_f32_16x16x64_bf16 v[176:179], a[52:55], v[220:227], v18 abid:1
    buffer_load_dwordx4 a[104:107], v11, s[16:19], s43 offen offset:2048 sc1
    s_waitcnt vmcnt(15)
    v_smfmac_f32_16x16x64_bf16 v[144:147], a[56:59], v[204:211], v19
    v_smfmac_f32_16x16x64_bf16 v[180:183], a[56:59], v[220:227], v19
    buffer_load_dwordx4 a[108:111], v11, s[16:19], s43 offen offset:3072 sc1
    s_waitcnt vmcnt(15)
    v_smfmac_f32_16x16x64_bf16 v[148:151], a[60:63], v[204:211], v19 abid:1
    v_smfmac_f32_16x16x64_bf16 v[184:187], a[60:63], v[220:227], v19 abid:1
    s_add_u32 s43, s43, 4096
    buffer_load_dwordx4 a[112:115], v11, s[16:19], s43 offen offset:0 sc1
    s_waitcnt vmcnt(14)
    v_smfmac_f32_16x16x64_bf16 v[152:155], a[64:67], v[204:211], v20
    v_smfmac_f32_16x16x64_bf16 v[188:191], a[64:67], v[220:227], v20
    buffer_load_dwordx4 a[116:119], v11, s[16:19], s43 offen offset:1024 sc1
    s_waitcnt vmcnt(14)
    v_smfmac_f32_16x16x64_bf16 v[156:159], a[68:71], v[204:211], v20 abid:1
    v_smfmac_f32_16x16x64_bf16 v[192:195], a[68:71], v[220:227], v20 abid:1
    buffer_load_dwordx4 a[120:123], v11, s[16:19], s43 offen offset:2048 sc1
    s_waitcnt vmcnt(14)
    s_waitcnt lgkmcnt(2)
    v_smfmac_f32_16x16x64_bf16 v[124:127], a[72:75], v[196:203], v21
    s_waitcnt lgkmcnt(0)
    v_smfmac_f32_16x16x64_bf16 v[160:163], a[72:75], v[228:235], v21
    buffer_load_dwordx4 a[124:127], v11, s[16:19], s43 offen offset:3072 sc1
    ds_read_b128 v[204:207], v1 offset:3072
    ds_read_b128 v[208:211], v2 offset:3072
    s_waitcnt vmcnt(14)
    v_smfmac_f32_16x16x64_bf16 v[128:131], a[76:79], v[196:203], v21 abid:1
    v_smfmac_f32_16x16x64_bf16 v[164:167], a[76:79], v[228:235], v21 abid:1
    s_add_u32 s53, s53, 4096
    buffer_load_dwordx4 v[28:31], v11, s[16:19], s53 offen offset:0 sc1
    s_add_u32 s43, s43, 4096
    buffer_load_dwordx4 a[128:131], v11, s[16:19], s43 offen offset:0 sc1
    ds_read_b128 v[220:223], v1 offset:21504
    ds_read_b128 v[224:227], v2 offset:21504
    s_waitcnt vmcnt(15)
    v_smfmac_f32_16x16x64_bf16 v[132:135], a[80:83], v[196:203], v22
    v_smfmac_f32_16x16x64_bf16 v[168:171], a[80:83], v[228:235], v22
    buffer_load_dwordx4 a[132:135], v11, s[16:19], s43 offen offset:1024 sc1
    s_waitcnt vmcnt(15)
    v_smfmac_f32_16x16x64_bf16 v[136:139], a[84:87], v[196:203], v22 abid:1
    v_smfmac_f32_16x16x64_bf16 v[172:175], a[84:87], v[228:235], v22 abid:1
    buffer_load_dwordx4 a[136:139], v11, s[16:19], s43 offen offset:2048 sc1
    s_waitcnt vmcnt(15)
    v_smfmac_f32_16x16x64_bf16 v[140:143], a[88:91], v[196:203], v23
    v_smfmac_f32_16x16x64_bf16 v[176:179], a[88:91], v[228:235], v23
    buffer_load_dwordx4 a[140:143], v11, s[16:19], s43 offen offset:3072 sc1
    s_waitcnt vmcnt(14)
    v_smfmac_f32_16x16x64_bf16 v[144:147], a[92:95], v[196:203], v23 abid:1
    v_smfmac_f32_16x16x64_bf16 v[180:183], a[92:95], v[228:235], v23 abid:1
    v_readfirstlane_b32 s30, v0
    s_mov_b32 s31, 0
    s_sub_u32 s30, s30, s101
    s_cmp_eq_u32 s30, 9
    s_cbranch_scc0 M_pc_spin
M_pc_ok:
    s_mov_b32 m0, s29
    s_nop 0
    buffer_load_dwordx4 v11, s[16:19], s67 offen offset:0 sc1 lds
    buffer_load_dwordx4 v11, s[16:19], s67 offen offset:1024 sc1 lds
    buffer_load_dwordx4 v11, s[16:19], s67 offen offset:2048 sc1 lds
    buffer_load_dwordx4 v11, s[16:19], s67 offen offset:3072 sc1 lds
    s_add_u32 s67, s67, 4096
    s_add_u32 m0, m0, 4096
    s_nop 0
    buffer_load_dwordx4 v11, s[16:19], s67 offen offset:0 sc1 lds
    buffer_load_dwordx4 v11, s[16:19], s67 offen offset:1024 sc1 lds
    buffer_load_dwordx4 v11, s[16:19], s67 offen offset:2048 sc1 lds
    buffer_load_dwordx4 v11, s[16:19], s67 offen offset:3072 sc1 lds
    s_add_u32 s67, s67, 4096
    s_add_u32 m0, m0, 4096
    s_nop 0
    buffer_load_dwordx4 v11, s[16:19], s67 offen offset:0 sc1 lds
    s_mov_b32 exec_hi, 0x7f
    buffer_load_dwordx4 v11, s[16:19], s67 offen offset:1024 sc1 lds
    s_mov_b32 exec_hi, -1
    s_add_u32 s43, s43, 4096
    buffer_load_dwordx4 a[144:147], v11, s[16:19], s43 offen offset:0 sc1
    s_waitcnt vmcnt(23)
    v_smfmac_f32_16x16x64_bf16 v[148:151], a[96:99], v[196:203], v24
    v_smfmac_f32_16x16x64_bf16 v[184:187], a[96:99], v[228:235], v24
    buffer_load_dwordx4 a[148:151], v11, s[16:19], s43 offen offset:1024 sc1
    s_waitcnt vmcnt(23)
    v_smfmac_f32_16x16x64_bf16 v[152:155], a[100:103], v[196:203], v24 abid:1
    v_smfmac_f32_16x16x64_bf16 v[188:191], a[100:103], v[228:235], v24 abid:1
    buffer_load_dwordx4 a[152:155], v11, s[16:19], s43 offen offset:2048 sc1
    s_waitcnt vmcnt(23)
    v_smfmac_f32_16x16x64_bf16 v[156:159], a[104:107], v[196:203], v25
    v_smfmac_f32_16x16x64_bf16 v[192:195], a[104:107], v[228:235], v25
    buffer_load_dwordx4 a[156:159], v11, s[16:19], s43 offen offset:3072 sc1
    s_waitcnt vmcnt(23)
    s_waitcnt lgkmcnt(2)
    v_smfmac_f32_16x16x64_bf16 v[124:127], a[108:111], v[204:211], v25 abid:1
    s_waitcnt lgkmcnt(0)
    v_smfmac_f32_16x16x64_bf16 v[160:163], a[108:111], v[220:227], v25 abid:1
    buffer_load_dwordx4 v[32:35], v11, s[16:19], s53 offen offset:1024 sc1
    s_add_u32 s43, s43, 4096
    buffer_load_dwordx4 a[160:163], v11, s[16:19], s43 offen offset:0 sc1
    ds_read_b128 v[196:199], v1 offset:4096
    ds_read_b128 v[200:203], v2 offset:4096
    s_waitcnt vmcnt(24)
    v_smfmac_f32_16x16x64_bf16 v[128:131], a[112:115], v[204:211], v26
    v_smfmac_f32_16x16x64_bf16 v[164:167], a[112:115], v[220:227], v26
    buffer_load_dwordx4 a[164:167], v11, s[16:19], s43 offen offset:1024 sc1
    ds_read_b128 v[228:231], v1 offset:22528
    ds_read_b128 v[232:235], v2 offset:22528
    s_waitcnt vmcnt(24)
    v_smfmac_f32_16x16x64_bf16 v[132:135], a[116:119], v[204:211], v26 abid:1
    v_smfmac_f32_16x16x64_bf16 v[168:171], a[116:119], v[220:227], v26 abid:1
    buffer_load_dwordx4 a[168:171], v11, s[16:19], s43 offen offset:2048 sc1
    s_waitcnt vmcnt(24)
    v_smfmac_f32_16x16x64_bf16 v[136:139], a[120:123], v[204:211], v27
    v_smfmac_f32_16x16x64_bf16 v[172:175], a[120:123], v[220:227], v27
    buffer_load_dwordx4 a[172:175], v11, s[16:19], s43 offen offset:3072 sc1
    s_waitcnt vmcnt(24)
    v_smfmac_f32_16x16x64_bf16 v[140:143], a[124:127], v[204:211], v27 abid:1
    v_smfmac_f32_16x16x64_bf16 v[176:179], a[124:127], v[220:227], v27 abid:1
    s_add_u32 s43, s43, 4096
    buffer_load_dwordx4 a[176:179], v11, s[16:19], s43 offen offset:0 sc1
    s_waitcnt vmcnt(23)
    v_smfmac_f32_16x16x64_bf16 v[144:147], a[128:131], v[204:211], v28
    v_smfmac_f32_16x16x64_bf16 v[180:183], a[128:131], v[220:227], v28
    buffer_load_dwordx4 a[180:183], v11, s[16:19], s43 offen offset:1024 sc1
    s_waitcnt vmcnt(23)
    v_smfmac_f32_16x16x64_bf16 v[148:151], a[132:135], v[204:211], v28 abid:1
    v_smfmac_f32_16x16x64_bf16 v[184:187], a[132:135], v[220:227], v28 abid:1
    buffer_load_dwordx4 a[184:187], v11, s[16:19], s43 offen offset:2048 sc1
    s_waitcnt vmcnt(23)
    v_smfmac_f32_16x16x64_bf16 v[152:155], a[136:139], v[204:211], v29
    v_smfmac_f32_16x16x64_bf16 v[188:191], a[136:139], v[220:227], v29
    buffer_load_dwordx4 a[188:191], v11, s[16:19], s43 offen offset:3072 sc1
    s_waitcnt vmcnt(23)
    v_smfmac_f32_16x16x64_bf16 v[156:159], a[140:143], v[204:211], v29 abid:1
    v_smfmac_f32_16x16x64_bf16 v[192:195], a[140:143], v[220:227], v29 abid:1
    buffer_load_dwordx4 v[36:39], v11, s[16:19], s53 offen offset:2048 sc1
    s_add_u32 s43, s43, 4096
    buffer_load_dwordx4 a[192:195], v11, s[16:19], s43 offen offset:0 sc1
    s_waitcnt vmcnt(14)
    s_waitcnt lgkmcnt(2)
    v_smfmac_f32_16x16x64_bf16 v[124:127], a[144:147], v[196:203], v30
    s_waitcnt lgkmcnt(0)
    v_smfmac_f32_16x16x64_bf16 v[160:163], a[144:147], v[228:235], v30
    v_mov_b32 v0, s29
    ds_read_b128 v[244:247], v0 offset:9792
    ds_read_b128 v[248:251], v0 offset:9808
    ds_read_b32 v240, v0 offset:9824
    ds_read_b128 v[236:239], v9 offset:9728
    buffer_load_dwordx4 a[196:199], v11, s[16:19], s43 offen offset:1024 sc1
    ds_read_b128 v[204:207], v1 offset:5120
    ds_read_b128 v[208:211], v2 offset:5120
    s_waitcnt vmcnt(14)
    v_smfmac_f32_16x16x64_bf16 v[128:131], a[148:151], v[196:203], v30 abid:1
    v_smfmac_f32_16x16x64_bf16 v[164:167], a[148:151], v[228:235], v30 abid:1
    s_waitcnt lgkmcnt(5)
    v_or3_b32 v0, v244, v245, v246
    s_waitcnt lgkmcnt(4)
    v_or3_b32 v0, v0, v247, v248
    v_or3_b32 v0, v0, v249, v250
    s_waitcnt lgkmcnt(3)
    v_or3_b32 v0, v0, v251, v240
    s_nop 0
    v_readfirstlane_b32 s27, v0
    s_nop 0
    s_cmp_lg_u32 s27, 0
    s_cbranch_scc1 M_pool
M_poolr:
    buffer_load_dwordx4 a[200:203], v11, s[16:19], s43 offen offset:2048 sc1
    ds_read_b128 v[220:223], v1 offset:23552
    ds_read_b128 v[224:227], v2 offset:23552
    s_waitcnt vmcnt(14)
    v_smfmac_f32_16x16x64_bf16 v[132:135], a[152:155], v[196:203], v31
    v_smfmac_f32_16x16x64_bf16 v[168:171], a[152:155], v[228:235], v31
    s_waitcnt lgkmcnt(4)
    v_xad_u32 v236, v236, v3, v4
    v_xad_u32 v237, v237, v3, v4
    ds_read2st64_b32 v[244:245], v236 offset0:0 offset1:72
    ds_read2st64_b32 v[246:247], v237 offset0:0 offset1:72
    ds_read_b128 v[240:243], v8 offset:8192
    buffer_load_dwordx4 a[204:207], v11, s[16:19], s43 offen offset:3072 sc1
    s_waitcnt vmcnt(14)
    v_smfmac_f32_16x16x64_bf16 v[136:139], a[156:159], v[196:203], v31 abid:1
    v_smfmac_f32_16x16x64_bf16 v[172:175], a[156:159], v[228:235], v31 abid:1
    v_xad_u32 v238, v238, v3, v4
    v_xad_u32 v239, v239, v3, v4
    ds_read2st64_b32 v[248:249], v238 offset0:0 offset1:72
    ds_read2st64_b32 v[250:251], v239 offset0:0 offset1:72
    ds_read_b128 v[236:239], v9 offset:9216
    s_add_u32 s43, s43, 4096
    buffer_load_dwordx4 a[208:211], v11, s[16:19], s43 offen offset:0 sc1
    s_waitcnt vmcnt(13)
    v_smfmac_f32_16x16x64_bf16 v[140:143], a[160:163], v[196:203], v32
    v_smfmac_f32_16x16x64_bf16 v[176:179], a[160:163], v[228:235], v32
    buffer_load_dwordx4 a[212:215], v11, s[16:19], s43 offen offset:1024 sc1
    s_waitcnt vmcnt(13)
    v_smfmac_f32_16x16x64_bf16 v[144:147], a[164:167], v[196:203], v32 abid:1
    v_smfmac_f32_16x16x64_bf16 v[180:183], a[164:167], v[228:235], v32 abid:1
    s_waitcnt lgkmcnt(1)
    v_smfmac_f32_16x16x64_bf16 v[156:159], v[240:243], v[244:251], v10
    v_smfmac_f32_16x16x64_bf16 v[192:195], v[240:243], v[244:251], v10 abid:1
    buffer_load_dwordx4 a[216:219], v11, s[16:19], s43 offen offset:2048 sc1
    s_waitcnt vmcnt(13)
    v_smfmac_f32_16x16x64_bf16 v[148:151], a[168:171], v[196:203], v33
    v_smfmac_f32_16x16x64_bf16 v[184:187], a[168:171], v[228:235], v33
    s_waitcnt lgkmcnt(0)
    v_xad_u32 v236, v236, v3, v4
    v_xad_u32 v237, v237, v3, v4
    ds_read2st64_b32 v[244:245], v236 offset0:0 offset1:72
    ds_read2st64_b32 v[246:247], v237 offset0:0 offset1:72
    ds_read_b128 v[240:243], v8 offset:0
    buffer_load_dwordx4 a[220:223], v11, s[16:19], s43 offen offset:3072 sc1
    s_waitcnt vmcnt(13)
    v_smfmac_f32_16x16x64_bf16 v[152:155], a[172:175], v[196:203], v33 abid:1
    v_smfmac_f32_16x16x64_bf16 v[188:191], a[172:175], v[228:235], v33 abid:1
    v_xad_u32 v238, v238, v3, v4
    v_xad_u32 v239, v239, v3, v4
    ds_read2st64_b32 v[248:249], v238 offset0:0 offset1:72
    ds_read2st64_b32 v[250:251], v239 offset0:0 offset1:72
    ds_read_b128 v[236:239], v9 offset:9280
    buffer_load_dwordx4 v[40:43], v11, s[16:19], s53 offen offset:3072 sc1
    s_add_u32 s43, s43, 4096
    buffer_load_dwordx4 a[224:227], v11, s[16:19], s43 offen offset:0 sc1
    s_waitcnt vmcnt(14)
    v_smfmac_f32_16x16x64_bf16 v[156:159], a[176:179], v[196:203], v34
    v_smfmac_f32_16x16x64_bf16 v[192:195], a[176:179], v[228:235], v34
    buffer_load_dwordx4 a[228:231], v11, s[16:19], s43 offen offset:1024 sc1
    s_waitcnt vmcnt(14)
    v_smfmac_f32_16x16x64_bf16 v[124:127], a[180:183], v[204:211], v34 abid:1
    v_smfmac_f32_16x16x64_bf16 v[160:163], a[180:183], v[220:227], v34 abid:1
    s_waitcnt lgkmcnt(1)
    v_smfmac_f32_16x16x64_bf16 v[124:127], v[240:243], v[244:251], v10
    v_smfmac_f32_16x16x64_bf16 v[160:163], v[240:243], v[244:251], v10 abid:1
    buffer_load_dwordx4 a[232:235], v11, s[16:19], s43 offen offset:2048 sc1
    ds_read_b128 v[196:199], v1 offset:6144
    ds_read_b128 v[200:203], v2 offset:6144
    s_waitcnt vmcnt(14)
    v_smfmac_f32_16x16x64_bf16 v[128:131], a[184:187], v[204:211], v35
    v_smfmac_f32_16x16x64_bf16 v[164:167], a[184:187], v[220:227], v35
    s_waitcnt lgkmcnt(2)
    v_xad_u32 v236, v236, v3, v4
    v_xad_u32 v237, v237, v3, v4
    ds_read2st64_b32 v[244:245], v236 offset0:0 offset1:72
    ds_read2st64_b32 v[246:247], v237 offset0:0 offset1:72
    ds_read_b128 v[240:243], v8 offset:1024
    buffer_load_dwordx4 a[236:239], v11, s[16:19], s43 offen offset:3072 sc1
    ds_read_b128 v[228:231], v1 offset:24576
    ds_read_b128 v[232:235], v2 offset:24576
    s_waitcnt vmcnt(14)
    v_smfmac_f32_16x16x64_bf16 v[132:135], a[188:191], v[204:211], v35 abid:1
    v_smfmac_f32_16x16x64_bf16 v[168:171], a[188:191], v[220:227], v35 abid:1
    v_xad_u32 v238, v238, v3, v4
    v_xad_u32 v239, v239, v3, v4
    ds_read2st64_b32 v[248:249], v238 offset0:0 offset1:72
    ds_read2st64_b32 v[250:251], v239 offset0:0 offset1:72
    ds_read_b128 v[236:239], v9 offset:9344
    s_add_u32 s43, s43, 4096
    buffer_load_dwordx4 a[240:243], v11, s[16:19], s43 offen offset:0 sc1
    s_waitcnt vmcnt(13)
    v_smfmac_f32_16x16x64_bf16 v[136:139], a[192:195], v[204:211], v36
    v_smfmac_f32_16x16x64_bf16 v[172:175], a[192:195], v[220:227], v36
    buffer_load_dwordx4 a[244:247], v11, s[16:19], s43 offen offset:1024 sc1
    s_waitcnt vmcnt(13)
    v_smfmac_f32_16x16x64_bf16 v[140:143], a[196:199], v[204:211], v36 abid:1
    v_smfmac_f32_16x16x64_bf16 v[176:179], a[196:199], v[220:227], v36 abid:1
    s_waitcnt lgkmcnt(1)
    v_smfmac_f32_16x16x64_bf16 v[128:131], v[240:243], v[244:251], v10
    v_smfmac_f32_16x16x64_bf16 v[164:167], v[240:243], v[244:251], v10 abid:1
    buffer_load_dwordx4 a[248:251], v11, s[16:19], s43 offen offset:2048 sc1
    s_waitcnt vmcnt(13)
    v_smfmac_f32_16x16x64_bf16 v[144:147], a[200:203], v[204:211], v37
    v_smfmac_f32_16x16x64_bf16 v[180:183], a[200:203], v[220:227], v37
    s_waitcnt lgkmcnt(0)
    v_xad_u32 v236, v236, v3, v4
    v_xad_u32 v237, v237, v3, v4
    ds_read2st64_b32 v[244:245], v236 offset0:0 offset1:72
    ds_read2st64_b32 v[246:247], v237 offset0:0 offset1:72
    ds_read_b128 v[240:243], v8 offset:2048
    buffer_load_dwordx4 a[252:255], v11, s[16:19], s43 offen offset:3072 sc1
    s_waitcnt vmcnt(13)
    v_smfmac_f32_16x16x64_bf16 v[148:151], a[204:207], v[204:211], v37 abid:1
    v_smfmac_f32_16x16x64_bf16 v[184:187], a[204:207], v[220:227], v37 abid:1
    v_xad_u32 v238, v238, v3, v4
    v_xad_u32 v239, v239, v3, v4
    ds_read2st64_b32 v[248:249], v238 offset0:0 offset1:72
    ds_read2st64_b32 v[250:251], v239 offset0:0 offset1:72
    ds_read_b128 v[236:239], v9 offset:9408
    s_add_u32 s53, s53, 4096
    buffer_load_dwordx4 v[44:47], v11, s[16:19], s53 offen offset:0 sc1
    s_add_u32 s43, s43, 4096
    buffer_load_dwordx4 v[56:59], v11, s[16:19], s43 offen offset:0 sc1
    s_waitcnt vmcnt(14)
    v_smfmac_f32_16x16x64_bf16 v[152:155], a[208:211], v[204:211], v38
    v_smfmac_f32_16x16x64_bf16 v[188:191], a[208:211], v[220:227], v38
    buffer_load_dwordx4 v[60:63], v11, s[16:19], s43 offen offset:1024 sc1
    s_waitcnt vmcnt(14)
    v_smfmac_f32_16x16x64_bf16 v[156:159], a[212:215], v[204:211], v38 abid:1
    v_smfmac_f32_16x16x64_bf16 v[192:195], a[212:215], v[220:227], v38 abid:1
    s_waitcnt lgkmcnt(1)
    v_smfmac_f32_16x16x64_bf16 v[132:135], v[240:243], v[244:251], v10
    v_smfmac_f32_16x16x64_bf16 v[168:171], v[240:243], v[244:251], v10 abid:1
    buffer_load_dwordx4 v[64:67], v11, s[16:19], s43 offen offset:2048 sc1
    s_waitcnt vmcnt(14)
    v_smfmac_f32_16x16x64_bf16 v[124:127], a[216:219], v[196:203], v39
    v_smfmac_f32_16x16x64_bf16 v[160:163], a[216:219], v[228:235], v39
    s_waitcnt lgkmcnt(0)
    v_xad_u32 v236, v236, v3, v4
    v_xad_u32 v237, v237, v3, v4
    ds_read2st64_b32 v[244:245], v236 offset0:0 offset1:72
    ds_read2st64_b32 v[246:247], v237 offset0:0 offset1:72
    ds_read_b128 v[240:243], v8 offset:3072
    buffer_load_dwordx4 v[68:71], v11, s[16:19], s43 offen offset:3072 sc1
    ds_read_b128 v[204:207], v1 offset:7168
    ds_read_b128 v[208:211], v2 offset:7168
    s_waitcnt vmcnt(14)
    v_smfmac_f32_16x16x64_bf16 v[128:131], a[220:223], v[196:203], v39 abid:1
    v_smfmac_f32_16x16x64_bf16 v[164:167], a[220:223], v[228:235], v39 abid:1
    v_xad_u32 v238, v238, v3, v4
    v_xad_u32 v239, v239, v3, v4
    ds_read2st64_b32 v[248:249], v238 offset0:0 offset1:72
    ds_read2st64_b32 v[250:251], v239 offset0:0 offset1:72
    ds_read_b128 v[236:239], v9 offset:9472
    s_add_u32 s43, s43, 4096
    buffer_load_dwordx4 v[72:75], v11, s[16:19], s43 offen offset:0 sc1
    ds_read_b128 v[220:223], v1 offset:25600
    ds_read_b128 v[224:227], v2 offset:25600
    s_waitcnt vmcnt(13)
    v_smfmac_f32_16x16x64_bf16 v[132:135], a[224:227], v[196:203], v40
    v_smfmac_f32_16x16x64_bf16 v[168:171], a[224:227], v[228:235], v40
    buffer_load_dwordx4 v[76:79], v11, s[16:19], s43 offen offset:1024 sc1
    s_waitcnt vmcnt(13)
    v_smfmac_f32_16x16x64_bf16 v[136:139], a[228:231], v[196:203], v40 abid:1
    v_smfmac_f32_16x16x64_bf16 v[172:175], a[228:231], v[228:235], v40 abid:1
    s_waitcnt lgkmcnt(3)
    v_smfmac_f32_16x16x64_bf16 v[136:139], v[240:243], v[244:251], v10
    v_smfmac_f32_16x16x64_bf16 v[172:175], v[240:243], v[244:251], v10 abid:1
    buffer_load_dwordx4 v[80:83], v11, s[16:19], s43 offen offset:2048 sc1
    s_waitcnt vmcnt(13)
    v_smfmac_f32_16x16x64_bf16 v[140:143], a[232:235], v[196:203], v41
    v_smfmac_f32_16x16x64_bf16 v[176:179], a[232:235], v[228:235], v41
    s_waitcnt lgkmcnt(2)
    v_xad_u32 v236, v236, v3, v4
    v_xad_u32 v237, v237, v3, v4
    ds_read2st64_b32 v[244:245], v236 offset0:0 offset1:72
    ds_read2st64_b32 v[246:247], v237 offset0:0 offset1:72
    ds_read_b128 v[240:243], v8 offset:4096
    buffer_load_dwordx4 v[84:87], v11, s[16:19], s43 offen offset:3072 sc1
    s_waitcnt vmcnt(13)
    v_smfmac_f32_16x16x64_bf16 v[144:147], a[236:239], v[196:203], v41 abid:1
    v_smfmac_f32_16x16x64_bf16 v[180:183], a[236:239], v[228:235], v41 abid:1
    v_xad_u32 v238, v238, v3, v4
    v_xad_u32 v239, v239, v3, v4
    ds_read2st64_b32 v[248:249], v238 offset0:0 offset1:72
    ds_read2st64_b32 v[250:251], v239 offset0:0 offset1:72
    ds_read_b128 v[236:239], v9 offset:9536
    buffer_load_dwordx4 v[48:51], v11, s[16:19], s53 offen offset:1024 sc1
    s_add_u32 s43, s43, 4096
    buffer_load_dwordx4 v[88:91], v11, s[16:19], s43 offen offset:0 sc1
    s_waitcnt vmcnt(14)
    v_smfmac_f32_16x16x64_bf16 v[148:151], a[240:243], v[196:203], v42
    v_smfmac_f32_16x16x64_bf16 v[184:187], a[240:243], v[228:235], v42
    buffer_load_dwordx4 v[92:95], v11, s[16:19], s43 offen offset:1024 sc1
    s_waitcnt vmcnt(14)
    v_smfmac_f32_16x16x64_bf16 v[152:155], a[244:247], v[196:203], v42 abid:1
    v_smfmac_f32_16x16x64_bf16 v[188:191], a[244:247], v[228:235], v42 abid:1
    s_waitcnt lgkmcnt(1)
    v_smfmac_f32_16x16x64_bf16 v[140:143], v[240:243], v[244:251], v10
    v_smfmac_f32_16x16x64_bf16 v[176:179], v[240:243], v[244:251], v10 abid:1
    buffer_load_dwordx4 v[96:99], v11, s[16:19], s43 offen offset:2048 sc1
    s_waitcnt vmcnt(14)
    v_smfmac_f32_16x16x64_bf16 v[156:159], a[248:251], v[196:203], v43
    v_smfmac_f32_16x16x64_bf16 v[192:195], a[248:251], v[228:235], v43
    s_waitcnt lgkmcnt(0)
    v_xad_u32 v236, v236, v3, v4
    v_xad_u32 v237, v237, v3, v4
    ds_read2st64_b32 v[244:245], v236 offset0:0 offset1:72
    ds_read2st64_b32 v[246:247], v237 offset0:0 offset1:72
    ds_read_b128 v[240:243], v8 offset:5120
    buffer_load_dwordx4 v[100:103], v11, s[16:19], s43 offen offset:3072 sc1
    s_waitcnt vmcnt(14)
    v_smfmac_f32_16x16x64_bf16 v[124:127], a[252:255], v[204:211], v43 abid:1
    v_xad_u32 v238, v238, v3, v4
    v_xad_u32 v239, v239, v3, v4
    ds_read2st64_b32 v[248:249], v238 offset0:0 offset1:72
    ds_read2st64_b32 v[250:251], v239 offset0:0 offset1:72
    ds_read_b128 v[236:239], v9 offset:9600
    s_add_u32 s43, s43, 4096
    buffer_load_dwordx4 v[104:107], v11, s[16:19], s43 offen offset:0 sc1
    ds_read_b128 v[196:199], v1 offset:8192
    ds_read_b128 v[200:203], v2 offset:8192
    s_waitcnt vmcnt(13)
    v_smfmac_f32_16x16x64_bf16 v[128:131], v[56:59], v[204:211], v44
    buffer_load_dwordx4 v[108:111], v11, s[16:19], s43 offen offset:1024 sc1
    ds_read_b128 v[228:231], v1 offset:26624
    ds_read_b128 v[232:235], v2 offset:26624
    s_waitcnt vmcnt(13)
    v_smfmac_f32_16x16x64_bf16 v[132:135], v[60:63], v[204:211], v44 abid:1
    s_waitcnt lgkmcnt(5)
    v_smfmac_f32_16x16x64_bf16 v[144:147], v[240:243], v[244:251], v10
    v_smfmac_f32_16x16x64_bf16 v[180:183], v[240:243], v[244:251], v10 abid:1
    buffer_load_dwordx4 v[112:115], v11, s[16:19], s43 offen offset:2048 sc1
    s_waitcnt vmcnt(13)
    v_smfmac_f32_16x16x64_bf16 v[136:139], v[64:67], v[204:211], v45
    s_waitcnt lgkmcnt(4)
    v_xad_u32 v236, v236, v3, v4
    v_xad_u32 v237, v237, v3, v4
    ds_read2st64_b32 v[244:245], v236 offset0:0 offset1:72
    ds_read2st64_b32 v[246:247], v237 offset0:0 offset1:72
    ds_read_b128 v[240:243], v8 offset:6144
    buffer_load_dwordx4 v[116:119], v11, s[16:19], s43 offen offset:3072 sc1
    s_waitcnt vmcnt(13)
    v_smfmac_f32_16x16x64_bf16 v[140:143], v[68:71], v[204:211], v45 abid:1
    v_xad_u32 v238, v238, v3, v4
    v_xad_u32 v239, v239, v3, v4
    ds_read2st64_b32 v[248:249], v238 offset0:0 offset1:72
    ds_read2st64_b32 v[250:251], v239 offset0:0 offset1:72
    ds_read_b128 v[236:239], v9 offset:9664
    buffer_load_dword v52, v11, s[16:19], s53 offen offset:2048 sc1
    s_add_u32 s43, s43, 4096
    buffer_load_dwordx4 v[120:123], v11, s[16:19], s43 offen offset:0 sc1
    s_waitcnt vmcnt(14)
    v_smfmac_f32_16x16x64_bf16 v[144:147], v[72:75], v[204:211], v46
    s_waitcnt vmcnt(13)
    v_smfmac_f32_16x16x64_bf16 v[148:151], v[76:79], v[204:211], v46 abid:1
    s_waitcnt lgkmcnt(1)
    v_smfmac_f32_16x16x64_bf16 v[148:151], v[240:243], v[244:251], v10
    v_smfmac_f32_16x16x64_bf16 v[184:187], v[240:243], v[244:251], v10 abid:1
    s_waitcnt vmcnt(12)
    v_smfmac_f32_16x16x64_bf16 v[152:155], v[80:83], v[204:211], v47
    s_waitcnt lgkmcnt(0)
    v_xad_u32 v236, v236, v3, v4
    v_xad_u32 v237, v237, v3, v4
    ds_read2st64_b32 v[244:245], v236 offset0:0 offset1:72
    ds_read2st64_b32 v[246:247], v237 offset0:0 offset1:72
    ds_read_b128 v[240:243], v8 offset:7168
    s_waitcnt vmcnt(11)
    v_smfmac_f32_16x16x64_bf16 v[156:159], v[84:87], v[204:211], v47 abid:1
    v_xad_u32 v238, v238, v3, v4
    v_xad_u32 v239, v239, v3, v4
    ds_read2st64_b32 v[248:249], v238 offset0:0 offset1:72
    ds_read2st64_b32 v[250:251], v239 offset0:0 offset1:72
    s_waitcnt vmcnt(9)
    v_smfmac_f32_16x16x64_bf16 v[124:127], v[88:91], v[196:203], v48
    s_waitcnt vmcnt(8)
    v_smfmac_f32_16x16x64_bf16 v[128:131], v[92:95], v[196:203], v48 abid:1
    s_waitcnt lgkmcnt(0)
    v_smfmac_f32_16x16x64_bf16 v[152:155], v[240:243], v[244:251], v10
    v_smfmac_f32_16x16x64_bf16 v[188:191], v[240:243], v[244:251], v10 abid:1
    s_waitcnt vmcnt(7)
    v_smfmac_f32_16x16x64_bf16 v[132:135], v[96:99], v[196:203], v49
    s_waitcnt vmcnt(6)
    v_smfmac_f32_16x16x64_bf16 v[136:139], v[100:103], v[196:203], v49 abid:1
    s_waitcnt vmcnt(5)
    v_smfmac_f32_16x16x64_bf16 v[140:143], v[104:107], v[196:203], v50
    s_waitcnt vmcnt(4)
    v_smfmac_f32_16x16x64_bf16 v[144:147], v[108:111], v[196:203], v50 abid:1
    s_waitcnt vmcnt(3)
    v_smfmac_f32_16x16x64_bf16 v[148:151], v[112:115], v[196:203], v51
    s_waitcnt vmcnt(2)
    v_smfmac_f32_16x16x64_bf16 v[152:155], v[116:119], v[196:203], v51 abid:1
    s_waitcnt vmcnt(0)
    v_smfmac_f32_16x16x64_bf16 v[156:159], v[120:123], v[196:203], v52
    s_cmp_lt_u32 s21, 2
    s_cbranch_scc1 M_xlate
M_xlater:
    s_mov_b32 s21, 0
    s_cmp_lg_u32 s27, 0
    s_cbranch_scc1 M_slow
M_slowr0:
    v_cvt_pk_bf16_f32 v124, v124, v125
    v_cvt_pk_bf16_f32 v125, v126, v127
    v_cvt_pk_bf16_f32 v126, v128, v129
    v_cvt_pk_bf16_f32 v127, v130, v131
    v_cvt_pk_bf16_f32 v132, v132, v133
    v_cvt_pk_bf16_f32 v133, v134, v135
    v_cvt_pk_bf16_f32 v134, v136, v137
    v_cvt_pk_bf16_f32 v135, v138, v139
    ds_read_b128 v[136:139], v9 offset:10032
    v_cndmask_b32_dpp v128, v124, v132, vcc row_ror:8 row_mask:0xf bank_mask:0xf
    v_cndmask_b32_dpp v129, v125, v133, vcc row_ror:8 row_mask:0xf bank_mask:0xf
    v_cndmask_b32_dpp v130, v126, v134, vcc row_ror:8 row_mask:0xf bank_mask:0xf
    v_cndmask_b32_dpp v131, v127, v135, vcc row_ror:8 row_mask:0xf bank_mask:0xf
    buffer_store_dwordx4 v[128:131], v6, s[12:15], s59 offen offset:0 sc1
    v_mov_b32_dpp v124, v132 row_ror:8 row_mask:0xf bank_mask:0xc
    v_mov_b32_dpp v125, v133 row_ror:8 row_mask:0xf bank_mask:0xc
    v_mov_b32_dpp v126, v134 row_ror:8 row_mask:0xf bank_mask:0xc
    v_mov_b32_dpp v127, v135 row_ror:8 row_mask:0xf bank_mask:0xc
    buffer_store_dwordx4 v[124:127], v6, s[12:15], s24 offen offset:0 sc1
    ds_read_b128 v[128:131], v9 offset:9904
    ds_read_b128 v[132:135], v9 offset:9968
    ds_read_b128 v[124:127], v9 offset:9840
    v_cvt_pk_bf16_f32 v140, v140, v141
    v_cvt_pk_bf16_f32 v141, v142, v143
    v_cvt_pk_bf16_f32 v142, v144, v145
    v_cvt_pk_bf16_f32 v143, v146, v147
    v_cvt_pk_bf16_f32 v148, v148, v149
    v_cvt_pk_bf16_f32 v149, v150, v151
    v_cvt_pk_bf16_f32 v150, v152, v153
    v_cvt_pk_bf16_f32 v151, v154, v155
    ds_read_b128 v[152:155], v9 offset:10288
    v_cndmask_b32_dpp v144, v140, v148, vcc row_ror:8 row_mask:0xf bank_mask:0xf
    v_cndmask_b32_dpp v145, v141, v149, vcc row_ror:8 row_mask:0xf bank_mask:0xf
    v_cndmask_b32_dpp v146, v142, v150, vcc row_ror:8 row_mask:0xf bank_mask:0xf
    v_cndmask_b32_dpp v147, v143, v151, vcc row_ror:8 row_mask:0xf bank_mask:0xf
    buffer_store_dwordx4 v[144:147], v6, s[12:15], s59 offen offset:128 sc1
    v_mov_b32_dpp v140, v148 row_ror:8 row_mask:0xf bank_mask:0xc
    v_mov_b32_dpp v141, v149 row_ror:8 row_mask:0xf bank_mask:0xc
    v_mov_b32_dpp v142, v150 row_ror:8 row_mask:0xf bank_mask:0xc
    v_mov_b32_dpp v143, v151 row_ror:8 row_mask:0xf bank_mask:0xc
    buffer_store_dwordx4 v[140:143], v6, s[12:15], s24 offen offset:128 sc1
    ds_read_b128 v[144:147], v9 offset:10160
    ds_read_b128 v[148:151], v9 offset:10224
    ds_read_b128 v[140:143], v9 offset:10096
    v_cvt_pk_bf16_f32 v156, v156, v157
    v_cvt_pk_bf16_f32 v157, v158, v159
    ds_write_b64 v252, v[156:157] offset:26144
    ds_read_b128 v[156:159], v9 offset:10352
    s_mov_b32 s21, 1
    s_mov_b32 s25, 36864
    s_add_u32 s90, s24, 9437184
    s_add_u32 s22, s90, 9437184
    s_add_u32 s28, s26, 73728
    s_cmp_eq_u32 s41, 3
    s_cselect_b32 s88, 0, 75497472
    s_cselect_b32 s89, 0x30000, s28
    s_add_u32 s23, s24, 18432
    s_cmp_lt_u32 s20, 2
    s_cselect_b32 s66, s23, s24
    s_add_u32 s66, s66, s95
    v_mov_b32 v0, s22
    ds_write_b32 v253, v0
    v_mov_b32 v0, 162880
    v_add_u32 v4, 36864, v4
    v_add_u32 v1, 36864, v1
    v_add_u32 v2, 36864, v2
M_top:
    s_add_u32 s23, s24, 18432
    s_add_u32 s58, s24, 27648
    s_mov_b32 s24, s90
    s_add_u32 s59, s90, 9216
    s_waitcnt vmcnt(4) lgkmcnt(0)
    s_barrier
    ds_read_b32 v0, v0
    ds_read_b128 v[244:247], v8 offset:12048
    v_smfmac_f32_16x16x64_bf16 v[160:163], a[252:255], v[220:227], v43 abid:1
    ds_read_b128 v[196:199], v1 offset:0
    v_smfmac_f32_16x16x64_bf16 v[160:163], v[88:91], v[228:235], v48
    ds_read_b128 v[200:203], v2 offset:0
    v_smfmac_f32_16x16x64_bf16 v[164:167], v[56:59], v[220:227], v44
    ds_read_b128 v[204:207], v1 offset:1024
    v_smfmac_f32_16x16x64_bf16 v[164:167], v[92:95], v[228:235], v48 abid:1
    ds_read_b128 v[208:211], v2 offset:1024
    v_smfmac_f32_16x16x64_bf16 v[168:171], v[60:63], v[220:227], v44 abid:1
    ds_read_b128 v[212:215], v1 offset:2048
    s_waitcnt lgkmcnt(6)
    v_readfirstlane_b32 s22, v0
    v_smfmac_f32_16x16x64_bf16 v[168:171], v[96:99], v[228:235], v49
    ds_read_b128 v[216:219], v2 offset:2048
    s_cmp_lt_u32 s22, 75497472
    s_cselect_b32 s10, s88, 0
    v_smfmac_f32_16x16x64_bf16 v[172:175], v[64:67], v[220:227], v45
    s_waitcnt vmcnt(6)
    s_waitcnt lgkmcnt(6)
    buffer_store_dwordx4 v[244:247], v7, s[12:15], s66 offen sc1
    v_smfmac_f32_16x16x64_bf16 v[172:175], v[100:103], v[228:235], v49 abid:1
    ds_read_b128 v[236:239], v9 offset:9728
    v_smfmac_f32_16x16x64_bf16 v[176:179], v[68:71], v[220:227], v45 abid:1
    v_smfmac_f32_16x16x64_bf16 v[176:179], v[104:107], v[228:235], v50
    v_smfmac_f32_16x16x64_bf16 v[180:183], v[72:75], v[220:227], v46
    s_mov_b32 m0, s89
    v_cvt_pk_bf16_f32 v160, v160, v161
    v_smfmac_f32_16x16x64_bf16 v[180:183], v[108:111], v[228:235], v50 abid:1
    s_waitcnt vmcnt(5)
    buffer_load_dwordx4 v5, s[8:11], s22 offen offset:0 nt lds
    v_cvt_pk_bf16_f32 v161, v162, v163
    v_smfmac_f32_16x16x64_bf16 v[184:187], v[76:79], v[220:227], v46 abid:1
    v_cvt_pk_bf16_f32 v162, v164, v165
    v_smfmac_f32_16x16x64_bf16 v[184:187], v[112:115], v[228:235], v51
    v_cvt_pk_bf16_f32 v163, v166, v167
    v_smfmac_f32_16x16x64_bf16 v[188:191], v[80:83], v[220:227], v47
    v_cvt_pk_bf16_f32 v168, v168, v169
    v_smfmac_f32_16x16x64_bf16 v[188:191], v[116:119], v[228:235], v51 abid:1
    v_cvt_pk_bf16_f32 v169, v170, v171
    v_smfmac_f32_16x16x64_bf16 v[192:195], v[84:87], v[220:227], v47 abid:1
    s_barrier
    v_cvt_pk_bf16_f32 v170, v172, v173
    v_smfmac_f32_16x16x64_bf16 v[192:195], v[120:123], v[228:235], v52
    ds_read_b128 v[220:223], v1 offset:3072
    s_waitcnt lgkmcnt(6)
    v_cvt_pk_bf16_f32 v171, v174, v175
    v_smfmac_f32_16x16x64_bf16 v[124:127], a[0:3], v[196:203], v12
    ds_read_b128 v[224:227], v2 offset:3072
    ds_read_b128 v[172:175], v9 offset:10032
    s_waitcnt lgkmcnt(6)
    v_cndmask_b32_dpp v164, v160, v168, vcc row_ror:8 row_mask:0xf bank_mask:0xf
    v_smfmac_f32_16x16x64_bf16 v[124:127], a[36:39], v[204:211], v16 abid:1
    ds_read_b128 v[228:231], v1 offset:4096
    s_waitcnt lgkmcnt(5)
    v_cndmask_b32_dpp v165, v161, v169, vcc row_ror:8 row_mask:0xf bank_mask:0xf
    v_smfmac_f32_16x16x64_bf16 v[124:127], a[72:75], v[212:219], v21
    ds_read_b128 v[232:235], v2 offset:4096
    v_cndmask_b32_dpp v166, v162, v170, vcc row_ror:8 row_mask:0xf bank_mask:0xf
    v_smfmac_f32_16x16x64_bf16 v[128:131], a[4:7], v[196:203], v12 abid:1
    s_add_u32 m0, m0, 896
    v_cndmask_b32_dpp v167, v163, v171, vcc row_ror:8 row_mask:0xf bank_mask:0xf
    v_smfmac_f32_16x16x64_bf16 v[128:131], a[40:43], v[204:211], v17
    s_waitcnt vmcnt(6)
    buffer_store_dwordx4 v[164:167], v6, s[12:15], s58 offen offset:0 sc1
    v_mov_b32_dpp v160, v168 row_ror:8 row_mask:0xf bank_mask:0xc
    v_smfmac_f32_16x16x64_bf16 v[128:131], a[76:79], v[212:219], v21 abid:1
    s_waitcnt vmcnt(5)
    buffer_load_dwordx4 v5, s[8:11], s22 offen offset:128 nt lds
    s_waitcnt lgkmcnt(5)
    v_xad_u32 v236, v236, v3, v4
    v_smfmac_f32_16x16x64_bf16 v[132:135], a[8:11], v[196:203], v13
    ds_read2st64_b32 v[244:245], v236 offset0:0 offset1:72
    v_xad_u32 v237, v237, v3, v4
    v_smfmac_f32_16x16x64_bf16 v[132:135], a[44:47], v[204:211], v17 abid:1
    ds_read2st64_b32 v[246:247], v237 offset0:0 offset1:72
    v_xad_u32 v238, v238, v3, v4
    v_smfmac_f32_16x16x64_bf16 v[132:135], a[80:83], v[212:219], v22
    ds_read2st64_b32 v[248:249], v238 offset0:0 offset1:72
    v_xad_u32 v239, v239, v3, v4
    v_smfmac_f32_16x16x64_bf16 v[136:139], a[12:15], v[196:203], v13 abid:1
    ds_read2st64_b32 v[250:251], v239 offset0:0 offset1:72
    v_mov_b32_dpp v161, v169 row_ror:8 row_mask:0xf bank_mask:0xc
    v_smfmac_f32_16x16x64_bf16 v[136:139], a[48:51], v[204:211], v18
    ds_read_b128 v[236:239], v9 offset:9216
    ds_read_b128 v[240:243], v8 offset:8192
    v_mov_b32_dpp v162, v170 row_ror:8 row_mask:0xf bank_mask:0xc
    v_smfmac_f32_16x16x64_bf16 v[136:139], a[84:87], v[212:219], v22 abid:1
    v_mov_b32_dpp v163, v171 row_ror:8 row_mask:0xf bank_mask:0xc
    v_smfmac_f32_16x16x64_bf16 v[140:143], a[16:19], v[196:203], v14
    s_waitcnt vmcnt(6)
    buffer_store_dwordx4 v[160:163], v6, s[12:15], s23 offen offset:0 sc1
    ds_read_b128 v[164:167], v9 offset:9904
    v_smfmac_f32_16x16x64_bf16 v[140:143], a[52:55], v[204:211], v18 abid:1
    ds_read_b128 v[168:171], v9 offset:9968
    ds_read_b128 v[160:163], v9 offset:9840
    v_cvt_pk_bf16_f32 v192, v192, v193
    v_smfmac_f32_16x16x64_bf16 v[140:143], a[88:91], v[212:219], v23
    v_cvt_pk_bf16_f32 v193, v194, v195
    v_smfmac_f32_16x16x64_bf16 v[144:147], a[20:23], v[196:203], v14 abid:1
    ds_write_b64 v252, v[192:193] offset:0
    ds_read_b128 v[192:195], v9 offset:10352
    v_smfmac_f32_16x16x64_bf16 v[144:147], a[56:59], v[204:211], v19
    v_smfmac_f32_16x16x64_bf16 v[144:147], a[92:95], v[212:219], v23 abid:1
    s_waitcnt lgkmcnt(5)
    v_xad_u32 v236, v236, v3, v4
    v_smfmac_f32_16x16x64_bf16 v[156:159], v[240:243], v[244:251], v10
    s_waitcnt lgkmcnt(0)
    v_xad_u32 v237, v237, v3, v4
    v_smfmac_f32_16x16x64_bf16 v[192:195], v[240:243], v[244:251], v10 abid:1
    ds_read2st64_b32 v[244:245], v236 offset0:0 offset1:72
    v_xad_u32 v238, v238, v3, v4
    v_smfmac_f32_16x16x64_bf16 v[148:151], a[24:27], v[196:203], v15
    ds_read2st64_b32 v[246:247], v237 offset0:0 offset1:72
    v_xad_u32 v239, v239, v3, v4
    v_smfmac_f32_16x16x64_bf16 v[148:151], a[60:63], v[204:211], v19 abid:1
    ds_read2st64_b32 v[248:249], v238 offset0:0 offset1:72
    v_smfmac_f32_16x16x64_bf16 v[148:151], a[96:99], v[212:219], v24
    ds_read2st64_b32 v[250:251], v239 offset0:0 offset1:72
    s_add_u32 m0, m0, 896
    v_smfmac_f32_16x16x64_bf16 v[152:155], a[28:31], v[196:203], v15 abid:1
    ds_read_b128 v[236:239], v9 offset:9280
    ds_read_b128 v[240:243], v8 offset:0
    s_waitcnt vmcnt(5)
    v_smfmac_f32_16x16x64_bf16 v[152:155], a[64:67], v[204:211], v20
    buffer_load_dwordx4 v5, s[8:11], s22 offen offset:256 nt lds
    v_smfmac_f32_16x16x64_bf16 v[152:155], a[100:103], v[212:219], v24 abid:1
    v_smfmac_f32_16x16x64_bf16 v[156:159], a[32:35], v[196:203], v16
    v_smfmac_f32_16x16x64_bf16 v[156:159], a[68:71], v[204:211], v20 abid:1
    v_smfmac_f32_16x16x64_bf16 v[156:159], a[104:107], v[212:219], v25
    ds_read_b128 v[196:199], v1 offset:5120
    v_cvt_pk_bf16_f32 v176, v176, v177
    v_smfmac_f32_16x16x64_bf16 v[124:127], a[108:111], v[220:227], v25 abid:1
    ds_read_b128 v[200:203], v2 offset:5120
    v_cvt_pk_bf16_f32 v177, v178, v179
    v_smfmac_f32_16x16x64_bf16 v[124:127], a[144:147], v[228:235], v30
    ds_read_b128 v[204:207], v1 offset:6144
    v_cvt_pk_bf16_f32 v178, v180, v181
    v_smfmac_f32_16x16x64_bf16 v[128:131], a[112:115], v[220:227], v26
    ds_read_b128 v[208:211], v2 offset:6144
    v_cvt_pk_bf16_f32 v179, v182, v183
    v_smfmac_f32_16x16x64_bf16 v[128:131], a[148:151], v[228:235], v30 abid:1
    s_waitcnt lgkmcnt(4)
    v_xad_u32 v236, v236, v3, v4
    v_smfmac_f32_16x16x64_bf16 v[124:127], v[240:243], v[244:251], v10
    s_add_u32 m0, m0, 896
    v_xad_u32 v237, v237, v3, v4
    v_smfmac_f32_16x16x64_bf16 v[160:163], v[240:243], v[244:251], v10 abid:1
    ds_read2st64_b32 v[244:245], v236 offset0:0 offset1:72
    s_waitcnt vmcnt(5)
    v_xad_u32 v238, v238, v3, v4
    v_smfmac_f32_16x16x64_bf16 v[132:135], a[116:119], v[220:227], v26 abid:1
    ds_read2st64_b32 v[246:247], v237 offset0:0 offset1:72
    buffer_load_dwordx4 v5, s[8:11], s22 offen offset:384 nt lds
    v_xad_u32 v239, v239, v3, v4
    v_smfmac_f32_16x16x64_bf16 v[132:135], a[152:155], v[228:235], v31
    ds_read2st64_b32 v[248:249], v238 offset0:0 offset1:72
    v_cvt_pk_bf16_f32 v184, v184, v185
    v_smfmac_f32_16x16x64_bf16 v[136:139], a[120:123], v[220:227], v27
    ds_read2st64_b32 v[250:251], v239 offset0:0 offset1:72
    v_cvt_pk_bf16_f32 v185, v186, v187
    v_smfmac_f32_16x16x64_bf16 v[136:139], a[156:159], v[228:235], v31 abid:1
    ds_read_b128 v[236:239], v9 offset:9344
    ds_read_b128 v[240:243], v8 offset:1024
    v_cvt_pk_bf16_f32 v186, v188, v189
    v_smfmac_f32_16x16x64_bf16 v[140:143], a[124:127], v[220:227], v27 abid:1
    v_cvt_pk_bf16_f32 v187, v190, v191
    v_smfmac_f32_16x16x64_bf16 v[140:143], a[160:163], v[228:235], v32
    ds_read_b128 v[188:191], v9 offset:10288
    v_cndmask_b32_dpp v180, v176, v184, vcc row_ror:8 row_mask:0xf bank_mask:0xf
    v_smfmac_f32_16x16x64_bf16 v[144:147], a[128:131], v[220:227], v28
    v_cndmask_b32_dpp v181, v177, v185, vcc row_ror:8 row_mask:0xf bank_mask:0xf
    v_smfmac_f32_16x16x64_bf16 v[144:147], a[164:167], v[228:235], v32 abid:1
    v_cndmask_b32_dpp v182, v178, v186, vcc row_ror:8 row_mask:0xf bank_mask:0xf
    v_smfmac_f32_16x16x64_bf16 v[148:151], a[132:135], v[220:227], v28 abid:1
    v_cndmask_b32_dpp v183, v179, v187, vcc row_ror:8 row_mask:0xf bank_mask:0xf
    v_smfmac_f32_16x16x64_bf16 v[148:151], a[168:171], v[228:235], v33
    s_waitcnt vmcnt(6)
    buffer_store_dwordx4 v[180:183], v6, s[12:15], s58 offen offset:128 sc1
    v_mov_b32_dpp v176, v184 row_ror:8 row_mask:0xf bank_mask:0xc
    v_smfmac_f32_16x16x64_bf16 v[152:155], a[136:139], v[220:227], v29
    v_mov_b32_dpp v177, v185 row_ror:8 row_mask:0xf bank_mask:0xc
    v_smfmac_f32_16x16x64_bf16 v[152:155], a[172:175], v[228:235], v33 abid:1
    s_waitcnt lgkmcnt(1)
    v_xad_u32 v236, v236, v3, v4
    v_smfmac_f32_16x16x64_bf16 v[128:131], v[240:243], v[244:251], v10
    v_xad_u32 v237, v237, v3, v4
    v_smfmac_f32_16x16x64_bf16 v[164:167], v[240:243], v[244:251], v10 abid:1
    ds_read2st64_b32 v[244:245], v236 offset0:0 offset1:72
    v_xad_u32 v238, v238, v3, v4
    v_smfmac_f32_16x16x64_bf16 v[156:159], a[140:143], v[220:227], v29 abid:1
    ds_read2st64_b32 v[246:247], v237 offset0:0 offset1:72
    v_xad_u32 v239, v239, v3, v4
    v_smfmac_f32_16x16x64_bf16 v[156:159], a[176:179], v[228:235], v34
    ds_read_b128 v[220:223], v1 offset:7168
    ds_read2st64_b32 v[248:249], v238 offset0:0 offset1:72
    v_mov_b32_dpp v178, v186 row_ror:8 row_mask:0xf bank_mask:0xc
    v_smfmac_f32_16x16x64_bf16 v[124:127], a[180:183], v[196:203], v34 abid:1
    ds_read_b128 v[224:227], v2 offset:7168
    ds_read2st64_b32 v[250:251], v239 offset0:0 offset1:72
    v_mov_b32_dpp v179, v187 row_ror:8 row_mask:0xf bank_mask:0xc
    v_smfmac_f32_16x16x64_bf16 v[124:127], a[216:219], v[204:211], v39
    ds_read_b128 v[228:231], v1 offset:8192
    ds_read_b128 v[236:239], v9 offset:9408
    s_waitcnt vmcnt(6)
    v_smfmac_f32_16x16x64_bf16 v[128:131], a[184:187], v[196:203], v35
    ds_read_b128 v[232:235], v2 offset:8192
    ds_read_b128 v[240:243], v8 offset:2048
    buffer_store_dwordx4 v[176:179], v6, s[12:15], s23 offen offset:128 sc1
    v_smfmac_f32_16x16x64_bf16 v[128:131], a[220:223], v[204:211], v39 abid:1
    ds_read_b128 v[180:183], v9 offset:10160
    ds_read_b128 v[184:187], v9 offset:10224
    ds_read_b128 v[176:179], v9 offset:10096
    v_smfmac_f32_16x16x64_bf16 v[132:135], a[188:191], v[196:203], v35 abid:1
    v_smfmac_f32_16x16x64_bf16 v[132:135], a[224:227], v[204:211], v40
    s_add_u32 m0, m0, 896
    v_smfmac_f32_16x16x64_bf16 v[136:139], a[192:195], v[196:203], v36
    s_waitcnt vmcnt(5)
    buffer_load_dwordx4 v5, s[8:11], s22 offen offset:512 nt lds
    v_smfmac_f32_16x16x64_bf16 v[136:139], a[228:231], v[204:211], v40 abid:1
    v_smfmac_f32_16x16x64_bf16 v[140:143], a[196:199], v[196:203], v36 abid:1
    v_smfmac_f32_16x16x64_bf16 v[140:143], a[232:235], v[204:211], v41
    s_waitcnt lgkmcnt(3)
    v_xad_u32 v236, v236, v3, v4
    v_smfmac_f32_16x16x64_bf16 v[132:135], v[240:243], v[244:251], v10
    v_xad_u32 v237, v237, v3, v4
    v_smfmac_f32_16x16x64_bf16 v[168:171], v[240:243], v[244:251], v10 abid:1
    ds_read2st64_b32 v[244:245], v236 offset0:0 offset1:72
    v_xad_u32 v238, v238, v3, v4
    v_smfmac_f32_16x16x64_bf16 v[144:147], a[200:203], v[196:203], v37
    ds_read2st64_b32 v[246:247], v237 offset0:0 offset1:72
    v_xad_u32 v239, v239, v3, v4
    v_smfmac_f32_16x16x64_bf16 v[144:147], a[236:239], v[204:211], v41 abid:1
    ds_read2st64_b32 v[248:249], v238 offset0:0 offset1:72
    v_smfmac_f32_16x16x64_bf16 v[148:151], a[204:207], v[196:203], v37 abid:1
    ds_read2st64_b32 v[250:251], v239 offset0:0 offset1:72
    v_smfmac_f32_16x16x64_bf16 v[148:151], a[240:243], v[204:211], v42
    ds_read_b128 v[236:239], v9 offset:9472
    ds_read_b128 v[240:243], v8 offset:3072
    v_smfmac_f32_16x16x64_bf16 v[152:155], a[208:211], v[196:203], v38
    s_add_u32 m0, m0, 896
    v_smfmac_f32_16x16x64_bf16 v[152:155], a[244:247], v[204:211], v42 abid:1
    s_waitcnt vmcnt(5)
    buffer_load_dwordx4 v5, s[8:11], s22 offen offset:640 nt lds
    v_smfmac_f32_16x16x64_bf16 v[156:159], a[212:215], v[196:203], v38 abid:1
    v_smfmac_f32_16x16x64_bf16 v[156:159], a[248:251], v[204:211], v43
    ds_read_b128 v[196:199], v1 offset:18432
    v_smfmac_f32_16x16x64_bf16 v[124:127], a[252:255], v[220:227], v43 abid:1
    ds_read_b128 v[200:203], v2 offset:18432
    v_smfmac_f32_16x16x64_bf16 v[124:127], v[88:91], v[228:235], v48
    ds_read_b128 v[204:207], v1 offset:19456
    v_smfmac_f32_16x16x64_bf16 v[128:131], v[56:59], v[220:227], v44
    ds_read_b128 v[208:211], v2 offset:19456
    v_smfmac_f32_16x16x64_bf16 v[128:131], v[92:95], v[228:235], v48 abid:1
    ds_read_b128 v[212:215], v1 offset:20480
    s_waitcnt lgkmcnt(5)
    v_xad_u32 v236, v236, v3, v4
    v_smfmac_f32_16x16x64_bf16 v[136:139], v[240:243], v[244:251], v10
    ds_read_b128 v[216:219], v2 offset:20480
    v_xad_u32 v237, v237, v3, v4
    v_smfmac_f32_16x16x64_bf16 v[172:175], v[240:243], v[244:251], v10 abid:1
    ds_read2st64_b32 v[244:245], v236 offset0:0 offset1:72
    v_xad_u32 v238, v238, v3, v4
    v_smfmac_f32_16x16x64_bf16 v[132:135], v[60:63], v[220:227], v44 abid:1
    ds_read2st64_b32 v[246:247], v237 offset0:0 offset1:72
    v_xad_u32 v239, v239, v3, v4
    v_smfmac_f32_16x16x64_bf16 v[132:135], v[96:99], v[228:235], v49
    ds_read2st64_b32 v[248:249], v238 offset0:0 offset1:72
    s_add_u32 m0, m0, 896
    v_smfmac_f32_16x16x64_bf16 v[136:139], v[64:67], v[220:227], v45
    ds_read2st64_b32 v[250:251], v239 offset0:0 offset1:72
    s_waitcnt vmcnt(5)
    buffer_load_dwordx4 v5, s[8:11], s22 offen offset:768 nt lds
    v_smfmac_f32_16x16x64_bf16 v[136:139], v[100:103], v[228:235], v49 abid:1
    ds_read_b128 v[236:239], v9 offset:9536
    ds_read_b128 v[240:243], v8 offset:4096
    v_smfmac_f32_16x16x64_bf16 v[140:143], v[68:71], v[220:227], v45 abid:1
    v_smfmac_f32_16x16x64_bf16 v[140:143], v[104:107], v[228:235], v50
    v_mov_b32 v0, 1
    v_smfmac_f32_16x16x64_bf16 v[144:147], v[72:75], v[220:227], v46
    s_waitcnt vmcnt(6)
    buffer_atomic_add v0, v253, s[16:19], s92 offen sc0 sc1
    v_smfmac_f32_16x16x64_bf16 v[144:147], v[108:111], v[228:235], v50 abid:1
    v_smfmac_f32_16x16x64_bf16 v[148:151], v[76:79], v[220:227], v46 abid:1
    v_smfmac_f32_16x16x64_bf16 v[148:151], v[112:115], v[228:235], v51
    v_smfmac_f32_16x16x64_bf16 v[152:155], v[80:83], v[220:227], v47
    v_smfmac_f32_16x16x64_bf16 v[152:155], v[116:119], v[228:235], v51 abid:1
    s_waitcnt lgkmcnt(0)
    v_xad_u32 v236, v236, v3, v4
    v_smfmac_f32_16x16x64_bf16 v[140:143], v[240:243], v[244:251], v10
    v_xad_u32 v237, v237, v3, v4
    v_smfmac_f32_16x16x64_bf16 v[176:179], v[240:243], v[244:251], v10 abid:1
    s_cmp_lg_u32 s27, 0
    s_cbranch_scc1 M_slow
M_slowr:
    v_xad_u32 v238, v238, v3, v4
    v_smfmac_f32_16x16x64_bf16 v[156:159], v[84:87], v[220:227], v47 abid:1
    ds_read2st64_b32 v[244:245], v236 offset0:0 offset1:72
    v_xad_u32 v239, v239, v3, v4
    v_smfmac_f32_16x16x64_bf16 v[156:159], v[120:123], v[228:235], v52
    ds_read_b128 v[220:223], v1 offset:21504
    ds_read2st64_b32 v[246:247], v237 offset0:0 offset1:72
    v_smfmac_f32_16x16x64_bf16 v[160:163], a[0:3], v[196:203], v12
    ds_read_b128 v[224:227], v2 offset:21504
    ds_read2st64_b32 v[248:249], v238 offset0:0 offset1:72
    v_smfmac_f32_16x16x64_bf16 v[160:163], a[36:39], v[204:211], v16 abid:1
    ds_read_b128 v[228:231], v1 offset:22528
    ds_read2st64_b32 v[250:251], v239 offset0:0 offset1:72
    v_smfmac_f32_16x16x64_bf16 v[160:163], a[72:75], v[212:219], v21
    ds_read_b128 v[232:235], v2 offset:22528
    ds_read_b128 v[236:239], v9 offset:9600
    v_smfmac_f32_16x16x64_bf16 v[164:167], a[4:7], v[196:203], v12 abid:1
    ds_read_b128 v[240:243], v8 offset:5120
    v_cvt_pk_bf16_f32 v156, v156, v157
    v_smfmac_f32_16x16x64_bf16 v[164:167], a[40:43], v[204:211], v17
    s_add_u32 m0, m0, 896
    v_cvt_pk_bf16_f32 v157, v158, v159
    v_smfmac_f32_16x16x64_bf16 v[164:167], a[76:79], v[212:219], v21 abid:1
    ds_write_b64 v252, v[156:157] offset:26144
    ds_read_b128 v[156:159], v9 offset:10352
    s_waitcnt vmcnt(5)
    v_smfmac_f32_16x16x64_bf16 v[168:171], a[8:11], v[196:203], v13
    buffer_load_dwordx4 v5, s[8:11], s22 offen offset:896 nt lds
    v_smfmac_f32_16x16x64_bf16 v[168:171], a[44:47], v[204:211], v17 abid:1
    v_cvt_pk_bf16_f32 v124, v124, v125
    v_smfmac_f32_16x16x64_bf16 v[168:171], a[80:83], v[212:219], v22
    s_waitcnt lgkmcnt(2)
    v_xad_u32 v236, v236, v3, v4
    v_smfmac_f32_16x16x64_bf16 v[144:147], v[240:243], v[244:251], v10
    v_xad_u32 v237, v237, v3, v4
    v_smfmac_f32_16x16x64_bf16 v[180:183], v[240:243], v[244:251], v10 abid:1
    ds_read2st64_b32 v[244:245], v236 offset0:0 offset1:72
    v_xad_u32 v238, v238, v3, v4
    v_smfmac_f32_16x16x64_bf16 v[172:175], a[12:15], v[196:203], v13 abid:1
    ds_read2st64_b32 v[246:247], v237 offset0:0 offset1:72
    v_xad_u32 v239, v239, v3, v4
    v_smfmac_f32_16x16x64_bf16 v[172:175], a[48:51], v[204:211], v18
    ds_read2st64_b32 v[248:249], v238 offset0:0 offset1:72
    v_cvt_pk_bf16_f32 v125, v126, v127
    v_smfmac_f32_16x16x64_bf16 v[172:175], a[84:87], v[212:219], v22 abid:1
    ds_read2st64_b32 v[250:251], v239 offset0:0 offset1:72
    v_cvt_pk_bf16_f32 v126, v128, v129
    v_smfmac_f32_16x16x64_bf16 v[176:179], a[16:19], v[196:203], v14
    ds_read_b128 v[236:239], v9 offset:9664
    ds_read_b128 v[240:243], v8 offset:6144
    v_cvt_pk_bf16_f32 v127, v130, v131
    v_smfmac_f32_16x16x64_bf16 v[176:179], a[52:55], v[204:211], v18 abid:1
    s_add_u32 m0, m0, 896
    v_cvt_pk_bf16_f32 v132, v132, v133
    v_smfmac_f32_16x16x64_bf16 v[176:179], a[88:91], v[212:219], v23
    s_waitcnt vmcnt(5)
    buffer_load_dwordx4 v5, s[8:11], s22 offen offset:1024 nt lds
    v_cvt_pk_bf16_f32 v133, v134, v135
    v_smfmac_f32_16x16x64_bf16 v[180:183], a[20:23], v[196:203], v14 abid:1
    v_cvt_pk_bf16_f32 v134, v136, v137
    v_smfmac_f32_16x16x64_bf16 v[180:183], a[56:59], v[204:211], v19
    v_cvt_pk_bf16_f32 v135, v138, v139
    v_smfmac_f32_16x16x64_bf16 v[180:183], a[92:95], v[212:219], v23 abid:1
    ds_read_b128 v[136:139], v9 offset:10032
    v_cndmask_b32_dpp v128, v124, v132, vcc row_ror:8 row_mask:0xf bank_mask:0xf
    v_smfmac_f32_16x16x64_bf16 v[184:187], a[24:27], v[196:203], v15
    v_cndmask_b32_dpp v129, v125, v133, vcc row_ror:8 row_mask:0xf bank_mask:0xf
    v_smfmac_f32_16x16x64_bf16 v[184:187], a[60:63], v[204:211], v19 abid:1
    v_cndmask_b32_dpp v130, v126, v134, vcc row_ror:8 row_mask:0xf bank_mask:0xf
    v_smfmac_f32_16x16x64_bf16 v[184:187], a[96:99], v[212:219], v24
    s_waitcnt lgkmcnt(1)
    v_xad_u32 v236, v236, v3, v4
    v_smfmac_f32_16x16x64_bf16 v[148:151], v[240:243], v[244:251], v10
    v_xad_u32 v237, v237, v3, v4
    v_smfmac_f32_16x16x64_bf16 v[184:187], v[240:243], v[244:251], v10 abid:1
    ds_read2st64_b32 v[244:245], v236 offset0:0 offset1:72
    v_xad_u32 v238, v238, v3, v4
    v_smfmac_f32_16x16x64_bf16 v[188:191], a[28:31], v[196:203], v15 abid:1
    ds_read2st64_b32 v[246:247], v237 offset0:0 offset1:72
    v_xad_u32 v239, v239, v3, v4
    v_smfmac_f32_16x16x64_bf16 v[188:191], a[64:67], v[204:211], v20
    ds_read2st64_b32 v[248:249], v238 offset0:0 offset1:72
    v_cndmask_b32_dpp v131, v127, v135, vcc row_ror:8 row_mask:0xf bank_mask:0xf
    v_smfmac_f32_16x16x64_bf16 v[188:191], a[100:103], v[212:219], v24 abid:1
    ds_read2st64_b32 v[250:251], v239 offset0:0 offset1:72
    s_waitcnt vmcnt(6)
    buffer_store_dwordx4 v[128:131], v6, s[12:15], s59 offen offset:0 sc1
    v_smfmac_f32_16x16x64_bf16 v[192:195], a[32:35], v[196:203], v16
    ds_read_b128 v[240:243], v8 offset:7168
    v_mov_b32_dpp v124, v132 row_ror:8 row_mask:0xf bank_mask:0xc
    v_smfmac_f32_16x16x64_bf16 v[192:195], a[68:71], v[204:211], v20 abid:1
    v_mov_b32_dpp v125, v133 row_ror:8 row_mask:0xf bank_mask:0xc
    v_smfmac_f32_16x16x64_bf16 v[192:195], a[104:107], v[212:219], v25
    ds_read_b128 v[196:199], v1 offset:23552
    v_mov_b32_dpp v126, v134 row_ror:8 row_mask:0xf bank_mask:0xc
    v_smfmac_f32_16x16x64_bf16 v[160:163], a[108:111], v[220:227], v25 abid:1
    ds_read_b128 v[200:203], v2 offset:23552
    v_mov_b32_dpp v127, v135 row_ror:8 row_mask:0xf bank_mask:0xc
    v_smfmac_f32_16x16x64_bf16 v[160:163], a[144:147], v[228:235], v30
    ds_read_b128 v[204:207], v1 offset:24576
    s_waitcnt vmcnt(6)
    buffer_store_dwordx4 v[124:127], v6, s[12:15], s24 offen offset:0 sc1
    v_smfmac_f32_16x16x64_bf16 v[164:167], a[112:115], v[220:227], v26
    ds_read_b128 v[208:211], v2 offset:24576
    ds_read_b128 v[128:131], v9 offset:9904
    ds_read_b128 v[132:135], v9 offset:9968
    v_smfmac_f32_16x16x64_bf16 v[164:167], a[148:151], v[228:235], v30 abid:1
    ds_read_b128 v[124:127], v9 offset:9840
    v_smfmac_f32_16x16x64_bf16 v[168:171], a[116:119], v[220:227], v26 abid:1
    v_smfmac_f32_16x16x64_bf16 v[168:171], a[152:155], v[228:235], v31
    s_waitcnt lgkmcnt(7)
    v_smfmac_f32_16x16x64_bf16 v[152:155], v[240:243], v[244:251], v10
    v_smfmac_f32_16x16x64_bf16 v[188:191], v[240:243], v[244:251], v10 abid:1
    v_smfmac_f32_16x16x64_bf16 v[172:175], a[120:123], v[220:227], v27
    v_smfmac_f32_16x16x64_bf16 v[172:175], a[156:159], v[228:235], v31 abid:1
    v_smfmac_f32_16x16x64_bf16 v[176:179], a[124:127], v[220:227], v27 abid:1
    v_smfmac_f32_16x16x64_bf16 v[176:179], a[160:163], v[228:235], v32
    v_smfmac_f32_16x16x64_bf16 v[180:183], a[128:131], v[220:227], v28
    v_smfmac_f32_16x16x64_bf16 v[180:183], a[164:167], v[228:235], v32 abid:1
    v_cvt_pk_bf16_f32 v140, v140, v141
    v_smfmac_f32_16x16x64_bf16 v[184:187], a[132:135], v[220:227], v28 abid:1
    v_cvt_pk_bf16_f32 v141, v142, v143
    v_smfmac_f32_16x16x64_bf16 v[184:187], a[168:171], v[228:235], v33
    v_cvt_pk_bf16_f32 v142, v144, v145
    v_smfmac_f32_16x16x64_bf16 v[188:191], a[136:139], v[220:227], v29
    s_add_u32 s28, s28, 36864
    s_cmp_ge_u32 s28, 110592
    v_cvt_pk_bf16_f32 v143, v146, v147
    v_smfmac_f32_16x16x64_bf16 v[188:191], a[172:175], v[228:235], v33 abid:1
    s_cselect_b32 s28, s26, s28
    s_add_u32 s30, s25, 36864
    v_cvt_pk_bf16_f32 v148, v148, v149
    v_smfmac_f32_16x16x64_bf16 v[192:195], a[140:143], v[220:227], v29 abid:1
    s_cmp_eq_u32 s30, 110592
    s_cselect_b32 s30, 0, s30
    v_cvt_pk_bf16_f32 v149, v150, v151
    v_smfmac_f32_16x16x64_bf16 v[192:195], a[176:179], v[228:235], v34
    ds_read_b128 v[220:223], v1 offset:25600
    s_sub_u32 s31, s30, s25
    s_waitcnt lgkmcnt(6)
    v_cvt_pk_bf16_f32 v150, v152, v153
    v_smfmac_f32_16x16x64_bf16 v[160:163], a[180:183], v[196:203], v34 abid:1
    ds_read_b128 v[224:227], v2 offset:25600
    s_mov_b32 s25, s30
    s_waitcnt lgkmcnt(5)
    v_cvt_pk_bf16_f32 v151, v154, v155
    v_smfmac_f32_16x16x64_bf16 v[160:163], a[216:219], v[204:211], v39
    ds_read_b128 v[228:231], v1 offset:26624
    ds_read_b128 v[152:155], v9 offset:10288
    v_cndmask_b32_dpp v144, v140, v148, vcc row_ror:8 row_mask:0xf bank_mask:0xf
    v_smfmac_f32_16x16x64_bf16 v[164:167], a[184:187], v[196:203], v35
    ds_read_b128 v[232:235], v2 offset:26624
    s_mov_b32 s89, s28
    v_cndmask_b32_dpp v145, v141, v149, vcc row_ror:8 row_mask:0xf bank_mask:0xf
    v_smfmac_f32_16x16x64_bf16 v[164:167], a[220:223], v[204:211], v39 abid:1
    s_mov_b32 s90, s22
    s_mov_b32 s88, 75497472
    v_cndmask_b32_dpp v146, v142, v150, vcc row_ror:8 row_mask:0xf bank_mask:0xf
    v_smfmac_f32_16x16x64_bf16 v[168:171], a[188:191], v[196:203], v35 abid:1
    s_cmp_lt_u32 s20, 2
    s_cselect_b32 s66, s23, s24
    v_cndmask_b32_dpp v147, v143, v151, vcc row_ror:8 row_mask:0xf bank_mask:0xf
    v_smfmac_f32_16x16x64_bf16 v[168:171], a[224:227], v[204:211], v40
    s_waitcnt vmcnt(6)
    buffer_store_dwordx4 v[144:147], v6, s[12:15], s59 offen offset:128 sc1
    v_mov_b32_dpp v140, v148 row_ror:8 row_mask:0xf bank_mask:0xc
    v_smfmac_f32_16x16x64_bf16 v[172:175], a[192:195], v[196:203], v36
    s_waitcnt vmcnt(5)
    s_add_u32 s66, s66, s95
    v_mul_u32_u24 v0, s94, v0
    v_smfmac_f32_16x16x64_bf16 v[172:175], a[228:231], v[204:211], v40 abid:1
    v_add_u32 v0, s93, v0
    v_smfmac_f32_16x16x64_bf16 v[176:179], a[196:199], v[196:203], v36 abid:1
    v_min_u32 v0, 75497472, v0
    v_smfmac_f32_16x16x64_bf16 v[176:179], a[232:235], v[204:211], v41
    ds_write_b32 v253, v0
    v_mov_b32 v0, 162880
    v_smfmac_f32_16x16x64_bf16 v[180:183], a[200:203], v[196:203], v37
    v_mov_b32_dpp v141, v149 row_ror:8 row_mask:0xf bank_mask:0xc
    v_smfmac_f32_16x16x64_bf16 v[180:183], a[236:239], v[204:211], v41 abid:1
    v_mov_b32_dpp v142, v150 row_ror:8 row_mask:0xf bank_mask:0xc
    v_smfmac_f32_16x16x64_bf16 v[184:187], a[204:207], v[196:203], v37 abid:1
    v_mov_b32_dpp v143, v151 row_ror:8 row_mask:0xf bank_mask:0xc
    v_smfmac_f32_16x16x64_bf16 v[184:187], a[240:243], v[204:211], v42
    s_waitcnt vmcnt(6)
    buffer_store_dwordx4 v[140:143], v6, s[12:15], s24 offen offset:128 sc1
    ds_read_b128 v[144:147], v9 offset:10160
    v_smfmac_f32_16x16x64_bf16 v[188:191], a[208:211], v[196:203], v38
    ds_read_b128 v[148:151], v9 offset:10224
    ds_read_b128 v[140:143], v9 offset:10096
    v_add_u32 v4, s31, v4
    v_smfmac_f32_16x16x64_bf16 v[188:191], a[244:247], v[204:211], v42 abid:1
    v_add_u32 v1, s31, v1
    v_smfmac_f32_16x16x64_bf16 v[192:195], a[212:215], v[196:203], v38 abid:1
    v_add_u32 v2, s31, v2
    v_smfmac_f32_16x16x64_bf16 v[192:195], a[248:251], v[204:211], v43
    s_cmp_lt_u32 s90, 75497472
    s_cbranch_scc1 M_top
    s_add_u32 s23, s24, 18432
    s_add_u32 s58, s24, 27648
    s_waitcnt lgkmcnt(0)
    s_barrier
    ds_read_b128 v[244:247], v8 offset:12048
    v_smfmac_f32_16x16x64_bf16 v[192:195], v[84:87], v[220:227], v47 abid:1
    v_smfmac_f32_16x16x64_bf16 v[192:195], v[120:123], v[228:235], v52
    v_smfmac_f32_16x16x64_bf16 v[160:163], a[252:255], v[220:227], v43 abid:1
    v_smfmac_f32_16x16x64_bf16 v[160:163], v[88:91], v[228:235], v48
    v_smfmac_f32_16x16x64_bf16 v[164:167], v[56:59], v[220:227], v44
    s_waitcnt lgkmcnt(0)
    buffer_store_dwordx4 v[244:247], v7, s[12:15], s66 offen sc1
    s_barrier
    s_add_u32 s66, s23, s95
    v_smfmac_f32_16x16x64_bf16 v[164:167], v[92:95], v[228:235], v48 abid:1
    v_smfmac_f32_16x16x64_bf16 v[168:171], v[60:63], v[220:227], v44 abid:1
    v_smfmac_f32_16x16x64_bf16 v[168:171], v[96:99], v[228:235], v49
    v_cvt_pk_bf16_f32 v192, v192, v193
    v_smfmac_f32_16x16x64_bf16 v[172:175], v[64:67], v[220:227], v45
    v_cvt_pk_bf16_f32 v193, v194, v195
    v_smfmac_f32_16x16x64_bf16 v[172:175], v[100:103], v[228:235], v49 abid:1
    ds_write_b64 v252, v[192:193] offset:0
    v_smfmac_f32_16x16x64_bf16 v[176:179], v[68:71], v[220:227], v45 abid:1
    v_smfmac_f32_16x16x64_bf16 v[176:179], v[104:107], v[228:235], v50
    v_cvt_pk_bf16_f32 v160, v160, v161
    v_smfmac_f32_16x16x64_bf16 v[180:183], v[72:75], v[220:227], v46
    s_waitcnt lgkmcnt(0)
    s_barrier
    ds_read_b128 v[244:247], v8 offset:12048
    v_smfmac_f32_16x16x64_bf16 v[180:183], v[108:111], v[228:235], v50 abid:1
    v_cvt_pk_bf16_f32 v161, v162, v163
    v_smfmac_f32_16x16x64_bf16 v[184:187], v[76:79], v[220:227], v46 abid:1
    v_cvt_pk_bf16_f32 v162, v164, v165
    v_smfmac_f32_16x16x64_bf16 v[184:187], v[112:115], v[228:235], v51
    v_cvt_pk_bf16_f32 v163, v166, v167
    v_smfmac_f32_16x16x64_bf16 v[188:191], v[80:83], v[220:227], v47
    v_cvt_pk_bf16_f32 v168, v168, v169
    v_smfmac_f32_16x16x64_bf16 v[188:191], v[116:119], v[228:235], v51 abid:1
    v_cvt_pk_bf16_f32 v169, v170, v171
    v_cvt_pk_bf16_f32 v170, v172, v173
    v_cvt_pk_bf16_f32 v171, v174, v175
    v_cndmask_b32_dpp v164, v160, v168, vcc row_ror:8 row_mask:0xf bank_mask:0xf
    v_cndmask_b32_dpp v165, v161, v169, vcc row_ror:8 row_mask:0xf bank_mask:0xf
    v_cndmask_b32_dpp v166, v162, v170, vcc row_ror:8 row_mask:0xf bank_mask:0xf
    v_cndmask_b32_dpp v167, v163, v171, vcc row_ror:8 row_mask:0xf bank_mask:0xf
    buffer_store_dwordx4 v[164:167], v6, s[12:15], s58 offen offset:0 sc1
    v_mov_b32_dpp v160, v168 row_ror:8 row_mask:0xf bank_mask:0xc
    v_mov_b32_dpp v161, v169 row_ror:8 row_mask:0xf bank_mask:0xc
    v_mov_b32_dpp v162, v170 row_ror:8 row_mask:0xf bank_mask:0xc
    v_mov_b32_dpp v163, v171 row_ror:8 row_mask:0xf bank_mask:0xc
    buffer_store_dwordx4 v[160:163], v6, s[12:15], s23 offen offset:0 sc1
    v_cvt_pk_bf16_f32 v176, v176, v177
    v_cvt_pk_bf16_f32 v177, v178, v179
    v_cvt_pk_bf16_f32 v178, v180, v181
    v_cvt_pk_bf16_f32 v179, v182, v183
    v_cvt_pk_bf16_f32 v184, v184, v185
    v_cvt_pk_bf16_f32 v185, v186, v187
    v_cvt_pk_bf16_f32 v186, v188, v189
    v_cvt_pk_bf16_f32 v187, v190, v191
    v_cndmask_b32_dpp v180, v176, v184, vcc row_ror:8 row_mask:0xf bank_mask:0xf
    v_cndmask_b32_dpp v181, v177, v185, vcc row_ror:8 row_mask:0xf bank_mask:0xf
    v_cndmask_b32_dpp v182, v178, v186, vcc row_ror:8 row_mask:0xf bank_mask:0xf
    v_cndmask_b32_dpp v183, v179, v187, vcc row_ror:8 row_mask:0xf bank_mask:0xf
    buffer_store_dwordx4 v[180:183], v6, s[12:15], s58 offen offset:128 sc1
    v_mov_b32_dpp v176, v184 row_ror:8 row_mask:0xf bank_mask:0xc
    v_mov_b32_dpp v177, v185 row_ror:8 row_mask:0xf bank_mask:0xc
    v_mov_b32_dpp v178, v186 row_ror:8 row_mask:0xf bank_mask:0xc
    v_mov_b32_dpp v179, v187 row_ror:8 row_mask:0xf bank_mask:0xc
    buffer_store_dwordx4 v[176:179], v6, s[12:15], s23 offen offset:128 sc1
    s_cmp_lt_u32 s20, 2
    s_cbranch_scc0 M_fin
    s_waitcnt lgkmcnt(0)
    buffer_store_dwordx4 v[244:247], v7, s[12:15], s66 offen sc1
M_fin:
M_end:
    s_endpgm
M_pf_spin:
    s_sleep 1
    buffer_load_dword v0, off, s[16:19], s96 sc1
    s_add_u32 s31, s31, 1
    s_waitcnt vmcnt(0)
    v_readfirstlane_b32 s30, v0
    s_nop 0
    s_sub_u32 s30, s30, s100
    s_cmp_eq_u32 s30, 21
    s_cbranch_scc1 M_pf_ok
    s_cmp_lt_u32 s31, 24
    s_cbranch_scc1 M_pf_spin
M_pf_spin2:
    s_sleep 4
    buffer_load_dword v0, off, s[68:71], 0 offset:128 sc1
    s_add_u32 s31, s31, 1
    s_cmp_ge_u32 s31, 131072
    s_cbranch_scc1 M_end
    s_waitcnt vmcnt(0)
    v_readfirstlane_b32 s30, v0
    s_nop 0
    s_cmp_eq_u32 s30, 1
    s_cbranch_scc0 M_pf_spin2
    s_branch M_pf_ok
M_pc_spin:
    s_sleep 1
    buffer_load_dword v0, off, s[16:19], s97 sc1
    s_add_u32 s31, s31, 1
    s_waitcnt vmcnt(0)
    v_readfirstlane_b32 s30, v0
    s_nop 0
    s_sub_u32 s30, s30, s101
    s_cmp_eq_u32 s30, 9
    s_cbranch_scc1 M_pc_ok
    s_cmp_lt_u32 s31, 24
    s_cbranch_scc1 M_pc_spin
M_pc_spin2:
    s_sleep 4
    buffer_load_dword v0, off, s[68:71], 0 offset:192 sc1
    s_add_u32 s31, s31, 1
    s_cmp_ge_u32 s31, 131072
    s_cbranch_scc1 M_end
    s_waitcnt vmcnt(0)
    v_readfirstlane_b32 s30, v0
    s_nop 0
    s_cmp_eq_u32 s30, 1
    s_cbranch_scc0 M_pc_spin2
    s_branch M_pc_ok
M_xlate:
    s_mov_b32 m0, s42
    s_nop 0
    buffer_load_dwordx4 v5, s[8:11], s22 offen offset:0 nt lds
    s_add_u32 m0, m0, 896
    s_nop 0
    buffer_load_dwordx4 v5, s[8:11], s22 offen offset:128 nt lds
    s_add_u32 m0, m0, 896
    s_nop 0
    buffer_load_dwordx4 v5, s[8:11], s22 offen offset:256 nt lds
    s_add_u32 m0, m0, 896
    s_nop 0
    buffer_load_dwordx4 v5, s[8:11], s22 offen offset:384 nt lds
    s_add_u32 m0, m0, 896
    s_nop 0
    buffer_load_dwordx4 v5, s[8:11], s22 offen offset:512 nt lds
    s_add_u32 m0, m0, 896
    s_nop 0
    buffer_load_dwordx4 v5, s[8:11], s22 offen offset:640 nt lds
    s_add_u32 m0, m0, 896
    s_nop 0
    buffer_load_dwordx4 v5, s[8:11], s22 offen offset:768 nt lds
    s_add_u32 m0, m0, 896
    s_nop 0
    buffer_load_dwordx4 v5, s[8:11], s22 offen offset:896 nt lds
    s_add_u32 m0, m0, 896
    s_nop 0
    buffer_load_dwordx4 v5, s[8:11], s22 offen offset:1024 nt lds
    s_add_u32 s22, s22, 9437184
    s_add_u32 s42, s42, 36864
    s_branch M_xlater
M_pool:
    v_readfirstlane_b32 s32, v244
    v_readfirstlane_b32 s33, v245
    v_readfirstlane_b32 s34, v246
    v_readfirstlane_b32 s35, v247
    v_readfirstlane_b32 s36, v248
    v_readfirstlane_b32 s37, v249
    v_readfirstlane_b32 s38, v250
    v_readfirstlane_b32 s39, v251
    v_readfirstlane_b32 s40, v240
    s_mov_b32 s27, 0
    s_add_u32 s54, s29, 10416
    s_mul_i32 s55, s20, 78336
    s_add_u32 s55, s55, 416256
    s_mov_b32 exec_hi, 3
    s_min_u32 s32, s32, 16
    s_mov_b32 s44, s27
    s_mov_b32 s56, 0
M_pool0:
    s_cmp_lt_u32 s56, s32
    s_cbranch_scc0 M_poole0
    s_add_u32 s57, s27, s56
    s_cmp_lt_u32 s57, 3
    s_cbranch_scc0 M_poole0
    s_mul_i32 s57, s57, 544
    s_add_u32 m0, s57, s54
    s_add_u32 s57, s56, 0
    s_mul_i32 s57, s57, 544
    s_add_u32 s57, s57, s55
    buffer_load_dwordx4 v11, s[16:19], s57 offen sc1 lds
    s_add_u32 s56, s56, 1
    s_branch M_pool0
M_poole0:
    s_add_u32 s27, s27, s32
    s_min_u32 s33, s33, 16
    s_mov_b32 s45, s27
    s_mov_b32 s56, 0
M_pool1:
    s_cmp_lt_u32 s56, s33
    s_cbranch_scc0 M_poole1
    s_add_u32 s57, s27, s56
    s_cmp_lt_u32 s57, 3
    s_cbranch_scc0 M_poole1
    s_mul_i32 s57, s57, 544
    s_add_u32 m0, s57, s54
    s_add_u32 s57, s56, 16
    s_mul_i32 s57, s57, 544
    s_add_u32 s57, s57, s55
    buffer_load_dwordx4 v11, s[16:19], s57 offen sc1 lds
    s_add_u32 s56, s56, 1
    s_branch M_pool1
M_poole1:
    s_add_u32 s27, s27, s33
    s_min_u32 s34, s34, 16
    s_mov_b32 s46, s27
    s_mov_b32 s56, 0
M_pool2:
    s_cmp_lt_u32 s56, s34
    s_cbranch_scc0 M_poole2
    s_add_u32 s57, s27, s56
    s_cmp_lt_u32 s57, 3
    s_cbranch_scc0 M_poole2
    s_mul_i32 s57, s57, 544
    s_add_u32 m0, s57, s54
    s_add_u32 s57, s56, 32
    s_mul_i32 s57, s57, 544
    s_add_u32 s57, s57, s55
    buffer_load_dwordx4 v11, s[16:19], s57 offen sc1 lds
    s_add_u32 s56, s56, 1
    s_branch M_pool2
M_poole2:
    s_add_u32 s27, s27, s34
    s_min_u32 s35, s35, 16
    s_mov_b32 s47, s27
    s_mov_b32 s56, 0
M_pool3:
    s_cmp_lt_u32 s56, s35
    s_cbranch_scc0 M_poole3
    s_add_u32 s57, s27, s56
    s_cmp_lt_u32 s57, 3
    s_cbranch_scc0 M_poole3
    s_mul_i32 s57, s57, 544
    s_add_u32 m0, s57, s54
    s_add_u32 s57, s56, 48
    s_mul_i32 s57, s57, 544
    s_add_u32 s57, s57, s55
    buffer_load_dwordx4 v11, s[16:19], s57 offen sc1 lds
    s_add_u32 s56, s56, 1
    s_branch M_pool3
M_poole3:
    s_add_u32 s27, s27, s35
    s_min_u32 s36, s36, 16
    s_mov_b32 s48, s27
    s_mov_b32 s56, 0
M_pool4:
    s_cmp_lt_u32 s56, s36
    s_cbranch_scc0 M_poole4
    s_add_u32 s57, s27, s56
    s_cmp_lt_u32 s57, 3
    s_cbranch_scc0 M_poole4
    s_mul_i32 s57, s57, 544
    s_add_u32 m0, s57, s54
    s_add_u32 s57, s56, 64
    s_mul_i32 s57, s57, 544
    s_add_u32 s57, s57, s55
    buffer_load_dwordx4 v11, s[16:19], s57 offen sc1 lds
    s_add_u32 s56, s56, 1
    s_branch M_pool4
M_poole4:
    s_add_u32 s27, s27, s36
    s_min_u32 s37, s37, 16
    s_mov_b32 s49, s27
    s_mov_b32 s56, 0
M_pool5:
    s_cmp_lt_u32 s56, s37
    s_cbranch_scc0 M_poole5
    s_add_u32 s57, s27, s56
    s_cmp_lt_u32 s57, 3
    s_cbranch_scc0 M_poole5
    s_mul_i32 s57, s57, 544
    s_add_u32 m0, s57, s54
    s_add_u32 s57, s56, 80
    s_mul_i32 s57, s57, 544
    s_add_u32 s57, s57, s55
    buffer_load_dwordx4 v11, s[16:19], s57 offen sc1 lds
    s_add_u32 s56, s56, 1
    s_branch M_pool5
M_poole5:
    s_add_u32 s27, s27, s37
    s_min_u32 s38, s38, 16
    s_mov_b32 s50, s27
    s_mov_b32 s56, 0
M_pool6:
    s_cmp_lt_u32 s56, s38
    s_cbranch_scc0 M_poole6
    s_add_u32 s57, s27, s56
    s_cmp_lt_u32 s57, 3
    s_cbranch_scc0 M_poole6
    s_mul_i32 s57, s57, 544
    s_add_u32 m0, s57, s54
    s_add_u32 s57, s56, 96
    s_mul_i32 s57, s57, 544
    s_add_u32 s57, s57, s55
    buffer_load_dwordx4 v11, s[16:19], s57 offen sc1 lds
    s_add_u32 s56, s56, 1
    s_branch M_pool6
M_poole6:
    s_add_u32 s27, s27, s38
    s_min_u32 s39, s39, 16
    s_mov_b32 s51, s27
    s_mov_b32 s56, 0
M_pool7:
    s_cmp_lt_u32 s56, s39
    s_cbranch_scc0 M_poole7
    s_add_u32 s57, s27, s56
    s_cmp_lt_u32 s57, 3
    s_cbranch_scc0 M_poole7
    s_mul_i32 s57, s57, 544
    s_add_u32 m0, s57, s54
    s_add_u32 s57, s56, 112
    s_mul_i32 s57, s57, 544
    s_add_u32 s57, s57, s55
    buffer_load_dwordx4 v11, s[16:19], s57 offen sc1 lds
    s_add_u32 s56, s56, 1
    s_branch M_pool7
M_poole7:
    s_add_u32 s27, s27, s39
    s_min_u32 s40, s40, 16
    s_mov_b32 s52, s27
    s_mov_b32 s56, 0
M_pool8:
    s_cmp_lt_u32 s56, s40
    s_cbranch_scc0 M_poole8
    s_add_u32 s57, s27, s56
    s_cmp_lt_u32 s57, 3
    s_cbranch_scc0 M_poole8
    s_mul_i32 s57, s57, 544
    s_add_u32 m0, s57, s54
    s_add_u32 s57, s56, 128
    s_mul_i32 s57, s57, 544
    s_add_u32 s57, s57, s55
    buffer_load_dwordx4 v11, s[16:19], s57 offen sc1 lds
    s_add_u32 s56, s56, 1
    s_branch M_pool8
M_poole8:
    s_add_u32 s27, s27, s40
    s_mov_b32 exec_hi, -1
    s_branch M_poolr
M_slow:
    s_mov_b32 s56, 0
M_sl0:
    s_cmp_lt_u32 s56, s32
    s_cbranch_scc0 M_sle0
    s_add_u32 s57, s44, s56
    s_cmp_lt_u32 s57, 3
    s_cbranch_scc0 M_slg0
    s_mul_i32 s57, s57, 544
    s_add_u32 s57, s57, s54
    v_add_u32 v248, s57, v55
    v_add_u32 v249, s57, v54
    ds_read_b64 v[240:241], v248
    ds_read_b64 v[242:243], v249
    s_waitcnt lgkmcnt(0)
    s_branch M_slc0
M_slg0:
    s_add_u32 s57, s56, 0
    s_mul_i32 s57, s57, 544
    s_add_u32 s57, s57, s55
    buffer_load_dwordx2 v[240:241], v55, s[16:19], s57 offen sc1
    buffer_load_dwordx2 v[242:243], v54, s[16:19], s57 offen sc1
    s_waitcnt vmcnt(0)
M_slc0:
    v_xad_u32 v240, v240, v3, v4
    v_xad_u32 v241, v241, v3, v4
    ds_read2st64_b32 v[244:245], v240 offset0:0 offset1:72
    ds_read2st64_b32 v[246:247], v241 offset0:0 offset1:72
    s_add_u32 s56, s56, 1
    s_nop 7
    s_waitcnt lgkmcnt(0)
    v_smfmac_f32_16x16x32_bf16 v[124:127], v[242:243], v[244:247], v10
    v_smfmac_f32_16x16x32_bf16 v[160:163], v[242:243], v[244:247], v10 abid:2
    s_branch M_sl0
M_sle0:
    s_mov_b32 s56, 0
M_sl1:
    s_cmp_lt_u32 s56, s33
    s_cbranch_scc0 M_sle1
    s_add_u32 s57, s45, s56
    s_cmp_lt_u32 s57, 3
    s_cbranch_scc0 M_slg1
    s_mul_i32 s57, s57, 544
    s_add_u32 s57, s57, s54
    v_add_u32 v248, s57, v55
    v_add_u32 v249, s57, v54
    ds_read_b64 v[240:241], v248
    ds_read_b64 v[242:243], v249
    s_waitcnt lgkmcnt(0)
    s_branch M_slc1
M_slg1:
    s_add_u32 s57, s56, 16
    s_mul_i32 s57, s57, 544
    s_add_u32 s57, s57, s55
    buffer_load_dwordx2 v[240:241], v55, s[16:19], s57 offen sc1
    buffer_load_dwordx2 v[242:243], v54, s[16:19], s57 offen sc1
    s_waitcnt vmcnt(0)
M_slc1:
    v_xad_u32 v240, v240, v3, v4
    v_xad_u32 v241, v241, v3, v4
    ds_read2st64_b32 v[244:245], v240 offset0:0 offset1:72
    ds_read2st64_b32 v[246:247], v241 offset0:0 offset1:72
    s_add_u32 s56, s56, 1
    s_nop 7
    s_waitcnt lgkmcnt(0)
    v_smfmac_f32_16x16x32_bf16 v[128:131], v[242:243], v[244:247], v10
    v_smfmac_f32_16x16x32_bf16 v[164:167], v[242:243], v[244:247], v10 abid:2
    s_branch M_sl1
M_sle1:
    s_mov_b32 s56, 0
M_sl2:
    s_cmp_lt_u32 s56, s34
    s_cbranch_scc0 M_sle2
    s_add_u32 s57, s46, s56
    s_cmp_lt_u32 s57, 3
    s_cbranch_scc0 M_slg2
    s_mul_i32 s57, s57, 544
    s_add_u32 s57, s57, s54
    v_add_u32 v248, s57, v55
    v_add_u32 v249, s57, v54
    ds_read_b64 v[240:241], v248
    ds_read_b64 v[242:243], v249
    s_waitcnt lgkmcnt(0)
    s_branch M_slc2
M_slg2:
    s_add_u32 s57, s56, 32
    s_mul_i32 s57, s57, 544
    s_add_u32 s57, s57, s55
    buffer_load_dwordx2 v[240:241], v55, s[16:19], s57 offen sc1
    buffer_load_dwordx2 v[242:243], v54, s[16:19], s57 offen sc1
    s_waitcnt vmcnt(0)
M_slc2:
    v_xad_u32 v240, v240, v3, v4
    v_xad_u32 v241, v241, v3, v4
    ds_read2st64_b32 v[244:245], v240 offset0:0 offset1:72
    ds_read2st64_b32 v[246:247], v241 offset0:0 offset1:72
    s_add_u32 s56, s56, 1
    s_nop 7
    s_waitcnt lgkmcnt(0)
    v_smfmac_f32_16x16x32_bf16 v[132:135], v[242:243], v[244:247], v10
    v_smfmac_f32_16x16x32_bf16 v[168:171], v[242:243], v[244:247], v10 abid:2
    s_branch M_sl2
M_sle2:
    s_mov_b32 s56, 0
M_sl3:
    s_cmp_lt_u32 s56, s35
    s_cbranch_scc0 M_sle3
    s_add_u32 s57, s47, s56
    s_cmp_lt_u32 s57, 3
    s_cbranch_scc0 M_slg3
    s_mul_i32 s57, s57, 544
    s_add_u32 s57, s57, s54
    v_add_u32 v248, s57, v55
    v_add_u32 v249, s57, v54
    ds_read_b64 v[240:241], v248
    ds_read_b64 v[242:243], v249
    s_waitcnt lgkmcnt(0)
    s_branch M_slc3
M_slg3:
    s_add_u32 s57, s56, 48
    s_mul_i32 s57, s57, 544
    s_add_u32 s57, s57, s55
    buffer_load_dwordx2 v[240:241], v55, s[16:19], s57 offen sc1
    buffer_load_dwordx2 v[242:243], v54, s[16:19], s57 offen sc1
    s_waitcnt vmcnt(0)
M_slc3:
    v_xad_u32 v240, v240, v3, v4
    v_xad_u32 v241, v241, v3, v4
    ds_read2st64_b32 v[244:245], v240 offset0:0 offset1:72
    ds_read2st64_b32 v[246:247], v241 offset0:0 offset1:72
    s_add_u32 s56, s56, 1
    s_nop 7
    s_waitcnt lgkmcnt(0)
    v_smfmac_f32_16x16x32_bf16 v[136:139], v[242:243], v[244:247], v10
    v_smfmac_f32_16x16x32_bf16 v[172:175], v[242:243], v[244:247], v10 abid:2
    s_branch M_sl3
M_sle3:
    s_mov_b32 s56, 0
M_sl4:
    s_cmp_lt_u32 s56, s36
    s_cbranch_scc0 M_sle4
    s_add_u32 s57, s48, s56
    s_cmp_lt_u32 s57, 3
    s_cbranch_scc0 M_slg4
    s_mul_i32 s57, s57, 544
    s_add_u32 s57, s57, s54
    v_add_u32 v248, s57, v55
    v_add_u32 v249, s57, v54
    ds_read_b64 v[240:241], v248
    ds_read_b64 v[242:243], v249
    s_waitcnt lgkmcnt(0)
    s_branch M_slc4
M_slg4:
    s_add_u32 s57, s56, 64
    s_mul_i32 s57, s57, 544
    s_add_u32 s57, s57, s55
    buffer_load_dwordx2 v[240:241], v55, s[16:19], s57 offen sc1
    buffer_load_dwordx2 v[242:243], v54, s[16:19], s57 offen sc1
    s_waitcnt vmcnt(0)
M_slc4:
    v_xad_u32 v240, v240, v3, v4
    v_xad_u32 v241, v241, v3, v4
    ds_read2st64_b32 v[244:245], v240 offset0:0 offset1:72
    ds_read2st64_b32 v[246:247], v241 offset0:0 offset1:72
    s_add_u32 s56, s56, 1
    s_nop 7
    s_waitcnt lgkmcnt(0)
    v_smfmac_f32_16x16x32_bf16 v[140:143], v[242:243], v[244:247], v10
    v_smfmac_f32_16x16x32_bf16 v[176:179], v[242:243], v[244:247], v10 abid:2
    s_branch M_sl4
M_sle4:
    s_mov_b32 s56, 0
M_sl5:
    s_cmp_lt_u32 s56, s37
    s_cbranch_scc0 M_sle5
    s_add_u32 s57, s49, s56
    s_cmp_lt_u32 s57, 3
    s_cbranch_scc0 M_slg5
    s_mul_i32 s57, s57, 544
    s_add_u32 s57, s57, s54
    v_add_u32 v248, s57, v55
    v_add_u32 v249, s57, v54
    ds_read_b64 v[240:241], v248
    ds_read_b64 v[242:243], v249
    s_waitcnt lgkmcnt(0)
    s_branch M_slc5
M_slg5:
    s_add_u32 s57, s56, 80
    s_mul_i32 s57, s57, 544
    s_add_u32 s57, s57, s55
    buffer_load_dwordx2 v[240:241], v55, s[16:19], s57 offen sc1
    buffer_load_dwordx2 v[242:243], v54, s[16:19], s57 offen sc1
    s_waitcnt vmcnt(0)
M_slc5:
    v_xad_u32 v240, v240, v3, v4
    v_xad_u32 v241, v241, v3, v4
    ds_read2st64_b32 v[244:245], v240 offset0:0 offset1:72
    ds_read2st64_b32 v[246:247], v241 offset0:0 offset1:72
    s_add_u32 s56, s56, 1
    s_nop 7
    s_waitcnt lgkmcnt(0)
    v_smfmac_f32_16x16x32_bf16 v[144:147], v[242:243], v[244:247], v10
    v_smfmac_f32_16x16x32_bf16 v[180:183], v[242:243], v[244:247], v10 abid:2
    s_branch M_sl5
M_sle5:
    s_mov_b32 s56, 0
M_sl6:
    s_cmp_lt_u32 s56, s38
    s_cbranch_scc0 M_sle6
    s_add_u32 s57, s50, s56
    s_cmp_lt_u32 s57, 3
    s_cbranch_scc0 M_slg6
    s_mul_i32 s57, s57, 544
    s_add_u32 s57, s57, s54
    v_add_u32 v248, s57, v55
    v_add_u32 v249, s57, v54
    ds_read_b64 v[240:241], v248
    ds_read_b64 v[242:243], v249
    s_waitcnt lgkmcnt(0)
    s_branch M_slc6
M_slg6:
    s_add_u32 s57, s56, 96
    s_mul_i32 s57, s57, 544
    s_add_u32 s57, s57, s55
    buffer_load_dwordx2 v[240:241], v55, s[16:19], s57 offen sc1
    buffer_load_dwordx2 v[242:243], v54, s[16:19], s57 offen sc1
    s_waitcnt vmcnt(0)
M_slc6:
    v_xad_u32 v240, v240, v3, v4
    v_xad_u32 v241, v241, v3, v4
    ds_read2st64_b32 v[244:245], v240 offset0:0 offset1:72
    ds_read2st64_b32 v[246:247], v241 offset0:0 offset1:72
    s_add_u32 s56, s56, 1
    s_nop 7
    s_waitcnt lgkmcnt(0)
    v_smfmac_f32_16x16x32_bf16 v[148:151], v[242:243], v[244:247], v10
    v_smfmac_f32_16x16x32_bf16 v[184:187], v[242:243], v[244:247], v10 abid:2
    s_branch M_sl6
M_sle6:
    s_mov_b32 s56, 0
M_sl7:
    s_cmp_lt_u32 s56, s39
    s_cbranch_scc0 M_sle7
    s_add_u32 s57, s51, s56
    s_cmp_lt_u32 s57, 3
    s_cbranch_scc0 M_slg7
    s_mul_i32 s57, s57, 544
    s_add_u32 s57, s57, s54
    v_add_u32 v248, s57, v55
    v_add_u32 v249, s57, v54
    ds_read_b64 v[240:241], v248
    ds_read_b64 v[242:243], v249
    s_waitcnt lgkmcnt(0)
    s_branch M_slc7
M_slg7:
    s_add_u32 s57, s56, 112
    s_mul_i32 s57, s57, 544
    s_add_u32 s57, s57, s55
    buffer_load_dwordx2 v[240:241], v55, s[16:19], s57 offen sc1
    buffer_load_dwordx2 v[242:243], v54, s[16:19], s57 offen sc1
    s_waitcnt vmcnt(0)
M_slc7:
    v_xad_u32 v240, v240, v3, v4
    v_xad_u32 v241, v241, v3, v4
    ds_read2st64_b32 v[244:245], v240 offset0:0 offset1:72
    ds_read2st64_b32 v[246:247], v241 offset0:0 offset1:72
    s_add_u32 s56, s56, 1
    s_nop 7
    s_waitcnt lgkmcnt(0)
    v_smfmac_f32_16x16x32_bf16 v[152:155], v[242:243], v[244:247], v10
    v_smfmac_f32_16x16x32_bf16 v[188:191], v[242:243], v[244:247], v10 abid:2
    s_branch M_sl7
M_sle7:
    s_mov_b32 s56, 0
M_sl8:
    s_cmp_lt_u32 s56, s40
    s_cbranch_scc0 M_sle8
    s_add_u32 s57, s52, s56
    s_cmp_lt_u32 s57, 3
    s_cbranch_scc0 M_slg8
    s_mul_i32 s57, s57, 544
    s_add_u32 s57, s57, s54
    v_add_u32 v248, s57, v55
    v_add_u32 v249, s57, v54
    ds_read_b64 v[240:241], v248
    ds_read_b64 v[242:243], v249
    s_waitcnt lgkmcnt(0)
    s_branch M_slc8
M_slg8:
    s_add_u32 s57, s56, 128
    s_mul_i32 s57, s57, 544
    s_add_u32 s57, s57, s55
    buffer_load_dwordx2 v[240:241], v55, s[16:19], s57 offen sc1
    buffer_load_dwordx2 v[242:243], v54, s[16:19], s57 offen sc1
    s_waitcnt vmcnt(0)
M_slc8:
    v_xad_u32 v240, v240, v3, v4
    v_xad_u32 v241, v241, v3, v4
    ds_read2st64_b32 v[244:245], v240 offset0:0 offset1:72
    ds_read2st64_b32 v[246:247], v241 offset0:0 offset1:72
    s_add_u32 s56, s56, 1
    s_nop 7
    s_waitcnt lgkmcnt(0)
    v_smfmac_f32_16x16x32_bf16 v[156:159], v[242:243], v[244:247], v10
    v_smfmac_f32_16x16x32_bf16 v[192:195], v[242:243], v[244:247], v10 abid:2
    s_branch M_sl8
M_sle8:
    s_nop 7
    s_cmp_eq_u32 s21, 0
    s_cbranch_scc1 M_slowr0
    s_branch M_slowr
F_task:
    s_mul_i32 s30, s2, 49
    s_lshr_b32 s30, s30, 10
    s_mul_i32 s31, s30, 21
    s_sub_u32 s35, s2, s31
    s_lshl_b32 s35, s35, 2
    s_add_u32 s35, s35, s20
    s_min_u32 s35, s35, 80
    s_mul_i32 s32, s35, 57
    s_lshr_b32 s32, s32, 9
    s_mul_i32 s31, s32, 9
    s_sub_u32 s31, s35, s31
    s_lshr_b32 s33, s31, 1
    s_lshl_b32 s33, s33, 5
    s_and_b32 s34, s31, 1
    s_lshl_b32 s34, s34, 2
    s_add_u32 s33, s33, s34
    s_lshl_b32 s34, s30, 7
    s_add_u32 s33, s33, s34
    s_lshl_b32 s34, s30, 4
    s_add_u32 s34, s34, 512
    s_cmp_lt_u32 s31, 8
    s_cselect_b32 s33, s33, s34
    s_cselect_b32 s34, 3, 2
    v_lshrrev_b32 v15, 2, v14
    v_lshlrev_b32 v15, s34, v15
    v_and_b32 v16, 3, v14
    v_add3_u32 v15, v15, v16, s33
    v_lshlrev_b32 v15, 1, v15
    v_mul_u32_u24 v16, 18432, v13
    v_add_u32 v15, v15, v16
    s_mul_i32 s36, s32, 73728
    s_add_u32 s37, s36, 4608
    s_add_u32 s38, s36, 9216
    s_add_u32 s39, s36, 13824
    s_waitcnt lgkmcnt(0)
    s_mov_b32 s4, s74
    s_mov_b32 s5, s75
    s_mov_b32 s16, s82
    s_mov_b32 s17, s83
    s_mov_b64 exec, 3
    buffer_load_dword v253, v253, s[16:19], s96 offen sc1
    s_mov_b64 exec, -1
    buffer_load_ushort v16, v15, s[4:7], s36 offen offset:0
    buffer_load_ushort v17, v15, s[4:7], s36 offen offset:1152
    buffer_load_ushort v18, v15, s[4:7], s36 offen offset:2304
    buffer_load_ushort v19, v15, s[4:7], s36 offen offset:3456
    buffer_load_ushort v20, v15, s[4:7], s37 offen offset:0
    buffer_load_ushort v21, v15, s[4:7], s37 offen offset:1152
    buffer_load_ushort v22, v15, s[4:7], s37 offen offset:2304
    buffer_load_ushort v23, v15, s[4:7], s37 offen offset:3456
    buffer_load_ushort v24, v15, s[4:7], s38 offen offset:0
    buffer_load_ushort v25, v15, s[4:7], s38 offen offset:1152
    buffer_load_ushort v26, v15, s[4:7], s38 offen offset:2304
    buffer_load_ushort v27, v15, s[4:7], s38 offen offset:3456
    buffer_load_ushort v28, v15, s[4:7], s39 offen offset:0
    buffer_load_ushort v29, v15, s[4:7], s39 offen offset:1152
    buffer_load_ushort v30, v15, s[4:7], s39 offen offset:2304
    buffer_load_ushort v31, v15, s[4:7], s39 offen offset:3456
    s_mov_b32 s68, s80
    s_mov_b32 s69, s81
    s_mov_b32 s36, 3437096686
    s_mov_b32 s37, 1150609561
    s_mov_b32 s38, 0x0202
    v_mov_b32 v41, 0x01000100
    v_mov_b32 v40, 0
    s_mul_i32 s39, s30, 81
    s_add_u32 s39, s39, s35
    s_lshl_b32 s39, s39, 10
    s_mul_i32 s40, s30, 21
    s_sub_u32 s40, s2, s40
    s_and_b32 s33, s40, 1
    s_lshr_b32 s40, s40, 1
    s_mul_i32 s34, s30, 11
    s_add_u32 s40, s40, s34
    s_lshl_b32 s40, s40, 10
    s_lshl_b32 s33, s33, 3
    s_add_u32 s40, s40, s33
    s_add_u32 s40, s40, 331776
    s_lshl_b32 s33, s20, 1
    v_add_u32 v42, s33, v54
    s_mov_b32 s41, 2
    s_waitcnt vmcnt(12)
    v_and_b32 v44, 0x7fff, v16
    v_and_b32 v45, 0x7fff, v17
    v_and_b32 v46, 0x7fff, v18
    v_and_b32 v47, 0x7fff, v19
    v_max_u32 v48, v44, v45
    v_min_u32 v49, v44, v45
    v_max_u32 v50, v46, v47
    v_min_u32 v51, v46, v47
    v_min_u32 v48, v48, v50
    v_max3_u32 v48, v48, v49, v51
    v_max_u32 v48, 1, v48
    v_sub_u32 v47, v47, v48
    v_sub_u32 v46, v46, v48
    v_sub_u32 v45, v45, v48
    v_sub_u32 v44, v44, v48
    v_lshrrev_b32 v49, 31, v47
    v_alignbit_b32 v49, v49, v46, 31
    v_alignbit_b32 v49, v49, v45, 31
    v_alignbit_b32 v49, v49, v44, 31
    v_lshlrev_b32 v50, 2, v49
    v_lshrrev_b64 v[52:53], v50, s[36:37]
    v_lshl_or_b32 v44, v17, 16, v16
    v_lshl_or_b32 v45, v19, 16, v18
    v_and_b32 v46, 3, v52
    v_bfe_u32 v47, v52, 2, 2
    v_and_b32 v52, 15, v52
    v_lshl_or_b32 v46, v47, 16, v46
    v_lshl_or_b32 v40, v52, 0, v40
    v_mad_u32_u24 v46, v46, s38, v41
    v_perm_b32 v32, v45, v44, v46
    s_waitcnt vmcnt(8)
    v_and_b32 v44, 0x7fff, v20
    v_and_b32 v45, 0x7fff, v21
    v_and_b32 v46, 0x7fff, v22
    v_and_b32 v47, 0x7fff, v23
    v_max_u32 v48, v44, v45
    v_min_u32 v49, v44, v45
    v_max_u32 v50, v46, v47
    v_min_u32 v51, v46, v47
    v_min_u32 v48, v48, v50
    v_max3_u32 v48, v48, v49, v51
    v_max_u32 v48, 1, v48
    v_sub_u32 v47, v47, v48
    v_sub_u32 v46, v46, v48
    v_sub_u32 v45, v45, v48
    v_sub_u32 v44, v44, v48
    v_lshrrev_b32 v49, 31, v47
    v_alignbit_b32 v49, v49, v46, 31
    v_alignbit_b32 v49, v49, v45, 31
    v_alignbit_b32 v49, v49, v44, 31
    v_lshlrev_b32 v50, 2, v49
    v_lshrrev_b64 v[52:53], v50, s[36:37]
    v_lshl_or_b32 v44, v21, 16, v20
    v_lshl_or_b32 v45, v23, 16, v22
    v_and_b32 v46, 3, v52
    v_bfe_u32 v47, v52, 2, 2
    v_and_b32 v52, 15, v52
    v_lshl_or_b32 v46, v47, 16, v46
    v_lshl_or_b32 v40, v52, 4, v40
    v_mad_u32_u24 v46, v46, s38, v41
    v_perm_b32 v33, v45, v44, v46
    s_waitcnt vmcnt(4)
    v_and_b32 v44, 0x7fff, v24
    v_and_b32 v45, 0x7fff, v25
    v_and_b32 v46, 0x7fff, v26
    v_and_b32 v47, 0x7fff, v27
    v_max_u32 v48, v44, v45
    v_min_u32 v49, v44, v45
    v_max_u32 v50, v46, v47
    v_min_u32 v51, v46, v47
    v_min_u32 v48, v48, v50
    v_max3_u32 v48, v48, v49, v51
    v_max_u32 v48, 1, v48
    v_sub_u32 v47, v47, v48
    v_sub_u32 v46, v46, v48
    v_sub_u32 v45, v45, v48
    v_sub_u32 v44, v44, v48
    v_lshrrev_b32 v49, 31, v47
    v_alignbit_b32 v49, v49, v46, 31
    v_alignbit_b32 v49, v49, v45, 31
    v_alignbit_b32 v49, v49, v44, 31
    v_lshlrev_b32 v50, 2, v49
    v_lshrrev_b64 v[52:53], v50, s[36:37]
    v_lshl_or_b32 v44, v25, 16, v24
    v_lshl_or_b32 v45, v27, 16, v26
    v_and_b32 v46, 3, v52
    v_bfe_u32 v47, v52, 2, 2
    v_and_b32 v52, 15, v52
    v_lshl_or_b32 v46, v47, 16, v46
    v_lshl_or_b32 v40, v52, 8, v40
    v_mad_u32_u24 v46, v46, s38, v41
    v_perm_b32 v34, v45, v44, v46
    s_waitcnt vmcnt(0)
    v_and_b32 v44, 0x7fff, v28
    v_and_b32 v45, 0x7fff, v29
    v_and_b32 v46, 0x7fff, v30
    v_and_b32 v47, 0x7fff, v31
    v_max_u32 v48, v44, v45
    v_min_u32 v49, v44, v45
    v_max_u32 v50, v46, v47
    v_min_u32 v51, v46, v47
    v_min_u32 v48, v48, v50
    v_max3_u32 v48, v48, v49, v51
    v_max_u32 v48, 1, v48
    v_sub_u32 v47, v47, v48
    v_sub_u32 v46, v46, v48
    v_sub_u32 v45, v45, v48
    v_sub_u32 v44, v44, v48
    v_lshrrev_b32 v49, 31, v47
    v_alignbit_b32 v49, v49, v46, 31
    v_alignbit_b32 v49, v49, v45, 31
    v_alignbit_b32 v49, v49, v44, 31
    v_lshlrev_b32 v50, 2, v49
    v_lshrrev_b64 v[52:53], v50, s[36:37]
    v_lshl_or_b32 v44, v29, 16, v28
    v_lshl_or_b32 v45, v31, 16, v30
    v_and_b32 v46, 3, v52
    v_bfe_u32 v47, v52, 2, 2
    v_and_b32 v52, 15, v52
    v_lshl_or_b32 v46, v47, 16, v46
    v_lshl_or_b32 v40, v52, 12, v40
    v_mad_u32_u24 v46, v46, s38, v41
    v_perm_b32 v35, v45, v44, v46
    ds_write_b16 v42, v40
    buffer_store_dwordx4 v[32:35], v11, s[16:19], s39 offen sc1
    s_waitcnt lgkmcnt(0)
    s_barrier
    s_cmp_lg_u32 s20, 0
    s_cbranch_scc1 F_sig
    ds_read_b64 v[36:37], v54
    s_waitcnt lgkmcnt(0)
    buffer_store_dwordx2 v[36:37], v11, s[16:19], s40 offen sc1
    s_cmp_lg_u32 s2, 0
    s_cbranch_scc1 F_sig
    v_mov_b32 v44, 0
    v_mov_b32 v45, 0
    v_mov_b32 v46, 0
    v_mov_b32 v47, 0
    s_mov_b32 s40, 730112
    buffer_store_dwordx4 v[44:47], v11, s[16:19], s40 offen sc1
F_sig:
    s_lshl_b32 s30, s30, 12
    s_add_u32 s30, s30, 731136
    v_lshlrev_b32 v17, 8, v12
    v_mov_b32 v16, 1
    s_waitcnt vmcnt(0)
    s_barrier
    s_cmp_lg_u32 s20, 0
    s_cbranch_scc1 M_x
    s_mov_b64 exec, 0xffff
    buffer_atomic_add v16, v17, s[16:19], s30 offen sc1
    s_mov_b64 exec, 1
    v_mov_b32 v252, 1
    s_mov_b32 s98, 83
    s_mov_b32 s99, 128
    buffer_atomic_add v252, off, s[68:71], 0 offset:0 sc0 sc1
    s_mov_b64 exec, -1
    s_branch M_x
C_task:
    s_sub_u32 s35, s2, 84
    s_mul_i32 s30, s35, 57
    s_lshr_b32 s30, s30, 9
    s_mul_i32 s31, s30, 9
    s_sub_u32 s31, s35, s31
    s_lshr_b32 s33, s31, 1
    s_lshl_b32 s33, s33, 5
    s_and_b32 s34, s31, 1
    s_lshl_b32 s34, s34, 2
    s_add_u32 s33, s33, s34
    s_lshl_b32 s34, s30, 7
    s_add_u32 s33, s33, s34
    s_lshl_b32 s34, s30, 4
    s_add_u32 s34, s34, 512
    s_cmp_lt_u32 s31, 8
    s_cselect_b32 s33, s33, s34
    s_cselect_b32 s34, 3, 2
    v_lshrrev_b32 v15, 2, v14
    v_lshlrev_b32 v15, s34, v15
    v_and_b32 v16, 3, v14
    v_add3_u32 v15, v15, v16, s33
    v_lshlrev_b32 v15, 1, v15
    v_lshrrev_b32 v17, 4, v0
    v_mul_u32_u24 v16, 4608, v17
    v_add_u32 v15, v15, v16
    s_mov_b32 s36, 0
    s_waitcnt lgkmcnt(0)
    s_mov_b32 s4, s74
    s_mov_b32 s5, s75
    s_mov_b32 s16, s82
    s_mov_b32 s17, s83
    s_mov_b64 exec, 3
    buffer_load_dword v253, v253, s[16:19], s96 offen sc1
    s_mov_b64 exec, -1
    buffer_load_ushort v60, v15, s[4:7], s36 offen offset:0
    buffer_load_ushort v61, v15, s[4:7], s36 offen offset:1152
    buffer_load_ushort v62, v15, s[4:7], s36 offen offset:2304
    buffer_load_ushort v63, v15, s[4:7], s36 offen offset:3456
    s_add_u32 s36, s36, 73728
    buffer_load_ushort v64, v15, s[4:7], s36 offen offset:0
    buffer_load_ushort v65, v15, s[4:7], s36 offen offset:1152
    buffer_load_ushort v66, v15, s[4:7], s36 offen offset:2304
    buffer_load_ushort v67, v15, s[4:7], s36 offen offset:3456
    s_add_u32 s36, s36, 73728
    buffer_load_ushort v68, v15, s[4:7], s36 offen offset:0
    buffer_load_ushort v69, v15, s[4:7], s36 offen offset:1152
    buffer_load_ushort v70, v15, s[4:7], s36 offen offset:2304
    buffer_load_ushort v71, v15, s[4:7], s36 offen offset:3456
    s_add_u32 s36, s36, 73728
    buffer_load_ushort v72, v15, s[4:7], s36 offen offset:0
    buffer_load_ushort v73, v15, s[4:7], s36 offen offset:1152
    buffer_load_ushort v74, v15, s[4:7], s36 offen offset:2304
    buffer_load_ushort v75, v15, s[4:7], s36 offen offset:3456
    s_add_u32 s36, s36, 73728
    buffer_load_ushort v76, v15, s[4:7], s36 offen offset:0
    buffer_load_ushort v77, v15, s[4:7], s36 offen offset:1152
    buffer_load_ushort v78, v15, s[4:7], s36 offen offset:2304
    buffer_load_ushort v79, v15, s[4:7], s36 offen offset:3456
    s_add_u32 s36, s36, 73728
    buffer_load_ushort v80, v15, s[4:7], s36 offen offset:0
    buffer_load_ushort v81, v15, s[4:7], s36 offen offset:1152
    buffer_load_ushort v82, v15, s[4:7], s36 offen offset:2304
    buffer_load_ushort v83, v15, s[4:7], s36 offen offset:3456
    s_add_u32 s36, s36, 73728
    buffer_load_ushort v84, v15, s[4:7], s36 offen offset:0
    buffer_load_ushort v85, v15, s[4:7], s36 offen offset:1152
    buffer_load_ushort v86, v15, s[4:7], s36 offen offset:2304
    buffer_load_ushort v87, v15, s[4:7], s36 offen offset:3456
    s_add_u32 s36, s36, 73728
    buffer_load_ushort v88, v15, s[4:7], s36 offen offset:0
    buffer_load_ushort v89, v15, s[4:7], s36 offen offset:1152
    buffer_load_ushort v90, v15, s[4:7], s36 offen offset:2304
    buffer_load_ushort v91, v15, s[4:7], s36 offen offset:3456
    s_add_u32 s36, s36, 73728
    buffer_load_ushort v92, v15, s[4:7], s36 offen offset:0
    buffer_load_ushort v93, v15, s[4:7], s36 offen offset:1152
    buffer_load_ushort v94, v15, s[4:7], s36 offen offset:2304
    buffer_load_ushort v95, v15, s[4:7], s36 offen offset:3456
    s_mov_b32 s68, s80
    s_mov_b32 s69, s81
    s_mov_b32 s41, 2
    v_lshlrev_b32 v18, 2, v0
    v_mov_b32 v19, 0
    ds_write_b32 v18, v19 offset:9216
    ds_write_b32 v18, v19 offset:9728
    v_mov_b32 v19, 144
    v_lshlrev_b32 v20, 1, v0
    v_and_b32 v20, 8, v20
    s_cmp_eq_u32 s20, 3
    s_cbranch_scc1 C_a
    ds_write_b32 v18, v19 offset:10752
    ds_write_b32 v18, v20 offset:11520
C_a:
    s_mov_b32 s37, 65819
    s_mov_b32 s38, 0xffff
    v_lshlrev_b32 v17, 2, v17
    s_waitcnt lgkmcnt(0)
    s_barrier
    s_waitcnt vmcnt(32)
    v_and_b32 v44, 0x7fff, v60
    v_and_b32 v45, 0x7fff, v61
    v_and_b32 v46, 0x7fff, v62
    v_and_b32 v47, 0x7fff, v63
    v_max_u32 v48, v44, v45
    v_min_u32 v49, v44, v45
    v_max_u32 v50, v46, v47
    v_min_u32 v51, v46, v47
    v_min_u32 v48, v48, v50
    v_max3_u32 v48, v48, v49, v51
    v_max_u32 v48, 1, v48
    v_sub_u32 v47, v47, v48
    v_sub_u32 v46, v46, v48
    v_sub_u32 v45, v45, v48
    v_sub_u32 v44, v44, v48
    v_lshrrev_b32 v49, 31, v47
    v_alignbit_b32 v49, v49, v46, 31
    v_alignbit_b32 v49, v49, v45, 31
    v_alignbit_b32 v49, v49, v44, 31
    v_lshlrev_b32 v50, 1, v49
    v_lshrrev_b32 v50, v50, s37
    v_lshl_or_b32 v44, v61, 16, v60
    v_and_b32 v46, 1, v50
    v_bfe_u32 v47, v50, 1, 1
    v_lshl_or_b32 v46, v47, 16, v46
    v_mul_u32_u24 v46, s38, v46
    v_and_b32 v44, v44, v46
    ds_write_b32 v18, v44 offset:0
    ds_or_b32 v17, v44 offset:9728
    s_waitcnt vmcnt(28)
    v_and_b32 v44, 0x7fff, v64
    v_and_b32 v45, 0x7fff, v65
    v_and_b32 v46, 0x7fff, v66
    v_and_b32 v47, 0x7fff, v67
    v_max_u32 v48, v44, v45
    v_min_u32 v49, v44, v45
    v_max_u32 v50, v46, v47
    v_min_u32 v51, v46, v47
    v_min_u32 v48, v48, v50
    v_max3_u32 v48, v48, v49, v51
    v_max_u32 v48, 1, v48
    v_sub_u32 v47, v47, v48
    v_sub_u32 v46, v46, v48
    v_sub_u32 v45, v45, v48
    v_sub_u32 v44, v44, v48
    v_lshrrev_b32 v49, 31, v47
    v_alignbit_b32 v49, v49, v46, 31
    v_alignbit_b32 v49, v49, v45, 31
    v_alignbit_b32 v49, v49, v44, 31
    v_lshlrev_b32 v50, 1, v49
    v_lshrrev_b32 v50, v50, s37
    v_lshl_or_b32 v44, v65, 16, v64
    v_and_b32 v46, 1, v50
    v_bfe_u32 v47, v50, 1, 1
    v_lshl_or_b32 v46, v47, 16, v46
    v_mul_u32_u24 v46, s38, v46
    v_and_b32 v44, v44, v46
    ds_write_b32 v18, v44 offset:1024
    ds_or_b32 v17, v44 offset:9792
    s_waitcnt vmcnt(24)
    v_and_b32 v44, 0x7fff, v68
    v_and_b32 v45, 0x7fff, v69
    v_and_b32 v46, 0x7fff, v70
    v_and_b32 v47, 0x7fff, v71
    v_max_u32 v48, v44, v45
    v_min_u32 v49, v44, v45
    v_max_u32 v50, v46, v47
    v_min_u32 v51, v46, v47
    v_min_u32 v48, v48, v50
    v_max3_u32 v48, v48, v49, v51
    v_max_u32 v48, 1, v48
    v_sub_u32 v47, v47, v48
    v_sub_u32 v46, v46, v48
    v_sub_u32 v45, v45, v48
    v_sub_u32 v44, v44, v48
    v_lshrrev_b32 v49, 31, v47
    v_alignbit_b32 v49, v49, v46, 31
    v_alignbit_b32 v49, v49, v45, 31
    v_alignbit_b32 v49, v49, v44, 31
    v_lshlrev_b32 v50, 1, v49
    v_lshrrev_b32 v50, v50, s37
    v_lshl_or_b32 v44, v69, 16, v68
    v_and_b32 v46, 1, v50
    v_bfe_u32 v47, v50, 1, 1
    v_lshl_or_b32 v46, v47, 16, v46
    v_mul_u32_u24 v46, s38, v46
    v_and_b32 v44, v44, v46
    ds_write_b32 v18, v44 offset:2048
    ds_or_b32 v17, v44 offset:9856
    s_waitcnt vmcnt(20)
    v_and_b32 v44, 0x7fff, v72
    v_and_b32 v45, 0x7fff, v73
    v_and_b32 v46, 0x7fff, v74
    v_and_b32 v47, 0x7fff, v75
    v_max_u32 v48, v44, v45
    v_min_u32 v49, v44, v45
    v_max_u32 v50, v46, v47
    v_min_u32 v51, v46, v47
    v_min_u32 v48, v48, v50
    v_max3_u32 v48, v48, v49, v51
    v_max_u32 v48, 1, v48
    v_sub_u32 v47, v47, v48
    v_sub_u32 v46, v46, v48
    v_sub_u32 v45, v45, v48
    v_sub_u32 v44, v44, v48
    v_lshrrev_b32 v49, 31, v47
    v_alignbit_b32 v49, v49, v46, 31
    v_alignbit_b32 v49, v49, v45, 31
    v_alignbit_b32 v49, v49, v44, 31
    v_lshlrev_b32 v50, 1, v49
    v_lshrrev_b32 v50, v50, s37
    v_lshl_or_b32 v44, v73, 16, v72
    v_and_b32 v46, 1, v50
    v_bfe_u32 v47, v50, 1, 1
    v_lshl_or_b32 v46, v47, 16, v46
    v_mul_u32_u24 v46, s38, v46
    v_and_b32 v44, v44, v46
    ds_write_b32 v18, v44 offset:3072
    ds_or_b32 v17, v44 offset:9920
    s_waitcnt vmcnt(16)
    v_and_b32 v44, 0x7fff, v76
    v_and_b32 v45, 0x7fff, v77
    v_and_b32 v46, 0x7fff, v78
    v_and_b32 v47, 0x7fff, v79
    v_max_u32 v48, v44, v45
    v_min_u32 v49, v44, v45
    v_max_u32 v50, v46, v47
    v_min_u32 v51, v46, v47
    v_min_u32 v48, v48, v50
    v_max3_u32 v48, v48, v49, v51
    v_max_u32 v48, 1, v48
    v_sub_u32 v47, v47, v48
    v_sub_u32 v46, v46, v48
    v_sub_u32 v45, v45, v48
    v_sub_u32 v44, v44, v48
    v_lshrrev_b32 v49, 31, v47
    v_alignbit_b32 v49, v49, v46, 31
    v_alignbit_b32 v49, v49, v45, 31
    v_alignbit_b32 v49, v49, v44, 31
    v_lshlrev_b32 v50, 1, v49
    v_lshrrev_b32 v50, v50, s37
    v_lshl_or_b32 v44, v77, 16, v76
    v_and_b32 v46, 1, v50
    v_bfe_u32 v47, v50, 1, 1
    v_lshl_or_b32 v46, v47, 16, v46
    v_mul_u32_u24 v46, s38, v46
    v_and_b32 v44, v44, v46
    ds_write_b32 v18, v44 offset:4096
    ds_or_b32 v17, v44 offset:9984
    s_waitcnt vmcnt(12)
    v_and_b32 v44, 0x7fff, v80
    v_and_b32 v45, 0x7fff, v81
    v_and_b32 v46, 0x7fff, v82
    v_and_b32 v47, 0x7fff, v83
    v_max_u32 v48, v44, v45
    v_min_u32 v49, v44, v45
    v_max_u32 v50, v46, v47
    v_min_u32 v51, v46, v47
    v_min_u32 v48, v48, v50
    v_max3_u32 v48, v48, v49, v51
    v_max_u32 v48, 1, v48
    v_sub_u32 v47, v47, v48
    v_sub_u32 v46, v46, v48
    v_sub_u32 v45, v45, v48
    v_sub_u32 v44, v44, v48
    v_lshrrev_b32 v49, 31, v47
    v_alignbit_b32 v49, v49, v46, 31
    v_alignbit_b32 v49, v49, v45, 31
    v_alignbit_b32 v49, v49, v44, 31
    v_lshlrev_b32 v50, 1, v49
    v_lshrrev_b32 v50, v50, s37
    v_lshl_or_b32 v44, v81, 16, v80
    v_and_b32 v46, 1, v50
    v_bfe_u32 v47, v50, 1, 1
    v_lshl_or_b32 v46, v47, 16, v46
    v_mul_u32_u24 v46, s38, v46
    v_and_b32 v44, v44, v46
    ds_write_b32 v18, v44 offset:5120
    ds_or_b32 v17, v44 offset:10048
    s_waitcnt vmcnt(8)
    v_and_b32 v44, 0x7fff, v84
    v_and_b32 v45, 0x7fff, v85
    v_and_b32 v46, 0x7fff, v86
    v_and_b32 v47, 0x7fff, v87
    v_max_u32 v48, v44, v45
    v_min_u32 v49, v44, v45
    v_max_u32 v50, v46, v47
    v_min_u32 v51, v46, v47
    v_min_u32 v48, v48, v50
    v_max3_u32 v48, v48, v49, v51
    v_max_u32 v48, 1, v48
    v_sub_u32 v47, v47, v48
    v_sub_u32 v46, v46, v48
    v_sub_u32 v45, v45, v48
    v_sub_u32 v44, v44, v48
    v_lshrrev_b32 v49, 31, v47
    v_alignbit_b32 v49, v49, v46, 31
    v_alignbit_b32 v49, v49, v45, 31
    v_alignbit_b32 v49, v49, v44, 31
    v_lshlrev_b32 v50, 1, v49
    v_lshrrev_b32 v50, v50, s37
    v_lshl_or_b32 v44, v85, 16, v84
    v_and_b32 v46, 1, v50
    v_bfe_u32 v47, v50, 1, 1
    v_lshl_or_b32 v46, v47, 16, v46
    v_mul_u32_u24 v46, s38, v46
    v_and_b32 v44, v44, v46
    ds_write_b32 v18, v44 offset:6144
    ds_or_b32 v17, v44 offset:10112
    s_waitcnt vmcnt(4)
    v_and_b32 v44, 0x7fff, v88
    v_and_b32 v45, 0x7fff, v89
    v_and_b32 v46, 0x7fff, v90
    v_and_b32 v47, 0x7fff, v91
    v_max_u32 v48, v44, v45
    v_min_u32 v49, v44, v45
    v_max_u32 v50, v46, v47
    v_min_u32 v51, v46, v47
    v_min_u32 v48, v48, v50
    v_max3_u32 v48, v48, v49, v51
    v_max_u32 v48, 1, v48
    v_sub_u32 v47, v47, v48
    v_sub_u32 v46, v46, v48
    v_sub_u32 v45, v45, v48
    v_sub_u32 v44, v44, v48
    v_lshrrev_b32 v49, 31, v47
    v_alignbit_b32 v49, v49, v46, 31
    v_alignbit_b32 v49, v49, v45, 31
    v_alignbit_b32 v49, v49, v44, 31
    v_lshlrev_b32 v50, 1, v49
    v_lshrrev_b32 v50, v50, s37
    v_lshl_or_b32 v44, v89, 16, v88
    v_and_b32 v46, 1, v50
    v_bfe_u32 v47, v50, 1, 1
    v_lshl_or_b32 v46, v47, 16, v46
    v_mul_u32_u24 v46, s38, v46
    v_and_b32 v44, v44, v46
    ds_write_b32 v18, v44 offset:7168
    ds_or_b32 v17, v44 offset:10176
    s_waitcnt vmcnt(0)
    v_and_b32 v44, 0x7fff, v92
    v_and_b32 v45, 0x7fff, v93
    v_and_b32 v46, 0x7fff, v94
    v_and_b32 v47, 0x7fff, v95
    v_max_u32 v48, v44, v45
    v_min_u32 v49, v44, v45
    v_max_u32 v50, v46, v47
    v_min_u32 v51, v46, v47
    v_min_u32 v48, v48, v50
    v_max3_u32 v48, v48, v49, v51
    v_max_u32 v48, 1, v48
    v_sub_u32 v47, v47, v48
    v_sub_u32 v46, v46, v48
    v_sub_u32 v45, v45, v48
    v_sub_u32 v44, v44, v48
    v_lshrrev_b32 v49, 31, v47
    v_alignbit_b32 v49, v49, v46, 31
    v_alignbit_b32 v49, v49, v45, 31
    v_alignbit_b32 v49, v49, v44, 31
    v_lshlrev_b32 v50, 1, v49
    v_lshrrev_b32 v50, v50, s37
    v_lshl_or_b32 v44, v93, 16, v92
    v_and_b32 v46, 1, v50
    v_bfe_u32 v47, v50, 1, 1
    v_lshl_or_b32 v46, v47, 16, v46
    v_mul_u32_u24 v46, s38, v46
    v_and_b32 v44, v44, v46
    ds_write_b32 v18, v44 offset:8192
    ds_or_b32 v17, v44 offset:10240
    v_lshlrev_b32 v19, 2, v12
    s_waitcnt lgkmcnt(0)
    s_barrier
    ds_read_b32 v20, v19 offset:9728
    ds_read_b32 v21, v19 offset:9984
    ds_read_b32 v22, v19 offset:10240
    s_mov_b32 s56, 0x55555555
    s_mov_b32 s57, 0x55555555
    s_waitcnt lgkmcnt(0)
    v_cmp_ne_u32 s[44:45], 0, v20
    v_cmp_ne_u32 s[46:47], 0, v21
    v_cmp_ne_u32 s[48:49], 0, v22
    s_nop 3
    s_bcnt1_i32_b64 s36, s[44:45]
    s_bcnt1_i32_b64 s37, s[46:47]
    s_bcnt1_i32_b64 s38, s[48:49]
    s_add_u32 s37, s37, s36
    s_add_u32 s38, s38, s37
    s_and_b64 s[50:51], s[44:45], s[56:57]
    s_bcnt1_i32_b64 s39, s[50:51]
    s_and_b64 s[50:51], s[46:47], s[56:57]
    s_bcnt1_i32_b64 s40, s[50:51]
    s_add_u32 s40, s40, s39
    s_cmp_eq_u32 s20, 0
    s_cselect_b32 s36, 0, s36
    s_cselect_b32 s39, 0, s39
    s_cselect_b64 s[44:45], s[44:45], s[46:47]
    s_cmp_ge_u32 s20, 2
    s_cselect_b32 s36, s37, s36
    s_cselect_b32 s39, s40, s39
    s_cselect_b64 s[44:45], s[48:49], s[44:45]
    s_cmp_eq_u32 s20, 3
    s_cselect_b64 s[44:45], 0, s[44:45]
    s_and_b64 s[50:51], s[44:45], s[56:57]
    v_mov_b32 v20, s36
    v_mbcnt_lo_u32_b32 v20, s44, v20
    v_mbcnt_hi_u32_b32 v20, s45, v20
    v_mov_b32 v21, s39
    v_mbcnt_lo_u32_b32 v21, s50, v21
    v_mbcnt_hi_u32_b32 v21, s51, v21
    v_sub_u32 v22, v20, v21
    v_sub_u32 v22, 15, v22
    v_cndmask_b32 v21, v22, v21, s[56:57]
    v_sub_u32 v22, 15, v21
    v_lshrrev_b32 v23, 3, v21
    v_min_u32 v21, v21, v22
    v_and_b32 v22, 1, v21
    v_lshl_or_b32 v24, v22, 1, v23
    v_lshrrev_b32 v21, 1, v21
    v_lshl_or_b32 v25, v24, 2, v21
    v_and_b32 v26, 2, v21
    v_or_b32 v26, v26, v22
    v_and_b32 v21, 1, v21
    v_lshl_or_b32 v21, v23, 1, v21
    v_lshl_or_b32 v26, v26, 2, v21
    v_cmp_gt_u32 vcc, 16, v20
    v_lshrrev_b32 v27, 4, v0
    v_and_b32 v28, 15, v0
    v_cndmask_b32 v25, v20, v25, vcc
    v_cndmask_b32 v26, v20, v26, vcc
    v_lshlrev_b32 v25, 2, v25
    v_lshlrev_b32 v26, 2, v26
    v_lshlrev_b32 v27, 10, v27
    v_lshl_or_b32 v27, v28, 3, v27
    s_mov_b64 exec, s[44:45]
    ds_write_b32 v26, v0 offset:10752
    ds_write_b32 v25, v27 offset:11520
    s_mov_b64 exec, -1
    s_add_u32 s38, s38, 7
    s_lshr_b32 s38, s38, 3
    s_max_u32 s38, s38, 2
    s_sub_u32 s38, s38, 2
    s_mul_i32 s36, s30, 9856
    s_add_u32 s36, s36, 376832
    v_lshlrev_b32 v20, 4, v13
    v_lshlrev_b32 v21, 2, v14
    s_waitcnt lgkmcnt(0)
    s_barrier
    s_cmp_eq_u32 s20, 0
    s_cbranch_scc0 C_ov
    ds_read_b128 v[24:27], v20 offset:10752
    ds_read_b128 v[32:35], v11 offset:11520
    s_lshl_b32 s37, s31, 10
    s_add_u32 s37, s37, s36
    s_lshl_b32 s39, s31, 6
    s_add_u32 s39, s39, s36
    s_add_u32 s39, s39, 9216
    s_lshl_b32 s40, s31, 2
    s_add_u32 s40, s40, s36
    s_add_u32 s40, s40, 9792
    s_waitcnt lgkmcnt(1)
    v_lshl_add_u32 v24, v24, 6, v21
    v_lshl_add_u32 v25, v25, 6, v21
    v_lshl_add_u32 v26, v26, 6, v21
    v_lshl_add_u32 v27, v27, 6, v21
    ds_read_b32 v28, v24
    ds_read_b32 v29, v25
    ds_read_b32 v30, v26
    ds_read_b32 v31, v27
    v_mov_b32 v22, s38
    s_waitcnt lgkmcnt(0)
    buffer_store_dwordx4 v[28:31], v11, s[16:19], s37 offen sc1
    s_mov_b64 exec, 15
    buffer_store_dwordx4 v[32:35], v11, s[16:19], s39 offen sc1
    s_mov_b64 exec, 1
    buffer_store_dword v22, off, s[16:19], s40 sc1
    s_mov_b64 exec, -1
    s_branch C_sig
C_ov:
    s_sub_u32 s39, s20, 1
    v_lshlrev_b32 v20, 3, v13
C_ovl:
    s_cmp_lt_u32 s39, s38
    s_cbranch_scc0 C_sig
    s_lshl_b32 s40, s39, 5
    v_add_u32 v22, s40, v20
    v_add_u32 v23, s40, v11
    ds_read_b64 v[24:25], v22 offset:10816
    ds_read_b128 v[32:35], v23 offset:11584
    s_lshl_b32 s37, s35, 4
    s_add_u32 s37, s37, s39
    s_mul_i32 s37, s37, 544
    s_add_u32 s37, s37, 416256
    s_waitcnt lgkmcnt(1)
    v_lshl_add_u32 v24, v24, 6, v21
    v_lshl_add_u32 v25, v25, 6, v21
    ds_read_b32 v28, v24
    ds_read_b32 v29, v25
    s_waitcnt lgkmcnt(0)
    buffer_store_dwordx2 v[28:29], v54, s[16:19], s37 offen sc1
    s_mov_b64 exec, 3
    buffer_store_dwordx4 v[32:35], v11, s[16:19], s37 offen offset:512 sc1
    s_mov_b64 exec, -1
    s_add_u32 s39, s39, 3
    s_branch C_ovl
C_sig:
    s_lshl_b32 s30, s30, 12
    s_add_u32 s30, s30, 747520
    v_lshlrev_b32 v17, 8, v12
    v_mov_b32 v16, 1
    s_waitcnt vmcnt(0)
    s_barrier
    s_cmp_lg_u32 s20, 0
    s_cbranch_scc1 M_x
    s_mov_b64 exec, 0xffff
    buffer_atomic_add v16, v17, s[16:19], s30 offen sc1
    s_mov_b64 exec, 1
    v_mov_b32 v252, 1
    s_mov_b32 s98, 35
    s_mov_b32 s99, 192
    buffer_atomic_add v252, off, s[68:71], 0 offset:64 sc0 sc1
    s_mov_b64 exec, -1
    s_branch M_x
M_codeend:
.section .rodata,"a"
.p2align 6
.amdhsa_kernel standalone__structured_sparse_n_m__ragged_kernel
  .amdhsa_next_free_vgpr 512
  .amdhsa_next_free_sgpr 102
  .amdhsa_accum_offset 256
  .amdhsa_group_segment_fixed_size 0
  .amdhsa_kernarg_size 48
  .amdhsa_user_sgpr_count 2
  .amdhsa_user_sgpr_kernarg_segment_ptr 1
  .amdhsa_system_sgpr_workgroup_id_x 1
  .amdhsa_float_denorm_mode_32 3
.end_amdhsa_kernel
```

```asm
; @launch grid=(256,1,1) block=(256,1,1) lds=157968
.amdgcn_target "amdgcn-amd-amdhsa--gfx950"
.text
.globl standalone__structured_sparse_n_m__ragged_kernel
.p2align 8
.type standalone__structured_sparse_n_m__ragged_kernel,@function
standalone__structured_sparse_n_m__ragged_kernel:
    s_cmp_ge_u32 s2, 256
    s_cbranch_scc1 M_end
    s_load_dwordx8 s[72:79], s[0:1], 0
    s_load_dwordx4 s[80:83], s[0:1], 32
    s_getpc_b64 s[84:85]
    s_lshr_b32 s30, s2, 3
    s_and_b32 s30, s30, 15
    s_lshl_b32 s30, s30, 11
    s_and_b32 s84, s84, 0xffffff00
    s_cmp_ge_u32 s2, 88
    s_cselect_b32 s86, M_codeend-standalone__structured_sparse_n_m__ragged_kernel, 0
    s_mov_b32 s87, 0x20000
    v_lshlrev_b32 v254, 3, v0
    s_mov_b32 exec_lo, 0x00010001
    s_mov_b32 exec_hi, 0x00010001
    buffer_load_dword v254, v254, s[84:87], s30 offen
    s_mov_b64 exec, -1
    v_lshrrev_b32 v20, 6, v0
    v_and_b32 v12, 63, v0
    v_readfirstlane_b32 s20, v20
    v_lshrrev_b32 v22, 3, v0
    v_mul_u32_u24 v22, 1152, v22
    v_lshrrev_b32 v23, 4, v0
    v_xor_b32 v23, v23, v0
    v_and_b32 v23, 7, v23
    v_lshl_add_u32 v5, v23, 4, v22
    v_lshrrev_b32 v13, 4, v12
    v_and_b32 v14, 15, v12
    v_lshlrev_b32 v11, 4, v12
    v_lshlrev_b32 v54, 3, v12
    v_lshlrev_b32 v25, 4, v13
    v_lshlrev_b32 v26, 3, v13
    s_mov_b32 s6, 663552
    s_mov_b32 s7, 0x20000
    s_mov_b32 s10, 75497472
    s_mov_b32 s11, s7
    s_mov_b32 s18, 738304
    s_mov_b32 s19, s7
    s_movk_i32 s70, 256
    s_mov_b32 s71, s7
    s_movk_i32 s86, 1152
    s_mov_b32 s87, s7
    s_mov_b32 s98, 0
    s_mul_i32 s96, s20, 8
    s_and_b32 s97, s2, 7
    s_add_u32 s96, s96, s97
    s_lshl_b32 s96, s96, 8
    s_add_u32 s96, s96, 721920
    s_mul_i32 s22, s2, 36864
    s_mul_i32 s26, s20, 9216
    s_mov_b32 s24, s22
    s_mov_b32 s42, s26
    s_lshl_b32 s28, s20, 8
    s_lshl_b32 s29, s20, 5
    s_mov_b32 s21, 0
    s_cmp_lt_u32 s2, 81
    s_cselect_b32 s41, 2, 2
    s_cbranch_scc0 M_x1
    s_mul_i32 s32, s2, 57
    s_lshr_b32 s32, s32, 9
    s_mul_i32 s33, s32, 9
    s_sub_u32 s33, s2, s33
    s_mul_i32 s54, s32, 73728
    s_lshl_b32 s35, s33, 7
    s_add_u32 s54, s54, s35
    s_add_u32 s55, s54, 36864
    s_lshl_b32 s36, s20, 10
    s_add_u32 m0, s36, 73728
    s_lshr_b32 s30, s33, 1
    s_and_b32 s31, s33, 1
    s_lshl_b32 s37, s32, 8
    s_lshl_b32 s38, s31, 7
    s_add_u32 s37, s37, s38
    s_lshl_b32 s38, s32, 6
    s_add_u32 s38, s38, 2304
    s_cmp_lt_u32 s33, 8
    s_cselect_b32 s30, s30, s20
    s_cselect_b32 s37, s37, s38
    s_cselect_b32 s44, 0xff, 15
    s_cselect_b32 s45, s20, 3
    s_cmp_eq_u32 s45, 3
    s_cselect_b32 s99, 738304, 0
    s_mul_i32 s48, s30, 97280
    s_add_u32 s37, s37, s48
    v_mov_b32 v44, 2.0
    v_mov_b32 v45, 0
    v_mov_b32 v46, 2.0
    v_mov_b32 v47, 0
    s_waitcnt lgkmcnt(0)
    s_mov_b64 s[4:5], s[74:75]
    buffer_load_dwordx4 v5, s[4:7], s54 offen lds
    s_add_u32 m0, m0, 4096
    s_mov_b32 s45, 0
    buffer_load_dwordx4 v5, s[4:7], s55 offen lds
    s_mov_b64 s[16:17], s[82:83]
    s_mov_b64 s[8:9], s[72:73]
    s_mov_b64 s[84:85], s[76:77]
    s_mov_b64 s[68:69], s[80:81]
    buffer_load_dword v253, off, s[16:19], s96 sc1
    s_mov_b64 exec, s[44:45]
    s_mov_b32 s18, s99
    buffer_store_dwordx4 v[44:47], v11, s[16:19], s37 offen sc1
    s_mov_b32 s18, 738304
    s_mov_b64 exec, -1
    buffer_load_dwordx4 v[196:199], v25, s[84:87], s28 offen offset:0
    buffer_load_dwordx4 v[200:203], v25, s[84:87], s28 offen offset:64
    buffer_load_dwordx4 v[204:207], v25, s[84:87], s28 offen offset:128
    buffer_load_dwordx4 v[208:211], v25, s[84:87], s28 offen offset:192
    buffer_load_dwordx2 v[212:213], v26, s[84:87], s29 offen offset:1024
    s_mov_b32 m0, s42
    s_nop 0
    buffer_load_dwordx4 v5, s[8:11], s22 offen offset:0 nt lds
    s_add_u32 m0, m0, 896
    s_nop 0
    buffer_load_dwordx4 v5, s[8:11], s22 offen offset:128 nt lds
    s_add_u32 m0, m0, 896
    s_nop 0
    buffer_load_dwordx4 v5, s[8:11], s22 offen offset:256 nt lds
    s_add_u32 m0, m0, 896
    s_nop 0
    buffer_load_dwordx4 v5, s[8:11], s22 offen offset:384 nt lds
    s_lshl_b32 s34, s31, 2
    s_add_u32 s34, s34, s20
    s_lshr_b32 s35, s20, 1
    s_lshl_b32 s35, s35, 6
    s_and_b32 s36, s20, 1
    s_lshl_b32 s36, s36, 3
    s_add_u32 s35, s35, s36
    s_lshl_b32 s36, s20, 5
    s_mul_i32 s39, s32, 10240
    s_add_u32 s39, s39, 5120
    s_lshl_b32 s40, s34, 1
    s_add_u32 s40, s40, s39
    s_lshl_b32 s38, s32, 1
    s_cmp_eq_u32 s32, 8
    s_cselect_b32 s38, 1024, s38
    s_add_u32 s38, s38, 3072
    s_cmp_lt_u32 s33, 8
    s_cselect_b32 s34, s34, 8
    s_cselect_b32 s35, s35, s36
    s_cselect_b32 s36, 4, 3
    s_cselect_b32 s40, s40, s38
    s_cselect_b32 s46, 0, s20
    s_cselect_b32 s47, 16, 8
    s_add_u32 s40, s40, s48
    s_lshl_b32 s38, s34, 10
    s_add_u32 s39, s39, s38
    s_add_u32 s39, s39, s48
    s_add_u32 s39, s39, 1024
    v_and_b32 v15, 3, v14
    v_lshlrev_b32 v15, s36, v15
    v_add_u32 v15, s35, v15
    v_lshrrev_b32 v16, 3, v14
    v_lshlrev_b32 v16, 4, v16
    v_xor_b32 v15, v15, v16
    v_lshrrev_b32 v16, 2, v14
    v_lshl_add_u32 v16, v13, 4, v16
    v_lshl_add_u32 v15, v16, 7, v15
    v_add_u32 v24, 73728, v15
    v_xor_b32 v27, 32, v24
    v_xor_b32 v28, 64, v24
    v_xor_b32 v29, 0x60, v24
    s_lshl_b32 s31, s46, 2
    s_add_u32 s31, s31, 81920
    v_mov_b32 v60, s31
    v_mov_b32 v61, 1
    ds_write_b32 v60, v61
    s_mul_i32 s49, s30, 81
    s_mul_i32 s31, s32, 9
    s_add_u32 s49, s49, s31
    s_add_u32 s49, s49, s34
    s_lshl_b32 s49, s49, 10
    s_add_u32 s49, s49, 389120
    s_lshl_b32 s31, s34, 24
    s_lshl_b32 s38, s32, 10
    s_add_u32 s31, s31, s38
    v_lshlrev_b32 v31, 18, v14
    v_lshl_add_u32 v31, v13, 5, v31
    v_add_u32 v31, s31, v31
    s_mov_b32 s50, 3437096686
    s_mov_b32 s51, 1150609561
    s_mov_b32 s52, 0x00010001
    s_mov_b32 s53, 0x00200010
    s_mov_b32 s38, 0x0202
    s_mul_i32 s30, s30, 2048
    s_add_u32 s30, s30, 721920
    s_cmp_eq_u32 s33, 8
    s_cselect_b32 s34, 32, 8
    s_bfm_b64 s[56:57], s34, 0
    s_cmp_eq_u32 s20, 0
    s_cselect_b32 s98, 1, 0
    v_lshlrev_b32 v30, 8, v12
    v_add_u32 v74, 81984, v54
    v_lshl_add_u32 v73, s20, 1, v74
    v_mov_b32 v41, 0x01000100
    v_mov_b32 v40, 0
    v_mov_b32 v63, -2.0
    s_waitcnt vmcnt(11) lgkmcnt(0)
    s_barrier
    ds_read_b64_tr_b16 v[16:17], v24
    ds_read_b64_tr_b16 v[18:19], v27 offset:512
    ds_read_b64_tr_b16 v[20:21], v28 offset:1024
    ds_read_b64_tr_b16 v[22:23], v29 offset:1536
    s_waitcnt lgkmcnt(3)
    v_and_b32 v44, 0x7fff7fff, v16
    v_and_b32 v45, 0x7fff7fff, v17
    v_pk_max_u16 v46, v44, v45
    v_pk_min_u16 v47, v44, v45
    v_pk_min_u16 v46, v46, v46 op_sel:[0,1] op_sel_hi:[1,0]
    v_pk_max_u16 v47, v47, v47 op_sel:[0,1] op_sel_hi:[1,0]
    v_pk_max_u16 v46, v46, s52
    v_pk_max_u16 v46, v46, v47
    v_pk_sub_i16 v44, v44, v46
    v_pk_sub_i16 v45, v45, v46
    v_pk_ashrrev_i16 v44, 15, v44 op_sel_hi:[0,1]
    v_pk_ashrrev_i16 v45, 15, v45 op_sel_hi:[0,1]
    v_alignbit_b32 v47, -1, v44, 16
    v_alignbit_b32 v46, v45, v45, 16
    v_and_b32 v48, 0x00080004, v44
    v_bitop3_b32 v46, v45, v46, v47 bitop3:0xe8
    v_and_or_b32 v64, v45, s53, v48
    v_bitop3_b32 v36, v16, v44, v46 bitop3:0x10
    v_min_u32 v68, 1, v36
    s_waitcnt lgkmcnt(2)
    v_and_b32 v44, 0x7fff7fff, v18
    v_and_b32 v45, 0x7fff7fff, v19
    v_pk_max_u16 v46, v44, v45
    v_pk_min_u16 v47, v44, v45
    v_pk_min_u16 v46, v46, v46 op_sel:[0,1] op_sel_hi:[1,0]
    v_pk_max_u16 v47, v47, v47 op_sel:[0,1] op_sel_hi:[1,0]
    v_pk_max_u16 v46, v46, s52
    v_pk_max_u16 v46, v46, v47
    v_pk_sub_i16 v44, v44, v46
    v_pk_sub_i16 v45, v45, v46
    v_pk_ashrrev_i16 v44, 15, v44 op_sel_hi:[0,1]
    v_pk_ashrrev_i16 v45, 15, v45 op_sel_hi:[0,1]
    v_alignbit_b32 v47, -1, v44, 16
    v_alignbit_b32 v46, v45, v45, 16
    v_and_b32 v48, 0x00080004, v44
    v_bitop3_b32 v46, v45, v46, v47 bitop3:0xe8
    v_and_or_b32 v65, v45, s53, v48
    v_bitop3_b32 v37, v18, v44, v46 bitop3:0x10
    v_min_u32 v69, 1, v37
    s_waitcnt lgkmcnt(1)
    v_and_b32 v44, 0x7fff7fff, v20
    v_and_b32 v45, 0x7fff7fff, v21
    v_pk_max_u16 v46, v44, v45
    v_pk_min_u16 v47, v44, v45
    v_pk_min_u16 v46, v46, v46 op_sel:[0,1] op_sel_hi:[1,0]
    v_pk_max_u16 v47, v47, v47 op_sel:[0,1] op_sel_hi:[1,0]
    v_pk_max_u16 v46, v46, s52
    v_pk_max_u16 v46, v46, v47
    v_pk_sub_i16 v44, v44, v46
    v_pk_sub_i16 v45, v45, v46
    v_pk_ashrrev_i16 v44, 15, v44 op_sel_hi:[0,1]
    v_pk_ashrrev_i16 v45, 15, v45 op_sel_hi:[0,1]
    v_alignbit_b32 v47, -1, v44, 16
    v_alignbit_b32 v46, v45, v45, 16
    v_and_b32 v48, 0x00080004, v44
    v_bitop3_b32 v46, v45, v46, v47 bitop3:0xe8
    v_and_or_b32 v66, v45, s53, v48
    v_bitop3_b32 v38, v20, v44, v46 bitop3:0x10
    v_min_u32 v70, 1, v38
    s_waitcnt lgkmcnt(0)
    v_and_b32 v44, 0x7fff7fff, v22
    v_and_b32 v45, 0x7fff7fff, v23
    v_pk_max_u16 v46, v44, v45
    v_pk_min_u16 v47, v44, v45
    v_pk_min_u16 v46, v46, v46 op_sel:[0,1] op_sel_hi:[1,0]
    v_pk_max_u16 v47, v47, v47 op_sel:[0,1] op_sel_hi:[1,0]
    v_pk_max_u16 v46, v46, s52
    v_pk_max_u16 v46, v46, v47
    v_pk_sub_i16 v44, v44, v46
    v_pk_sub_i16 v45, v45, v46
    v_pk_ashrrev_i16 v44, 15, v44 op_sel_hi:[0,1]
    v_pk_ashrrev_i16 v45, 15, v45 op_sel_hi:[0,1]
    v_alignbit_b32 v47, -1, v44, 16
    v_alignbit_b32 v46, v45, v45, 16
    v_and_b32 v48, 0x00080004, v44
    v_bitop3_b32 v46, v45, v46, v47 bitop3:0xe8
    v_and_or_b32 v67, v45, s53, v48
    v_bitop3_b32 v39, v22, v44, v46 bitop3:0x10
    v_min_u32 v71, 1, v39
    v_add_u32 v72, v68, v69
    v_add3_u32 v72, v72, v70, v71
    buffer_store_dwordx4 v[36:39], v11, s[16:19], s49 offen sc1
    v_cmp_ne_u32 vcc, 0, v72
    s_and_saveexec_b64 s[44:45], vcc
    ds_add_rtn_u32 v62, v60, v72
    s_mov_b64 exec, -1
    v_lshrrev_b32 v48, 16, v64
    v_or_b32 v48, v48, v64
    v_lshrrev_b64 v[52:53], v48, s[50:51]
    v_and_b32 v64, 15, v52
    v_lshl_or_b32 v40, v64, 0, v40
    v_lshrrev_b32 v48, 16, v65
    v_or_b32 v48, v48, v65
    v_lshrrev_b64 v[52:53], v48, s[50:51]
    v_and_b32 v65, 15, v52
    v_lshl_or_b32 v40, v65, 4, v40
    v_lshrrev_b32 v48, 16, v66
    v_or_b32 v48, v48, v66
    v_lshrrev_b64 v[52:53], v48, s[50:51]
    v_and_b32 v66, 15, v52
    v_lshl_or_b32 v40, v66, 8, v40
    v_lshrrev_b32 v48, 16, v67
    v_or_b32 v48, v48, v67
    v_lshrrev_b64 v[52:53], v48, s[50:51]
    v_and_b32 v67, 15, v52
    v_lshl_or_b32 v40, v67, 12, v40
    ds_write_b16 v73, v40
    v_mul_u32_u24 v46, 0x4001, v64
    v_and_b32 v46, 0x30003, v46
    v_mad_u32_u24 v46, v46, s38, v41
    v_perm_b32 v32, v17, v16, v46
    v_mul_u32_u24 v46, 0x4001, v65
    v_and_b32 v46, 0x30003, v46
    v_mad_u32_u24 v46, v46, s38, v41
    v_perm_b32 v33, v19, v18, v46
    s_waitcnt vmcnt(10) lgkmcnt(0)
    s_barrier
    ds_read_b64 v[50:51], v74
    v_mul_u32_u24 v46, 0x4001, v66
    v_and_b32 v46, 0x30003, v46
    v_mad_u32_u24 v46, v46, s38, v41
    v_perm_b32 v34, v21, v20, v46
    v_mul_u32_u24 v46, 0x4001, v67
    v_and_b32 v46, 0x30003, v46
    v_mad_u32_u24 v46, v46, s38, v41
    v_perm_b32 v35, v23, v22, v46
    buffer_store_dwordx4 v[32:35], v11, s[16:19], s39 offen sc1
    s_cmp_eq_u32 s33, 8
    s_cbranch_scc0 F_i1
    buffer_store_short v40, v11, s[16:19], s40 offen sc1
    s_branch F_i2
F_i1:
    s_cmp_eq_u32 s20, 0
    s_cbranch_scc0 F_i2
    s_waitcnt lgkmcnt(0)
    buffer_store_dwordx2 v[50:51], v11, s[16:19], s40 offen sc1
F_i2:
    s_cbranch_vccz F_z
    v_cmp_ne_u32 vcc, 0, v36
    s_and_saveexec_b64 s[44:45], vcc
    s_cbranch_execz F_e0
    v_cmp_gt_u32 vcc, s47, v62
    v_add_u32 v42, 0, v31
    v_lshlrev_b32 v44, 3, v62
    v_add_u32 v62, 1, v62
    v_cndmask_b32 v42, v63, v42, vcc
    v_cndmask_b32 v43, 0, v36, vcc
    v_cndmask_b32 v44, 0, v44, vcc
    buffer_store_dwordx2 v[42:43], v44, s[16:19], s37 offen sc1
F_e0:
    s_mov_b64 exec, -1
    v_cmp_ne_u32 vcc, 0, v37
    s_and_saveexec_b64 s[44:45], vcc
    s_cbranch_execz F_e1
    v_cmp_gt_u32 vcc, s47, v62
    v_add_u32 v42, 8, v31
    v_lshlrev_b32 v44, 3, v62
    v_add_u32 v62, 1, v62
    v_cndmask_b32 v42, v63, v42, vcc
    v_cndmask_b32 v43, 0, v37, vcc
    v_cndmask_b32 v44, 0, v44, vcc
    buffer_store_dwordx2 v[42:43], v44, s[16:19], s37 offen sc1
F_e1:
    s_mov_b64 exec, -1
    v_cmp_ne_u32 vcc, 0, v38
    s_and_saveexec_b64 s[44:45], vcc
    s_cbranch_execz F_e2
    v_cmp_gt_u32 vcc, s47, v62
    v_add_u32 v42, 16, v31
    v_lshlrev_b32 v44, 3, v62
    v_add_u32 v62, 1, v62
    v_cndmask_b32 v42, v63, v42, vcc
    v_cndmask_b32 v43, 0, v38, vcc
    v_cndmask_b32 v44, 0, v44, vcc
    buffer_store_dwordx2 v[42:43], v44, s[16:19], s37 offen sc1
F_e2:
    s_mov_b64 exec, -1
    v_cmp_ne_u32 vcc, 0, v39
    s_and_saveexec_b64 s[44:45], vcc
    s_cbranch_execz F_e3
    v_cmp_gt_u32 vcc, s47, v62
    v_add_u32 v42, 24, v31
    v_lshlrev_b32 v44, 3, v62
    v_add_u32 v62, 1, v62
    v_cndmask_b32 v42, v63, v42, vcc
    v_cndmask_b32 v43, 0, v39, vcc
    v_cndmask_b32 v44, 0, v44, vcc
    buffer_store_dwordx2 v[42:43], v44, s[16:19], s37 offen sc1
F_e3:
    s_mov_b64 exec, -1
F_z:
    s_cmp_lg_u32 s2, 0
    s_cbranch_scc1 F_sig
    v_mov_b32 v64, 0
    v_mov_b32 v65, 0
    v_mov_b32 v66, 0
    v_mov_b32 v67, 0
    s_mov_b32 s40, 720896
    buffer_store_dwordx4 v[64:67], v11, s[16:19], s40 offen sc1
F_sig:
    s_waitcnt vmcnt(0) lgkmcnt(0)
    s_barrier
    s_cmp_lg_u32 s20, 0
    s_cbranch_scc1 F_end
    s_mov_b64 exec, s[56:57]
    buffer_atomic_add v61, v30, s[16:19], s30 offen sc1
    s_mov_b64 exec, -1
F_end:
    s_add_u32 m0, s42, 3584
    s_nop 0
    buffer_load_dwordx4 v5, s[8:11], s22 offen offset:512 nt lds
    s_add_u32 m0, m0, 896
    s_nop 0
    buffer_load_dwordx4 v5, s[8:11], s22 offen offset:640 nt lds
    s_add_u32 m0, m0, 896
    s_nop 0
    buffer_load_dwordx4 v5, s[8:11], s22 offen offset:768 nt lds
    s_add_u32 m0, m0, 896
    s_nop 0
    buffer_load_dwordx4 v5, s[8:11], s22 offen offset:896 nt lds
    s_add_u32 m0, m0, 896
    s_nop 0
    buffer_load_dwordx4 v5, s[8:11], s22 offen offset:1024 nt lds
    s_add_u32 s22, s22, 9437184
    s_add_u32 s42, s42, 36864
    s_mov_b32 s21, 1
    s_branch M_xl
M_x1:
    s_waitcnt lgkmcnt(0)
    s_mov_b64 s[4:5], s[74:75]
    s_mov_b64 s[16:17], s[82:83]
    s_mov_b64 s[8:9], s[72:73]
    s_mov_b64 s[84:85], s[76:77]
    s_mov_b64 s[68:69], s[80:81]
    buffer_load_dword v253, off, s[16:19], s96 sc1
    buffer_load_dwordx4 v[196:199], v25, s[84:87], s28 offen offset:0
    buffer_load_dwordx4 v[200:203], v25, s[84:87], s28 offen offset:64
    buffer_load_dwordx4 v[204:207], v25, s[84:87], s28 offen offset:128
    buffer_load_dwordx4 v[208:211], v25, s[84:87], s28 offen offset:192
    buffer_load_dwordx2 v[212:213], v26, s[84:87], s29 offen offset:1024
M_xl:
    s_add_u32 s21, s21, 1
    s_mov_b32 m0, s42
    s_nop 0
    buffer_load_dwordx4 v5, s[8:11], s22 offen offset:0 nt lds
    s_add_u32 m0, m0, 896
    s_nop 0
    buffer_load_dwordx4 v5, s[8:11], s22 offen offset:128 nt lds
    s_add_u32 m0, m0, 896
    s_nop 0
    buffer_load_dwordx4 v5, s[8:11], s22 offen offset:256 nt lds
    s_add_u32 m0, m0, 896
    s_nop 0
    buffer_load_dwordx4 v5, s[8:11], s22 offen offset:384 nt lds
    s_add_u32 m0, m0, 896
    s_nop 0
    buffer_load_dwordx4 v5, s[8:11], s22 offen offset:512 nt lds
    s_add_u32 m0, m0, 896
    s_nop 0
    buffer_load_dwordx4 v5, s[8:11], s22 offen offset:640 nt lds
    s_add_u32 m0, m0, 896
    s_nop 0
    buffer_load_dwordx4 v5, s[8:11], s22 offen offset:768 nt lds
    s_add_u32 m0, m0, 896
    s_nop 0
    buffer_load_dwordx4 v5, s[8:11], s22 offen offset:896 nt lds
    s_add_u32 m0, m0, 896
    s_nop 0
    buffer_load_dwordx4 v5, s[8:11], s22 offen offset:1024 nt lds
    s_add_u32 s22, s22, 9437184
    s_add_u32 s42, s42, 36864
    s_cmp_lt_u32 s21, s41
    s_cbranch_scc1 M_xl
    s_mov_b32 s12, s78
    s_mov_b32 s13, s79
    s_mov_b32 s14, 75497472
    s_mov_b32 s15, 0x20000
    s_waitcnt vmcnt(9)
    v_readlane_b32 s100, v253, 0
    s_mul_i32 s29, s20, 11840
    s_add_u32 s29, s29, 110592
    v_lshrrev_b32 v24, 1, v14
    v_and_b32 v27, 7, v14
    v_lshlrev_b32 v22, 7, v27
    v_lshl_or_b32 v3, v24, 4, v22
    v_lshrrev_b32 v23, 3, v14
    v_mul_u32_u24 v4, 9216, v23
    v_xad_u32 v1, v25, v3, v4
    v_xor_b32 v2, 64, v1
    v_add_u32 v9, s29, v25
    v_add_u32 v8, s29, v11
    v_mul_u32_u24 v24, 1152, v27
    v_lshl_add_u32 v24, v23, 6, v24
    v_add3_u32 v6, v24, v25, s28
    v_lshrrev_b32 v24, 3, v12
    v_xor_b32 v28, v24, v12
    v_and_b32 v28, 7, v28
    v_mul_u32_u24 v24, 1152, v24
    v_lshl_add_u32 v24, v28, 4, v24
    v_add_u32 v7, 1024, v24
    s_lshl_b32 s30, s20, 1
    v_lshrrev_b32 v24, 1, v13
    v_add_u32 v24, s30, v24
    v_xor_b32 v24, v24, v27
    v_lshl_add_u32 v24, v24, 4, v22
    v_and_b32 v28, 8, v26
    v_mul_u32_u24 v29, 11840, v23
    v_add3_u32 v24, v24, v28, v29
    v_add_u32 v252, 121408, v24
    s_cmp_eq_u32 s20, 0
    s_mov_b32 s31, 1073899784
    s_cselect_b32 s30, 157952, s31
    v_mov_b32 v253, s31
    v_writelane_b32 v253, s30, 0
    s_lshr_b32 s30, s2, 3
    s_and_b32 s30, s30, 3
    s_lshl_b32 s92, s30, 8
    s_add_u32 s92, s92, 562944
    s_add_u32 s30, s30, 768
    s_mul_i32 s93, s30, 36864
    s_mov_b32 s94, 147456
    s_and_b32 s95, s20, 1
    s_mul_i32 s95, s95, 9216
    v_mov_b32 v10, 0xeeee4444
    s_add_u32 s59, s24, 9216
    s_mul_i32 s43, s20, 97280
    s_add_u32 s47, s29, 9216
    s_add_u32 s48, s29, 9792
    s_add_u32 s49, s29, 10112
    s_add_u32 s54, s29, 1073751872
    s_mov_b32 s50, 3130536464
    s_mov_b32 s51, 4275861076
    s_mov_b32 s52, 3696531472
    s_mov_b32 s53, 4269193778
    v_mov_b32 v16, 0
    v_mov_b32 v17, 0
    v_mov_b32 v18, 0
    v_mov_b32 v19, 0
    v_cmp_gt_u32 s[44:45], 36, v12
    v_and_b32 v20, 8, v54
    s_nop 0
    v_cndmask_b32 v20, 0, v20, s[44:45]
    v_mov_b32 v21, v20
    v_mov_b32 v22, v20
    v_mov_b32 v23, v20
    v_mov_b32 v64, 1073741824
    v_mov_b32 v65, 0
    v_mov_b32 v66, 1073741824
    v_mov_b32 v67, 0
    v_lshl_add_u32 v53, v12, 2, s49
    ds_write_b128 v8, v[16:19] offset:0
    ds_write_b128 v8, v[16:19] offset:1024
    ds_write_b128 v8, v[16:19] offset:2048
    ds_write_b128 v8, v[16:19] offset:3072
    ds_write_b128 v8, v[16:19] offset:4096
    ds_write_b128 v8, v[16:19] offset:5120
    ds_write_b128 v8, v[16:19] offset:6144
    ds_write_b128 v8, v[16:19] offset:7168
    ds_write_b128 v8, v[16:19] offset:8192
    ds_write_b128 v8, v[20:23] offset:9216
    v_lshlrev_b32 v124, 16, v196
    v_and_b32 v125, 0xffff0000, v196
    v_lshlrev_b32 v126, 16, v197
    v_and_b32 v127, 0xffff0000, v197
    v_lshlrev_b32 v128, 16, v198
    v_and_b32 v129, 0xffff0000, v198
    v_lshlrev_b32 v130, 16, v199
    v_and_b32 v131, 0xffff0000, v199
    v_lshlrev_b32 v132, 16, v200
    v_and_b32 v133, 0xffff0000, v200
    v_lshlrev_b32 v134, 16, v201
    v_and_b32 v135, 0xffff0000, v201
    v_lshlrev_b32 v136, 16, v202
    v_and_b32 v137, 0xffff0000, v202
    v_lshlrev_b32 v138, 16, v203
    v_and_b32 v139, 0xffff0000, v203
    v_lshlrev_b32 v140, 16, v204
    v_and_b32 v141, 0xffff0000, v204
    v_lshlrev_b32 v142, 16, v205
    v_and_b32 v143, 0xffff0000, v205
    v_lshlrev_b32 v144, 16, v206
    v_and_b32 v145, 0xffff0000, v206
    v_lshlrev_b32 v146, 16, v207
    v_and_b32 v147, 0xffff0000, v207
    v_lshlrev_b32 v148, 16, v208
    v_and_b32 v149, 0xffff0000, v208
    v_lshlrev_b32 v150, 16, v209
    v_and_b32 v151, 0xffff0000, v209
    v_lshlrev_b32 v152, 16, v210
    v_and_b32 v153, 0xffff0000, v210
    v_lshlrev_b32 v154, 16, v211
    v_and_b32 v155, 0xffff0000, v211
    v_lshlrev_b32 v156, 16, v212
    v_and_b32 v157, 0xffff0000, v212
    v_lshlrev_b32 v158, 16, v213
    v_and_b32 v159, 0xffff0000, v213
    s_mov_b32 exec_lo, 0x00010001
    s_mov_b32 exec_hi, 0x00010001
    ds_write_b128 v9, v[124:127] offset:10240
    ds_write_b128 v9, v[128:131] offset:10304
    ds_write_b128 v9, v[132:135] offset:10368
    ds_write_b128 v9, v[136:139] offset:10432
    ds_write_b128 v9, v[140:143] offset:10496
    ds_write_b128 v9, v[144:147] offset:10560
    ds_write_b128 v9, v[148:151] offset:10624
    ds_write_b128 v9, v[152:155] offset:10688
    ds_write_b128 v9, v[156:159] offset:10752
    s_mov_b64 exec, -1
    s_waitcnt vmcnt(1)
    buffer_load_dword v0, off, s[16:19], s96 sc1
    s_mul_i32 s30, s20, 175
    s_add_u32 s30, s30, s2
    s_sub_u32 s30, s30, 81
    s_cmp_lt_u32 s2, 81
    s_cselect_b32 s30, 1023, s30
    s_lshl_b32 s30, s30, 1
    v_lshrrev_b32 v244, 5, v12
    v_add_u32 v248, s30, v244
    v_mul_u32_u24 v245, 4855, v248
    v_lshrrev_b32 v245, 20, v245
    v_mul_u32_u24 v246, 216, v245
    v_sub_u32 v244, v248, v246
    v_mul_u32_u24 v246, 24, v245
    v_sub_u32 v247, v244, v246
    v_cmp_lt_u32 s[30:31], v244, v246
    v_subrev_u32 v246, 1, v245
    v_sub_u32 v245, 8, v245
    v_cndmask_b32 v244, v247, v244, s[30:31]
    v_cndmask_b32 v245, v245, v246, s[30:31]
    v_sub_u32 v244, 2012, v244
    v_cmp_gt_u32 vcc, 1080, v248
    v_subrev_u32 v248, 1080, v248
    v_mul_u32_u24 v246, 7282, v248
    v_lshrrev_b32 v246, 16, v246
    v_mul_u32_u24 v247, 9, v246
    v_sub_u32 v247, v248, v247
    v_add_u32 v246, 2013, v246
    v_cndmask_b32 v244, v246, v244, vcc
    v_cndmask_b32 v245, v247, v245, vcc
    v_mul_u32_u24 v244, 36864, v244
    v_lshl_add_u32 v244, v245, 7, v244
    v_and_b32 v245, 31, v12
    v_mul_u32_u24 v245, 1152, v245
    v_add_u32 v254, v244, v245
    s_mov_b32 vcc_lo, 0xff00ff00
    s_mov_b32 vcc_hi, 0xff00ff00
    s_waitcnt vmcnt(0)
    v_readfirstlane_b32 s30, v0
    s_mov_b32 s31, 0
    s_sub_u32 s30, s30, s100
    s_cmp_eq_u32 s30, 27
    s_cbranch_scc0 M_pf_spin
M_pf_ok:
    buffer_load_dwordx4 v[56:59], v11, s[16:19], s43 offen offset:0 sc1
    buffer_load_dwordx4 v[60:63], v11, s[16:19], s43 offen offset:1024 sc1
    s_mov_b32 exec_hi, 0xfffff
    buffer_load_dwordx4 v[64:67], v11, s[16:19], s43 offen offset:2048 sc1
    s_mov_b32 exec_hi, -1
    buffer_load_dwordx4 v[48:51], v11, s[16:19], s43 offen offset:3072 sc1
    s_add_u32 s43, s43, 4096
    buffer_load_dword v52, v11, s[16:19], s43 offen offset:0 sc1
    buffer_load_dwordx4 v[12:15], v11, s[16:19], s43 offen offset:1024 sc1
    buffer_load_dwordx4 a[0:3], v11, s[16:19], s43 offen offset:2048 sc1
    buffer_load_dwordx4 a[4:7], v11, s[16:19], s43 offen offset:3072 sc1
    s_add_u32 s43, s43, 4096
    buffer_load_dwordx4 a[8:11], v11, s[16:19], s43 offen offset:0 sc1
    buffer_load_dwordx4 a[12:15], v11, s[16:19], s43 offen offset:1024 sc1
    buffer_load_dwordx4 a[16:19], v11, s[16:19], s43 offen offset:2048 sc1
    buffer_load_dwordx4 a[20:23], v11, s[16:19], s43 offen offset:3072 sc1
    s_add_u32 s43, s43, 4096
    buffer_load_dwordx4 a[24:27], v11, s[16:19], s43 offen offset:0 sc1
    buffer_load_dwordx4 a[28:31], v11, s[16:19], s43 offen offset:1024 sc1
    buffer_load_dwordx4 a[32:35], v11, s[16:19], s43 offen offset:2048 sc1
    buffer_load_dwordx4 v[16:19], v11, s[16:19], s43 offen offset:3072 sc1
    s_add_u32 s43, s43, 4096
    buffer_load_dwordx4 a[36:39], v11, s[16:19], s43 offen offset:0 sc1
    buffer_load_dwordx4 a[40:43], v11, s[16:19], s43 offen offset:1024 sc1
    buffer_load_dwordx4 a[44:47], v11, s[16:19], s43 offen offset:2048 sc1
    ds_read_b128 v[160:163], v9 offset:10240
    ds_read_b128 v[164:167], v9 offset:10304
    ds_read_b128 v[168:171], v9 offset:10368
    ds_read_b128 v[172:175], v9 offset:10432
    ds_read_b128 v[176:179], v9 offset:10496
    ds_read_b128 v[180:183], v9 offset:10560
    ds_read_b128 v[184:187], v9 offset:10624
    ds_read_b128 v[188:191], v9 offset:10688
    ds_read_b128 v[192:195], v9 offset:10752
    s_cmp_eq_u32 s98, 0
    s_cbranch_scc1 M_cnt
    s_mov_b32 s98, 0
    v_mov_b32 v0, 1
    s_mov_b64 exec, 1
    buffer_atomic_add v0, off, s[68:71], 0 offset:0 sc1
    s_mov_b64 exec, -1
    s_nop 3
M_cnt:
    s_waitcnt vmcnt(12)
    s_barrier
    ds_read_b128 v[196:199], v1 offset:0
    ds_read_b128 v[200:203], v2 offset:0
    ds_read_b128 v[228:231], v1 offset:18432
    ds_read_b128 v[232:235], v2 offset:18432
    s_waitcnt lgkmcnt(2)
    v_smfmac_f32_16x16x64_bf16 v[124:127], a[0:3], v[196:203], v12
    buffer_load_dwordx4 a[48:51], v11, s[16:19], s43 offen offset:3072 sc1
    s_waitcnt lgkmcnt(0)
    v_mov_b32 v82, s54
    v_smfmac_f32_16x16x64_bf16 v[160:163], a[0:3], v[228:235], v12
    ds_read_b128 v[204:207], v1 offset:1024
    ds_read_b128 v[208:211], v2 offset:1024
    v_bfe_u32 v74, v56, 24, 4
    v_lshlrev_b32 v75, 1, v56
    v_lshl_add_u32 v74, v74, 2, s49
    v_and_b32 v75, 16, v75
    s_waitcnt vmcnt(12)
    v_and_or_b32 v74, v56, 2.0, v74
    v_smfmac_f32_16x16x64_bf16 v[128:131], a[4:7], v[196:203], v12 abid:1
    s_add_u32 s43, s43, 4096
    buffer_load_dwordx4 a[52:55], v11, s[16:19], s43 offen offset:0 sc1
    v_lshlrev_b32 v75, v75, 1
    v_smfmac_f32_16x16x64_bf16 v[164:167], a[4:7], v[228:235], v12 abid:1
    ds_read_b128 v[220:223], v1 offset:19456
    ds_read_b128 v[224:227], v2 offset:19456
    ds_add_rtn_u32 v68, v74, v75
    v_bfe_u32 v76, v58, 24, 4
    v_lshlrev_b32 v77, 1, v58
    v_lshl_add_u32 v76, v76, 2, s49
    s_waitcnt vmcnt(12)
    v_and_b32 v77, 16, v77
    v_smfmac_f32_16x16x64_bf16 v[132:135], a[8:11], v[196:203], v13
    buffer_load_dwordx4 a[56:59], v11, s[16:19], s43 offen offset:1024 sc1
    v_and_or_b32 v76, v58, 2.0, v76
    v_smfmac_f32_16x16x64_bf16 v[168:171], a[8:11], v[228:235], v13
    s_waitcnt vmcnt(12)
    v_lshlrev_b32 v77, v77, 1
    v_smfmac_f32_16x16x64_bf16 v[136:139], a[12:15], v[196:203], v13 abid:1
    buffer_load_dwordx4 a[60:63], v11, s[16:19], s43 offen offset:2048 sc1
    ds_add_rtn_u32 v69, v76, v77
    v_bfe_u32 v74, v60, 24, 4
    v_smfmac_f32_16x16x64_bf16 v[172:175], a[12:15], v[228:235], v13 abid:1
    v_lshlrev_b32 v75, 1, v60
    v_lshl_add_u32 v74, v74, 2, s49
    v_and_b32 v75, 16, v75
    v_and_or_b32 v74, v60, 2.0, v74
    s_waitcnt vmcnt(12)
    v_lshlrev_b32 v75, v75, 1
    v_smfmac_f32_16x16x64_bf16 v[140:143], a[16:19], v[196:203], v14
    buffer_load_dwordx4 a[64:67], v11, s[16:19], s43 offen offset:3072 sc1
    ds_add_rtn_u32 v70, v74, v75
    v_bfe_u32 v76, v62, 24, 4
    v_smfmac_f32_16x16x64_bf16 v[176:179], a[16:19], v[228:235], v14
    v_lshlrev_b32 v77, 1, v62
    v_lshl_add_u32 v76, v76, 2, s49
    v_and_b32 v77, 16, v77
    v_and_or_b32 v76, v62, 2.0, v76
    s_waitcnt vmcnt(12)
    v_lshlrev_b32 v77, v77, 1
    v_smfmac_f32_16x16x64_bf16 v[144:147], a[20:23], v[196:203], v14 abid:1
    s_add_u32 s43, s43, 4096
    buffer_load_dwordx4 a[68:71], v11, s[16:19], s43 offen offset:0 sc1
    ds_add_rtn_u32 v71, v76, v77
    v_bfe_u32 v74, v64, 24, 4
    v_smfmac_f32_16x16x64_bf16 v[180:183], a[20:23], v[228:235], v14 abid:1
    v_lshlrev_b32 v75, 1, v64
    v_lshl_add_u32 v74, v74, 2, s49
    v_and_b32 v75, 16, v75
    s_waitcnt vmcnt(12)
    v_and_or_b32 v74, v64, 2.0, v74
    v_smfmac_f32_16x16x64_bf16 v[148:151], a[24:27], v[196:203], v15
    buffer_load_dwordx4 v[20:23], v11, s[16:19], s43 offen offset:1024 sc1
    buffer_load_dwordx4 a[72:75], v11, s[16:19], s43 offen offset:2048 sc1
    v_lshlrev_b32 v75, v75, 1
    v_smfmac_f32_16x16x64_bf16 v[184:187], a[24:27], v[228:235], v15
    ds_add_rtn_u32 v72, v74, v75
    v_bfe_u32 v76, v66, 24, 4
    v_lshlrev_b32 v77, 1, v66
    v_lshl_add_u32 v76, v76, 2, s49
    s_waitcnt vmcnt(13)
    v_and_b32 v77, 16, v77
    v_smfmac_f32_16x16x64_bf16 v[152:155], a[28:31], v[196:203], v15 abid:1
    buffer_load_dwordx4 a[76:79], v11, s[16:19], s43 offen offset:3072 sc1
    v_and_or_b32 v76, v66, 2.0, v76
    v_smfmac_f32_16x16x64_bf16 v[188:191], a[28:31], v[228:235], v15 abid:1
    s_waitcnt vmcnt(13)
    v_lshlrev_b32 v77, v77, 1
    v_smfmac_f32_16x16x64_bf16 v[156:159], a[32:35], v[196:203], v48
    s_add_u32 s43, s43, 4096
    buffer_load_dwordx4 a[80:83], v11, s[16:19], s43 offen offset:0 sc1
    ds_add_rtn_u32 v73, v76, v77
    ds_read_b32 v80, v53
    v_and_b32 v74, 8, v56
    v_smfmac_f32_16x16x64_bf16 v[192:195], a[32:35], v[228:235], v48
    s_waitcnt lgkmcnt(6)
    v_lshrrev_b32 v75, 16, v68
    v_cmp_ne_u32 s[44:45], 0, v74
    v_and_b32 v76, 0xffff, v68
    v_sub_u32 v74, 15, v75
    v_and_b32 v68, 2.0, v56
    s_waitcnt vmcnt(12)
    v_add3_u32 v68, v76, v75, v68
    v_smfmac_f32_16x16x64_bf16 v[124:127], a[36:39], v[204:211], v16
    buffer_load_dwordx4 a[84:87], v11, s[16:19], s43 offen offset:1024 sc1
    v_cndmask_b32 v74, v76, v74, s[44:45]
    v_smfmac_f32_16x16x64_bf16 v[160:163], a[36:39], v[220:227], v16
    ds_read_b128 v[196:199], v1 offset:2048
    ds_read_b128 v[200:203], v2 offset:2048
    v_cmp_gt_u32 s[44:45], 16, v68
    v_lshlrev_b32 v74, 2, v74
    v_lshrrev_b64 v[76:77], v74, s[50:51]
    v_lshrrev_b64 v[78:79], v74, s[52:53]
    s_waitcnt vmcnt(12)
    v_bfe_u32 v74, v56, 24, 4
    v_smfmac_f32_16x16x64_bf16 v[128:131], a[40:43], v[204:211], v16 abid:1
    buffer_load_dwordx4 a[88:91], v11, s[16:19], s43 offen offset:2048 sc1
    v_and_b32 v76, 15, v76
    v_smfmac_f32_16x16x64_bf16 v[164:167], a[40:43], v[220:227], v16 abid:1
    ds_read_b128 v[228:231], v1 offset:20480
    ds_read_b128 v[232:235], v2 offset:20480
    v_and_b32 v78, 15, v78
    v_lshl_add_u32 v76, v74, 4, v76
    v_mul_u32_u24 v78, 68, v78
    s_waitcnt vmcnt(12)
    v_lshrrev_b32 v77, 14, v56
    v_smfmac_f32_16x16x64_bf16 v[132:135], a[44:47], v[204:211], v17
    buffer_load_dwordx4 a[92:95], v11, s[16:19], s43 offen offset:3072 sc1
    v_lshl_add_u32 v76, v76, 2, s47
    v_smfmac_f32_16x16x64_bf16 v[168:171], a[44:47], v[220:227], v17
    v_and_b32 v78, 0x30c, v78
    v_and_b32 v77, 0x3cf0, v77
    v_cndmask_b32 v75, v82, v76, s[44:45]
    v_add3_u32 v77, v77, v78, s29
    s_waitcnt vmcnt(12)
    v_and_b32 v78, 0x3fff, v56
    v_smfmac_f32_16x16x64_bf16 v[136:139], a[48:51], v[204:211], v17 abid:1
    s_add_u32 s43, s43, 4096
    buffer_load_dwordx4 a[96:99], v11, s[16:19], s43 offen offset:0 sc1
    v_cndmask_b32 v74, v82, v77, s[44:45]
    v_smfmac_f32_16x16x64_bf16 v[172:175], a[48:51], v[220:227], v17 abid:1
    ds_write_b32 v75, v78
    ds_write_b32 v74, v57
    v_and_b32 v74, 8, v58
    s_waitcnt lgkmcnt(11)
    v_lshrrev_b32 v75, 16, v69
    s_waitcnt vmcnt(12)
    v_cmp_ne_u32 s[44:45], 0, v74
    v_smfmac_f32_16x16x64_bf16 v[140:143], a[52:55], v[204:211], v18
    buffer_load_dwordx4 a[100:103], v11, s[16:19], s43 offen offset:1024 sc1
    v_and_b32 v76, 0xffff, v69
    v_smfmac_f32_16x16x64_bf16 v[176:179], a[52:55], v[220:227], v18
    v_sub_u32 v74, 15, v75
    v_and_b32 v69, 2.0, v58
    v_add3_u32 v69, v76, v75, v69
    s_waitcnt vmcnt(12)
    v_cndmask_b32 v74, v76, v74, s[44:45]
    v_smfmac_f32_16x16x64_bf16 v[144:147], a[56:59], v[204:211], v18 abid:1
    buffer_load_dwordx4 a[104:107], v11, s[16:19], s43 offen offset:2048 sc1
    v_cmp_gt_u32 s[44:45], 16, v69
    v_smfmac_f32_16x16x64_bf16 v[180:183], a[56:59], v[220:227], v18 abid:1
    v_lshlrev_b32 v74, 2, v74
    v_lshrrev_b64 v[76:77], v74, s[50:51]
    v_lshrrev_b64 v[78:79], v74, s[52:53]
    v_bfe_u32 v74, v58, 24, 4
    s_waitcnt vmcnt(12)
    v_and_b32 v76, 15, v76
    v_smfmac_f32_16x16x64_bf16 v[148:151], a[60:63], v[204:211], v19
    buffer_load_dwordx4 v[24:27], v11, s[16:19], s43 offen offset:3072 sc1
    s_add_u32 s43, s43, 4096
    buffer_load_dwordx4 a[108:111], v11, s[16:19], s43 offen offset:0 sc1
    v_and_b32 v78, 15, v78
    v_smfmac_f32_16x16x64_bf16 v[184:187], a[60:63], v[220:227], v19
    v_lshl_add_u32 v76, v74, 4, v76
    v_mul_u32_u24 v78, 68, v78
    v_lshrrev_b32 v77, 14, v58
    v_lshl_add_u32 v76, v76, 2, s47
    s_waitcnt vmcnt(13)
    v_and_b32 v78, 0x30c, v78
    v_smfmac_f32_16x16x64_bf16 v[152:155], a[64:67], v[204:211], v19 abid:1
    buffer_load_dwordx4 a[112:115], v11, s[16:19], s43 offen offset:1024 sc1
    v_and_b32 v77, 0x3cf0, v77
    v_smfmac_f32_16x16x64_bf16 v[188:191], a[64:67], v[220:227], v19 abid:1
    v_cndmask_b32 v75, v82, v76, s[44:45]
    v_add3_u32 v77, v77, v78, s29
    v_and_b32 v78, 0x3fff, v58
    s_waitcnt vmcnt(13)
    v_cndmask_b32 v74, v82, v77, s[44:45]
    v_smfmac_f32_16x16x64_bf16 v[156:159], a[68:71], v[204:211], v48 abid:1
    buffer_load_dwordx4 a[116:119], v11, s[16:19], s43 offen offset:2048 sc1
    ds_write_b32 v75, v78
    ds_write_b32 v74, v59
    v_and_b32 v74, 8, v60
    v_smfmac_f32_16x16x64_bf16 v[192:195], a[68:71], v[220:227], v48 abid:1
    s_waitcnt lgkmcnt(12)
    v_lshrrev_b32 v75, 16, v70
    v_cmp_ne_u32 s[44:45], 0, v74
    s_waitcnt vmcnt(12)
    s_waitcnt lgkmcnt(6)
    v_and_b32 v76, 0xffff, v70
    v_smfmac_f32_16x16x64_bf16 v[124:127], a[72:75], v[196:203], v20
    buffer_load_dwordx4 a[120:123], v11, s[16:19], s43 offen offset:3072 sc1
    s_waitcnt lgkmcnt(4)
    v_sub_u32 v74, 15, v75
    v_smfmac_f32_16x16x64_bf16 v[160:163], a[72:75], v[228:235], v20
    ds_read_b128 v[204:207], v1 offset:3072
    ds_read_b128 v[208:211], v2 offset:3072
    v_and_b32 v70, 2.0, v60
    v_add3_u32 v70, v76, v75, v70
    v_cndmask_b32 v74, v76, v74, s[44:45]
    s_waitcnt vmcnt(12)
    v_cmp_gt_u32 s[44:45], 16, v70
    v_smfmac_f32_16x16x64_bf16 v[128:131], a[76:79], v[196:203], v20 abid:1
    s_add_u32 s43, s43, 4096
    buffer_load_dwordx4 a[124:127], v11, s[16:19], s43 offen offset:0 sc1
    v_lshlrev_b32 v74, 2, v74
    v_smfmac_f32_16x16x64_bf16 v[164:167], a[76:79], v[228:235], v20 abid:1
    ds_read_b128 v[220:223], v1 offset:21504
    ds_read_b128 v[224:227], v2 offset:21504
    v_lshrrev_b64 v[76:77], v74, s[50:51]
    v_lshrrev_b64 v[78:79], v74, s[52:53]
    v_bfe_u32 v74, v60, 24, 4
    v_and_b32 v76, 15, v76
    s_waitcnt vmcnt(12)
    v_and_b32 v78, 15, v78
    v_smfmac_f32_16x16x64_bf16 v[132:135], a[80:83], v[196:203], v21
    buffer_load_dwordx4 a[128:131], v11, s[16:19], s43 offen offset:1024 sc1
    v_lshl_add_u32 v76, v74, 4, v76
    v_smfmac_f32_16x16x64_bf16 v[168:171], a[80:83], v[228:235], v21
    v_mul_u32_u24 v78, 68, v78
    v_lshrrev_b32 v77, 14, v60
    v_lshl_add_u32 v76, v76, 2, s47
    v_and_b32 v78, 0x30c, v78
    s_waitcnt vmcnt(12)
    v_and_b32 v77, 0x3cf0, v77
    v_smfmac_f32_16x16x64_bf16 v[136:139], a[84:87], v[196:203], v21 abid:1
    buffer_load_dwordx4 a[132:135], v11, s[16:19], s43 offen offset:2048 sc1
    v_cndmask_b32 v75, v82, v76, s[44:45]
    v_smfmac_f32_16x16x64_bf16 v[172:175], a[84:87], v[228:235], v21 abid:1
    v_add3_u32 v77, v77, v78, s29
    v_and_b32 v78, 0x3fff, v60
    s_waitcnt vmcnt(12)
    v_cndmask_b32 v74, v82, v77, s[44:45]
    v_smfmac_f32_16x16x64_bf16 v[140:143], a[88:91], v[196:203], v22
    buffer_load_dwordx4 a[136:139], v11, s[16:19], s43 offen offset:3072 sc1
    ds_write_b32 v75, v78
    ds_write_b32 v74, v61
    v_and_b32 v74, 8, v62
    v_smfmac_f32_16x16x64_bf16 v[176:179], a[88:91], v[228:235], v22
    v_lshrrev_b32 v75, 16, v71
    v_cmp_ne_u32 s[44:45], 0, v74
    v_and_b32 v76, 0xffff, v71
    s_waitcnt vmcnt(12)
    v_sub_u32 v74, 15, v75
    v_smfmac_f32_16x16x64_bf16 v[144:147], a[92:95], v[196:203], v22 abid:1
    s_add_u32 s43, s43, 4096
    buffer_load_dwordx4 a[140:143], v11, s[16:19], s43 offen offset:0 sc1
    v_and_b32 v71, 2.0, v62
    v_smfmac_f32_16x16x64_bf16 v[180:183], a[92:95], v[228:235], v22 abid:1
    v_add3_u32 v71, v76, v75, v71
    v_cndmask_b32 v74, v76, v74, s[44:45]
    v_cmp_gt_u32 s[44:45], 16, v71
    v_lshlrev_b32 v74, 2, v74
    s_waitcnt vmcnt(12)
    v_lshrrev_b64 v[76:77], v74, s[50:51]
    v_smfmac_f32_16x16x64_bf16 v[148:151], a[96:99], v[196:203], v23
    buffer_load_dwordx4 v[28:31], v11, s[16:19], s43 offen offset:1024 sc1
    buffer_load_dwordx4 a[144:147], v11, s[16:19], s43 offen offset:2048 sc1
    v_lshrrev_b64 v[78:79], v74, s[52:53]
    v_smfmac_f32_16x16x64_bf16 v[184:187], a[96:99], v[228:235], v23
    v_bfe_u32 v74, v62, 24, 4
    v_and_b32 v76, 15, v76
    v_and_b32 v78, 15, v78
    s_waitcnt vmcnt(13)
    v_lshl_add_u32 v76, v74, 4, v76
    v_smfmac_f32_16x16x64_bf16 v[152:155], a[100:103], v[196:203], v23 abid:1
    buffer_load_dwordx4 a[148:151], v11, s[16:19], s43 offen offset:3072 sc1
    v_mul_u32_u24 v78, 68, v78
    v_smfmac_f32_16x16x64_bf16 v[188:191], a[100:103], v[228:235], v23 abid:1
    v_lshrrev_b32 v77, 14, v62
    v_lshl_add_u32 v76, v76, 2, s47
    v_and_b32 v78, 0x30c, v78
    v_and_b32 v77, 0x3cf0, v77
    s_waitcnt vmcnt(13)
    v_cndmask_b32 v75, v82, v76, s[44:45]
    v_smfmac_f32_16x16x64_bf16 v[156:159], a[104:107], v[196:203], v49
    s_add_u32 s43, s43, 4096
    buffer_load_dwordx4 a[152:155], v11, s[16:19], s43 offen offset:0 sc1
    v_add3_u32 v77, v77, v78, s29
    v_smfmac_f32_16x16x64_bf16 v[192:195], a[104:107], v[228:235], v49
    v_and_b32 v78, 0x3fff, v62
    s_waitcnt vmcnt(12)
    s_waitcnt lgkmcnt(4)
    v_cndmask_b32 v74, v82, v77, s[44:45]
    v_smfmac_f32_16x16x64_bf16 v[124:127], a[108:111], v[204:211], v24
    buffer_load_dwordx4 a[156:159], v11, s[16:19], s43 offen offset:1024 sc1
    ds_write_b32 v75, v78
    ds_write_b32 v74, v63
    s_waitcnt lgkmcnt(4)
    v_and_b32 v74, 8, v64
    v_smfmac_f32_16x16x64_bf16 v[160:163], a[108:111], v[220:227], v24
    ds_read_b128 v[196:199], v1 offset:4096
    ds_read_b128 v[200:203], v2 offset:4096
    v_lshrrev_b32 v75, 16, v72
    v_cmp_ne_u32 s[44:45], 0, v74
    v_and_b32 v76, 0xffff, v72
    v_sub_u32 v74, 15, v75
    s_waitcnt vmcnt(12)
    v_and_b32 v72, 2.0, v64
    v_smfmac_f32_16x16x64_bf16 v[128:131], a[112:115], v[204:211], v24 abid:1
    buffer_load_dwordx4 a[160:163], v11, s[16:19], s43 offen offset:2048 sc1
    v_add3_u32 v72, v76, v75, v72
    v_smfmac_f32_16x16x64_bf16 v[164:167], a[112:115], v[220:227], v24 abid:1
    ds_read_b128 v[228:231], v1 offset:22528
    ds_read_b128 v[232:235], v2 offset:22528
    v_cndmask_b32 v74, v76, v74, s[44:45]
    v_cmp_gt_u32 s[44:45], 16, v72
    v_lshlrev_b32 v74, 2, v74
    v_lshrrev_b64 v[76:77], v74, s[50:51]
    s_waitcnt vmcnt(12)
    v_lshrrev_b64 v[78:79], v74, s[52:53]
    v_smfmac_f32_16x16x64_bf16 v[132:135], a[116:119], v[204:211], v25
    buffer_load_dwordx4 a[164:167], v11, s[16:19], s43 offen offset:3072 sc1
    v_bfe_u32 v74, v64, 24, 4
    v_smfmac_f32_16x16x64_bf16 v[168:171], a[116:119], v[220:227], v25
    v_and_b32 v76, 15, v76
    v_and_b32 v78, 15, v78
    v_lshl_add_u32 v76, v74, 4, v76
    s_waitcnt vmcnt(12)
    v_mul_u32_u24 v78, 68, v78
    v_smfmac_f32_16x16x64_bf16 v[136:139], a[120:123], v[204:211], v25 abid:1
    s_add_u32 s43, s43, 4096
    buffer_load_dwordx4 a[168:171], v11, s[16:19], s43 offen offset:0 sc1
    v_lshrrev_b32 v77, 14, v64
    v_smfmac_f32_16x16x64_bf16 v[172:175], a[120:123], v[220:227], v25 abid:1
    v_lshl_add_u32 v76, v76, 2, s47
    v_and_b32 v78, 0x30c, v78
    v_and_b32 v77, 0x3cf0, v77
    v_cndmask_b32 v75, v82, v76, s[44:45]
    s_waitcnt vmcnt(12)
    v_add3_u32 v77, v77, v78, s29
    v_smfmac_f32_16x16x64_bf16 v[140:143], a[124:127], v[204:211], v26
    buffer_load_dwordx4 a[172:175], v11, s[16:19], s43 offen offset:1024 sc1
    v_and_b32 v78, 0x3fff, v64
    v_smfmac_f32_16x16x64_bf16 v[176:179], a[124:127], v[220:227], v26
    s_waitcnt vmcnt(12)
    v_cndmask_b32 v74, v82, v77, s[44:45]
    v_smfmac_f32_16x16x64_bf16 v[144:147], a[128:131], v[204:211], v26 abid:1
    buffer_load_dwordx4 a[176:179], v11, s[16:19], s43 offen offset:2048 sc1
    ds_write_b32 v75, v78
    ds_write_b32 v74, v65
    v_and_b32 v74, 8, v66
    v_smfmac_f32_16x16x64_bf16 v[180:183], a[128:131], v[220:227], v26 abid:1
    v_lshrrev_b32 v75, 16, v73
    v_cmp_ne_u32 s[44:45], 0, v74
    v_and_b32 v76, 0xffff, v73
    v_sub_u32 v74, 15, v75
    v_and_b32 v73, 2.0, v66
    s_waitcnt vmcnt(12)
    v_add3_u32 v73, v76, v75, v73
    v_smfmac_f32_16x16x64_bf16 v[148:151], a[132:135], v[204:211], v27
    buffer_load_dwordx4 v[32:35], v11, s[16:19], s43 offen offset:3072 sc1
    s_add_u32 s43, s43, 4096
    buffer_load_dwordx4 a[180:183], v11, s[16:19], s43 offen offset:0 sc1
    v_cndmask_b32 v74, v76, v74, s[44:45]
    v_smfmac_f32_16x16x64_bf16 v[184:187], a[132:135], v[220:227], v27
    v_cmp_gt_u32 s[44:45], 16, v73
    v_lshlrev_b32 v74, 2, v74
    v_lshrrev_b64 v[76:77], v74, s[50:51]
    v_lshrrev_b64 v[78:79], v74, s[52:53]
    s_waitcnt vmcnt(13)
    v_bfe_u32 v74, v66, 24, 4
    v_smfmac_f32_16x16x64_bf16 v[152:155], a[136:139], v[204:211], v27 abid:1
    buffer_load_dwordx4 a[184:187], v11, s[16:19], s43 offen offset:1024 sc1
    v_and_b32 v76, 15, v76
    v_smfmac_f32_16x16x64_bf16 v[188:191], a[136:139], v[220:227], v27 abid:1
    v_and_b32 v78, 15, v78
    v_lshl_add_u32 v76, v74, 4, v76
    v_mul_u32_u24 v78, 68, v78
    v_lshrrev_b32 v77, 14, v66
    s_waitcnt vmcnt(13)
    v_lshl_add_u32 v76, v76, 2, s47
    v_smfmac_f32_16x16x64_bf16 v[156:159], a[140:143], v[204:211], v49 abid:1
    buffer_load_dwordx4 a[188:191], v11, s[16:19], s43 offen offset:2048 sc1
    v_and_b32 v78, 0x30c, v78
    v_smfmac_f32_16x16x64_bf16 v[192:195], a[140:143], v[220:227], v49 abid:1
    v_and_b32 v77, 0x3cf0, v77
    v_cndmask_b32 v75, v82, v76, s[44:45]
    v_add3_u32 v77, v77, v78, s29
    s_waitcnt vmcnt(12)
    s_waitcnt lgkmcnt(4)
    v_and_b32 v78, 0x3fff, v66
    v_smfmac_f32_16x16x64_bf16 v[124:127], a[144:147], v[196:203], v28
    buffer_load_dwordx4 a[192:195], v11, s[16:19], s43 offen offset:3072 sc1
    s_waitcnt lgkmcnt(2)
    v_cndmask_b32 v74, v82, v77, s[44:45]
    v_smfmac_f32_16x16x64_bf16 v[160:163], a[144:147], v[228:235], v28
    ds_read_b128 v[204:207], v1 offset:5120
    ds_read_b128 v[208:211], v2 offset:5120
    ds_write_b32 v75, v78
    ds_write_b32 v74, v67
    v_lshrrev_b32 v74, 16, v80
    v_and_b32 v80, 0xffff, v80
    s_waitcnt vmcnt(12)
    v_or3_b32 v75, v56, v60, v64
    v_smfmac_f32_16x16x64_bf16 v[128:131], a[148:151], v[196:203], v28 abid:1
    s_add_u32 s43, s43, 4096
    buffer_load_dwordx4 a[196:199], v11, s[16:19], s43 offen offset:0 sc1
    v_add_u32 v80, v80, v74
    v_smfmac_f32_16x16x64_bf16 v[164:167], a[148:151], v[228:235], v28 abid:1
    ds_read_b128 v[220:223], v1 offset:23552
    ds_read_b128 v[224:227], v2 offset:23552
    v_cmp_gt_i32 s[32:33], 0, v75
    s_waitcnt vmcnt(12)
    v_cmp_lt_u32 s[34:35], 16, v80
    v_smfmac_f32_16x16x64_bf16 v[132:135], a[152:155], v[196:203], v29
    buffer_load_dwordx4 a[200:203], v11, s[16:19], s43 offen offset:1024 sc1
    s_mov_b32 s46, 0
    s_mov_b32 s21, 0
    s_or_b32 s32, s32, s33
    s_and_b32 s27, s34, 0x1ff
    s_or_b32 s33, s32, s27
    s_cbranch_scc1 M_ovb
M_ovbr:
    ds_read_b128 v[236:239], v9 offset:9728
    ds_read_b128 v[216:219], v9 offset:9792
    v_smfmac_f32_16x16x64_bf16 v[168:171], a[152:155], v[228:235], v29
    s_waitcnt vmcnt(12)
    v_smfmac_f32_16x16x64_bf16 v[136:139], a[156:159], v[196:203], v29 abid:1
    buffer_load_dwordx4 a[204:207], v11, s[16:19], s43 offen offset:2048 sc1
    s_waitcnt lgkmcnt(1)
    v_xad_u32 v236, v236, v3, v4
    v_smfmac_f32_16x16x64_bf16 v[172:175], a[156:159], v[228:235], v29 abid:1
    s_waitcnt vmcnt(12)
    v_xad_u32 v237, v237, v3, v4
    v_smfmac_f32_16x16x64_bf16 v[140:143], a[160:163], v[196:203], v30
    buffer_load_dwordx4 a[208:211], v11, s[16:19], s43 offen offset:3072 sc1
    ds_read2st64_b32 v[244:245], v236 offset0:0 offset1:72
    ds_read2st64_b32 v[246:247], v237 offset0:0 offset1:72
    v_xad_u32 v238, v238, v3, v4
    v_smfmac_f32_16x16x64_bf16 v[176:179], a[160:163], v[228:235], v30
    s_waitcnt vmcnt(12)
    v_xad_u32 v239, v239, v3, v4
    v_smfmac_f32_16x16x64_bf16 v[144:147], a[164:167], v[196:203], v30 abid:1
    s_add_u32 s43, s43, 4096
    buffer_load_dwordx4 a[212:215], v11, s[16:19], s43 offen offset:0 sc1
    ds_read2st64_b32 v[248:249], v238 offset0:0 offset1:72
    ds_read2st64_b32 v[250:251], v239 offset0:0 offset1:72
    ds_read_b128 v[240:243], v8 offset:8192
    ds_read_b128 v[236:239], v9 offset:9216
    s_waitcnt lgkmcnt(6)
    v_and_b32 v212, 0x3fff, v216
    v_smfmac_f32_16x16x64_bf16 v[180:183], a[164:167], v[228:235], v30 abid:1
    v_and_b32 v214, 0x3fff, v218
    s_waitcnt vmcnt(12)
    v_xad_u32 v212, v212, v3, v4
    v_smfmac_f32_16x16x64_bf16 v[148:151], a[168:171], v[196:203], v31
    buffer_load_dwordx4 v[36:39], v11, s[16:19], s43 offen offset:1024 sc1
    buffer_load_dwordx4 a[216:219], v11, s[16:19], s43 offen offset:2048 sc1
    ds_read2st64_b32 v[212:213], v212 offset0:0 offset1:72
    v_xad_u32 v214, v214, v3, v4
    v_smfmac_f32_16x16x64_bf16 v[184:187], a[168:171], v[228:235], v31
    ds_read2st64_b32 v[214:215], v214 offset0:0 offset1:72
    s_waitcnt vmcnt(13)
    v_smfmac_f32_16x16x64_bf16 v[152:155], a[172:175], v[196:203], v31 abid:1
    buffer_load_dwordx4 a[220:223], v11, s[16:19], s43 offen offset:3072 sc1
    s_waitcnt lgkmcnt(3)
    v_smfmac_f32_16x16x64_bf16 v[156:159], v[240:243], v[244:251], v10
    v_smfmac_f32_16x16x64_bf16 v[192:195], v[240:243], v[244:251], v10 abid:1
    s_waitcnt lgkmcnt(2)
    v_xad_u32 v236, v236, v3, v4
    v_smfmac_f32_16x16x64_bf16 v[188:191], a[172:175], v[228:235], v31 abid:1
    s_waitcnt vmcnt(13)
    v_xad_u32 v237, v237, v3, v4
    v_smfmac_f32_16x16x64_bf16 v[156:159], a[176:179], v[196:203], v50
    s_add_u32 s43, s43, 4096
    buffer_load_dwordx4 a[224:227], v11, s[16:19], s43 offen offset:0 sc1
    ds_read2st64_b32 v[244:245], v236 offset0:0 offset1:72
    ds_read2st64_b32 v[246:247], v237 offset0:0 offset1:72
    v_xad_u32 v238, v238, v3, v4
    v_smfmac_f32_16x16x64_bf16 v[192:195], a[176:179], v[228:235], v50
    s_waitcnt vmcnt(12)
    v_xad_u32 v239, v239, v3, v4
    v_smfmac_f32_16x16x64_bf16 v[124:127], a[180:183], v[204:211], v32
    buffer_load_dwordx4 a[228:231], v11, s[16:19], s43 offen offset:1024 sc1
    ds_read2st64_b32 v[248:249], v238 offset0:0 offset1:72
    ds_read2st64_b32 v[250:251], v239 offset0:0 offset1:72
    ds_read_b128 v[240:243], v8 offset:0
    ds_read_b128 v[236:239], v9 offset:9280
    s_waitcnt lgkmcnt(6)
    s_bitcmp1_b32 s27, 0
    s_cbranch_scc1 M_ov0
M_ovp0:
    s_bitcmp1_b32 s27, 1
    s_cbranch_scc1 M_ov1
M_ovp1:
    s_bitcmp1_b32 s27, 2
    s_cbranch_scc1 M_ov2
M_ovp2:
    v_smfmac_f32_16x16x64_bf16 v[160:163], a[180:183], v[220:227], v32
    ds_read_b128 v[196:199], v1 offset:6144
    ds_read_b128 v[200:203], v2 offset:6144
    s_waitcnt vmcnt(12)
    v_smfmac_f32_16x16x64_bf16 v[128:131], a[184:187], v[204:211], v32 abid:1
    buffer_load_dwordx4 a[232:235], v11, s[16:19], s43 offen offset:2048 sc1
    v_smfmac_f32_16x16x64_bf16 v[164:167], a[184:187], v[220:227], v32 abid:1
    ds_read_b128 v[228:231], v1 offset:24576
    ds_read_b128 v[232:235], v2 offset:24576
    s_waitcnt vmcnt(12)
    v_smfmac_f32_16x16x64_bf16 v[132:135], a[188:191], v[204:211], v33
    buffer_load_dwordx4 a[236:239], v11, s[16:19], s43 offen offset:3072 sc1
    s_waitcnt lgkmcnt(5)
    v_smfmac_f32_16x16x64_bf16 v[124:127], v[240:243], v[244:251], v10
    v_smfmac_f32_16x16x64_bf16 v[160:163], v[240:243], v[244:251], v10 abid:1
    s_waitcnt lgkmcnt(4)
    v_xad_u32 v236, v236, v3, v4
    v_smfmac_f32_16x16x64_bf16 v[168:171], a[188:191], v[220:227], v33
    s_waitcnt vmcnt(12)
    v_xad_u32 v237, v237, v3, v4
    v_smfmac_f32_16x16x64_bf16 v[136:139], a[192:195], v[204:211], v33 abid:1
    s_add_u32 s43, s43, 4096
    buffer_load_dwordx4 a[240:243], v11, s[16:19], s43 offen offset:0 sc1
    ds_read2st64_b32 v[244:245], v236 offset0:0 offset1:72
    ds_read2st64_b32 v[246:247], v237 offset0:0 offset1:72
    v_xad_u32 v238, v238, v3, v4
    v_smfmac_f32_16x16x64_bf16 v[172:175], a[192:195], v[220:227], v33 abid:1
    s_waitcnt vmcnt(12)
    v_xad_u32 v239, v239, v3, v4
    v_smfmac_f32_16x16x64_bf16 v[140:143], a[196:199], v[204:211], v34
    buffer_load_dwordx4 a[244:247], v11, s[16:19], s43 offen offset:1024 sc1
    ds_read2st64_b32 v[248:249], v238 offset0:0 offset1:72
    ds_read2st64_b32 v[250:251], v239 offset0:0 offset1:72
    ds_read_b128 v[240:243], v8 offset:1024
    ds_read_b128 v[236:239], v9 offset:9344
    s_bitcmp1_b32 s27, 3
    s_cbranch_scc1 M_ov3
M_ovp3:
    s_bitcmp1_b32 s27, 4
    s_cbranch_scc1 M_ov4
M_ovp4:
    s_bitcmp1_b32 s27, 5
    s_cbranch_scc1 M_ov5
M_ovp5:
    v_smfmac_f32_16x16x64_bf16 v[176:179], a[196:199], v[220:227], v34
    s_waitcnt vmcnt(12)
    v_smfmac_f32_16x16x64_bf16 v[144:147], a[200:203], v[204:211], v34 abid:1
    buffer_load_dwordx4 a[248:251], v11, s[16:19], s43 offen offset:2048 sc1
    v_smfmac_f32_16x16x64_bf16 v[180:183], a[200:203], v[220:227], v34 abid:1
    s_waitcnt vmcnt(12)
    v_smfmac_f32_16x16x64_bf16 v[148:151], a[204:207], v[204:211], v35
    buffer_load_dwordx4 v[40:43], v11, s[16:19], s43 offen offset:3072 sc1
    s_add_u32 s43, s43, 4096
    buffer_load_dwordx4 a[252:255], v11, s[16:19], s43 offen offset:0 sc1
    s_waitcnt lgkmcnt(1)
    v_smfmac_f32_16x16x64_bf16 v[128:131], v[240:243], v[244:251], v10
    v_smfmac_f32_16x16x64_bf16 v[164:167], v[240:243], v[244:251], v10 abid:1
    s_waitcnt lgkmcnt(0)
    v_xad_u32 v236, v236, v3, v4
    v_smfmac_f32_16x16x64_bf16 v[184:187], a[204:207], v[220:227], v35
    s_waitcnt vmcnt(13)
    v_xad_u32 v237, v237, v3, v4
    v_smfmac_f32_16x16x64_bf16 v[152:155], a[208:211], v[204:211], v35 abid:1
    buffer_load_dwordx4 v[56:59], v11, s[16:19], s43 offen offset:1024 sc1
    ds_read2st64_b32 v[244:245], v236 offset0:0 offset1:72
    ds_read2st64_b32 v[246:247], v237 offset0:0 offset1:72
    v_xad_u32 v238, v238, v3, v4
    v_smfmac_f32_16x16x64_bf16 v[188:191], a[208:211], v[220:227], v35 abid:1
    s_waitcnt vmcnt(13)
    v_xad_u32 v239, v239, v3, v4
    v_smfmac_f32_16x16x64_bf16 v[156:159], a[212:215], v[204:211], v50 abid:1
    buffer_load_dwordx4 v[60:63], v11, s[16:19], s43 offen offset:2048 sc1
    ds_read2st64_b32 v[248:249], v238 offset0:0 offset1:72
    ds_read2st64_b32 v[250:251], v239 offset0:0 offset1:72
    ds_read_b128 v[240:243], v8 offset:2048
    ds_read_b128 v[236:239], v9 offset:9408
    s_bitcmp1_b32 s27, 6
    s_cbranch_scc1 M_ov6
M_ovp6:
    s_bitcmp1_b32 s27, 7
    s_cbranch_scc1 M_ov7
M_ovp7:
    s_bitcmp1_b32 s27, 8
    s_cbranch_scc1 M_ov8
M_ovp8:
    v_smfmac_f32_16x16x64_bf16 v[192:195], a[212:215], v[220:227], v50 abid:1
    s_waitcnt vmcnt(12)
    v_smfmac_f32_16x16x64_bf16 v[124:127], a[216:219], v[196:203], v36
    buffer_load_dwordx4 v[64:67], v11, s[16:19], s43 offen offset:3072 sc1
    v_smfmac_f32_16x16x64_bf16 v[160:163], a[216:219], v[228:235], v36
    ds_read_b128 v[204:207], v1 offset:7168
    ds_read_b128 v[208:211], v2 offset:7168
    s_waitcnt vmcnt(12)
    v_smfmac_f32_16x16x64_bf16 v[128:131], a[220:223], v[196:203], v36 abid:1
    s_add_u32 s43, s43, 4096
    buffer_load_dwordx4 v[68:71], v11, s[16:19], s43 offen offset:0 sc1
    s_waitcnt lgkmcnt(3)
    v_smfmac_f32_16x16x64_bf16 v[132:135], v[240:243], v[244:251], v10
    v_smfmac_f32_16x16x64_bf16 v[168:171], v[240:243], v[244:251], v10 abid:1
    s_waitcnt lgkmcnt(2)
    v_xad_u32 v236, v236, v3, v4
    v_smfmac_f32_16x16x64_bf16 v[164:167], a[220:223], v[228:235], v36 abid:1
    ds_read_b128 v[220:223], v1 offset:25600
    ds_read_b128 v[224:227], v2 offset:25600
    s_waitcnt vmcnt(12)
    v_xad_u32 v237, v237, v3, v4
    v_smfmac_f32_16x16x64_bf16 v[132:135], a[224:227], v[196:203], v37
    buffer_load_dwordx4 v[72:75], v11, s[16:19], s43 offen offset:1024 sc1
    ds_read2st64_b32 v[244:245], v236 offset0:0 offset1:72
    ds_read2st64_b32 v[246:247], v237 offset0:0 offset1:72
    v_xad_u32 v238, v238, v3, v4
    v_smfmac_f32_16x16x64_bf16 v[168:171], a[224:227], v[228:235], v37
    s_waitcnt vmcnt(12)
    v_xad_u32 v239, v239, v3, v4
    v_smfmac_f32_16x16x64_bf16 v[136:139], a[228:231], v[196:203], v37 abid:1
    buffer_load_dwordx4 v[76:79], v11, s[16:19], s43 offen offset:2048 sc1
    ds_read2st64_b32 v[248:249], v238 offset0:0 offset1:72
    ds_read2st64_b32 v[250:251], v239 offset0:0 offset1:72
    ds_read_b128 v[240:243], v8 offset:3072
    ds_read_b128 v[236:239], v9 offset:9472
    v_smfmac_f32_16x16x64_bf16 v[172:175], a[228:231], v[228:235], v37 abid:1
    s_waitcnt vmcnt(12)
    v_smfmac_f32_16x16x64_bf16 v[140:143], a[232:235], v[196:203], v38
    buffer_load_dwordx4 v[80:83], v11, s[16:19], s43 offen offset:3072 sc1
    v_smfmac_f32_16x16x64_bf16 v[176:179], a[232:235], v[228:235], v38
    s_waitcnt vmcnt(12)
    v_smfmac_f32_16x16x64_bf16 v[144:147], a[236:239], v[196:203], v38 abid:1
    s_add_u32 s43, s43, 4096
    buffer_load_dwordx4 v[84:87], v11, s[16:19], s43 offen offset:0 sc1
    s_waitcnt lgkmcnt(1)
    v_smfmac_f32_16x16x64_bf16 v[136:139], v[240:243], v[244:251], v10
    v_smfmac_f32_16x16x64_bf16 v[172:175], v[240:243], v[244:251], v10 abid:1
    s_waitcnt lgkmcnt(0)
    v_xad_u32 v236, v236, v3, v4
    v_smfmac_f32_16x16x64_bf16 v[180:183], a[236:239], v[228:235], v38 abid:1
    s_waitcnt vmcnt(12)
    v_xad_u32 v237, v237, v3, v4
    v_smfmac_f32_16x16x64_bf16 v[148:151], a[240:243], v[196:203], v39
    buffer_load_dwordx4 v[44:47], v11, s[16:19], s43 offen offset:1024 sc1
    buffer_load_dwordx4 v[88:91], v11, s[16:19], s43 offen offset:2048 sc1
    ds_read2st64_b32 v[244:245], v236 offset0:0 offset1:72
    ds_read2st64_b32 v[246:247], v237 offset0:0 offset1:72
    v_xad_u32 v238, v238, v3, v4
    v_smfmac_f32_16x16x64_bf16 v[184:187], a[240:243], v[228:235], v39
    s_waitcnt vmcnt(13)
    v_xad_u32 v239, v239, v3, v4
    v_smfmac_f32_16x16x64_bf16 v[152:155], a[244:247], v[196:203], v39 abid:1
    buffer_load_dwordx4 v[92:95], v11, s[16:19], s43 offen offset:3072 sc1
    ds_read2st64_b32 v[248:249], v238 offset0:0 offset1:72
    ds_read2st64_b32 v[250:251], v239 offset0:0 offset1:72
    ds_read_b128 v[240:243], v8 offset:4096
    ds_read_b128 v[236:239], v9 offset:9536
    v_smfmac_f32_16x16x64_bf16 v[188:191], a[244:247], v[228:235], v39 abid:1
    s_waitcnt vmcnt(13)
    v_smfmac_f32_16x16x64_bf16 v[156:159], a[248:251], v[196:203], v51
    s_add_u32 s43, s43, 4096
    buffer_load_dwordx4 v[96:99], v11, s[16:19], s43 offen offset:0 sc1
    v_smfmac_f32_16x16x64_bf16 v[192:195], a[248:251], v[228:235], v51
    s_waitcnt vmcnt(12)
    v_smfmac_f32_16x16x64_bf16 v[124:127], a[252:255], v[204:211], v40
    buffer_load_dwordx4 v[100:103], v11, s[16:19], s43 offen offset:1024 sc1
    ds_read_b128 v[196:199], v1 offset:8192
    ds_read_b128 v[200:203], v2 offset:8192
    s_waitcnt lgkmcnt(3)
    v_smfmac_f32_16x16x64_bf16 v[140:143], v[240:243], v[244:251], v10
    v_smfmac_f32_16x16x64_bf16 v[176:179], v[240:243], v[244:251], v10 abid:1
    s_waitcnt lgkmcnt(2)
    v_xad_u32 v236, v236, v3, v4
    s_waitcnt vmcnt(12)
    v_xad_u32 v237, v237, v3, v4
    v_smfmac_f32_16x16x64_bf16 v[128:131], v[56:59], v[204:211], v40 abid:1
    buffer_load_dwordx4 v[104:107], v11, s[16:19], s43 offen offset:2048 sc1
    ds_read_b128 v[228:231], v1 offset:26624
    ds_read_b128 v[232:235], v2 offset:26624
    ds_read2st64_b32 v[244:245], v236 offset0:0 offset1:72
    ds_read2st64_b32 v[246:247], v237 offset0:0 offset1:72
    v_xad_u32 v238, v238, v3, v4
    s_waitcnt vmcnt(12)
    v_xad_u32 v239, v239, v3, v4
    v_smfmac_f32_16x16x64_bf16 v[132:135], v[60:63], v[204:211], v41
    buffer_load_dwordx4 v[108:111], v11, s[16:19], s43 offen offset:3072 sc1
    ds_read2st64_b32 v[248:249], v238 offset0:0 offset1:72
    ds_read2st64_b32 v[250:251], v239 offset0:0 offset1:72
    ds_read_b128 v[240:243], v8 offset:5120
    ds_read_b128 v[236:239], v9 offset:9600
    s_waitcnt vmcnt(12)
    v_smfmac_f32_16x16x64_bf16 v[136:139], v[64:67], v[204:211], v41 abid:1
    s_add_u32 s43, s43, 4096
    buffer_load_dwordx4 v[112:115], v11, s[16:19], s43 offen offset:0 sc1
    s_waitcnt vmcnt(12)
    v_smfmac_f32_16x16x64_bf16 v[140:143], v[68:71], v[204:211], v42
    buffer_load_dwordx4 v[116:119], v11, s[16:19], s43 offen offset:1024 sc1
    s_waitcnt lgkmcnt(1)
    v_smfmac_f32_16x16x64_bf16 v[144:147], v[240:243], v[244:251], v10
    v_smfmac_f32_16x16x64_bf16 v[180:183], v[240:243], v[244:251], v10 abid:1
    s_waitcnt lgkmcnt(0)
    v_xad_u32 v236, v236, v3, v4
    s_waitcnt vmcnt(12)
    v_xad_u32 v237, v237, v3, v4
    v_smfmac_f32_16x16x64_bf16 v[144:147], v[72:75], v[204:211], v42 abid:1
    buffer_load_dwordx4 v[120:123], v11, s[16:19], s43 offen offset:2048 sc1
    ds_read2st64_b32 v[244:245], v236 offset0:0 offset1:72
    ds_read2st64_b32 v[246:247], v237 offset0:0 offset1:72
    v_xad_u32 v238, v238, v3, v4
    s_waitcnt vmcnt(12)
    v_xad_u32 v239, v239, v3, v4
    v_smfmac_f32_16x16x64_bf16 v[148:151], v[76:79], v[204:211], v43
    buffer_load_dword v254, v254, s[8:11], 0 offen
    ds_read2st64_b32 v[248:249], v238 offset0:0 offset1:72
    ds_read2st64_b32 v[250:251], v239 offset0:0 offset1:72
    ds_read_b128 v[240:243], v8 offset:6144
    ds_read_b128 v[236:239], v9 offset:9664
    s_waitcnt vmcnt(12)
    v_smfmac_f32_16x16x64_bf16 v[152:155], v[80:83], v[204:211], v43 abid:1
    s_waitcnt vmcnt(11)
    v_smfmac_f32_16x16x64_bf16 v[156:159], v[84:87], v[204:211], v51 abid:1
    s_waitcnt lgkmcnt(1)
    v_smfmac_f32_16x16x64_bf16 v[148:151], v[240:243], v[244:251], v10
    v_smfmac_f32_16x16x64_bf16 v[184:187], v[240:243], v[244:251], v10 abid:1
    s_waitcnt lgkmcnt(0)
    v_xad_u32 v236, v236, v3, v4
    s_waitcnt vmcnt(9)
    v_xad_u32 v237, v237, v3, v4
    v_smfmac_f32_16x16x64_bf16 v[124:127], v[88:91], v[196:203], v44
    ds_read2st64_b32 v[244:245], v236 offset0:0 offset1:72
    ds_read2st64_b32 v[246:247], v237 offset0:0 offset1:72
    v_xad_u32 v238, v238, v3, v4
    s_waitcnt vmcnt(8)
    v_xad_u32 v239, v239, v3, v4
    v_smfmac_f32_16x16x64_bf16 v[128:131], v[92:95], v[196:203], v44 abid:1
    ds_read2st64_b32 v[248:249], v238 offset0:0 offset1:72
    ds_read2st64_b32 v[250:251], v239 offset0:0 offset1:72
    ds_read_b128 v[240:243], v8 offset:7168
    s_waitcnt vmcnt(7)
    v_smfmac_f32_16x16x64_bf16 v[132:135], v[96:99], v[196:203], v45
    s_waitcnt vmcnt(6)
    v_smfmac_f32_16x16x64_bf16 v[136:139], v[100:103], v[196:203], v45 abid:1
    s_waitcnt lgkmcnt(0)
    v_smfmac_f32_16x16x64_bf16 v[152:155], v[240:243], v[244:251], v10
    v_smfmac_f32_16x16x64_bf16 v[188:191], v[240:243], v[244:251], v10 abid:1
    s_waitcnt vmcnt(5)
    v_smfmac_f32_16x16x64_bf16 v[140:143], v[104:107], v[196:203], v46
    s_waitcnt vmcnt(4)
    v_smfmac_f32_16x16x64_bf16 v[144:147], v[108:111], v[196:203], v46 abid:1
    s_waitcnt vmcnt(3)
    v_smfmac_f32_16x16x64_bf16 v[148:151], v[112:115], v[196:203], v47
    s_waitcnt vmcnt(2)
    v_smfmac_f32_16x16x64_bf16 v[152:155], v[116:119], v[196:203], v47 abid:1
    s_waitcnt vmcnt(1)
    v_smfmac_f32_16x16x64_bf16 v[156:159], v[120:123], v[196:203], v52
    s_cmp_gt_u32 s46, 1
    s_cbranch_scc1 M_slow
M_slowr0:
    v_cvt_pk_bf16_f32 v124, v124, v125
    v_cvt_pk_bf16_f32 v125, v126, v127
    v_cvt_pk_bf16_f32 v126, v128, v129
    v_cvt_pk_bf16_f32 v127, v130, v131
    v_cvt_pk_bf16_f32 v132, v132, v133
    v_cvt_pk_bf16_f32 v133, v134, v135
    v_cvt_pk_bf16_f32 v134, v136, v137
    v_cvt_pk_bf16_f32 v135, v138, v139
    ds_read_b128 v[136:139], v9 offset:10432
    v_cndmask_b32_dpp v128, v124, v132, vcc row_ror:8 row_mask:0xf bank_mask:0xf
    v_cndmask_b32_dpp v129, v125, v133, vcc row_ror:8 row_mask:0xf bank_mask:0xf
    v_cndmask_b32_dpp v130, v126, v134, vcc row_ror:8 row_mask:0xf bank_mask:0xf
    v_cndmask_b32_dpp v131, v127, v135, vcc row_ror:8 row_mask:0xf bank_mask:0xf
    buffer_store_dwordx4 v[128:131], v6, s[12:15], s59 offen offset:0 sc1
    v_mov_b32_dpp v124, v132 row_ror:8 row_mask:0xf bank_mask:0xc
    v_mov_b32_dpp v125, v133 row_ror:8 row_mask:0xf bank_mask:0xc
    v_mov_b32_dpp v126, v134 row_ror:8 row_mask:0xf bank_mask:0xc
    v_mov_b32_dpp v127, v135 row_ror:8 row_mask:0xf bank_mask:0xc
    buffer_store_dwordx4 v[124:127], v6, s[12:15], s24 offen offset:0 sc1
    ds_read_b128 v[128:131], v9 offset:10304
    ds_read_b128 v[132:135], v9 offset:10368
    ds_read_b128 v[124:127], v9 offset:10240
    v_cvt_pk_bf16_f32 v140, v140, v141
    v_cvt_pk_bf16_f32 v141, v142, v143
    v_cvt_pk_bf16_f32 v142, v144, v145
    v_cvt_pk_bf16_f32 v143, v146, v147
    v_cvt_pk_bf16_f32 v148, v148, v149
    v_cvt_pk_bf16_f32 v149, v150, v151
    v_cvt_pk_bf16_f32 v150, v152, v153
    v_cvt_pk_bf16_f32 v151, v154, v155
    ds_read_b128 v[152:155], v9 offset:10688
    v_cndmask_b32_dpp v144, v140, v148, vcc row_ror:8 row_mask:0xf bank_mask:0xf
    v_cndmask_b32_dpp v145, v141, v149, vcc row_ror:8 row_mask:0xf bank_mask:0xf
    v_cndmask_b32_dpp v146, v142, v150, vcc row_ror:8 row_mask:0xf bank_mask:0xf
    v_cndmask_b32_dpp v147, v143, v151, vcc row_ror:8 row_mask:0xf bank_mask:0xf
    buffer_store_dwordx4 v[144:147], v6, s[12:15], s59 offen offset:128 sc1
    v_mov_b32_dpp v140, v148 row_ror:8 row_mask:0xf bank_mask:0xc
    v_mov_b32_dpp v141, v149 row_ror:8 row_mask:0xf bank_mask:0xc
    v_mov_b32_dpp v142, v150 row_ror:8 row_mask:0xf bank_mask:0xc
    v_mov_b32_dpp v143, v151 row_ror:8 row_mask:0xf bank_mask:0xc
    buffer_store_dwordx4 v[140:143], v6, s[12:15], s24 offen offset:128 sc1
    ds_read_b128 v[144:147], v9 offset:10560
    ds_read_b128 v[148:151], v9 offset:10624
    ds_read_b128 v[140:143], v9 offset:10496
    v_cvt_pk_bf16_f32 v156, v156, v157
    v_cvt_pk_bf16_f32 v157, v158, v159
    ds_write_b64 v252, v[156:157] offset:23680
    ds_read_b128 v[156:159], v9 offset:10752
    s_mov_b32 s91, 0
    s_mov_b32 s25, 36864
    s_add_u32 s90, s24, 9437184
    s_add_u32 s22, s90, 9437184
    s_add_u32 s28, s26, 73728
    s_cmp_eq_u32 s41, 3
    s_cselect_b32 s10, 0, 75497472
    s_cselect_b32 s89, 0x30000, s28
    s_add_u32 s23, s24, 18432
    s_cmp_lt_u32 s20, 2
    s_cselect_b32 s66, s23, s24
    s_add_u32 s66, s66, s95
    v_mov_b32 v0, s22
    ds_write_b32 v253, v0
    v_mov_b32 v0, 157952
    v_add_u32 v4, 36864, v4
    v_add_u32 v1, 36864, v1
    v_add_u32 v2, 36864, v2
    s_branch M_top1
M_top:
    s_waitcnt vmcnt(4)
M_top1:
    s_add_u32 s23, s24, 18432
    s_add_u32 s58, s24, 27648
    s_mov_b32 s24, s90
    s_add_u32 s59, s90, 9216
    s_waitcnt lgkmcnt(0)
    s_barrier
    ds_read_b32 v0, v0
    ds_read_b128 v[244:247], v8 offset:10816
    v_smfmac_f32_16x16x64_bf16 v[160:163], a[252:255], v[220:227], v40
    ds_read_b128 v[196:199], v1 offset:0
    v_smfmac_f32_16x16x64_bf16 v[160:163], v[88:91], v[228:235], v44
    ds_read_b128 v[200:203], v2 offset:0
    v_smfmac_f32_16x16x64_bf16 v[164:167], v[56:59], v[220:227], v40 abid:1
    ds_read_b128 v[204:207], v1 offset:1024
    v_smfmac_f32_16x16x64_bf16 v[164:167], v[92:95], v[228:235], v44 abid:1
    ds_read_b128 v[208:211], v2 offset:1024
    v_smfmac_f32_16x16x64_bf16 v[168:171], v[60:63], v[220:227], v41
    ds_read_b128 v[212:215], v1 offset:2048
    s_waitcnt lgkmcnt(6)
    v_readfirstlane_b32 s22, v0
    v_smfmac_f32_16x16x64_bf16 v[168:171], v[96:99], v[228:235], v45
    ds_read_b128 v[216:219], v2 offset:2048
    s_cmp_lt_u32 s22, 75497472
    s_cbranch_scc0 M_bF
M_bL:
    v_smfmac_f32_16x16x64_bf16 v[172:175], v[64:67], v[220:227], v41 abid:1
    s_waitcnt vmcnt(6)
    s_waitcnt lgkmcnt(6)
    buffer_store_dwordx4 v[244:247], v7, s[12:15], s66 offen sc1
    v_smfmac_f32_16x16x64_bf16 v[172:175], v[100:103], v[228:235], v45 abid:1
    ds_read_b128 v[236:239], v9 offset:9728
    v_smfmac_f32_16x16x64_bf16 v[176:179], v[68:71], v[220:227], v42
    s_mov_b32 s21, 1
    v_smfmac_f32_16x16x64_bf16 v[176:179], v[104:107], v[228:235], v46
    v_smfmac_f32_16x16x64_bf16 v[180:183], v[72:75], v[220:227], v42 abid:1
    s_mov_b32 m0, s89
    v_cvt_pk_bf16_f32 v160, v160, v161
    v_smfmac_f32_16x16x64_bf16 v[180:183], v[108:111], v[228:235], v46 abid:1
    s_waitcnt vmcnt(6)
    buffer_load_dwordx4 v5, s[8:11], s22 offen offset:0 nt lds
    v_cvt_pk_bf16_f32 v161, v162, v163
    v_smfmac_f32_16x16x64_bf16 v[184:187], v[76:79], v[220:227], v43
    v_cvt_pk_bf16_f32 v162, v164, v165
    v_smfmac_f32_16x16x64_bf16 v[184:187], v[112:115], v[228:235], v47
    v_cvt_pk_bf16_f32 v163, v166, v167
    v_smfmac_f32_16x16x64_bf16 v[188:191], v[80:83], v[220:227], v43 abid:1
    v_cvt_pk_bf16_f32 v168, v168, v169
    v_smfmac_f32_16x16x64_bf16 v[188:191], v[116:119], v[228:235], v47 abid:1
    v_cvt_pk_bf16_f32 v169, v170, v171
    v_smfmac_f32_16x16x64_bf16 v[192:195], v[84:87], v[220:227], v51 abid:1
    s_barrier
    v_cvt_pk_bf16_f32 v170, v172, v173
    v_smfmac_f32_16x16x64_bf16 v[192:195], v[120:123], v[228:235], v52
    ds_read_b128 v[220:223], v1 offset:3072
    s_waitcnt lgkmcnt(6)
    v_cvt_pk_bf16_f32 v171, v174, v175
    v_smfmac_f32_16x16x64_bf16 v[124:127], a[0:3], v[196:203], v12
    ds_read_b128 v[224:227], v2 offset:3072
    ds_read_b128 v[172:175], v9 offset:10432
    s_waitcnt lgkmcnt(6)
    v_cndmask_b32_dpp v164, v160, v168, vcc row_ror:8 row_mask:0xf bank_mask:0xf
    v_smfmac_f32_16x16x64_bf16 v[124:127], a[36:39], v[204:211], v16
    ds_read_b128 v[228:231], v1 offset:4096
    s_waitcnt lgkmcnt(5)
    v_cndmask_b32_dpp v165, v161, v169, vcc row_ror:8 row_mask:0xf bank_mask:0xf
    v_smfmac_f32_16x16x64_bf16 v[124:127], a[72:75], v[212:219], v20
    ds_read_b128 v[232:235], v2 offset:4096
    v_cndmask_b32_dpp v166, v162, v170, vcc row_ror:8 row_mask:0xf bank_mask:0xf
    v_smfmac_f32_16x16x64_bf16 v[128:131], a[4:7], v[196:203], v12 abid:1
    s_add_u32 m0, m0, 896
    v_cndmask_b32_dpp v167, v163, v171, vcc row_ror:8 row_mask:0xf bank_mask:0xf
    v_smfmac_f32_16x16x64_bf16 v[128:131], a[40:43], v[204:211], v16 abid:1
    s_waitcnt vmcnt(6)
    buffer_store_dwordx4 v[164:167], v6, s[12:15], s58 offen offset:0 sc1
    v_mov_b32_dpp v160, v168 row_ror:8 row_mask:0xf bank_mask:0xc
    v_smfmac_f32_16x16x64_bf16 v[128:131], a[76:79], v[212:219], v20 abid:1
    s_waitcnt vmcnt(6)
    buffer_load_dwordx4 v5, s[8:11], s22 offen offset:128 nt lds
    s_waitcnt lgkmcnt(5)
    v_xad_u32 v236, v236, v3, v4
    v_smfmac_f32_16x16x64_bf16 v[132:135], a[8:11], v[196:203], v13
    ds_read2st64_b32 v[244:245], v236 offset0:0 offset1:72
    v_xad_u32 v237, v237, v3, v4
    v_smfmac_f32_16x16x64_bf16 v[132:135], a[44:47], v[204:211], v17
    ds_read2st64_b32 v[246:247], v237 offset0:0 offset1:72
    v_xad_u32 v238, v238, v3, v4
    v_smfmac_f32_16x16x64_bf16 v[132:135], a[80:83], v[212:219], v21
    ds_read2st64_b32 v[248:249], v238 offset0:0 offset1:72
    v_xad_u32 v239, v239, v3, v4
    v_smfmac_f32_16x16x64_bf16 v[136:139], a[12:15], v[196:203], v13 abid:1
    ds_read2st64_b32 v[250:251], v239 offset0:0 offset1:72
    v_mov_b32_dpp v161, v169 row_ror:8 row_mask:0xf bank_mask:0xc
    v_smfmac_f32_16x16x64_bf16 v[136:139], a[48:51], v[204:211], v17 abid:1
    ds_read_b128 v[236:239], v9 offset:9216
    ds_read_b128 v[240:243], v8 offset:8192
    v_mov_b32_dpp v162, v170 row_ror:8 row_mask:0xf bank_mask:0xc
    v_smfmac_f32_16x16x64_bf16 v[136:139], a[84:87], v[212:219], v21 abid:1
    v_mov_b32_dpp v163, v171 row_ror:8 row_mask:0xf bank_mask:0xc
    v_smfmac_f32_16x16x64_bf16 v[140:143], a[16:19], v[196:203], v14
    s_waitcnt vmcnt(6)
    buffer_store_dwordx4 v[160:163], v6, s[12:15], s23 offen offset:0 sc1
    ds_read_b128 v[164:167], v9 offset:10304
    v_smfmac_f32_16x16x64_bf16 v[140:143], a[52:55], v[204:211], v18
    ds_read_b128 v[168:171], v9 offset:10368
    ds_read_b128 v[160:163], v9 offset:10240
    v_cvt_pk_bf16_f32 v192, v192, v193
    v_smfmac_f32_16x16x64_bf16 v[140:143], a[88:91], v[212:219], v22
    v_cvt_pk_bf16_f32 v193, v194, v195
    v_smfmac_f32_16x16x64_bf16 v[144:147], a[20:23], v[196:203], v14 abid:1
    ds_write_b64 v252, v[192:193] offset:0
    ds_read_b128 v[192:195], v9 offset:10752
    v_smfmac_f32_16x16x64_bf16 v[144:147], a[56:59], v[204:211], v18 abid:1
    v_smfmac_f32_16x16x64_bf16 v[144:147], a[92:95], v[212:219], v22 abid:1
    s_waitcnt lgkmcnt(5)
    v_xad_u32 v236, v236, v3, v4
    v_smfmac_f32_16x16x64_bf16 v[156:159], v[240:243], v[244:251], v10
    s_waitcnt lgkmcnt(0)
    v_xad_u32 v237, v237, v3, v4
    v_smfmac_f32_16x16x64_bf16 v[192:195], v[240:243], v[244:251], v10 abid:1
    ds_read2st64_b32 v[244:245], v236 offset0:0 offset1:72
    v_xad_u32 v238, v238, v3, v4
    v_smfmac_f32_16x16x64_bf16 v[148:151], a[24:27], v[196:203], v15
    ds_read2st64_b32 v[246:247], v237 offset0:0 offset1:72
    v_xad_u32 v239, v239, v3, v4
    v_smfmac_f32_16x16x64_bf16 v[148:151], a[60:63], v[204:211], v19
    ds_read2st64_b32 v[248:249], v238 offset0:0 offset1:72
    v_smfmac_f32_16x16x64_bf16 v[148:151], a[96:99], v[212:219], v23
    ds_read2st64_b32 v[250:251], v239 offset0:0 offset1:72
    s_add_u32 m0, m0, 896
    v_smfmac_f32_16x16x64_bf16 v[152:155], a[28:31], v[196:203], v15 abid:1
    ds_read_b128 v[236:239], v9 offset:9280
    ds_read_b128 v[240:243], v8 offset:0
    s_waitcnt vmcnt(6)
    v_smfmac_f32_16x16x64_bf16 v[152:155], a[64:67], v[204:211], v19 abid:1
    buffer_load_dwordx4 v5, s[8:11], s22 offen offset:256 nt lds
    v_smfmac_f32_16x16x64_bf16 v[152:155], a[100:103], v[212:219], v23 abid:1
    v_smfmac_f32_16x16x64_bf16 v[156:159], a[32:35], v[196:203], v48
    v_smfmac_f32_16x16x64_bf16 v[156:159], a[68:71], v[204:211], v48 abid:1
    v_smfmac_f32_16x16x64_bf16 v[156:159], a[104:107], v[212:219], v49
    ds_read_b128 v[196:199], v1 offset:5120
    v_cvt_pk_bf16_f32 v176, v176, v177
    v_smfmac_f32_16x16x64_bf16 v[124:127], a[108:111], v[220:227], v24
    ds_read_b128 v[200:203], v2 offset:5120
    v_cvt_pk_bf16_f32 v177, v178, v179
    v_smfmac_f32_16x16x64_bf16 v[124:127], a[144:147], v[228:235], v28
    ds_read_b128 v[204:207], v1 offset:6144
    ds_read_b128 v[216:219], v9 offset:9792
    v_cvt_pk_bf16_f32 v178, v180, v181
    v_smfmac_f32_16x16x64_bf16 v[128:131], a[112:115], v[220:227], v24 abid:1
    ds_read_b128 v[208:211], v2 offset:6144
    v_cvt_pk_bf16_f32 v179, v182, v183
    v_smfmac_f32_16x16x64_bf16 v[128:131], a[148:151], v[228:235], v28 abid:1
    s_waitcnt lgkmcnt(5)
    v_xad_u32 v236, v236, v3, v4
    v_smfmac_f32_16x16x64_bf16 v[124:127], v[240:243], v[244:251], v10
    s_add_u32 m0, m0, 896
    v_xad_u32 v237, v237, v3, v4
    v_smfmac_f32_16x16x64_bf16 v[160:163], v[240:243], v[244:251], v10 abid:1
    ds_read2st64_b32 v[244:245], v236 offset0:0 offset1:72
    s_waitcnt vmcnt(6)
    v_xad_u32 v238, v238, v3, v4
    v_smfmac_f32_16x16x64_bf16 v[132:135], a[116:119], v[220:227], v25
    ds_read2st64_b32 v[246:247], v237 offset0:0 offset1:72
    buffer_load_dwordx4 v5, s[8:11], s22 offen offset:384 nt lds
    v_xad_u32 v239, v239, v3, v4
    v_smfmac_f32_16x16x64_bf16 v[132:135], a[152:155], v[228:235], v29
    ds_read2st64_b32 v[248:249], v238 offset0:0 offset1:72
    v_cvt_pk_bf16_f32 v184, v184, v185
    v_smfmac_f32_16x16x64_bf16 v[136:139], a[120:123], v[220:227], v25 abid:1
    ds_read2st64_b32 v[250:251], v239 offset0:0 offset1:72
    v_cvt_pk_bf16_f32 v185, v186, v187
    v_smfmac_f32_16x16x64_bf16 v[136:139], a[156:159], v[228:235], v29 abid:1
    ds_read_b128 v[236:239], v9 offset:9344
    ds_read_b128 v[240:243], v8 offset:1024
    v_cvt_pk_bf16_f32 v186, v188, v189
    v_smfmac_f32_16x16x64_bf16 v[140:143], a[124:127], v[220:227], v26
    v_cvt_pk_bf16_f32 v187, v190, v191
    v_smfmac_f32_16x16x64_bf16 v[140:143], a[160:163], v[228:235], v30
    ds_read_b128 v[188:191], v9 offset:10688
    v_cndmask_b32_dpp v180, v176, v184, vcc row_ror:8 row_mask:0xf bank_mask:0xf
    v_smfmac_f32_16x16x64_bf16 v[144:147], a[128:131], v[220:227], v26 abid:1
    v_cndmask_b32_dpp v181, v177, v185, vcc row_ror:8 row_mask:0xf bank_mask:0xf
    v_smfmac_f32_16x16x64_bf16 v[144:147], a[164:167], v[228:235], v30 abid:1
    v_cndmask_b32_dpp v182, v178, v186, vcc row_ror:8 row_mask:0xf bank_mask:0xf
    v_smfmac_f32_16x16x64_bf16 v[148:151], a[132:135], v[220:227], v27
    v_cndmask_b32_dpp v183, v179, v187, vcc row_ror:8 row_mask:0xf bank_mask:0xf
    v_smfmac_f32_16x16x64_bf16 v[148:151], a[168:171], v[228:235], v31
    s_waitcnt vmcnt(6)
    buffer_store_dwordx4 v[180:183], v6, s[12:15], s58 offen offset:128 sc1
    v_mov_b32_dpp v176, v184 row_ror:8 row_mask:0xf bank_mask:0xc
    v_smfmac_f32_16x16x64_bf16 v[152:155], a[136:139], v[220:227], v27 abid:1
    v_mov_b32_dpp v177, v185 row_ror:8 row_mask:0xf bank_mask:0xc
    v_smfmac_f32_16x16x64_bf16 v[152:155], a[172:175], v[228:235], v31 abid:1
    s_waitcnt lgkmcnt(1)
    v_xad_u32 v236, v236, v3, v4
    v_smfmac_f32_16x16x64_bf16 v[128:131], v[240:243], v[244:251], v10
    v_xad_u32 v237, v237, v3, v4
    v_smfmac_f32_16x16x64_bf16 v[164:167], v[240:243], v[244:251], v10 abid:1
    ds_read2st64_b32 v[244:245], v236 offset0:0 offset1:72
    v_xad_u32 v238, v238, v3, v4
    v_smfmac_f32_16x16x64_bf16 v[156:159], a[140:143], v[220:227], v49 abid:1
    ds_read2st64_b32 v[246:247], v237 offset0:0 offset1:72
    v_xad_u32 v239, v239, v3, v4
    v_smfmac_f32_16x16x64_bf16 v[156:159], a[176:179], v[228:235], v50
    ds_read_b128 v[220:223], v1 offset:7168
    ds_read2st64_b32 v[248:249], v238 offset0:0 offset1:72
    v_mov_b32_dpp v178, v186 row_ror:8 row_mask:0xf bank_mask:0xc
    v_smfmac_f32_16x16x64_bf16 v[124:127], a[180:183], v[196:203], v32
    ds_read_b128 v[224:227], v2 offset:7168
    ds_read2st64_b32 v[250:251], v239 offset0:0 offset1:72
    v_mov_b32_dpp v179, v187 row_ror:8 row_mask:0xf bank_mask:0xc
    v_smfmac_f32_16x16x64_bf16 v[124:127], a[216:219], v[204:211], v36
    ds_read_b128 v[228:231], v1 offset:8192
    ds_read_b128 v[236:239], v9 offset:9408
    s_waitcnt vmcnt(6)
    v_smfmac_f32_16x16x64_bf16 v[128:131], a[184:187], v[196:203], v32 abid:1
    ds_read_b128 v[232:235], v2 offset:8192
    ds_read_b128 v[240:243], v8 offset:2048
    buffer_store_dwordx4 v[176:179], v6, s[12:15], s23 offen offset:128 sc1
    v_smfmac_f32_16x16x64_bf16 v[128:131], a[220:223], v[204:211], v36 abid:1
    ds_read_b128 v[180:183], v9 offset:10560
    ds_read_b128 v[184:187], v9 offset:10624
    ds_read_b128 v[176:179], v9 offset:10496
    v_smfmac_f32_16x16x64_bf16 v[132:135], a[188:191], v[196:203], v33
    v_and_b32 v212, 0x3fff, v216
    v_smfmac_f32_16x16x64_bf16 v[132:135], a[224:227], v[204:211], v37
    s_add_u32 m0, m0, 896
    v_and_b32 v214, 0x3fff, v218
    v_smfmac_f32_16x16x64_bf16 v[136:139], a[192:195], v[196:203], v33 abid:1
    s_waitcnt vmcnt(6)
    buffer_load_dwordx4 v5, s[8:11], s22 offen offset:512 nt lds
    v_xad_u32 v212, v212, v3, v4
    v_smfmac_f32_16x16x64_bf16 v[136:139], a[228:231], v[204:211], v37 abid:1
    ds_read2st64_b32 v[212:213], v212 offset0:0 offset1:72
    v_xad_u32 v214, v214, v3, v4
    v_smfmac_f32_16x16x64_bf16 v[140:143], a[196:199], v[196:203], v34
    ds_read2st64_b32 v[214:215], v214 offset0:0 offset1:72
    v_smfmac_f32_16x16x64_bf16 v[140:143], a[232:235], v[204:211], v38
    s_waitcnt lgkmcnt(5)
    v_xad_u32 v236, v236, v3, v4
    v_smfmac_f32_16x16x64_bf16 v[132:135], v[240:243], v[244:251], v10
    v_xad_u32 v237, v237, v3, v4
    v_smfmac_f32_16x16x64_bf16 v[168:171], v[240:243], v[244:251], v10 abid:1
    ds_read2st64_b32 v[244:245], v236 offset0:0 offset1:72
    v_xad_u32 v238, v238, v3, v4
    v_smfmac_f32_16x16x64_bf16 v[144:147], a[200:203], v[196:203], v34 abid:1
    ds_read2st64_b32 v[246:247], v237 offset0:0 offset1:72
    v_xad_u32 v239, v239, v3, v4
    v_smfmac_f32_16x16x64_bf16 v[144:147], a[236:239], v[204:211], v38 abid:1
    ds_read2st64_b32 v[248:249], v238 offset0:0 offset1:72
    s_bitcmp1_b32 s27, 0
    s_waitcnt lgkmcnt(3)
    s_cbranch_scc1 M_ov0
M_ovr0L:
    v_smfmac_f32_16x16x64_bf16 v[148:151], a[204:207], v[196:203], v35
    ds_read2st64_b32 v[250:251], v239 offset0:0 offset1:72
    s_bitcmp1_b32 s27, 1
    s_cbranch_scc1 M_ov1
M_ovr1L:
    v_smfmac_f32_16x16x64_bf16 v[148:151], a[240:243], v[204:211], v39
    ds_read_b128 v[236:239], v9 offset:9472
    ds_read_b128 v[240:243], v8 offset:3072
    v_smfmac_f32_16x16x64_bf16 v[152:155], a[208:211], v[196:203], v35 abid:1
    s_add_u32 m0, m0, 896
    s_bitcmp1_b32 s27, 2
    s_cbranch_scc1 M_ov2
M_ovr2L:
    v_smfmac_f32_16x16x64_bf16 v[152:155], a[244:247], v[204:211], v39 abid:1
    s_waitcnt vmcnt(6)
    buffer_load_dwordx4 v5, s[8:11], s22 offen offset:640 nt lds
    v_smfmac_f32_16x16x64_bf16 v[156:159], a[212:215], v[196:203], v50 abid:1
    s_bitcmp1_b32 s27, 3
    s_cbranch_scc1 M_ov3
M_ovr3L:
    v_smfmac_f32_16x16x64_bf16 v[156:159], a[248:251], v[204:211], v51
    ds_read_b128 v[196:199], v1 offset:18432
    s_bitcmp1_b32 s27, 4
    s_cbranch_scc1 M_ov4
M_ovr4L:
    v_smfmac_f32_16x16x64_bf16 v[124:127], a[252:255], v[220:227], v40
    ds_read_b128 v[200:203], v2 offset:18432
    s_bitcmp1_b32 s27, 5
    s_cbranch_scc1 M_ov5
M_ovr5L:
    v_smfmac_f32_16x16x64_bf16 v[124:127], v[88:91], v[228:235], v44
    ds_read_b128 v[204:207], v1 offset:19456
    s_bitcmp1_b32 s27, 6
    s_cbranch_scc1 M_ov6
M_ovr6L:
    v_smfmac_f32_16x16x64_bf16 v[128:131], v[56:59], v[220:227], v40 abid:1
    ds_read_b128 v[208:211], v2 offset:19456
    s_bitcmp1_b32 s27, 7
    s_cbranch_scc1 M_ov7
M_ovr7L:
    v_smfmac_f32_16x16x64_bf16 v[128:131], v[92:95], v[228:235], v44 abid:1
    s_waitcnt lgkmcnt(4)
    v_xad_u32 v236, v236, v3, v4
    v_smfmac_f32_16x16x64_bf16 v[136:139], v[240:243], v[244:251], v10
    s_add_u32 m0, m0, 896
    v_xad_u32 v237, v237, v3, v4
    v_smfmac_f32_16x16x64_bf16 v[172:175], v[240:243], v[244:251], v10 abid:1
    ds_read2st64_b32 v[244:245], v236 offset0:0 offset1:72
    s_waitcnt vmcnt(6)
    v_xad_u32 v238, v238, v3, v4
    v_smfmac_f32_16x16x64_bf16 v[132:135], v[60:63], v[220:227], v41
    ds_read2st64_b32 v[246:247], v237 offset0:0 offset1:72
    buffer_load_dwordx4 v5, s[8:11], s22 offen offset:768 nt lds
    v_xad_u32 v239, v239, v3, v4
    v_smfmac_f32_16x16x64_bf16 v[132:135], v[96:99], v[228:235], v45
    ds_read2st64_b32 v[248:249], v238 offset0:0 offset1:72
    s_bitcmp1_b32 s27, 8
    s_cbranch_scc1 M_ov8
M_ovr8L:
    v_smfmac_f32_16x16x64_bf16 v[136:139], v[64:67], v[220:227], v41 abid:1
    ds_read2st64_b32 v[250:251], v239 offset0:0 offset1:72
    v_smfmac_f32_16x16x64_bf16 v[136:139], v[100:103], v[228:235], v45 abid:1
    ds_read_b128 v[236:239], v9 offset:9536
    ds_read_b128 v[240:243], v8 offset:4096
    v_smfmac_f32_16x16x64_bf16 v[140:143], v[68:71], v[220:227], v42
    v_smfmac_f32_16x16x64_bf16 v[140:143], v[104:107], v[228:235], v46
    v_mov_b32 v0, 1
    v_smfmac_f32_16x16x64_bf16 v[144:147], v[72:75], v[220:227], v42 abid:1
    ds_read_b128 v[212:215], v1 offset:20480
    s_waitcnt vmcnt(6)
    buffer_atomic_add v0, v253, s[16:19], s92 offen sc0 sc1
    v_smfmac_f32_16x16x64_bf16 v[144:147], v[108:111], v[228:235], v46 abid:1
    ds_read_b128 v[216:219], v2 offset:20480
    v_smfmac_f32_16x16x64_bf16 v[148:151], v[76:79], v[220:227], v43
    v_smfmac_f32_16x16x64_bf16 v[148:151], v[112:115], v[228:235], v47
    v_smfmac_f32_16x16x64_bf16 v[152:155], v[80:83], v[220:227], v43 abid:1
    v_smfmac_f32_16x16x64_bf16 v[152:155], v[116:119], v[228:235], v47 abid:1
    s_waitcnt lgkmcnt(2)
    v_xad_u32 v236, v236, v3, v4
    v_smfmac_f32_16x16x64_bf16 v[140:143], v[240:243], v[244:251], v10
    v_xad_u32 v237, v237, v3, v4
    v_smfmac_f32_16x16x64_bf16 v[176:179], v[240:243], v[244:251], v10 abid:1
    s_cmp_gt_u32 s46, 1
    s_cbranch_scc1 M_slow
M_slowrL:
    v_xad_u32 v238, v238, v3, v4
    v_smfmac_f32_16x16x64_bf16 v[156:159], v[84:87], v[220:227], v51 abid:1
    ds_read2st64_b32 v[244:245], v236 offset0:0 offset1:72
    v_xad_u32 v239, v239, v3, v4
    v_smfmac_f32_16x16x64_bf16 v[156:159], v[120:123], v[228:235], v52
    ds_read_b128 v[220:223], v1 offset:21504
    ds_read2st64_b32 v[246:247], v237 offset0:0 offset1:72
    v_smfmac_f32_16x16x64_bf16 v[160:163], a[0:3], v[196:203], v12
    ds_read_b128 v[224:227], v2 offset:21504
    ds_read2st64_b32 v[248:249], v238 offset0:0 offset1:72
    v_smfmac_f32_16x16x64_bf16 v[160:163], a[36:39], v[204:211], v16
    ds_read_b128 v[228:231], v1 offset:22528
    ds_read2st64_b32 v[250:251], v239 offset0:0 offset1:72
    s_waitcnt lgkmcnt(7)
    v_smfmac_f32_16x16x64_bf16 v[160:163], a[72:75], v[212:219], v20
    ds_read_b128 v[232:235], v2 offset:22528
    ds_read_b128 v[236:239], v9 offset:9600
    v_smfmac_f32_16x16x64_bf16 v[164:167], a[4:7], v[196:203], v12 abid:1
    ds_read_b128 v[240:243], v8 offset:5120
    v_cvt_pk_bf16_f32 v156, v156, v157
    v_smfmac_f32_16x16x64_bf16 v[164:167], a[40:43], v[204:211], v16 abid:1
    s_add_u32 m0, m0, 896
    v_cvt_pk_bf16_f32 v157, v158, v159
    v_smfmac_f32_16x16x64_bf16 v[164:167], a[76:79], v[212:219], v20 abid:1
    ds_write_b64 v252, v[156:157] offset:23680
    ds_read_b128 v[156:159], v9 offset:10752
    s_waitcnt vmcnt(6)
    v_smfmac_f32_16x16x64_bf16 v[168:171], a[8:11], v[196:203], v13
    buffer_load_dwordx4 v5, s[8:11], s22 offen offset:896 nt lds
    v_smfmac_f32_16x16x64_bf16 v[168:171], a[44:47], v[204:211], v17
    v_cvt_pk_bf16_f32 v124, v124, v125
    v_smfmac_f32_16x16x64_bf16 v[168:171], a[80:83], v[212:219], v21
    s_waitcnt lgkmcnt(2)
    v_xad_u32 v236, v236, v3, v4
    v_smfmac_f32_16x16x64_bf16 v[144:147], v[240:243], v[244:251], v10
    v_xad_u32 v237, v237, v3, v4
    v_smfmac_f32_16x16x64_bf16 v[180:183], v[240:243], v[244:251], v10 abid:1
    ds_read2st64_b32 v[244:245], v236 offset0:0 offset1:72
    v_xad_u32 v238, v238, v3, v4
    v_smfmac_f32_16x16x64_bf16 v[172:175], a[12:15], v[196:203], v13 abid:1
    ds_read2st64_b32 v[246:247], v237 offset0:0 offset1:72
    v_xad_u32 v239, v239, v3, v4
    v_smfmac_f32_16x16x64_bf16 v[172:175], a[48:51], v[204:211], v17 abid:1
    ds_read2st64_b32 v[248:249], v238 offset0:0 offset1:72
    v_cvt_pk_bf16_f32 v125, v126, v127
    v_smfmac_f32_16x16x64_bf16 v[172:175], a[84:87], v[212:219], v21 abid:1
    ds_read2st64_b32 v[250:251], v239 offset0:0 offset1:72
    v_cvt_pk_bf16_f32 v126, v128, v129
    v_smfmac_f32_16x16x64_bf16 v[176:179], a[16:19], v[196:203], v14
    ds_read_b128 v[236:239], v9 offset:9664
    ds_read_b128 v[240:243], v8 offset:6144
    v_cvt_pk_bf16_f32 v127, v130, v131
    v_smfmac_f32_16x16x64_bf16 v[176:179], a[52:55], v[204:211], v18
    s_add_u32 m0, m0, 896
    v_cvt_pk_bf16_f32 v132, v132, v133
    v_smfmac_f32_16x16x64_bf16 v[176:179], a[88:91], v[212:219], v22
    s_waitcnt vmcnt(6)
    buffer_load_dwordx4 v5, s[8:11], s22 offen offset:1024 nt lds
    v_cvt_pk_bf16_f32 v133, v134, v135
    v_smfmac_f32_16x16x64_bf16 v[180:183], a[20:23], v[196:203], v14 abid:1
    v_cvt_pk_bf16_f32 v134, v136, v137
    v_smfmac_f32_16x16x64_bf16 v[180:183], a[56:59], v[204:211], v18 abid:1
    v_cvt_pk_bf16_f32 v135, v138, v139
    v_smfmac_f32_16x16x64_bf16 v[180:183], a[92:95], v[212:219], v22 abid:1
    ds_read_b128 v[136:139], v9 offset:10432
    v_cndmask_b32_dpp v128, v124, v132, vcc row_ror:8 row_mask:0xf bank_mask:0xf
    v_smfmac_f32_16x16x64_bf16 v[184:187], a[24:27], v[196:203], v15
    v_cndmask_b32_dpp v129, v125, v133, vcc row_ror:8 row_mask:0xf bank_mask:0xf
    v_smfmac_f32_16x16x64_bf16 v[184:187], a[60:63], v[204:211], v19
    v_cndmask_b32_dpp v130, v126, v134, vcc row_ror:8 row_mask:0xf bank_mask:0xf
    v_smfmac_f32_16x16x64_bf16 v[184:187], a[96:99], v[212:219], v23
    s_waitcnt lgkmcnt(1)
    v_xad_u32 v236, v236, v3, v4
    v_smfmac_f32_16x16x64_bf16 v[148:151], v[240:243], v[244:251], v10
    v_xad_u32 v237, v237, v3, v4
    v_smfmac_f32_16x16x64_bf16 v[184:187], v[240:243], v[244:251], v10 abid:1
    ds_read2st64_b32 v[244:245], v236 offset0:0 offset1:72
    v_xad_u32 v238, v238, v3, v4
    v_smfmac_f32_16x16x64_bf16 v[188:191], a[28:31], v[196:203], v15 abid:1
    ds_read2st64_b32 v[246:247], v237 offset0:0 offset1:72
    v_xad_u32 v239, v239, v3, v4
    v_smfmac_f32_16x16x64_bf16 v[188:191], a[64:67], v[204:211], v19 abid:1
    ds_read2st64_b32 v[248:249], v238 offset0:0 offset1:72
    v_cndmask_b32_dpp v131, v127, v135, vcc row_ror:8 row_mask:0xf bank_mask:0xf
    v_smfmac_f32_16x16x64_bf16 v[188:191], a[100:103], v[212:219], v23 abid:1
    ds_read2st64_b32 v[250:251], v239 offset0:0 offset1:72
    s_waitcnt vmcnt(6)
    buffer_store_dwordx4 v[128:131], v6, s[12:15], s59 offen offset:0 sc1
    v_smfmac_f32_16x16x64_bf16 v[192:195], a[32:35], v[196:203], v48
    ds_read_b128 v[240:243], v8 offset:7168
    v_mov_b32_dpp v124, v132 row_ror:8 row_mask:0xf bank_mask:0xc
    v_smfmac_f32_16x16x64_bf16 v[192:195], a[68:71], v[204:211], v48 abid:1
    v_mov_b32_dpp v125, v133 row_ror:8 row_mask:0xf bank_mask:0xc
    v_smfmac_f32_16x16x64_bf16 v[192:195], a[104:107], v[212:219], v49
    ds_read_b128 v[196:199], v1 offset:23552
    v_mov_b32_dpp v126, v134 row_ror:8 row_mask:0xf bank_mask:0xc
    v_smfmac_f32_16x16x64_bf16 v[160:163], a[108:111], v[220:227], v24
    ds_read_b128 v[200:203], v2 offset:23552
    v_mov_b32_dpp v127, v135 row_ror:8 row_mask:0xf bank_mask:0xc
    v_smfmac_f32_16x16x64_bf16 v[160:163], a[144:147], v[228:235], v28
    ds_read_b128 v[204:207], v1 offset:24576
    s_waitcnt vmcnt(6)
    buffer_store_dwordx4 v[124:127], v6, s[12:15], s24 offen offset:0 sc1
    v_smfmac_f32_16x16x64_bf16 v[164:167], a[112:115], v[220:227], v24 abid:1
    ds_read_b128 v[208:211], v2 offset:24576
    ds_read_b128 v[128:131], v9 offset:10304
    ds_read_b128 v[132:135], v9 offset:10368
    v_smfmac_f32_16x16x64_bf16 v[164:167], a[148:151], v[228:235], v28 abid:1
    ds_read_b128 v[124:127], v9 offset:10240
    v_smfmac_f32_16x16x64_bf16 v[168:171], a[116:119], v[220:227], v25
    v_smfmac_f32_16x16x64_bf16 v[168:171], a[152:155], v[228:235], v29
    s_waitcnt lgkmcnt(7)
    v_smfmac_f32_16x16x64_bf16 v[152:155], v[240:243], v[244:251], v10
    v_smfmac_f32_16x16x64_bf16 v[188:191], v[240:243], v[244:251], v10 abid:1
    v_smfmac_f32_16x16x64_bf16 v[172:175], a[120:123], v[220:227], v25 abid:1
    v_smfmac_f32_16x16x64_bf16 v[172:175], a[156:159], v[228:235], v29 abid:1
    v_smfmac_f32_16x16x64_bf16 v[176:179], a[124:127], v[220:227], v26
    v_smfmac_f32_16x16x64_bf16 v[176:179], a[160:163], v[228:235], v30
    v_smfmac_f32_16x16x64_bf16 v[180:183], a[128:131], v[220:227], v26 abid:1
    v_smfmac_f32_16x16x64_bf16 v[180:183], a[164:167], v[228:235], v30 abid:1
    v_cvt_pk_bf16_f32 v140, v140, v141
    v_smfmac_f32_16x16x64_bf16 v[184:187], a[132:135], v[220:227], v27
    v_cvt_pk_bf16_f32 v141, v142, v143
    v_smfmac_f32_16x16x64_bf16 v[184:187], a[168:171], v[228:235], v31
    v_cvt_pk_bf16_f32 v142, v144, v145
    v_smfmac_f32_16x16x64_bf16 v[188:191], a[136:139], v[220:227], v27 abid:1
    s_add_u32 s28, s28, 36864
    s_cmp_ge_u32 s28, 110592
    v_cvt_pk_bf16_f32 v143, v146, v147
    v_smfmac_f32_16x16x64_bf16 v[188:191], a[172:175], v[228:235], v31 abid:1
    s_cselect_b32 s28, s26, s28
    s_add_u32 s30, s25, 36864
    v_cvt_pk_bf16_f32 v148, v148, v149
    v_smfmac_f32_16x16x64_bf16 v[192:195], a[140:143], v[220:227], v49 abid:1
    s_cmp_eq_u32 s30, 110592
    s_cselect_b32 s30, 0, s30
    v_cvt_pk_bf16_f32 v149, v150, v151
    v_smfmac_f32_16x16x64_bf16 v[192:195], a[176:179], v[228:235], v50
    ds_read_b128 v[220:223], v1 offset:25600
    s_sub_u32 s31, s30, s25
    s_waitcnt lgkmcnt(6)
    v_cvt_pk_bf16_f32 v150, v152, v153
    v_smfmac_f32_16x16x64_bf16 v[160:163], a[180:183], v[196:203], v32
    ds_read_b128 v[224:227], v2 offset:25600
    s_mov_b32 s25, s30
    s_waitcnt lgkmcnt(5)
    v_cvt_pk_bf16_f32 v151, v154, v155
    v_smfmac_f32_16x16x64_bf16 v[160:163], a[216:219], v[204:211], v36
    ds_read_b128 v[228:231], v1 offset:26624
    ds_read_b128 v[152:155], v9 offset:10688
    v_cndmask_b32_dpp v144, v140, v148, vcc row_ror:8 row_mask:0xf bank_mask:0xf
    v_smfmac_f32_16x16x64_bf16 v[164:167], a[184:187], v[196:203], v32 abid:1
    ds_read_b128 v[232:235], v2 offset:26624
    s_mov_b32 s89, s28
    v_cndmask_b32_dpp v145, v141, v149, vcc row_ror:8 row_mask:0xf bank_mask:0xf
    v_smfmac_f32_16x16x64_bf16 v[164:167], a[220:223], v[204:211], v36 abid:1
    s_mov_b32 s90, s22
    s_mov_b32 s10, 75497472
    v_cndmask_b32_dpp v146, v142, v150, vcc row_ror:8 row_mask:0xf bank_mask:0xf
    v_smfmac_f32_16x16x64_bf16 v[168:171], a[188:191], v[196:203], v33
    s_add_u32 s91, s91, 1
    s_cmp_lt_u32 s20, 2
    v_cndmask_b32_dpp v147, v143, v151, vcc row_ror:8 row_mask:0xf bank_mask:0xf
    v_smfmac_f32_16x16x64_bf16 v[168:171], a[224:227], v[204:211], v37
    s_waitcnt vmcnt(6)
    buffer_store_dwordx4 v[144:147], v6, s[12:15], s59 offen offset:128 sc1
    v_mov_b32_dpp v140, v148 row_ror:8 row_mask:0xf bank_mask:0xc
    v_smfmac_f32_16x16x64_bf16 v[172:175], a[192:195], v[196:203], v33 abid:1
    s_waitcnt vmcnt(5)
    s_cselect_b32 s66, s23, s24
    v_mul_u32_u24 v0, s94, v0
    v_smfmac_f32_16x16x64_bf16 v[172:175], a[228:231], v[204:211], v37 abid:1
    s_add_u32 s66, s66, s95
    v_add_u32 v0, s93, v0
    v_smfmac_f32_16x16x64_bf16 v[176:179], a[196:199], v[196:203], v34
    v_min_u32 v0, 75497472, v0
    v_smfmac_f32_16x16x64_bf16 v[176:179], a[232:235], v[204:211], v38
    ds_write_b32 v253, v0
    v_mov_b32 v0, 157952
    v_smfmac_f32_16x16x64_bf16 v[180:183], a[200:203], v[196:203], v34 abid:1
    v_mov_b32_dpp v141, v149 row_ror:8 row_mask:0xf bank_mask:0xc
    v_smfmac_f32_16x16x64_bf16 v[180:183], a[236:239], v[204:211], v38 abid:1
    v_mov_b32_dpp v142, v150 row_ror:8 row_mask:0xf bank_mask:0xc
    v_smfmac_f32_16x16x64_bf16 v[184:187], a[204:207], v[196:203], v35
    v_mov_b32_dpp v143, v151 row_ror:8 row_mask:0xf bank_mask:0xc
    v_smfmac_f32_16x16x64_bf16 v[184:187], a[240:243], v[204:211], v39
    s_waitcnt vmcnt(6)
    buffer_store_dwordx4 v[140:143], v6, s[12:15], s24 offen offset:128 sc1
    ds_read_b128 v[144:147], v9 offset:10560
    v_smfmac_f32_16x16x64_bf16 v[188:191], a[208:211], v[196:203], v35 abid:1
    ds_read_b128 v[148:151], v9 offset:10624
    ds_read_b128 v[140:143], v9 offset:10496
    v_add_u32 v4, s31, v4
    v_smfmac_f32_16x16x64_bf16 v[188:191], a[244:247], v[204:211], v39 abid:1
    v_add_u32 v1, s31, v1
    v_smfmac_f32_16x16x64_bf16 v[192:195], a[212:215], v[196:203], v50 abid:1
    v_add_u32 v2, s31, v2
    v_smfmac_f32_16x16x64_bf16 v[192:195], a[248:251], v[204:211], v51
    s_branch M_top
M_bF:
    v_smfmac_f32_16x16x64_bf16 v[172:175], v[64:67], v[220:227], v41 abid:1
    s_waitcnt lgkmcnt(6)
    buffer_store_dwordx4 v[244:247], v7, s[12:15], s66 offen sc1
    v_smfmac_f32_16x16x64_bf16 v[172:175], v[100:103], v[228:235], v45 abid:1
    ds_read_b128 v[236:239], v9 offset:9728
    v_smfmac_f32_16x16x64_bf16 v[176:179], v[68:71], v[220:227], v42
    s_mov_b32 s21, 2
    v_smfmac_f32_16x16x64_bf16 v[176:179], v[104:107], v[228:235], v46
    v_smfmac_f32_16x16x64_bf16 v[180:183], v[72:75], v[220:227], v42 abid:1
    v_cvt_pk_bf16_f32 v160, v160, v161
    v_smfmac_f32_16x16x64_bf16 v[180:183], v[108:111], v[228:235], v46 abid:1
    v_cvt_pk_bf16_f32 v161, v162, v163
    v_smfmac_f32_16x16x64_bf16 v[184:187], v[76:79], v[220:227], v43
    v_cvt_pk_bf16_f32 v162, v164, v165
    v_smfmac_f32_16x16x64_bf16 v[184:187], v[112:115], v[228:235], v47
    v_cvt_pk_bf16_f32 v163, v166, v167
    v_smfmac_f32_16x16x64_bf16 v[188:191], v[80:83], v[220:227], v43 abid:1
    v_cvt_pk_bf16_f32 v168, v168, v169
    v_smfmac_f32_16x16x64_bf16 v[188:191], v[116:119], v[228:235], v47 abid:1
    v_cvt_pk_bf16_f32 v169, v170, v171
    v_smfmac_f32_16x16x64_bf16 v[192:195], v[84:87], v[220:227], v51 abid:1
    s_barrier
    v_cvt_pk_bf16_f32 v170, v172, v173
    v_smfmac_f32_16x16x64_bf16 v[192:195], v[120:123], v[228:235], v52
    ds_read_b128 v[220:223], v1 offset:3072
    s_waitcnt lgkmcnt(6)
    v_cvt_pk_bf16_f32 v171, v174, v175
    v_smfmac_f32_16x16x64_bf16 v[124:127], a[0:3], v[196:203], v12
    ds_read_b128 v[224:227], v2 offset:3072
    ds_read_b128 v[172:175], v9 offset:10432
    s_waitcnt lgkmcnt(6)
    v_cndmask_b32_dpp v164, v160, v168, vcc row_ror:8 row_mask:0xf bank_mask:0xf
    v_smfmac_f32_16x16x64_bf16 v[124:127], a[36:39], v[204:211], v16
    ds_read_b128 v[228:231], v1 offset:4096
    s_waitcnt lgkmcnt(5)
    v_cndmask_b32_dpp v165, v161, v169, vcc row_ror:8 row_mask:0xf bank_mask:0xf
    v_smfmac_f32_16x16x64_bf16 v[124:127], a[72:75], v[212:219], v20
    ds_read_b128 v[232:235], v2 offset:4096
    v_cndmask_b32_dpp v166, v162, v170, vcc row_ror:8 row_mask:0xf bank_mask:0xf
    v_smfmac_f32_16x16x64_bf16 v[128:131], a[4:7], v[196:203], v12 abid:1
    v_cndmask_b32_dpp v167, v163, v171, vcc row_ror:8 row_mask:0xf bank_mask:0xf
    v_smfmac_f32_16x16x64_bf16 v[128:131], a[40:43], v[204:211], v16 abid:1
    buffer_store_dwordx4 v[164:167], v6, s[12:15], s58 offen offset:0 sc1
    v_mov_b32_dpp v160, v168 row_ror:8 row_mask:0xf bank_mask:0xc
    v_smfmac_f32_16x16x64_bf16 v[128:131], a[76:79], v[212:219], v20 abid:1
    s_waitcnt lgkmcnt(5)
    v_xad_u32 v236, v236, v3, v4
    v_smfmac_f32_16x16x64_bf16 v[132:135], a[8:11], v[196:203], v13
    ds_read2st64_b32 v[244:245], v236 offset0:0 offset1:72
    v_xad_u32 v237, v237, v3, v4
    v_smfmac_f32_16x16x64_bf16 v[132:135], a[44:47], v[204:211], v17
    ds_read2st64_b32 v[246:247], v237 offset0:0 offset1:72
    v_xad_u32 v238, v238, v3, v4
    v_smfmac_f32_16x16x64_bf16 v[132:135], a[80:83], v[212:219], v21
    ds_read2st64_b32 v[248:249], v238 offset0:0 offset1:72
    v_xad_u32 v239, v239, v3, v4
    v_smfmac_f32_16x16x64_bf16 v[136:139], a[12:15], v[196:203], v13 abid:1
    ds_read2st64_b32 v[250:251], v239 offset0:0 offset1:72
    v_mov_b32_dpp v161, v169 row_ror:8 row_mask:0xf bank_mask:0xc
    v_smfmac_f32_16x16x64_bf16 v[136:139], a[48:51], v[204:211], v17 abid:1
    ds_read_b128 v[236:239], v9 offset:9216
    ds_read_b128 v[240:243], v8 offset:8192
    v_mov_b32_dpp v162, v170 row_ror:8 row_mask:0xf bank_mask:0xc
    v_smfmac_f32_16x16x64_bf16 v[136:139], a[84:87], v[212:219], v21 abid:1
    v_mov_b32_dpp v163, v171 row_ror:8 row_mask:0xf bank_mask:0xc
    v_smfmac_f32_16x16x64_bf16 v[140:143], a[16:19], v[196:203], v14
    buffer_store_dwordx4 v[160:163], v6, s[12:15], s23 offen offset:0 sc1
    ds_read_b128 v[164:167], v9 offset:10304
    ds_read_b128 v[168:171], v9 offset:10368
    v_smfmac_f32_16x16x64_bf16 v[140:143], a[52:55], v[204:211], v18
    ds_read_b128 v[160:163], v9 offset:10240
    v_cvt_pk_bf16_f32 v192, v192, v193
    v_smfmac_f32_16x16x64_bf16 v[140:143], a[88:91], v[212:219], v22
    v_cvt_pk_bf16_f32 v193, v194, v195
    v_smfmac_f32_16x16x64_bf16 v[144:147], a[20:23], v[196:203], v14 abid:1
    ds_write_b64 v252, v[192:193] offset:0
    ds_read_b128 v[192:195], v9 offset:10752
    v_smfmac_f32_16x16x64_bf16 v[144:147], a[56:59], v[204:211], v18 abid:1
    v_smfmac_f32_16x16x64_bf16 v[144:147], a[92:95], v[212:219], v22 abid:1
    s_waitcnt lgkmcnt(5)
    v_xad_u32 v236, v236, v3, v4
    v_smfmac_f32_16x16x64_bf16 v[156:159], v[240:243], v[244:251], v10
    s_waitcnt lgkmcnt(0)
    v_xad_u32 v237, v237, v3, v4
    v_smfmac_f32_16x16x64_bf16 v[192:195], v[240:243], v[244:251], v10 abid:1
    ds_read2st64_b32 v[244:245], v236 offset0:0 offset1:72
    v_xad_u32 v238, v238, v3, v4
    v_smfmac_f32_16x16x64_bf16 v[148:151], a[24:27], v[196:203], v15
    ds_read2st64_b32 v[246:247], v237 offset0:0 offset1:72
    v_xad_u32 v239, v239, v3, v4
    v_smfmac_f32_16x16x64_bf16 v[148:151], a[60:63], v[204:211], v19
    ds_read2st64_b32 v[248:249], v238 offset0:0 offset1:72
    v_smfmac_f32_16x16x64_bf16 v[148:151], a[96:99], v[212:219], v23
    ds_read2st64_b32 v[250:251], v239 offset0:0 offset1:72
    v_smfmac_f32_16x16x64_bf16 v[152:155], a[28:31], v[196:203], v15 abid:1
    ds_read_b128 v[236:239], v9 offset:9280
    ds_read_b128 v[240:243], v8 offset:0
    v_smfmac_f32_16x16x64_bf16 v[152:155], a[64:67], v[204:211], v19 abid:1
    v_smfmac_f32_16x16x64_bf16 v[152:155], a[100:103], v[212:219], v23 abid:1
    v_smfmac_f32_16x16x64_bf16 v[156:159], a[32:35], v[196:203], v48
    v_smfmac_f32_16x16x64_bf16 v[156:159], a[68:71], v[204:211], v48 abid:1
    v_smfmac_f32_16x16x64_bf16 v[156:159], a[104:107], v[212:219], v49
    ds_read_b128 v[196:199], v1 offset:5120
    v_cvt_pk_bf16_f32 v176, v176, v177
    v_smfmac_f32_16x16x64_bf16 v[124:127], a[108:111], v[220:227], v24
    ds_read_b128 v[200:203], v2 offset:5120
    v_cvt_pk_bf16_f32 v177, v178, v179
    v_smfmac_f32_16x16x64_bf16 v[124:127], a[144:147], v[228:235], v28
    ds_read_b128 v[204:207], v1 offset:6144
    ds_read_b128 v[216:219], v9 offset:9792
    v_cvt_pk_bf16_f32 v178, v180, v181
    v_smfmac_f32_16x16x64_bf16 v[128:131], a[112:115], v[220:227], v24 abid:1
    ds_read_b128 v[208:211], v2 offset:6144
    v_cvt_pk_bf16_f32 v179, v182, v183
    v_smfmac_f32_16x16x64_bf16 v[128:131], a[148:151], v[228:235], v28 abid:1
    s_waitcnt lgkmcnt(5)
    v_xad_u32 v236, v236, v3, v4
    v_smfmac_f32_16x16x64_bf16 v[124:127], v[240:243], v[244:251], v10
    v_xad_u32 v237, v237, v3, v4
    v_smfmac_f32_16x16x64_bf16 v[160:163], v[240:243], v[244:251], v10 abid:1
    ds_read2st64_b32 v[244:245], v236 offset0:0 offset1:72
    v_xad_u32 v238, v238, v3, v4
    v_smfmac_f32_16x16x64_bf16 v[132:135], a[116:119], v[220:227], v25
    ds_read2st64_b32 v[246:247], v237 offset0:0 offset1:72
    v_xad_u32 v239, v239, v3, v4
    v_smfmac_f32_16x16x64_bf16 v[132:135], a[152:155], v[228:235], v29
    ds_read2st64_b32 v[248:249], v238 offset0:0 offset1:72
    v_cvt_pk_bf16_f32 v184, v184, v185
    v_smfmac_f32_16x16x64_bf16 v[136:139], a[120:123], v[220:227], v25 abid:1
    ds_read2st64_b32 v[250:251], v239 offset0:0 offset1:72
    v_cvt_pk_bf16_f32 v185, v186, v187
    v_smfmac_f32_16x16x64_bf16 v[136:139], a[156:159], v[228:235], v29 abid:1
    ds_read_b128 v[236:239], v9 offset:9344
    ds_read_b128 v[240:243], v8 offset:1024
    v_cvt_pk_bf16_f32 v186, v188, v189
    v_smfmac_f32_16x16x64_bf16 v[140:143], a[124:127], v[220:227], v26
    v_cvt_pk_bf16_f32 v187, v190, v191
    v_smfmac_f32_16x16x64_bf16 v[140:143], a[160:163], v[228:235], v30
    ds_read_b128 v[188:191], v9 offset:10688
    v_cndmask_b32_dpp v180, v176, v184, vcc row_ror:8 row_mask:0xf bank_mask:0xf
    v_smfmac_f32_16x16x64_bf16 v[144:147], a[128:131], v[220:227], v26 abid:1
    v_cndmask_b32_dpp v181, v177, v185, vcc row_ror:8 row_mask:0xf bank_mask:0xf
    v_smfmac_f32_16x16x64_bf16 v[144:147], a[164:167], v[228:235], v30 abid:1
    v_cndmask_b32_dpp v182, v178, v186, vcc row_ror:8 row_mask:0xf bank_mask:0xf
    v_smfmac_f32_16x16x64_bf16 v[148:151], a[132:135], v[220:227], v27
    v_cndmask_b32_dpp v183, v179, v187, vcc row_ror:8 row_mask:0xf bank_mask:0xf
    v_smfmac_f32_16x16x64_bf16 v[148:151], a[168:171], v[228:235], v31
    buffer_store_dwordx4 v[180:183], v6, s[12:15], s58 offen offset:128 sc1
    v_mov_b32_dpp v176, v184 row_ror:8 row_mask:0xf bank_mask:0xc
    v_smfmac_f32_16x16x64_bf16 v[152:155], a[136:139], v[220:227], v27 abid:1
    v_mov_b32_dpp v177, v185 row_ror:8 row_mask:0xf bank_mask:0xc
    v_smfmac_f32_16x16x64_bf16 v[152:155], a[172:175], v[228:235], v31 abid:1
    s_waitcnt lgkmcnt(1)
    v_xad_u32 v236, v236, v3, v4
    v_smfmac_f32_16x16x64_bf16 v[128:131], v[240:243], v[244:251], v10
    v_xad_u32 v237, v237, v3, v4
    v_smfmac_f32_16x16x64_bf16 v[164:167], v[240:243], v[244:251], v10 abid:1
    ds_read2st64_b32 v[244:245], v236 offset0:0 offset1:72
    v_xad_u32 v238, v238, v3, v4
    v_smfmac_f32_16x16x64_bf16 v[156:159], a[140:143], v[220:227], v49 abid:1
    ds_read2st64_b32 v[246:247], v237 offset0:0 offset1:72
    v_xad_u32 v239, v239, v3, v4
    v_smfmac_f32_16x16x64_bf16 v[156:159], a[176:179], v[228:235], v50
    ds_read_b128 v[220:223], v1 offset:7168
    ds_read2st64_b32 v[248:249], v238 offset0:0 offset1:72
    v_mov_b32_dpp v178, v186 row_ror:8 row_mask:0xf bank_mask:0xc
    v_smfmac_f32_16x16x64_bf16 v[124:127], a[180:183], v[196:203], v32
    ds_read_b128 v[224:227], v2 offset:7168
    ds_read2st64_b32 v[250:251], v239 offset0:0 offset1:72
    v_mov_b32_dpp v179, v187 row_ror:8 row_mask:0xf bank_mask:0xc
    v_smfmac_f32_16x16x64_bf16 v[124:127], a[216:219], v[204:211], v36
    ds_read_b128 v[228:231], v1 offset:8192
    ds_read_b128 v[236:239], v9 offset:9408
    buffer_store_dwordx4 v[176:179], v6, s[12:15], s23 offen offset:128 sc1
    v_smfmac_f32_16x16x64_bf16 v[128:131], a[184:187], v[196:203], v32 abid:1
    ds_read_b128 v[232:235], v2 offset:8192
    ds_read_b128 v[240:243], v8 offset:2048
    ds_read_b128 v[180:183], v9 offset:10560
    v_smfmac_f32_16x16x64_bf16 v[128:131], a[220:223], v[204:211], v36 abid:1
    ds_read_b128 v[184:187], v9 offset:10624
    ds_read_b128 v[176:179], v9 offset:10496
    v_and_b32 v212, 0x3fff, v216
    v_smfmac_f32_16x16x64_bf16 v[132:135], a[188:191], v[196:203], v33
    v_and_b32 v214, 0x3fff, v218
    v_smfmac_f32_16x16x64_bf16 v[132:135], a[224:227], v[204:211], v37
    v_xad_u32 v212, v212, v3, v4
    v_smfmac_f32_16x16x64_bf16 v[136:139], a[192:195], v[196:203], v33 abid:1
    ds_read2st64_b32 v[212:213], v212 offset0:0 offset1:72
    v_xad_u32 v214, v214, v3, v4
    v_smfmac_f32_16x16x64_bf16 v[136:139], a[228:231], v[204:211], v37 abid:1
    ds_read2st64_b32 v[214:215], v214 offset0:0 offset1:72
    v_smfmac_f32_16x16x64_bf16 v[140:143], a[196:199], v[196:203], v34
    v_smfmac_f32_16x16x64_bf16 v[140:143], a[232:235], v[204:211], v38
    s_waitcnt lgkmcnt(5)
    v_xad_u32 v236, v236, v3, v4
    v_smfmac_f32_16x16x64_bf16 v[132:135], v[240:243], v[244:251], v10
    v_xad_u32 v237, v237, v3, v4
    v_smfmac_f32_16x16x64_bf16 v[168:171], v[240:243], v[244:251], v10 abid:1
    ds_read2st64_b32 v[244:245], v236 offset0:0 offset1:72
    v_xad_u32 v238, v238, v3, v4
    v_smfmac_f32_16x16x64_bf16 v[144:147], a[200:203], v[196:203], v34 abid:1
    ds_read2st64_b32 v[246:247], v237 offset0:0 offset1:72
    v_xad_u32 v239, v239, v3, v4
    v_smfmac_f32_16x16x64_bf16 v[144:147], a[236:239], v[204:211], v38 abid:1
    ds_read2st64_b32 v[248:249], v238 offset0:0 offset1:72
    s_bitcmp1_b32 s27, 0
    s_waitcnt lgkmcnt(3)
    s_cbranch_scc1 M_ov0
M_ovr0F:
    v_smfmac_f32_16x16x64_bf16 v[148:151], a[204:207], v[196:203], v35
    ds_read2st64_b32 v[250:251], v239 offset0:0 offset1:72
    s_bitcmp1_b32 s27, 1
    s_cbranch_scc1 M_ov1
M_ovr1F:
    v_smfmac_f32_16x16x64_bf16 v[148:151], a[240:243], v[204:211], v39
    ds_read_b128 v[236:239], v9 offset:9472
    ds_read_b128 v[240:243], v8 offset:3072
    v_smfmac_f32_16x16x64_bf16 v[152:155], a[208:211], v[196:203], v35 abid:1
    s_bitcmp1_b32 s27, 2
    s_cbranch_scc1 M_ov2
M_ovr2F:
    v_smfmac_f32_16x16x64_bf16 v[152:155], a[244:247], v[204:211], v39 abid:1
    s_bitcmp1_b32 s27, 3
    s_cbranch_scc1 M_ov3
M_ovr3F:
    v_smfmac_f32_16x16x64_bf16 v[156:159], a[212:215], v[196:203], v50 abid:1
    s_bitcmp1_b32 s27, 4
    s_cbranch_scc1 M_ov4
M_ovr4F:
    v_smfmac_f32_16x16x64_bf16 v[156:159], a[248:251], v[204:211], v51
    ds_read_b128 v[196:199], v1 offset:18432
    s_bitcmp1_b32 s27, 5
    s_cbranch_scc1 M_ov5
M_ovr5F:
    v_smfmac_f32_16x16x64_bf16 v[124:127], a[252:255], v[220:227], v40
    ds_read_b128 v[200:203], v2 offset:18432
    s_bitcmp1_b32 s27, 6
    s_cbranch_scc1 M_ov6
M_ovr6F:
    v_smfmac_f32_16x16x64_bf16 v[124:127], v[88:91], v[228:235], v44
    ds_read_b128 v[204:207], v1 offset:19456
    s_bitcmp1_b32 s27, 7
    s_cbranch_scc1 M_ov7
M_ovr7F:
    v_smfmac_f32_16x16x64_bf16 v[128:131], v[56:59], v[220:227], v40 abid:1
    ds_read_b128 v[208:211], v2 offset:19456
    s_bitcmp1_b32 s27, 8
    s_cbranch_scc1 M_ov8
M_ovr8F:
    v_smfmac_f32_16x16x64_bf16 v[128:131], v[92:95], v[228:235], v44 abid:1
    s_waitcnt lgkmcnt(4)
    v_xad_u32 v236, v236, v3, v4
    v_smfmac_f32_16x16x64_bf16 v[136:139], v[240:243], v[244:251], v10
    v_xad_u32 v237, v237, v3, v4
    v_smfmac_f32_16x16x64_bf16 v[172:175], v[240:243], v[244:251], v10 abid:1
    ds_read2st64_b32 v[244:245], v236 offset0:0 offset1:72
    v_xad_u32 v238, v238, v3, v4
    v_smfmac_f32_16x16x64_bf16 v[132:135], v[60:63], v[220:227], v41
    ds_read2st64_b32 v[246:247], v237 offset0:0 offset1:72
    v_xad_u32 v239, v239, v3, v4
    v_smfmac_f32_16x16x64_bf16 v[132:135], v[96:99], v[228:235], v45
    ds_read2st64_b32 v[248:249], v238 offset0:0 offset1:72
    v_smfmac_f32_16x16x64_bf16 v[136:139], v[64:67], v[220:227], v41 abid:1
    ds_read2st64_b32 v[250:251], v239 offset0:0 offset1:72
    v_smfmac_f32_16x16x64_bf16 v[136:139], v[100:103], v[228:235], v45 abid:1
    ds_read_b128 v[236:239], v9 offset:9536
    ds_read_b128 v[240:243], v8 offset:4096
    v_smfmac_f32_16x16x64_bf16 v[140:143], v[68:71], v[220:227], v42
    v_smfmac_f32_16x16x64_bf16 v[140:143], v[104:107], v[228:235], v46
    v_smfmac_f32_16x16x64_bf16 v[144:147], v[72:75], v[220:227], v42 abid:1
    ds_read_b128 v[212:215], v1 offset:20480
    v_smfmac_f32_16x16x64_bf16 v[144:147], v[108:111], v[228:235], v46 abid:1
    ds_read_b128 v[216:219], v2 offset:20480
    v_smfmac_f32_16x16x64_bf16 v[148:151], v[76:79], v[220:227], v43
    v_smfmac_f32_16x16x64_bf16 v[148:151], v[112:115], v[228:235], v47
    v_smfmac_f32_16x16x64_bf16 v[152:155], v[80:83], v[220:227], v43 abid:1
    v_smfmac_f32_16x16x64_bf16 v[152:155], v[116:119], v[228:235], v47 abid:1
    s_waitcnt lgkmcnt(2)
    v_xad_u32 v236, v236, v3, v4
    v_smfmac_f32_16x16x64_bf16 v[140:143], v[240:243], v[244:251], v10
    v_xad_u32 v237, v237, v3, v4
    v_smfmac_f32_16x16x64_bf16 v[176:179], v[240:243], v[244:251], v10 abid:1
    s_cmp_gt_u32 s46, 1
    s_cbranch_scc1 M_slow
M_slowrF:
    v_xad_u32 v238, v238, v3, v4
    v_smfmac_f32_16x16x64_bf16 v[156:159], v[84:87], v[220:227], v51 abid:1
    ds_read2st64_b32 v[244:245], v236 offset0:0 offset1:72
    v_xad_u32 v239, v239, v3, v4
    v_smfmac_f32_16x16x64_bf16 v[156:159], v[120:123], v[228:235], v52
    ds_read_b128 v[220:223], v1 offset:21504
    ds_read2st64_b32 v[246:247], v237 offset0:0 offset1:72
    v_smfmac_f32_16x16x64_bf16 v[160:163], a[0:3], v[196:203], v12
    ds_read_b128 v[224:227], v2 offset:21504
    ds_read2st64_b32 v[248:249], v238 offset0:0 offset1:72
    v_smfmac_f32_16x16x64_bf16 v[160:163], a[36:39], v[204:211], v16
    ds_read_b128 v[228:231], v1 offset:22528
    ds_read2st64_b32 v[250:251], v239 offset0:0 offset1:72
    s_waitcnt lgkmcnt(7)
    v_smfmac_f32_16x16x64_bf16 v[160:163], a[72:75], v[212:219], v20
    ds_read_b128 v[232:235], v2 offset:22528
    ds_read_b128 v[236:239], v9 offset:9600
    v_smfmac_f32_16x16x64_bf16 v[164:167], a[4:7], v[196:203], v12 abid:1
    ds_read_b128 v[240:243], v8 offset:5120
    v_cvt_pk_bf16_f32 v156, v156, v157
    v_smfmac_f32_16x16x64_bf16 v[164:167], a[40:43], v[204:211], v16 abid:1
    v_cvt_pk_bf16_f32 v157, v158, v159
    v_smfmac_f32_16x16x64_bf16 v[164:167], a[76:79], v[212:219], v20 abid:1
    ds_write_b64 v252, v[156:157] offset:23680
    v_smfmac_f32_16x16x64_bf16 v[168:171], a[8:11], v[196:203], v13
    v_smfmac_f32_16x16x64_bf16 v[168:171], a[44:47], v[204:211], v17
    v_cvt_pk_bf16_f32 v124, v124, v125
    v_smfmac_f32_16x16x64_bf16 v[168:171], a[80:83], v[212:219], v21
    s_waitcnt lgkmcnt(1)
    v_xad_u32 v236, v236, v3, v4
    v_smfmac_f32_16x16x64_bf16 v[144:147], v[240:243], v[244:251], v10
    v_xad_u32 v237, v237, v3, v4
    v_smfmac_f32_16x16x64_bf16 v[180:183], v[240:243], v[244:251], v10 abid:1
    ds_read2st64_b32 v[244:245], v236 offset0:0 offset1:72
    v_xad_u32 v238, v238, v3, v4
    v_smfmac_f32_16x16x64_bf16 v[172:175], a[12:15], v[196:203], v13 abid:1
    ds_read2st64_b32 v[246:247], v237 offset0:0 offset1:72
    v_xad_u32 v239, v239, v3, v4
    v_smfmac_f32_16x16x64_bf16 v[172:175], a[48:51], v[204:211], v17 abid:1
    ds_read2st64_b32 v[248:249], v238 offset0:0 offset1:72
    v_cvt_pk_bf16_f32 v125, v126, v127
    v_smfmac_f32_16x16x64_bf16 v[172:175], a[84:87], v[212:219], v21 abid:1
    ds_read2st64_b32 v[250:251], v239 offset0:0 offset1:72
    v_cvt_pk_bf16_f32 v126, v128, v129
    v_smfmac_f32_16x16x64_bf16 v[176:179], a[16:19], v[196:203], v14
    ds_read_b128 v[236:239], v9 offset:9664
    ds_read_b128 v[240:243], v8 offset:6144
    v_cvt_pk_bf16_f32 v127, v130, v131
    v_smfmac_f32_16x16x64_bf16 v[176:179], a[52:55], v[204:211], v18
    v_cvt_pk_bf16_f32 v132, v132, v133
    v_smfmac_f32_16x16x64_bf16 v[176:179], a[88:91], v[212:219], v22
    v_cvt_pk_bf16_f32 v133, v134, v135
    v_smfmac_f32_16x16x64_bf16 v[180:183], a[20:23], v[196:203], v14 abid:1
    v_cvt_pk_bf16_f32 v134, v136, v137
    v_smfmac_f32_16x16x64_bf16 v[180:183], a[56:59], v[204:211], v18 abid:1
    v_cvt_pk_bf16_f32 v135, v138, v139
    v_smfmac_f32_16x16x64_bf16 v[180:183], a[92:95], v[212:219], v22 abid:1
    v_cndmask_b32_dpp v128, v124, v132, vcc row_ror:8 row_mask:0xf bank_mask:0xf
    v_smfmac_f32_16x16x64_bf16 v[184:187], a[24:27], v[196:203], v15
    v_cndmask_b32_dpp v129, v125, v133, vcc row_ror:8 row_mask:0xf bank_mask:0xf
    v_smfmac_f32_16x16x64_bf16 v[184:187], a[60:63], v[204:211], v19
    v_cndmask_b32_dpp v130, v126, v134, vcc row_ror:8 row_mask:0xf bank_mask:0xf
    v_smfmac_f32_16x16x64_bf16 v[184:187], a[96:99], v[212:219], v23
    s_waitcnt lgkmcnt(0)
    v_xad_u32 v236, v236, v3, v4
    v_smfmac_f32_16x16x64_bf16 v[148:151], v[240:243], v[244:251], v10
    v_xad_u32 v237, v237, v3, v4
    v_smfmac_f32_16x16x64_bf16 v[184:187], v[240:243], v[244:251], v10 abid:1
    ds_read2st64_b32 v[244:245], v236 offset0:0 offset1:72
    v_xad_u32 v238, v238, v3, v4
    v_smfmac_f32_16x16x64_bf16 v[188:191], a[28:31], v[196:203], v15 abid:1
    ds_read2st64_b32 v[246:247], v237 offset0:0 offset1:72
    v_xad_u32 v239, v239, v3, v4
    v_smfmac_f32_16x16x64_bf16 v[188:191], a[64:67], v[204:211], v19 abid:1
    ds_read2st64_b32 v[248:249], v238 offset0:0 offset1:72
    v_cndmask_b32_dpp v131, v127, v135, vcc row_ror:8 row_mask:0xf bank_mask:0xf
    v_smfmac_f32_16x16x64_bf16 v[188:191], a[100:103], v[212:219], v23 abid:1
    ds_read2st64_b32 v[250:251], v239 offset0:0 offset1:72
    buffer_store_dwordx4 v[128:131], v6, s[12:15], s59 offen offset:0 sc1
    v_mov_b32_dpp v124, v132 row_ror:8 row_mask:0xf bank_mask:0xc
    v_smfmac_f32_16x16x64_bf16 v[192:195], a[32:35], v[196:203], v48
    ds_read_b128 v[240:243], v8 offset:7168
    v_mov_b32_dpp v125, v133 row_ror:8 row_mask:0xf bank_mask:0xc
    v_smfmac_f32_16x16x64_bf16 v[192:195], a[68:71], v[204:211], v48 abid:1
    v_mov_b32_dpp v126, v134 row_ror:8 row_mask:0xf bank_mask:0xc
    v_smfmac_f32_16x16x64_bf16 v[192:195], a[104:107], v[212:219], v49
    ds_read_b128 v[196:199], v1 offset:23552
    v_mov_b32_dpp v127, v135 row_ror:8 row_mask:0xf bank_mask:0xc
    v_smfmac_f32_16x16x64_bf16 v[160:163], a[108:111], v[220:227], v24
    ds_read_b128 v[200:203], v2 offset:23552
    buffer_store_dwordx4 v[124:127], v6, s[12:15], s24 offen offset:0 sc1
    v_smfmac_f32_16x16x64_bf16 v[160:163], a[144:147], v[228:235], v28
    ds_read_b128 v[204:207], v1 offset:24576
    v_smfmac_f32_16x16x64_bf16 v[164:167], a[112:115], v[220:227], v24 abid:1
    ds_read_b128 v[208:211], v2 offset:24576
    v_smfmac_f32_16x16x64_bf16 v[164:167], a[148:151], v[228:235], v28 abid:1
    v_smfmac_f32_16x16x64_bf16 v[168:171], a[116:119], v[220:227], v25
    v_smfmac_f32_16x16x64_bf16 v[168:171], a[152:155], v[228:235], v29
    s_waitcnt lgkmcnt(4)
    v_smfmac_f32_16x16x64_bf16 v[152:155], v[240:243], v[244:251], v10
    v_smfmac_f32_16x16x64_bf16 v[188:191], v[240:243], v[244:251], v10 abid:1
    v_smfmac_f32_16x16x64_bf16 v[172:175], a[120:123], v[220:227], v25 abid:1
    v_smfmac_f32_16x16x64_bf16 v[172:175], a[156:159], v[228:235], v29 abid:1
    v_smfmac_f32_16x16x64_bf16 v[176:179], a[124:127], v[220:227], v26
    v_smfmac_f32_16x16x64_bf16 v[176:179], a[160:163], v[228:235], v30
    v_smfmac_f32_16x16x64_bf16 v[180:183], a[128:131], v[220:227], v26 abid:1
    v_smfmac_f32_16x16x64_bf16 v[180:183], a[164:167], v[228:235], v30 abid:1
    v_cvt_pk_bf16_f32 v140, v140, v141
    v_smfmac_f32_16x16x64_bf16 v[184:187], a[132:135], v[220:227], v27
    v_cvt_pk_bf16_f32 v141, v142, v143
    v_smfmac_f32_16x16x64_bf16 v[184:187], a[168:171], v[228:235], v31
    v_cvt_pk_bf16_f32 v142, v144, v145
    v_smfmac_f32_16x16x64_bf16 v[188:191], a[136:139], v[220:227], v27 abid:1
    s_cmp_lt_u32 s20, 2
    s_cselect_b32 s66, s23, s24
    v_cvt_pk_bf16_f32 v143, v146, v147
    v_smfmac_f32_16x16x64_bf16 v[188:191], a[172:175], v[228:235], v31 abid:1
    s_add_u32 s66, s66, s95
    v_cvt_pk_bf16_f32 v148, v148, v149
    v_smfmac_f32_16x16x64_bf16 v[192:195], a[140:143], v[220:227], v49 abid:1
    v_cvt_pk_bf16_f32 v149, v150, v151
    v_smfmac_f32_16x16x64_bf16 v[192:195], a[176:179], v[228:235], v50
    ds_read_b128 v[220:223], v1 offset:25600
    s_waitcnt lgkmcnt(3)
    v_cvt_pk_bf16_f32 v150, v152, v153
    v_smfmac_f32_16x16x64_bf16 v[160:163], a[180:183], v[196:203], v32
    ds_read_b128 v[224:227], v2 offset:25600
    s_waitcnt lgkmcnt(2)
    v_cvt_pk_bf16_f32 v151, v154, v155
    v_smfmac_f32_16x16x64_bf16 v[160:163], a[216:219], v[204:211], v36
    ds_read_b128 v[228:231], v1 offset:26624
    v_cndmask_b32_dpp v144, v140, v148, vcc row_ror:8 row_mask:0xf bank_mask:0xf
    v_smfmac_f32_16x16x64_bf16 v[164:167], a[184:187], v[196:203], v32 abid:1
    ds_read_b128 v[232:235], v2 offset:26624
    v_cndmask_b32_dpp v145, v141, v149, vcc row_ror:8 row_mask:0xf bank_mask:0xf
    v_smfmac_f32_16x16x64_bf16 v[164:167], a[220:223], v[204:211], v36 abid:1
    v_cndmask_b32_dpp v146, v142, v150, vcc row_ror:8 row_mask:0xf bank_mask:0xf
    v_smfmac_f32_16x16x64_bf16 v[168:171], a[188:191], v[196:203], v33
    v_cndmask_b32_dpp v147, v143, v151, vcc row_ror:8 row_mask:0xf bank_mask:0xf
    v_smfmac_f32_16x16x64_bf16 v[168:171], a[224:227], v[204:211], v37
    buffer_store_dwordx4 v[144:147], v6, s[12:15], s59 offen offset:128 sc1
    v_mov_b32_dpp v140, v148 row_ror:8 row_mask:0xf bank_mask:0xc
    v_smfmac_f32_16x16x64_bf16 v[172:175], a[192:195], v[196:203], v33 abid:1
    v_mov_b32_dpp v141, v149 row_ror:8 row_mask:0xf bank_mask:0xc
    v_smfmac_f32_16x16x64_bf16 v[172:175], a[228:231], v[204:211], v37 abid:1
    v_mov_b32_dpp v142, v150 row_ror:8 row_mask:0xf bank_mask:0xc
    v_smfmac_f32_16x16x64_bf16 v[176:179], a[196:199], v[196:203], v34
    v_mov_b32_dpp v143, v151 row_ror:8 row_mask:0xf bank_mask:0xc
    v_smfmac_f32_16x16x64_bf16 v[176:179], a[232:235], v[204:211], v38
    buffer_store_dwordx4 v[140:143], v6, s[12:15], s24 offen offset:128 sc1
    v_smfmac_f32_16x16x64_bf16 v[180:183], a[200:203], v[196:203], v34 abid:1
    v_smfmac_f32_16x16x64_bf16 v[180:183], a[236:239], v[204:211], v38 abid:1
    v_smfmac_f32_16x16x64_bf16 v[184:187], a[204:207], v[196:203], v35
    v_smfmac_f32_16x16x64_bf16 v[184:187], a[240:243], v[204:211], v39
    v_smfmac_f32_16x16x64_bf16 v[188:191], a[208:211], v[196:203], v35 abid:1
    v_smfmac_f32_16x16x64_bf16 v[188:191], a[244:247], v[204:211], v39 abid:1
    v_smfmac_f32_16x16x64_bf16 v[192:195], a[212:215], v[196:203], v50 abid:1
    v_smfmac_f32_16x16x64_bf16 v[192:195], a[248:251], v[204:211], v51
    s_add_u32 s23, s24, 18432
    s_add_u32 s58, s24, 27648
    s_waitcnt lgkmcnt(0)
    s_barrier
    ds_read_b128 v[244:247], v8 offset:10816
    v_smfmac_f32_16x16x64_bf16 v[192:195], v[84:87], v[220:227], v51 abid:1
    v_smfmac_f32_16x16x64_bf16 v[192:195], v[120:123], v[228:235], v52
    v_smfmac_f32_16x16x64_bf16 v[160:163], a[252:255], v[220:227], v40
    v_smfmac_f32_16x16x64_bf16 v[160:163], v[88:91], v[228:235], v44
    v_smfmac_f32_16x16x64_bf16 v[164:167], v[56:59], v[220:227], v40 abid:1
    s_waitcnt lgkmcnt(0)
    buffer_store_dwordx4 v[244:247], v7, s[12:15], s66 offen sc1
    s_barrier
    s_add_u32 s66, s23, s95
    v_smfmac_f32_16x16x64_bf16 v[164:167], v[92:95], v[228:235], v44 abid:1
    v_smfmac_f32_16x16x64_bf16 v[168:171], v[60:63], v[220:227], v41
    v_smfmac_f32_16x16x64_bf16 v[168:171], v[96:99], v[228:235], v45
    v_cvt_pk_bf16_f32 v192, v192, v193
    v_smfmac_f32_16x16x64_bf16 v[172:175], v[64:67], v[220:227], v41 abid:1
    v_cvt_pk_bf16_f32 v193, v194, v195
    v_smfmac_f32_16x16x64_bf16 v[172:175], v[100:103], v[228:235], v45 abid:1
    ds_write_b64 v252, v[192:193] offset:0
    v_smfmac_f32_16x16x64_bf16 v[176:179], v[68:71], v[220:227], v42
    v_smfmac_f32_16x16x64_bf16 v[176:179], v[104:107], v[228:235], v46
    v_cvt_pk_bf16_f32 v160, v160, v161
    v_smfmac_f32_16x16x64_bf16 v[180:183], v[72:75], v[220:227], v42 abid:1
    s_waitcnt lgkmcnt(0)
    s_barrier
    ds_read_b128 v[244:247], v8 offset:10816
    v_smfmac_f32_16x16x64_bf16 v[180:183], v[108:111], v[228:235], v46 abid:1
    v_cvt_pk_bf16_f32 v161, v162, v163
    v_smfmac_f32_16x16x64_bf16 v[184:187], v[76:79], v[220:227], v43
    v_cvt_pk_bf16_f32 v162, v164, v165
    v_smfmac_f32_16x16x64_bf16 v[184:187], v[112:115], v[228:235], v47
    v_cvt_pk_bf16_f32 v163, v166, v167
    v_smfmac_f32_16x16x64_bf16 v[188:191], v[80:83], v[220:227], v43 abid:1
    v_cvt_pk_bf16_f32 v168, v168, v169
    v_smfmac_f32_16x16x64_bf16 v[188:191], v[116:119], v[228:235], v47 abid:1
    v_cvt_pk_bf16_f32 v169, v170, v171
    v_cvt_pk_bf16_f32 v170, v172, v173
    v_cvt_pk_bf16_f32 v171, v174, v175
    v_cndmask_b32_dpp v164, v160, v168, vcc row_ror:8 row_mask:0xf bank_mask:0xf
    v_cndmask_b32_dpp v165, v161, v169, vcc row_ror:8 row_mask:0xf bank_mask:0xf
    v_cndmask_b32_dpp v166, v162, v170, vcc row_ror:8 row_mask:0xf bank_mask:0xf
    v_cndmask_b32_dpp v167, v163, v171, vcc row_ror:8 row_mask:0xf bank_mask:0xf
    buffer_store_dwordx4 v[164:167], v6, s[12:15], s58 offen offset:0 sc1
    v_mov_b32_dpp v160, v168 row_ror:8 row_mask:0xf bank_mask:0xc
    v_mov_b32_dpp v161, v169 row_ror:8 row_mask:0xf bank_mask:0xc
    v_mov_b32_dpp v162, v170 row_ror:8 row_mask:0xf bank_mask:0xc
    v_mov_b32_dpp v163, v171 row_ror:8 row_mask:0xf bank_mask:0xc
    buffer_store_dwordx4 v[160:163], v6, s[12:15], s23 offen offset:0 sc1
    v_cvt_pk_bf16_f32 v176, v176, v177
    v_cvt_pk_bf16_f32 v177, v178, v179
    v_cvt_pk_bf16_f32 v178, v180, v181
    v_cvt_pk_bf16_f32 v179, v182, v183
    v_cvt_pk_bf16_f32 v184, v184, v185
    v_cvt_pk_bf16_f32 v185, v186, v187
    v_cvt_pk_bf16_f32 v186, v188, v189
    v_cvt_pk_bf16_f32 v187, v190, v191
    v_cndmask_b32_dpp v180, v176, v184, vcc row_ror:8 row_mask:0xf bank_mask:0xf
    v_cndmask_b32_dpp v181, v177, v185, vcc row_ror:8 row_mask:0xf bank_mask:0xf
    v_cndmask_b32_dpp v182, v178, v186, vcc row_ror:8 row_mask:0xf bank_mask:0xf
    v_cndmask_b32_dpp v183, v179, v187, vcc row_ror:8 row_mask:0xf bank_mask:0xf
    buffer_store_dwordx4 v[180:183], v6, s[12:15], s58 offen offset:128 sc1
    v_mov_b32_dpp v176, v184 row_ror:8 row_mask:0xf bank_mask:0xc
    v_mov_b32_dpp v177, v185 row_ror:8 row_mask:0xf bank_mask:0xc
    v_mov_b32_dpp v178, v186 row_ror:8 row_mask:0xf bank_mask:0xc
    v_mov_b32_dpp v179, v187 row_ror:8 row_mask:0xf bank_mask:0xc
    buffer_store_dwordx4 v[176:179], v6, s[12:15], s23 offen offset:128 sc1
    s_cmp_lt_u32 s20, 2
    s_cbranch_scc0 M_fin
    s_waitcnt lgkmcnt(0)
    buffer_store_dwordx4 v[244:247], v7, s[12:15], s66 offen sc1
M_fin:
M_end:
    s_endpgm
M_pf_spin:
    s_sleep 1
    buffer_load_dword v0, off, s[16:19], s96 sc1
    s_add_u32 s31, s31, 1
    s_waitcnt vmcnt(0)
    v_readfirstlane_b32 s30, v0
    s_nop 0
    s_sub_u32 s30, s30, s100
    s_cmp_eq_u32 s30, 27
    s_cbranch_scc1 M_pf_ok
    s_cmp_lt_u32 s31, 24
    s_cbranch_scc1 M_pf_spin
    s_cmp_eq_u32 s98, 0
    s_cbranch_scc1 M_pf_spin2
    s_mov_b32 s98, 0
    v_mov_b32 v0, 1
    s_mov_b64 exec, 1
    buffer_atomic_add v0, off, s[68:71], 0 offset:0 sc1
    s_mov_b64 exec, -1
    s_nop 3
M_pf_spin2:
    s_sleep 16
    buffer_load_dword v0, off, s[68:71], 0 offset:0 sc1
    s_add_u32 s31, s31, 1
    s_cmp_ge_u32 s31, 131072
    s_cbranch_scc1 M_end
    s_waitcnt vmcnt(0)
    v_readfirstlane_b32 s30, v0
    s_nop 0
    s_cmp_eq_u32 s30, 81
    s_cbranch_scc0 M_pf_spin2
    s_branch M_pf_ok
M_ovb:
    s_mov_b32 s33, 0
    v_subrev_u32 v74, 16, v68
    v_mov_b32 v75, s33
    v_cmp_gt_u32 s[44:45], 48, v74
    s_nop 1
    v_mbcnt_lo_u32_b32 v75, s44, v75
    v_mbcnt_hi_u32_b32 v75, s45, v75
    s_bcnt1_i32_b64 s34, s[44:45]
    v_min_u32 v75, 32, v75
    s_add_u32 s33, s33, s34
    v_lshl_add_u32 v75, v75, 3, s48
    v_cndmask_b32 v75, v82, v75, s[44:45]
    ds_write_b64 v75, v[56:57]
    v_subrev_u32 v74, 16, v69
    v_mov_b32 v75, s33
    v_cmp_gt_u32 s[44:45], 48, v74
    s_nop 1
    v_mbcnt_lo_u32_b32 v75, s44, v75
    v_mbcnt_hi_u32_b32 v75, s45, v75
    s_bcnt1_i32_b64 s34, s[44:45]
    v_min_u32 v75, 32, v75
    s_add_u32 s33, s33, s34
    v_lshl_add_u32 v75, v75, 3, s48
    v_cndmask_b32 v75, v82, v75, s[44:45]
    ds_write_b64 v75, v[58:59]
    v_subrev_u32 v74, 16, v70
    v_mov_b32 v75, s33
    v_cmp_gt_u32 s[44:45], 48, v74
    s_nop 1
    v_mbcnt_lo_u32_b32 v75, s44, v75
    v_mbcnt_hi_u32_b32 v75, s45, v75
    s_bcnt1_i32_b64 s34, s[44:45]
    v_min_u32 v75, 32, v75
    s_add_u32 s33, s33, s34
    v_lshl_add_u32 v75, v75, 3, s48
    v_cndmask_b32 v75, v82, v75, s[44:45]
    ds_write_b64 v75, v[60:61]
    v_subrev_u32 v74, 16, v71
    v_mov_b32 v75, s33
    v_cmp_gt_u32 s[44:45], 48, v74
    s_nop 1
    v_mbcnt_lo_u32_b32 v75, s44, v75
    v_mbcnt_hi_u32_b32 v75, s45, v75
    s_bcnt1_i32_b64 s34, s[44:45]
    v_min_u32 v75, 32, v75
    s_add_u32 s33, s33, s34
    v_lshl_add_u32 v75, v75, 3, s48
    v_cndmask_b32 v75, v82, v75, s[44:45]
    ds_write_b64 v75, v[62:63]
    v_subrev_u32 v74, 16, v72
    v_mov_b32 v75, s33
    v_cmp_gt_u32 s[44:45], 48, v74
    s_nop 1
    v_mbcnt_lo_u32_b32 v75, s44, v75
    v_mbcnt_hi_u32_b32 v75, s45, v75
    s_bcnt1_i32_b64 s34, s[44:45]
    v_min_u32 v75, 32, v75
    s_add_u32 s33, s33, s34
    v_lshl_add_u32 v75, v75, 3, s48
    v_cndmask_b32 v75, v82, v75, s[44:45]
    ds_write_b64 v75, v[64:65]
    v_subrev_u32 v74, 16, v73
    v_mov_b32 v75, s33
    v_cmp_gt_u32 s[44:45], 48, v74
    s_nop 1
    v_mbcnt_lo_u32_b32 v75, s44, v75
    v_mbcnt_hi_u32_b32 v75, s45, v75
    s_bcnt1_i32_b64 s34, s[44:45]
    v_min_u32 v75, 32, v75
    s_add_u32 s33, s33, s34
    v_lshl_add_u32 v75, v75, 3, s48
    v_cndmask_b32 v75, v82, v75, s[44:45]
    ds_write_b64 v75, v[66:67]
    s_add_u32 s46, s33, 7
    s_lshr_b32 s46, s46, 3
    s_cmp_gt_u32 s33, 32
    s_cselect_b32 s32, 1, s32
    s_cmp_eq_u32 s32, 0
    s_cbranch_scc1 M_ovbr
    s_mov_b32 s27, 0
    s_mov_b32 s46, 0x80000000
    v_mov_b32 v244, 0
    v_mov_b32 v245, 0
    v_mov_b32 v246, 0
    v_mov_b32 v247, 0
    ds_write_b128 v8, v[244:247] offset:0
    ds_write_b128 v8, v[244:247] offset:1024
    ds_write_b128 v8, v[244:247] offset:2048
    ds_write_b128 v8, v[244:247] offset:3072
    ds_write_b128 v8, v[244:247] offset:4096
    ds_write_b128 v8, v[244:247] offset:5120
    ds_write_b128 v8, v[244:247] offset:6144
    ds_write_b128 v8, v[244:247] offset:7168
    ds_write_b128 v8, v[244:247] offset:8192
    s_waitcnt lgkmcnt(0)
    s_branch M_ovbr
M_ov0:
    v_bfe_u32 v53, v11, 4, 4
    v_lshrrev_b32 v54, 18, v216
    v_lshrrev_b32 v55, 18, v218
    v_or_b32 v53, 0, v53
    v_cmp_eq_u32 s[44:45], v54, v53
    v_cmp_eq_u32 s[54:55], v55, v53
    s_nop 0
    v_cndmask_b32 v54, 0, v217, s[44:45]
    v_cndmask_b32 v55, 0, v219, s[54:55]
    s_nop 1
    v_smfmac_f32_16x16x32_bf16 v[124:127], v[54:55], v[212:215], v10
    v_smfmac_f32_16x16x32_bf16 v[160:163], v[54:55], v[212:215], v10 abid:2
    s_nop 3
    s_cmp_eq_u32 s21, 1
    s_cbranch_scc1 M_ovr0L
    s_cmp_eq_u32 s21, 2
    s_cbranch_scc1 M_ovr0F
    s_branch M_ovp0
M_ov1:
    v_bfe_u32 v53, v11, 4, 4
    v_lshrrev_b32 v54, 18, v216
    v_lshrrev_b32 v55, 18, v218
    v_or_b32 v53, 64, v53
    v_cmp_eq_u32 s[44:45], v54, v53
    v_cmp_eq_u32 s[54:55], v55, v53
    s_nop 0
    v_cndmask_b32 v54, 0, v217, s[44:45]
    v_cndmask_b32 v55, 0, v219, s[54:55]
    s_nop 1
    v_smfmac_f32_16x16x32_bf16 v[128:131], v[54:55], v[212:215], v10
    v_smfmac_f32_16x16x32_bf16 v[164:167], v[54:55], v[212:215], v10 abid:2
    s_nop 3
    s_cmp_eq_u32 s21, 1
    s_cbranch_scc1 M_ovr1L
    s_cmp_eq_u32 s21, 2
    s_cbranch_scc1 M_ovr1F
    s_branch M_ovp1
M_ov2:
    v_bfe_u32 v53, v11, 4, 4
    v_lshrrev_b32 v54, 18, v216
    v_lshrrev_b32 v55, 18, v218
    v_or_b32 v53, 128, v53
    v_cmp_eq_u32 s[44:45], v54, v53
    v_cmp_eq_u32 s[54:55], v55, v53
    s_nop 0
    v_cndmask_b32 v54, 0, v217, s[44:45]
    v_cndmask_b32 v55, 0, v219, s[54:55]
    s_nop 1
    v_smfmac_f32_16x16x32_bf16 v[132:135], v[54:55], v[212:215], v10
    v_smfmac_f32_16x16x32_bf16 v[168:171], v[54:55], v[212:215], v10 abid:2
    s_nop 3
    s_cmp_eq_u32 s21, 1
    s_cbranch_scc1 M_ovr2L
    s_cmp_eq_u32 s21, 2
    s_cbranch_scc1 M_ovr2F
    s_branch M_ovp2
M_ov3:
    v_bfe_u32 v53, v11, 4, 4
    v_lshrrev_b32 v54, 18, v216
    v_lshrrev_b32 v55, 18, v218
    v_or_b32 v53, 192, v53
    v_cmp_eq_u32 s[44:45], v54, v53
    v_cmp_eq_u32 s[54:55], v55, v53
    s_nop 0
    v_cndmask_b32 v54, 0, v217, s[44:45]
    v_cndmask_b32 v55, 0, v219, s[54:55]
    s_nop 1
    v_smfmac_f32_16x16x32_bf16 v[136:139], v[54:55], v[212:215], v10
    v_smfmac_f32_16x16x32_bf16 v[172:175], v[54:55], v[212:215], v10 abid:2
    s_nop 3
    s_cmp_eq_u32 s21, 1
    s_cbranch_scc1 M_ovr3L
    s_cmp_eq_u32 s21, 2
    s_cbranch_scc1 M_ovr3F
    s_branch M_ovp3
M_ov4:
    v_bfe_u32 v53, v11, 4, 4
    v_lshrrev_b32 v54, 18, v216
    v_lshrrev_b32 v55, 18, v218
    v_or_b32 v53, 256, v53
    v_cmp_eq_u32 s[44:45], v54, v53
    v_cmp_eq_u32 s[54:55], v55, v53
    s_nop 0
    v_cndmask_b32 v54, 0, v217, s[44:45]
    v_cndmask_b32 v55, 0, v219, s[54:55]
    s_nop 1
    v_smfmac_f32_16x16x32_bf16 v[140:143], v[54:55], v[212:215], v10
    v_smfmac_f32_16x16x32_bf16 v[176:179], v[54:55], v[212:215], v10 abid:2
    s_nop 3
    s_cmp_eq_u32 s21, 1
    s_cbranch_scc1 M_ovr4L
    s_cmp_eq_u32 s21, 2
    s_cbranch_scc1 M_ovr4F
    s_branch M_ovp4
M_ov5:
    v_bfe_u32 v53, v11, 4, 4
    v_lshrrev_b32 v54, 18, v216
    v_lshrrev_b32 v55, 18, v218
    v_or_b32 v53, 320, v53
    v_cmp_eq_u32 s[44:45], v54, v53
    v_cmp_eq_u32 s[54:55], v55, v53
    s_nop 0
    v_cndmask_b32 v54, 0, v217, s[44:45]
    v_cndmask_b32 v55, 0, v219, s[54:55]
    s_nop 1
    v_smfmac_f32_16x16x32_bf16 v[144:147], v[54:55], v[212:215], v10
    v_smfmac_f32_16x16x32_bf16 v[180:183], v[54:55], v[212:215], v10 abid:2
    s_nop 3
    s_cmp_eq_u32 s21, 1
    s_cbranch_scc1 M_ovr5L
    s_cmp_eq_u32 s21, 2
    s_cbranch_scc1 M_ovr5F
    s_branch M_ovp5
M_ov6:
    v_bfe_u32 v53, v11, 4, 4
    v_lshrrev_b32 v54, 18, v216
    v_lshrrev_b32 v55, 18, v218
    v_or_b32 v53, 384, v53
    v_cmp_eq_u32 s[44:45], v54, v53
    v_cmp_eq_u32 s[54:55], v55, v53
    s_nop 0
    v_cndmask_b32 v54, 0, v217, s[44:45]
    v_cndmask_b32 v55, 0, v219, s[54:55]
    s_nop 1
    v_smfmac_f32_16x16x32_bf16 v[148:151], v[54:55], v[212:215], v10
    v_smfmac_f32_16x16x32_bf16 v[184:187], v[54:55], v[212:215], v10 abid:2
    s_nop 3
    s_cmp_eq_u32 s21, 1
    s_cbranch_scc1 M_ovr6L
    s_cmp_eq_u32 s21, 2
    s_cbranch_scc1 M_ovr6F
    s_branch M_ovp6
M_ov7:
    v_bfe_u32 v53, v11, 4, 4
    v_lshrrev_b32 v54, 18, v216
    v_lshrrev_b32 v55, 18, v218
    v_or_b32 v53, 448, v53
    v_cmp_eq_u32 s[44:45], v54, v53
    v_cmp_eq_u32 s[54:55], v55, v53
    s_nop 0
    v_cndmask_b32 v54, 0, v217, s[44:45]
    v_cndmask_b32 v55, 0, v219, s[54:55]
    s_nop 1
    v_smfmac_f32_16x16x32_bf16 v[152:155], v[54:55], v[212:215], v10
    v_smfmac_f32_16x16x32_bf16 v[188:191], v[54:55], v[212:215], v10 abid:2
    s_nop 3
    s_cmp_eq_u32 s21, 1
    s_cbranch_scc1 M_ovr7L
    s_cmp_eq_u32 s21, 2
    s_cbranch_scc1 M_ovr7F
    s_branch M_ovp7
M_ov8:
    v_bfe_u32 v53, v11, 4, 4
    v_lshrrev_b32 v54, 18, v216
    v_lshrrev_b32 v55, 18, v218
    v_or_b32 v53, 512, v53
    v_cmp_eq_u32 s[44:45], v54, v53
    v_cmp_eq_u32 s[54:55], v55, v53
    s_nop 0
    v_cndmask_b32 v54, 0, v217, s[44:45]
    v_cndmask_b32 v55, 0, v219, s[54:55]
    s_nop 1
    v_smfmac_f32_16x16x32_bf16 v[156:159], v[54:55], v[212:215], v10
    v_smfmac_f32_16x16x32_bf16 v[192:195], v[54:55], v[212:215], v10 abid:2
    s_nop 3
    s_cmp_eq_u32 s21, 1
    s_cbranch_scc1 M_ovr8L
    s_cmp_eq_u32 s21, 2
    s_cbranch_scc1 M_ovr8F
    s_branch M_ovp8
M_slow:
    s_bitcmp1_b32 s46, 31
    s_cbranch_scc1 M_dense
    s_mov_b32 s56, 1
M_sl:
    s_lshl_b32 s57, s56, 6
    v_add_u32 v240, s57, v9
    ds_read_b128 v[248:251], v240 offset:9792
    s_waitcnt lgkmcnt(0)
    v_and_b32 v240, 0x3fff, v248
    v_and_b32 v241, 0x3fff, v250
    v_xad_u32 v240, v240, v3, v4
    v_xad_u32 v241, v241, v3, v4
    ds_read2st64_b32 v[244:245], v240 offset0:0 offset1:72
    ds_read2st64_b32 v[246:247], v241 offset0:0 offset1:72
    s_waitcnt lgkmcnt(0)
    s_bitcmp1_b32 s27, 0
    s_cbranch_scc0 M_sle0
    v_bfe_u32 v53, v11, 4, 4
    v_lshrrev_b32 v242, 18, v248
    v_lshrrev_b32 v243, 18, v250
    v_or_b32 v53, 0, v53
    v_cmp_eq_u32 s[44:45], v242, v53
    v_cmp_eq_u32 s[54:55], v243, v53
    s_nop 0
    v_cndmask_b32 v242, 0, v249, s[44:45]
    v_cndmask_b32 v243, 0, v251, s[54:55]
    s_nop 1
    v_smfmac_f32_16x16x32_bf16 v[124:127], v[242:243], v[244:247], v10
    v_smfmac_f32_16x16x32_bf16 v[160:163], v[242:243], v[244:247], v10 abid:2
M_sle0:
    s_bitcmp1_b32 s27, 1
    s_cbranch_scc0 M_sle1
    v_bfe_u32 v53, v11, 4, 4
    v_lshrrev_b32 v242, 18, v248
    v_lshrrev_b32 v243, 18, v250
    v_or_b32 v53, 64, v53
    v_cmp_eq_u32 s[44:45], v242, v53
    v_cmp_eq_u32 s[54:55], v243, v53
    s_nop 0
    v_cndmask_b32 v242, 0, v249, s[44:45]
    v_cndmask_b32 v243, 0, v251, s[54:55]
    s_nop 1
    v_smfmac_f32_16x16x32_bf16 v[128:131], v[242:243], v[244:247], v10
    v_smfmac_f32_16x16x32_bf16 v[164:167], v[242:243], v[244:247], v10 abid:2
M_sle1:
    s_bitcmp1_b32 s27, 2
    s_cbranch_scc0 M_sle2
    v_bfe_u32 v53, v11, 4, 4
    v_lshrrev_b32 v242, 18, v248
    v_lshrrev_b32 v243, 18, v250
    v_or_b32 v53, 128, v53
    v_cmp_eq_u32 s[44:45], v242, v53
    v_cmp_eq_u32 s[54:55], v243, v53
    s_nop 0
    v_cndmask_b32 v242, 0, v249, s[44:45]
    v_cndmask_b32 v243, 0, v251, s[54:55]
    s_nop 1
    v_smfmac_f32_16x16x32_bf16 v[132:135], v[242:243], v[244:247], v10
    v_smfmac_f32_16x16x32_bf16 v[168:171], v[242:243], v[244:247], v10 abid:2
M_sle2:
    s_bitcmp1_b32 s27, 3
    s_cbranch_scc0 M_sle3
    v_bfe_u32 v53, v11, 4, 4
    v_lshrrev_b32 v242, 18, v248
    v_lshrrev_b32 v243, 18, v250
    v_or_b32 v53, 192, v53
    v_cmp_eq_u32 s[44:45], v242, v53
    v_cmp_eq_u32 s[54:55], v243, v53
    s_nop 0
    v_cndmask_b32 v242, 0, v249, s[44:45]
    v_cndmask_b32 v243, 0, v251, s[54:55]
    s_nop 1
    v_smfmac_f32_16x16x32_bf16 v[136:139], v[242:243], v[244:247], v10
    v_smfmac_f32_16x16x32_bf16 v[172:175], v[242:243], v[244:247], v10 abid:2
M_sle3:
    s_bitcmp1_b32 s27, 4
    s_cbranch_scc0 M_sle4
    v_bfe_u32 v53, v11, 4, 4
    v_lshrrev_b32 v242, 18, v248
    v_lshrrev_b32 v243, 18, v250
    v_or_b32 v53, 256, v53
    v_cmp_eq_u32 s[44:45], v242, v53
    v_cmp_eq_u32 s[54:55], v243, v53
    s_nop 0
    v_cndmask_b32 v242, 0, v249, s[44:45]
    v_cndmask_b32 v243, 0, v251, s[54:55]
    s_nop 1
    v_smfmac_f32_16x16x32_bf16 v[140:143], v[242:243], v[244:247], v10
    v_smfmac_f32_16x16x32_bf16 v[176:179], v[242:243], v[244:247], v10 abid:2
M_sle4:
    s_bitcmp1_b32 s27, 5
    s_cbranch_scc0 M_sle5
    v_bfe_u32 v53, v11, 4, 4
    v_lshrrev_b32 v242, 18, v248
    v_lshrrev_b32 v243, 18, v250
    v_or_b32 v53, 320, v53
    v_cmp_eq_u32 s[44:45], v242, v53
    v_cmp_eq_u32 s[54:55], v243, v53
    s_nop 0
    v_cndmask_b32 v242, 0, v249, s[44:45]
    v_cndmask_b32 v243, 0, v251, s[54:55]
    s_nop 1
    v_smfmac_f32_16x16x32_bf16 v[144:147], v[242:243], v[244:247], v10
    v_smfmac_f32_16x16x32_bf16 v[180:183], v[242:243], v[244:247], v10 abid:2
M_sle5:
    s_bitcmp1_b32 s27, 6
    s_cbranch_scc0 M_sle6
    v_bfe_u32 v53, v11, 4, 4
    v_lshrrev_b32 v242, 18, v248
    v_lshrrev_b32 v243, 18, v250
    v_or_b32 v53, 384, v53
    v_cmp_eq_u32 s[44:45], v242, v53
    v_cmp_eq_u32 s[54:55], v243, v53
    s_nop 0
    v_cndmask_b32 v242, 0, v249, s[44:45]
    v_cndmask_b32 v243, 0, v251, s[54:55]
    s_nop 1
    v_smfmac_f32_16x16x32_bf16 v[148:151], v[242:243], v[244:247], v10
    v_smfmac_f32_16x16x32_bf16 v[184:187], v[242:243], v[244:247], v10 abid:2
M_sle6:
    s_bitcmp1_b32 s27, 7
    s_cbranch_scc0 M_sle7
    v_bfe_u32 v53, v11, 4, 4
    v_lshrrev_b32 v242, 18, v248
    v_lshrrev_b32 v243, 18, v250
    v_or_b32 v53, 448, v53
    v_cmp_eq_u32 s[44:45], v242, v53
    v_cmp_eq_u32 s[54:55], v243, v53
    s_nop 0
    v_cndmask_b32 v242, 0, v249, s[44:45]
    v_cndmask_b32 v243, 0, v251, s[54:55]
    s_nop 1
    v_smfmac_f32_16x16x32_bf16 v[152:155], v[242:243], v[244:247], v10
    v_smfmac_f32_16x16x32_bf16 v[188:191], v[242:243], v[244:247], v10 abid:2
M_sle7:
    s_bitcmp1_b32 s27, 8
    s_cbranch_scc0 M_sle8
    v_bfe_u32 v53, v11, 4, 4
    v_lshrrev_b32 v242, 18, v248
    v_lshrrev_b32 v243, 18, v250
    v_or_b32 v53, 512, v53
    v_cmp_eq_u32 s[44:45], v242, v53
    v_cmp_eq_u32 s[54:55], v243, v53
    s_nop 0
    v_cndmask_b32 v242, 0, v249, s[44:45]
    v_cndmask_b32 v243, 0, v251, s[54:55]
    s_nop 1
    v_smfmac_f32_16x16x32_bf16 v[156:159], v[242:243], v[244:247], v10
    v_smfmac_f32_16x16x32_bf16 v[192:195], v[242:243], v[244:247], v10 abid:2
M_sle8:
    s_add_u32 s56, s56, 1
    s_cmp_lt_u32 s56, s46
    s_cbranch_scc1 M_sl
M_slx:
    s_nop 7
    s_cmp_eq_u32 s21, 1
    s_cbranch_scc1 M_slowrL
    s_cmp_eq_u32 s21, 2
    s_cbranch_scc1 M_slowrF
    s_branch M_slowr0
M_dense:
    s_mul_i32 s57, s20, 82944
    s_add_u32 s57, s57, 389120
    s_mov_b32 s56, 0
    v_mov_b32 v53, v1
    v_mov_b32 v55, v2
M_dn0:
    ds_read_b128 v[244:247], v53 offset:0
    ds_read_b128 v[248:251], v55 offset:0
    v_add_u32 v53, 1024, v53
    v_add_u32 v55, 1024, v55
    buffer_load_dwordx4 v[240:243], v11, s[16:19], s57 offen sc1
    s_add_u32 s57, s57, 1024
    s_waitcnt vmcnt(0) lgkmcnt(0)
    v_smfmac_f32_16x16x64_bf16 v[124:127], v[240:243], v[244:251], v10
    buffer_load_dwordx4 v[240:243], v11, s[16:19], s57 offen sc1
    s_add_u32 s57, s57, 1024
    s_waitcnt vmcnt(0) lgkmcnt(0)
    v_smfmac_f32_16x16x64_bf16 v[128:131], v[240:243], v[244:251], v10
    buffer_load_dwordx4 v[240:243], v11, s[16:19], s57 offen sc1
    s_add_u32 s57, s57, 1024
    s_waitcnt vmcnt(0) lgkmcnt(0)
    v_smfmac_f32_16x16x64_bf16 v[132:135], v[240:243], v[244:251], v10
    buffer_load_dwordx4 v[240:243], v11, s[16:19], s57 offen sc1
    s_add_u32 s57, s57, 1024
    s_waitcnt vmcnt(0) lgkmcnt(0)
    v_smfmac_f32_16x16x64_bf16 v[136:139], v[240:243], v[244:251], v10
    buffer_load_dwordx4 v[240:243], v11, s[16:19], s57 offen sc1
    s_add_u32 s57, s57, 1024
    s_waitcnt vmcnt(0) lgkmcnt(0)
    v_smfmac_f32_16x16x64_bf16 v[140:143], v[240:243], v[244:251], v10
    buffer_load_dwordx4 v[240:243], v11, s[16:19], s57 offen sc1
    s_add_u32 s57, s57, 1024
    s_waitcnt vmcnt(0) lgkmcnt(0)
    v_smfmac_f32_16x16x64_bf16 v[144:147], v[240:243], v[244:251], v10
    buffer_load_dwordx4 v[240:243], v11, s[16:19], s57 offen sc1
    s_add_u32 s57, s57, 1024
    s_waitcnt vmcnt(0) lgkmcnt(0)
    v_smfmac_f32_16x16x64_bf16 v[148:151], v[240:243], v[244:251], v10
    buffer_load_dwordx4 v[240:243], v11, s[16:19], s57 offen sc1
    s_add_u32 s57, s57, 1024
    s_waitcnt vmcnt(0) lgkmcnt(0)
    v_smfmac_f32_16x16x64_bf16 v[152:155], v[240:243], v[244:251], v10
    buffer_load_dwordx4 v[240:243], v11, s[16:19], s57 offen sc1
    s_add_u32 s57, s57, 1024
    s_waitcnt vmcnt(0) lgkmcnt(0)
    v_smfmac_f32_16x16x64_bf16 v[156:159], v[240:243], v[244:251], v10
    s_add_u32 s56, s56, 1
    s_cmp_lt_u32 s56, 9
    s_cbranch_scc1 M_dn0
    s_mul_i32 s57, s20, 82944
    s_add_u32 s57, s57, 389120
    s_mov_b32 s56, 0
    v_mov_b32 v53, v1
    v_mov_b32 v55, v2
M_dn1:
    ds_read_b128 v[244:247], v53 offset:18432
    ds_read_b128 v[248:251], v55 offset:18432
    v_add_u32 v53, 1024, v53
    v_add_u32 v55, 1024, v55
    buffer_load_dwordx4 v[240:243], v11, s[16:19], s57 offen sc1
    s_add_u32 s57, s57, 1024
    s_waitcnt vmcnt(0) lgkmcnt(0)
    v_smfmac_f32_16x16x64_bf16 v[160:163], v[240:243], v[244:251], v10
    buffer_load_dwordx4 v[240:243], v11, s[16:19], s57 offen sc1
    s_add_u32 s57, s57, 1024
    s_waitcnt vmcnt(0) lgkmcnt(0)
    v_smfmac_f32_16x16x64_bf16 v[164:167], v[240:243], v[244:251], v10
    buffer_load_dwordx4 v[240:243], v11, s[16:19], s57 offen sc1
    s_add_u32 s57, s57, 1024
    s_waitcnt vmcnt(0) lgkmcnt(0)
    v_smfmac_f32_16x16x64_bf16 v[168:171], v[240:243], v[244:251], v10
    buffer_load_dwordx4 v[240:243], v11, s[16:19], s57 offen sc1
    s_add_u32 s57, s57, 1024
    s_waitcnt vmcnt(0) lgkmcnt(0)
    v_smfmac_f32_16x16x64_bf16 v[172:175], v[240:243], v[244:251], v10
    buffer_load_dwordx4 v[240:243], v11, s[16:19], s57 offen sc1
    s_add_u32 s57, s57, 1024
    s_waitcnt vmcnt(0) lgkmcnt(0)
    v_smfmac_f32_16x16x64_bf16 v[176:179], v[240:243], v[244:251], v10
    buffer_load_dwordx4 v[240:243], v11, s[16:19], s57 offen sc1
    s_add_u32 s57, s57, 1024
    s_waitcnt vmcnt(0) lgkmcnt(0)
    v_smfmac_f32_16x16x64_bf16 v[180:183], v[240:243], v[244:251], v10
    buffer_load_dwordx4 v[240:243], v11, s[16:19], s57 offen sc1
    s_add_u32 s57, s57, 1024
    s_waitcnt vmcnt(0) lgkmcnt(0)
    v_smfmac_f32_16x16x64_bf16 v[184:187], v[240:243], v[244:251], v10
    buffer_load_dwordx4 v[240:243], v11, s[16:19], s57 offen sc1
    s_add_u32 s57, s57, 1024
    s_waitcnt vmcnt(0) lgkmcnt(0)
    v_smfmac_f32_16x16x64_bf16 v[188:191], v[240:243], v[244:251], v10
    buffer_load_dwordx4 v[240:243], v11, s[16:19], s57 offen sc1
    s_add_u32 s57, s57, 1024
    s_waitcnt vmcnt(0) lgkmcnt(0)
    v_smfmac_f32_16x16x64_bf16 v[192:195], v[240:243], v[244:251], v10
    s_add_u32 s56, s56, 1
    s_cmp_lt_u32 s56, 9
    s_cbranch_scc1 M_dn1
    s_branch M_slx
M_codeend:
.section .rodata,"a"
.p2align 6
.amdhsa_kernel standalone__structured_sparse_n_m__ragged_kernel
  .amdhsa_next_free_vgpr 512
  .amdhsa_next_free_sgpr 102
  .amdhsa_accum_offset 256
  .amdhsa_group_segment_fixed_size 0
  .amdhsa_kernarg_size 48
  .amdhsa_user_sgpr_count 2
  .amdhsa_user_sgpr_kernarg_segment_ptr 1
  .amdhsa_system_sgpr_workgroup_id_x 1
  .amdhsa_float_denorm_mode_32 3
.end_amdhsa_kernel
```

```asm
; @launch grid=(256,1,1) block=(256,1,1) lds=162064
.amdgcn_target "amdgcn-amd-amdhsa--gfx950"
.text
.globl standalone__structured_sparse_n_m__ragged_kernel
.p2align 8
.type standalone__structured_sparse_n_m__ragged_kernel,@function
standalone__structured_sparse_n_m__ragged_kernel:
    s_cmp_ge_u32 s2, 256
    s_cbranch_scc1 M_end
    s_load_dwordx8 s[72:79], s[0:1], 0
    s_load_dwordx4 s[80:83], s[0:1], 32
    s_getpc_b64 s[84:85]
    s_lshr_b32 s30, s2, 3
    s_and_b32 s30, s30, 15
    s_lshl_b32 s30, s30, 11
    s_and_b32 s84, s84, 0xffffff00
    s_cmp_ge_u32 s2, 88
    s_cselect_b32 s86, M_codeend-standalone__structured_sparse_n_m__ragged_kernel, 0
    s_mov_b32 s87, 0x20000
    v_lshlrev_b32 v254, 3, v0
    s_mov_b32 exec_lo, 0x00010001
    s_mov_b32 exec_hi, 0x00010001
    buffer_load_dword v254, v254, s[84:87], s30 offen
    s_mov_b64 exec, -1
    v_lshrrev_b32 v20, 6, v0
    v_and_b32 v12, 63, v0
    v_readfirstlane_b32 s20, v20
    v_lshrrev_b32 v22, 3, v0
    v_mul_u32_u24 v22, 1152, v22
    v_lshrrev_b32 v23, 4, v0
    v_xor_b32 v23, v23, v0
    v_and_b32 v23, 7, v23
    v_lshl_add_u32 v5, v23, 4, v22
    v_lshrrev_b32 v13, 4, v12
    v_and_b32 v14, 15, v12
    v_lshlrev_b32 v11, 4, v12
    v_lshlrev_b32 v54, 3, v12
    v_lshlrev_b32 v25, 4, v13
    v_lshlrev_b32 v26, 3, v13
    s_mov_b32 s6, 663552
    s_mov_b32 s7, 0x20000
    s_mov_b32 s10, 75497472
    s_mov_b32 s11, s7
    s_mov_b32 s18, 738304
    s_mov_b32 s19, s7
    s_movk_i32 s70, 256
    s_mov_b32 s71, s7
    s_movk_i32 s86, 1152
    s_mov_b32 s87, s7
    s_mov_b32 s98, 0
    s_mul_i32 s96, s20, 8
    s_and_b32 s97, s2, 7
    s_add_u32 s96, s96, s97
    s_lshl_b32 s96, s96, 8
    s_add_u32 s96, s96, 721920
    s_mul_i32 s22, s2, 36864
    s_mul_i32 s26, s20, 9216
    s_mov_b32 s24, s22
    s_mov_b32 s42, s26
    s_lshl_b32 s28, s20, 8
    s_lshl_b32 s29, s20, 5
    s_mov_b32 s21, 0
    s_cmp_lt_u32 s2, 81
    s_cselect_b32 s41, 2, 2
    s_cbranch_scc0 M_x1
    s_mul_i32 s32, s2, 57
    s_lshr_b32 s32, s32, 9
    s_mul_i32 s33, s32, 9
    s_sub_u32 s33, s2, s33
    s_mul_i32 s54, s32, 73728
    s_lshl_b32 s35, s33, 7
    s_add_u32 s54, s54, s35
    s_add_u32 s55, s54, 36864
    s_lshl_b32 s36, s20, 10
    s_add_u32 m0, s36, 73728
    s_lshr_b32 s30, s33, 1
    s_and_b32 s31, s33, 1
    s_lshl_b32 s37, s32, 8
    s_lshl_b32 s38, s31, 7
    s_add_u32 s37, s37, s38
    s_lshl_b32 s38, s32, 6
    s_add_u32 s38, s38, 2304
    s_cmp_lt_u32 s33, 8
    s_cselect_b32 s30, s30, s20
    s_cselect_b32 s37, s37, s38
    s_cselect_b32 s44, 0xff, 15
    s_cselect_b32 s45, s20, 3
    s_cmp_eq_u32 s45, 3
    s_cselect_b32 s99, 738304, 0
    s_mul_i32 s48, s30, 97280
    s_add_u32 s37, s37, s48
    v_mov_b32 v44, 2.0
    v_mov_b32 v45, 0
    v_mov_b32 v46, 2.0
    v_mov_b32 v47, 0
    s_waitcnt lgkmcnt(0)
    s_mov_b64 s[4:5], s[74:75]
    buffer_load_dwordx4 v5, s[4:7], s54 offen lds
    s_add_u32 m0, m0, 4096
    s_mov_b32 s45, 0
    buffer_load_dwordx4 v5, s[4:7], s55 offen lds
    s_mov_b64 s[16:17], s[82:83]
    s_mov_b64 s[8:9], s[72:73]
    s_mov_b64 s[84:85], s[76:77]
    s_mov_b64 s[68:69], s[80:81]
    buffer_load_dword v253, off, s[16:19], s96 sc1
    s_mov_b64 exec, s[44:45]
    s_mov_b32 s18, s99
    buffer_store_dwordx4 v[44:47], v11, s[16:19], s37 offen sc1
    s_mov_b32 s18, 738304
    s_mov_b64 exec, -1
    buffer_load_dwordx4 v[196:199], v25, s[84:87], s28 offen offset:0
    buffer_load_dwordx4 v[200:203], v25, s[84:87], s28 offen offset:64
    buffer_load_dwordx4 v[204:207], v25, s[84:87], s28 offen offset:128
    buffer_load_dwordx4 v[208:211], v25, s[84:87], s28 offen offset:192
    buffer_load_dwordx2 v[212:213], v26, s[84:87], s29 offen offset:1024
    s_mov_b32 m0, s42
    s_nop 0
    buffer_load_dwordx4 v5, s[8:11], s22 offen offset:0 nt lds
    s_add_u32 m0, m0, 896
    s_nop 0
    buffer_load_dwordx4 v5, s[8:11], s22 offen offset:128 nt lds
    s_add_u32 m0, m0, 896
    s_nop 0
    buffer_load_dwordx4 v5, s[8:11], s22 offen offset:256 nt lds
    s_add_u32 m0, m0, 896
    s_nop 0
    buffer_load_dwordx4 v5, s[8:11], s22 offen offset:384 nt lds
    s_lshl_b32 s34, s31, 2
    s_add_u32 s34, s34, s20
    s_lshr_b32 s35, s20, 1
    s_lshl_b32 s35, s35, 6
    s_and_b32 s36, s20, 1
    s_lshl_b32 s36, s36, 3
    s_add_u32 s35, s35, s36
    s_lshl_b32 s36, s20, 5
    s_mul_i32 s39, s32, 10240
    s_add_u32 s39, s39, 5120
    s_lshl_b32 s40, s34, 1
    s_add_u32 s40, s40, s39
    s_lshl_b32 s38, s32, 1
    s_cmp_eq_u32 s32, 8
    s_cselect_b32 s38, 1024, s38
    s_add_u32 s38, s38, 3072
    s_cmp_lt_u32 s33, 8
    s_cselect_b32 s34, s34, 8
    s_cselect_b32 s35, s35, s36
    s_cselect_b32 s36, 4, 3
    s_cselect_b32 s40, s40, s38
    s_cselect_b32 s46, 0, s20
    s_cselect_b32 s47, 16, 8
    s_add_u32 s40, s40, s48
    s_lshl_b32 s38, s34, 10
    s_add_u32 s39, s39, s38
    s_add_u32 s39, s39, s48
    s_add_u32 s39, s39, 1024
    v_and_b32 v15, 3, v14
    v_lshlrev_b32 v15, s36, v15
    v_add_u32 v15, s35, v15
    v_lshrrev_b32 v16, 3, v14
    v_lshlrev_b32 v16, 4, v16
    v_xor_b32 v15, v15, v16
    v_lshrrev_b32 v16, 2, v14
    v_lshl_add_u32 v16, v13, 4, v16
    v_lshl_add_u32 v15, v16, 7, v15
    v_add_u32 v24, 73728, v15
    v_xor_b32 v27, 32, v24
    v_xor_b32 v28, 64, v24
    v_xor_b32 v29, 0x60, v24
    s_lshl_b32 s31, s46, 2
    s_add_u32 s31, s31, 81920
    v_mov_b32 v60, s31
    v_mov_b32 v61, 1
    ds_write_b32 v60, v61
    s_mul_i32 s49, s30, 81
    s_mul_i32 s31, s32, 9
    s_add_u32 s49, s49, s31
    s_add_u32 s49, s49, s34
    s_lshl_b32 s49, s49, 10
    s_add_u32 s49, s49, 389120
    s_lshl_b32 s31, s34, 24
    s_lshl_b32 s38, s32, 10
    s_add_u32 s31, s31, s38
    v_lshlrev_b32 v31, 18, v14
    v_lshl_add_u32 v31, v13, 5, v31
    v_add_u32 v31, s31, v31
    s_mov_b32 s50, 3437096686
    s_mov_b32 s51, 1150609561
    s_mov_b32 s52, 0x00010001
    s_mov_b32 s53, 0x00200010
    s_mov_b32 s38, 0x0202
    s_mul_i32 s30, s30, 2048
    s_add_u32 s30, s30, 721920
    s_cmp_eq_u32 s33, 8
    s_cselect_b32 s34, 32, 8
    s_bfm_b64 s[56:57], s34, 0
    s_cmp_eq_u32 s20, 0
    s_cselect_b32 s98, 1, 0
    v_lshlrev_b32 v30, 8, v12
    v_add_u32 v74, 81984, v54
    v_lshl_add_u32 v73, s20, 1, v74
    v_mov_b32 v41, 0x01000100
    v_mov_b32 v40, 0
    v_mov_b32 v63, -2.0
    s_waitcnt vmcnt(11) lgkmcnt(0)
    s_barrier
    ds_read_b64_tr_b16 v[16:17], v24
    ds_read_b64_tr_b16 v[18:19], v27 offset:512
    ds_read_b64_tr_b16 v[20:21], v28 offset:1024
    ds_read_b64_tr_b16 v[22:23], v29 offset:1536
    s_waitcnt lgkmcnt(3)
    v_and_b32 v44, 0x7fff7fff, v16
    v_and_b32 v45, 0x7fff7fff, v17
    v_pk_max_u16 v46, v44, v45
    v_pk_min_u16 v47, v44, v45
    v_pk_min_u16 v46, v46, v46 op_sel:[0,1] op_sel_hi:[1,0]
    v_pk_max_u16 v47, v47, v47 op_sel:[0,1] op_sel_hi:[1,0]
    v_pk_max_u16 v46, v46, s52
    v_pk_max_u16 v46, v46, v47
    v_pk_sub_i16 v44, v44, v46
    v_pk_sub_i16 v45, v45, v46
    v_pk_ashrrev_i16 v44, 15, v44 op_sel_hi:[0,1]
    v_pk_ashrrev_i16 v45, 15, v45 op_sel_hi:[0,1]
    v_alignbit_b32 v47, -1, v44, 16
    v_alignbit_b32 v46, v45, v45, 16
    v_and_b32 v48, 0x00080004, v44
    v_bitop3_b32 v46, v45, v46, v47 bitop3:0xe8
    v_and_or_b32 v64, v45, s53, v48
    v_bitop3_b32 v36, v16, v44, v46 bitop3:0x10
    v_min_u32 v68, 1, v36
    s_waitcnt lgkmcnt(2)
    v_and_b32 v44, 0x7fff7fff, v18
    v_and_b32 v45, 0x7fff7fff, v19
    v_pk_max_u16 v46, v44, v45
    v_pk_min_u16 v47, v44, v45
    v_pk_min_u16 v46, v46, v46 op_sel:[0,1] op_sel_hi:[1,0]
    v_pk_max_u16 v47, v47, v47 op_sel:[0,1] op_sel_hi:[1,0]
    v_pk_max_u16 v46, v46, s52
    v_pk_max_u16 v46, v46, v47
    v_pk_sub_i16 v44, v44, v46
    v_pk_sub_i16 v45, v45, v46
    v_pk_ashrrev_i16 v44, 15, v44 op_sel_hi:[0,1]
    v_pk_ashrrev_i16 v45, 15, v45 op_sel_hi:[0,1]
    v_alignbit_b32 v47, -1, v44, 16
    v_alignbit_b32 v46, v45, v45, 16
    v_and_b32 v48, 0x00080004, v44
    v_bitop3_b32 v46, v45, v46, v47 bitop3:0xe8
    v_and_or_b32 v65, v45, s53, v48
    v_bitop3_b32 v37, v18, v44, v46 bitop3:0x10
    v_min_u32 v69, 1, v37
    s_waitcnt lgkmcnt(1)
    v_and_b32 v44, 0x7fff7fff, v20
    v_and_b32 v45, 0x7fff7fff, v21
    v_pk_max_u16 v46, v44, v45
    v_pk_min_u16 v47, v44, v45
    v_pk_min_u16 v46, v46, v46 op_sel:[0,1] op_sel_hi:[1,0]
    v_pk_max_u16 v47, v47, v47 op_sel:[0,1] op_sel_hi:[1,0]
    v_pk_max_u16 v46, v46, s52
    v_pk_max_u16 v46, v46, v47
    v_pk_sub_i16 v44, v44, v46
    v_pk_sub_i16 v45, v45, v46
    v_pk_ashrrev_i16 v44, 15, v44 op_sel_hi:[0,1]
    v_pk_ashrrev_i16 v45, 15, v45 op_sel_hi:[0,1]
    v_alignbit_b32 v47, -1, v44, 16
    v_alignbit_b32 v46, v45, v45, 16
    v_and_b32 v48, 0x00080004, v44
    v_bitop3_b32 v46, v45, v46, v47 bitop3:0xe8
    v_and_or_b32 v66, v45, s53, v48
    v_bitop3_b32 v38, v20, v44, v46 bitop3:0x10
    v_min_u32 v70, 1, v38
    s_waitcnt lgkmcnt(0)
    v_and_b32 v44, 0x7fff7fff, v22
    v_and_b32 v45, 0x7fff7fff, v23
    v_pk_max_u16 v46, v44, v45
    v_pk_min_u16 v47, v44, v45
    v_pk_min_u16 v46, v46, v46 op_sel:[0,1] op_sel_hi:[1,0]
    v_pk_max_u16 v47, v47, v47 op_sel:[0,1] op_sel_hi:[1,0]
    v_pk_max_u16 v46, v46, s52
    v_pk_max_u16 v46, v46, v47
    v_pk_sub_i16 v44, v44, v46
    v_pk_sub_i16 v45, v45, v46
    v_pk_ashrrev_i16 v44, 15, v44 op_sel_hi:[0,1]
    v_pk_ashrrev_i16 v45, 15, v45 op_sel_hi:[0,1]
    v_alignbit_b32 v47, -1, v44, 16
    v_alignbit_b32 v46, v45, v45, 16
    v_and_b32 v48, 0x00080004, v44
    v_bitop3_b32 v46, v45, v46, v47 bitop3:0xe8
    v_and_or_b32 v67, v45, s53, v48
    v_bitop3_b32 v39, v22, v44, v46 bitop3:0x10
    v_min_u32 v71, 1, v39
    v_add_u32 v72, v68, v69
    v_add3_u32 v72, v72, v70, v71
    buffer_store_dwordx4 v[36:39], v11, s[16:19], s49 offen sc1
    v_cmp_ne_u32 vcc, 0, v72
    s_and_saveexec_b64 s[44:45], vcc
    ds_add_rtn_u32 v62, v60, v72
    s_mov_b64 exec, -1
    v_lshrrev_b32 v48, 16, v64
    v_or_b32 v48, v48, v64
    v_lshrrev_b64 v[52:53], v48, s[50:51]
    v_and_b32 v64, 15, v52
    v_lshl_or_b32 v40, v64, 0, v40
    v_lshrrev_b32 v48, 16, v65
    v_or_b32 v48, v48, v65
    v_lshrrev_b64 v[52:53], v48, s[50:51]
    v_and_b32 v65, 15, v52
    v_lshl_or_b32 v40, v65, 4, v40
    v_lshrrev_b32 v48, 16, v66
    v_or_b32 v48, v48, v66
    v_lshrrev_b64 v[52:53], v48, s[50:51]
    v_and_b32 v66, 15, v52
    v_lshl_or_b32 v40, v66, 8, v40
    v_lshrrev_b32 v48, 16, v67
    v_or_b32 v48, v48, v67
    v_lshrrev_b64 v[52:53], v48, s[50:51]
    v_and_b32 v67, 15, v52
    v_lshl_or_b32 v40, v67, 12, v40
    ds_write_b16 v73, v40
    v_mul_u32_u24 v46, 0x4001, v64
    v_and_b32 v46, 0x30003, v46
    v_mad_u32_u24 v46, v46, s38, v41
    v_perm_b32 v32, v17, v16, v46
    v_mul_u32_u24 v46, 0x4001, v65
    v_and_b32 v46, 0x30003, v46
    v_mad_u32_u24 v46, v46, s38, v41
    v_perm_b32 v33, v19, v18, v46
    s_waitcnt vmcnt(10) lgkmcnt(0)
    s_barrier
    ds_read_b64 v[50:51], v74
    v_mul_u32_u24 v46, 0x4001, v66
    v_and_b32 v46, 0x30003, v46
    v_mad_u32_u24 v46, v46, s38, v41
    v_perm_b32 v34, v21, v20, v46
    v_mul_u32_u24 v46, 0x4001, v67
    v_and_b32 v46, 0x30003, v46
    v_mad_u32_u24 v46, v46, s38, v41
    v_perm_b32 v35, v23, v22, v46
    buffer_store_dwordx4 v[32:35], v11, s[16:19], s39 offen sc1
    s_cmp_eq_u32 s33, 8
    s_cbranch_scc0 F_i1
    buffer_store_short v40, v11, s[16:19], s40 offen sc1
    s_branch F_i2
F_i1:
    s_cmp_eq_u32 s20, 0
    s_cbranch_scc0 F_i2
    s_waitcnt lgkmcnt(0)
    buffer_store_dwordx2 v[50:51], v11, s[16:19], s40 offen sc1
F_i2:
    s_cbranch_vccz F_z
    v_cmp_ne_u32 vcc, 0, v36
    s_and_saveexec_b64 s[44:45], vcc
    s_cbranch_execz F_e0
    v_cmp_gt_u32 vcc, s47, v62
    v_add_u32 v42, 0, v31
    v_lshlrev_b32 v44, 3, v62
    v_add_u32 v62, 1, v62
    v_cndmask_b32 v42, v63, v42, vcc
    v_cndmask_b32 v43, 0, v36, vcc
    v_cndmask_b32 v44, 0, v44, vcc
    buffer_store_dwordx2 v[42:43], v44, s[16:19], s37 offen sc1
F_e0:
    s_mov_b64 exec, -1
    v_cmp_ne_u32 vcc, 0, v37
    s_and_saveexec_b64 s[44:45], vcc
    s_cbranch_execz F_e1
    v_cmp_gt_u32 vcc, s47, v62
    v_add_u32 v42, 8, v31
    v_lshlrev_b32 v44, 3, v62
    v_add_u32 v62, 1, v62
    v_cndmask_b32 v42, v63, v42, vcc
    v_cndmask_b32 v43, 0, v37, vcc
    v_cndmask_b32 v44, 0, v44, vcc
    buffer_store_dwordx2 v[42:43], v44, s[16:19], s37 offen sc1
F_e1:
    s_mov_b64 exec, -1
    v_cmp_ne_u32 vcc, 0, v38
    s_and_saveexec_b64 s[44:45], vcc
    s_cbranch_execz F_e2
    v_cmp_gt_u32 vcc, s47, v62
    v_add_u32 v42, 16, v31
    v_lshlrev_b32 v44, 3, v62
    v_add_u32 v62, 1, v62
    v_cndmask_b32 v42, v63, v42, vcc
    v_cndmask_b32 v43, 0, v38, vcc
    v_cndmask_b32 v44, 0, v44, vcc
    buffer_store_dwordx2 v[42:43], v44, s[16:19], s37 offen sc1
F_e2:
    s_mov_b64 exec, -1
    v_cmp_ne_u32 vcc, 0, v39
    s_and_saveexec_b64 s[44:45], vcc
    s_cbranch_execz F_e3
    v_cmp_gt_u32 vcc, s47, v62
    v_add_u32 v42, 24, v31
    v_lshlrev_b32 v44, 3, v62
    v_add_u32 v62, 1, v62
    v_cndmask_b32 v42, v63, v42, vcc
    v_cndmask_b32 v43, 0, v39, vcc
    v_cndmask_b32 v44, 0, v44, vcc
    buffer_store_dwordx2 v[42:43], v44, s[16:19], s37 offen sc1
F_e3:
    s_mov_b64 exec, -1
F_z:
    s_cmp_lg_u32 s2, 0
    s_cbranch_scc1 F_sig
    v_mov_b32 v64, 0
    v_mov_b32 v65, 0
    v_mov_b32 v66, 0
    v_mov_b32 v67, 0
    s_mov_b32 s40, 720896
    buffer_store_dwordx4 v[64:67], v11, s[16:19], s40 offen sc1
F_sig:
    s_waitcnt vmcnt(0) lgkmcnt(0)
    s_barrier
    s_cmp_lg_u32 s20, 0
    s_cbranch_scc1 F_end
    s_mov_b64 exec, s[56:57]
    buffer_atomic_add v61, v30, s[16:19], s30 offen sc1
    s_mov_b64 exec, -1
F_end:
    s_add_u32 m0, s42, 3584
    s_nop 0
    buffer_load_dwordx4 v5, s[8:11], s22 offen offset:512 nt lds
    s_add_u32 m0, m0, 896
    s_nop 0
    buffer_load_dwordx4 v5, s[8:11], s22 offen offset:640 nt lds
    s_add_u32 m0, m0, 896
    s_nop 0
    buffer_load_dwordx4 v5, s[8:11], s22 offen offset:768 nt lds
    s_add_u32 m0, m0, 896
    s_nop 0
    buffer_load_dwordx4 v5, s[8:11], s22 offen offset:896 nt lds
    s_add_u32 m0, m0, 896
    s_nop 0
    buffer_load_dwordx4 v5, s[8:11], s22 offen offset:1024 nt lds
    s_add_u32 s22, s22, 9437184
    s_add_u32 s42, s42, 36864
    s_mov_b32 s21, 1
    s_branch M_xl
M_x1:
    s_waitcnt lgkmcnt(0)
    s_mov_b64 s[4:5], s[74:75]
    s_mov_b64 s[16:17], s[82:83]
    s_mov_b64 s[8:9], s[72:73]
    s_mov_b64 s[84:85], s[76:77]
    s_mov_b64 s[68:69], s[80:81]
    buffer_load_dword v253, off, s[16:19], s96 sc1
    buffer_load_dwordx4 v[196:199], v25, s[84:87], s28 offen offset:0
    buffer_load_dwordx4 v[200:203], v25, s[84:87], s28 offen offset:64
    buffer_load_dwordx4 v[204:207], v25, s[84:87], s28 offen offset:128
    buffer_load_dwordx4 v[208:211], v25, s[84:87], s28 offen offset:192
    buffer_load_dwordx2 v[212:213], v26, s[84:87], s29 offen offset:1024
M_xl:
    s_add_u32 s21, s21, 1
    s_mov_b32 m0, s42
    s_nop 0
    buffer_load_dwordx4 v5, s[8:11], s22 offen offset:0 nt lds
    s_add_u32 m0, m0, 896
    s_nop 0
    buffer_load_dwordx4 v5, s[8:11], s22 offen offset:128 nt lds
    s_add_u32 m0, m0, 896
    s_nop 0
    buffer_load_dwordx4 v5, s[8:11], s22 offen offset:256 nt lds
    s_add_u32 m0, m0, 896
    s_nop 0
    buffer_load_dwordx4 v5, s[8:11], s22 offen offset:384 nt lds
    s_add_u32 m0, m0, 896
    s_nop 0
    buffer_load_dwordx4 v5, s[8:11], s22 offen offset:512 nt lds
    s_add_u32 m0, m0, 896
    s_nop 0
    buffer_load_dwordx4 v5, s[8:11], s22 offen offset:640 nt lds
    s_add_u32 m0, m0, 896
    s_nop 0
    buffer_load_dwordx4 v5, s[8:11], s22 offen offset:768 nt lds
    s_add_u32 m0, m0, 896
    s_nop 0
    buffer_load_dwordx4 v5, s[8:11], s22 offen offset:896 nt lds
    s_add_u32 m0, m0, 896
    s_nop 0
    buffer_load_dwordx4 v5, s[8:11], s22 offen offset:1024 nt lds
    s_add_u32 s22, s22, 9437184
    s_add_u32 s42, s42, 36864
    s_cmp_lt_u32 s21, s41
    s_cbranch_scc1 M_xl
    s_mov_b32 s12, s78
    s_mov_b32 s13, s79
    s_mov_b32 s14, 75497472
    s_mov_b32 s15, 0x20000
    s_waitcnt vmcnt(9)
    v_readlane_b32 s100, v253, 0
    s_mul_i32 s29, s20, 12864
    s_add_u32 s29, s29, 110592
    v_lshrrev_b32 v24, 1, v14
    v_and_b32 v27, 7, v14
    v_lshlrev_b32 v22, 7, v27
    v_lshl_or_b32 v3, v24, 4, v22
    v_lshrrev_b32 v23, 3, v14
    v_mul_u32_u24 v4, 9216, v23
    v_xad_u32 v1, v25, v3, v4
    v_xor_b32 v2, 64, v1
    v_add_u32 v9, s29, v25
    v_add_u32 v8, s29, v11
    v_mul_u32_u24 v24, 1152, v27
    v_lshl_add_u32 v24, v23, 6, v24
    v_add3_u32 v6, v24, v25, s28
    v_lshrrev_b32 v24, 3, v12
    v_xor_b32 v28, v24, v12
    v_and_b32 v28, 7, v28
    v_mul_u32_u24 v24, 1152, v24
    v_lshl_add_u32 v24, v28, 4, v24
    v_add_u32 v7, 1024, v24
    s_lshl_b32 s30, s20, 1
    v_lshrrev_b32 v24, 1, v13
    v_add_u32 v24, s30, v24
    v_xor_b32 v24, v24, v27
    v_lshl_add_u32 v24, v24, 4, v22
    v_and_b32 v28, 8, v26
    v_mul_u32_u24 v29, 12864, v23
    v_add3_u32 v24, v24, v28, v29
    v_add_u32 v252, 121408, v24
    s_cmp_eq_u32 s20, 0
    s_mov_b32 s31, 1073903880
    s_cselect_b32 s30, 162048, s31
    v_mov_b32 v253, s31
    v_writelane_b32 v253, s30, 0
    s_lshr_b32 s30, s2, 3
    s_and_b32 s30, s30, 3
    s_mul_i32 s92, s30, 256
    s_add_u32 s92, s92, 558848
    s_add_u32 s30, s30, 768
    s_mul_i32 s93, s30, 36864
    s_mov_b32 s94, 147456
    s_and_b32 s95, s20, 1
    s_mul_i32 s95, s95, 9216
    v_mov_b32 v10, 0xeeee4444
    s_add_u32 s59, s24, 9216
    s_mul_i32 s43, s20, 97280
    s_add_u32 s47, s29, 9216
    s_add_u32 s48, s29, 9792
    s_add_u32 s49, s29, 10112
    s_add_u32 s54, s29, 1073751872
    s_mov_b32 s50, 3130536464
    s_mov_b32 s51, 4275861076
    s_mov_b32 s52, 3696531472
    s_mov_b32 s53, 4269193778
    v_mov_b32 v16, 0
    v_mov_b32 v17, 0
    v_mov_b32 v18, 0
    v_mov_b32 v19, 0
    v_cmp_gt_u32 s[44:45], 36, v12
    v_and_b32 v20, 8, v54
    s_nop 0
    v_cndmask_b32 v20, 0, v20, s[44:45]
    v_mov_b32 v21, v20
    v_mov_b32 v22, v20
    v_mov_b32 v23, v20
    v_mov_b32 v64, 1073741824
    v_mov_b32 v65, 0
    v_mov_b32 v66, 1073741824
    v_mov_b32 v67, 0
    v_lshl_add_u32 v53, v12, 2, s49
    ds_write_b128 v8, v[16:19] offset:0
    ds_write_b128 v8, v[16:19] offset:1024
    ds_write_b128 v8, v[16:19] offset:2048
    ds_write_b128 v8, v[16:19] offset:3072
    ds_write_b128 v8, v[16:19] offset:4096
    ds_write_b128 v8, v[16:19] offset:5120
    ds_write_b128 v8, v[16:19] offset:6144
    ds_write_b128 v8, v[16:19] offset:7168
    ds_write_b128 v8, v[16:19] offset:8192
    ds_write_b128 v8, v[20:23] offset:9216
    v_lshlrev_b32 v124, 16, v196
    v_and_b32 v125, 0xffff0000, v196
    v_lshlrev_b32 v126, 16, v197
    v_and_b32 v127, 0xffff0000, v197
    v_lshlrev_b32 v128, 16, v198
    v_and_b32 v129, 0xffff0000, v198
    v_lshlrev_b32 v130, 16, v199
    v_and_b32 v131, 0xffff0000, v199
    v_lshlrev_b32 v132, 16, v200
    v_and_b32 v133, 0xffff0000, v200
    v_lshlrev_b32 v134, 16, v201
    v_and_b32 v135, 0xffff0000, v201
    v_lshlrev_b32 v136, 16, v202
    v_and_b32 v137, 0xffff0000, v202
    v_lshlrev_b32 v138, 16, v203
    v_and_b32 v139, 0xffff0000, v203
    v_lshlrev_b32 v140, 16, v204
    v_and_b32 v141, 0xffff0000, v204
    v_lshlrev_b32 v142, 16, v205
    v_and_b32 v143, 0xffff0000, v205
    v_lshlrev_b32 v144, 16, v206
    v_and_b32 v145, 0xffff0000, v206
    v_lshlrev_b32 v146, 16, v207
    v_and_b32 v147, 0xffff0000, v207
    v_lshlrev_b32 v148, 16, v208
    v_and_b32 v149, 0xffff0000, v208
    v_lshlrev_b32 v150, 16, v209
    v_and_b32 v151, 0xffff0000, v209
    v_lshlrev_b32 v152, 16, v210
    v_and_b32 v153, 0xffff0000, v210
    v_lshlrev_b32 v154, 16, v211
    v_and_b32 v155, 0xffff0000, v211
    v_lshlrev_b32 v156, 16, v212
    v_and_b32 v157, 0xffff0000, v212
    v_lshlrev_b32 v158, 16, v213
    v_and_b32 v159, 0xffff0000, v213
    s_mov_b32 exec_lo, 0x00010001
    s_mov_b32 exec_hi, 0x00010001
    ds_write_b128 v9, v[124:127] offset:10240
    ds_write_b128 v9, v[128:131] offset:10304
    ds_write_b128 v9, v[132:135] offset:10368
    ds_write_b128 v9, v[136:139] offset:10432
    ds_write_b128 v9, v[140:143] offset:10496
    ds_write_b128 v9, v[144:147] offset:10560
    ds_write_b128 v9, v[148:151] offset:10624
    ds_write_b128 v9, v[152:155] offset:10688
    ds_write_b128 v9, v[156:159] offset:10752
    s_mov_b64 exec, -1
    s_waitcnt vmcnt(1)
    buffer_load_dword v0, off, s[16:19], s96 sc1
    s_mul_i32 s30, s20, 256
    s_add_u32 s30, s30, s2
    s_sub_u32 s30, s30, 0
    s_cmp_lt_u32 s2, 0
    s_cselect_b32 s30, 1023, s30
    s_lshl_b32 s30, s30, 1
    v_lshrrev_b32 v244, 5, v12
    v_add_u32 v248, s30, v244
    v_mul_u32_u24 v245, 7282, v248
    v_lshrrev_b32 v245, 20, v245
    v_mul_u32_u24 v246, 144, v245
    v_sub_u32 v244, v248, v246
    v_mul_u32_u24 v246, 16, v245
    v_sub_u32 v247, v244, v246
    v_cmp_lt_u32 s[30:31], v244, v246
    v_subrev_u32 v246, 1, v245
    v_sub_u32 v245, 8, v245
    v_cndmask_b32 v244, v247, v244, s[30:31]
    v_cndmask_b32 v245, v245, v246, s[30:31]
    v_sub_u32 v244, 2047, v244
    v_cmp_gt_u32 vcc, 720, v248
    v_subrev_u32 v248, 720, v248
    v_mul_u32_u24 v246, 7282, v248
    v_lshrrev_b32 v246, 16, v246
    v_mul_u32_u24 v247, 9, v246
    v_sub_u32 v247, v248, v247
    v_add_u32 v246, 2048, v246
    v_cndmask_b32 v244, v246, v244, vcc
    v_cndmask_b32 v245, v247, v245, vcc
    v_mul_u32_u24 v244, 36864, v244
    v_lshl_add_u32 v244, v245, 7, v244
    v_and_b32 v245, 31, v12
    v_mul_u32_u24 v245, 1152, v245
    v_add_u32 v254, v244, v245
    s_mov_b32 vcc_lo, 0xff00ff00
    s_mov_b32 vcc_hi, 0xff00ff00
    s_waitcnt vmcnt(0)
    v_readfirstlane_b32 s30, v0
    s_mov_b32 s31, 0
    s_sub_u32 s30, s30, s100
    s_cmp_eq_u32 s30, 27
    s_cbranch_scc0 M_pf_spin
M_pf_ok:
    buffer_load_dwordx4 v[56:59], v11, s[16:19], s43 offen offset:0 sc1
    buffer_load_dwordx4 v[60:63], v11, s[16:19], s43 offen offset:1024 sc1
    s_mov_b32 exec_hi, 0xfffff
    buffer_load_dwordx4 v[64:67], v11, s[16:19], s43 offen offset:2048 sc1
    s_mov_b32 exec_hi, -1
    buffer_load_dwordx4 v[48:51], v11, s[16:19], s43 offen offset:3072 sc1
    s_add_u32 s43, s43, 4096
    buffer_load_dword v52, v11, s[16:19], s43 offen offset:0 sc1
    buffer_load_dwordx4 v[12:15], v11, s[16:19], s43 offen offset:1024 sc1
    buffer_load_dwordx4 a[0:3], v11, s[16:19], s43 offen offset:2048 sc1
    buffer_load_dwordx4 a[4:7], v11, s[16:19], s43 offen offset:3072 sc1
    s_add_u32 s43, s43, 4096
    buffer_load_dwordx4 a[8:11], v11, s[16:19], s43 offen offset:0 sc1
    buffer_load_dwordx4 a[12:15], v11, s[16:19], s43 offen offset:1024 sc1
    buffer_load_dwordx4 a[16:19], v11, s[16:19], s43 offen offset:2048 sc1
    buffer_load_dwordx4 a[20:23], v11, s[16:19], s43 offen offset:3072 sc1
    s_add_u32 s43, s43, 4096
    buffer_load_dwordx4 a[24:27], v11, s[16:19], s43 offen offset:0 sc1
    buffer_load_dwordx4 a[28:31], v11, s[16:19], s43 offen offset:1024 sc1
    buffer_load_dwordx4 a[32:35], v11, s[16:19], s43 offen offset:2048 sc1
    buffer_load_dwordx4 v[16:19], v11, s[16:19], s43 offen offset:3072 sc1
    s_add_u32 s43, s43, 4096
    buffer_load_dwordx4 a[36:39], v11, s[16:19], s43 offen offset:0 sc1
    buffer_load_dwordx4 a[40:43], v11, s[16:19], s43 offen offset:1024 sc1
    buffer_load_dwordx4 a[44:47], v11, s[16:19], s43 offen offset:2048 sc1
    ds_read_b128 v[160:163], v9 offset:10240
    ds_read_b128 v[164:167], v9 offset:10304
    ds_read_b128 v[168:171], v9 offset:10368
    ds_read_b128 v[172:175], v9 offset:10432
    ds_read_b128 v[176:179], v9 offset:10496
    ds_read_b128 v[180:183], v9 offset:10560
    ds_read_b128 v[184:187], v9 offset:10624
    ds_read_b128 v[188:191], v9 offset:10688
    ds_read_b128 v[192:195], v9 offset:10752
    s_cmp_eq_u32 s98, 0
    s_cbranch_scc1 M_cnt
    s_mov_b32 s98, 0
    v_mov_b32 v0, 1
    s_mov_b64 exec, 1
    buffer_atomic_add v0, off, s[68:71], 0 offset:0 sc1
    s_mov_b64 exec, -1
    s_nop 3
M_cnt:
    s_waitcnt vmcnt(12)
    s_barrier
    ds_read_b128 v[196:199], v1 offset:0
    ds_read_b128 v[200:203], v2 offset:0
    ds_read_b128 v[228:231], v1 offset:18432
    ds_read_b128 v[232:235], v2 offset:18432
    s_waitcnt lgkmcnt(2)
    v_smfmac_f32_16x16x64_bf16 v[124:127], a[0:3], v[196:203], v12
    buffer_load_dwordx4 a[48:51], v11, s[16:19], s43 offen offset:3072 sc1
    s_waitcnt lgkmcnt(0)
    v_mov_b32 v82, s54
    v_smfmac_f32_16x16x64_bf16 v[160:163], a[0:3], v[228:235], v12
    ds_read_b128 v[204:207], v1 offset:1024
    ds_read_b128 v[208:211], v2 offset:1024
    v_bfe_u32 v74, v56, 24, 4
    v_lshlrev_b32 v75, 1, v56
    v_lshl_add_u32 v74, v74, 2, s49
    v_and_b32 v75, 16, v75
    s_waitcnt vmcnt(12)
    v_and_or_b32 v74, v56, 2.0, v74
    v_smfmac_f32_16x16x64_bf16 v[128:131], a[4:7], v[196:203], v12 abid:1
    s_add_u32 s43, s43, 4096
    buffer_load_dwordx4 a[52:55], v11, s[16:19], s43 offen offset:0 sc1
    v_lshlrev_b32 v75, v75, 1
    v_smfmac_f32_16x16x64_bf16 v[164:167], a[4:7], v[228:235], v12 abid:1
    ds_read_b128 v[220:223], v1 offset:19456
    ds_read_b128 v[224:227], v2 offset:19456
    ds_add_rtn_u32 v68, v74, v75
    v_bfe_u32 v76, v58, 24, 4
    v_lshlrev_b32 v77, 1, v58
    v_lshl_add_u32 v76, v76, 2, s49
    s_waitcnt vmcnt(12)
    v_and_b32 v77, 16, v77
    v_smfmac_f32_16x16x64_bf16 v[132:135], a[8:11], v[196:203], v13
    buffer_load_dwordx4 a[56:59], v11, s[16:19], s43 offen offset:1024 sc1
    v_and_or_b32 v76, v58, 2.0, v76
    v_smfmac_f32_16x16x64_bf16 v[168:171], a[8:11], v[228:235], v13
    s_waitcnt vmcnt(12)
    v_lshlrev_b32 v77, v77, 1
    v_smfmac_f32_16x16x64_bf16 v[136:139], a[12:15], v[196:203], v13 abid:1
    buffer_load_dwordx4 a[60:63], v11, s[16:19], s43 offen offset:2048 sc1
    ds_add_rtn_u32 v69, v76, v77
    v_bfe_u32 v74, v60, 24, 4
    v_smfmac_f32_16x16x64_bf16 v[172:175], a[12:15], v[228:235], v13 abid:1
    v_lshlrev_b32 v75, 1, v60
    v_lshl_add_u32 v74, v74, 2, s49
    v_and_b32 v75, 16, v75
    v_and_or_b32 v74, v60, 2.0, v74
    s_waitcnt vmcnt(12)
    v_lshlrev_b32 v75, v75, 1
    v_smfmac_f32_16x16x64_bf16 v[140:143], a[16:19], v[196:203], v14
    buffer_load_dwordx4 a[64:67], v11, s[16:19], s43 offen offset:3072 sc1
    ds_add_rtn_u32 v70, v74, v75
    v_bfe_u32 v76, v62, 24, 4
    v_smfmac_f32_16x16x64_bf16 v[176:179], a[16:19], v[228:235], v14
    v_lshlrev_b32 v77, 1, v62
    v_lshl_add_u32 v76, v76, 2, s49
    v_and_b32 v77, 16, v77
    v_and_or_b32 v76, v62, 2.0, v76
    s_waitcnt vmcnt(12)
    v_lshlrev_b32 v77, v77, 1
    v_smfmac_f32_16x16x64_bf16 v[144:147], a[20:23], v[196:203], v14 abid:1
    s_add_u32 s43, s43, 4096
    buffer_load_dwordx4 a[68:71], v11, s[16:19], s43 offen offset:0 sc1
    ds_add_rtn_u32 v71, v76, v77
    v_bfe_u32 v74, v64, 24, 4
    v_smfmac_f32_16x16x64_bf16 v[180:183], a[20:23], v[228:235], v14 abid:1
    v_lshlrev_b32 v75, 1, v64
    v_lshl_add_u32 v74, v74, 2, s49
    v_and_b32 v75, 16, v75
    s_waitcnt vmcnt(12)
    v_and_or_b32 v74, v64, 2.0, v74
    v_smfmac_f32_16x16x64_bf16 v[148:151], a[24:27], v[196:203], v15
    buffer_load_dwordx4 v[20:23], v11, s[16:19], s43 offen offset:1024 sc1
    buffer_load_dwordx4 a[72:75], v11, s[16:19], s43 offen offset:2048 sc1
    v_lshlrev_b32 v75, v75, 1
    v_smfmac_f32_16x16x64_bf16 v[184:187], a[24:27], v[228:235], v15
    ds_add_rtn_u32 v72, v74, v75
    v_bfe_u32 v76, v66, 24, 4
    v_lshlrev_b32 v77, 1, v66
    v_lshl_add_u32 v76, v76, 2, s49
    s_waitcnt vmcnt(13)
    v_and_b32 v77, 16, v77
    v_smfmac_f32_16x16x64_bf16 v[152:155], a[28:31], v[196:203], v15 abid:1
    buffer_load_dwordx4 a[76:79], v11, s[16:19], s43 offen offset:3072 sc1
    v_and_or_b32 v76, v66, 2.0, v76
    v_smfmac_f32_16x16x64_bf16 v[188:191], a[28:31], v[228:235], v15 abid:1
    s_waitcnt vmcnt(13)
    v_lshlrev_b32 v77, v77, 1
    v_smfmac_f32_16x16x64_bf16 v[156:159], a[32:35], v[196:203], v48
    s_add_u32 s43, s43, 4096
    buffer_load_dwordx4 a[80:83], v11, s[16:19], s43 offen offset:0 sc1
    ds_add_rtn_u32 v73, v76, v77
    ds_read_b32 v80, v53
    v_and_b32 v74, 8, v56
    v_smfmac_f32_16x16x64_bf16 v[192:195], a[32:35], v[228:235], v48
    s_waitcnt lgkmcnt(6)
    v_lshrrev_b32 v75, 16, v68
    v_cmp_ne_u32 s[44:45], 0, v74
    v_and_b32 v76, 0xffff, v68
    v_sub_u32 v74, 15, v75
    v_and_b32 v68, 2.0, v56
    s_waitcnt vmcnt(12)
    v_add3_u32 v68, v76, v75, v68
    v_smfmac_f32_16x16x64_bf16 v[124:127], a[36:39], v[204:211], v16
    buffer_load_dwordx4 a[84:87], v11, s[16:19], s43 offen offset:1024 sc1
    v_cndmask_b32 v74, v76, v74, s[44:45]
    v_smfmac_f32_16x16x64_bf16 v[160:163], a[36:39], v[220:227], v16
    ds_read_b128 v[196:199], v1 offset:2048
    ds_read_b128 v[200:203], v2 offset:2048
    v_cmp_gt_u32 s[44:45], 16, v68
    v_lshlrev_b32 v74, 2, v74
    v_lshrrev_b64 v[76:77], v74, s[50:51]
    v_lshrrev_b64 v[78:79], v74, s[52:53]
    s_waitcnt vmcnt(12)
    v_bfe_u32 v74, v56, 24, 4
    v_smfmac_f32_16x16x64_bf16 v[128:131], a[40:43], v[204:211], v16 abid:1
    buffer_load_dwordx4 a[88:91], v11, s[16:19], s43 offen offset:2048 sc1
    v_and_b32 v76, 15, v76
    v_smfmac_f32_16x16x64_bf16 v[164:167], a[40:43], v[220:227], v16 abid:1
    ds_read_b128 v[228:231], v1 offset:20480
    ds_read_b128 v[232:235], v2 offset:20480
    v_and_b32 v78, 15, v78
    v_lshl_add_u32 v76, v74, 4, v76
    v_mul_u32_u24 v78, 68, v78
    s_waitcnt vmcnt(12)
    v_lshrrev_b32 v77, 14, v56
    v_smfmac_f32_16x16x64_bf16 v[132:135], a[44:47], v[204:211], v17
    buffer_load_dwordx4 a[92:95], v11, s[16:19], s43 offen offset:3072 sc1
    v_lshl_add_u32 v76, v76, 2, s47
    v_smfmac_f32_16x16x64_bf16 v[168:171], a[44:47], v[220:227], v17
    v_and_b32 v78, 0x30c, v78
    v_and_b32 v77, 0x3cf0, v77
    v_cndmask_b32 v75, v82, v76, s[44:45]
    v_add3_u32 v77, v77, v78, s29
    s_waitcnt vmcnt(12)
    v_and_b32 v78, 0x3fff, v56
    v_smfmac_f32_16x16x64_bf16 v[136:139], a[48:51], v[204:211], v17 abid:1
    s_add_u32 s43, s43, 4096
    buffer_load_dwordx4 a[96:99], v11, s[16:19], s43 offen offset:0 sc1
    v_cndmask_b32 v74, v82, v77, s[44:45]
    v_smfmac_f32_16x16x64_bf16 v[172:175], a[48:51], v[220:227], v17 abid:1
    ds_write_b32 v75, v78
    ds_write_b32 v74, v57
    v_and_b32 v74, 8, v58
    s_waitcnt lgkmcnt(11)
    v_lshrrev_b32 v75, 16, v69
    s_waitcnt vmcnt(12)
    v_cmp_ne_u32 s[44:45], 0, v74
    v_smfmac_f32_16x16x64_bf16 v[140:143], a[52:55], v[204:211], v18
    buffer_load_dwordx4 a[100:103], v11, s[16:19], s43 offen offset:1024 sc1
    v_and_b32 v76, 0xffff, v69
    v_smfmac_f32_16x16x64_bf16 v[176:179], a[52:55], v[220:227], v18
    v_sub_u32 v74, 15, v75
    v_and_b32 v69, 2.0, v58
    v_add3_u32 v69, v76, v75, v69
    s_waitcnt vmcnt(12)
    v_cndmask_b32 v74, v76, v74, s[44:45]
    v_smfmac_f32_16x16x64_bf16 v[144:147], a[56:59], v[204:211], v18 abid:1
    buffer_load_dwordx4 a[104:107], v11, s[16:19], s43 offen offset:2048 sc1
    v_cmp_gt_u32 s[44:45], 16, v69
    v_smfmac_f32_16x16x64_bf16 v[180:183], a[56:59], v[220:227], v18 abid:1
    v_lshlrev_b32 v74, 2, v74
    v_lshrrev_b64 v[76:77], v74, s[50:51]
    v_lshrrev_b64 v[78:79], v74, s[52:53]
    v_bfe_u32 v74, v58, 24, 4
    s_waitcnt vmcnt(12)
    v_and_b32 v76, 15, v76
    v_smfmac_f32_16x16x64_bf16 v[148:151], a[60:63], v[204:211], v19
    buffer_load_dwordx4 v[24:27], v11, s[16:19], s43 offen offset:3072 sc1
    s_add_u32 s43, s43, 4096
    buffer_load_dwordx4 a[108:111], v11, s[16:19], s43 offen offset:0 sc1
    v_and_b32 v78, 15, v78
    v_smfmac_f32_16x16x64_bf16 v[184:187], a[60:63], v[220:227], v19
    v_lshl_add_u32 v76, v74, 4, v76
    v_mul_u32_u24 v78, 68, v78
    v_lshrrev_b32 v77, 14, v58
    v_lshl_add_u32 v76, v76, 2, s47
    s_waitcnt vmcnt(13)
    v_and_b32 v78, 0x30c, v78
    v_smfmac_f32_16x16x64_bf16 v[152:155], a[64:67], v[204:211], v19 abid:1
    buffer_load_dwordx4 a[112:115], v11, s[16:19], s43 offen offset:1024 sc1
    v_and_b32 v77, 0x3cf0, v77
    v_smfmac_f32_16x16x64_bf16 v[188:191], a[64:67], v[220:227], v19 abid:1
    v_cndmask_b32 v75, v82, v76, s[44:45]
    v_add3_u32 v77, v77, v78, s29
    v_and_b32 v78, 0x3fff, v58
    s_waitcnt vmcnt(13)
    v_cndmask_b32 v74, v82, v77, s[44:45]
    v_smfmac_f32_16x16x64_bf16 v[156:159], a[68:71], v[204:211], v48 abid:1
    buffer_load_dwordx4 a[116:119], v11, s[16:19], s43 offen offset:2048 sc1
    ds_write_b32 v75, v78
    ds_write_b32 v74, v59
    v_and_b32 v74, 8, v60
    v_smfmac_f32_16x16x64_bf16 v[192:195], a[68:71], v[220:227], v48 abid:1
    s_waitcnt lgkmcnt(12)
    v_lshrrev_b32 v75, 16, v70
    v_cmp_ne_u32 s[44:45], 0, v74
    s_waitcnt vmcnt(12)
    s_waitcnt lgkmcnt(6)
    v_and_b32 v76, 0xffff, v70
    v_smfmac_f32_16x16x64_bf16 v[124:127], a[72:75], v[196:203], v20
    buffer_load_dwordx4 a[120:123], v11, s[16:19], s43 offen offset:3072 sc1
    s_waitcnt lgkmcnt(4)
    v_sub_u32 v74, 15, v75
    v_smfmac_f32_16x16x64_bf16 v[160:163], a[72:75], v[228:235], v20
    ds_read_b128 v[204:207], v1 offset:3072
    ds_read_b128 v[208:211], v2 offset:3072
    v_and_b32 v70, 2.0, v60
    v_add3_u32 v70, v76, v75, v70
    v_cndmask_b32 v74, v76, v74, s[44:45]
    s_waitcnt vmcnt(12)
    v_cmp_gt_u32 s[44:45], 16, v70
    v_smfmac_f32_16x16x64_bf16 v[128:131], a[76:79], v[196:203], v20 abid:1
    s_add_u32 s43, s43, 4096
    buffer_load_dwordx4 a[124:127], v11, s[16:19], s43 offen offset:0 sc1
    v_lshlrev_b32 v74, 2, v74
    v_smfmac_f32_16x16x64_bf16 v[164:167], a[76:79], v[228:235], v20 abid:1
    ds_read_b128 v[220:223], v1 offset:21504
    ds_read_b128 v[224:227], v2 offset:21504
    v_lshrrev_b64 v[76:77], v74, s[50:51]
    v_lshrrev_b64 v[78:79], v74, s[52:53]
    v_bfe_u32 v74, v60, 24, 4
    v_and_b32 v76, 15, v76
    s_waitcnt vmcnt(12)
    v_and_b32 v78, 15, v78
    v_smfmac_f32_16x16x64_bf16 v[132:135], a[80:83], v[196:203], v21
    buffer_load_dwordx4 a[128:131], v11, s[16:19], s43 offen offset:1024 sc1
    v_lshl_add_u32 v76, v74, 4, v76
    v_smfmac_f32_16x16x64_bf16 v[168:171], a[80:83], v[228:235], v21
    v_mul_u32_u24 v78, 68, v78
    v_lshrrev_b32 v77, 14, v60
    v_lshl_add_u32 v76, v76, 2, s47
    v_and_b32 v78, 0x30c, v78
    s_waitcnt vmcnt(12)
    v_and_b32 v77, 0x3cf0, v77
    v_smfmac_f32_16x16x64_bf16 v[136:139], a[84:87], v[196:203], v21 abid:1
    buffer_load_dwordx4 a[132:135], v11, s[16:19], s43 offen offset:2048 sc1
    v_cndmask_b32 v75, v82, v76, s[44:45]
    v_smfmac_f32_16x16x64_bf16 v[172:175], a[84:87], v[228:235], v21 abid:1
    v_add3_u32 v77, v77, v78, s29
    v_and_b32 v78, 0x3fff, v60
    s_waitcnt vmcnt(12)
    v_cndmask_b32 v74, v82, v77, s[44:45]
    v_smfmac_f32_16x16x64_bf16 v[140:143], a[88:91], v[196:203], v22
    buffer_load_dwordx4 a[136:139], v11, s[16:19], s43 offen offset:3072 sc1
    ds_write_b32 v75, v78
    ds_write_b32 v74, v61
    v_and_b32 v74, 8, v62
    v_smfmac_f32_16x16x64_bf16 v[176:179], a[88:91], v[228:235], v22
    v_lshrrev_b32 v75, 16, v71
    v_cmp_ne_u32 s[44:45], 0, v74
    v_and_b32 v76, 0xffff, v71
    s_waitcnt vmcnt(12)
    v_sub_u32 v74, 15, v75
    v_smfmac_f32_16x16x64_bf16 v[144:147], a[92:95], v[196:203], v22 abid:1
    s_add_u32 s43, s43, 4096
    buffer_load_dwordx4 a[140:143], v11, s[16:19], s43 offen offset:0 sc1
    v_and_b32 v71, 2.0, v62
    v_smfmac_f32_16x16x64_bf16 v[180:183], a[92:95], v[228:235], v22 abid:1
    v_add3_u32 v71, v76, v75, v71
    v_cndmask_b32 v74, v76, v74, s[44:45]
    v_cmp_gt_u32 s[44:45], 16, v71
    v_lshlrev_b32 v74, 2, v74
    s_waitcnt vmcnt(12)
    v_lshrrev_b64 v[76:77], v74, s[50:51]
    v_smfmac_f32_16x16x64_bf16 v[148:151], a[96:99], v[196:203], v23
    buffer_load_dwordx4 v[28:31], v11, s[16:19], s43 offen offset:1024 sc1
    buffer_load_dwordx4 a[144:147], v11, s[16:19], s43 offen offset:2048 sc1
    v_lshrrev_b64 v[78:79], v74, s[52:53]
    v_smfmac_f32_16x16x64_bf16 v[184:187], a[96:99], v[228:235], v23
    v_bfe_u32 v74, v62, 24, 4
    v_and_b32 v76, 15, v76
    v_and_b32 v78, 15, v78
    s_waitcnt vmcnt(13)
    v_lshl_add_u32 v76, v74, 4, v76
    v_smfmac_f32_16x16x64_bf16 v[152:155], a[100:103], v[196:203], v23 abid:1
    buffer_load_dwordx4 a[148:151], v11, s[16:19], s43 offen offset:3072 sc1
    v_mul_u32_u24 v78, 68, v78
    v_smfmac_f32_16x16x64_bf16 v[188:191], a[100:103], v[228:235], v23 abid:1
    v_lshrrev_b32 v77, 14, v62
    v_lshl_add_u32 v76, v76, 2, s47
    v_and_b32 v78, 0x30c, v78
    v_and_b32 v77, 0x3cf0, v77
    s_waitcnt vmcnt(13)
    v_cndmask_b32 v75, v82, v76, s[44:45]
    v_smfmac_f32_16x16x64_bf16 v[156:159], a[104:107], v[196:203], v49
    s_add_u32 s43, s43, 4096
    buffer_load_dwordx4 a[152:155], v11, s[16:19], s43 offen offset:0 sc1
    v_add3_u32 v77, v77, v78, s29
    v_smfmac_f32_16x16x64_bf16 v[192:195], a[104:107], v[228:235], v49
    v_and_b32 v78, 0x3fff, v62
    s_waitcnt vmcnt(12)
    s_waitcnt lgkmcnt(4)
    v_cndmask_b32 v74, v82, v77, s[44:45]
    v_smfmac_f32_16x16x64_bf16 v[124:127], a[108:111], v[204:211], v24
    buffer_load_dwordx4 a[156:159], v11, s[16:19], s43 offen offset:1024 sc1
    ds_write_b32 v75, v78
    ds_write_b32 v74, v63
    s_waitcnt lgkmcnt(4)
    v_and_b32 v74, 8, v64
    v_smfmac_f32_16x16x64_bf16 v[160:163], a[108:111], v[220:227], v24
    ds_read_b128 v[196:199], v1 offset:4096
    ds_read_b128 v[200:203], v2 offset:4096
    v_lshrrev_b32 v75, 16, v72
    v_cmp_ne_u32 s[44:45], 0, v74
    v_and_b32 v76, 0xffff, v72
    v_sub_u32 v74, 15, v75
    s_waitcnt vmcnt(12)
    v_and_b32 v72, 2.0, v64
    v_smfmac_f32_16x16x64_bf16 v[128:131], a[112:115], v[204:211], v24 abid:1
    buffer_load_dwordx4 a[160:163], v11, s[16:19], s43 offen offset:2048 sc1
    v_add3_u32 v72, v76, v75, v72
    v_smfmac_f32_16x16x64_bf16 v[164:167], a[112:115], v[220:227], v24 abid:1
    ds_read_b128 v[228:231], v1 offset:22528
    ds_read_b128 v[232:235], v2 offset:22528
    v_cndmask_b32 v74, v76, v74, s[44:45]
    v_cmp_gt_u32 s[44:45], 16, v72
    v_lshlrev_b32 v74, 2, v74
    v_lshrrev_b64 v[76:77], v74, s[50:51]
    s_waitcnt vmcnt(12)
    v_lshrrev_b64 v[78:79], v74, s[52:53]
    v_smfmac_f32_16x16x64_bf16 v[132:135], a[116:119], v[204:211], v25
    buffer_load_dwordx4 a[164:167], v11, s[16:19], s43 offen offset:3072 sc1
    v_bfe_u32 v74, v64, 24, 4
    v_smfmac_f32_16x16x64_bf16 v[168:171], a[116:119], v[220:227], v25
    v_and_b32 v76, 15, v76
    v_and_b32 v78, 15, v78
    v_lshl_add_u32 v76, v74, 4, v76
    s_waitcnt vmcnt(12)
    v_mul_u32_u24 v78, 68, v78
    v_smfmac_f32_16x16x64_bf16 v[136:139], a[120:123], v[204:211], v25 abid:1
    s_add_u32 s43, s43, 4096
    buffer_load_dwordx4 a[168:171], v11, s[16:19], s43 offen offset:0 sc1
    v_lshrrev_b32 v77, 14, v64
    v_smfmac_f32_16x16x64_bf16 v[172:175], a[120:123], v[220:227], v25 abid:1
    v_lshl_add_u32 v76, v76, 2, s47
    v_and_b32 v78, 0x30c, v78
    v_and_b32 v77, 0x3cf0, v77
    v_cndmask_b32 v75, v82, v76, s[44:45]
    s_waitcnt vmcnt(12)
    v_add3_u32 v77, v77, v78, s29
    v_smfmac_f32_16x16x64_bf16 v[140:143], a[124:127], v[204:211], v26
    buffer_load_dwordx4 a[172:175], v11, s[16:19], s43 offen offset:1024 sc1
    v_and_b32 v78, 0x3fff, v64
    v_smfmac_f32_16x16x64_bf16 v[176:179], a[124:127], v[220:227], v26
    s_waitcnt vmcnt(12)
    v_cndmask_b32 v74, v82, v77, s[44:45]
    v_smfmac_f32_16x16x64_bf16 v[144:147], a[128:131], v[204:211], v26 abid:1
    buffer_load_dwordx4 a[176:179], v11, s[16:19], s43 offen offset:2048 sc1
    ds_write_b32 v75, v78
    ds_write_b32 v74, v65
    v_and_b32 v74, 8, v66
    v_smfmac_f32_16x16x64_bf16 v[180:183], a[128:131], v[220:227], v26 abid:1
    v_lshrrev_b32 v75, 16, v73
    v_cmp_ne_u32 s[44:45], 0, v74
    v_and_b32 v76, 0xffff, v73
    v_sub_u32 v74, 15, v75
    v_and_b32 v73, 2.0, v66
    s_waitcnt vmcnt(12)
    v_add3_u32 v73, v76, v75, v73
    v_smfmac_f32_16x16x64_bf16 v[148:151], a[132:135], v[204:211], v27
    buffer_load_dwordx4 v[32:35], v11, s[16:19], s43 offen offset:3072 sc1
    s_add_u32 s43, s43, 4096
    buffer_load_dwordx4 a[180:183], v11, s[16:19], s43 offen offset:0 sc1
    v_cndmask_b32 v74, v76, v74, s[44:45]
    v_smfmac_f32_16x16x64_bf16 v[184:187], a[132:135], v[220:227], v27
    v_cmp_gt_u32 s[44:45], 16, v73
    v_lshlrev_b32 v74, 2, v74
    v_lshrrev_b64 v[76:77], v74, s[50:51]
    v_lshrrev_b64 v[78:79], v74, s[52:53]
    s_waitcnt vmcnt(13)
    v_bfe_u32 v74, v66, 24, 4
    v_smfmac_f32_16x16x64_bf16 v[152:155], a[136:139], v[204:211], v27 abid:1
    buffer_load_dwordx4 a[184:187], v11, s[16:19], s43 offen offset:1024 sc1
    v_and_b32 v76, 15, v76
    v_smfmac_f32_16x16x64_bf16 v[188:191], a[136:139], v[220:227], v27 abid:1
    v_and_b32 v78, 15, v78
    v_lshl_add_u32 v76, v74, 4, v76
    v_mul_u32_u24 v78, 68, v78
    v_lshrrev_b32 v77, 14, v66
    s_waitcnt vmcnt(13)
    v_lshl_add_u32 v76, v76, 2, s47
    v_smfmac_f32_16x16x64_bf16 v[156:159], a[140:143], v[204:211], v49 abid:1
    buffer_load_dwordx4 a[188:191], v11, s[16:19], s43 offen offset:2048 sc1
    v_and_b32 v78, 0x30c, v78
    v_smfmac_f32_16x16x64_bf16 v[192:195], a[140:143], v[220:227], v49 abid:1
    v_and_b32 v77, 0x3cf0, v77
    v_cndmask_b32 v75, v82, v76, s[44:45]
    v_add3_u32 v77, v77, v78, s29
    s_waitcnt vmcnt(12)
    s_waitcnt lgkmcnt(4)
    v_and_b32 v78, 0x3fff, v66
    v_smfmac_f32_16x16x64_bf16 v[124:127], a[144:147], v[196:203], v28
    buffer_load_dwordx4 a[192:195], v11, s[16:19], s43 offen offset:3072 sc1
    s_waitcnt lgkmcnt(2)
    v_cndmask_b32 v74, v82, v77, s[44:45]
    v_smfmac_f32_16x16x64_bf16 v[160:163], a[144:147], v[228:235], v28
    ds_read_b128 v[204:207], v1 offset:5120
    ds_read_b128 v[208:211], v2 offset:5120
    ds_write_b32 v75, v78
    ds_write_b32 v74, v67
    v_lshrrev_b32 v74, 16, v80
    v_and_b32 v80, 0xffff, v80
    s_waitcnt vmcnt(12)
    v_or3_b32 v75, v56, v60, v64
    v_smfmac_f32_16x16x64_bf16 v[128:131], a[148:151], v[196:203], v28 abid:1
    s_add_u32 s43, s43, 4096
    buffer_load_dwordx4 a[196:199], v11, s[16:19], s43 offen offset:0 sc1
    v_add_u32 v80, v80, v74
    v_smfmac_f32_16x16x64_bf16 v[164:167], a[148:151], v[228:235], v28 abid:1
    ds_read_b128 v[220:223], v1 offset:23552
    ds_read_b128 v[224:227], v2 offset:23552
    v_cmp_gt_i32 s[32:33], 0, v75
    s_waitcnt vmcnt(12)
    v_cmp_lt_u32 s[34:35], 16, v80
    v_smfmac_f32_16x16x64_bf16 v[132:135], a[152:155], v[196:203], v29
    buffer_load_dwordx4 a[200:203], v11, s[16:19], s43 offen offset:1024 sc1
    s_mov_b32 s46, 0
    s_mov_b32 s21, 0
    s_or_b32 s32, s32, s33
    s_and_b32 s27, s34, 0x1ff
    s_or_b32 s33, s32, s27
    s_cbranch_scc1 M_ovb
M_ovbr:
    ds_read_b128 v[236:239], v9 offset:9408
    ds_read_b128 v[216:219], v9 offset:9792
    v_smfmac_f32_16x16x64_bf16 v[168:171], a[152:155], v[228:235], v29
    s_waitcnt vmcnt(12)
    v_smfmac_f32_16x16x64_bf16 v[136:139], a[156:159], v[196:203], v29 abid:1
    buffer_load_dwordx4 a[204:207], v11, s[16:19], s43 offen offset:2048 sc1
    s_waitcnt lgkmcnt(1)
    v_xad_u32 v236, v236, v3, v4
    v_smfmac_f32_16x16x64_bf16 v[172:175], a[156:159], v[228:235], v29 abid:1
    s_waitcnt vmcnt(12)
    v_xad_u32 v237, v237, v3, v4
    v_smfmac_f32_16x16x64_bf16 v[140:143], a[160:163], v[196:203], v30
    buffer_load_dwordx4 a[208:211], v11, s[16:19], s43 offen offset:3072 sc1
    ds_read2st64_b32 v[244:245], v236 offset0:0 offset1:72
    ds_read2st64_b32 v[246:247], v237 offset0:0 offset1:72
    v_xad_u32 v238, v238, v3, v4
    v_smfmac_f32_16x16x64_bf16 v[176:179], a[160:163], v[228:235], v30
    s_waitcnt vmcnt(12)
    v_xad_u32 v239, v239, v3, v4
    v_smfmac_f32_16x16x64_bf16 v[144:147], a[164:167], v[196:203], v30 abid:1
    s_add_u32 s43, s43, 4096
    buffer_load_dwordx4 a[212:215], v11, s[16:19], s43 offen offset:0 sc1
    ds_read2st64_b32 v[248:249], v238 offset0:0 offset1:72
    ds_read2st64_b32 v[250:251], v239 offset0:0 offset1:72
    ds_read_b128 v[240:243], v8 offset:3072
    ds_read_b128 v[236:239], v9 offset:9280
    s_waitcnt lgkmcnt(6)
    v_and_b32 v212, 0x3fff, v216
    v_smfmac_f32_16x16x64_bf16 v[180:183], a[164:167], v[228:235], v30 abid:1
    v_and_b32 v214, 0x3fff, v218
    s_waitcnt vmcnt(12)
    v_xad_u32 v212, v212, v3, v4
    v_smfmac_f32_16x16x64_bf16 v[148:151], a[168:171], v[196:203], v31
    buffer_load_dwordx4 v[36:39], v11, s[16:19], s43 offen offset:1024 sc1
    buffer_load_dwordx4 a[216:219], v11, s[16:19], s43 offen offset:2048 sc1
    ds_read2st64_b32 v[212:213], v212 offset0:0 offset1:72
    v_xad_u32 v214, v214, v3, v4
    v_smfmac_f32_16x16x64_bf16 v[184:187], a[168:171], v[228:235], v31
    ds_read2st64_b32 v[214:215], v214 offset0:0 offset1:72
    s_waitcnt vmcnt(13)
    v_smfmac_f32_16x16x64_bf16 v[152:155], a[172:175], v[196:203], v31 abid:1
    buffer_load_dwordx4 a[220:223], v11, s[16:19], s43 offen offset:3072 sc1
    s_waitcnt lgkmcnt(3)
    v_smfmac_f32_16x16x64_bf16 v[136:139], v[240:243], v[244:251], v10
    v_smfmac_f32_16x16x64_bf16 v[172:175], v[240:243], v[244:251], v10 abid:1
    s_waitcnt lgkmcnt(2)
    v_xad_u32 v236, v236, v3, v4
    v_smfmac_f32_16x16x64_bf16 v[188:191], a[172:175], v[228:235], v31 abid:1
    s_waitcnt vmcnt(13)
    v_xad_u32 v237, v237, v3, v4
    v_smfmac_f32_16x16x64_bf16 v[156:159], a[176:179], v[196:203], v50
    s_add_u32 s43, s43, 4096
    buffer_load_dwordx4 a[224:227], v11, s[16:19], s43 offen offset:0 sc1
    ds_read2st64_b32 v[244:245], v236 offset0:0 offset1:72
    ds_read2st64_b32 v[246:247], v237 offset0:0 offset1:72
    v_xad_u32 v238, v238, v3, v4
    v_smfmac_f32_16x16x64_bf16 v[192:195], a[176:179], v[228:235], v50
    s_waitcnt vmcnt(12)
    v_xad_u32 v239, v239, v3, v4
    v_smfmac_f32_16x16x64_bf16 v[124:127], a[180:183], v[204:211], v32
    buffer_load_dwordx4 a[228:231], v11, s[16:19], s43 offen offset:1024 sc1
    ds_read2st64_b32 v[248:249], v238 offset0:0 offset1:72
    ds_read2st64_b32 v[250:251], v239 offset0:0 offset1:72
    ds_read_b128 v[240:243], v8 offset:1024
    ds_read_b128 v[236:239], v9 offset:9344
    s_waitcnt lgkmcnt(6)
    s_and_b32 s30, s27, 7
    s_cbranch_scc1 M_ov0
M_ovp0:
    v_smfmac_f32_16x16x64_bf16 v[160:163], a[180:183], v[220:227], v32
    ds_read_b128 v[196:199], v1 offset:6144
    ds_read_b128 v[200:203], v2 offset:6144
    s_waitcnt vmcnt(12)
    v_smfmac_f32_16x16x64_bf16 v[128:131], a[184:187], v[204:211], v32 abid:1
    buffer_load_dwordx4 a[232:235], v11, s[16:19], s43 offen offset:2048 sc1
    v_smfmac_f32_16x16x64_bf16 v[164:167], a[184:187], v[220:227], v32 abid:1
    ds_read_b128 v[228:231], v1 offset:24576
    ds_read_b128 v[232:235], v2 offset:24576
    s_waitcnt vmcnt(12)
    v_smfmac_f32_16x16x64_bf16 v[132:135], a[188:191], v[204:211], v33
    buffer_load_dwordx4 a[236:239], v11, s[16:19], s43 offen offset:3072 sc1
    s_waitcnt lgkmcnt(5)
    v_smfmac_f32_16x16x64_bf16 v[128:131], v[240:243], v[244:251], v10
    v_smfmac_f32_16x16x64_bf16 v[164:167], v[240:243], v[244:251], v10 abid:1
    s_waitcnt lgkmcnt(4)
    v_xad_u32 v236, v236, v3, v4
    v_smfmac_f32_16x16x64_bf16 v[168:171], a[188:191], v[220:227], v33
    s_waitcnt vmcnt(12)
    v_xad_u32 v237, v237, v3, v4
    v_smfmac_f32_16x16x64_bf16 v[136:139], a[192:195], v[204:211], v33 abid:1
    s_add_u32 s43, s43, 4096
    buffer_load_dwordx4 a[240:243], v11, s[16:19], s43 offen offset:0 sc1
    ds_read2st64_b32 v[244:245], v236 offset0:0 offset1:72
    ds_read2st64_b32 v[246:247], v237 offset0:0 offset1:72
    v_xad_u32 v238, v238, v3, v4
    v_smfmac_f32_16x16x64_bf16 v[172:175], a[192:195], v[220:227], v33 abid:1
    s_waitcnt vmcnt(12)
    v_xad_u32 v239, v239, v3, v4
    v_smfmac_f32_16x16x64_bf16 v[140:143], a[196:199], v[204:211], v34
    buffer_load_dwordx4 a[244:247], v11, s[16:19], s43 offen offset:1024 sc1
    ds_read2st64_b32 v[248:249], v238 offset0:0 offset1:72
    ds_read2st64_b32 v[250:251], v239 offset0:0 offset1:72
    ds_read_b128 v[240:243], v8 offset:2048
    ds_read_b128 v[236:239], v9 offset:9216
    s_and_b32 s30, s27, 56
    s_cbranch_scc1 M_ov1
M_ovp1:
    v_smfmac_f32_16x16x64_bf16 v[176:179], a[196:199], v[220:227], v34
    s_waitcnt vmcnt(12)
    v_smfmac_f32_16x16x64_bf16 v[144:147], a[200:203], v[204:211], v34 abid:1
    buffer_load_dwordx4 a[248:251], v11, s[16:19], s43 offen offset:2048 sc1
    v_smfmac_f32_16x16x64_bf16 v[180:183], a[200:203], v[220:227], v34 abid:1
    s_waitcnt vmcnt(12)
    v_smfmac_f32_16x16x64_bf16 v[148:151], a[204:207], v[204:211], v35
    buffer_load_dwordx4 v[40:43], v11, s[16:19], s43 offen offset:3072 sc1
    s_add_u32 s43, s43, 4096
    buffer_load_dwordx4 a[252:255], v11, s[16:19], s43 offen offset:0 sc1
    s_waitcnt lgkmcnt(1)
    v_smfmac_f32_16x16x64_bf16 v[132:135], v[240:243], v[244:251], v10
    v_smfmac_f32_16x16x64_bf16 v[168:171], v[240:243], v[244:251], v10 abid:1
    s_waitcnt lgkmcnt(0)
    v_xad_u32 v236, v236, v3, v4
    v_smfmac_f32_16x16x64_bf16 v[184:187], a[204:207], v[220:227], v35
    s_waitcnt vmcnt(13)
    v_xad_u32 v237, v237, v3, v4
    v_smfmac_f32_16x16x64_bf16 v[152:155], a[208:211], v[204:211], v35 abid:1
    buffer_load_dwordx4 v[56:59], v11, s[16:19], s43 offen offset:1024 sc1
    ds_read2st64_b32 v[244:245], v236 offset0:0 offset1:72
    ds_read2st64_b32 v[246:247], v237 offset0:0 offset1:72
    v_xad_u32 v238, v238, v3, v4
    v_smfmac_f32_16x16x64_bf16 v[188:191], a[208:211], v[220:227], v35 abid:1
    s_waitcnt vmcnt(13)
    v_xad_u32 v239, v239, v3, v4
    v_smfmac_f32_16x16x64_bf16 v[156:159], a[212:215], v[204:211], v50 abid:1
    buffer_load_dwordx4 v[60:63], v11, s[16:19], s43 offen offset:2048 sc1
    ds_read2st64_b32 v[248:249], v238 offset0:0 offset1:72
    ds_read2st64_b32 v[250:251], v239 offset0:0 offset1:72
    ds_read_b128 v[240:243], v8 offset:0
    ds_read_b128 v[236:239], v9 offset:9728
    s_and_b32 s30, s27, 448
    s_cbranch_scc1 M_ov2
M_ovp2:
    v_smfmac_f32_16x16x64_bf16 v[192:195], a[212:215], v[220:227], v50 abid:1
    s_waitcnt vmcnt(12)
    v_smfmac_f32_16x16x64_bf16 v[124:127], a[216:219], v[196:203], v36
    buffer_load_dwordx4 v[64:67], v11, s[16:19], s43 offen offset:3072 sc1
    v_smfmac_f32_16x16x64_bf16 v[160:163], a[216:219], v[228:235], v36
    ds_read_b128 v[204:207], v1 offset:7168
    ds_read_b128 v[208:211], v2 offset:7168
    s_waitcnt vmcnt(12)
    v_smfmac_f32_16x16x64_bf16 v[128:131], a[220:223], v[196:203], v36 abid:1
    s_add_u32 s43, s43, 4096
    buffer_load_dwordx4 v[68:71], v11, s[16:19], s43 offen offset:0 sc1
    s_waitcnt lgkmcnt(3)
    v_smfmac_f32_16x16x64_bf16 v[124:127], v[240:243], v[244:251], v10
    v_smfmac_f32_16x16x64_bf16 v[160:163], v[240:243], v[244:251], v10 abid:1
    s_waitcnt lgkmcnt(2)
    v_xad_u32 v236, v236, v3, v4
    v_smfmac_f32_16x16x64_bf16 v[164:167], a[220:223], v[228:235], v36 abid:1
    ds_read_b128 v[220:223], v1 offset:25600
    ds_read_b128 v[224:227], v2 offset:25600
    s_waitcnt vmcnt(12)
    v_xad_u32 v237, v237, v3, v4
    v_smfmac_f32_16x16x64_bf16 v[132:135], a[224:227], v[196:203], v37
    buffer_load_dwordx4 v[72:75], v11, s[16:19], s43 offen offset:1024 sc1
    ds_read2st64_b32 v[244:245], v236 offset0:0 offset1:72
    ds_read2st64_b32 v[246:247], v237 offset0:0 offset1:72
    v_xad_u32 v238, v238, v3, v4
    v_smfmac_f32_16x16x64_bf16 v[168:171], a[224:227], v[228:235], v37
    s_waitcnt vmcnt(12)
    v_xad_u32 v239, v239, v3, v4
    v_smfmac_f32_16x16x64_bf16 v[136:139], a[228:231], v[196:203], v37 abid:1
    buffer_load_dwordx4 v[76:79], v11, s[16:19], s43 offen offset:2048 sc1
    ds_read2st64_b32 v[248:249], v238 offset0:0 offset1:72
    ds_read2st64_b32 v[250:251], v239 offset0:0 offset1:72
    ds_read_b128 v[240:243], v8 offset:8192
    ds_read_b128 v[236:239], v9 offset:9664
    v_smfmac_f32_16x16x64_bf16 v[172:175], a[228:231], v[228:235], v37 abid:1
    s_waitcnt vmcnt(12)
    v_smfmac_f32_16x16x64_bf16 v[140:143], a[232:235], v[196:203], v38
    buffer_load_dwordx4 v[80:83], v11, s[16:19], s43 offen offset:3072 sc1
    v_smfmac_f32_16x16x64_bf16 v[176:179], a[232:235], v[228:235], v38
    s_waitcnt vmcnt(12)
    v_smfmac_f32_16x16x64_bf16 v[144:147], a[236:239], v[196:203], v38 abid:1
    s_add_u32 s43, s43, 4096
    buffer_load_dwordx4 v[84:87], v11, s[16:19], s43 offen offset:0 sc1
    s_waitcnt lgkmcnt(1)
    v_smfmac_f32_16x16x64_bf16 v[156:159], v[240:243], v[244:251], v10
    v_smfmac_f32_16x16x64_bf16 v[192:195], v[240:243], v[244:251], v10 abid:1
    s_waitcnt lgkmcnt(0)
    v_xad_u32 v236, v236, v3, v4
    v_smfmac_f32_16x16x64_bf16 v[180:183], a[236:239], v[228:235], v38 abid:1
    s_waitcnt vmcnt(12)
    v_xad_u32 v237, v237, v3, v4
    v_smfmac_f32_16x16x64_bf16 v[148:151], a[240:243], v[196:203], v39
    buffer_load_dwordx4 v[44:47], v11, s[16:19], s43 offen offset:1024 sc1
    buffer_load_dwordx4 v[88:91], v11, s[16:19], s43 offen offset:2048 sc1
    ds_read2st64_b32 v[244:245], v236 offset0:0 offset1:72
    ds_read2st64_b32 v[246:247], v237 offset0:0 offset1:72
    v_xad_u32 v238, v238, v3, v4
    v_smfmac_f32_16x16x64_bf16 v[184:187], a[240:243], v[228:235], v39
    s_waitcnt vmcnt(13)
    v_xad_u32 v239, v239, v3, v4
    v_smfmac_f32_16x16x64_bf16 v[152:155], a[244:247], v[196:203], v39 abid:1
    buffer_load_dwordx4 v[92:95], v11, s[16:19], s43 offen offset:3072 sc1
    ds_read2st64_b32 v[248:249], v238 offset0:0 offset1:72
    ds_read2st64_b32 v[250:251], v239 offset0:0 offset1:72
    ds_read_b128 v[240:243], v8 offset:7168
    ds_read_b128 v[236:239], v9 offset:9536
    v_smfmac_f32_16x16x64_bf16 v[188:191], a[244:247], v[228:235], v39 abid:1
    s_waitcnt vmcnt(13)
    v_smfmac_f32_16x16x64_bf16 v[156:159], a[248:251], v[196:203], v51
    s_add_u32 s43, s43, 4096
    buffer_load_dwordx4 v[96:99], v11, s[16:19], s43 offen offset:0 sc1
    v_smfmac_f32_16x16x64_bf16 v[192:195], a[248:251], v[228:235], v51
    s_waitcnt vmcnt(12)
    v_smfmac_f32_16x16x64_bf16 v[124:127], a[252:255], v[204:211], v40
    buffer_load_dwordx4 v[100:103], v11, s[16:19], s43 offen offset:1024 sc1
    ds_read_b128 v[196:199], v1 offset:8192
    ds_read_b128 v[200:203], v2 offset:8192
    s_waitcnt lgkmcnt(3)
    v_smfmac_f32_16x16x64_bf16 v[152:155], v[240:243], v[244:251], v10
    v_smfmac_f32_16x16x64_bf16 v[188:191], v[240:243], v[244:251], v10 abid:1
    s_waitcnt lgkmcnt(2)
    v_xad_u32 v236, v236, v3, v4
    s_waitcnt vmcnt(12)
    v_xad_u32 v237, v237, v3, v4
    v_smfmac_f32_16x16x64_bf16 v[128:131], v[56:59], v[204:211], v40 abid:1
    buffer_load_dwordx4 v[104:107], v11, s[16:19], s43 offen offset:2048 sc1
    ds_read_b128 v[228:231], v1 offset:26624
    ds_read_b128 v[232:235], v2 offset:26624
    ds_read2st64_b32 v[244:245], v236 offset0:0 offset1:72
    ds_read2st64_b32 v[246:247], v237 offset0:0 offset1:72
    v_xad_u32 v238, v238, v3, v4
    s_waitcnt vmcnt(12)
    v_xad_u32 v239, v239, v3, v4
    v_smfmac_f32_16x16x64_bf16 v[132:135], v[60:63], v[204:211], v41
    buffer_load_dwordx4 v[108:111], v11, s[16:19], s43 offen offset:3072 sc1
    ds_read2st64_b32 v[248:249], v238 offset0:0 offset1:72
    ds_read2st64_b32 v[250:251], v239 offset0:0 offset1:72
    ds_read_b128 v[240:243], v8 offset:5120
    ds_read_b128 v[236:239], v9 offset:9600
    s_waitcnt vmcnt(12)
    v_smfmac_f32_16x16x64_bf16 v[136:139], v[64:67], v[204:211], v41 abid:1
    s_add_u32 s43, s43, 4096
    buffer_load_dwordx4 v[112:115], v11, s[16:19], s43 offen offset:0 sc1
    s_waitcnt vmcnt(12)
    v_smfmac_f32_16x16x64_bf16 v[140:143], v[68:71], v[204:211], v42
    buffer_load_dwordx4 v[116:119], v11, s[16:19], s43 offen offset:1024 sc1
    s_waitcnt lgkmcnt(1)
    v_smfmac_f32_16x16x64_bf16 v[144:147], v[240:243], v[244:251], v10
    v_smfmac_f32_16x16x64_bf16 v[180:183], v[240:243], v[244:251], v10 abid:1
    s_waitcnt lgkmcnt(0)
    v_xad_u32 v236, v236, v3, v4
    s_waitcnt vmcnt(12)
    v_xad_u32 v237, v237, v3, v4
    v_smfmac_f32_16x16x64_bf16 v[144:147], v[72:75], v[204:211], v42 abid:1
    buffer_load_dwordx4 v[120:123], v11, s[16:19], s43 offen offset:2048 sc1
    ds_read2st64_b32 v[244:245], v236 offset0:0 offset1:72
    ds_read2st64_b32 v[246:247], v237 offset0:0 offset1:72
    v_xad_u32 v238, v238, v3, v4
    s_waitcnt vmcnt(12)
    v_xad_u32 v239, v239, v3, v4
    v_smfmac_f32_16x16x64_bf16 v[148:151], v[76:79], v[204:211], v43
    s_mov_b32 m0, s42
    s_nop 0
    buffer_load_dwordx4 v5, s[8:11], s22 offen offset:0 nt lds
    buffer_load_dword v254, v254, s[8:11], 0 offen
    ds_read2st64_b32 v[248:249], v238 offset0:0 offset1:72
    ds_read2st64_b32 v[250:251], v239 offset0:0 offset1:72
    ds_read_b128 v[240:243], v8 offset:6144
    ds_read_b128 v[236:239], v9 offset:9472
    s_waitcnt vmcnt(13)
    v_smfmac_f32_16x16x64_bf16 v[152:155], v[80:83], v[204:211], v43 abid:1
    s_add_u32 m0, m0, 896
    s_nop 0
    buffer_load_dwordx4 v5, s[8:11], s22 offen offset:128 nt lds
    s_waitcnt vmcnt(13)
    v_smfmac_f32_16x16x64_bf16 v[156:159], v[84:87], v[204:211], v51 abid:1
    s_add_u32 m0, m0, 896
    s_nop 0
    buffer_load_dwordx4 v5, s[8:11], s22 offen offset:256 nt lds
    s_waitcnt lgkmcnt(1)
    v_smfmac_f32_16x16x64_bf16 v[148:151], v[240:243], v[244:251], v10
    v_smfmac_f32_16x16x64_bf16 v[184:187], v[240:243], v[244:251], v10 abid:1
    s_waitcnt lgkmcnt(0)
    v_xad_u32 v236, v236, v3, v4
    s_waitcnt vmcnt(12)
    v_xad_u32 v237, v237, v3, v4
    v_smfmac_f32_16x16x64_bf16 v[124:127], v[88:91], v[196:203], v44
    s_add_u32 m0, m0, 896
    s_nop 0
    buffer_load_dwordx4 v5, s[8:11], s22 offen offset:384 nt lds
    ds_read2st64_b32 v[244:245], v236 offset0:0 offset1:72
    ds_read2st64_b32 v[246:247], v237 offset0:0 offset1:72
    v_xad_u32 v238, v238, v3, v4
    s_waitcnt vmcnt(12)
    v_xad_u32 v239, v239, v3, v4
    v_smfmac_f32_16x16x64_bf16 v[128:131], v[92:95], v[196:203], v44 abid:1
    ds_read2st64_b32 v[248:249], v238 offset0:0 offset1:72
    ds_read2st64_b32 v[250:251], v239 offset0:0 offset1:72
    ds_read_b128 v[240:243], v8 offset:4096
    s_waitcnt vmcnt(11)
    v_smfmac_f32_16x16x64_bf16 v[132:135], v[96:99], v[196:203], v45
    s_waitcnt vmcnt(10)
    v_smfmac_f32_16x16x64_bf16 v[136:139], v[100:103], v[196:203], v45 abid:1
    s_waitcnt lgkmcnt(0)
    v_smfmac_f32_16x16x64_bf16 v[140:143], v[240:243], v[244:251], v10
    v_smfmac_f32_16x16x64_bf16 v[176:179], v[240:243], v[244:251], v10 abid:1
    s_waitcnt vmcnt(9)
    v_smfmac_f32_16x16x64_bf16 v[140:143], v[104:107], v[196:203], v46
    s_waitcnt vmcnt(8)
    v_smfmac_f32_16x16x64_bf16 v[144:147], v[108:111], v[196:203], v46 abid:1
    s_waitcnt vmcnt(7)
    v_smfmac_f32_16x16x64_bf16 v[148:151], v[112:115], v[196:203], v47
    s_waitcnt vmcnt(6)
    v_smfmac_f32_16x16x64_bf16 v[152:155], v[116:119], v[196:203], v47 abid:1
    s_waitcnt vmcnt(5)
    v_smfmac_f32_16x16x64_bf16 v[156:159], v[120:123], v[196:203], v52
    s_cmp_gt_u32 s46, 1
    s_cbranch_scc1 M_slow
M_slowr0:
    v_cvt_pk_bf16_f32 v124, v124, v125
    v_cvt_pk_bf16_f32 v125, v126, v127
    v_cvt_pk_bf16_f32 v126, v128, v129
    v_cvt_pk_bf16_f32 v127, v130, v131
    v_cvt_pk_bf16_f32 v132, v132, v133
    v_cvt_pk_bf16_f32 v133, v134, v135
    v_cvt_pk_bf16_f32 v134, v136, v137
    v_cvt_pk_bf16_f32 v135, v138, v139
    ds_read_b128 v[136:139], v9 offset:10432
    v_cndmask_b32_dpp v128, v124, v132, vcc row_ror:8 row_mask:0xf bank_mask:0xf
    v_cndmask_b32_dpp v129, v125, v133, vcc row_ror:8 row_mask:0xf bank_mask:0xf
    v_cndmask_b32_dpp v130, v126, v134, vcc row_ror:8 row_mask:0xf bank_mask:0xf
    v_cndmask_b32_dpp v131, v127, v135, vcc row_ror:8 row_mask:0xf bank_mask:0xf
    buffer_store_dwordx4 v[128:131], v6, s[12:15], s59 offen offset:0 sc1
    v_mov_b32_dpp v124, v132 row_ror:8 row_mask:0xf bank_mask:0xc
    v_mov_b32_dpp v125, v133 row_ror:8 row_mask:0xf bank_mask:0xc
    v_mov_b32_dpp v126, v134 row_ror:8 row_mask:0xf bank_mask:0xc
    v_mov_b32_dpp v127, v135 row_ror:8 row_mask:0xf bank_mask:0xc
    buffer_store_dwordx4 v[124:127], v6, s[12:15], s24 offen offset:0 sc1
    ds_read_b128 v[128:131], v9 offset:10304
    ds_read_b128 v[132:135], v9 offset:10368
    ds_read_b128 v[124:127], v9 offset:10240
    v_cvt_pk_bf16_f32 v140, v140, v141
    v_cvt_pk_bf16_f32 v141, v142, v143
    v_cvt_pk_bf16_f32 v142, v144, v145
    v_cvt_pk_bf16_f32 v143, v146, v147
    v_cvt_pk_bf16_f32 v148, v148, v149
    v_cvt_pk_bf16_f32 v149, v150, v151
    v_cvt_pk_bf16_f32 v150, v152, v153
    v_cvt_pk_bf16_f32 v151, v154, v155
    ds_read_b128 v[152:155], v9 offset:10688
    v_cndmask_b32_dpp v144, v140, v148, vcc row_ror:8 row_mask:0xf bank_mask:0xf
    v_cndmask_b32_dpp v145, v141, v149, vcc row_ror:8 row_mask:0xf bank_mask:0xf
    v_cndmask_b32_dpp v146, v142, v150, vcc row_ror:8 row_mask:0xf bank_mask:0xf
    v_cndmask_b32_dpp v147, v143, v151, vcc row_ror:8 row_mask:0xf bank_mask:0xf
    buffer_store_dwordx4 v[144:147], v6, s[12:15], s59 offen offset:128 sc1
    v_mov_b32_dpp v140, v148 row_ror:8 row_mask:0xf bank_mask:0xc
    v_mov_b32_dpp v141, v149 row_ror:8 row_mask:0xf bank_mask:0xc
    v_mov_b32_dpp v142, v150 row_ror:8 row_mask:0xf bank_mask:0xc
    v_mov_b32_dpp v143, v151 row_ror:8 row_mask:0xf bank_mask:0xc
    buffer_store_dwordx4 v[140:143], v6, s[12:15], s24 offen offset:128 sc1
    ds_read_b128 v[144:147], v9 offset:10560
    ds_read_b128 v[148:151], v9 offset:10624
    ds_read_b128 v[140:143], v9 offset:10496
    v_cvt_pk_bf16_f32 v156, v156, v157
    v_cvt_pk_bf16_f32 v157, v158, v159
    ds_write_b64 v252, v[156:157] offset:25728
    ds_read_b128 v[156:159], v9 offset:10752
    s_mov_b32 s91, 0
    s_mov_b32 s25, 36864
    s_add_u32 s90, s24, 9437184
    s_mov_b32 s28, s26
    s_add_u32 s23, s24, 18432
    s_cmp_lt_u32 s20, 2
    s_cselect_b32 s66, s23, s24
    s_add_u32 s66, s66, s95
    v_add_u32 v4, 36864, v4
    v_add_u32 v1, 36864, v1
    v_add_u32 v2, 36864, v2
    s_branch M_top1
M_top:
    s_waitcnt vmcnt(8)
M_top1:
    s_add_u32 s23, s24, 18432
    s_add_u32 s58, s24, 27648
    s_mov_b32 s24, s90
    s_add_u32 s59, s90, 9216
    s_waitcnt lgkmcnt(0)
    s_barrier
    ds_read_b128 v[244:247], v8 offset:10816
    v_smfmac_f32_16x16x64_bf16 v[160:163], a[252:255], v[220:227], v40
    ds_read_b128 v[196:199], v1 offset:0
    v_smfmac_f32_16x16x64_bf16 v[160:163], v[88:91], v[228:235], v44
    ds_read_b128 v[200:203], v2 offset:0
    s_cmp_lt_u32 s22, 75497472
    s_cbranch_scc0 M_bF
    s_cmp_lt_u32 s91, 2
    s_cbranch_scc1 M_bE
M_bL:
    v_smfmac_f32_16x16x64_bf16 v[164:167], v[56:59], v[220:227], v40 abid:1
    ds_read_b128 v[204:207], v1 offset:1024
    v_smfmac_f32_16x16x64_bf16 v[164:167], v[92:95], v[228:235], v44 abid:1
    ds_read_b128 v[208:211], v2 offset:1024
    v_mov_b32 v0, 1
    v_smfmac_f32_16x16x64_bf16 v[168:171], v[60:63], v[220:227], v41
    ds_read_b128 v[212:215], v1 offset:2048
    v_smfmac_f32_16x16x64_bf16 v[168:171], v[96:99], v[228:235], v45
    ds_read_b128 v[216:219], v2 offset:2048
    v_smfmac_f32_16x16x64_bf16 v[172:175], v[64:67], v[220:227], v41 abid:1
    s_waitcnt vmcnt(8)
    s_waitcnt lgkmcnt(6)
    buffer_store_dwordx4 v[244:247], v7, s[12:15], s66 offen sc1
    v_smfmac_f32_16x16x64_bf16 v[172:175], v[100:103], v[228:235], v45 abid:1
    ds_read_b128 v[236:239], v9 offset:9408
    v_smfmac_f32_16x16x64_bf16 v[176:179], v[68:71], v[220:227], v42
    s_waitcnt vmcnt(8)
    buffer_atomic_add v0, v253, s[16:19], s92 offen sc0 sc1
    s_mov_b32 s21, 1
    v_smfmac_f32_16x16x64_bf16 v[176:179], v[104:107], v[228:235], v46
    v_smfmac_f32_16x16x64_bf16 v[180:183], v[72:75], v[220:227], v42 abid:1
    v_cvt_pk_bf16_f32 v160, v160, v161
    v_smfmac_f32_16x16x64_bf16 v[180:183], v[108:111], v[228:235], v46 abid:1
    v_cvt_pk_bf16_f32 v161, v162, v163
    v_smfmac_f32_16x16x64_bf16 v[184:187], v[76:79], v[220:227], v43
    v_cvt_pk_bf16_f32 v162, v164, v165
    v_smfmac_f32_16x16x64_bf16 v[184:187], v[112:115], v[228:235], v47
    v_cvt_pk_bf16_f32 v163, v166, v167
    v_smfmac_f32_16x16x64_bf16 v[188:191], v[80:83], v[220:227], v43 abid:1
    s_add_u32 m0, m0, 896
    v_cvt_pk_bf16_f32 v168, v168, v169
    v_smfmac_f32_16x16x64_bf16 v[188:191], v[116:119], v[228:235], v47 abid:1
    s_waitcnt vmcnt(8)
    buffer_load_dwordx4 v5, s[8:11], s22 offen offset:512 nt lds
    v_cvt_pk_bf16_f32 v169, v170, v171
    v_smfmac_f32_16x16x64_bf16 v[192:195], v[84:87], v[220:227], v51 abid:1
    v_cvt_pk_bf16_f32 v170, v172, v173
    v_smfmac_f32_16x16x64_bf16 v[192:195], v[120:123], v[228:235], v52
    ds_read_b128 v[220:223], v1 offset:3072
    s_waitcnt lgkmcnt(6)
    v_cvt_pk_bf16_f32 v171, v174, v175
    v_smfmac_f32_16x16x64_bf16 v[124:127], a[0:3], v[196:203], v12
    ds_read_b128 v[224:227], v2 offset:3072
    ds_read_b128 v[172:175], v9 offset:10432
    s_waitcnt lgkmcnt(6)
    v_cndmask_b32_dpp v164, v160, v168, vcc row_ror:8 row_mask:0xf bank_mask:0xf
    v_smfmac_f32_16x16x64_bf16 v[124:127], a[36:39], v[204:211], v16
    ds_read_b128 v[228:231], v1 offset:4096
    s_waitcnt lgkmcnt(5)
    v_cndmask_b32_dpp v165, v161, v169, vcc row_ror:8 row_mask:0xf bank_mask:0xf
    v_smfmac_f32_16x16x64_bf16 v[124:127], a[72:75], v[212:219], v20
    ds_read_b128 v[232:235], v2 offset:4096
    v_cndmask_b32_dpp v166, v162, v170, vcc row_ror:8 row_mask:0xf bank_mask:0xf
    v_smfmac_f32_16x16x64_bf16 v[128:131], a[4:7], v[196:203], v12 abid:1
    s_barrier
    v_cndmask_b32_dpp v167, v163, v171, vcc row_ror:8 row_mask:0xf bank_mask:0xf
    v_smfmac_f32_16x16x64_bf16 v[128:131], a[40:43], v[204:211], v16 abid:1
    s_waitcnt vmcnt(8)
    buffer_store_dwordx4 v[164:167], v6, s[12:15], s58 offen offset:0 sc1
    s_waitcnt lgkmcnt(5)
    v_xad_u32 v236, v236, v3, v4
    v_smfmac_f32_16x16x64_bf16 v[128:131], a[76:79], v[212:219], v20 abid:1
    v_xad_u32 v237, v237, v3, v4
    v_smfmac_f32_16x16x64_bf16 v[132:135], a[8:11], v[196:203], v13
    ds_read2st64_b32 v[244:245], v236 offset0:0 offset1:72
    ds_read_b128 v[240:243], v8 offset:3072
    v_xad_u32 v238, v238, v3, v4
    v_smfmac_f32_16x16x64_bf16 v[132:135], a[44:47], v[204:211], v17
    ds_read2st64_b32 v[246:247], v237 offset0:0 offset1:72
    v_xad_u32 v239, v239, v3, v4
    v_smfmac_f32_16x16x64_bf16 v[132:135], a[80:83], v[212:219], v21
    ds_read2st64_b32 v[248:249], v238 offset0:0 offset1:72
    v_mov_b32_dpp v160, v168 row_ror:8 row_mask:0xf bank_mask:0xc
    v_smfmac_f32_16x16x64_bf16 v[136:139], a[12:15], v[196:203], v13 abid:1
    ds_read2st64_b32 v[250:251], v239 offset0:0 offset1:72
    ds_read_b128 v[236:239], v9 offset:9280
    v_mov_b32_dpp v161, v169 row_ror:8 row_mask:0xf bank_mask:0xc
    v_smfmac_f32_16x16x64_bf16 v[136:139], a[48:51], v[204:211], v17 abid:1
    v_mov_b32_dpp v162, v170 row_ror:8 row_mask:0xf bank_mask:0xc
    v_smfmac_f32_16x16x64_bf16 v[136:139], a[84:87], v[212:219], v21 abid:1
    v_mov_b32_dpp v163, v171 row_ror:8 row_mask:0xf bank_mask:0xc
    v_smfmac_f32_16x16x64_bf16 v[140:143], a[16:19], v[196:203], v14
    s_waitcnt vmcnt(8)
    buffer_store_dwordx4 v[160:163], v6, s[12:15], s23 offen offset:0 sc1
    ds_read_b128 v[164:167], v9 offset:10304
    v_smfmac_f32_16x16x64_bf16 v[140:143], a[52:55], v[204:211], v18
    ds_read_b128 v[168:171], v9 offset:10368
    ds_read_b128 v[160:163], v9 offset:10240
    v_smfmac_f32_16x16x64_bf16 v[140:143], a[88:91], v[212:219], v22
    v_smfmac_f32_16x16x64_bf16 v[144:147], a[20:23], v[196:203], v14 abid:1
    v_smfmac_f32_16x16x64_bf16 v[144:147], a[56:59], v[204:211], v18 abid:1
    v_smfmac_f32_16x16x64_bf16 v[144:147], a[92:95], v[212:219], v22 abid:1
    s_waitcnt lgkmcnt(3)
    v_xad_u32 v236, v236, v3, v4
    v_smfmac_f32_16x16x64_bf16 v[136:139], v[240:243], v[244:251], v10
    v_xad_u32 v237, v237, v3, v4
    v_smfmac_f32_16x16x64_bf16 v[172:175], v[240:243], v[244:251], v10 abid:1
    ds_read2st64_b32 v[244:245], v236 offset0:0 offset1:72
    ds_read_b128 v[240:243], v8 offset:1024
    v_xad_u32 v238, v238, v3, v4
    v_smfmac_f32_16x16x64_bf16 v[148:151], a[24:27], v[196:203], v15
    ds_read2st64_b32 v[246:247], v237 offset0:0 offset1:72
    v_xad_u32 v239, v239, v3, v4
    v_smfmac_f32_16x16x64_bf16 v[148:151], a[60:63], v[204:211], v19
    ds_read2st64_b32 v[248:249], v238 offset0:0 offset1:72
    v_cvt_pk_bf16_f32 v192, v192, v193
    v_smfmac_f32_16x16x64_bf16 v[148:151], a[96:99], v[212:219], v23
    ds_read2st64_b32 v[250:251], v239 offset0:0 offset1:72
    ds_read_b128 v[236:239], v9 offset:9344
    v_cvt_pk_bf16_f32 v193, v194, v195
    v_smfmac_f32_16x16x64_bf16 v[152:155], a[28:31], v[196:203], v15 abid:1
    ds_write_b64 v252, v[192:193] offset:0
    ds_read_b128 v[192:195], v9 offset:10752
    v_smfmac_f32_16x16x64_bf16 v[152:155], a[64:67], v[204:211], v19 abid:1
    s_add_u32 m0, m0, 896
    v_smfmac_f32_16x16x64_bf16 v[152:155], a[100:103], v[212:219], v23 abid:1
    s_waitcnt vmcnt(8)
    buffer_load_dwordx4 v5, s[8:11], s22 offen offset:640 nt lds
    v_smfmac_f32_16x16x64_bf16 v[156:159], a[32:35], v[196:203], v48
    v_smfmac_f32_16x16x64_bf16 v[156:159], a[68:71], v[204:211], v48 abid:1
    v_smfmac_f32_16x16x64_bf16 v[156:159], a[104:107], v[212:219], v49
    ds_read_b128 v[196:199], v1 offset:5120
    v_cvt_pk_bf16_f32 v176, v176, v177
    v_smfmac_f32_16x16x64_bf16 v[124:127], a[108:111], v[220:227], v24
    ds_read_b128 v[200:203], v2 offset:5120
    v_cvt_pk_bf16_f32 v177, v178, v179
    v_smfmac_f32_16x16x64_bf16 v[124:127], a[144:147], v[228:235], v28
    ds_read_b128 v[204:207], v1 offset:6144
    ds_read_b128 v[216:219], v9 offset:9792
    v_cvt_pk_bf16_f32 v178, v180, v181
    v_smfmac_f32_16x16x64_bf16 v[128:131], a[112:115], v[220:227], v24 abid:1
    ds_read_b128 v[208:211], v2 offset:6144
    v_cvt_pk_bf16_f32 v179, v182, v183
    v_smfmac_f32_16x16x64_bf16 v[128:131], a[148:151], v[228:235], v28 abid:1
    s_waitcnt lgkmcnt(7)
    v_xad_u32 v236, v236, v3, v4
    v_smfmac_f32_16x16x64_bf16 v[128:131], v[240:243], v[244:251], v10
    s_add_u32 m0, m0, 896
    v_xad_u32 v237, v237, v3, v4
    v_smfmac_f32_16x16x64_bf16 v[164:167], v[240:243], v[244:251], v10 abid:1
    ds_read2st64_b32 v[244:245], v236 offset0:0 offset1:72
    ds_read_b128 v[240:243], v8 offset:2048
    v_xad_u32 v238, v238, v3, v4
    v_smfmac_f32_16x16x64_bf16 v[132:135], a[116:119], v[220:227], v25
    ds_read2st64_b32 v[246:247], v237 offset0:0 offset1:72
    s_waitcnt vmcnt(8)
    v_xad_u32 v239, v239, v3, v4
    v_smfmac_f32_16x16x64_bf16 v[132:135], a[152:155], v[228:235], v29
    ds_read2st64_b32 v[248:249], v238 offset0:0 offset1:72
    buffer_load_dwordx4 v5, s[8:11], s22 offen offset:768 nt lds
    v_cvt_pk_bf16_f32 v184, v184, v185
    v_smfmac_f32_16x16x64_bf16 v[136:139], a[120:123], v[220:227], v25 abid:1
    ds_read2st64_b32 v[250:251], v239 offset0:0 offset1:72
    ds_read_b128 v[236:239], v9 offset:9216
    v_cvt_pk_bf16_f32 v185, v186, v187
    v_smfmac_f32_16x16x64_bf16 v[136:139], a[156:159], v[228:235], v29 abid:1
    v_cvt_pk_bf16_f32 v186, v188, v189
    v_smfmac_f32_16x16x64_bf16 v[140:143], a[124:127], v[220:227], v26
    v_cvt_pk_bf16_f32 v187, v190, v191
    v_smfmac_f32_16x16x64_bf16 v[140:143], a[160:163], v[228:235], v30
    ds_read_b128 v[188:191], v9 offset:10688
    v_cndmask_b32_dpp v180, v176, v184, vcc row_ror:8 row_mask:0xf bank_mask:0xf
    v_smfmac_f32_16x16x64_bf16 v[144:147], a[128:131], v[220:227], v26 abid:1
    v_cndmask_b32_dpp v181, v177, v185, vcc row_ror:8 row_mask:0xf bank_mask:0xf
    v_smfmac_f32_16x16x64_bf16 v[144:147], a[164:167], v[228:235], v30 abid:1
    v_cndmask_b32_dpp v182, v178, v186, vcc row_ror:8 row_mask:0xf bank_mask:0xf
    v_smfmac_f32_16x16x64_bf16 v[148:151], a[132:135], v[220:227], v27
    v_cndmask_b32_dpp v183, v179, v187, vcc row_ror:8 row_mask:0xf bank_mask:0xf
    v_smfmac_f32_16x16x64_bf16 v[148:151], a[168:171], v[228:235], v31
    s_waitcnt vmcnt(8)
    buffer_store_dwordx4 v[180:183], v6, s[12:15], s58 offen offset:128 sc1
    v_mov_b32_dpp v176, v184 row_ror:8 row_mask:0xf bank_mask:0xc
    v_smfmac_f32_16x16x64_bf16 v[152:155], a[136:139], v[220:227], v27 abid:1
    v_mov_b32_dpp v177, v185 row_ror:8 row_mask:0xf bank_mask:0xc
    v_smfmac_f32_16x16x64_bf16 v[152:155], a[172:175], v[228:235], v31 abid:1
    s_waitcnt lgkmcnt(1)
    v_xad_u32 v236, v236, v3, v4
    v_smfmac_f32_16x16x64_bf16 v[132:135], v[240:243], v[244:251], v10
    v_xad_u32 v237, v237, v3, v4
    v_smfmac_f32_16x16x64_bf16 v[168:171], v[240:243], v[244:251], v10 abid:1
    ds_read2st64_b32 v[244:245], v236 offset0:0 offset1:72
    ds_read_b128 v[240:243], v8 offset:0
    v_xad_u32 v238, v238, v3, v4
    v_smfmac_f32_16x16x64_bf16 v[156:159], a[140:143], v[220:227], v49 abid:1
    ds_read2st64_b32 v[246:247], v237 offset0:0 offset1:72
    v_xad_u32 v239, v239, v3, v4
    v_smfmac_f32_16x16x64_bf16 v[156:159], a[176:179], v[228:235], v50
    ds_read2st64_b32 v[248:249], v238 offset0:0 offset1:72
    ds_read_b128 v[220:223], v1 offset:7168
    v_mov_b32_dpp v178, v186 row_ror:8 row_mask:0xf bank_mask:0xc
    v_smfmac_f32_16x16x64_bf16 v[124:127], a[180:183], v[196:203], v32
    ds_read2st64_b32 v[250:251], v239 offset0:0 offset1:72
    ds_read_b128 v[236:239], v9 offset:9728
    v_mov_b32_dpp v179, v187 row_ror:8 row_mask:0xf bank_mask:0xc
    v_smfmac_f32_16x16x64_bf16 v[124:127], a[216:219], v[204:211], v36
    ds_read_b128 v[224:227], v2 offset:7168
    s_waitcnt vmcnt(8)
    buffer_store_dwordx4 v[176:179], v6, s[12:15], s23 offen offset:128 sc1
    v_smfmac_f32_16x16x64_bf16 v[128:131], a[184:187], v[196:203], v32 abid:1
    ds_read_b128 v[228:231], v1 offset:8192
    ds_read_b128 v[180:183], v9 offset:10560
    ds_read_b128 v[184:187], v9 offset:10624
    v_smfmac_f32_16x16x64_bf16 v[128:131], a[220:223], v[204:211], v36 abid:1
    ds_read_b128 v[232:235], v2 offset:8192
    ds_read_b128 v[176:179], v9 offset:10496
    v_and_b32 v212, 0x3fff, v216
    v_smfmac_f32_16x16x64_bf16 v[132:135], a[188:191], v[196:203], v33
    v_and_b32 v214, 0x3fff, v218
    v_smfmac_f32_16x16x64_bf16 v[132:135], a[224:227], v[204:211], v37
    v_xad_u32 v212, v212, v3, v4
    v_smfmac_f32_16x16x64_bf16 v[136:139], a[192:195], v[196:203], v33 abid:1
    ds_read2st64_b32 v[212:213], v212 offset0:0 offset1:72
    v_xad_u32 v214, v214, v3, v4
    v_smfmac_f32_16x16x64_bf16 v[136:139], a[228:231], v[204:211], v37 abid:1
    ds_read2st64_b32 v[214:215], v214 offset0:0 offset1:72
    v_smfmac_f32_16x16x64_bf16 v[140:143], a[196:199], v[196:203], v34
    v_smfmac_f32_16x16x64_bf16 v[140:143], a[232:235], v[204:211], v38
    s_waitcnt vmcnt(7)
    s_waitcnt lgkmcnt(8)
    v_xad_u32 v236, v236, v3, v4
    v_smfmac_f32_16x16x64_bf16 v[124:127], v[240:243], v[244:251], v10
    v_xad_u32 v237, v237, v3, v4
    v_smfmac_f32_16x16x64_bf16 v[160:163], v[240:243], v[244:251], v10 abid:1
    ds_read2st64_b32 v[244:245], v236 offset0:0 offset1:72
    ds_read_b128 v[240:243], v8 offset:8192
    v_xad_u32 v238, v238, v3, v4
    v_smfmac_f32_16x16x64_bf16 v[144:147], a[200:203], v[196:203], v34 abid:1
    ds_read2st64_b32 v[246:247], v237 offset0:0 offset1:72
    v_xad_u32 v239, v239, v3, v4
    v_smfmac_f32_16x16x64_bf16 v[144:147], a[236:239], v[204:211], v38 abid:1
    ds_read2st64_b32 v[248:249], v238 offset0:0 offset1:72
    v_mul_u32_u24 v0, s94, v0
    v_smfmac_f32_16x16x64_bf16 v[148:151], a[204:207], v[196:203], v35
    ds_read2st64_b32 v[250:251], v239 offset0:0 offset1:72
    ds_read_b128 v[236:239], v9 offset:9664
    v_add_u32 v0, s93, v0
    v_smfmac_f32_16x16x64_bf16 v[148:151], a[240:243], v[204:211], v39
    s_add_u32 m0, m0, 896
    v_min_u32 v0, 75497472, v0
    v_smfmac_f32_16x16x64_bf16 v[152:155], a[208:211], v[196:203], v35 abid:1
    ds_write_b32 v253, v0
    s_waitcnt vmcnt(8)
    v_mov_b32 v0, 162048
    v_smfmac_f32_16x16x64_bf16 v[152:155], a[244:247], v[204:211], v39 abid:1
    buffer_load_dwordx4 v5, s[8:11], s22 offen offset:896 nt lds
    s_and_b32 s30, s27, 7
    s_waitcnt lgkmcnt(7)
    s_cbranch_scc1 M_ov0
M_ovr0L:
    v_smfmac_f32_16x16x64_bf16 v[156:159], a[212:215], v[196:203], v50 abid:1
    s_and_b32 s30, s27, 56
    s_cbranch_scc1 M_ov1
M_ovr1L:
    v_smfmac_f32_16x16x64_bf16 v[156:159], a[248:251], v[204:211], v51
    ds_read_b128 v[196:199], v1 offset:18432
    s_and_b32 s30, s27, 448
    s_cbranch_scc1 M_ov2
M_ovr2L:
    v_smfmac_f32_16x16x64_bf16 v[124:127], a[252:255], v[220:227], v40
    ds_read_b128 v[200:203], v2 offset:18432
    v_smfmac_f32_16x16x64_bf16 v[124:127], v[88:91], v[228:235], v44
    ds_read_b128 v[204:207], v1 offset:19456
    v_smfmac_f32_16x16x64_bf16 v[128:131], v[56:59], v[220:227], v40 abid:1
    ds_read_b128 v[208:211], v2 offset:19456
    v_smfmac_f32_16x16x64_bf16 v[128:131], v[92:95], v[228:235], v44 abid:1
    s_waitcnt lgkmcnt(4)
    s_barrier
    v_xad_u32 v236, v236, v3, v4
    v_smfmac_f32_16x16x64_bf16 v[156:159], v[240:243], v[244:251], v10
    ds_read_b32 v0, v0
    v_xad_u32 v237, v237, v3, v4
    v_smfmac_f32_16x16x64_bf16 v[192:195], v[240:243], v[244:251], v10 abid:1
    ds_read2st64_b32 v[244:245], v236 offset0:0 offset1:72
    ds_read_b128 v[240:243], v8 offset:7168
    v_xad_u32 v238, v238, v3, v4
    v_smfmac_f32_16x16x64_bf16 v[132:135], v[60:63], v[220:227], v41
    ds_read2st64_b32 v[246:247], v237 offset0:0 offset1:72
    v_xad_u32 v239, v239, v3, v4
    v_smfmac_f32_16x16x64_bf16 v[132:135], v[96:99], v[228:235], v45
    ds_read2st64_b32 v[248:249], v238 offset0:0 offset1:72
    s_add_u32 m0, m0, 896
    v_smfmac_f32_16x16x64_bf16 v[136:139], v[64:67], v[220:227], v41 abid:1
    ds_read2st64_b32 v[250:251], v239 offset0:0 offset1:72
    ds_read_b128 v[236:239], v9 offset:9536
    s_waitcnt vmcnt(8)
    v_smfmac_f32_16x16x64_bf16 v[136:139], v[100:103], v[228:235], v45 abid:1
    buffer_load_dwordx4 v5, s[8:11], s22 offen offset:1024 nt lds
    s_waitcnt lgkmcnt(6)
    v_readfirstlane_b32 s88, v0
    v_smfmac_f32_16x16x64_bf16 v[140:143], v[68:71], v[220:227], v42
    s_cmp_lt_u32 s88, 75497472
    s_cselect_b32 s10, 75497472, 0
    v_smfmac_f32_16x16x64_bf16 v[140:143], v[104:107], v[228:235], v46
    v_smfmac_f32_16x16x64_bf16 v[144:147], v[72:75], v[220:227], v42 abid:1
    ds_read_b128 v[212:215], v1 offset:20480
    v_smfmac_f32_16x16x64_bf16 v[144:147], v[108:111], v[228:235], v46 abid:1
    ds_read_b128 v[216:219], v2 offset:20480
    v_smfmac_f32_16x16x64_bf16 v[148:151], v[76:79], v[220:227], v43
    v_smfmac_f32_16x16x64_bf16 v[148:151], v[112:115], v[228:235], v47
    v_smfmac_f32_16x16x64_bf16 v[152:155], v[80:83], v[220:227], v43 abid:1
    v_smfmac_f32_16x16x64_bf16 v[152:155], v[116:119], v[228:235], v47 abid:1
    s_waitcnt lgkmcnt(2)
    v_xad_u32 v236, v236, v3, v4
    v_smfmac_f32_16x16x64_bf16 v[152:155], v[240:243], v[244:251], v10
    v_xad_u32 v237, v237, v3, v4
    v_smfmac_f32_16x16x64_bf16 v[188:191], v[240:243], v[244:251], v10 abid:1
    s_cmp_gt_u32 s46, 1
    s_cbranch_scc1 M_slow
M_slowrL:
    v_xad_u32 v238, v238, v3, v4
    v_smfmac_f32_16x16x64_bf16 v[156:159], v[84:87], v[220:227], v51 abid:1
    ds_read2st64_b32 v[244:245], v236 offset0:0 offset1:72
    ds_read_b128 v[240:243], v8 offset:5120
    v_xad_u32 v239, v239, v3, v4
    v_smfmac_f32_16x16x64_bf16 v[156:159], v[120:123], v[228:235], v52
    ds_read2st64_b32 v[246:247], v237 offset0:0 offset1:72
    ds_read_b128 v[220:223], v1 offset:21504
    v_smfmac_f32_16x16x64_bf16 v[160:163], a[0:3], v[196:203], v12
    ds_read2st64_b32 v[248:249], v238 offset0:0 offset1:72
    ds_read_b128 v[224:227], v2 offset:21504
    v_smfmac_f32_16x16x64_bf16 v[160:163], a[36:39], v[204:211], v16
    ds_read2st64_b32 v[250:251], v239 offset0:0 offset1:72
    ds_read_b128 v[236:239], v9 offset:9600
    s_waitcnt lgkmcnt(8)
    v_smfmac_f32_16x16x64_bf16 v[160:163], a[72:75], v[212:219], v20
    ds_read_b128 v[228:231], v1 offset:22528
    v_smfmac_f32_16x16x64_bf16 v[164:167], a[4:7], v[196:203], v12 abid:1
    ds_read_b128 v[232:235], v2 offset:22528
    v_cvt_pk_bf16_f32 v156, v156, v157
    v_smfmac_f32_16x16x64_bf16 v[164:167], a[40:43], v[204:211], v16 abid:1
    s_mov_b32 m0, s28
    v_cvt_pk_bf16_f32 v157, v158, v159
    v_smfmac_f32_16x16x64_bf16 v[164:167], a[76:79], v[212:219], v20 abid:1
    ds_write_b64 v252, v[156:157] offset:25728
    ds_read_b128 v[156:159], v9 offset:10752
    s_waitcnt vmcnt(8)
    v_smfmac_f32_16x16x64_bf16 v[168:171], a[8:11], v[196:203], v13
    buffer_load_dwordx4 v5, s[8:11], s88 offen offset:0 nt lds
    v_smfmac_f32_16x16x64_bf16 v[168:171], a[44:47], v[204:211], v17
    v_cvt_pk_bf16_f32 v124, v124, v125
    v_smfmac_f32_16x16x64_bf16 v[168:171], a[80:83], v[212:219], v21
    s_waitcnt lgkmcnt(4)
    v_xad_u32 v236, v236, v3, v4
    v_smfmac_f32_16x16x64_bf16 v[144:147], v[240:243], v[244:251], v10
    v_xad_u32 v237, v237, v3, v4
    v_smfmac_f32_16x16x64_bf16 v[180:183], v[240:243], v[244:251], v10 abid:1
    ds_read2st64_b32 v[244:245], v236 offset0:0 offset1:72
    ds_read_b128 v[240:243], v8 offset:6144
    v_xad_u32 v238, v238, v3, v4
    v_smfmac_f32_16x16x64_bf16 v[172:175], a[12:15], v[196:203], v13 abid:1
    ds_read2st64_b32 v[246:247], v237 offset0:0 offset1:72
    v_xad_u32 v239, v239, v3, v4
    v_smfmac_f32_16x16x64_bf16 v[172:175], a[48:51], v[204:211], v17 abid:1
    ds_read2st64_b32 v[248:249], v238 offset0:0 offset1:72
    v_cvt_pk_bf16_f32 v125, v126, v127
    v_smfmac_f32_16x16x64_bf16 v[172:175], a[84:87], v[212:219], v21 abid:1
    ds_read2st64_b32 v[250:251], v239 offset0:0 offset1:72
    ds_read_b128 v[236:239], v9 offset:9472
    v_cvt_pk_bf16_f32 v126, v128, v129
    v_smfmac_f32_16x16x64_bf16 v[176:179], a[16:19], v[196:203], v14
    v_cvt_pk_bf16_f32 v127, v130, v131
    v_smfmac_f32_16x16x64_bf16 v[176:179], a[52:55], v[204:211], v18
    v_cvt_pk_bf16_f32 v132, v132, v133
    v_smfmac_f32_16x16x64_bf16 v[176:179], a[88:91], v[212:219], v22
    v_cvt_pk_bf16_f32 v133, v134, v135
    v_smfmac_f32_16x16x64_bf16 v[180:183], a[20:23], v[196:203], v14 abid:1
    s_add_u32 m0, m0, 896
    v_cvt_pk_bf16_f32 v134, v136, v137
    v_smfmac_f32_16x16x64_bf16 v[180:183], a[56:59], v[204:211], v18 abid:1
    s_waitcnt vmcnt(8)
    buffer_load_dwordx4 v5, s[8:11], s88 offen offset:128 nt lds
    v_cvt_pk_bf16_f32 v135, v138, v139
    v_smfmac_f32_16x16x64_bf16 v[180:183], a[92:95], v[212:219], v22 abid:1
    ds_read_b128 v[136:139], v9 offset:10432
    v_cndmask_b32_dpp v128, v124, v132, vcc row_ror:8 row_mask:0xf bank_mask:0xf
    v_smfmac_f32_16x16x64_bf16 v[184:187], a[24:27], v[196:203], v15
    v_cndmask_b32_dpp v129, v125, v133, vcc row_ror:8 row_mask:0xf bank_mask:0xf
    v_smfmac_f32_16x16x64_bf16 v[184:187], a[60:63], v[204:211], v19
    v_cndmask_b32_dpp v130, v126, v134, vcc row_ror:8 row_mask:0xf bank_mask:0xf
    v_smfmac_f32_16x16x64_bf16 v[184:187], a[96:99], v[212:219], v23
    s_waitcnt lgkmcnt(1)
    v_xad_u32 v236, v236, v3, v4
    v_smfmac_f32_16x16x64_bf16 v[148:151], v[240:243], v[244:251], v10
    v_xad_u32 v237, v237, v3, v4
    v_smfmac_f32_16x16x64_bf16 v[184:187], v[240:243], v[244:251], v10 abid:1
    ds_read2st64_b32 v[244:245], v236 offset0:0 offset1:72
    ds_read_b128 v[240:243], v8 offset:4096
    v_xad_u32 v238, v238, v3, v4
    v_smfmac_f32_16x16x64_bf16 v[188:191], a[28:31], v[196:203], v15 abid:1
    ds_read2st64_b32 v[246:247], v237 offset0:0 offset1:72
    v_xad_u32 v239, v239, v3, v4
    v_smfmac_f32_16x16x64_bf16 v[188:191], a[64:67], v[204:211], v19 abid:1
    ds_read2st64_b32 v[248:249], v238 offset0:0 offset1:72
    v_cndmask_b32_dpp v131, v127, v135, vcc row_ror:8 row_mask:0xf bank_mask:0xf
    v_smfmac_f32_16x16x64_bf16 v[188:191], a[100:103], v[212:219], v23 abid:1
    ds_read2st64_b32 v[250:251], v239 offset0:0 offset1:72
    s_waitcnt vmcnt(8)
    buffer_store_dwordx4 v[128:131], v6, s[12:15], s59 offen offset:0 sc1
    v_smfmac_f32_16x16x64_bf16 v[192:195], a[32:35], v[196:203], v48
    v_mov_b32_dpp v124, v132 row_ror:8 row_mask:0xf bank_mask:0xc
    v_smfmac_f32_16x16x64_bf16 v[192:195], a[68:71], v[204:211], v48 abid:1
    v_mov_b32_dpp v125, v133 row_ror:8 row_mask:0xf bank_mask:0xc
    v_smfmac_f32_16x16x64_bf16 v[192:195], a[104:107], v[212:219], v49
    ds_read_b128 v[196:199], v1 offset:23552
    v_mov_b32_dpp v126, v134 row_ror:8 row_mask:0xf bank_mask:0xc
    v_smfmac_f32_16x16x64_bf16 v[160:163], a[108:111], v[220:227], v24
    ds_read_b128 v[200:203], v2 offset:23552
    v_mov_b32_dpp v127, v135 row_ror:8 row_mask:0xf bank_mask:0xc
    v_smfmac_f32_16x16x64_bf16 v[160:163], a[144:147], v[228:235], v28
    ds_read_b128 v[204:207], v1 offset:24576
    s_waitcnt vmcnt(8)
    buffer_store_dwordx4 v[124:127], v6, s[12:15], s24 offen offset:0 sc1
    v_smfmac_f32_16x16x64_bf16 v[164:167], a[112:115], v[220:227], v24 abid:1
    ds_read_b128 v[208:211], v2 offset:24576
    ds_read_b128 v[128:131], v9 offset:10304
    ds_read_b128 v[132:135], v9 offset:10368
    v_smfmac_f32_16x16x64_bf16 v[164:167], a[148:151], v[228:235], v28 abid:1
    ds_read_b128 v[124:127], v9 offset:10240
    v_smfmac_f32_16x16x64_bf16 v[168:171], a[116:119], v[220:227], v25
    v_smfmac_f32_16x16x64_bf16 v[168:171], a[152:155], v[228:235], v29
    s_waitcnt lgkmcnt(7)
    v_smfmac_f32_16x16x64_bf16 v[140:143], v[240:243], v[244:251], v10
    v_smfmac_f32_16x16x64_bf16 v[176:179], v[240:243], v[244:251], v10 abid:1
    v_smfmac_f32_16x16x64_bf16 v[172:175], a[120:123], v[220:227], v25 abid:1
    s_add_u32 s28, s28, 36864
    s_cmp_ge_u32 s28, 110592
    s_cselect_b32 s28, s26, s28
    v_smfmac_f32_16x16x64_bf16 v[172:175], a[156:159], v[228:235], v29 abid:1
    s_add_u32 s30, s25, 36864
    s_cmp_eq_u32 s30, 110592
    s_cselect_b32 s30, 0, s30
    v_smfmac_f32_16x16x64_bf16 v[176:179], a[124:127], v[220:227], v26
    s_sub_u32 s31, s30, s25
    s_mov_b32 s25, s30
    s_mov_b32 s90, s22
    v_smfmac_f32_16x16x64_bf16 v[176:179], a[160:163], v[228:235], v30
    s_mov_b32 s22, s88
    s_add_u32 s91, s91, 1
    s_cmp_lt_u32 s20, 2
    v_smfmac_f32_16x16x64_bf16 v[180:183], a[128:131], v[220:227], v26 abid:1
    s_cselect_b32 s66, s23, s24
    s_add_u32 s66, s66, s95
    v_smfmac_f32_16x16x64_bf16 v[180:183], a[164:167], v[228:235], v30 abid:1
    v_cvt_pk_bf16_f32 v140, v140, v141
    v_smfmac_f32_16x16x64_bf16 v[184:187], a[132:135], v[220:227], v27
    s_add_u32 m0, m0, 896
    v_cvt_pk_bf16_f32 v141, v142, v143
    v_smfmac_f32_16x16x64_bf16 v[184:187], a[168:171], v[228:235], v31
    s_waitcnt vmcnt(8)
    buffer_load_dwordx4 v5, s[8:11], s88 offen offset:256 nt lds
    v_cvt_pk_bf16_f32 v142, v144, v145
    v_smfmac_f32_16x16x64_bf16 v[188:191], a[136:139], v[220:227], v27 abid:1
    v_cvt_pk_bf16_f32 v143, v146, v147
    v_smfmac_f32_16x16x64_bf16 v[188:191], a[172:175], v[228:235], v31 abid:1
    v_cvt_pk_bf16_f32 v148, v148, v149
    v_smfmac_f32_16x16x64_bf16 v[192:195], a[140:143], v[220:227], v49 abid:1
    v_cvt_pk_bf16_f32 v149, v150, v151
    v_smfmac_f32_16x16x64_bf16 v[192:195], a[176:179], v[228:235], v50
    ds_read_b128 v[220:223], v1 offset:25600
    s_waitcnt lgkmcnt(6)
    v_cvt_pk_bf16_f32 v150, v152, v153
    v_smfmac_f32_16x16x64_bf16 v[160:163], a[180:183], v[196:203], v32
    ds_read_b128 v[224:227], v2 offset:25600
    s_waitcnt lgkmcnt(5)
    v_cvt_pk_bf16_f32 v151, v154, v155
    v_smfmac_f32_16x16x64_bf16 v[160:163], a[216:219], v[204:211], v36
    ds_read_b128 v[228:231], v1 offset:26624
    ds_read_b128 v[152:155], v9 offset:10688
    v_cndmask_b32_dpp v144, v140, v148, vcc row_ror:8 row_mask:0xf bank_mask:0xf
    v_smfmac_f32_16x16x64_bf16 v[164:167], a[184:187], v[196:203], v32 abid:1
    ds_read_b128 v[232:235], v2 offset:26624
    v_cndmask_b32_dpp v145, v141, v149, vcc row_ror:8 row_mask:0xf bank_mask:0xf
    v_smfmac_f32_16x16x64_bf16 v[164:167], a[220:223], v[204:211], v36 abid:1
    s_add_u32 m0, m0, 896
    v_cndmask_b32_dpp v146, v142, v150, vcc row_ror:8 row_mask:0xf bank_mask:0xf
    v_smfmac_f32_16x16x64_bf16 v[168:171], a[188:191], v[196:203], v33
    s_waitcnt vmcnt(8)
    buffer_load_dwordx4 v5, s[8:11], s88 offen offset:384 nt lds
    v_cndmask_b32_dpp v147, v143, v151, vcc row_ror:8 row_mask:0xf bank_mask:0xf
    v_smfmac_f32_16x16x64_bf16 v[168:171], a[224:227], v[204:211], v37
    s_waitcnt vmcnt(8)
    buffer_store_dwordx4 v[144:147], v6, s[12:15], s59 offen offset:128 sc1
    v_mov_b32_dpp v140, v148 row_ror:8 row_mask:0xf bank_mask:0xc
    v_smfmac_f32_16x16x64_bf16 v[172:175], a[192:195], v[196:203], v33 abid:1
    v_mov_b32_dpp v141, v149 row_ror:8 row_mask:0xf bank_mask:0xc
    v_smfmac_f32_16x16x64_bf16 v[172:175], a[228:231], v[204:211], v37 abid:1
    v_mov_b32_dpp v142, v150 row_ror:8 row_mask:0xf bank_mask:0xc
    v_smfmac_f32_16x16x64_bf16 v[176:179], a[196:199], v[196:203], v34
    v_mov_b32_dpp v143, v151 row_ror:8 row_mask:0xf bank_mask:0xc
    v_smfmac_f32_16x16x64_bf16 v[176:179], a[232:235], v[204:211], v38
    s_waitcnt vmcnt(8)
    buffer_store_dwordx4 v[140:143], v6, s[12:15], s24 offen offset:128 sc1
    ds_read_b128 v[144:147], v9 offset:10560
    v_smfmac_f32_16x16x64_bf16 v[180:183], a[200:203], v[196:203], v34 abid:1
    ds_read_b128 v[148:151], v9 offset:10624
    ds_read_b128 v[140:143], v9 offset:10496
    v_add_u32 v4, s31, v4
    v_smfmac_f32_16x16x64_bf16 v[180:183], a[236:239], v[204:211], v38 abid:1
    v_add_u32 v1, s31, v1
    v_smfmac_f32_16x16x64_bf16 v[184:187], a[204:207], v[196:203], v35
    v_add_u32 v2, s31, v2
    v_smfmac_f32_16x16x64_bf16 v[184:187], a[240:243], v[204:211], v39
    v_smfmac_f32_16x16x64_bf16 v[188:191], a[208:211], v[196:203], v35 abid:1
    v_smfmac_f32_16x16x64_bf16 v[188:191], a[244:247], v[204:211], v39 abid:1
    v_smfmac_f32_16x16x64_bf16 v[192:195], a[212:215], v[196:203], v50 abid:1
    v_smfmac_f32_16x16x64_bf16 v[192:195], a[248:251], v[204:211], v51
    s_branch M_top
M_bE:
    v_smfmac_f32_16x16x64_bf16 v[164:167], v[56:59], v[220:227], v40 abid:1
    ds_read_b128 v[204:207], v1 offset:1024
    v_smfmac_f32_16x16x64_bf16 v[164:167], v[92:95], v[228:235], v44 abid:1
    ds_read_b128 v[208:211], v2 offset:1024
    v_mov_b32 v0, 1
    v_smfmac_f32_16x16x64_bf16 v[168:171], v[60:63], v[220:227], v41
    ds_read_b128 v[212:215], v1 offset:2048
    v_smfmac_f32_16x16x64_bf16 v[168:171], v[96:99], v[228:235], v45
    ds_read_b128 v[216:219], v2 offset:2048
    v_smfmac_f32_16x16x64_bf16 v[172:175], v[64:67], v[220:227], v41 abid:1
    s_waitcnt vmcnt(6)
    s_waitcnt lgkmcnt(6)
    buffer_store_dwordx4 v[244:247], v7, s[12:15], s66 offen sc1
    v_smfmac_f32_16x16x64_bf16 v[172:175], v[100:103], v[228:235], v45 abid:1
    ds_read_b128 v[236:239], v9 offset:9408
    v_smfmac_f32_16x16x64_bf16 v[176:179], v[68:71], v[220:227], v42
    s_waitcnt vmcnt(6)
    buffer_atomic_add v0, v253, s[16:19], s92 offen sc0 sc1
    s_mov_b32 s21, 2
    v_smfmac_f32_16x16x64_bf16 v[176:179], v[104:107], v[228:235], v46
    v_smfmac_f32_16x16x64_bf16 v[180:183], v[72:75], v[220:227], v42 abid:1
    v_cvt_pk_bf16_f32 v160, v160, v161
    v_smfmac_f32_16x16x64_bf16 v[180:183], v[108:111], v[228:235], v46 abid:1
    v_cvt_pk_bf16_f32 v161, v162, v163
    v_smfmac_f32_16x16x64_bf16 v[184:187], v[76:79], v[220:227], v43
    v_cvt_pk_bf16_f32 v162, v164, v165
    v_smfmac_f32_16x16x64_bf16 v[184:187], v[112:115], v[228:235], v47
    v_cvt_pk_bf16_f32 v163, v166, v167
    v_smfmac_f32_16x16x64_bf16 v[188:191], v[80:83], v[220:227], v43 abid:1
    s_add_u32 m0, m0, 896
    v_cvt_pk_bf16_f32 v168, v168, v169
    v_smfmac_f32_16x16x64_bf16 v[188:191], v[116:119], v[228:235], v47 abid:1
    s_waitcnt vmcnt(6)
    buffer_load_dwordx4 v5, s[8:11], s22 offen offset:512 nt lds
    v_cvt_pk_bf16_f32 v169, v170, v171
    v_smfmac_f32_16x16x64_bf16 v[192:195], v[84:87], v[220:227], v51 abid:1
    v_cvt_pk_bf16_f32 v170, v172, v173
    v_smfmac_f32_16x16x64_bf16 v[192:195], v[120:123], v[228:235], v52
    ds_read_b128 v[220:223], v1 offset:3072
    s_waitcnt lgkmcnt(6)
    v_cvt_pk_bf16_f32 v171, v174, v175
    v_smfmac_f32_16x16x64_bf16 v[124:127], a[0:3], v[196:203], v12
    ds_read_b128 v[224:227], v2 offset:3072
    ds_read_b128 v[172:175], v9 offset:10432
    s_waitcnt lgkmcnt(6)
    v_cndmask_b32_dpp v164, v160, v168, vcc row_ror:8 row_mask:0xf bank_mask:0xf
    v_smfmac_f32_16x16x64_bf16 v[124:127], a[36:39], v[204:211], v16
    ds_read_b128 v[228:231], v1 offset:4096
    s_waitcnt lgkmcnt(5)
    v_cndmask_b32_dpp v165, v161, v169, vcc row_ror:8 row_mask:0xf bank_mask:0xf
    v_smfmac_f32_16x16x64_bf16 v[124:127], a[72:75], v[212:219], v20
    ds_read_b128 v[232:235], v2 offset:4096
    v_cndmask_b32_dpp v166, v162, v170, vcc row_ror:8 row_mask:0xf bank_mask:0xf
    v_smfmac_f32_16x16x64_bf16 v[128:131], a[4:7], v[196:203], v12 abid:1
    s_barrier
    v_cndmask_b32_dpp v167, v163, v171, vcc row_ror:8 row_mask:0xf bank_mask:0xf
    v_smfmac_f32_16x16x64_bf16 v[128:131], a[40:43], v[204:211], v16 abid:1
    s_waitcnt vmcnt(6)
    buffer_store_dwordx4 v[164:167], v6, s[12:15], s58 offen offset:0 sc1
    s_waitcnt lgkmcnt(5)
    v_xad_u32 v236, v236, v3, v4
    v_smfmac_f32_16x16x64_bf16 v[128:131], a[76:79], v[212:219], v20 abid:1
    v_xad_u32 v237, v237, v3, v4
    v_smfmac_f32_16x16x64_bf16 v[132:135], a[8:11], v[196:203], v13
    ds_read2st64_b32 v[244:245], v236 offset0:0 offset1:72
    ds_read_b128 v[240:243], v8 offset:3072
    v_xad_u32 v238, v238, v3, v4
    v_smfmac_f32_16x16x64_bf16 v[132:135], a[44:47], v[204:211], v17
    ds_read2st64_b32 v[246:247], v237 offset0:0 offset1:72
    v_xad_u32 v239, v239, v3, v4
    v_smfmac_f32_16x16x64_bf16 v[132:135], a[80:83], v[212:219], v21
    ds_read2st64_b32 v[248:249], v238 offset0:0 offset1:72
    v_mov_b32_dpp v160, v168 row_ror:8 row_mask:0xf bank_mask:0xc
    v_smfmac_f32_16x16x64_bf16 v[136:139], a[12:15], v[196:203], v13 abid:1
    ds_read2st64_b32 v[250:251], v239 offset0:0 offset1:72
    ds_read_b128 v[236:239], v9 offset:9280
    v_mov_b32_dpp v161, v169 row_ror:8 row_mask:0xf bank_mask:0xc
    v_smfmac_f32_16x16x64_bf16 v[136:139], a[48:51], v[204:211], v17 abid:1
    v_mov_b32_dpp v162, v170 row_ror:8 row_mask:0xf bank_mask:0xc
    v_smfmac_f32_16x16x64_bf16 v[136:139], a[84:87], v[212:219], v21 abid:1
    v_mov_b32_dpp v163, v171 row_ror:8 row_mask:0xf bank_mask:0xc
    v_smfmac_f32_16x16x64_bf16 v[140:143], a[16:19], v[196:203], v14
    s_waitcnt vmcnt(6)
    buffer_store_dwordx4 v[160:163], v6, s[12:15], s23 offen offset:0 sc1
    ds_read_b128 v[164:167], v9 offset:10304
    v_smfmac_f32_16x16x64_bf16 v[140:143], a[52:55], v[204:211], v18
    ds_read_b128 v[168:171], v9 offset:10368
    ds_read_b128 v[160:163], v9 offset:10240
    v_smfmac_f32_16x16x64_bf16 v[140:143], a[88:91], v[212:219], v22
    v_smfmac_f32_16x16x64_bf16 v[144:147], a[20:23], v[196:203], v14 abid:1
    v_smfmac_f32_16x16x64_bf16 v[144:147], a[56:59], v[204:211], v18 abid:1
    v_smfmac_f32_16x16x64_bf16 v[144:147], a[92:95], v[212:219], v22 abid:1
    s_waitcnt lgkmcnt(3)
    v_xad_u32 v236, v236, v3, v4
    v_smfmac_f32_16x16x64_bf16 v[136:139], v[240:243], v[244:251], v10
    v_xad_u32 v237, v237, v3, v4
    v_smfmac_f32_16x16x64_bf16 v[172:175], v[240:243], v[244:251], v10 abid:1
    ds_read2st64_b32 v[244:245], v236 offset0:0 offset1:72
    ds_read_b128 v[240:243], v8 offset:1024
    v_xad_u32 v238, v238, v3, v4
    v_smfmac_f32_16x16x64_bf16 v[148:151], a[24:27], v[196:203], v15
    ds_read2st64_b32 v[246:247], v237 offset0:0 offset1:72
    v_xad_u32 v239, v239, v3, v4
    v_smfmac_f32_16x16x64_bf16 v[148:151], a[60:63], v[204:211], v19
    ds_read2st64_b32 v[248:249], v238 offset0:0 offset1:72
    v_cvt_pk_bf16_f32 v192, v192, v193
    v_smfmac_f32_16x16x64_bf16 v[148:151], a[96:99], v[212:219], v23
    ds_read2st64_b32 v[250:251], v239 offset0:0 offset1:72
    ds_read_b128 v[236:239], v9 offset:9344
    v_cvt_pk_bf16_f32 v193, v194, v195
    v_smfmac_f32_16x16x64_bf16 v[152:155], a[28:31], v[196:203], v15 abid:1
    ds_write_b64 v252, v[192:193] offset:0
    ds_read_b128 v[192:195], v9 offset:10752
    v_smfmac_f32_16x16x64_bf16 v[152:155], a[64:67], v[204:211], v19 abid:1
    s_add_u32 m0, m0, 896
    v_smfmac_f32_16x16x64_bf16 v[152:155], a[100:103], v[212:219], v23 abid:1
    s_waitcnt vmcnt(6)
    buffer_load_dwordx4 v5, s[8:11], s22 offen offset:640 nt lds
    v_smfmac_f32_16x16x64_bf16 v[156:159], a[32:35], v[196:203], v48
    v_smfmac_f32_16x16x64_bf16 v[156:159], a[68:71], v[204:211], v48 abid:1
    v_smfmac_f32_16x16x64_bf16 v[156:159], a[104:107], v[212:219], v49
    ds_read_b128 v[196:199], v1 offset:5120
    v_cvt_pk_bf16_f32 v176, v176, v177
    v_smfmac_f32_16x16x64_bf16 v[124:127], a[108:111], v[220:227], v24
    ds_read_b128 v[200:203], v2 offset:5120
    v_cvt_pk_bf16_f32 v177, v178, v179
    v_smfmac_f32_16x16x64_bf16 v[124:127], a[144:147], v[228:235], v28
    ds_read_b128 v[204:207], v1 offset:6144
    ds_read_b128 v[216:219], v9 offset:9792
    v_cvt_pk_bf16_f32 v178, v180, v181
    v_smfmac_f32_16x16x64_bf16 v[128:131], a[112:115], v[220:227], v24 abid:1
    ds_read_b128 v[208:211], v2 offset:6144
    v_cvt_pk_bf16_f32 v179, v182, v183
    v_smfmac_f32_16x16x64_bf16 v[128:131], a[148:151], v[228:235], v28 abid:1
    s_waitcnt lgkmcnt(7)
    v_xad_u32 v236, v236, v3, v4
    v_smfmac_f32_16x16x64_bf16 v[128:131], v[240:243], v[244:251], v10
    s_add_u32 m0, m0, 896
    v_xad_u32 v237, v237, v3, v4
    v_smfmac_f32_16x16x64_bf16 v[164:167], v[240:243], v[244:251], v10 abid:1
    ds_read2st64_b32 v[244:245], v236 offset0:0 offset1:72
    ds_read_b128 v[240:243], v8 offset:2048
    v_xad_u32 v238, v238, v3, v4
    v_smfmac_f32_16x16x64_bf16 v[132:135], a[116:119], v[220:227], v25
    ds_read2st64_b32 v[246:247], v237 offset0:0 offset1:72
    s_waitcnt vmcnt(6)
    v_xad_u32 v239, v239, v3, v4
    v_smfmac_f32_16x16x64_bf16 v[132:135], a[152:155], v[228:235], v29
    ds_read2st64_b32 v[248:249], v238 offset0:0 offset1:72
    buffer_load_dwordx4 v5, s[8:11], s22 offen offset:768 nt lds
    v_cvt_pk_bf16_f32 v184, v184, v185
    v_smfmac_f32_16x16x64_bf16 v[136:139], a[120:123], v[220:227], v25 abid:1
    ds_read2st64_b32 v[250:251], v239 offset0:0 offset1:72
    ds_read_b128 v[236:239], v9 offset:9216
    v_cvt_pk_bf16_f32 v185, v186, v187
    v_smfmac_f32_16x16x64_bf16 v[136:139], a[156:159], v[228:235], v29 abid:1
    v_cvt_pk_bf16_f32 v186, v188, v189
    v_smfmac_f32_16x16x64_bf16 v[140:143], a[124:127], v[220:227], v26
    v_cvt_pk_bf16_f32 v187, v190, v191
    v_smfmac_f32_16x16x64_bf16 v[140:143], a[160:163], v[228:235], v30
    ds_read_b128 v[188:191], v9 offset:10688
    v_cndmask_b32_dpp v180, v176, v184, vcc row_ror:8 row_mask:0xf bank_mask:0xf
    v_smfmac_f32_16x16x64_bf16 v[144:147], a[128:131], v[220:227], v26 abid:1
    v_cndmask_b32_dpp v181, v177, v185, vcc row_ror:8 row_mask:0xf bank_mask:0xf
    v_smfmac_f32_16x16x64_bf16 v[144:147], a[164:167], v[228:235], v30 abid:1
    v_cndmask_b32_dpp v182, v178, v186, vcc row_ror:8 row_mask:0xf bank_mask:0xf
    v_smfmac_f32_16x16x64_bf16 v[148:151], a[132:135], v[220:227], v27
    v_cndmask_b32_dpp v183, v179, v187, vcc row_ror:8 row_mask:0xf bank_mask:0xf
    v_smfmac_f32_16x16x64_bf16 v[148:151], a[168:171], v[228:235], v31
    s_waitcnt vmcnt(6)
    buffer_store_dwordx4 v[180:183], v6, s[12:15], s58 offen offset:128 sc1
    v_mov_b32_dpp v176, v184 row_ror:8 row_mask:0xf bank_mask:0xc
    v_smfmac_f32_16x16x64_bf16 v[152:155], a[136:139], v[220:227], v27 abid:1
    v_mov_b32_dpp v177, v185 row_ror:8 row_mask:0xf bank_mask:0xc
    v_smfmac_f32_16x16x64_bf16 v[152:155], a[172:175], v[228:235], v31 abid:1
    s_waitcnt lgkmcnt(1)
    v_xad_u32 v236, v236, v3, v4
    v_smfmac_f32_16x16x64_bf16 v[132:135], v[240:243], v[244:251], v10
    v_xad_u32 v237, v237, v3, v4
    v_smfmac_f32_16x16x64_bf16 v[168:171], v[240:243], v[244:251], v10 abid:1
    ds_read2st64_b32 v[244:245], v236 offset0:0 offset1:72
    ds_read_b128 v[240:243], v8 offset:0
    v_xad_u32 v238, v238, v3, v4
    v_smfmac_f32_16x16x64_bf16 v[156:159], a[140:143], v[220:227], v49 abid:1
    ds_read2st64_b32 v[246:247], v237 offset0:0 offset1:72
    v_xad_u32 v239, v239, v3, v4
    v_smfmac_f32_16x16x64_bf16 v[156:159], a[176:179], v[228:235], v50
    ds_read2st64_b32 v[248:249], v238 offset0:0 offset1:72
    ds_read_b128 v[220:223], v1 offset:7168
    v_mov_b32_dpp v178, v186 row_ror:8 row_mask:0xf bank_mask:0xc
    v_smfmac_f32_16x16x64_bf16 v[124:127], a[180:183], v[196:203], v32
    ds_read2st64_b32 v[250:251], v239 offset0:0 offset1:72
    ds_read_b128 v[236:239], v9 offset:9728
    v_mov_b32_dpp v179, v187 row_ror:8 row_mask:0xf bank_mask:0xc
    v_smfmac_f32_16x16x64_bf16 v[124:127], a[216:219], v[204:211], v36
    ds_read_b128 v[224:227], v2 offset:7168
    s_waitcnt vmcnt(6)
    buffer_store_dwordx4 v[176:179], v6, s[12:15], s23 offen offset:128 sc1
    v_smfmac_f32_16x16x64_bf16 v[128:131], a[184:187], v[196:203], v32 abid:1
    ds_read_b128 v[228:231], v1 offset:8192
    ds_read_b128 v[180:183], v9 offset:10560
    ds_read_b128 v[184:187], v9 offset:10624
    v_smfmac_f32_16x16x64_bf16 v[128:131], a[220:223], v[204:211], v36 abid:1
    ds_read_b128 v[232:235], v2 offset:8192
    ds_read_b128 v[176:179], v9 offset:10496
    v_and_b32 v212, 0x3fff, v216
    v_smfmac_f32_16x16x64_bf16 v[132:135], a[188:191], v[196:203], v33
    v_and_b32 v214, 0x3fff, v218
    v_smfmac_f32_16x16x64_bf16 v[132:135], a[224:227], v[204:211], v37
    v_xad_u32 v212, v212, v3, v4
    v_smfmac_f32_16x16x64_bf16 v[136:139], a[192:195], v[196:203], v33 abid:1
    ds_read2st64_b32 v[212:213], v212 offset0:0 offset1:72
    v_xad_u32 v214, v214, v3, v4
    v_smfmac_f32_16x16x64_bf16 v[136:139], a[228:231], v[204:211], v37 abid:1
    ds_read2st64_b32 v[214:215], v214 offset0:0 offset1:72
    v_smfmac_f32_16x16x64_bf16 v[140:143], a[196:199], v[196:203], v34
    v_smfmac_f32_16x16x64_bf16 v[140:143], a[232:235], v[204:211], v38
    s_waitcnt vmcnt(7)
    s_waitcnt lgkmcnt(8)
    v_xad_u32 v236, v236, v3, v4
    v_smfmac_f32_16x16x64_bf16 v[124:127], v[240:243], v[244:251], v10
    v_xad_u32 v237, v237, v3, v4
    v_smfmac_f32_16x16x64_bf16 v[160:163], v[240:243], v[244:251], v10 abid:1
    ds_read2st64_b32 v[244:245], v236 offset0:0 offset1:72
    ds_read_b128 v[240:243], v8 offset:8192
    v_xad_u32 v238, v238, v3, v4
    v_smfmac_f32_16x16x64_bf16 v[144:147], a[200:203], v[196:203], v34 abid:1
    ds_read2st64_b32 v[246:247], v237 offset0:0 offset1:72
    v_xad_u32 v239, v239, v3, v4
    v_smfmac_f32_16x16x64_bf16 v[144:147], a[236:239], v[204:211], v38 abid:1
    ds_read2st64_b32 v[248:249], v238 offset0:0 offset1:72
    v_mul_u32_u24 v0, s94, v0
    v_smfmac_f32_16x16x64_bf16 v[148:151], a[204:207], v[196:203], v35
    ds_read2st64_b32 v[250:251], v239 offset0:0 offset1:72
    ds_read_b128 v[236:239], v9 offset:9664
    v_add_u32 v0, s93, v0
    v_smfmac_f32_16x16x64_bf16 v[148:151], a[240:243], v[204:211], v39
    s_add_u32 m0, m0, 896
    v_min_u32 v0, 75497472, v0
    v_smfmac_f32_16x16x64_bf16 v[152:155], a[208:211], v[196:203], v35 abid:1
    ds_write_b32 v253, v0
    s_waitcnt vmcnt(6)
    v_mov_b32 v0, 162048
    v_smfmac_f32_16x16x64_bf16 v[152:155], a[244:247], v[204:211], v39 abid:1
    buffer_load_dwordx4 v5, s[8:11], s22 offen offset:896 nt lds
    s_and_b32 s30, s27, 7
    s_waitcnt lgkmcnt(7)
    s_cbranch_scc1 M_ov0
M_ovr0E:
    v_smfmac_f32_16x16x64_bf16 v[156:159], a[212:215], v[196:203], v50 abid:1
    s_and_b32 s30, s27, 56
    s_cbranch_scc1 M_ov1
M_ovr1E:
    v_smfmac_f32_16x16x64_bf16 v[156:159], a[248:251], v[204:211], v51
    ds_read_b128 v[196:199], v1 offset:18432
    s_and_b32 s30, s27, 448
    s_cbranch_scc1 M_ov2
M_ovr2E:
    v_smfmac_f32_16x16x64_bf16 v[124:127], a[252:255], v[220:227], v40
    ds_read_b128 v[200:203], v2 offset:18432
    v_smfmac_f32_16x16x64_bf16 v[124:127], v[88:91], v[228:235], v44
    ds_read_b128 v[204:207], v1 offset:19456
    v_smfmac_f32_16x16x64_bf16 v[128:131], v[56:59], v[220:227], v40 abid:1
    ds_read_b128 v[208:211], v2 offset:19456
    v_smfmac_f32_16x16x64_bf16 v[128:131], v[92:95], v[228:235], v44 abid:1
    s_waitcnt lgkmcnt(4)
    s_barrier
    v_xad_u32 v236, v236, v3, v4
    v_smfmac_f32_16x16x64_bf16 v[156:159], v[240:243], v[244:251], v10
    ds_read_b32 v0, v0
    v_xad_u32 v237, v237, v3, v4
    v_smfmac_f32_16x16x64_bf16 v[192:195], v[240:243], v[244:251], v10 abid:1
    ds_read2st64_b32 v[244:245], v236 offset0:0 offset1:72
    ds_read_b128 v[240:243], v8 offset:7168
    v_xad_u32 v238, v238, v3, v4
    v_smfmac_f32_16x16x64_bf16 v[132:135], v[60:63], v[220:227], v41
    ds_read2st64_b32 v[246:247], v237 offset0:0 offset1:72
    v_xad_u32 v239, v239, v3, v4
    v_smfmac_f32_16x16x64_bf16 v[132:135], v[96:99], v[228:235], v45
    ds_read2st64_b32 v[248:249], v238 offset0:0 offset1:72
    s_add_u32 m0, m0, 896
    v_smfmac_f32_16x16x64_bf16 v[136:139], v[64:67], v[220:227], v41 abid:1
    ds_read2st64_b32 v[250:251], v239 offset0:0 offset1:72
    ds_read_b128 v[236:239], v9 offset:9536
    s_waitcnt vmcnt(6)
    v_smfmac_f32_16x16x64_bf16 v[136:139], v[100:103], v[228:235], v45 abid:1
    buffer_load_dwordx4 v5, s[8:11], s22 offen offset:1024 nt lds
    s_waitcnt lgkmcnt(6)
    v_readfirstlane_b32 s88, v0
    v_smfmac_f32_16x16x64_bf16 v[140:143], v[68:71], v[220:227], v42
    s_cmp_lt_u32 s88, 75497472
    s_cselect_b32 s10, 75497472, 0
    v_smfmac_f32_16x16x64_bf16 v[140:143], v[104:107], v[228:235], v46
    v_smfmac_f32_16x16x64_bf16 v[144:147], v[72:75], v[220:227], v42 abid:1
    ds_read_b128 v[212:215], v1 offset:20480
    v_smfmac_f32_16x16x64_bf16 v[144:147], v[108:111], v[228:235], v46 abid:1
    ds_read_b128 v[216:219], v2 offset:20480
    v_smfmac_f32_16x16x64_bf16 v[148:151], v[76:79], v[220:227], v43
    v_smfmac_f32_16x16x64_bf16 v[148:151], v[112:115], v[228:235], v47
    v_smfmac_f32_16x16x64_bf16 v[152:155], v[80:83], v[220:227], v43 abid:1
    v_smfmac_f32_16x16x64_bf16 v[152:155], v[116:119], v[228:235], v47 abid:1
    s_waitcnt lgkmcnt(2)
    v_xad_u32 v236, v236, v3, v4
    v_smfmac_f32_16x16x64_bf16 v[152:155], v[240:243], v[244:251], v10
    v_xad_u32 v237, v237, v3, v4
    v_smfmac_f32_16x16x64_bf16 v[188:191], v[240:243], v[244:251], v10 abid:1
    s_cmp_gt_u32 s46, 1
    s_cbranch_scc1 M_slow
M_slowrE:
    v_xad_u32 v238, v238, v3, v4
    v_smfmac_f32_16x16x64_bf16 v[156:159], v[84:87], v[220:227], v51 abid:1
    ds_read2st64_b32 v[244:245], v236 offset0:0 offset1:72
    ds_read_b128 v[240:243], v8 offset:5120
    v_xad_u32 v239, v239, v3, v4
    v_smfmac_f32_16x16x64_bf16 v[156:159], v[120:123], v[228:235], v52
    ds_read2st64_b32 v[246:247], v237 offset0:0 offset1:72
    ds_read_b128 v[220:223], v1 offset:21504
    v_smfmac_f32_16x16x64_bf16 v[160:163], a[0:3], v[196:203], v12
    ds_read2st64_b32 v[248:249], v238 offset0:0 offset1:72
    ds_read_b128 v[224:227], v2 offset:21504
    v_smfmac_f32_16x16x64_bf16 v[160:163], a[36:39], v[204:211], v16
    ds_read2st64_b32 v[250:251], v239 offset0:0 offset1:72
    ds_read_b128 v[236:239], v9 offset:9600
    s_waitcnt lgkmcnt(8)
    v_smfmac_f32_16x16x64_bf16 v[160:163], a[72:75], v[212:219], v20
    ds_read_b128 v[228:231], v1 offset:22528
    v_smfmac_f32_16x16x64_bf16 v[164:167], a[4:7], v[196:203], v12 abid:1
    ds_read_b128 v[232:235], v2 offset:22528
    v_cvt_pk_bf16_f32 v156, v156, v157
    v_smfmac_f32_16x16x64_bf16 v[164:167], a[40:43], v[204:211], v16 abid:1
    s_mov_b32 m0, s28
    v_cvt_pk_bf16_f32 v157, v158, v159
    v_smfmac_f32_16x16x64_bf16 v[164:167], a[76:79], v[212:219], v20 abid:1
    ds_write_b64 v252, v[156:157] offset:25728
    ds_read_b128 v[156:159], v9 offset:10752
    s_waitcnt vmcnt(6)
    v_smfmac_f32_16x16x64_bf16 v[168:171], a[8:11], v[196:203], v13
    buffer_load_dwordx4 v5, s[8:11], s88 offen offset:0 nt lds
    v_smfmac_f32_16x16x64_bf16 v[168:171], a[44:47], v[204:211], v17
    v_cvt_pk_bf16_f32 v124, v124, v125
    v_smfmac_f32_16x16x64_bf16 v[168:171], a[80:83], v[212:219], v21
    s_waitcnt lgkmcnt(4)
    v_xad_u32 v236, v236, v3, v4
    v_smfmac_f32_16x16x64_bf16 v[144:147], v[240:243], v[244:251], v10
    v_xad_u32 v237, v237, v3, v4
    v_smfmac_f32_16x16x64_bf16 v[180:183], v[240:243], v[244:251], v10 abid:1
    ds_read2st64_b32 v[244:245], v236 offset0:0 offset1:72
    ds_read_b128 v[240:243], v8 offset:6144
    v_xad_u32 v238, v238, v3, v4
    v_smfmac_f32_16x16x64_bf16 v[172:175], a[12:15], v[196:203], v13 abid:1
    ds_read2st64_b32 v[246:247], v237 offset0:0 offset1:72
    v_xad_u32 v239, v239, v3, v4
    v_smfmac_f32_16x16x64_bf16 v[172:175], a[48:51], v[204:211], v17 abid:1
    ds_read2st64_b32 v[248:249], v238 offset0:0 offset1:72
    v_cvt_pk_bf16_f32 v125, v126, v127
    v_smfmac_f32_16x16x64_bf16 v[172:175], a[84:87], v[212:219], v21 abid:1
    ds_read2st64_b32 v[250:251], v239 offset0:0 offset1:72
    ds_read_b128 v[236:239], v9 offset:9472
    v_cvt_pk_bf16_f32 v126, v128, v129
    v_smfmac_f32_16x16x64_bf16 v[176:179], a[16:19], v[196:203], v14
    v_cvt_pk_bf16_f32 v127, v130, v131
    v_smfmac_f32_16x16x64_bf16 v[176:179], a[52:55], v[204:211], v18
    v_cvt_pk_bf16_f32 v132, v132, v133
    v_smfmac_f32_16x16x64_bf16 v[176:179], a[88:91], v[212:219], v22
    v_cvt_pk_bf16_f32 v133, v134, v135
    v_smfmac_f32_16x16x64_bf16 v[180:183], a[20:23], v[196:203], v14 abid:1
    s_add_u32 m0, m0, 896
    v_cvt_pk_bf16_f32 v134, v136, v137
    v_smfmac_f32_16x16x64_bf16 v[180:183], a[56:59], v[204:211], v18 abid:1
    s_waitcnt vmcnt(6)
    buffer_load_dwordx4 v5, s[8:11], s88 offen offset:128 nt lds
    v_cvt_pk_bf16_f32 v135, v138, v139
    v_smfmac_f32_16x16x64_bf16 v[180:183], a[92:95], v[212:219], v22 abid:1
    ds_read_b128 v[136:139], v9 offset:10432
    v_cndmask_b32_dpp v128, v124, v132, vcc row_ror:8 row_mask:0xf bank_mask:0xf
    v_smfmac_f32_16x16x64_bf16 v[184:187], a[24:27], v[196:203], v15
    v_cndmask_b32_dpp v129, v125, v133, vcc row_ror:8 row_mask:0xf bank_mask:0xf
    v_smfmac_f32_16x16x64_bf16 v[184:187], a[60:63], v[204:211], v19
    v_cndmask_b32_dpp v130, v126, v134, vcc row_ror:8 row_mask:0xf bank_mask:0xf
    v_smfmac_f32_16x16x64_bf16 v[184:187], a[96:99], v[212:219], v23
    s_waitcnt lgkmcnt(1)
    v_xad_u32 v236, v236, v3, v4
    v_smfmac_f32_16x16x64_bf16 v[148:151], v[240:243], v[244:251], v10
    v_xad_u32 v237, v237, v3, v4
    v_smfmac_f32_16x16x64_bf16 v[184:187], v[240:243], v[244:251], v10 abid:1
    ds_read2st64_b32 v[244:245], v236 offset0:0 offset1:72
    ds_read_b128 v[240:243], v8 offset:4096
    v_xad_u32 v238, v238, v3, v4
    v_smfmac_f32_16x16x64_bf16 v[188:191], a[28:31], v[196:203], v15 abid:1
    ds_read2st64_b32 v[246:247], v237 offset0:0 offset1:72
    v_xad_u32 v239, v239, v3, v4
    v_smfmac_f32_16x16x64_bf16 v[188:191], a[64:67], v[204:211], v19 abid:1
    ds_read2st64_b32 v[248:249], v238 offset0:0 offset1:72
    v_cndmask_b32_dpp v131, v127, v135, vcc row_ror:8 row_mask:0xf bank_mask:0xf
    v_smfmac_f32_16x16x64_bf16 v[188:191], a[100:103], v[212:219], v23 abid:1
    ds_read2st64_b32 v[250:251], v239 offset0:0 offset1:72
    s_waitcnt vmcnt(6)
    buffer_store_dwordx4 v[128:131], v6, s[12:15], s59 offen offset:0 sc1
    v_smfmac_f32_16x16x64_bf16 v[192:195], a[32:35], v[196:203], v48
    v_mov_b32_dpp v124, v132 row_ror:8 row_mask:0xf bank_mask:0xc
    v_smfmac_f32_16x16x64_bf16 v[192:195], a[68:71], v[204:211], v48 abid:1
    v_mov_b32_dpp v125, v133 row_ror:8 row_mask:0xf bank_mask:0xc
    v_smfmac_f32_16x16x64_bf16 v[192:195], a[104:107], v[212:219], v49
    ds_read_b128 v[196:199], v1 offset:23552
    v_mov_b32_dpp v126, v134 row_ror:8 row_mask:0xf bank_mask:0xc
    v_smfmac_f32_16x16x64_bf16 v[160:163], a[108:111], v[220:227], v24
    ds_read_b128 v[200:203], v2 offset:23552
    v_mov_b32_dpp v127, v135 row_ror:8 row_mask:0xf bank_mask:0xc
    v_smfmac_f32_16x16x64_bf16 v[160:163], a[144:147], v[228:235], v28
    ds_read_b128 v[204:207], v1 offset:24576
    s_waitcnt vmcnt(6)
    buffer_store_dwordx4 v[124:127], v6, s[12:15], s24 offen offset:0 sc1
    v_smfmac_f32_16x16x64_bf16 v[164:167], a[112:115], v[220:227], v24 abid:1
    ds_read_b128 v[208:211], v2 offset:24576
    ds_read_b128 v[128:131], v9 offset:10304
    ds_read_b128 v[132:135], v9 offset:10368
    v_smfmac_f32_16x16x64_bf16 v[164:167], a[148:151], v[228:235], v28 abid:1
    ds_read_b128 v[124:127], v9 offset:10240
    v_smfmac_f32_16x16x64_bf16 v[168:171], a[116:119], v[220:227], v25
    v_smfmac_f32_16x16x64_bf16 v[168:171], a[152:155], v[228:235], v29
    s_waitcnt lgkmcnt(7)
    v_smfmac_f32_16x16x64_bf16 v[140:143], v[240:243], v[244:251], v10
    v_smfmac_f32_16x16x64_bf16 v[176:179], v[240:243], v[244:251], v10 abid:1
    v_smfmac_f32_16x16x64_bf16 v[172:175], a[120:123], v[220:227], v25 abid:1
    s_add_u32 s28, s28, 36864
    s_cmp_ge_u32 s28, 110592
    s_cselect_b32 s28, s26, s28
    v_smfmac_f32_16x16x64_bf16 v[172:175], a[156:159], v[228:235], v29 abid:1
    s_add_u32 s30, s25, 36864
    s_cmp_eq_u32 s30, 110592
    s_cselect_b32 s30, 0, s30
    v_smfmac_f32_16x16x64_bf16 v[176:179], a[124:127], v[220:227], v26
    s_sub_u32 s31, s30, s25
    s_mov_b32 s25, s30
    s_mov_b32 s90, s22
    v_smfmac_f32_16x16x64_bf16 v[176:179], a[160:163], v[228:235], v30
    s_mov_b32 s22, s88
    s_add_u32 s91, s91, 1
    s_cmp_lt_u32 s20, 2
    v_smfmac_f32_16x16x64_bf16 v[180:183], a[128:131], v[220:227], v26 abid:1
    s_cselect_b32 s66, s23, s24
    s_add_u32 s66, s66, s95
    v_smfmac_f32_16x16x64_bf16 v[180:183], a[164:167], v[228:235], v30 abid:1
    v_cvt_pk_bf16_f32 v140, v140, v141
    v_smfmac_f32_16x16x64_bf16 v[184:187], a[132:135], v[220:227], v27
    s_add_u32 m0, m0, 896
    v_cvt_pk_bf16_f32 v141, v142, v143
    v_smfmac_f32_16x16x64_bf16 v[184:187], a[168:171], v[228:235], v31
    s_waitcnt vmcnt(6)
    buffer_load_dwordx4 v5, s[8:11], s88 offen offset:256 nt lds
    v_cvt_pk_bf16_f32 v142, v144, v145
    v_smfmac_f32_16x16x64_bf16 v[188:191], a[136:139], v[220:227], v27 abid:1
    v_cvt_pk_bf16_f32 v143, v146, v147
    v_smfmac_f32_16x16x64_bf16 v[188:191], a[172:175], v[228:235], v31 abid:1
    v_cvt_pk_bf16_f32 v148, v148, v149
    v_smfmac_f32_16x16x64_bf16 v[192:195], a[140:143], v[220:227], v49 abid:1
    v_cvt_pk_bf16_f32 v149, v150, v151
    v_smfmac_f32_16x16x64_bf16 v[192:195], a[176:179], v[228:235], v50
    ds_read_b128 v[220:223], v1 offset:25600
    s_waitcnt lgkmcnt(6)
    v_cvt_pk_bf16_f32 v150, v152, v153
    v_smfmac_f32_16x16x64_bf16 v[160:163], a[180:183], v[196:203], v32
    ds_read_b128 v[224:227], v2 offset:25600
    s_waitcnt lgkmcnt(5)
    v_cvt_pk_bf16_f32 v151, v154, v155
    v_smfmac_f32_16x16x64_bf16 v[160:163], a[216:219], v[204:211], v36
    ds_read_b128 v[228:231], v1 offset:26624
    ds_read_b128 v[152:155], v9 offset:10688
    v_cndmask_b32_dpp v144, v140, v148, vcc row_ror:8 row_mask:0xf bank_mask:0xf
    v_smfmac_f32_16x16x64_bf16 v[164:167], a[184:187], v[196:203], v32 abid:1
    ds_read_b128 v[232:235], v2 offset:26624
    v_cndmask_b32_dpp v145, v141, v149, vcc row_ror:8 row_mask:0xf bank_mask:0xf
    v_smfmac_f32_16x16x64_bf16 v[164:167], a[220:223], v[204:211], v36 abid:1
    s_add_u32 m0, m0, 896
    v_cndmask_b32_dpp v146, v142, v150, vcc row_ror:8 row_mask:0xf bank_mask:0xf
    v_smfmac_f32_16x16x64_bf16 v[168:171], a[188:191], v[196:203], v33
    s_waitcnt vmcnt(6)
    buffer_load_dwordx4 v5, s[8:11], s88 offen offset:384 nt lds
    v_cndmask_b32_dpp v147, v143, v151, vcc row_ror:8 row_mask:0xf bank_mask:0xf
    v_smfmac_f32_16x16x64_bf16 v[168:171], a[224:227], v[204:211], v37
    s_waitcnt vmcnt(6)
    buffer_store_dwordx4 v[144:147], v6, s[12:15], s59 offen offset:128 sc1
    v_mov_b32_dpp v140, v148 row_ror:8 row_mask:0xf bank_mask:0xc
    v_smfmac_f32_16x16x64_bf16 v[172:175], a[192:195], v[196:203], v33 abid:1
    v_mov_b32_dpp v141, v149 row_ror:8 row_mask:0xf bank_mask:0xc
    v_smfmac_f32_16x16x64_bf16 v[172:175], a[228:231], v[204:211], v37 abid:1
    v_mov_b32_dpp v142, v150 row_ror:8 row_mask:0xf bank_mask:0xc
    v_smfmac_f32_16x16x64_bf16 v[176:179], a[196:199], v[196:203], v34
    v_mov_b32_dpp v143, v151 row_ror:8 row_mask:0xf bank_mask:0xc
    v_smfmac_f32_16x16x64_bf16 v[176:179], a[232:235], v[204:211], v38
    s_waitcnt vmcnt(6)
    buffer_store_dwordx4 v[140:143], v6, s[12:15], s24 offen offset:128 sc1
    ds_read_b128 v[144:147], v9 offset:10560
    v_smfmac_f32_16x16x64_bf16 v[180:183], a[200:203], v[196:203], v34 abid:1
    ds_read_b128 v[148:151], v9 offset:10624
    ds_read_b128 v[140:143], v9 offset:10496
    v_add_u32 v4, s31, v4
    v_smfmac_f32_16x16x64_bf16 v[180:183], a[236:239], v[204:211], v38 abid:1
    v_add_u32 v1, s31, v1
    v_smfmac_f32_16x16x64_bf16 v[184:187], a[204:207], v[196:203], v35
    v_add_u32 v2, s31, v2
    v_smfmac_f32_16x16x64_bf16 v[184:187], a[240:243], v[204:211], v39
    v_smfmac_f32_16x16x64_bf16 v[188:191], a[208:211], v[196:203], v35 abid:1
    v_smfmac_f32_16x16x64_bf16 v[188:191], a[244:247], v[204:211], v39 abid:1
    v_smfmac_f32_16x16x64_bf16 v[192:195], a[212:215], v[196:203], v50 abid:1
    v_smfmac_f32_16x16x64_bf16 v[192:195], a[248:251], v[204:211], v51
    s_branch M_top
M_bF:
    v_smfmac_f32_16x16x64_bf16 v[164:167], v[56:59], v[220:227], v40 abid:1
    ds_read_b128 v[204:207], v1 offset:1024
    v_smfmac_f32_16x16x64_bf16 v[164:167], v[92:95], v[228:235], v44 abid:1
    ds_read_b128 v[208:211], v2 offset:1024
    v_smfmac_f32_16x16x64_bf16 v[168:171], v[60:63], v[220:227], v41
    ds_read_b128 v[212:215], v1 offset:2048
    v_smfmac_f32_16x16x64_bf16 v[168:171], v[96:99], v[228:235], v45
    ds_read_b128 v[216:219], v2 offset:2048
    v_smfmac_f32_16x16x64_bf16 v[172:175], v[64:67], v[220:227], v41 abid:1
    s_waitcnt lgkmcnt(6)
    buffer_store_dwordx4 v[244:247], v7, s[12:15], s66 offen sc1
    v_smfmac_f32_16x16x64_bf16 v[172:175], v[100:103], v[228:235], v45 abid:1
    ds_read_b128 v[236:239], v9 offset:9408
    v_smfmac_f32_16x16x64_bf16 v[176:179], v[68:71], v[220:227], v42
    s_mov_b32 s21, 3
    v_smfmac_f32_16x16x64_bf16 v[176:179], v[104:107], v[228:235], v46
    v_smfmac_f32_16x16x64_bf16 v[180:183], v[72:75], v[220:227], v42 abid:1
    v_cvt_pk_bf16_f32 v160, v160, v161
    v_smfmac_f32_16x16x64_bf16 v[180:183], v[108:111], v[228:235], v46 abid:1
    v_cvt_pk_bf16_f32 v161, v162, v163
    v_smfmac_f32_16x16x64_bf16 v[184:187], v[76:79], v[220:227], v43
    v_cvt_pk_bf16_f32 v162, v164, v165
    v_smfmac_f32_16x16x64_bf16 v[184:187], v[112:115], v[228:235], v47
    v_cvt_pk_bf16_f32 v163, v166, v167
    v_smfmac_f32_16x16x64_bf16 v[188:191], v[80:83], v[220:227], v43 abid:1
    v_cvt_pk_bf16_f32 v168, v168, v169
    v_smfmac_f32_16x16x64_bf16 v[188:191], v[116:119], v[228:235], v47 abid:1
    v_cvt_pk_bf16_f32 v169, v170, v171
    v_smfmac_f32_16x16x64_bf16 v[192:195], v[84:87], v[220:227], v51 abid:1
    v_cvt_pk_bf16_f32 v170, v172, v173
    v_smfmac_f32_16x16x64_bf16 v[192:195], v[120:123], v[228:235], v52
    ds_read_b128 v[220:223], v1 offset:3072
    s_waitcnt lgkmcnt(6)
    v_cvt_pk_bf16_f32 v171, v174, v175
    v_smfmac_f32_16x16x64_bf16 v[124:127], a[0:3], v[196:203], v12
    ds_read_b128 v[224:227], v2 offset:3072
    ds_read_b128 v[172:175], v9 offset:10432
    s_waitcnt lgkmcnt(6)
    v_cndmask_b32_dpp v164, v160, v168, vcc row_ror:8 row_mask:0xf bank_mask:0xf
    v_smfmac_f32_16x16x64_bf16 v[124:127], a[36:39], v[204:211], v16
    ds_read_b128 v[228:231], v1 offset:4096
    s_waitcnt lgkmcnt(5)
    v_cndmask_b32_dpp v165, v161, v169, vcc row_ror:8 row_mask:0xf bank_mask:0xf
    v_smfmac_f32_16x16x64_bf16 v[124:127], a[72:75], v[212:219], v20
    ds_read_b128 v[232:235], v2 offset:4096
    s_waitcnt lgkmcnt(5)
    v_xad_u32 v236, v236, v3, v4
    v_smfmac_f32_16x16x64_bf16 v[128:131], a[4:7], v[196:203], v12 abid:1
    s_barrier
    v_xad_u32 v237, v237, v3, v4
    v_smfmac_f32_16x16x64_bf16 v[128:131], a[40:43], v[204:211], v16 abid:1
    ds_read2st64_b32 v[244:245], v236 offset0:0 offset1:72
    ds_read_b128 v[240:243], v8 offset:3072
    v_xad_u32 v238, v238, v3, v4
    v_smfmac_f32_16x16x64_bf16 v[128:131], a[76:79], v[212:219], v20 abid:1
    ds_read2st64_b32 v[246:247], v237 offset0:0 offset1:72
    v_xad_u32 v239, v239, v3, v4
    v_smfmac_f32_16x16x64_bf16 v[132:135], a[8:11], v[196:203], v13
    ds_read2st64_b32 v[248:249], v238 offset0:0 offset1:72
    v_cndmask_b32_dpp v166, v162, v170, vcc row_ror:8 row_mask:0xf bank_mask:0xf
    v_smfmac_f32_16x16x64_bf16 v[132:135], a[44:47], v[204:211], v17
    ds_read2st64_b32 v[250:251], v239 offset0:0 offset1:72
    ds_read_b128 v[236:239], v9 offset:9280
    v_cndmask_b32_dpp v167, v163, v171, vcc row_ror:8 row_mask:0xf bank_mask:0xf
    v_smfmac_f32_16x16x64_bf16 v[132:135], a[80:83], v[212:219], v21
    buffer_store_dwordx4 v[164:167], v6, s[12:15], s58 offen offset:0 sc1
    v_mov_b32_dpp v160, v168 row_ror:8 row_mask:0xf bank_mask:0xc
    v_smfmac_f32_16x16x64_bf16 v[136:139], a[12:15], v[196:203], v13 abid:1
    v_mov_b32_dpp v161, v169 row_ror:8 row_mask:0xf bank_mask:0xc
    v_smfmac_f32_16x16x64_bf16 v[136:139], a[48:51], v[204:211], v17 abid:1
    v_mov_b32_dpp v162, v170 row_ror:8 row_mask:0xf bank_mask:0xc
    v_smfmac_f32_16x16x64_bf16 v[136:139], a[84:87], v[212:219], v21 abid:1
    v_mov_b32_dpp v163, v171 row_ror:8 row_mask:0xf bank_mask:0xc
    v_smfmac_f32_16x16x64_bf16 v[140:143], a[16:19], v[196:203], v14
    buffer_store_dwordx4 v[160:163], v6, s[12:15], s23 offen offset:0 sc1
    ds_read_b128 v[164:167], v9 offset:10304
    ds_read_b128 v[168:171], v9 offset:10368
    v_smfmac_f32_16x16x64_bf16 v[140:143], a[52:55], v[204:211], v18
    ds_read_b128 v[160:163], v9 offset:10240
    v_smfmac_f32_16x16x64_bf16 v[140:143], a[88:91], v[212:219], v22
    s_waitcnt lgkmcnt(3)
    v_xad_u32 v236, v236, v3, v4
    v_smfmac_f32_16x16x64_bf16 v[136:139], v[240:243], v[244:251], v10
    v_xad_u32 v237, v237, v3, v4
    v_smfmac_f32_16x16x64_bf16 v[172:175], v[240:243], v[244:251], v10 abid:1
    ds_read2st64_b32 v[244:245], v236 offset0:0 offset1:72
    ds_read_b128 v[240:243], v8 offset:1024
    v_xad_u32 v238, v238, v3, v4
    v_smfmac_f32_16x16x64_bf16 v[144:147], a[20:23], v[196:203], v14 abid:1
    ds_read2st64_b32 v[246:247], v237 offset0:0 offset1:72
    v_xad_u32 v239, v239, v3, v4
    v_smfmac_f32_16x16x64_bf16 v[144:147], a[56:59], v[204:211], v18 abid:1
    ds_read2st64_b32 v[248:249], v238 offset0:0 offset1:72
    v_smfmac_f32_16x16x64_bf16 v[144:147], a[92:95], v[212:219], v22 abid:1
    ds_read2st64_b32 v[250:251], v239 offset0:0 offset1:72
    ds_read_b128 v[236:239], v9 offset:9344
    v_smfmac_f32_16x16x64_bf16 v[148:151], a[24:27], v[196:203], v15
    v_cvt_pk_bf16_f32 v192, v192, v193
    v_smfmac_f32_16x16x64_bf16 v[148:151], a[60:63], v[204:211], v19
    v_cvt_pk_bf16_f32 v193, v194, v195
    v_smfmac_f32_16x16x64_bf16 v[148:151], a[96:99], v[212:219], v23
    ds_write_b64 v252, v[192:193] offset:0
    ds_read_b128 v[192:195], v9 offset:10752
    v_smfmac_f32_16x16x64_bf16 v[152:155], a[28:31], v[196:203], v15 abid:1
    v_smfmac_f32_16x16x64_bf16 v[152:155], a[64:67], v[204:211], v19 abid:1
    v_smfmac_f32_16x16x64_bf16 v[152:155], a[100:103], v[212:219], v23 abid:1
    v_smfmac_f32_16x16x64_bf16 v[156:159], a[32:35], v[196:203], v48
    v_smfmac_f32_16x16x64_bf16 v[156:159], a[68:71], v[204:211], v48 abid:1
    v_smfmac_f32_16x16x64_bf16 v[156:159], a[104:107], v[212:219], v49
    s_waitcnt lgkmcnt(2)
    v_xad_u32 v236, v236, v3, v4
    v_smfmac_f32_16x16x64_bf16 v[128:131], v[240:243], v[244:251], v10
    ds_read_b128 v[196:199], v1 offset:5120
    v_xad_u32 v237, v237, v3, v4
    v_smfmac_f32_16x16x64_bf16 v[164:167], v[240:243], v[244:251], v10 abid:1
    ds_read2st64_b32 v[244:245], v236 offset0:0 offset1:72
    ds_read_b128 v[240:243], v8 offset:2048
    v_xad_u32 v238, v238, v3, v4
    v_smfmac_f32_16x16x64_bf16 v[124:127], a[108:111], v[220:227], v24
    ds_read2st64_b32 v[246:247], v237 offset0:0 offset1:72
    v_xad_u32 v239, v239, v3, v4
    v_smfmac_f32_16x16x64_bf16 v[124:127], a[144:147], v[228:235], v28
    ds_read2st64_b32 v[248:249], v238 offset0:0 offset1:72
    ds_read_b128 v[200:203], v2 offset:5120
    v_cvt_pk_bf16_f32 v176, v176, v177
    v_smfmac_f32_16x16x64_bf16 v[128:131], a[112:115], v[220:227], v24 abid:1
    ds_read2st64_b32 v[250:251], v239 offset0:0 offset1:72
    ds_read_b128 v[236:239], v9 offset:9216
    v_cvt_pk_bf16_f32 v177, v178, v179
    v_smfmac_f32_16x16x64_bf16 v[128:131], a[148:151], v[228:235], v28 abid:1
    ds_read_b128 v[204:207], v1 offset:6144
    ds_read_b128 v[216:219], v9 offset:9792
    v_cvt_pk_bf16_f32 v178, v180, v181
    v_smfmac_f32_16x16x64_bf16 v[132:135], a[116:119], v[220:227], v25
    ds_read_b128 v[208:211], v2 offset:6144
    v_cvt_pk_bf16_f32 v179, v182, v183
    v_smfmac_f32_16x16x64_bf16 v[132:135], a[152:155], v[228:235], v29
    v_cvt_pk_bf16_f32 v184, v184, v185
    v_smfmac_f32_16x16x64_bf16 v[136:139], a[120:123], v[220:227], v25 abid:1
    v_cvt_pk_bf16_f32 v185, v186, v187
    v_smfmac_f32_16x16x64_bf16 v[136:139], a[156:159], v[228:235], v29 abid:1
    v_cvt_pk_bf16_f32 v186, v188, v189
    v_smfmac_f32_16x16x64_bf16 v[140:143], a[124:127], v[220:227], v26
    v_cvt_pk_bf16_f32 v187, v190, v191
    v_smfmac_f32_16x16x64_bf16 v[140:143], a[160:163], v[228:235], v30
    ds_read_b128 v[188:191], v9 offset:10688
    s_waitcnt lgkmcnt(4)
    v_xad_u32 v236, v236, v3, v4
    v_smfmac_f32_16x16x64_bf16 v[132:135], v[240:243], v[244:251], v10
    v_xad_u32 v237, v237, v3, v4
    v_smfmac_f32_16x16x64_bf16 v[168:171], v[240:243], v[244:251], v10 abid:1
    ds_read2st64_b32 v[244:245], v236 offset0:0 offset1:72
    ds_read_b128 v[240:243], v8 offset:0
    v_xad_u32 v238, v238, v3, v4
    v_smfmac_f32_16x16x64_bf16 v[144:147], a[128:131], v[220:227], v26 abid:1
    ds_read2st64_b32 v[246:247], v237 offset0:0 offset1:72
    v_xad_u32 v239, v239, v3, v4
    v_smfmac_f32_16x16x64_bf16 v[144:147], a[164:167], v[228:235], v30 abid:1
    ds_read2st64_b32 v[248:249], v238 offset0:0 offset1:72
    v_cndmask_b32_dpp v180, v176, v184, vcc row_ror:8 row_mask:0xf bank_mask:0xf
    v_smfmac_f32_16x16x64_bf16 v[148:151], a[132:135], v[220:227], v27
    ds_read2st64_b32 v[250:251], v239 offset0:0 offset1:72
    ds_read_b128 v[236:239], v9 offset:9728
    v_cndmask_b32_dpp v181, v177, v185, vcc row_ror:8 row_mask:0xf bank_mask:0xf
    v_smfmac_f32_16x16x64_bf16 v[148:151], a[168:171], v[228:235], v31
    v_cndmask_b32_dpp v182, v178, v186, vcc row_ror:8 row_mask:0xf bank_mask:0xf
    v_smfmac_f32_16x16x64_bf16 v[152:155], a[136:139], v[220:227], v27 abid:1
    v_cndmask_b32_dpp v183, v179, v187, vcc row_ror:8 row_mask:0xf bank_mask:0xf
    v_smfmac_f32_16x16x64_bf16 v[152:155], a[172:175], v[228:235], v31 abid:1
    buffer_store_dwordx4 v[180:183], v6, s[12:15], s58 offen offset:128 sc1
    v_mov_b32_dpp v176, v184 row_ror:8 row_mask:0xf bank_mask:0xc
    v_smfmac_f32_16x16x64_bf16 v[156:159], a[140:143], v[220:227], v49 abid:1
    v_mov_b32_dpp v177, v185 row_ror:8 row_mask:0xf bank_mask:0xc
    v_smfmac_f32_16x16x64_bf16 v[156:159], a[176:179], v[228:235], v50
    ds_read_b128 v[220:223], v1 offset:7168
    v_mov_b32_dpp v178, v186 row_ror:8 row_mask:0xf bank_mask:0xc
    v_smfmac_f32_16x16x64_bf16 v[124:127], a[180:183], v[196:203], v32
    ds_read_b128 v[224:227], v2 offset:7168
    s_waitcnt lgkmcnt(9)
    v_mov_b32_dpp v179, v187 row_ror:8 row_mask:0xf bank_mask:0xc
    v_smfmac_f32_16x16x64_bf16 v[124:127], a[216:219], v[204:211], v36
    ds_read_b128 v[228:231], v1 offset:8192
    buffer_store_dwordx4 v[176:179], v6, s[12:15], s23 offen offset:128 sc1
    ds_read_b128 v[180:183], v9 offset:10560
    v_smfmac_f32_16x16x64_bf16 v[128:131], a[184:187], v[196:203], v32 abid:1
    ds_read_b128 v[232:235], v2 offset:8192
    ds_read_b128 v[184:187], v9 offset:10624
    ds_read_b128 v[176:179], v9 offset:10496
    v_smfmac_f32_16x16x64_bf16 v[128:131], a[220:223], v[204:211], v36 abid:1
    s_waitcnt lgkmcnt(7)
    v_xad_u32 v236, v236, v3, v4
    v_smfmac_f32_16x16x64_bf16 v[124:127], v[240:243], v[244:251], v10
    v_xad_u32 v237, v237, v3, v4
    v_smfmac_f32_16x16x64_bf16 v[160:163], v[240:243], v[244:251], v10 abid:1
    ds_read2st64_b32 v[244:245], v236 offset0:0 offset1:72
    ds_read_b128 v[240:243], v8 offset:8192
    v_xad_u32 v238, v238, v3, v4
    v_smfmac_f32_16x16x64_bf16 v[132:135], a[188:191], v[196:203], v33
    ds_read2st64_b32 v[246:247], v237 offset0:0 offset1:72
    v_xad_u32 v239, v239, v3, v4
    v_smfmac_f32_16x16x64_bf16 v[132:135], a[224:227], v[204:211], v37
    ds_read2st64_b32 v[248:249], v238 offset0:0 offset1:72
    v_and_b32 v212, 0x3fff, v216
    v_smfmac_f32_16x16x64_bf16 v[136:139], a[192:195], v[196:203], v33 abid:1
    ds_read2st64_b32 v[250:251], v239 offset0:0 offset1:72
    ds_read_b128 v[236:239], v9 offset:9664
    v_and_b32 v214, 0x3fff, v218
    v_smfmac_f32_16x16x64_bf16 v[136:139], a[228:231], v[204:211], v37 abid:1
    v_xad_u32 v212, v212, v3, v4
    v_smfmac_f32_16x16x64_bf16 v[140:143], a[196:199], v[196:203], v34
    ds_read2st64_b32 v[212:213], v212 offset0:0 offset1:72
    v_xad_u32 v214, v214, v3, v4
    v_smfmac_f32_16x16x64_bf16 v[140:143], a[232:235], v[204:211], v38
    ds_read2st64_b32 v[214:215], v214 offset0:0 offset1:72
    v_smfmac_f32_16x16x64_bf16 v[144:147], a[200:203], v[196:203], v34 abid:1
    v_smfmac_f32_16x16x64_bf16 v[144:147], a[236:239], v[204:211], v38 abid:1
    v_smfmac_f32_16x16x64_bf16 v[148:151], a[204:207], v[196:203], v35
    v_smfmac_f32_16x16x64_bf16 v[148:151], a[240:243], v[204:211], v39
    s_waitcnt lgkmcnt(2)
    v_xad_u32 v236, v236, v3, v4
    v_smfmac_f32_16x16x64_bf16 v[156:159], v[240:243], v[244:251], v10
    s_and_b32 s30, s27, 7
    s_waitcnt lgkmcnt(0)
    s_cbranch_scc1 M_ov0
M_ovr0F:
    v_xad_u32 v237, v237, v3, v4
    v_smfmac_f32_16x16x64_bf16 v[192:195], v[240:243], v[244:251], v10 abid:1
    ds_read2st64_b32 v[244:245], v236 offset0:0 offset1:72
    ds_read_b128 v[240:243], v8 offset:7168
    v_xad_u32 v238, v238, v3, v4
    v_smfmac_f32_16x16x64_bf16 v[152:155], a[208:211], v[196:203], v35 abid:1
    ds_read2st64_b32 v[246:247], v237 offset0:0 offset1:72
    v_xad_u32 v239, v239, v3, v4
    v_smfmac_f32_16x16x64_bf16 v[152:155], a[244:247], v[204:211], v39 abid:1
    ds_read2st64_b32 v[248:249], v238 offset0:0 offset1:72
    s_and_b32 s30, s27, 56
    s_cbranch_scc1 M_ov1
M_ovr1F:
    v_smfmac_f32_16x16x64_bf16 v[156:159], a[212:215], v[196:203], v50 abid:1
    ds_read2st64_b32 v[250:251], v239 offset0:0 offset1:72
    ds_read_b128 v[236:239], v9 offset:9536
    v_smfmac_f32_16x16x64_bf16 v[156:159], a[248:251], v[204:211], v51
    ds_read_b128 v[196:199], v1 offset:18432
    s_and_b32 s30, s27, 448
    s_cbranch_scc1 M_ov2
M_ovr2F:
    v_smfmac_f32_16x16x64_bf16 v[124:127], a[252:255], v[220:227], v40
    ds_read_b128 v[200:203], v2 offset:18432
    v_smfmac_f32_16x16x64_bf16 v[124:127], v[88:91], v[228:235], v44
    ds_read_b128 v[204:207], v1 offset:19456
    v_smfmac_f32_16x16x64_bf16 v[128:131], v[56:59], v[220:227], v40 abid:1
    ds_read_b128 v[208:211], v2 offset:19456
    v_smfmac_f32_16x16x64_bf16 v[128:131], v[92:95], v[228:235], v44 abid:1
    s_cmp_lt_u32 s20, 2
    s_cselect_b32 s66, s23, s24
    s_add_u32 s66, s66, s95
    v_smfmac_f32_16x16x64_bf16 v[132:135], v[60:63], v[220:227], v41
    s_add_u32 s23, s24, 18432
    s_add_u32 s58, s24, 27648
    s_add_u32 s67, s23, s95
    v_smfmac_f32_16x16x64_bf16 v[132:135], v[96:99], v[228:235], v45
    v_smfmac_f32_16x16x64_bf16 v[136:139], v[64:67], v[220:227], v41 abid:1
    v_smfmac_f32_16x16x64_bf16 v[136:139], v[100:103], v[228:235], v45 abid:1
    s_waitcnt lgkmcnt(4)
    v_xad_u32 v236, v236, v3, v4
    v_smfmac_f32_16x16x64_bf16 v[152:155], v[240:243], v[244:251], v10
    v_xad_u32 v237, v237, v3, v4
    v_smfmac_f32_16x16x64_bf16 v[188:191], v[240:243], v[244:251], v10 abid:1
    s_cmp_gt_u32 s46, 1
    s_cbranch_scc1 M_slow
M_slowrF:
    v_xad_u32 v238, v238, v3, v4
    v_smfmac_f32_16x16x64_bf16 v[140:143], v[68:71], v[220:227], v42
    ds_read2st64_b32 v[244:245], v236 offset0:0 offset1:72
    ds_read_b128 v[240:243], v8 offset:5120
    v_xad_u32 v239, v239, v3, v4
    v_smfmac_f32_16x16x64_bf16 v[140:143], v[104:107], v[228:235], v46
    ds_read2st64_b32 v[246:247], v237 offset0:0 offset1:72
    v_smfmac_f32_16x16x64_bf16 v[144:147], v[72:75], v[220:227], v42 abid:1
    ds_read2st64_b32 v[248:249], v238 offset0:0 offset1:72
    ds_read_b128 v[212:215], v1 offset:20480
    v_smfmac_f32_16x16x64_bf16 v[144:147], v[108:111], v[228:235], v46 abid:1
    ds_read2st64_b32 v[250:251], v239 offset0:0 offset1:72
    ds_read_b128 v[236:239], v9 offset:9600
    v_smfmac_f32_16x16x64_bf16 v[148:151], v[76:79], v[220:227], v43
    ds_read_b128 v[216:219], v2 offset:20480
    v_smfmac_f32_16x16x64_bf16 v[148:151], v[112:115], v[228:235], v47
    v_smfmac_f32_16x16x64_bf16 v[152:155], v[80:83], v[220:227], v43 abid:1
    v_smfmac_f32_16x16x64_bf16 v[152:155], v[116:119], v[228:235], v47 abid:1
    v_smfmac_f32_16x16x64_bf16 v[156:159], v[84:87], v[220:227], v51 abid:1
    v_smfmac_f32_16x16x64_bf16 v[156:159], v[120:123], v[228:235], v52
    ds_read_b128 v[220:223], v1 offset:21504
    s_waitcnt lgkmcnt(2)
    v_xad_u32 v236, v236, v3, v4
    v_smfmac_f32_16x16x64_bf16 v[144:147], v[240:243], v[244:251], v10
    ds_read_b128 v[224:227], v2 offset:21504
    v_xad_u32 v237, v237, v3, v4
    v_smfmac_f32_16x16x64_bf16 v[180:183], v[240:243], v[244:251], v10 abid:1
    ds_read2st64_b32 v[244:245], v236 offset0:0 offset1:72
    ds_read_b128 v[240:243], v8 offset:6144
    v_xad_u32 v238, v238, v3, v4
    v_smfmac_f32_16x16x64_bf16 v[192:195], a[32:35], v[196:203], v48
    ds_read2st64_b32 v[246:247], v237 offset0:0 offset1:72
    ds_read_b128 v[228:231], v1 offset:22528
    v_xad_u32 v239, v239, v3, v4
    v_smfmac_f32_16x16x64_bf16 v[192:195], a[68:71], v[204:211], v48 abid:1
    ds_read2st64_b32 v[248:249], v238 offset0:0 offset1:72
    ds_read_b128 v[232:235], v2 offset:22528
    s_waitcnt lgkmcnt(8)
    v_cvt_pk_bf16_f32 v124, v124, v125
    v_smfmac_f32_16x16x64_bf16 v[192:195], a[104:107], v[212:219], v49
    ds_read2st64_b32 v[250:251], v239 offset0:0 offset1:72
    ds_read_b128 v[236:239], v9 offset:9472
    v_cvt_pk_bf16_f32 v125, v126, v127
    v_smfmac_f32_16x16x64_bf16 v[160:163], a[0:3], v[196:203], v12
    v_cvt_pk_bf16_f32 v126, v128, v129
    v_smfmac_f32_16x16x64_bf16 v[160:163], a[36:39], v[204:211], v16
    v_cvt_pk_bf16_f32 v127, v130, v131
    v_smfmac_f32_16x16x64_bf16 v[160:163], a[72:75], v[212:219], v20
    v_cvt_pk_bf16_f32 v156, v156, v157
    v_smfmac_f32_16x16x64_bf16 v[164:167], a[4:7], v[196:203], v12 abid:1
    v_cvt_pk_bf16_f32 v157, v158, v159
    v_smfmac_f32_16x16x64_bf16 v[164:167], a[40:43], v[204:211], v16 abid:1
    ds_write_b64 v252, v[156:157] offset:25728
    v_cvt_pk_bf16_f32 v132, v132, v133
    v_smfmac_f32_16x16x64_bf16 v[164:167], a[76:79], v[212:219], v20 abid:1
    v_cvt_pk_bf16_f32 v133, v134, v135
    v_smfmac_f32_16x16x64_bf16 v[168:171], a[8:11], v[196:203], v13
    v_cvt_pk_bf16_f32 v134, v136, v137
    v_smfmac_f32_16x16x64_bf16 v[168:171], a[44:47], v[204:211], v17
    v_cvt_pk_bf16_f32 v135, v138, v139
    v_smfmac_f32_16x16x64_bf16 v[168:171], a[80:83], v[212:219], v21
    s_waitcnt lgkmcnt(1)
    v_xad_u32 v236, v236, v3, v4
    v_smfmac_f32_16x16x64_bf16 v[148:151], v[240:243], v[244:251], v10
    v_xad_u32 v237, v237, v3, v4
    v_smfmac_f32_16x16x64_bf16 v[184:187], v[240:243], v[244:251], v10 abid:1
    ds_read2st64_b32 v[244:245], v236 offset0:0 offset1:72
    ds_read_b128 v[240:243], v8 offset:4096
    v_xad_u32 v238, v238, v3, v4
    v_smfmac_f32_16x16x64_bf16 v[172:175], a[12:15], v[196:203], v13 abid:1
    ds_read2st64_b32 v[246:247], v237 offset0:0 offset1:72
    v_xad_u32 v239, v239, v3, v4
    v_smfmac_f32_16x16x64_bf16 v[172:175], a[48:51], v[204:211], v17 abid:1
    ds_read2st64_b32 v[248:249], v238 offset0:0 offset1:72
    v_cndmask_b32_dpp v128, v124, v132, vcc row_ror:8 row_mask:0xf bank_mask:0xf
    v_smfmac_f32_16x16x64_bf16 v[172:175], a[84:87], v[212:219], v21 abid:1
    ds_read2st64_b32 v[250:251], v239 offset0:0 offset1:72
    ds_read_b128 v[196:199], v1 offset:23552
    v_cndmask_b32_dpp v129, v125, v133, vcc row_ror:8 row_mask:0xf bank_mask:0xf
    v_smfmac_f32_16x16x64_bf16 v[192:195], a[140:143], v[220:227], v49 abid:1
    ds_read_b128 v[200:203], v2 offset:23552
    v_cndmask_b32_dpp v130, v126, v134, vcc row_ror:8 row_mask:0xf bank_mask:0xf
    v_smfmac_f32_16x16x64_bf16 v[192:195], a[176:179], v[228:235], v50
    ds_read_b128 v[204:207], v1 offset:24576
    v_cndmask_b32_dpp v131, v127, v135, vcc row_ror:8 row_mask:0xf bank_mask:0xf
    v_smfmac_f32_16x16x64_bf16 v[160:163], a[108:111], v[220:227], v24
    ds_read_b128 v[208:211], v2 offset:24576
    buffer_store_dwordx4 v[128:131], v6, s[12:15], s59 offen offset:0 sc1
    v_mov_b32_dpp v124, v132 row_ror:8 row_mask:0xf bank_mask:0xc
    v_smfmac_f32_16x16x64_bf16 v[160:163], a[144:147], v[228:235], v28
    s_waitcnt lgkmcnt(9)
    s_barrier
    ds_read_b128 v[236:239], v8 offset:10816
    v_mov_b32_dpp v125, v133 row_ror:8 row_mask:0xf bank_mask:0xc
    v_smfmac_f32_16x16x64_bf16 v[164:167], a[112:115], v[220:227], v24 abid:1
    ds_read_b128 v[212:215], v1 offset:20480
    v_mov_b32_dpp v126, v134 row_ror:8 row_mask:0xf bank_mask:0xc
    v_smfmac_f32_16x16x64_bf16 v[164:167], a[148:151], v[228:235], v28 abid:1
    ds_read_b128 v[216:219], v2 offset:20480
    v_mov_b32_dpp v127, v135 row_ror:8 row_mask:0xf bank_mask:0xc
    v_smfmac_f32_16x16x64_bf16 v[168:171], a[116:119], v[220:227], v25
    buffer_store_dwordx4 v[124:127], v6, s[12:15], s24 offen offset:0 sc1
    v_smfmac_f32_16x16x64_bf16 v[168:171], a[152:155], v[228:235], v29
    s_waitcnt lgkmcnt(7)
    v_smfmac_f32_16x16x64_bf16 v[140:143], v[240:243], v[244:251], v10
    v_smfmac_f32_16x16x64_bf16 v[176:179], v[240:243], v[244:251], v10 abid:1
    s_waitcnt lgkmcnt(2)
    buffer_store_dwordx4 v[236:239], v7, s[12:15], s66 offen sc1
    v_smfmac_f32_16x16x64_bf16 v[172:175], a[120:123], v[220:227], v25 abid:1
    v_smfmac_f32_16x16x64_bf16 v[172:175], a[156:159], v[228:235], v29 abid:1
    ds_read_b128 v[220:223], v1 offset:25600
    v_smfmac_f32_16x16x64_bf16 v[192:195], a[212:215], v[196:203], v50 abid:1
    ds_read_b128 v[224:227], v2 offset:25600
    v_cvt_pk_bf16_f32 v140, v140, v141
    v_smfmac_f32_16x16x64_bf16 v[192:195], a[248:251], v[204:211], v51
    ds_read_b128 v[228:231], v1 offset:26624
    v_cvt_pk_bf16_f32 v141, v142, v143
    v_smfmac_f32_16x16x64_bf16 v[160:163], a[180:183], v[196:203], v32
    ds_read_b128 v[232:235], v2 offset:26624
    v_cvt_pk_bf16_f32 v142, v144, v145
    v_smfmac_f32_16x16x64_bf16 v[160:163], a[216:219], v[204:211], v36
    v_cvt_pk_bf16_f32 v143, v146, v147
    v_smfmac_f32_16x16x64_bf16 v[164:167], a[184:187], v[196:203], v32 abid:1
    v_cvt_pk_bf16_f32 v148, v148, v149
    v_smfmac_f32_16x16x64_bf16 v[164:167], a[220:223], v[204:211], v36 abid:1
    v_cvt_pk_bf16_f32 v149, v150, v151
    v_smfmac_f32_16x16x64_bf16 v[168:171], a[188:191], v[196:203], v33
    v_cvt_pk_bf16_f32 v150, v152, v153
    v_smfmac_f32_16x16x64_bf16 v[168:171], a[224:227], v[204:211], v37
    v_cvt_pk_bf16_f32 v151, v154, v155
    v_smfmac_f32_16x16x64_bf16 v[172:175], a[192:195], v[196:203], v33 abid:1
    v_cndmask_b32_dpp v144, v140, v148, vcc row_ror:8 row_mask:0xf bank_mask:0xf
    v_smfmac_f32_16x16x64_bf16 v[172:175], a[228:231], v[204:211], v37 abid:1
    ds_read_b128 v[196:199], v1 offset:18432
    s_waitcnt lgkmcnt(3)
    v_cndmask_b32_dpp v145, v141, v149, vcc row_ror:8 row_mask:0xf bank_mask:0xf
    v_smfmac_f32_16x16x64_bf16 v[192:195], v[84:87], v[220:227], v51 abid:1
    ds_read_b128 v[200:203], v2 offset:18432
    s_waitcnt lgkmcnt(2)
    v_cndmask_b32_dpp v146, v142, v150, vcc row_ror:8 row_mask:0xf bank_mask:0xf
    v_smfmac_f32_16x16x64_bf16 v[192:195], v[120:123], v[228:235], v52
    ds_read_b128 v[204:207], v1 offset:19456
    v_cndmask_b32_dpp v147, v143, v151, vcc row_ror:8 row_mask:0xf bank_mask:0xf
    v_smfmac_f32_16x16x64_bf16 v[160:163], a[252:255], v[220:227], v40
    ds_read_b128 v[208:211], v2 offset:19456
    buffer_store_dwordx4 v[144:147], v6, s[12:15], s59 offen offset:128 sc1
    v_mov_b32_dpp v140, v148 row_ror:8 row_mask:0xf bank_mask:0xc
    v_smfmac_f32_16x16x64_bf16 v[160:163], v[88:91], v[228:235], v44
    v_mov_b32_dpp v141, v149 row_ror:8 row_mask:0xf bank_mask:0xc
    v_smfmac_f32_16x16x64_bf16 v[164:167], v[56:59], v[220:227], v40 abid:1
    v_mov_b32_dpp v142, v150 row_ror:8 row_mask:0xf bank_mask:0xc
    v_smfmac_f32_16x16x64_bf16 v[164:167], v[92:95], v[228:235], v44 abid:1
    v_mov_b32_dpp v143, v151 row_ror:8 row_mask:0xf bank_mask:0xc
    v_smfmac_f32_16x16x64_bf16 v[168:171], v[60:63], v[220:227], v41
    buffer_store_dwordx4 v[140:143], v6, s[12:15], s24 offen offset:128 sc1
    v_cvt_pk_bf16_f32 v192, v192, v193
    v_smfmac_f32_16x16x64_bf16 v[168:171], v[96:99], v[228:235], v45
    v_cvt_pk_bf16_f32 v193, v194, v195
    v_smfmac_f32_16x16x64_bf16 v[172:175], v[64:67], v[220:227], v41 abid:1
    ds_write_b64 v252, v[192:193] offset:1024
    v_smfmac_f32_16x16x64_bf16 v[172:175], v[100:103], v[228:235], v45 abid:1
    ds_read_b128 v[220:223], v1 offset:21504
    s_waitcnt lgkmcnt(4)
    v_smfmac_f32_16x16x64_bf16 v[176:179], a[16:19], v[196:203], v14
    ds_read_b128 v[224:227], v2 offset:21504
    s_waitcnt lgkmcnt(3)
    v_smfmac_f32_16x16x64_bf16 v[176:179], a[52:55], v[204:211], v18
    ds_read_b128 v[228:231], v1 offset:22528
    v_smfmac_f32_16x16x64_bf16 v[176:179], a[88:91], v[212:219], v22
    ds_read_b128 v[232:235], v2 offset:22528
    s_waitcnt lgkmcnt(4)
    s_barrier
    ds_read_b128 v[236:239], v8 offset:11840
    v_smfmac_f32_16x16x64_bf16 v[180:183], a[20:23], v[196:203], v14 abid:1
    v_cvt_pk_bf16_f32 v160, v160, v161
    v_smfmac_f32_16x16x64_bf16 v[180:183], a[56:59], v[204:211], v18 abid:1
    v_cvt_pk_bf16_f32 v161, v162, v163
    v_smfmac_f32_16x16x64_bf16 v[180:183], a[92:95], v[212:219], v22 abid:1
    v_cvt_pk_bf16_f32 v162, v164, v165
    v_smfmac_f32_16x16x64_bf16 v[184:187], a[24:27], v[196:203], v15
    v_cvt_pk_bf16_f32 v163, v166, v167
    v_smfmac_f32_16x16x64_bf16 v[184:187], a[60:63], v[204:211], v19
    v_cvt_pk_bf16_f32 v168, v168, v169
    v_smfmac_f32_16x16x64_bf16 v[184:187], a[96:99], v[212:219], v23
    s_cmp_lt_u32 s20, 2
    s_waitcnt lgkmcnt(0)
    s_cbranch_scc0 M_fx
    buffer_store_dwordx4 v[236:239], v7, s[12:15], s67 offen sc1
M_fx:
    v_smfmac_f32_16x16x64_bf16 v[188:191], a[28:31], v[196:203], v15 abid:1
    v_cvt_pk_bf16_f32 v169, v170, v171
    v_smfmac_f32_16x16x64_bf16 v[188:191], a[64:67], v[204:211], v19 abid:1
    v_cvt_pk_bf16_f32 v170, v172, v173
    v_smfmac_f32_16x16x64_bf16 v[188:191], a[100:103], v[212:219], v23 abid:1
    ds_read_b128 v[196:199], v1 offset:23552
    v_cvt_pk_bf16_f32 v171, v174, v175
    v_smfmac_f32_16x16x64_bf16 v[176:179], a[124:127], v[220:227], v26
    ds_read_b128 v[200:203], v2 offset:23552
    v_cndmask_b32_dpp v164, v160, v168, vcc row_ror:8 row_mask:0xf bank_mask:0xf
    v_smfmac_f32_16x16x64_bf16 v[176:179], a[160:163], v[228:235], v30
    ds_read_b128 v[204:207], v1 offset:24576
    v_cndmask_b32_dpp v165, v161, v169, vcc row_ror:8 row_mask:0xf bank_mask:0xf
    v_smfmac_f32_16x16x64_bf16 v[180:183], a[128:131], v[220:227], v26 abid:1
    ds_read_b128 v[208:211], v2 offset:24576
    v_cndmask_b32_dpp v166, v162, v170, vcc row_ror:8 row_mask:0xf bank_mask:0xf
    v_smfmac_f32_16x16x64_bf16 v[180:183], a[164:167], v[228:235], v30 abid:1
    v_cndmask_b32_dpp v167, v163, v171, vcc row_ror:8 row_mask:0xf bank_mask:0xf
    v_smfmac_f32_16x16x64_bf16 v[184:187], a[132:135], v[220:227], v27
    buffer_store_dwordx4 v[164:167], v6, s[12:15], s58 offen offset:0 sc1
    v_mov_b32_dpp v160, v168 row_ror:8 row_mask:0xf bank_mask:0xc
    v_smfmac_f32_16x16x64_bf16 v[184:187], a[168:171], v[228:235], v31
    v_mov_b32_dpp v161, v169 row_ror:8 row_mask:0xf bank_mask:0xc
    v_smfmac_f32_16x16x64_bf16 v[188:191], a[136:139], v[220:227], v27 abid:1
    v_mov_b32_dpp v162, v170 row_ror:8 row_mask:0xf bank_mask:0xc
    v_smfmac_f32_16x16x64_bf16 v[188:191], a[172:175], v[228:235], v31 abid:1
    ds_read_b128 v[220:223], v1 offset:25600
    s_waitcnt lgkmcnt(3)
    v_mov_b32_dpp v163, v171 row_ror:8 row_mask:0xf bank_mask:0xc
    v_smfmac_f32_16x16x64_bf16 v[176:179], a[196:199], v[196:203], v34
    ds_read_b128 v[224:227], v2 offset:25600
    buffer_store_dwordx4 v[160:163], v6, s[12:15], s23 offen offset:0 sc1
    s_waitcnt lgkmcnt(2)
    v_smfmac_f32_16x16x64_bf16 v[176:179], a[232:235], v[204:211], v38
    ds_read_b128 v[228:231], v1 offset:26624
    v_smfmac_f32_16x16x64_bf16 v[180:183], a[200:203], v[196:203], v34 abid:1
    ds_read_b128 v[232:235], v2 offset:26624
    v_smfmac_f32_16x16x64_bf16 v[180:183], a[236:239], v[204:211], v38 abid:1
    v_smfmac_f32_16x16x64_bf16 v[184:187], a[204:207], v[196:203], v35
    v_smfmac_f32_16x16x64_bf16 v[184:187], a[240:243], v[204:211], v39
    v_smfmac_f32_16x16x64_bf16 v[188:191], a[208:211], v[196:203], v35 abid:1
    v_smfmac_f32_16x16x64_bf16 v[188:191], a[244:247], v[204:211], v39 abid:1
    s_waitcnt lgkmcnt(2)
    v_smfmac_f32_16x16x64_bf16 v[176:179], v[68:71], v[220:227], v42
    s_waitcnt lgkmcnt(0)
    v_smfmac_f32_16x16x64_bf16 v[176:179], v[104:107], v[228:235], v46
    v_smfmac_f32_16x16x64_bf16 v[180:183], v[72:75], v[220:227], v42 abid:1
    v_smfmac_f32_16x16x64_bf16 v[180:183], v[108:111], v[228:235], v46 abid:1
    v_smfmac_f32_16x16x64_bf16 v[184:187], v[76:79], v[220:227], v43
    v_smfmac_f32_16x16x64_bf16 v[184:187], v[112:115], v[228:235], v47
    v_smfmac_f32_16x16x64_bf16 v[188:191], v[80:83], v[220:227], v43 abid:1
    v_smfmac_f32_16x16x64_bf16 v[188:191], v[116:119], v[228:235], v47 abid:1
    s_nop 1
    v_cvt_pk_bf16_f32 v176, v176, v177
    v_cvt_pk_bf16_f32 v177, v178, v179
    v_cvt_pk_bf16_f32 v178, v180, v181
    v_cvt_pk_bf16_f32 v179, v182, v183
    v_cvt_pk_bf16_f32 v184, v184, v185
    v_cvt_pk_bf16_f32 v185, v186, v187
    v_cvt_pk_bf16_f32 v186, v188, v189
    v_cvt_pk_bf16_f32 v187, v190, v191
    v_cndmask_b32_dpp v180, v176, v184, vcc row_ror:8 row_mask:0xf bank_mask:0xf
    v_cndmask_b32_dpp v181, v177, v185, vcc row_ror:8 row_mask:0xf bank_mask:0xf
    v_cndmask_b32_dpp v182, v178, v186, vcc row_ror:8 row_mask:0xf bank_mask:0xf
    v_cndmask_b32_dpp v183, v179, v187, vcc row_ror:8 row_mask:0xf bank_mask:0xf
    buffer_store_dwordx4 v[180:183], v6, s[12:15], s58 offen offset:128 sc1
    v_mov_b32_dpp v176, v184 row_ror:8 row_mask:0xf bank_mask:0xc
    v_mov_b32_dpp v177, v185 row_ror:8 row_mask:0xf bank_mask:0xc
    v_mov_b32_dpp v178, v186 row_ror:8 row_mask:0xf bank_mask:0xc
    v_mov_b32_dpp v179, v187 row_ror:8 row_mask:0xf bank_mask:0xc
    buffer_store_dwordx4 v[176:179], v6, s[12:15], s23 offen offset:128 sc1
M_end:
    s_endpgm
M_pf_spin:
    s_sleep 1
    buffer_load_dword v0, off, s[16:19], s96 sc1
    s_add_u32 s31, s31, 1
    s_waitcnt vmcnt(0)
    v_readfirstlane_b32 s30, v0
    s_nop 0
    s_sub_u32 s30, s30, s100
    s_cmp_eq_u32 s30, 27
    s_cbranch_scc1 M_pf_ok
    s_cmp_lt_u32 s31, 24
    s_cbranch_scc1 M_pf_spin
    s_cmp_eq_u32 s98, 0
    s_cbranch_scc1 M_pf_spin2
    s_mov_b32 s98, 0
    v_mov_b32 v0, 1
    s_mov_b64 exec, 1
    buffer_atomic_add v0, off, s[68:71], 0 offset:0 sc1
    s_mov_b64 exec, -1
    s_nop 3
M_pf_spin2:
    s_sleep 16
    buffer_load_dword v0, off, s[68:71], 0 offset:0 sc1
    s_add_u32 s31, s31, 1
    s_cmp_ge_u32 s31, 131072
    s_cbranch_scc1 M_end
    s_waitcnt vmcnt(0)
    v_readfirstlane_b32 s30, v0
    s_nop 0
    s_cmp_eq_u32 s30, 81
    s_cbranch_scc0 M_pf_spin2
    s_branch M_pf_ok
M_ovb:
    s_mov_b32 s33, 0
    v_subrev_u32 v74, 16, v68
    v_mov_b32 v75, s33
    v_cmp_gt_u32 s[44:45], 48, v74
    s_nop 1
    v_mbcnt_lo_u32_b32 v75, s44, v75
    v_mbcnt_hi_u32_b32 v75, s45, v75
    s_bcnt1_i32_b64 s34, s[44:45]
    v_min_u32 v75, 32, v75
    s_add_u32 s33, s33, s34
    v_lshl_add_u32 v75, v75, 3, s48
    v_cndmask_b32 v75, v82, v75, s[44:45]
    ds_write_b64 v75, v[56:57]
    v_subrev_u32 v74, 16, v69
    v_mov_b32 v75, s33
    v_cmp_gt_u32 s[44:45], 48, v74
    s_nop 1
    v_mbcnt_lo_u32_b32 v75, s44, v75
    v_mbcnt_hi_u32_b32 v75, s45, v75
    s_bcnt1_i32_b64 s34, s[44:45]
    v_min_u32 v75, 32, v75
    s_add_u32 s33, s33, s34
    v_lshl_add_u32 v75, v75, 3, s48
    v_cndmask_b32 v75, v82, v75, s[44:45]
    ds_write_b64 v75, v[58:59]
    v_subrev_u32 v74, 16, v70
    v_mov_b32 v75, s33
    v_cmp_gt_u32 s[44:45], 48, v74
    s_nop 1
    v_mbcnt_lo_u32_b32 v75, s44, v75
    v_mbcnt_hi_u32_b32 v75, s45, v75
    s_bcnt1_i32_b64 s34, s[44:45]
    v_min_u32 v75, 32, v75
    s_add_u32 s33, s33, s34
    v_lshl_add_u32 v75, v75, 3, s48
    v_cndmask_b32 v75, v82, v75, s[44:45]
    ds_write_b64 v75, v[60:61]
    v_subrev_u32 v74, 16, v71
    v_mov_b32 v75, s33
    v_cmp_gt_u32 s[44:45], 48, v74
    s_nop 1
    v_mbcnt_lo_u32_b32 v75, s44, v75
    v_mbcnt_hi_u32_b32 v75, s45, v75
    s_bcnt1_i32_b64 s34, s[44:45]
    v_min_u32 v75, 32, v75
    s_add_u32 s33, s33, s34
    v_lshl_add_u32 v75, v75, 3, s48
    v_cndmask_b32 v75, v82, v75, s[44:45]
    ds_write_b64 v75, v[62:63]
    v_subrev_u32 v74, 16, v72
    v_mov_b32 v75, s33
    v_cmp_gt_u32 s[44:45], 48, v74
    s_nop 1
    v_mbcnt_lo_u32_b32 v75, s44, v75
    v_mbcnt_hi_u32_b32 v75, s45, v75
    s_bcnt1_i32_b64 s34, s[44:45]
    v_min_u32 v75, 32, v75
    s_add_u32 s33, s33, s34
    v_lshl_add_u32 v75, v75, 3, s48
    v_cndmask_b32 v75, v82, v75, s[44:45]
    ds_write_b64 v75, v[64:65]
    v_subrev_u32 v74, 16, v73
    v_mov_b32 v75, s33
    v_cmp_gt_u32 s[44:45], 48, v74
    s_nop 1
    v_mbcnt_lo_u32_b32 v75, s44, v75
    v_mbcnt_hi_u32_b32 v75, s45, v75
    s_bcnt1_i32_b64 s34, s[44:45]
    v_min_u32 v75, 32, v75
    s_add_u32 s33, s33, s34
    v_lshl_add_u32 v75, v75, 3, s48
    v_cndmask_b32 v75, v82, v75, s[44:45]
    ds_write_b64 v75, v[66:67]
    s_add_u32 s46, s33, 7
    s_lshr_b32 s46, s46, 3
    s_cmp_gt_u32 s33, 32
    s_cselect_b32 s32, 1, s32
    s_cmp_eq_u32 s32, 0
    s_cbranch_scc1 M_ovbr
    s_mov_b32 s27, 0
    s_mov_b32 s46, 0x80000000
    v_mov_b32 v244, 0
    v_mov_b32 v245, 0
    v_mov_b32 v246, 0
    v_mov_b32 v247, 0
    ds_write_b128 v8, v[244:247] offset:0
    ds_write_b128 v8, v[244:247] offset:1024
    ds_write_b128 v8, v[244:247] offset:2048
    ds_write_b128 v8, v[244:247] offset:3072
    ds_write_b128 v8, v[244:247] offset:4096
    ds_write_b128 v8, v[244:247] offset:5120
    ds_write_b128 v8, v[244:247] offset:6144
    ds_write_b128 v8, v[244:247] offset:7168
    ds_write_b128 v8, v[244:247] offset:8192
    s_waitcnt lgkmcnt(0)
    s_branch M_ovbr
M_ov0:
    s_bitcmp1_b32 s27, 0
    s_cbranch_scc0 M_ovs0
    v_bfe_u32 v53, v11, 4, 4
    v_lshrrev_b32 v54, 18, v216
    v_lshrrev_b32 v55, 18, v218
    v_or_b32 v53, 0, v53
    v_cmp_eq_u32 s[44:45], v54, v53
    v_cmp_eq_u32 s[54:55], v55, v53
    s_nop 0
    v_cndmask_b32 v54, 0, v217, s[44:45]
    v_cndmask_b32 v55, 0, v219, s[54:55]
    s_nop 1
    v_smfmac_f32_16x16x32_bf16 v[124:127], v[54:55], v[212:215], v10
    v_smfmac_f32_16x16x32_bf16 v[160:163], v[54:55], v[212:215], v10 abid:2
M_ovs0:
    s_bitcmp1_b32 s27, 1
    s_cbranch_scc0 M_ovs1
    v_bfe_u32 v53, v11, 4, 4
    v_lshrrev_b32 v54, 18, v216
    v_lshrrev_b32 v55, 18, v218
    v_or_b32 v53, 64, v53
    v_cmp_eq_u32 s[44:45], v54, v53
    v_cmp_eq_u32 s[54:55], v55, v53
    s_nop 0
    v_cndmask_b32 v54, 0, v217, s[44:45]
    v_cndmask_b32 v55, 0, v219, s[54:55]
    s_nop 1
    v_smfmac_f32_16x16x32_bf16 v[128:131], v[54:55], v[212:215], v10
    v_smfmac_f32_16x16x32_bf16 v[164:167], v[54:55], v[212:215], v10 abid:2
M_ovs1:
    s_bitcmp1_b32 s27, 2
    s_cbranch_scc0 M_ovs2
    v_bfe_u32 v53, v11, 4, 4
    v_lshrrev_b32 v54, 18, v216
    v_lshrrev_b32 v55, 18, v218
    v_or_b32 v53, 128, v53
    v_cmp_eq_u32 s[44:45], v54, v53
    v_cmp_eq_u32 s[54:55], v55, v53
    s_nop 0
    v_cndmask_b32 v54, 0, v217, s[44:45]
    v_cndmask_b32 v55, 0, v219, s[54:55]
    s_nop 1
    v_smfmac_f32_16x16x32_bf16 v[132:135], v[54:55], v[212:215], v10
    v_smfmac_f32_16x16x32_bf16 v[168:171], v[54:55], v[212:215], v10 abid:2
M_ovs2:
    s_nop 3
    s_cmp_eq_u32 s21, 1
    s_cbranch_scc1 M_ovr0L
    s_cmp_eq_u32 s21, 2
    s_cbranch_scc1 M_ovr0E
    s_cmp_eq_u32 s21, 3
    s_cbranch_scc1 M_ovr0F
    s_branch M_ovp0
M_ov1:
    s_bitcmp1_b32 s27, 3
    s_cbranch_scc0 M_ovs3
    v_bfe_u32 v53, v11, 4, 4
    v_lshrrev_b32 v54, 18, v216
    v_lshrrev_b32 v55, 18, v218
    v_or_b32 v53, 192, v53
    v_cmp_eq_u32 s[44:45], v54, v53
    v_cmp_eq_u32 s[54:55], v55, v53
    s_nop 0
    v_cndmask_b32 v54, 0, v217, s[44:45]
    v_cndmask_b32 v55, 0, v219, s[54:55]
    s_nop 1
    v_smfmac_f32_16x16x32_bf16 v[136:139], v[54:55], v[212:215], v10
    v_smfmac_f32_16x16x32_bf16 v[172:175], v[54:55], v[212:215], v10 abid:2
M_ovs3:
    s_bitcmp1_b32 s27, 4
    s_cbranch_scc0 M_ovs4
    v_bfe_u32 v53, v11, 4, 4
    v_lshrrev_b32 v54, 18, v216
    v_lshrrev_b32 v55, 18, v218
    v_or_b32 v53, 256, v53
    v_cmp_eq_u32 s[44:45], v54, v53
    v_cmp_eq_u32 s[54:55], v55, v53
    s_nop 0
    v_cndmask_b32 v54, 0, v217, s[44:45]
    v_cndmask_b32 v55, 0, v219, s[54:55]
    s_nop 1
    v_smfmac_f32_16x16x32_bf16 v[140:143], v[54:55], v[212:215], v10
    v_smfmac_f32_16x16x32_bf16 v[176:179], v[54:55], v[212:215], v10 abid:2
M_ovs4:
    s_bitcmp1_b32 s27, 5
    s_cbranch_scc0 M_ovs5
    v_bfe_u32 v53, v11, 4, 4
    v_lshrrev_b32 v54, 18, v216
    v_lshrrev_b32 v55, 18, v218
    v_or_b32 v53, 320, v53
    v_cmp_eq_u32 s[44:45], v54, v53
    v_cmp_eq_u32 s[54:55], v55, v53
    s_nop 0
    v_cndmask_b32 v54, 0, v217, s[44:45]
    v_cndmask_b32 v55, 0, v219, s[54:55]
    s_nop 1
    v_smfmac_f32_16x16x32_bf16 v[144:147], v[54:55], v[212:215], v10
    v_smfmac_f32_16x16x32_bf16 v[180:183], v[54:55], v[212:215], v10 abid:2
M_ovs5:
    s_nop 3
    s_cmp_eq_u32 s21, 1
    s_cbranch_scc1 M_ovr1L
    s_cmp_eq_u32 s21, 2
    s_cbranch_scc1 M_ovr1E
    s_cmp_eq_u32 s21, 3
    s_cbranch_scc1 M_ovr1F
    s_branch M_ovp1
M_ov2:
    s_bitcmp1_b32 s27, 6
    s_cbranch_scc0 M_ovs6
    v_bfe_u32 v53, v11, 4, 4
    v_lshrrev_b32 v54, 18, v216
    v_lshrrev_b32 v55, 18, v218
    v_or_b32 v53, 384, v53
    v_cmp_eq_u32 s[44:45], v54, v53
    v_cmp_eq_u32 s[54:55], v55, v53
    s_nop 0
    v_cndmask_b32 v54, 0, v217, s[44:45]
    v_cndmask_b32 v55, 0, v219, s[54:55]
    s_nop 1
    v_smfmac_f32_16x16x32_bf16 v[148:151], v[54:55], v[212:215], v10
    v_smfmac_f32_16x16x32_bf16 v[184:187], v[54:55], v[212:215], v10 abid:2
M_ovs6:
    s_bitcmp1_b32 s27, 7
    s_cbranch_scc0 M_ovs7
    v_bfe_u32 v53, v11, 4, 4
    v_lshrrev_b32 v54, 18, v216
    v_lshrrev_b32 v55, 18, v218
    v_or_b32 v53, 448, v53
    v_cmp_eq_u32 s[44:45], v54, v53
    v_cmp_eq_u32 s[54:55], v55, v53
    s_nop 0
    v_cndmask_b32 v54, 0, v217, s[44:45]
    v_cndmask_b32 v55, 0, v219, s[54:55]
    s_nop 1
    v_smfmac_f32_16x16x32_bf16 v[152:155], v[54:55], v[212:215], v10
    v_smfmac_f32_16x16x32_bf16 v[188:191], v[54:55], v[212:215], v10 abid:2
M_ovs7:
    s_bitcmp1_b32 s27, 8
    s_cbranch_scc0 M_ovs8
    v_bfe_u32 v53, v11, 4, 4
    v_lshrrev_b32 v54, 18, v216
    v_lshrrev_b32 v55, 18, v218
    v_or_b32 v53, 512, v53
    v_cmp_eq_u32 s[44:45], v54, v53
    v_cmp_eq_u32 s[54:55], v55, v53
    s_nop 0
    v_cndmask_b32 v54, 0, v217, s[44:45]
    v_cndmask_b32 v55, 0, v219, s[54:55]
    s_nop 1
    v_smfmac_f32_16x16x32_bf16 v[156:159], v[54:55], v[212:215], v10
    v_smfmac_f32_16x16x32_bf16 v[192:195], v[54:55], v[212:215], v10 abid:2
M_ovs8:
    s_nop 3
    s_cmp_eq_u32 s21, 1
    s_cbranch_scc1 M_ovr2L
    s_cmp_eq_u32 s21, 2
    s_cbranch_scc1 M_ovr2E
    s_cmp_eq_u32 s21, 3
    s_cbranch_scc1 M_ovr2F
    s_branch M_ovp2
M_slow:
    s_bitcmp1_b32 s46, 31
    s_cbranch_scc1 M_dense
    s_mov_b32 s56, 1
M_sl:
    s_lshl_b32 s57, s56, 6
    v_add_u32 v240, s57, v9
    ds_read_b128 v[248:251], v240 offset:9792
    s_waitcnt lgkmcnt(0)
    v_and_b32 v240, 0x3fff, v248
    v_and_b32 v241, 0x3fff, v250
    v_xad_u32 v240, v240, v3, v4
    v_xad_u32 v241, v241, v3, v4
    ds_read2st64_b32 v[244:245], v240 offset0:0 offset1:72
    ds_read2st64_b32 v[246:247], v241 offset0:0 offset1:72
    s_waitcnt lgkmcnt(0)
    s_bitcmp1_b32 s27, 0
    s_cbranch_scc0 M_sle0
    v_bfe_u32 v53, v11, 4, 4
    v_lshrrev_b32 v242, 18, v248
    v_lshrrev_b32 v243, 18, v250
    v_or_b32 v53, 0, v53
    v_cmp_eq_u32 s[44:45], v242, v53
    v_cmp_eq_u32 s[54:55], v243, v53
    s_nop 0
    v_cndmask_b32 v242, 0, v249, s[44:45]
    v_cndmask_b32 v243, 0, v251, s[54:55]
    s_nop 1
    v_smfmac_f32_16x16x32_bf16 v[124:127], v[242:243], v[244:247], v10
    v_smfmac_f32_16x16x32_bf16 v[160:163], v[242:243], v[244:247], v10 abid:2
M_sle0:
    s_bitcmp1_b32 s27, 1
    s_cbranch_scc0 M_sle1
    v_bfe_u32 v53, v11, 4, 4
    v_lshrrev_b32 v242, 18, v248
    v_lshrrev_b32 v243, 18, v250
    v_or_b32 v53, 64, v53
    v_cmp_eq_u32 s[44:45], v242, v53
    v_cmp_eq_u32 s[54:55], v243, v53
    s_nop 0
    v_cndmask_b32 v242, 0, v249, s[44:45]
    v_cndmask_b32 v243, 0, v251, s[54:55]
    s_nop 1
    v_smfmac_f32_16x16x32_bf16 v[128:131], v[242:243], v[244:247], v10
    v_smfmac_f32_16x16x32_bf16 v[164:167], v[242:243], v[244:247], v10 abid:2
M_sle1:
    s_bitcmp1_b32 s27, 2
    s_cbranch_scc0 M_sle2
    v_bfe_u32 v53, v11, 4, 4
    v_lshrrev_b32 v242, 18, v248
    v_lshrrev_b32 v243, 18, v250
    v_or_b32 v53, 128, v53
    v_cmp_eq_u32 s[44:45], v242, v53
    v_cmp_eq_u32 s[54:55], v243, v53
    s_nop 0
    v_cndmask_b32 v242, 0, v249, s[44:45]
    v_cndmask_b32 v243, 0, v251, s[54:55]
    s_nop 1
    v_smfmac_f32_16x16x32_bf16 v[132:135], v[242:243], v[244:247], v10
    v_smfmac_f32_16x16x32_bf16 v[168:171], v[242:243], v[244:247], v10 abid:2
M_sle2:
    s_bitcmp1_b32 s27, 3
    s_cbranch_scc0 M_sle3
    v_bfe_u32 v53, v11, 4, 4
    v_lshrrev_b32 v242, 18, v248
    v_lshrrev_b32 v243, 18, v250
    v_or_b32 v53, 192, v53
    v_cmp_eq_u32 s[44:45], v242, v53
    v_cmp_eq_u32 s[54:55], v243, v53
    s_nop 0
    v_cndmask_b32 v242, 0, v249, s[44:45]
    v_cndmask_b32 v243, 0, v251, s[54:55]
    s_nop 1
    v_smfmac_f32_16x16x32_bf16 v[136:139], v[242:243], v[244:247], v10
    v_smfmac_f32_16x16x32_bf16 v[172:175], v[242:243], v[244:247], v10 abid:2
M_sle3:
    s_bitcmp1_b32 s27, 4
    s_cbranch_scc0 M_sle4
    v_bfe_u32 v53, v11, 4, 4
    v_lshrrev_b32 v242, 18, v248
    v_lshrrev_b32 v243, 18, v250
    v_or_b32 v53, 256, v53
    v_cmp_eq_u32 s[44:45], v242, v53
    v_cmp_eq_u32 s[54:55], v243, v53
    s_nop 0
    v_cndmask_b32 v242, 0, v249, s[44:45]
    v_cndmask_b32 v243, 0, v251, s[54:55]
    s_nop 1
    v_smfmac_f32_16x16x32_bf16 v[140:143], v[242:243], v[244:247], v10
    v_smfmac_f32_16x16x32_bf16 v[176:179], v[242:243], v[244:247], v10 abid:2
M_sle4:
    s_bitcmp1_b32 s27, 5
    s_cbranch_scc0 M_sle5
    v_bfe_u32 v53, v11, 4, 4
    v_lshrrev_b32 v242, 18, v248
    v_lshrrev_b32 v243, 18, v250
    v_or_b32 v53, 320, v53
    v_cmp_eq_u32 s[44:45], v242, v53
    v_cmp_eq_u32 s[54:55], v243, v53
    s_nop 0
    v_cndmask_b32 v242, 0, v249, s[44:45]
    v_cndmask_b32 v243, 0, v251, s[54:55]
    s_nop 1
    v_smfmac_f32_16x16x32_bf16 v[144:147], v[242:243], v[244:247], v10
    v_smfmac_f32_16x16x32_bf16 v[180:183], v[242:243], v[244:247], v10 abid:2
M_sle5:
    s_bitcmp1_b32 s27, 6
    s_cbranch_scc0 M_sle6
    v_bfe_u32 v53, v11, 4, 4
    v_lshrrev_b32 v242, 18, v248
    v_lshrrev_b32 v243, 18, v250
    v_or_b32 v53, 384, v53
    v_cmp_eq_u32 s[44:45], v242, v53
    v_cmp_eq_u32 s[54:55], v243, v53
    s_nop 0
    v_cndmask_b32 v242, 0, v249, s[44:45]
    v_cndmask_b32 v243, 0, v251, s[54:55]
    s_nop 1
    v_smfmac_f32_16x16x32_bf16 v[148:151], v[242:243], v[244:247], v10
    v_smfmac_f32_16x16x32_bf16 v[184:187], v[242:243], v[244:247], v10 abid:2
M_sle6:
    s_bitcmp1_b32 s27, 7
    s_cbranch_scc0 M_sle7
    v_bfe_u32 v53, v11, 4, 4
    v_lshrrev_b32 v242, 18, v248
    v_lshrrev_b32 v243, 18, v250
    v_or_b32 v53, 448, v53
    v_cmp_eq_u32 s[44:45], v242, v53
    v_cmp_eq_u32 s[54:55], v243, v53
    s_nop 0
    v_cndmask_b32 v242, 0, v249, s[44:45]
    v_cndmask_b32 v243, 0, v251, s[54:55]
    s_nop 1
    v_smfmac_f32_16x16x32_bf16 v[152:155], v[242:243], v[244:247], v10
    v_smfmac_f32_16x16x32_bf16 v[188:191], v[242:243], v[244:247], v10 abid:2
M_sle7:
    s_bitcmp1_b32 s27, 8
    s_cbranch_scc0 M_sle8
    v_bfe_u32 v53, v11, 4, 4
    v_lshrrev_b32 v242, 18, v248
    v_lshrrev_b32 v243, 18, v250
    v_or_b32 v53, 512, v53
    v_cmp_eq_u32 s[44:45], v242, v53
    v_cmp_eq_u32 s[54:55], v243, v53
    s_nop 0
    v_cndmask_b32 v242, 0, v249, s[44:45]
    v_cndmask_b32 v243, 0, v251, s[54:55]
    s_nop 1
    v_smfmac_f32_16x16x32_bf16 v[156:159], v[242:243], v[244:247], v10
    v_smfmac_f32_16x16x32_bf16 v[192:195], v[242:243], v[244:247], v10 abid:2
M_sle8:
    s_add_u32 s56, s56, 1
    s_cmp_lt_u32 s56, s46
    s_cbranch_scc1 M_sl
M_slx:
    s_nop 7
    s_cmp_eq_u32 s21, 1
    s_cbranch_scc1 M_slowrL
    s_cmp_eq_u32 s21, 2
    s_cbranch_scc1 M_slowrE
    s_cmp_eq_u32 s21, 3
    s_cbranch_scc1 M_slowrF
    s_branch M_slowr0
M_dense:
    s_mul_i32 s57, s20, 82944
    s_add_u32 s57, s57, 389120
    s_mov_b32 s56, 0
    v_mov_b32 v53, v1
    v_mov_b32 v55, v2
M_dn0:
    ds_read_b128 v[244:247], v53 offset:0
    ds_read_b128 v[248:251], v55 offset:0
    v_add_u32 v53, 1024, v53
    v_add_u32 v55, 1024, v55
    buffer_load_dwordx4 v[240:243], v11, s[16:19], s57 offen sc1
    s_add_u32 s57, s57, 1024
    s_waitcnt vmcnt(0) lgkmcnt(0)
    v_smfmac_f32_16x16x64_bf16 v[124:127], v[240:243], v[244:251], v10
    buffer_load_dwordx4 v[240:243], v11, s[16:19], s57 offen sc1
    s_add_u32 s57, s57, 1024
    s_waitcnt vmcnt(0) lgkmcnt(0)
    v_smfmac_f32_16x16x64_bf16 v[128:131], v[240:243], v[244:251], v10
    buffer_load_dwordx4 v[240:243], v11, s[16:19], s57 offen sc1
    s_add_u32 s57, s57, 1024
    s_waitcnt vmcnt(0) lgkmcnt(0)
    v_smfmac_f32_16x16x64_bf16 v[132:135], v[240:243], v[244:251], v10
    buffer_load_dwordx4 v[240:243], v11, s[16:19], s57 offen sc1
    s_add_u32 s57, s57, 1024
    s_waitcnt vmcnt(0) lgkmcnt(0)
    v_smfmac_f32_16x16x64_bf16 v[136:139], v[240:243], v[244:251], v10
    buffer_load_dwordx4 v[240:243], v11, s[16:19], s57 offen sc1
    s_add_u32 s57, s57, 1024
    s_waitcnt vmcnt(0) lgkmcnt(0)
    v_smfmac_f32_16x16x64_bf16 v[140:143], v[240:243], v[244:251], v10
    buffer_load_dwordx4 v[240:243], v11, s[16:19], s57 offen sc1
    s_add_u32 s57, s57, 1024
    s_waitcnt vmcnt(0) lgkmcnt(0)
    v_smfmac_f32_16x16x64_bf16 v[144:147], v[240:243], v[244:251], v10
    buffer_load_dwordx4 v[240:243], v11, s[16:19], s57 offen sc1
    s_add_u32 s57, s57, 1024
    s_waitcnt vmcnt(0) lgkmcnt(0)
    v_smfmac_f32_16x16x64_bf16 v[148:151], v[240:243], v[244:251], v10
    buffer_load_dwordx4 v[240:243], v11, s[16:19], s57 offen sc1
    s_add_u32 s57, s57, 1024
    s_waitcnt vmcnt(0) lgkmcnt(0)
    v_smfmac_f32_16x16x64_bf16 v[152:155], v[240:243], v[244:251], v10
    buffer_load_dwordx4 v[240:243], v11, s[16:19], s57 offen sc1
    s_add_u32 s57, s57, 1024
    s_waitcnt vmcnt(0) lgkmcnt(0)
    v_smfmac_f32_16x16x64_bf16 v[156:159], v[240:243], v[244:251], v10
    s_add_u32 s56, s56, 1
    s_cmp_lt_u32 s56, 9
    s_cbranch_scc1 M_dn0
    s_mul_i32 s57, s20, 82944
    s_add_u32 s57, s57, 389120
    s_mov_b32 s56, 0
    v_mov_b32 v53, v1
    v_mov_b32 v55, v2
M_dn1:
    ds_read_b128 v[244:247], v53 offset:18432
    ds_read_b128 v[248:251], v55 offset:18432
    v_add_u32 v53, 1024, v53
    v_add_u32 v55, 1024, v55
    buffer_load_dwordx4 v[240:243], v11, s[16:19], s57 offen sc1
    s_add_u32 s57, s57, 1024
    s_waitcnt vmcnt(0) lgkmcnt(0)
    v_smfmac_f32_16x16x64_bf16 v[160:163], v[240:243], v[244:251], v10
    buffer_load_dwordx4 v[240:243], v11, s[16:19], s57 offen sc1
    s_add_u32 s57, s57, 1024
    s_waitcnt vmcnt(0) lgkmcnt(0)
    v_smfmac_f32_16x16x64_bf16 v[164:167], v[240:243], v[244:251], v10
    buffer_load_dwordx4 v[240:243], v11, s[16:19], s57 offen sc1
    s_add_u32 s57, s57, 1024
    s_waitcnt vmcnt(0) lgkmcnt(0)
    v_smfmac_f32_16x16x64_bf16 v[168:171], v[240:243], v[244:251], v10
    buffer_load_dwordx4 v[240:243], v11, s[16:19], s57 offen sc1
    s_add_u32 s57, s57, 1024
    s_waitcnt vmcnt(0) lgkmcnt(0)
    v_smfmac_f32_16x16x64_bf16 v[172:175], v[240:243], v[244:251], v10
    buffer_load_dwordx4 v[240:243], v11, s[16:19], s57 offen sc1
    s_add_u32 s57, s57, 1024
    s_waitcnt vmcnt(0) lgkmcnt(0)
    v_smfmac_f32_16x16x64_bf16 v[176:179], v[240:243], v[244:251], v10
    buffer_load_dwordx4 v[240:243], v11, s[16:19], s57 offen sc1
    s_add_u32 s57, s57, 1024
    s_waitcnt vmcnt(0) lgkmcnt(0)
    v_smfmac_f32_16x16x64_bf16 v[180:183], v[240:243], v[244:251], v10
    buffer_load_dwordx4 v[240:243], v11, s[16:19], s57 offen sc1
    s_add_u32 s57, s57, 1024
    s_waitcnt vmcnt(0) lgkmcnt(0)
    v_smfmac_f32_16x16x64_bf16 v[184:187], v[240:243], v[244:251], v10
    buffer_load_dwordx4 v[240:243], v11, s[16:19], s57 offen sc1
    s_add_u32 s57, s57, 1024
    s_waitcnt vmcnt(0) lgkmcnt(0)
    v_smfmac_f32_16x16x64_bf16 v[188:191], v[240:243], v[244:251], v10
    buffer_load_dwordx4 v[240:243], v11, s[16:19], s57 offen sc1
    s_add_u32 s57, s57, 1024
    s_waitcnt vmcnt(0) lgkmcnt(0)
    v_smfmac_f32_16x16x64_bf16 v[192:195], v[240:243], v[244:251], v10
    s_add_u32 s56, s56, 1
    s_cmp_lt_u32 s56, 9
    s_cbranch_scc1 M_dn1
    s_branch M_slx
M_codeend:
.section .rodata,"a"
.p2align 6
.amdhsa_kernel standalone__structured_sparse_n_m__ragged_kernel
  .amdhsa_next_free_vgpr 512
  .amdhsa_next_free_sgpr 102
  .amdhsa_accum_offset 256
  .amdhsa_group_segment_fixed_size 0
  .amdhsa_kernarg_size 48
  .amdhsa_user_sgpr_count 2
  .amdhsa_user_sgpr_kernarg_segment_ptr 1
  .amdhsa_system_sgpr_workgroup_id_x 1
  .amdhsa_float_denorm_mode_32 3
.end_amdhsa_kernel
```

```asm
; @launch grid=(256,1,1) block=(256,1,1) lds=162064
.amdgcn_target "amdgcn-amd-amdhsa--gfx950"
.text
.globl standalone__structured_sparse_n_m__ragged_kernel
.p2align 8
.type standalone__structured_sparse_n_m__ragged_kernel,@function
standalone__structured_sparse_n_m__ragged_kernel:
    s_cmp_ge_u32 s2, 256
    s_cbranch_scc1 M_end
    s_load_dwordx8 s[72:79], s[0:1], 0
    s_load_dwordx4 s[80:83], s[0:1], 32
    s_getpc_b64 s[84:85]
    s_lshr_b32 s30, s2, 3
    s_and_b32 s30, s30, 15
    s_lshl_b32 s30, s30, 11
    s_and_b32 s84, s84, 0xffffff00
    s_cmp_ge_u32 s2, 88
    s_cselect_b32 s86, M_codeend-standalone__structured_sparse_n_m__ragged_kernel, 0
    s_mov_b32 s87, 0x20000
    v_lshlrev_b32 v254, 3, v0
    s_mov_b32 exec_lo, 0x00010001
    s_mov_b32 exec_hi, 0x00010001
    buffer_load_dword v254, v254, s[84:87], s30 offen
    s_mov_b64 exec, -1
    v_lshrrev_b32 v20, 6, v0
    v_and_b32 v12, 63, v0
    v_readfirstlane_b32 s20, v20
    v_lshrrev_b32 v22, 3, v0
    v_mul_u32_u24 v22, 1152, v22
    v_lshrrev_b32 v23, 4, v0
    v_xor_b32 v23, v23, v0
    v_and_b32 v23, 7, v23
    v_lshl_add_u32 v5, v23, 4, v22
    v_lshrrev_b32 v13, 4, v12
    v_and_b32 v14, 15, v12
    v_lshlrev_b32 v11, 4, v12
    v_lshlrev_b32 v54, 3, v12
    v_lshlrev_b32 v25, 4, v13
    v_lshlrev_b32 v26, 3, v13
    s_mov_b32 s6, 663552
    s_mov_b32 s7, 0x20000
    s_mov_b32 s10, 75497472
    s_mov_b32 s11, s7
    s_mov_b32 s18, 738304
    s_mov_b32 s19, s7
    s_movk_i32 s70, 256
    s_mov_b32 s71, s7
    s_movk_i32 s86, 1152
    s_mov_b32 s87, s7
    s_mov_b32 s98, 0
    s_mul_i32 s96, s20, 8
    s_and_b32 s97, s2, 7
    s_add_u32 s96, s96, s97
    s_lshl_b32 s96, s96, 8
    s_add_u32 s96, s96, 721920
    s_mul_i32 s22, s2, 36864
    s_mul_i32 s26, s20, 9216
    s_mov_b32 s24, s22
    s_mov_b32 s42, s26
    s_lshl_b32 s28, s20, 8
    s_lshl_b32 s29, s20, 5
    s_mov_b32 s21, 0
    s_cmp_lt_u32 s2, 81
    s_cselect_b32 s41, 2, 2
    s_cbranch_scc0 M_x1
    s_mul_i32 s32, s2, 57
    s_lshr_b32 s32, s32, 9
    s_mul_i32 s33, s32, 9
    s_sub_u32 s33, s2, s33
    s_mul_i32 s54, s32, 73728
    s_lshl_b32 s35, s33, 7
    s_add_u32 s54, s54, s35
    s_add_u32 s55, s54, 36864
    s_lshl_b32 s36, s20, 10
    s_add_u32 m0, s36, 73728
    s_lshr_b32 s30, s33, 1
    s_and_b32 s31, s33, 1
    s_lshl_b32 s37, s32, 8
    s_lshl_b32 s38, s31, 7
    s_add_u32 s37, s37, s38
    s_lshl_b32 s38, s32, 6
    s_add_u32 s38, s38, 2304
    s_cmp_lt_u32 s33, 8
    s_cselect_b32 s30, s30, s20
    s_cselect_b32 s37, s37, s38
    s_cselect_b32 s44, 0xff, 15
    s_cselect_b32 s45, s20, 3
    s_cmp_eq_u32 s45, 3
    s_cselect_b32 s99, 738304, 0
    s_mul_i32 s48, s30, 97280
    s_add_u32 s37, s37, s48
    v_mov_b32 v44, 2.0
    v_mov_b32 v45, 0
    v_mov_b32 v46, 2.0
    v_mov_b32 v47, 0
    s_waitcnt lgkmcnt(0)
    s_mov_b64 s[4:5], s[74:75]
    buffer_load_dwordx4 v5, s[4:7], s54 offen lds
    s_add_u32 m0, m0, 4096
    s_mov_b32 s45, 0
    buffer_load_dwordx4 v5, s[4:7], s55 offen lds
    s_mov_b64 s[16:17], s[82:83]
    s_mov_b64 s[8:9], s[72:73]
    s_mov_b64 s[84:85], s[76:77]
    s_mov_b64 s[68:69], s[80:81]
    buffer_load_dword v253, off, s[16:19], s96 sc1
    s_mov_b64 exec, s[44:45]
    s_mov_b32 s18, s99
    buffer_store_dwordx4 v[44:47], v11, s[16:19], s37 offen sc1
    s_mov_b32 s18, 738304
    s_mov_b64 exec, -1
    buffer_load_dwordx4 v[196:199], v25, s[84:87], s28 offen offset:0
    buffer_load_dwordx4 v[200:203], v25, s[84:87], s28 offen offset:64
    buffer_load_dwordx4 v[204:207], v25, s[84:87], s28 offen offset:128
    buffer_load_dwordx4 v[208:211], v25, s[84:87], s28 offen offset:192
    buffer_load_dwordx2 v[212:213], v26, s[84:87], s29 offen offset:1024
    s_mov_b32 m0, s42
    s_nop 0
    buffer_load_dwordx4 v5, s[8:11], s22 offen offset:0 nt lds
    s_add_u32 m0, m0, 896
    s_nop 0
    buffer_load_dwordx4 v5, s[8:11], s22 offen offset:128 nt lds
    s_add_u32 m0, m0, 896
    s_nop 0
    buffer_load_dwordx4 v5, s[8:11], s22 offen offset:256 nt lds
    s_add_u32 m0, m0, 896
    s_nop 0
    buffer_load_dwordx4 v5, s[8:11], s22 offen offset:384 nt lds
    s_lshl_b32 s34, s31, 2
    s_add_u32 s34, s34, s20
    s_lshr_b32 s35, s20, 1
    s_lshl_b32 s35, s35, 6
    s_and_b32 s36, s20, 1
    s_lshl_b32 s36, s36, 3
    s_add_u32 s35, s35, s36
    s_lshl_b32 s36, s20, 5
    s_mul_i32 s39, s32, 10240
    s_add_u32 s39, s39, 5120
    s_lshl_b32 s40, s34, 1
    s_add_u32 s40, s40, s39
    s_lshl_b32 s38, s32, 1
    s_cmp_eq_u32 s32, 8
    s_cselect_b32 s38, 1024, s38
    s_add_u32 s38, s38, 3072
    s_cmp_lt_u32 s33, 8
    s_cselect_b32 s34, s34, 8
    s_cselect_b32 s35, s35, s36
    s_cselect_b32 s36, 4, 3
    s_cselect_b32 s40, s40, s38
    s_cselect_b32 s46, 0, s20
    s_cselect_b32 s47, 16, 8
    s_add_u32 s40, s40, s48
    s_lshl_b32 s38, s34, 10
    s_add_u32 s39, s39, s38
    s_add_u32 s39, s39, s48
    s_add_u32 s39, s39, 1024
    v_and_b32 v15, 3, v14
    v_lshlrev_b32 v15, s36, v15
    v_add_u32 v15, s35, v15
    v_lshrrev_b32 v16, 3, v14
    v_lshlrev_b32 v16, 4, v16
    v_xor_b32 v15, v15, v16
    v_lshrrev_b32 v16, 2, v14
    v_lshl_add_u32 v16, v13, 4, v16
    v_lshl_add_u32 v15, v16, 7, v15
    v_add_u32 v24, 73728, v15
    v_xor_b32 v27, 32, v24
    v_xor_b32 v28, 64, v24
    v_xor_b32 v29, 0x60, v24
    s_lshl_b32 s31, s46, 2
    s_add_u32 s31, s31, 81920
    v_mov_b32 v60, s31
    v_mov_b32 v61, 1
    ds_write_b32 v60, v61
    s_mul_i32 s49, s30, 81
    s_mul_i32 s31, s32, 9
    s_add_u32 s49, s49, s31
    s_add_u32 s49, s49, s34
    s_lshl_b32 s49, s49, 10
    s_add_u32 s49, s49, 389120
    s_lshl_b32 s31, s34, 24
    s_lshl_b32 s38, s32, 10
    s_add_u32 s31, s31, s38
    v_lshlrev_b32 v31, 18, v14
    v_lshl_add_u32 v31, v13, 5, v31
    v_add_u32 v31, s31, v31
    s_mov_b32 s50, 3437096686
    s_mov_b32 s51, 1150609561
    s_mov_b32 s52, 0x00010001
    s_mov_b32 s53, 0x00200010
    s_mov_b32 s38, 0x0202
    s_mul_i32 s30, s30, 2048
    s_add_u32 s30, s30, 721920
    s_cmp_eq_u32 s33, 8
    s_cselect_b32 s34, 32, 8
    s_bfm_b64 s[56:57], s34, 0
    s_cmp_eq_u32 s20, 0
    s_cselect_b32 s98, 1, 0
    v_lshlrev_b32 v30, 8, v12
    v_add_u32 v74, 81984, v54
    v_lshl_add_u32 v73, s20, 1, v74
    v_mov_b32 v41, 0x01000100
    v_mov_b32 v40, 0
    v_mov_b32 v63, -2.0
    s_waitcnt vmcnt(11) lgkmcnt(0)
    s_barrier
    ds_read_b64_tr_b16 v[16:17], v24
    ds_read_b64_tr_b16 v[18:19], v27 offset:512
    ds_read_b64_tr_b16 v[20:21], v28 offset:1024
    ds_read_b64_tr_b16 v[22:23], v29 offset:1536
    s_waitcnt lgkmcnt(3)
    v_and_b32 v44, 0x7fff7fff, v16
    v_and_b32 v45, 0x7fff7fff, v17
    v_pk_max_u16 v46, v44, v45
    v_pk_min_u16 v47, v44, v45
    v_pk_min_u16 v46, v46, v46 op_sel:[0,1] op_sel_hi:[1,0]
    v_pk_max_u16 v47, v47, v47 op_sel:[0,1] op_sel_hi:[1,0]
    v_pk_max_u16 v46, v46, s52
    v_pk_max_u16 v46, v46, v47
    v_pk_sub_i16 v44, v44, v46
    v_pk_sub_i16 v45, v45, v46
    v_pk_ashrrev_i16 v44, 15, v44 op_sel_hi:[0,1]
    v_pk_ashrrev_i16 v45, 15, v45 op_sel_hi:[0,1]
    v_alignbit_b32 v47, -1, v44, 16
    v_alignbit_b32 v46, v45, v45, 16
    v_and_b32 v48, 0x00080004, v44
    v_bitop3_b32 v46, v45, v46, v47 bitop3:0xe8
    v_and_or_b32 v64, v45, s53, v48
    v_bitop3_b32 v36, v16, v44, v46 bitop3:0x10
    v_min_u32 v68, 1, v36
    s_waitcnt lgkmcnt(2)
    v_and_b32 v44, 0x7fff7fff, v18
    v_and_b32 v45, 0x7fff7fff, v19
    v_pk_max_u16 v46, v44, v45
    v_pk_min_u16 v47, v44, v45
    v_pk_min_u16 v46, v46, v46 op_sel:[0,1] op_sel_hi:[1,0]
    v_pk_max_u16 v47, v47, v47 op_sel:[0,1] op_sel_hi:[1,0]
    v_pk_max_u16 v46, v46, s52
    v_pk_max_u16 v46, v46, v47
    v_pk_sub_i16 v44, v44, v46
    v_pk_sub_i16 v45, v45, v46
    v_pk_ashrrev_i16 v44, 15, v44 op_sel_hi:[0,1]
    v_pk_ashrrev_i16 v45, 15, v45 op_sel_hi:[0,1]
    v_alignbit_b32 v47, -1, v44, 16
    v_alignbit_b32 v46, v45, v45, 16
    v_and_b32 v48, 0x00080004, v44
    v_bitop3_b32 v46, v45, v46, v47 bitop3:0xe8
    v_and_or_b32 v65, v45, s53, v48
    v_bitop3_b32 v37, v18, v44, v46 bitop3:0x10
    v_min_u32 v69, 1, v37
    s_waitcnt lgkmcnt(1)
    v_and_b32 v44, 0x7fff7fff, v20
    v_and_b32 v45, 0x7fff7fff, v21
    v_pk_max_u16 v46, v44, v45
    v_pk_min_u16 v47, v44, v45
    v_pk_min_u16 v46, v46, v46 op_sel:[0,1] op_sel_hi:[1,0]
    v_pk_max_u16 v47, v47, v47 op_sel:[0,1] op_sel_hi:[1,0]
    v_pk_max_u16 v46, v46, s52
    v_pk_max_u16 v46, v46, v47
    v_pk_sub_i16 v44, v44, v46
    v_pk_sub_i16 v45, v45, v46
    v_pk_ashrrev_i16 v44, 15, v44 op_sel_hi:[0,1]
    v_pk_ashrrev_i16 v45, 15, v45 op_sel_hi:[0,1]
    v_alignbit_b32 v47, -1, v44, 16
    v_alignbit_b32 v46, v45, v45, 16
    v_and_b32 v48, 0x00080004, v44
    v_bitop3_b32 v46, v45, v46, v47 bitop3:0xe8
    v_and_or_b32 v66, v45, s53, v48
    v_bitop3_b32 v38, v20, v44, v46 bitop3:0x10
    v_min_u32 v70, 1, v38
    s_waitcnt lgkmcnt(0)
    v_and_b32 v44, 0x7fff7fff, v22
    v_and_b32 v45, 0x7fff7fff, v23
    v_pk_max_u16 v46, v44, v45
    v_pk_min_u16 v47, v44, v45
    v_pk_min_u16 v46, v46, v46 op_sel:[0,1] op_sel_hi:[1,0]
    v_pk_max_u16 v47, v47, v47 op_sel:[0,1] op_sel_hi:[1,0]
    v_pk_max_u16 v46, v46, s52
    v_pk_max_u16 v46, v46, v47
    v_pk_sub_i16 v44, v44, v46
    v_pk_sub_i16 v45, v45, v46
    v_pk_ashrrev_i16 v44, 15, v44 op_sel_hi:[0,1]
    v_pk_ashrrev_i16 v45, 15, v45 op_sel_hi:[0,1]
    v_alignbit_b32 v47, -1, v44, 16
    v_alignbit_b32 v46, v45, v45, 16
    v_and_b32 v48, 0x00080004, v44
    v_bitop3_b32 v46, v45, v46, v47 bitop3:0xe8
    v_and_or_b32 v67, v45, s53, v48
    v_bitop3_b32 v39, v22, v44, v46 bitop3:0x10
    v_min_u32 v71, 1, v39
    v_add_u32 v72, v68, v69
    v_add3_u32 v72, v72, v70, v71
    buffer_store_dwordx4 v[36:39], v11, s[16:19], s49 offen sc1
    v_cmp_ne_u32 vcc, 0, v72
    s_and_saveexec_b64 s[44:45], vcc
    ds_add_rtn_u32 v62, v60, v72
    s_mov_b64 exec, -1
    v_lshrrev_b32 v48, 16, v64
    v_or_b32 v48, v48, v64
    v_lshrrev_b64 v[52:53], v48, s[50:51]
    v_and_b32 v64, 15, v52
    v_lshl_or_b32 v40, v64, 0, v40
    v_lshrrev_b32 v48, 16, v65
    v_or_b32 v48, v48, v65
    v_lshrrev_b64 v[52:53], v48, s[50:51]
    v_and_b32 v65, 15, v52
    v_lshl_or_b32 v40, v65, 4, v40
    v_lshrrev_b32 v48, 16, v66
    v_or_b32 v48, v48, v66
    v_lshrrev_b64 v[52:53], v48, s[50:51]
    v_and_b32 v66, 15, v52
    v_lshl_or_b32 v40, v66, 8, v40
    v_lshrrev_b32 v48, 16, v67
    v_or_b32 v48, v48, v67
    v_lshrrev_b64 v[52:53], v48, s[50:51]
    v_and_b32 v67, 15, v52
    v_lshl_or_b32 v40, v67, 12, v40
    ds_write_b16 v73, v40
    v_mul_u32_u24 v46, 0x4001, v64
    v_and_b32 v46, 0x30003, v46
    v_mad_u32_u24 v46, v46, s38, v41
    v_perm_b32 v32, v17, v16, v46
    v_mul_u32_u24 v46, 0x4001, v65
    v_and_b32 v46, 0x30003, v46
    v_mad_u32_u24 v46, v46, s38, v41
    v_perm_b32 v33, v19, v18, v46
    s_waitcnt vmcnt(10) lgkmcnt(0)
    s_barrier
    ds_read_b64 v[50:51], v74
    v_mul_u32_u24 v46, 0x4001, v66
    v_and_b32 v46, 0x30003, v46
    v_mad_u32_u24 v46, v46, s38, v41
    v_perm_b32 v34, v21, v20, v46
    v_mul_u32_u24 v46, 0x4001, v67
    v_and_b32 v46, 0x30003, v46
    v_mad_u32_u24 v46, v46, s38, v41
    v_perm_b32 v35, v23, v22, v46
    buffer_store_dwordx4 v[32:35], v11, s[16:19], s39 offen sc1
    s_cmp_eq_u32 s33, 8
    s_cbranch_scc0 F_i1
    buffer_store_short v40, v11, s[16:19], s40 offen sc1
    s_branch F_i2
F_i1:
    s_cmp_eq_u32 s20, 0
    s_cbranch_scc0 F_i2
    s_waitcnt lgkmcnt(0)
    buffer_store_dwordx2 v[50:51], v11, s[16:19], s40 offen sc1
F_i2:
    s_cbranch_vccz F_z
    v_cmp_ne_u32 vcc, 0, v36
    s_and_saveexec_b64 s[44:45], vcc
    s_cbranch_execz F_e0
    v_cmp_gt_u32 vcc, s47, v62
    v_add_u32 v42, 0, v31
    v_lshlrev_b32 v44, 3, v62
    v_add_u32 v62, 1, v62
    v_cndmask_b32 v42, v63, v42, vcc
    v_cndmask_b32 v43, 0, v36, vcc
    v_cndmask_b32 v44, 0, v44, vcc
    buffer_store_dwordx2 v[42:43], v44, s[16:19], s37 offen sc1
F_e0:
    s_mov_b64 exec, -1
    v_cmp_ne_u32 vcc, 0, v37
    s_and_saveexec_b64 s[44:45], vcc
    s_cbranch_execz F_e1
    v_cmp_gt_u32 vcc, s47, v62
    v_add_u32 v42, 8, v31
    v_lshlrev_b32 v44, 3, v62
    v_add_u32 v62, 1, v62
    v_cndmask_b32 v42, v63, v42, vcc
    v_cndmask_b32 v43, 0, v37, vcc
    v_cndmask_b32 v44, 0, v44, vcc
    buffer_store_dwordx2 v[42:43], v44, s[16:19], s37 offen sc1
F_e1:
    s_mov_b64 exec, -1
    v_cmp_ne_u32 vcc, 0, v38
    s_and_saveexec_b64 s[44:45], vcc
    s_cbranch_execz F_e2
    v_cmp_gt_u32 vcc, s47, v62
    v_add_u32 v42, 16, v31
    v_lshlrev_b32 v44, 3, v62
    v_add_u32 v62, 1, v62
    v_cndmask_b32 v42, v63, v42, vcc
    v_cndmask_b32 v43, 0, v38, vcc
    v_cndmask_b32 v44, 0, v44, vcc
    buffer_store_dwordx2 v[42:43], v44, s[16:19], s37 offen sc1
F_e2:
    s_mov_b64 exec, -1
    v_cmp_ne_u32 vcc, 0, v39
    s_and_saveexec_b64 s[44:45], vcc
    s_cbranch_execz F_e3
    v_cmp_gt_u32 vcc, s47, v62
    v_add_u32 v42, 24, v31
    v_lshlrev_b32 v44, 3, v62
    v_add_u32 v62, 1, v62
    v_cndmask_b32 v42, v63, v42, vcc
    v_cndmask_b32 v43, 0, v39, vcc
    v_cndmask_b32 v44, 0, v44, vcc
    buffer_store_dwordx2 v[42:43], v44, s[16:19], s37 offen sc1
F_e3:
    s_mov_b64 exec, -1
F_z:
    s_cmp_lg_u32 s2, 0
    s_cbranch_scc1 F_sig
    v_mov_b32 v64, 0
    v_mov_b32 v65, 0
    v_mov_b32 v66, 0
    v_mov_b32 v67, 0
    s_mov_b32 s40, 720896
    buffer_store_dwordx4 v[64:67], v11, s[16:19], s40 offen sc1
F_sig:
    s_waitcnt vmcnt(0) lgkmcnt(0)
    s_barrier
    s_cmp_lg_u32 s20, 0
    s_cbranch_scc1 F_end
    s_mov_b64 exec, s[56:57]
    buffer_atomic_add v61, v30, s[16:19], s30 offen sc1
    s_mov_b64 exec, -1
F_end:
    s_add_u32 m0, s42, 3584
    s_nop 0
    buffer_load_dwordx4 v5, s[8:11], s22 offen offset:512 nt lds
    s_add_u32 m0, m0, 896
    s_nop 0
    buffer_load_dwordx4 v5, s[8:11], s22 offen offset:640 nt lds
    s_add_u32 m0, m0, 896
    s_nop 0
    buffer_load_dwordx4 v5, s[8:11], s22 offen offset:768 nt lds
    s_add_u32 m0, m0, 896
    s_nop 0
    buffer_load_dwordx4 v5, s[8:11], s22 offen offset:896 nt lds
    s_add_u32 m0, m0, 896
    s_nop 0
    buffer_load_dwordx4 v5, s[8:11], s22 offen offset:1024 nt lds
    s_add_u32 s22, s22, 9437184
    s_add_u32 s42, s42, 36864
    s_mov_b32 s21, 1
    s_branch M_xl
M_x1:
    s_waitcnt lgkmcnt(0)
    s_mov_b64 s[4:5], s[74:75]
    s_mov_b64 s[16:17], s[82:83]
    s_mov_b64 s[8:9], s[72:73]
    s_mov_b64 s[84:85], s[76:77]
    s_mov_b64 s[68:69], s[80:81]
    buffer_load_dword v253, off, s[16:19], s96 sc1
    buffer_load_dwordx4 v[196:199], v25, s[84:87], s28 offen offset:0
    buffer_load_dwordx4 v[200:203], v25, s[84:87], s28 offen offset:64
    buffer_load_dwordx4 v[204:207], v25, s[84:87], s28 offen offset:128
    buffer_load_dwordx4 v[208:211], v25, s[84:87], s28 offen offset:192
    buffer_load_dwordx2 v[212:213], v26, s[84:87], s29 offen offset:1024
M_xl:
    s_add_u32 s21, s21, 1
    s_mov_b32 m0, s42
    s_nop 0
    buffer_load_dwordx4 v5, s[8:11], s22 offen offset:0 nt lds
    s_add_u32 m0, m0, 896
    s_nop 0
    buffer_load_dwordx4 v5, s[8:11], s22 offen offset:128 nt lds
    s_add_u32 m0, m0, 896
    s_nop 0
    buffer_load_dwordx4 v5, s[8:11], s22 offen offset:256 nt lds
    s_add_u32 m0, m0, 896
    s_nop 0
    buffer_load_dwordx4 v5, s[8:11], s22 offen offset:384 nt lds
    s_add_u32 m0, m0, 896
    s_nop 0
    buffer_load_dwordx4 v5, s[8:11], s22 offen offset:512 nt lds
    s_add_u32 m0, m0, 896
    s_nop 0
    buffer_load_dwordx4 v5, s[8:11], s22 offen offset:640 nt lds
    s_add_u32 m0, m0, 896
    s_nop 0
    buffer_load_dwordx4 v5, s[8:11], s22 offen offset:768 nt lds
    s_add_u32 m0, m0, 896
    s_nop 0
    buffer_load_dwordx4 v5, s[8:11], s22 offen offset:896 nt lds
    s_add_u32 m0, m0, 896
    s_nop 0
    buffer_load_dwordx4 v5, s[8:11], s22 offen offset:1024 nt lds
    s_add_u32 s22, s22, 9437184
    s_add_u32 s42, s42, 36864
    s_cmp_lt_u32 s21, s41
    s_cbranch_scc1 M_xl
    s_mov_b32 s12, s78
    s_mov_b32 s13, s79
    s_mov_b32 s14, 75497472
    s_mov_b32 s15, 0x20000
    s_waitcnt vmcnt(9)
    v_readlane_b32 s100, v253, 0
    s_mul_i32 s29, s20, 12864
    s_add_u32 s29, s29, 110592
    v_lshrrev_b32 v24, 1, v14
    v_and_b32 v27, 7, v14
    v_lshlrev_b32 v22, 7, v27
    v_lshl_or_b32 v3, v24, 4, v22
    v_lshrrev_b32 v23, 3, v14
    v_mul_u32_u24 v4, 9216, v23
    v_xad_u32 v1, v25, v3, v4
    v_xor_b32 v2, 64, v1
    v_add_u32 v9, s29, v25
    v_add_u32 v8, s29, v11
    v_mul_u32_u24 v24, 1152, v27
    v_lshl_add_u32 v24, v23, 6, v24
    v_add3_u32 v6, v24, v25, s28
    v_lshrrev_b32 v24, 3, v12
    v_xor_b32 v28, v24, v12
    v_and_b32 v28, 7, v28
    v_mul_u32_u24 v24, 1152, v24
    v_lshl_add_u32 v24, v28, 4, v24
    v_add_u32 v7, 1024, v24
    s_lshl_b32 s30, s20, 1
    v_lshrrev_b32 v24, 1, v13
    v_add_u32 v24, s30, v24
    v_xor_b32 v24, v24, v27
    v_lshl_add_u32 v24, v24, 4, v22
    v_and_b32 v28, 8, v26
    v_mul_u32_u24 v29, 12864, v23
    v_add3_u32 v24, v24, v28, v29
    v_add_u32 v252, 121408, v24
    s_cmp_eq_u32 s20, 0
    s_mov_b32 s31, 1073903880
    s_cselect_b32 s30, 162048, s31
    v_mov_b32 v253, s31
    v_writelane_b32 v253, s30, 0
    s_lshr_b32 s30, s2, 3
    s_and_b32 s30, s30, 3
    s_mul_i32 s92, s30, 256
    s_add_u32 s92, s92, 558848
    s_add_u32 s30, s30, 768
    s_mul_i32 s93, s30, 36864
    s_mov_b32 s94, 147456
    s_and_b32 s95, s20, 1
    s_mul_i32 s95, s95, 9216
    v_mov_b32 v10, 0xeeee4444
    s_add_u32 s59, s24, 9216
    s_mul_i32 s43, s20, 97280
    s_add_u32 s47, s29, 9216
    s_add_u32 s48, s29, 9792
    s_add_u32 s49, s29, 10112
    s_add_u32 s54, s29, 1073751872
    s_mov_b32 s50, 3130536464
    s_mov_b32 s51, 4275861076
    s_mov_b32 s52, 3696531472
    s_mov_b32 s53, 4269193778
    v_mov_b32 v16, 0
    v_mov_b32 v17, 0
    v_mov_b32 v18, 0
    v_mov_b32 v19, 0
    v_cmp_gt_u32 s[44:45], 36, v12
    v_and_b32 v20, 8, v54
    s_nop 0
    v_cndmask_b32 v20, 0, v20, s[44:45]
    v_mov_b32 v21, v20
    v_mov_b32 v22, v20
    v_mov_b32 v23, v20
    v_mov_b32 v64, 1073741824
    v_mov_b32 v65, 0
    v_mov_b32 v66, 1073741824
    v_mov_b32 v67, 0
    v_lshl_add_u32 v53, v12, 2, s49
    ds_write_b128 v8, v[16:19] offset:0
    ds_write_b128 v8, v[16:19] offset:1024
    ds_write_b128 v8, v[16:19] offset:2048
    ds_write_b128 v8, v[16:19] offset:3072
    ds_write_b128 v8, v[16:19] offset:4096
    ds_write_b128 v8, v[16:19] offset:5120
    ds_write_b128 v8, v[16:19] offset:6144
    ds_write_b128 v8, v[16:19] offset:7168
    ds_write_b128 v8, v[16:19] offset:8192
    ds_write_b128 v8, v[20:23] offset:9216
    v_lshlrev_b32 v124, 16, v196
    v_and_b32 v125, 0xffff0000, v196
    v_lshlrev_b32 v126, 16, v197
    v_and_b32 v127, 0xffff0000, v197
    v_lshlrev_b32 v128, 16, v198
    v_and_b32 v129, 0xffff0000, v198
    v_lshlrev_b32 v130, 16, v199
    v_and_b32 v131, 0xffff0000, v199
    v_lshlrev_b32 v132, 16, v200
    v_and_b32 v133, 0xffff0000, v200
    v_lshlrev_b32 v134, 16, v201
    v_and_b32 v135, 0xffff0000, v201
    v_lshlrev_b32 v136, 16, v202
    v_and_b32 v137, 0xffff0000, v202
    v_lshlrev_b32 v138, 16, v203
    v_and_b32 v139, 0xffff0000, v203
    v_lshlrev_b32 v140, 16, v204
    v_and_b32 v141, 0xffff0000, v204
    v_lshlrev_b32 v142, 16, v205
    v_and_b32 v143, 0xffff0000, v205
    v_lshlrev_b32 v144, 16, v206
    v_and_b32 v145, 0xffff0000, v206
    v_lshlrev_b32 v146, 16, v207
    v_and_b32 v147, 0xffff0000, v207
    v_lshlrev_b32 v148, 16, v208
    v_and_b32 v149, 0xffff0000, v208
    v_lshlrev_b32 v150, 16, v209
    v_and_b32 v151, 0xffff0000, v209
    v_lshlrev_b32 v152, 16, v210
    v_and_b32 v153, 0xffff0000, v210
    v_lshlrev_b32 v154, 16, v211
    v_and_b32 v155, 0xffff0000, v211
    v_lshlrev_b32 v156, 16, v212
    v_and_b32 v157, 0xffff0000, v212
    v_lshlrev_b32 v158, 16, v213
    v_and_b32 v159, 0xffff0000, v213
    s_mov_b32 exec_lo, 0x00010001
    s_mov_b32 exec_hi, 0x00010001
    ds_write_b128 v9, v[124:127] offset:10240
    ds_write_b128 v9, v[128:131] offset:10304
    ds_write_b128 v9, v[132:135] offset:10368
    ds_write_b128 v9, v[136:139] offset:10432
    ds_write_b128 v9, v[140:143] offset:10496
    ds_write_b128 v9, v[144:147] offset:10560
    ds_write_b128 v9, v[148:151] offset:10624
    ds_write_b128 v9, v[152:155] offset:10688
    ds_write_b128 v9, v[156:159] offset:10752
    s_mov_b64 exec, -1
    s_waitcnt vmcnt(1)
    buffer_load_dword v0, off, s[16:19], s96 sc1
    s_mul_i32 s30, s20, 256
    s_add_u32 s30, s30, s2
    s_sub_u32 s30, s30, 0
    s_cmp_lt_u32 s2, 0
    s_cselect_b32 s30, 1023, s30
    s_lshl_b32 s30, s30, 1
    v_lshrrev_b32 v244, 5, v12
    v_add_u32 v248, s30, v244
    v_mul_u32_u24 v245, 7282, v248
    v_lshrrev_b32 v245, 20, v245
    v_mul_u32_u24 v246, 144, v245
    v_sub_u32 v244, v248, v246
    v_mul_u32_u24 v246, 16, v245
    v_sub_u32 v247, v244, v246
    v_cmp_lt_u32 s[30:31], v244, v246
    v_subrev_u32 v246, 1, v245
    v_sub_u32 v245, 8, v245
    v_cndmask_b32 v244, v247, v244, s[30:31]
    v_cndmask_b32 v245, v245, v246, s[30:31]
    v_sub_u32 v244, 2047, v244
    v_cmp_gt_u32 vcc, 720, v248
    v_subrev_u32 v248, 720, v248
    v_mul_u32_u24 v246, 7282, v248
    v_lshrrev_b32 v246, 16, v246
    v_mul_u32_u24 v247, 9, v246
    v_sub_u32 v247, v248, v247
    v_add_u32 v246, 2048, v246
    v_cndmask_b32 v244, v246, v244, vcc
    v_cndmask_b32 v245, v247, v245, vcc
    v_mul_u32_u24 v244, 36864, v244
    v_lshl_add_u32 v244, v245, 7, v244
    v_and_b32 v245, 31, v12
    v_mul_u32_u24 v245, 1152, v245
    v_add_u32 v254, v244, v245
    s_mov_b32 vcc_lo, 0xff00ff00
    s_mov_b32 vcc_hi, 0xff00ff00
    s_waitcnt vmcnt(0)
    v_readfirstlane_b32 s30, v0
    s_mov_b32 s31, 0
    s_sub_u32 s30, s30, s100
    s_cmp_eq_u32 s30, 27
    s_cbranch_scc0 M_pf_spin
M_pf_ok:
    buffer_load_dwordx4 v[56:59], v11, s[16:19], s43 offen offset:0 sc1
    buffer_load_dwordx4 v[60:63], v11, s[16:19], s43 offen offset:1024 sc1
    s_mov_b32 exec_hi, 0xfffff
    buffer_load_dwordx4 v[64:67], v11, s[16:19], s43 offen offset:2048 sc1
    s_mov_b32 exec_hi, -1
    buffer_load_dwordx4 v[48:51], v11, s[16:19], s43 offen offset:3072 sc1
    s_add_u32 s43, s43, 4096
    buffer_load_dword v52, v11, s[16:19], s43 offen offset:0 sc1
    buffer_load_dwordx4 v[12:15], v11, s[16:19], s43 offen offset:1024 sc1
    buffer_load_dwordx4 a[0:3], v11, s[16:19], s43 offen offset:2048 sc1
    buffer_load_dwordx4 a[4:7], v11, s[16:19], s43 offen offset:3072 sc1
    s_add_u32 s43, s43, 4096
    buffer_load_dwordx4 a[8:11], v11, s[16:19], s43 offen offset:0 sc1
    buffer_load_dwordx4 a[12:15], v11, s[16:19], s43 offen offset:1024 sc1
    buffer_load_dwordx4 a[16:19], v11, s[16:19], s43 offen offset:2048 sc1
    buffer_load_dwordx4 a[20:23], v11, s[16:19], s43 offen offset:3072 sc1
    s_add_u32 s43, s43, 4096
    buffer_load_dwordx4 a[24:27], v11, s[16:19], s43 offen offset:0 sc1
    buffer_load_dwordx4 a[28:31], v11, s[16:19], s43 offen offset:1024 sc1
    buffer_load_dwordx4 a[32:35], v11, s[16:19], s43 offen offset:2048 sc1
    buffer_load_dwordx4 v[16:19], v11, s[16:19], s43 offen offset:3072 sc1
    s_add_u32 s43, s43, 4096
    buffer_load_dwordx4 a[36:39], v11, s[16:19], s43 offen offset:0 sc1
    buffer_load_dwordx4 a[40:43], v11, s[16:19], s43 offen offset:1024 sc1
    buffer_load_dwordx4 a[44:47], v11, s[16:19], s43 offen offset:2048 sc1
    ds_read_b128 v[160:163], v9 offset:10240
    ds_read_b128 v[164:167], v9 offset:10304
    ds_read_b128 v[168:171], v9 offset:10368
    ds_read_b128 v[172:175], v9 offset:10432
    ds_read_b128 v[176:179], v9 offset:10496
    ds_read_b128 v[180:183], v9 offset:10560
    ds_read_b128 v[184:187], v9 offset:10624
    ds_read_b128 v[188:191], v9 offset:10688
    ds_read_b128 v[192:195], v9 offset:10752
    s_cmp_eq_u32 s98, 0
    s_cbranch_scc1 M_cnt
    s_mov_b32 s98, 0
    v_mov_b32 v0, 1
    s_mov_b64 exec, 1
    buffer_atomic_add v0, off, s[68:71], 0 offset:0 sc1
    s_mov_b64 exec, -1
    s_nop 3
M_cnt:
    s_waitcnt vmcnt(12)
    s_barrier
    ds_read_b128 v[196:199], v1 offset:0
    ds_read_b128 v[200:203], v2 offset:0
    ds_read_b128 v[228:231], v1 offset:18432
    ds_read_b128 v[232:235], v2 offset:18432
    s_waitcnt lgkmcnt(2)
    v_smfmac_f32_16x16x64_bf16 v[124:127], a[0:3], v[196:203], v12
    buffer_load_dwordx4 a[48:51], v11, s[16:19], s43 offen offset:3072 sc1
    s_waitcnt lgkmcnt(0)
    v_mov_b32 v82, s54
    v_smfmac_f32_16x16x64_bf16 v[160:163], a[0:3], v[228:235], v12
    ds_read_b128 v[204:207], v1 offset:1024
    ds_read_b128 v[208:211], v2 offset:1024
    v_bfe_u32 v74, v56, 24, 4
    v_lshlrev_b32 v75, 1, v56
    v_lshl_add_u32 v74, v74, 2, s49
    v_and_b32 v75, 16, v75
    s_waitcnt vmcnt(12)
    v_and_or_b32 v74, v56, 2.0, v74
    v_smfmac_f32_16x16x64_bf16 v[128:131], a[4:7], v[196:203], v12 abid:1
    s_add_u32 s43, s43, 4096
    buffer_load_dwordx4 a[52:55], v11, s[16:19], s43 offen offset:0 sc1
    v_lshlrev_b32 v75, v75, 1
    v_smfmac_f32_16x16x64_bf16 v[164:167], a[4:7], v[228:235], v12 abid:1
    ds_read_b128 v[220:223], v1 offset:19456
    ds_read_b128 v[224:227], v2 offset:19456
    ds_add_rtn_u32 v68, v74, v75
    v_bfe_u32 v76, v58, 24, 4
    v_lshlrev_b32 v77, 1, v58
    v_lshl_add_u32 v76, v76, 2, s49
    s_waitcnt vmcnt(12)
    v_and_b32 v77, 16, v77
    v_smfmac_f32_16x16x64_bf16 v[132:135], a[8:11], v[196:203], v13
    buffer_load_dwordx4 a[56:59], v11, s[16:19], s43 offen offset:1024 sc1
    v_and_or_b32 v76, v58, 2.0, v76
    v_smfmac_f32_16x16x64_bf16 v[168:171], a[8:11], v[228:235], v13
    s_waitcnt vmcnt(12)
    v_lshlrev_b32 v77, v77, 1
    v_smfmac_f32_16x16x64_bf16 v[136:139], a[12:15], v[196:203], v13 abid:1
    buffer_load_dwordx4 a[60:63], v11, s[16:19], s43 offen offset:2048 sc1
    ds_add_rtn_u32 v69, v76, v77
    v_bfe_u32 v74, v60, 24, 4
    v_smfmac_f32_16x16x64_bf16 v[172:175], a[12:15], v[228:235], v13 abid:1
    v_lshlrev_b32 v75, 1, v60
    v_lshl_add_u32 v74, v74, 2, s49
    v_and_b32 v75, 16, v75
    v_and_or_b32 v74, v60, 2.0, v74
    s_waitcnt vmcnt(12)
    v_lshlrev_b32 v75, v75, 1
    v_smfmac_f32_16x16x64_bf16 v[140:143], a[16:19], v[196:203], v14
    buffer_load_dwordx4 a[64:67], v11, s[16:19], s43 offen offset:3072 sc1
    ds_add_rtn_u32 v70, v74, v75
    v_bfe_u32 v76, v62, 24, 4
    v_smfmac_f32_16x16x64_bf16 v[176:179], a[16:19], v[228:235], v14
    v_lshlrev_b32 v77, 1, v62
    v_lshl_add_u32 v76, v76, 2, s49
    v_and_b32 v77, 16, v77
    v_and_or_b32 v76, v62, 2.0, v76
    s_waitcnt vmcnt(12)
    v_lshlrev_b32 v77, v77, 1
    v_smfmac_f32_16x16x64_bf16 v[144:147], a[20:23], v[196:203], v14 abid:1
    s_add_u32 s43, s43, 4096
    buffer_load_dwordx4 a[68:71], v11, s[16:19], s43 offen offset:0 sc1
    ds_add_rtn_u32 v71, v76, v77
    v_bfe_u32 v74, v64, 24, 4
    v_smfmac_f32_16x16x64_bf16 v[180:183], a[20:23], v[228:235], v14 abid:1
    v_lshlrev_b32 v75, 1, v64
    v_lshl_add_u32 v74, v74, 2, s49
    v_and_b32 v75, 16, v75
    s_waitcnt vmcnt(12)
    v_and_or_b32 v74, v64, 2.0, v74
    v_smfmac_f32_16x16x64_bf16 v[148:151], a[24:27], v[196:203], v15
    buffer_load_dwordx4 v[20:23], v11, s[16:19], s43 offen offset:1024 sc1
    buffer_load_dwordx4 a[72:75], v11, s[16:19], s43 offen offset:2048 sc1
    v_lshlrev_b32 v75, v75, 1
    v_smfmac_f32_16x16x64_bf16 v[184:187], a[24:27], v[228:235], v15
    ds_add_rtn_u32 v72, v74, v75
    v_bfe_u32 v76, v66, 24, 4
    v_lshlrev_b32 v77, 1, v66
    v_lshl_add_u32 v76, v76, 2, s49
    s_waitcnt vmcnt(13)
    v_and_b32 v77, 16, v77
    v_smfmac_f32_16x16x64_bf16 v[152:155], a[28:31], v[196:203], v15 abid:1
    buffer_load_dwordx4 a[76:79], v11, s[16:19], s43 offen offset:3072 sc1
    v_and_or_b32 v76, v66, 2.0, v76
    v_smfmac_f32_16x16x64_bf16 v[188:191], a[28:31], v[228:235], v15 abid:1
    s_waitcnt vmcnt(13)
    v_lshlrev_b32 v77, v77, 1
    v_smfmac_f32_16x16x64_bf16 v[156:159], a[32:35], v[196:203], v48
    s_add_u32 s43, s43, 4096
    buffer_load_dwordx4 a[80:83], v11, s[16:19], s43 offen offset:0 sc1
    ds_add_rtn_u32 v73, v76, v77
    ds_read_b32 v80, v53
    v_and_b32 v74, 8, v56
    v_smfmac_f32_16x16x64_bf16 v[192:195], a[32:35], v[228:235], v48
    s_waitcnt lgkmcnt(6)
    v_lshrrev_b32 v75, 16, v68
    v_cmp_ne_u32 s[44:45], 0, v74
    v_and_b32 v76, 0xffff, v68
    v_sub_u32 v74, 15, v75
    v_and_b32 v68, 2.0, v56
    s_waitcnt vmcnt(12)
    v_add3_u32 v68, v76, v75, v68
    v_smfmac_f32_16x16x64_bf16 v[124:127], a[36:39], v[204:211], v16
    buffer_load_dwordx4 a[84:87], v11, s[16:19], s43 offen offset:1024 sc1
    v_cndmask_b32 v74, v76, v74, s[44:45]
    v_smfmac_f32_16x16x64_bf16 v[160:163], a[36:39], v[220:227], v16
    ds_read_b128 v[196:199], v1 offset:2048
    ds_read_b128 v[200:203], v2 offset:2048
    v_cmp_gt_u32 s[44:45], 16, v68
    v_lshlrev_b32 v74, 2, v74
    v_lshrrev_b64 v[76:77], v74, s[50:51]
    v_lshrrev_b64 v[78:79], v74, s[52:53]
    s_waitcnt vmcnt(12)
    v_bfe_u32 v74, v56, 24, 4
    v_smfmac_f32_16x16x64_bf16 v[128:131], a[40:43], v[204:211], v16 abid:1
    buffer_load_dwordx4 a[88:91], v11, s[16:19], s43 offen offset:2048 sc1
    v_and_b32 v76, 15, v76
    v_smfmac_f32_16x16x64_bf16 v[164:167], a[40:43], v[220:227], v16 abid:1
    ds_read_b128 v[228:231], v1 offset:20480
    ds_read_b128 v[232:235], v2 offset:20480
    v_and_b32 v78, 15, v78
    v_lshl_add_u32 v76, v74, 4, v76
    v_mul_u32_u24 v78, 68, v78
    s_waitcnt vmcnt(12)
    v_lshrrev_b32 v77, 14, v56
    v_smfmac_f32_16x16x64_bf16 v[132:135], a[44:47], v[204:211], v17
    buffer_load_dwordx4 a[92:95], v11, s[16:19], s43 offen offset:3072 sc1
    v_lshl_add_u32 v76, v76, 2, s47
    v_smfmac_f32_16x16x64_bf16 v[168:171], a[44:47], v[220:227], v17
    v_and_b32 v78, 0x30c, v78
    v_and_b32 v77, 0x3cf0, v77
    v_cndmask_b32 v75, v82, v76, s[44:45]
    v_add3_u32 v77, v77, v78, s29
    s_waitcnt vmcnt(12)
    v_and_b32 v78, 0x3fff, v56
    v_smfmac_f32_16x16x64_bf16 v[136:139], a[48:51], v[204:211], v17 abid:1
    s_add_u32 s43, s43, 4096
    buffer_load_dwordx4 a[96:99], v11, s[16:19], s43 offen offset:0 sc1
    v_cndmask_b32 v74, v82, v77, s[44:45]
    v_smfmac_f32_16x16x64_bf16 v[172:175], a[48:51], v[220:227], v17 abid:1
    ds_write_b32 v75, v78
    ds_write_b32 v74, v57
    v_and_b32 v74, 8, v58
    s_waitcnt lgkmcnt(11)
    v_lshrrev_b32 v75, 16, v69
    s_waitcnt vmcnt(12)
    v_cmp_ne_u32 s[44:45], 0, v74
    v_smfmac_f32_16x16x64_bf16 v[140:143], a[52:55], v[204:211], v18
    buffer_load_dwordx4 a[100:103], v11, s[16:19], s43 offen offset:1024 sc1
    v_and_b32 v76, 0xffff, v69
    v_smfmac_f32_16x16x64_bf16 v[176:179], a[52:55], v[220:227], v18
    v_sub_u32 v74, 15, v75
    v_and_b32 v69, 2.0, v58
    v_add3_u32 v69, v76, v75, v69
    s_waitcnt vmcnt(12)
    v_cndmask_b32 v74, v76, v74, s[44:45]
    v_smfmac_f32_16x16x64_bf16 v[144:147], a[56:59], v[204:211], v18 abid:1
    buffer_load_dwordx4 a[104:107], v11, s[16:19], s43 offen offset:2048 sc1
    v_cmp_gt_u32 s[44:45], 16, v69
    v_smfmac_f32_16x16x64_bf16 v[180:183], a[56:59], v[220:227], v18 abid:1
    v_lshlrev_b32 v74, 2, v74
    v_lshrrev_b64 v[76:77], v74, s[50:51]
    v_lshrrev_b64 v[78:79], v74, s[52:53]
    v_bfe_u32 v74, v58, 24, 4
    s_waitcnt vmcnt(12)
    v_and_b32 v76, 15, v76
    v_smfmac_f32_16x16x64_bf16 v[148:151], a[60:63], v[204:211], v19
    buffer_load_dwordx4 v[24:27], v11, s[16:19], s43 offen offset:3072 sc1
    s_add_u32 s43, s43, 4096
    buffer_load_dwordx4 a[108:111], v11, s[16:19], s43 offen offset:0 sc1
    v_and_b32 v78, 15, v78
    v_smfmac_f32_16x16x64_bf16 v[184:187], a[60:63], v[220:227], v19
    v_lshl_add_u32 v76, v74, 4, v76
    v_mul_u32_u24 v78, 68, v78
    v_lshrrev_b32 v77, 14, v58
    v_lshl_add_u32 v76, v76, 2, s47
    s_waitcnt vmcnt(13)
    v_and_b32 v78, 0x30c, v78
    v_smfmac_f32_16x16x64_bf16 v[152:155], a[64:67], v[204:211], v19 abid:1
    buffer_load_dwordx4 a[112:115], v11, s[16:19], s43 offen offset:1024 sc1
    v_and_b32 v77, 0x3cf0, v77
    v_smfmac_f32_16x16x64_bf16 v[188:191], a[64:67], v[220:227], v19 abid:1
    v_cndmask_b32 v75, v82, v76, s[44:45]
    v_add3_u32 v77, v77, v78, s29
    v_and_b32 v78, 0x3fff, v58
    s_waitcnt vmcnt(13)
    v_cndmask_b32 v74, v82, v77, s[44:45]
    v_smfmac_f32_16x16x64_bf16 v[156:159], a[68:71], v[204:211], v48 abid:1
    buffer_load_dwordx4 a[116:119], v11, s[16:19], s43 offen offset:2048 sc1
    ds_write_b32 v75, v78
    ds_write_b32 v74, v59
    v_and_b32 v74, 8, v60
    v_smfmac_f32_16x16x64_bf16 v[192:195], a[68:71], v[220:227], v48 abid:1
    s_waitcnt lgkmcnt(12)
    v_lshrrev_b32 v75, 16, v70
    v_cmp_ne_u32 s[44:45], 0, v74
    s_waitcnt vmcnt(12)
    s_waitcnt lgkmcnt(6)
    v_and_b32 v76, 0xffff, v70
    v_smfmac_f32_16x16x64_bf16 v[124:127], a[72:75], v[196:203], v20
    buffer_load_dwordx4 a[120:123], v11, s[16:19], s43 offen offset:3072 sc1
    s_waitcnt lgkmcnt(4)
    v_sub_u32 v74, 15, v75
    v_smfmac_f32_16x16x64_bf16 v[160:163], a[72:75], v[228:235], v20
    ds_read_b128 v[204:207], v1 offset:3072
    ds_read_b128 v[208:211], v2 offset:3072
    v_and_b32 v70, 2.0, v60
    v_add3_u32 v70, v76, v75, v70
    v_cndmask_b32 v74, v76, v74, s[44:45]
    s_waitcnt vmcnt(12)
    v_cmp_gt_u32 s[44:45], 16, v70
    v_smfmac_f32_16x16x64_bf16 v[128:131], a[76:79], v[196:203], v20 abid:1
    s_add_u32 s43, s43, 4096
    buffer_load_dwordx4 a[124:127], v11, s[16:19], s43 offen offset:0 sc1
    v_lshlrev_b32 v74, 2, v74
    v_smfmac_f32_16x16x64_bf16 v[164:167], a[76:79], v[228:235], v20 abid:1
    ds_read_b128 v[220:223], v1 offset:21504
    ds_read_b128 v[224:227], v2 offset:21504
    v_lshrrev_b64 v[76:77], v74, s[50:51]
    v_lshrrev_b64 v[78:79], v74, s[52:53]
    v_bfe_u32 v74, v60, 24, 4
    v_and_b32 v76, 15, v76
    s_waitcnt vmcnt(12)
    v_and_b32 v78, 15, v78
    v_smfmac_f32_16x16x64_bf16 v[132:135], a[80:83], v[196:203], v21
    buffer_load_dwordx4 a[128:131], v11, s[16:19], s43 offen offset:1024 sc1
    v_lshl_add_u32 v76, v74, 4, v76
    v_smfmac_f32_16x16x64_bf16 v[168:171], a[80:83], v[228:235], v21
    v_mul_u32_u24 v78, 68, v78
    v_lshrrev_b32 v77, 14, v60
    v_lshl_add_u32 v76, v76, 2, s47
    v_and_b32 v78, 0x30c, v78
    s_waitcnt vmcnt(12)
    v_and_b32 v77, 0x3cf0, v77
    v_smfmac_f32_16x16x64_bf16 v[136:139], a[84:87], v[196:203], v21 abid:1
    buffer_load_dwordx4 a[132:135], v11, s[16:19], s43 offen offset:2048 sc1
    v_cndmask_b32 v75, v82, v76, s[44:45]
    v_smfmac_f32_16x16x64_bf16 v[172:175], a[84:87], v[228:235], v21 abid:1
    v_add3_u32 v77, v77, v78, s29
    v_and_b32 v78, 0x3fff, v60
    s_waitcnt vmcnt(12)
    v_cndmask_b32 v74, v82, v77, s[44:45]
    v_smfmac_f32_16x16x64_bf16 v[140:143], a[88:91], v[196:203], v22
    buffer_load_dwordx4 a[136:139], v11, s[16:19], s43 offen offset:3072 sc1
    ds_write_b32 v75, v78
    ds_write_b32 v74, v61
    v_and_b32 v74, 8, v62
    v_smfmac_f32_16x16x64_bf16 v[176:179], a[88:91], v[228:235], v22
    v_lshrrev_b32 v75, 16, v71
    v_cmp_ne_u32 s[44:45], 0, v74
    v_and_b32 v76, 0xffff, v71
    s_waitcnt vmcnt(12)
    v_sub_u32 v74, 15, v75
    v_smfmac_f32_16x16x64_bf16 v[144:147], a[92:95], v[196:203], v22 abid:1
    s_add_u32 s43, s43, 4096
    buffer_load_dwordx4 a[140:143], v11, s[16:19], s43 offen offset:0 sc1
    v_and_b32 v71, 2.0, v62
    v_smfmac_f32_16x16x64_bf16 v[180:183], a[92:95], v[228:235], v22 abid:1
    v_add3_u32 v71, v76, v75, v71
    v_cndmask_b32 v74, v76, v74, s[44:45]
    v_cmp_gt_u32 s[44:45], 16, v71
    v_lshlrev_b32 v74, 2, v74
    s_waitcnt vmcnt(12)
    v_lshrrev_b64 v[76:77], v74, s[50:51]
    v_smfmac_f32_16x16x64_bf16 v[148:151], a[96:99], v[196:203], v23
    buffer_load_dwordx4 v[28:31], v11, s[16:19], s43 offen offset:1024 sc1
    buffer_load_dwordx4 a[144:147], v11, s[16:19], s43 offen offset:2048 sc1
    v_lshrrev_b64 v[78:79], v74, s[52:53]
    v_smfmac_f32_16x16x64_bf16 v[184:187], a[96:99], v[228:235], v23
    v_bfe_u32 v74, v62, 24, 4
    v_and_b32 v76, 15, v76
    v_and_b32 v78, 15, v78
    s_waitcnt vmcnt(13)
    v_lshl_add_u32 v76, v74, 4, v76
    v_smfmac_f32_16x16x64_bf16 v[152:155], a[100:103], v[196:203], v23 abid:1
    buffer_load_dwordx4 a[148:151], v11, s[16:19], s43 offen offset:3072 sc1
    v_mul_u32_u24 v78, 68, v78
    v_smfmac_f32_16x16x64_bf16 v[188:191], a[100:103], v[228:235], v23 abid:1
    v_lshrrev_b32 v77, 14, v62
    v_lshl_add_u32 v76, v76, 2, s47
    v_and_b32 v78, 0x30c, v78
    v_and_b32 v77, 0x3cf0, v77
    s_waitcnt vmcnt(13)
    v_cndmask_b32 v75, v82, v76, s[44:45]
    v_smfmac_f32_16x16x64_bf16 v[156:159], a[104:107], v[196:203], v49
    s_add_u32 s43, s43, 4096
    buffer_load_dwordx4 a[152:155], v11, s[16:19], s43 offen offset:0 sc1
    v_add3_u32 v77, v77, v78, s29
    v_smfmac_f32_16x16x64_bf16 v[192:195], a[104:107], v[228:235], v49
    v_and_b32 v78, 0x3fff, v62
    s_waitcnt vmcnt(12)
    s_waitcnt lgkmcnt(4)
    v_cndmask_b32 v74, v82, v77, s[44:45]
    v_smfmac_f32_16x16x64_bf16 v[124:127], a[108:111], v[204:211], v24
    buffer_load_dwordx4 a[156:159], v11, s[16:19], s43 offen offset:1024 sc1
    ds_write_b32 v75, v78
    ds_write_b32 v74, v63
    s_waitcnt lgkmcnt(4)
    v_and_b32 v74, 8, v64
    v_smfmac_f32_16x16x64_bf16 v[160:163], a[108:111], v[220:227], v24
    ds_read_b128 v[196:199], v1 offset:4096
    ds_read_b128 v[200:203], v2 offset:4096
    v_lshrrev_b32 v75, 16, v72
    v_cmp_ne_u32 s[44:45], 0, v74
    v_and_b32 v76, 0xffff, v72
    v_sub_u32 v74, 15, v75
    s_waitcnt vmcnt(12)
    v_and_b32 v72, 2.0, v64
    v_smfmac_f32_16x16x64_bf16 v[128:131], a[112:115], v[204:211], v24 abid:1
    buffer_load_dwordx4 a[160:163], v11, s[16:19], s43 offen offset:2048 sc1
    v_add3_u32 v72, v76, v75, v72
    v_smfmac_f32_16x16x64_bf16 v[164:167], a[112:115], v[220:227], v24 abid:1
    ds_read_b128 v[228:231], v1 offset:22528
    ds_read_b128 v[232:235], v2 offset:22528
    v_cndmask_b32 v74, v76, v74, s[44:45]
    v_cmp_gt_u32 s[44:45], 16, v72
    v_lshlrev_b32 v74, 2, v74
    v_lshrrev_b64 v[76:77], v74, s[50:51]
    s_waitcnt vmcnt(12)
    v_lshrrev_b64 v[78:79], v74, s[52:53]
    v_smfmac_f32_16x16x64_bf16 v[132:135], a[116:119], v[204:211], v25
    buffer_load_dwordx4 a[164:167], v11, s[16:19], s43 offen offset:3072 sc1
    v_bfe_u32 v74, v64, 24, 4
    v_smfmac_f32_16x16x64_bf16 v[168:171], a[116:119], v[220:227], v25
    v_and_b32 v76, 15, v76
    v_and_b32 v78, 15, v78
    v_lshl_add_u32 v76, v74, 4, v76
    s_waitcnt vmcnt(12)
    v_mul_u32_u24 v78, 68, v78
    v_smfmac_f32_16x16x64_bf16 v[136:139], a[120:123], v[204:211], v25 abid:1
    s_add_u32 s43, s43, 4096
    buffer_load_dwordx4 a[168:171], v11, s[16:19], s43 offen offset:0 sc1
    v_lshrrev_b32 v77, 14, v64
    v_smfmac_f32_16x16x64_bf16 v[172:175], a[120:123], v[220:227], v25 abid:1
    v_lshl_add_u32 v76, v76, 2, s47
    v_and_b32 v78, 0x30c, v78
    v_and_b32 v77, 0x3cf0, v77
    v_cndmask_b32 v75, v82, v76, s[44:45]
    s_waitcnt vmcnt(12)
    v_add3_u32 v77, v77, v78, s29
    v_smfmac_f32_16x16x64_bf16 v[140:143], a[124:127], v[204:211], v26
    buffer_load_dwordx4 a[172:175], v11, s[16:19], s43 offen offset:1024 sc1
    v_and_b32 v78, 0x3fff, v64
    v_smfmac_f32_16x16x64_bf16 v[176:179], a[124:127], v[220:227], v26
    s_waitcnt vmcnt(12)
    v_cndmask_b32 v74, v82, v77, s[44:45]
    v_smfmac_f32_16x16x64_bf16 v[144:147], a[128:131], v[204:211], v26 abid:1
    buffer_load_dwordx4 a[176:179], v11, s[16:19], s43 offen offset:2048 sc1
    ds_write_b32 v75, v78
    ds_write_b32 v74, v65
    v_and_b32 v74, 8, v66
    v_smfmac_f32_16x16x64_bf16 v[180:183], a[128:131], v[220:227], v26 abid:1
    v_lshrrev_b32 v75, 16, v73
    v_cmp_ne_u32 s[44:45], 0, v74
    v_and_b32 v76, 0xffff, v73
    v_sub_u32 v74, 15, v75
    v_and_b32 v73, 2.0, v66
    s_waitcnt vmcnt(12)
    v_add3_u32 v73, v76, v75, v73
    v_smfmac_f32_16x16x64_bf16 v[148:151], a[132:135], v[204:211], v27
    buffer_load_dwordx4 v[32:35], v11, s[16:19], s43 offen offset:3072 sc1
    s_add_u32 s43, s43, 4096
    buffer_load_dwordx4 a[180:183], v11, s[16:19], s43 offen offset:0 sc1
    v_cndmask_b32 v74, v76, v74, s[44:45]
    v_smfmac_f32_16x16x64_bf16 v[184:187], a[132:135], v[220:227], v27
    v_cmp_gt_u32 s[44:45], 16, v73
    v_lshlrev_b32 v74, 2, v74
    v_lshrrev_b64 v[76:77], v74, s[50:51]
    v_lshrrev_b64 v[78:79], v74, s[52:53]
    s_waitcnt vmcnt(13)
    v_bfe_u32 v74, v66, 24, 4
    v_smfmac_f32_16x16x64_bf16 v[152:155], a[136:139], v[204:211], v27 abid:1
    buffer_load_dwordx4 a[184:187], v11, s[16:19], s43 offen offset:1024 sc1
    v_and_b32 v76, 15, v76
    v_smfmac_f32_16x16x64_bf16 v[188:191], a[136:139], v[220:227], v27 abid:1
    v_and_b32 v78, 15, v78
    v_lshl_add_u32 v76, v74, 4, v76
    v_mul_u32_u24 v78, 68, v78
    v_lshrrev_b32 v77, 14, v66
    s_waitcnt vmcnt(13)
    v_lshl_add_u32 v76, v76, 2, s47
    v_smfmac_f32_16x16x64_bf16 v[156:159], a[140:143], v[204:211], v49 abid:1
    buffer_load_dwordx4 a[188:191], v11, s[16:19], s43 offen offset:2048 sc1
    v_and_b32 v78, 0x30c, v78
    v_smfmac_f32_16x16x64_bf16 v[192:195], a[140:143], v[220:227], v49 abid:1
    v_and_b32 v77, 0x3cf0, v77
    v_cndmask_b32 v75, v82, v76, s[44:45]
    v_add3_u32 v77, v77, v78, s29
    s_waitcnt vmcnt(12)
    s_waitcnt lgkmcnt(4)
    v_and_b32 v78, 0x3fff, v66
    v_smfmac_f32_16x16x64_bf16 v[124:127], a[144:147], v[196:203], v28
    buffer_load_dwordx4 a[192:195], v11, s[16:19], s43 offen offset:3072 sc1
    s_waitcnt lgkmcnt(2)
    v_cndmask_b32 v74, v82, v77, s[44:45]
    v_smfmac_f32_16x16x64_bf16 v[160:163], a[144:147], v[228:235], v28
    ds_read_b128 v[204:207], v1 offset:5120
    ds_read_b128 v[208:211], v2 offset:5120
    ds_write_b32 v75, v78
    ds_write_b32 v74, v67
    v_lshrrev_b32 v74, 16, v80
    v_and_b32 v80, 0xffff, v80
    s_waitcnt vmcnt(12)
    v_or3_b32 v75, v56, v60, v64
    v_smfmac_f32_16x16x64_bf16 v[128:131], a[148:151], v[196:203], v28 abid:1
    s_add_u32 s43, s43, 4096
    buffer_load_dwordx4 a[196:199], v11, s[16:19], s43 offen offset:0 sc1
    v_add_u32 v80, v80, v74
    v_smfmac_f32_16x16x64_bf16 v[164:167], a[148:151], v[228:235], v28 abid:1
    ds_read_b128 v[220:223], v1 offset:23552
    ds_read_b128 v[224:227], v2 offset:23552
    v_cmp_gt_i32 s[32:33], 0, v75
    s_waitcnt vmcnt(12)
    v_cmp_lt_u32 s[34:35], 16, v80
    v_smfmac_f32_16x16x64_bf16 v[132:135], a[152:155], v[196:203], v29
    buffer_load_dwordx4 a[200:203], v11, s[16:19], s43 offen offset:1024 sc1
    s_mov_b32 s46, 0
    s_mov_b32 s21, 0
    s_or_b32 s32, s32, s33
    s_and_b32 s27, s34, 0x1ff
    s_or_b32 s33, s32, s27
    s_cbranch_scc1 M_ovb
M_ovbr:
    ds_read_b128 v[236:239], v9 offset:9408
    ds_read_b128 v[216:219], v9 offset:9792
    v_smfmac_f32_16x16x64_bf16 v[168:171], a[152:155], v[228:235], v29
    s_waitcnt vmcnt(12)
    v_smfmac_f32_16x16x64_bf16 v[136:139], a[156:159], v[196:203], v29 abid:1
    buffer_load_dwordx4 a[204:207], v11, s[16:19], s43 offen offset:2048 sc1
    s_waitcnt lgkmcnt(1)
    v_xad_u32 v236, v236, v3, v4
    v_smfmac_f32_16x16x64_bf16 v[172:175], a[156:159], v[228:235], v29 abid:1
    s_waitcnt vmcnt(12)
    v_xad_u32 v237, v237, v3, v4
    v_smfmac_f32_16x16x64_bf16 v[140:143], a[160:163], v[196:203], v30
    buffer_load_dwordx4 a[208:211], v11, s[16:19], s43 offen offset:3072 sc1
    ds_read2st64_b32 v[244:245], v236 offset0:0 offset1:72
    ds_read2st64_b32 v[246:247], v237 offset0:0 offset1:72
    v_xad_u32 v238, v238, v3, v4
    v_smfmac_f32_16x16x64_bf16 v[176:179], a[160:163], v[228:235], v30
    s_waitcnt vmcnt(12)
    v_xad_u32 v239, v239, v3, v4
    v_smfmac_f32_16x16x64_bf16 v[144:147], a[164:167], v[196:203], v30 abid:1
    s_add_u32 s43, s43, 4096
    buffer_load_dwordx4 a[212:215], v11, s[16:19], s43 offen offset:0 sc1
    ds_read2st64_b32 v[248:249], v238 offset0:0 offset1:72
    ds_read2st64_b32 v[250:251], v239 offset0:0 offset1:72
    ds_read_b128 v[240:243], v8 offset:3072
    ds_read_b128 v[236:239], v9 offset:9280
    s_waitcnt lgkmcnt(6)
    v_and_b32 v212, 0x3fff, v216
    v_smfmac_f32_16x16x64_bf16 v[180:183], a[164:167], v[228:235], v30 abid:1
    v_and_b32 v214, 0x3fff, v218
    s_waitcnt vmcnt(12)
    v_xad_u32 v212, v212, v3, v4
    v_smfmac_f32_16x16x64_bf16 v[148:151], a[168:171], v[196:203], v31
    buffer_load_dwordx4 v[36:39], v11, s[16:19], s43 offen offset:1024 sc1
    buffer_load_dwordx4 a[216:219], v11, s[16:19], s43 offen offset:2048 sc1
    ds_read2st64_b32 v[212:213], v212 offset0:0 offset1:72
    v_xad_u32 v214, v214, v3, v4
    v_smfmac_f32_16x16x64_bf16 v[184:187], a[168:171], v[228:235], v31
    ds_read2st64_b32 v[214:215], v214 offset0:0 offset1:72
    s_waitcnt vmcnt(13)
    v_smfmac_f32_16x16x64_bf16 v[152:155], a[172:175], v[196:203], v31 abid:1
    buffer_load_dwordx4 a[220:223], v11, s[16:19], s43 offen offset:3072 sc1
    s_waitcnt lgkmcnt(3)
    v_smfmac_f32_16x16x64_bf16 v[136:139], v[240:243], v[244:251], v10
    v_smfmac_f32_16x16x64_bf16 v[172:175], v[240:243], v[244:251], v10 abid:1
    s_waitcnt lgkmcnt(2)
    v_xad_u32 v236, v236, v3, v4
    v_smfmac_f32_16x16x64_bf16 v[188:191], a[172:175], v[228:235], v31 abid:1
    s_waitcnt vmcnt(13)
    v_xad_u32 v237, v237, v3, v4
    v_smfmac_f32_16x16x64_bf16 v[156:159], a[176:179], v[196:203], v50
    s_add_u32 s43, s43, 4096
    buffer_load_dwordx4 a[224:227], v11, s[16:19], s43 offen offset:0 sc1
    ds_read2st64_b32 v[244:245], v236 offset0:0 offset1:72
    ds_read2st64_b32 v[246:247], v237 offset0:0 offset1:72
    v_xad_u32 v238, v238, v3, v4
    v_smfmac_f32_16x16x64_bf16 v[192:195], a[176:179], v[228:235], v50
    s_waitcnt vmcnt(12)
    v_xad_u32 v239, v239, v3, v4
    v_smfmac_f32_16x16x64_bf16 v[124:127], a[180:183], v[204:211], v32
    buffer_load_dwordx4 a[228:231], v11, s[16:19], s43 offen offset:1024 sc1
    ds_read2st64_b32 v[248:249], v238 offset0:0 offset1:72
    ds_read2st64_b32 v[250:251], v239 offset0:0 offset1:72
    ds_read_b128 v[240:243], v8 offset:1024
    ds_read_b128 v[236:239], v9 offset:9344
    s_waitcnt lgkmcnt(6)
    s_and_b32 s30, s27, 7
    s_cbranch_scc1 M_ov0
M_ovp0:
    v_smfmac_f32_16x16x64_bf16 v[160:163], a[180:183], v[220:227], v32
    ds_read_b128 v[196:199], v1 offset:6144
    ds_read_b128 v[200:203], v2 offset:6144
    s_waitcnt vmcnt(12)
    v_smfmac_f32_16x16x64_bf16 v[128:131], a[184:187], v[204:211], v32 abid:1
    buffer_load_dwordx4 a[232:235], v11, s[16:19], s43 offen offset:2048 sc1
    v_smfmac_f32_16x16x64_bf16 v[164:167], a[184:187], v[220:227], v32 abid:1
    ds_read_b128 v[228:231], v1 offset:24576
    ds_read_b128 v[232:235], v2 offset:24576
    s_waitcnt vmcnt(12)
    v_smfmac_f32_16x16x64_bf16 v[132:135], a[188:191], v[204:211], v33
    buffer_load_dwordx4 a[236:239], v11, s[16:19], s43 offen offset:3072 sc1
    s_waitcnt lgkmcnt(5)
    v_smfmac_f32_16x16x64_bf16 v[128:131], v[240:243], v[244:251], v10
    v_smfmac_f32_16x16x64_bf16 v[164:167], v[240:243], v[244:251], v10 abid:1
    s_waitcnt lgkmcnt(4)
    v_xad_u32 v236, v236, v3, v4
    v_smfmac_f32_16x16x64_bf16 v[168:171], a[188:191], v[220:227], v33
    s_waitcnt vmcnt(12)
    v_xad_u32 v237, v237, v3, v4
    v_smfmac_f32_16x16x64_bf16 v[136:139], a[192:195], v[204:211], v33 abid:1
    s_add_u32 s43, s43, 4096
    buffer_load_dwordx4 a[240:243], v11, s[16:19], s43 offen offset:0 sc1
    ds_read2st64_b32 v[244:245], v236 offset0:0 offset1:72
    ds_read2st64_b32 v[246:247], v237 offset0:0 offset1:72
    v_xad_u32 v238, v238, v3, v4
    v_smfmac_f32_16x16x64_bf16 v[172:175], a[192:195], v[220:227], v33 abid:1
    s_waitcnt vmcnt(12)
    v_xad_u32 v239, v239, v3, v4
    v_smfmac_f32_16x16x64_bf16 v[140:143], a[196:199], v[204:211], v34
    buffer_load_dwordx4 a[244:247], v11, s[16:19], s43 offen offset:1024 sc1
    ds_read2st64_b32 v[248:249], v238 offset0:0 offset1:72
    ds_read2st64_b32 v[250:251], v239 offset0:0 offset1:72
    ds_read_b128 v[240:243], v8 offset:2048
    ds_read_b128 v[236:239], v9 offset:9216
    s_and_b32 s30, s27, 56
    s_cbranch_scc1 M_ov1
M_ovp1:
    v_smfmac_f32_16x16x64_bf16 v[176:179], a[196:199], v[220:227], v34
    s_waitcnt vmcnt(12)
    v_smfmac_f32_16x16x64_bf16 v[144:147], a[200:203], v[204:211], v34 abid:1
    buffer_load_dwordx4 a[248:251], v11, s[16:19], s43 offen offset:2048 sc1
    v_smfmac_f32_16x16x64_bf16 v[180:183], a[200:203], v[220:227], v34 abid:1
    s_waitcnt vmcnt(12)
    v_smfmac_f32_16x16x64_bf16 v[148:151], a[204:207], v[204:211], v35
    buffer_load_dwordx4 v[40:43], v11, s[16:19], s43 offen offset:3072 sc1
    s_add_u32 s43, s43, 4096
    buffer_load_dwordx4 a[252:255], v11, s[16:19], s43 offen offset:0 sc1
    s_waitcnt lgkmcnt(1)
    v_smfmac_f32_16x16x64_bf16 v[132:135], v[240:243], v[244:251], v10
    v_smfmac_f32_16x16x64_bf16 v[168:171], v[240:243], v[244:251], v10 abid:1
    s_waitcnt lgkmcnt(0)
    v_xad_u32 v236, v236, v3, v4
    v_smfmac_f32_16x16x64_bf16 v[184:187], a[204:207], v[220:227], v35
    s_waitcnt vmcnt(13)
    v_xad_u32 v237, v237, v3, v4
    v_smfmac_f32_16x16x64_bf16 v[152:155], a[208:211], v[204:211], v35 abid:1
    buffer_load_dwordx4 v[56:59], v11, s[16:19], s43 offen offset:1024 sc1
    ds_read2st64_b32 v[244:245], v236 offset0:0 offset1:72
    ds_read2st64_b32 v[246:247], v237 offset0:0 offset1:72
    v_xad_u32 v238, v238, v3, v4
    v_smfmac_f32_16x16x64_bf16 v[188:191], a[208:211], v[220:227], v35 abid:1
    s_waitcnt vmcnt(13)
    v_xad_u32 v239, v239, v3, v4
    v_smfmac_f32_16x16x64_bf16 v[156:159], a[212:215], v[204:211], v50 abid:1
    buffer_load_dwordx4 v[60:63], v11, s[16:19], s43 offen offset:2048 sc1
    ds_read2st64_b32 v[248:249], v238 offset0:0 offset1:72
    ds_read2st64_b32 v[250:251], v239 offset0:0 offset1:72
    ds_read_b128 v[240:243], v8 offset:0
    ds_read_b128 v[236:239], v9 offset:9728
    s_and_b32 s30, s27, 448
    s_cbranch_scc1 M_ov2
M_ovp2:
    v_smfmac_f32_16x16x64_bf16 v[192:195], a[212:215], v[220:227], v50 abid:1
    s_waitcnt vmcnt(12)
    v_smfmac_f32_16x16x64_bf16 v[124:127], a[216:219], v[196:203], v36
    buffer_load_dwordx4 v[64:67], v11, s[16:19], s43 offen offset:3072 sc1
    v_smfmac_f32_16x16x64_bf16 v[160:163], a[216:219], v[228:235], v36
    ds_read_b128 v[204:207], v1 offset:7168
    ds_read_b128 v[208:211], v2 offset:7168
    s_waitcnt vmcnt(12)
    v_smfmac_f32_16x16x64_bf16 v[128:131], a[220:223], v[196:203], v36 abid:1
    s_add_u32 s43, s43, 4096
    buffer_load_dwordx4 v[68:71], v11, s[16:19], s43 offen offset:0 sc1
    s_waitcnt lgkmcnt(3)
    v_smfmac_f32_16x16x64_bf16 v[124:127], v[240:243], v[244:251], v10
    v_smfmac_f32_16x16x64_bf16 v[160:163], v[240:243], v[244:251], v10 abid:1
    s_waitcnt lgkmcnt(2)
    v_xad_u32 v236, v236, v3, v4
    v_smfmac_f32_16x16x64_bf16 v[164:167], a[220:223], v[228:235], v36 abid:1
    ds_read_b128 v[220:223], v1 offset:25600
    ds_read_b128 v[224:227], v2 offset:25600
    s_waitcnt vmcnt(12)
    v_xad_u32 v237, v237, v3, v4
    v_smfmac_f32_16x16x64_bf16 v[132:135], a[224:227], v[196:203], v37
    buffer_load_dwordx4 v[72:75], v11, s[16:19], s43 offen offset:1024 sc1
    ds_read2st64_b32 v[244:245], v236 offset0:0 offset1:72
    ds_read2st64_b32 v[246:247], v237 offset0:0 offset1:72
    v_xad_u32 v238, v238, v3, v4
    v_smfmac_f32_16x16x64_bf16 v[168:171], a[224:227], v[228:235], v37
    s_waitcnt vmcnt(12)
    v_xad_u32 v239, v239, v3, v4
    v_smfmac_f32_16x16x64_bf16 v[136:139], a[228:231], v[196:203], v37 abid:1
    buffer_load_dwordx4 v[76:79], v11, s[16:19], s43 offen offset:2048 sc1
    ds_read2st64_b32 v[248:249], v238 offset0:0 offset1:72
    ds_read2st64_b32 v[250:251], v239 offset0:0 offset1:72
    ds_read_b128 v[240:243], v8 offset:8192
    ds_read_b128 v[236:239], v9 offset:9664
    v_smfmac_f32_16x16x64_bf16 v[172:175], a[228:231], v[228:235], v37 abid:1
    s_waitcnt vmcnt(12)
    v_smfmac_f32_16x16x64_bf16 v[140:143], a[232:235], v[196:203], v38
    buffer_load_dwordx4 v[80:83], v11, s[16:19], s43 offen offset:3072 sc1
    v_smfmac_f32_16x16x64_bf16 v[176:179], a[232:235], v[228:235], v38
    s_waitcnt vmcnt(12)
    v_smfmac_f32_16x16x64_bf16 v[144:147], a[236:239], v[196:203], v38 abid:1
    s_add_u32 s43, s43, 4096
    buffer_load_dwordx4 v[84:87], v11, s[16:19], s43 offen offset:0 sc1
    s_waitcnt lgkmcnt(1)
    v_smfmac_f32_16x16x64_bf16 v[156:159], v[240:243], v[244:251], v10
    v_smfmac_f32_16x16x64_bf16 v[192:195], v[240:243], v[244:251], v10 abid:1
    s_waitcnt lgkmcnt(0)
    v_xad_u32 v236, v236, v3, v4
    v_smfmac_f32_16x16x64_bf16 v[180:183], a[236:239], v[228:235], v38 abid:1
    s_waitcnt vmcnt(12)
    v_xad_u32 v237, v237, v3, v4
    v_smfmac_f32_16x16x64_bf16 v[148:151], a[240:243], v[196:203], v39
    buffer_load_dwordx4 v[44:47], v11, s[16:19], s43 offen offset:1024 sc1
    buffer_load_dwordx4 v[88:91], v11, s[16:19], s43 offen offset:2048 sc1
    ds_read2st64_b32 v[244:245], v236 offset0:0 offset1:72
    ds_read2st64_b32 v[246:247], v237 offset0:0 offset1:72
    v_xad_u32 v238, v238, v3, v4
    v_smfmac_f32_16x16x64_bf16 v[184:187], a[240:243], v[228:235], v39
    s_waitcnt vmcnt(13)
    v_xad_u32 v239, v239, v3, v4
    v_smfmac_f32_16x16x64_bf16 v[152:155], a[244:247], v[196:203], v39 abid:1
    buffer_load_dwordx4 v[92:95], v11, s[16:19], s43 offen offset:3072 sc1
    ds_read2st64_b32 v[248:249], v238 offset0:0 offset1:72
    ds_read2st64_b32 v[250:251], v239 offset0:0 offset1:72
    ds_read_b128 v[240:243], v8 offset:7168
    ds_read_b128 v[236:239], v9 offset:9536
    v_smfmac_f32_16x16x64_bf16 v[188:191], a[244:247], v[228:235], v39 abid:1
    s_waitcnt vmcnt(13)
    v_smfmac_f32_16x16x64_bf16 v[156:159], a[248:251], v[196:203], v51
    s_add_u32 s43, s43, 4096
    buffer_load_dwordx4 v[96:99], v11, s[16:19], s43 offen offset:0 sc1
    v_smfmac_f32_16x16x64_bf16 v[192:195], a[248:251], v[228:235], v51
    s_waitcnt vmcnt(12)
    v_smfmac_f32_16x16x64_bf16 v[124:127], a[252:255], v[204:211], v40
    buffer_load_dwordx4 v[100:103], v11, s[16:19], s43 offen offset:1024 sc1
    ds_read_b128 v[196:199], v1 offset:8192
    ds_read_b128 v[200:203], v2 offset:8192
    s_waitcnt lgkmcnt(3)
    v_smfmac_f32_16x16x64_bf16 v[152:155], v[240:243], v[244:251], v10
    v_smfmac_f32_16x16x64_bf16 v[188:191], v[240:243], v[244:251], v10 abid:1
    s_waitcnt lgkmcnt(2)
    v_xad_u32 v236, v236, v3, v4
    s_waitcnt vmcnt(12)
    v_xad_u32 v237, v237, v3, v4
    v_smfmac_f32_16x16x64_bf16 v[128:131], v[56:59], v[204:211], v40 abid:1
    buffer_load_dwordx4 v[104:107], v11, s[16:19], s43 offen offset:2048 sc1
    ds_read_b128 v[228:231], v1 offset:26624
    ds_read_b128 v[232:235], v2 offset:26624
    ds_read2st64_b32 v[244:245], v236 offset0:0 offset1:72
    ds_read2st64_b32 v[246:247], v237 offset0:0 offset1:72
    v_xad_u32 v238, v238, v3, v4
    s_waitcnt vmcnt(12)
    v_xad_u32 v239, v239, v3, v4
    v_smfmac_f32_16x16x64_bf16 v[132:135], v[60:63], v[204:211], v41
    buffer_load_dwordx4 v[108:111], v11, s[16:19], s43 offen offset:3072 sc1
    ds_read2st64_b32 v[248:249], v238 offset0:0 offset1:72
    ds_read2st64_b32 v[250:251], v239 offset0:0 offset1:72
    ds_read_b128 v[240:243], v8 offset:5120
    ds_read_b128 v[236:239], v9 offset:9600
    s_waitcnt vmcnt(12)
    v_smfmac_f32_16x16x64_bf16 v[136:139], v[64:67], v[204:211], v41 abid:1
    s_add_u32 s43, s43, 4096
    buffer_load_dwordx4 v[112:115], v11, s[16:19], s43 offen offset:0 sc1
    s_waitcnt vmcnt(12)
    v_smfmac_f32_16x16x64_bf16 v[140:143], v[68:71], v[204:211], v42
    buffer_load_dwordx4 v[116:119], v11, s[16:19], s43 offen offset:1024 sc1
    s_waitcnt lgkmcnt(1)
    v_smfmac_f32_16x16x64_bf16 v[144:147], v[240:243], v[244:251], v10
    v_smfmac_f32_16x16x64_bf16 v[180:183], v[240:243], v[244:251], v10 abid:1
    s_waitcnt lgkmcnt(0)
    v_xad_u32 v236, v236, v3, v4
    s_waitcnt vmcnt(12)
    v_xad_u32 v237, v237, v3, v4
    v_smfmac_f32_16x16x64_bf16 v[144:147], v[72:75], v[204:211], v42 abid:1
    buffer_load_dwordx4 v[120:123], v11, s[16:19], s43 offen offset:2048 sc1
    ds_read2st64_b32 v[244:245], v236 offset0:0 offset1:72
    ds_read2st64_b32 v[246:247], v237 offset0:0 offset1:72
    v_xad_u32 v238, v238, v3, v4
    s_waitcnt vmcnt(12)
    v_xad_u32 v239, v239, v3, v4
    v_smfmac_f32_16x16x64_bf16 v[148:151], v[76:79], v[204:211], v43
    s_mov_b32 m0, s42
    s_nop 0
    buffer_load_dwordx4 v5, s[8:11], s22 offen offset:0 nt lds
    buffer_load_dword v254, v254, s[8:11], 0 offen
    ds_read2st64_b32 v[248:249], v238 offset0:0 offset1:72
    ds_read2st64_b32 v[250:251], v239 offset0:0 offset1:72
    ds_read_b128 v[240:243], v8 offset:6144
    ds_read_b128 v[236:239], v9 offset:9472
    s_waitcnt vmcnt(13)
    v_smfmac_f32_16x16x64_bf16 v[152:155], v[80:83], v[204:211], v43 abid:1
    s_add_u32 m0, m0, 896
    s_nop 0
    buffer_load_dwordx4 v5, s[8:11], s22 offen offset:128 nt lds
    s_waitcnt vmcnt(13)
    v_smfmac_f32_16x16x64_bf16 v[156:159], v[84:87], v[204:211], v51 abid:1
    s_add_u32 m0, m0, 896
    s_nop 0
    buffer_load_dwordx4 v5, s[8:11], s22 offen offset:256 nt lds
    s_waitcnt lgkmcnt(1)
    v_smfmac_f32_16x16x64_bf16 v[148:151], v[240:243], v[244:251], v10
    v_smfmac_f32_16x16x64_bf16 v[184:187], v[240:243], v[244:251], v10 abid:1
    s_waitcnt lgkmcnt(0)
    v_xad_u32 v236, v236, v3, v4
    s_waitcnt vmcnt(12)
    v_xad_u32 v237, v237, v3, v4
    v_smfmac_f32_16x16x64_bf16 v[124:127], v[88:91], v[196:203], v44
    s_add_u32 m0, m0, 896
    s_nop 0
    buffer_load_dwordx4 v5, s[8:11], s22 offen offset:384 nt lds
    ds_read2st64_b32 v[244:245], v236 offset0:0 offset1:72
    ds_read2st64_b32 v[246:247], v237 offset0:0 offset1:72
    v_xad_u32 v238, v238, v3, v4
    s_waitcnt vmcnt(12)
    v_xad_u32 v239, v239, v3, v4
    v_smfmac_f32_16x16x64_bf16 v[128:131], v[92:95], v[196:203], v44 abid:1
    ds_read2st64_b32 v[248:249], v238 offset0:0 offset1:72
    ds_read2st64_b32 v[250:251], v239 offset0:0 offset1:72
    ds_read_b128 v[240:243], v8 offset:4096
    s_waitcnt vmcnt(11)
    v_smfmac_f32_16x16x64_bf16 v[132:135], v[96:99], v[196:203], v45
    s_waitcnt vmcnt(10)
    v_smfmac_f32_16x16x64_bf16 v[136:139], v[100:103], v[196:203], v45 abid:1
    s_waitcnt lgkmcnt(0)
    v_smfmac_f32_16x16x64_bf16 v[140:143], v[240:243], v[244:251], v10
    v_smfmac_f32_16x16x64_bf16 v[176:179], v[240:243], v[244:251], v10 abid:1
    s_waitcnt vmcnt(9)
    v_smfmac_f32_16x16x64_bf16 v[140:143], v[104:107], v[196:203], v46
    s_waitcnt vmcnt(8)
    v_smfmac_f32_16x16x64_bf16 v[144:147], v[108:111], v[196:203], v46 abid:1
    s_waitcnt vmcnt(7)
    v_smfmac_f32_16x16x64_bf16 v[148:151], v[112:115], v[196:203], v47
    s_waitcnt vmcnt(6)
    v_smfmac_f32_16x16x64_bf16 v[152:155], v[116:119], v[196:203], v47 abid:1
    s_waitcnt vmcnt(5)
    v_smfmac_f32_16x16x64_bf16 v[156:159], v[120:123], v[196:203], v52
    s_cmp_gt_u32 s46, 1
    s_cbranch_scc1 M_slow
M_slowr0:
    v_cvt_pk_bf16_f32 v124, v124, v125
    v_cvt_pk_bf16_f32 v125, v126, v127
    v_cvt_pk_bf16_f32 v126, v128, v129
    v_cvt_pk_bf16_f32 v127, v130, v131
    v_cvt_pk_bf16_f32 v132, v132, v133
    v_cvt_pk_bf16_f32 v133, v134, v135
    v_cvt_pk_bf16_f32 v134, v136, v137
    v_cvt_pk_bf16_f32 v135, v138, v139
    ds_read_b128 v[136:139], v9 offset:10432
    v_cndmask_b32_dpp v128, v124, v132, vcc row_ror:8 row_mask:0xf bank_mask:0xf
    v_cndmask_b32_dpp v129, v125, v133, vcc row_ror:8 row_mask:0xf bank_mask:0xf
    v_cndmask_b32_dpp v130, v126, v134, vcc row_ror:8 row_mask:0xf bank_mask:0xf
    v_cndmask_b32_dpp v131, v127, v135, vcc row_ror:8 row_mask:0xf bank_mask:0xf
    buffer_store_dwordx4 v[128:131], v6, s[12:15], s59 offen offset:0 sc1
    v_mov_b32_dpp v124, v132 row_ror:8 row_mask:0xf bank_mask:0xc
    v_mov_b32_dpp v125, v133 row_ror:8 row_mask:0xf bank_mask:0xc
    v_mov_b32_dpp v126, v134 row_ror:8 row_mask:0xf bank_mask:0xc
    v_mov_b32_dpp v127, v135 row_ror:8 row_mask:0xf bank_mask:0xc
    buffer_store_dwordx4 v[124:127], v6, s[12:15], s24 offen offset:0 sc1
    ds_read_b128 v[128:131], v9 offset:10304
    ds_read_b128 v[132:135], v9 offset:10368
    ds_read_b128 v[124:127], v9 offset:10240
    v_cvt_pk_bf16_f32 v140, v140, v141
    v_cvt_pk_bf16_f32 v141, v142, v143
    v_cvt_pk_bf16_f32 v142, v144, v145
    v_cvt_pk_bf16_f32 v143, v146, v147
    v_cvt_pk_bf16_f32 v148, v148, v149
    v_cvt_pk_bf16_f32 v149, v150, v151
    v_cvt_pk_bf16_f32 v150, v152, v153
    v_cvt_pk_bf16_f32 v151, v154, v155
    ds_read_b128 v[152:155], v9 offset:10688
    v_cndmask_b32_dpp v144, v140, v148, vcc row_ror:8 row_mask:0xf bank_mask:0xf
    v_cndmask_b32_dpp v145, v141, v149, vcc row_ror:8 row_mask:0xf bank_mask:0xf
    v_cndmask_b32_dpp v146, v142, v150, vcc row_ror:8 row_mask:0xf bank_mask:0xf
    v_cndmask_b32_dpp v147, v143, v151, vcc row_ror:8 row_mask:0xf bank_mask:0xf
    buffer_store_dwordx4 v[144:147], v6, s[12:15], s59 offen offset:128 sc1
    v_mov_b32_dpp v140, v148 row_ror:8 row_mask:0xf bank_mask:0xc
    v_mov_b32_dpp v141, v149 row_ror:8 row_mask:0xf bank_mask:0xc
    v_mov_b32_dpp v142, v150 row_ror:8 row_mask:0xf bank_mask:0xc
    v_mov_b32_dpp v143, v151 row_ror:8 row_mask:0xf bank_mask:0xc
    buffer_store_dwordx4 v[140:143], v6, s[12:15], s24 offen offset:128 sc1
    ds_read_b128 v[144:147], v9 offset:10560
    ds_read_b128 v[148:151], v9 offset:10624
    ds_read_b128 v[140:143], v9 offset:10496
    v_cvt_pk_bf16_f32 v156, v156, v157
    v_cvt_pk_bf16_f32 v157, v158, v159
    ds_write_b64 v252, v[156:157] offset:25728
    ds_read_b128 v[156:159], v9 offset:10752
    s_mov_b32 s91, 0
    s_mov_b32 s25, 36864
    s_add_u32 s90, s24, 9437184
    s_mov_b32 s28, s26
    s_add_u32 s23, s24, 18432
    s_cmp_lt_u32 s20, 2
    s_cselect_b32 s66, s23, s24
    s_add_u32 s66, s66, s95
    v_add_u32 v4, 36864, v4
    v_add_u32 v1, 36864, v1
    v_add_u32 v2, 36864, v2
    s_branch M_top1
M_top:
    s_waitcnt vmcnt(8)
M_top1:
    s_add_u32 s23, s24, 18432
    s_add_u32 s58, s24, 27648
    s_mov_b32 s24, s90
    s_add_u32 s59, s90, 9216
    s_waitcnt lgkmcnt(0)
    s_barrier
    ds_read_b128 v[244:247], v8 offset:10816
    v_smfmac_f32_16x16x64_bf16 v[160:163], a[252:255], v[220:227], v40
    ds_read_b128 v[196:199], v1 offset:0
    v_smfmac_f32_16x16x64_bf16 v[160:163], v[88:91], v[228:235], v44
    ds_read_b128 v[200:203], v2 offset:0
    s_cmp_lt_u32 s22, 75497472
    s_cbranch_scc0 M_bF
    s_cmp_lt_u32 s91, 2
    s_cbranch_scc1 M_bE0
M_bL:
    v_smfmac_f32_16x16x64_bf16 v[164:167], v[56:59], v[220:227], v40 abid:1
    ds_read_b128 v[204:207], v1 offset:1024
    v_smfmac_f32_16x16x64_bf16 v[164:167], v[92:95], v[228:235], v44 abid:1
    ds_read_b128 v[208:211], v2 offset:1024
    v_mov_b32 v0, 1
    v_smfmac_f32_16x16x64_bf16 v[168:171], v[60:63], v[220:227], v41
    ds_read_b128 v[212:215], v1 offset:2048
    v_smfmac_f32_16x16x64_bf16 v[168:171], v[96:99], v[228:235], v45
    ds_read_b128 v[216:219], v2 offset:2048
    v_smfmac_f32_16x16x64_bf16 v[172:175], v[64:67], v[220:227], v41 abid:1
    s_waitcnt vmcnt(6)
    s_waitcnt lgkmcnt(6)
    buffer_store_dwordx4 v[244:247], v7, s[12:15], s66 offen sc1
    v_smfmac_f32_16x16x64_bf16 v[172:175], v[100:103], v[228:235], v45 abid:1
    ds_read_b128 v[236:239], v9 offset:9408
    v_smfmac_f32_16x16x64_bf16 v[176:179], v[68:71], v[220:227], v42
    s_waitcnt vmcnt(7)
    buffer_atomic_add v0, v253, s[16:19], s92 offen sc0 sc1
    s_mov_b32 s21, 1
    v_smfmac_f32_16x16x64_bf16 v[176:179], v[104:107], v[228:235], v46
    v_smfmac_f32_16x16x64_bf16 v[180:183], v[72:75], v[220:227], v42 abid:1
    v_cvt_pk_bf16_f32 v160, v160, v161
    v_smfmac_f32_16x16x64_bf16 v[180:183], v[108:111], v[228:235], v46 abid:1
    v_cvt_pk_bf16_f32 v161, v162, v163
    v_smfmac_f32_16x16x64_bf16 v[184:187], v[76:79], v[220:227], v43
    v_cvt_pk_bf16_f32 v162, v164, v165
    v_smfmac_f32_16x16x64_bf16 v[184:187], v[112:115], v[228:235], v47
    v_cvt_pk_bf16_f32 v163, v166, v167
    v_smfmac_f32_16x16x64_bf16 v[188:191], v[80:83], v[220:227], v43 abid:1
    s_add_u32 m0, m0, 896
    v_cvt_pk_bf16_f32 v168, v168, v169
    v_smfmac_f32_16x16x64_bf16 v[188:191], v[116:119], v[228:235], v47 abid:1
    s_waitcnt vmcnt(6)
    buffer_load_dwordx4 v5, s[8:11], s22 offen offset:512 nt lds
    v_cvt_pk_bf16_f32 v169, v170, v171
    v_smfmac_f32_16x16x64_bf16 v[192:195], v[84:87], v[220:227], v51 abid:1
    v_cvt_pk_bf16_f32 v170, v172, v173
    v_smfmac_f32_16x16x64_bf16 v[192:195], v[120:123], v[228:235], v52
    ds_read_b128 v[220:223], v1 offset:3072
    s_waitcnt lgkmcnt(6)
    v_cvt_pk_bf16_f32 v171, v174, v175
    v_smfmac_f32_16x16x64_bf16 v[124:127], a[0:3], v[196:203], v12
    ds_read_b128 v[224:227], v2 offset:3072
    ds_read_b128 v[172:175], v9 offset:10432
    s_waitcnt lgkmcnt(6)
    v_cndmask_b32_dpp v164, v160, v168, vcc row_ror:8 row_mask:0xf bank_mask:0xf
    v_smfmac_f32_16x16x64_bf16 v[124:127], a[36:39], v[204:211], v16
    ds_read_b128 v[228:231], v1 offset:4096
    s_waitcnt lgkmcnt(5)
    v_cndmask_b32_dpp v165, v161, v169, vcc row_ror:8 row_mask:0xf bank_mask:0xf
    v_smfmac_f32_16x16x64_bf16 v[124:127], a[72:75], v[212:219], v20
    ds_read_b128 v[232:235], v2 offset:4096
    v_cndmask_b32_dpp v166, v162, v170, vcc row_ror:8 row_mask:0xf bank_mask:0xf
    v_smfmac_f32_16x16x64_bf16 v[128:131], a[4:7], v[196:203], v12 abid:1
    s_barrier
    v_cndmask_b32_dpp v167, v163, v171, vcc row_ror:8 row_mask:0xf bank_mask:0xf
    v_smfmac_f32_16x16x64_bf16 v[128:131], a[40:43], v[204:211], v16 abid:1
    s_waitcnt vmcnt(7)
    buffer_store_dwordx4 v[164:167], v6, s[12:15], s58 offen offset:0 sc1
    s_waitcnt lgkmcnt(5)
    v_xad_u32 v236, v236, v3, v4
    v_smfmac_f32_16x16x64_bf16 v[128:131], a[76:79], v[212:219], v20 abid:1
    v_xad_u32 v237, v237, v3, v4
    v_smfmac_f32_16x16x64_bf16 v[132:135], a[8:11], v[196:203], v13
    ds_read2st64_b32 v[244:245], v236 offset0:0 offset1:72
    ds_read_b128 v[240:243], v8 offset:3072
    v_xad_u32 v238, v238, v3, v4
    v_smfmac_f32_16x16x64_bf16 v[132:135], a[44:47], v[204:211], v17
    ds_read2st64_b32 v[246:247], v237 offset0:0 offset1:72
    v_xad_u32 v239, v239, v3, v4
    v_smfmac_f32_16x16x64_bf16 v[132:135], a[80:83], v[212:219], v21
    ds_read2st64_b32 v[248:249], v238 offset0:0 offset1:72
    v_mov_b32_dpp v160, v168 row_ror:8 row_mask:0xf bank_mask:0xc
    v_smfmac_f32_16x16x64_bf16 v[136:139], a[12:15], v[196:203], v13 abid:1
    ds_read2st64_b32 v[250:251], v239 offset0:0 offset1:72
    ds_read_b128 v[236:239], v9 offset:9280
    v_mov_b32_dpp v161, v169 row_ror:8 row_mask:0xf bank_mask:0xc
    v_smfmac_f32_16x16x64_bf16 v[136:139], a[48:51], v[204:211], v17 abid:1
    v_mov_b32_dpp v162, v170 row_ror:8 row_mask:0xf bank_mask:0xc
    v_smfmac_f32_16x16x64_bf16 v[136:139], a[84:87], v[212:219], v21 abid:1
    v_mov_b32_dpp v163, v171 row_ror:8 row_mask:0xf bank_mask:0xc
    v_smfmac_f32_16x16x64_bf16 v[140:143], a[16:19], v[196:203], v14
    s_waitcnt vmcnt(6)
    buffer_store_dwordx4 v[160:163], v6, s[12:15], s23 offen offset:0 sc1
    ds_read_b128 v[164:167], v9 offset:10304
    v_smfmac_f32_16x16x64_bf16 v[140:143], a[52:55], v[204:211], v18
    ds_read_b128 v[168:171], v9 offset:10368
    ds_read_b128 v[160:163], v9 offset:10240
    v_smfmac_f32_16x16x64_bf16 v[140:143], a[88:91], v[212:219], v22
    v_smfmac_f32_16x16x64_bf16 v[144:147], a[20:23], v[196:203], v14 abid:1
    v_smfmac_f32_16x16x64_bf16 v[144:147], a[56:59], v[204:211], v18 abid:1
    v_smfmac_f32_16x16x64_bf16 v[144:147], a[92:95], v[212:219], v22 abid:1
    s_waitcnt lgkmcnt(3)
    v_xad_u32 v236, v236, v3, v4
    v_smfmac_f32_16x16x64_bf16 v[136:139], v[240:243], v[244:251], v10
    v_xad_u32 v237, v237, v3, v4
    v_smfmac_f32_16x16x64_bf16 v[172:175], v[240:243], v[244:251], v10 abid:1
    ds_read2st64_b32 v[244:245], v236 offset0:0 offset1:72
    ds_read_b128 v[240:243], v8 offset:1024
    v_xad_u32 v238, v238, v3, v4
    v_smfmac_f32_16x16x64_bf16 v[148:151], a[24:27], v[196:203], v15
    ds_read2st64_b32 v[246:247], v237 offset0:0 offset1:72
    v_xad_u32 v239, v239, v3, v4
    v_smfmac_f32_16x16x64_bf16 v[148:151], a[60:63], v[204:211], v19
    ds_read2st64_b32 v[248:249], v238 offset0:0 offset1:72
    v_cvt_pk_bf16_f32 v192, v192, v193
    v_smfmac_f32_16x16x64_bf16 v[148:151], a[96:99], v[212:219], v23
    ds_read2st64_b32 v[250:251], v239 offset0:0 offset1:72
    ds_read_b128 v[236:239], v9 offset:9344
    v_cvt_pk_bf16_f32 v193, v194, v195
    v_smfmac_f32_16x16x64_bf16 v[152:155], a[28:31], v[196:203], v15 abid:1
    ds_write_b64 v252, v[192:193] offset:0
    ds_read_b128 v[192:195], v9 offset:10752
    v_smfmac_f32_16x16x64_bf16 v[152:155], a[64:67], v[204:211], v19 abid:1
    s_add_u32 m0, m0, 896
    v_smfmac_f32_16x16x64_bf16 v[152:155], a[100:103], v[212:219], v23 abid:1
    s_waitcnt vmcnt(7)
    buffer_load_dwordx4 v5, s[8:11], s22 offen offset:640 nt lds
    v_smfmac_f32_16x16x64_bf16 v[156:159], a[32:35], v[196:203], v48
    v_smfmac_f32_16x16x64_bf16 v[156:159], a[68:71], v[204:211], v48 abid:1
    v_smfmac_f32_16x16x64_bf16 v[156:159], a[104:107], v[212:219], v49
    ds_read_b128 v[196:199], v1 offset:5120
    v_cvt_pk_bf16_f32 v176, v176, v177
    v_smfmac_f32_16x16x64_bf16 v[124:127], a[108:111], v[220:227], v24
    ds_read_b128 v[200:203], v2 offset:5120
    v_cvt_pk_bf16_f32 v177, v178, v179
    v_smfmac_f32_16x16x64_bf16 v[124:127], a[144:147], v[228:235], v28
    ds_read_b128 v[204:207], v1 offset:6144
    ds_read_b128 v[216:219], v9 offset:9792
    v_cvt_pk_bf16_f32 v178, v180, v181
    v_smfmac_f32_16x16x64_bf16 v[128:131], a[112:115], v[220:227], v24 abid:1
    ds_read_b128 v[208:211], v2 offset:6144
    v_cvt_pk_bf16_f32 v179, v182, v183
    v_smfmac_f32_16x16x64_bf16 v[128:131], a[148:151], v[228:235], v28 abid:1
    s_waitcnt lgkmcnt(7)
    v_xad_u32 v236, v236, v3, v4
    v_smfmac_f32_16x16x64_bf16 v[128:131], v[240:243], v[244:251], v10
    s_add_u32 m0, m0, 896
    v_xad_u32 v237, v237, v3, v4
    v_smfmac_f32_16x16x64_bf16 v[164:167], v[240:243], v[244:251], v10 abid:1
    ds_read2st64_b32 v[244:245], v236 offset0:0 offset1:72
    ds_read_b128 v[240:243], v8 offset:2048
    v_xad_u32 v238, v238, v3, v4
    v_smfmac_f32_16x16x64_bf16 v[132:135], a[116:119], v[220:227], v25
    ds_read2st64_b32 v[246:247], v237 offset0:0 offset1:72
    s_waitcnt vmcnt(6)
    v_xad_u32 v239, v239, v3, v4
    v_smfmac_f32_16x16x64_bf16 v[132:135], a[152:155], v[228:235], v29
    ds_read2st64_b32 v[248:249], v238 offset0:0 offset1:72
    buffer_load_dwordx4 v5, s[8:11], s22 offen offset:768 nt lds
    v_cvt_pk_bf16_f32 v184, v184, v185
    v_smfmac_f32_16x16x64_bf16 v[136:139], a[120:123], v[220:227], v25 abid:1
    ds_read2st64_b32 v[250:251], v239 offset0:0 offset1:72
    ds_read_b128 v[236:239], v9 offset:9216
    v_cvt_pk_bf16_f32 v185, v186, v187
    v_smfmac_f32_16x16x64_bf16 v[136:139], a[156:159], v[228:235], v29 abid:1
    v_cvt_pk_bf16_f32 v186, v188, v189
    v_smfmac_f32_16x16x64_bf16 v[140:143], a[124:127], v[220:227], v26
    v_cvt_pk_bf16_f32 v187, v190, v191
    v_smfmac_f32_16x16x64_bf16 v[140:143], a[160:163], v[228:235], v30
    ds_read_b128 v[188:191], v9 offset:10688
    v_cndmask_b32_dpp v180, v176, v184, vcc row_ror:8 row_mask:0xf bank_mask:0xf
    v_smfmac_f32_16x16x64_bf16 v[144:147], a[128:131], v[220:227], v26 abid:1
    v_cndmask_b32_dpp v181, v177, v185, vcc row_ror:8 row_mask:0xf bank_mask:0xf
    v_smfmac_f32_16x16x64_bf16 v[144:147], a[164:167], v[228:235], v30 abid:1
    v_cndmask_b32_dpp v182, v178, v186, vcc row_ror:8 row_mask:0xf bank_mask:0xf
    v_smfmac_f32_16x16x64_bf16 v[148:151], a[132:135], v[220:227], v27
    v_cndmask_b32_dpp v183, v179, v187, vcc row_ror:8 row_mask:0xf bank_mask:0xf
    v_smfmac_f32_16x16x64_bf16 v[148:151], a[168:171], v[228:235], v31
    s_waitcnt vmcnt(7)
    buffer_store_dwordx4 v[180:183], v6, s[12:15], s58 offen offset:128 sc1
    v_mov_b32_dpp v176, v184 row_ror:8 row_mask:0xf bank_mask:0xc
    v_smfmac_f32_16x16x64_bf16 v[152:155], a[136:139], v[220:227], v27 abid:1
    v_mov_b32_dpp v177, v185 row_ror:8 row_mask:0xf bank_mask:0xc
    v_smfmac_f32_16x16x64_bf16 v[152:155], a[172:175], v[228:235], v31 abid:1
    s_waitcnt lgkmcnt(1)
    v_xad_u32 v236, v236, v3, v4
    v_smfmac_f32_16x16x64_bf16 v[132:135], v[240:243], v[244:251], v10
    v_xad_u32 v237, v237, v3, v4
    v_smfmac_f32_16x16x64_bf16 v[168:171], v[240:243], v[244:251], v10 abid:1
    ds_read2st64_b32 v[244:245], v236 offset0:0 offset1:72
    ds_read_b128 v[240:243], v8 offset:0
    v_xad_u32 v238, v238, v3, v4
    v_smfmac_f32_16x16x64_bf16 v[156:159], a[140:143], v[220:227], v49 abid:1
    ds_read2st64_b32 v[246:247], v237 offset0:0 offset1:72
    v_xad_u32 v239, v239, v3, v4
    v_smfmac_f32_16x16x64_bf16 v[156:159], a[176:179], v[228:235], v50
    ds_read2st64_b32 v[248:249], v238 offset0:0 offset1:72
    ds_read_b128 v[220:223], v1 offset:7168
    v_mov_b32_dpp v178, v186 row_ror:8 row_mask:0xf bank_mask:0xc
    v_smfmac_f32_16x16x64_bf16 v[124:127], a[180:183], v[196:203], v32
    ds_read2st64_b32 v[250:251], v239 offset0:0 offset1:72
    ds_read_b128 v[236:239], v9 offset:9728
    v_mov_b32_dpp v179, v187 row_ror:8 row_mask:0xf bank_mask:0xc
    v_smfmac_f32_16x16x64_bf16 v[124:127], a[216:219], v[204:211], v36
    ds_read_b128 v[224:227], v2 offset:7168
    s_waitcnt vmcnt(6)
    buffer_store_dwordx4 v[176:179], v6, s[12:15], s23 offen offset:128 sc1
    v_smfmac_f32_16x16x64_bf16 v[128:131], a[184:187], v[196:203], v32 abid:1
    ds_read_b128 v[228:231], v1 offset:8192
    ds_read_b128 v[180:183], v9 offset:10560
    ds_read_b128 v[184:187], v9 offset:10624
    v_smfmac_f32_16x16x64_bf16 v[128:131], a[220:223], v[204:211], v36 abid:1
    ds_read_b128 v[232:235], v2 offset:8192
    ds_read_b128 v[176:179], v9 offset:10496
    v_and_b32 v212, 0x3fff, v216
    v_smfmac_f32_16x16x64_bf16 v[132:135], a[188:191], v[196:203], v33
    v_and_b32 v214, 0x3fff, v218
    v_smfmac_f32_16x16x64_bf16 v[132:135], a[224:227], v[204:211], v37
    v_xad_u32 v212, v212, v3, v4
    v_smfmac_f32_16x16x64_bf16 v[136:139], a[192:195], v[196:203], v33 abid:1
    ds_read2st64_b32 v[212:213], v212 offset0:0 offset1:72
    v_xad_u32 v214, v214, v3, v4
    v_smfmac_f32_16x16x64_bf16 v[136:139], a[228:231], v[204:211], v37 abid:1
    ds_read2st64_b32 v[214:215], v214 offset0:0 offset1:72
    v_smfmac_f32_16x16x64_bf16 v[140:143], a[196:199], v[196:203], v34
    v_smfmac_f32_16x16x64_bf16 v[140:143], a[232:235], v[204:211], v38
    s_waitcnt vmcnt(7)
    s_waitcnt lgkmcnt(8)
    v_xad_u32 v236, v236, v3, v4
    v_smfmac_f32_16x16x64_bf16 v[124:127], v[240:243], v[244:251], v10
    v_xad_u32 v237, v237, v3, v4
    v_smfmac_f32_16x16x64_bf16 v[160:163], v[240:243], v[244:251], v10 abid:1
    ds_read2st64_b32 v[244:245], v236 offset0:0 offset1:72
    ds_read_b128 v[240:243], v8 offset:8192
    v_xad_u32 v238, v238, v3, v4
    v_smfmac_f32_16x16x64_bf16 v[144:147], a[200:203], v[196:203], v34 abid:1
    ds_read2st64_b32 v[246:247], v237 offset0:0 offset1:72
    v_xad_u32 v239, v239, v3, v4
    v_smfmac_f32_16x16x64_bf16 v[144:147], a[236:239], v[204:211], v38 abid:1
    ds_read2st64_b32 v[248:249], v238 offset0:0 offset1:72
    v_mul_u32_u24 v0, s94, v0
    v_smfmac_f32_16x16x64_bf16 v[148:151], a[204:207], v[196:203], v35
    ds_read2st64_b32 v[250:251], v239 offset0:0 offset1:72
    ds_read_b128 v[236:239], v9 offset:9664
    v_add_u32 v0, s93, v0
    v_smfmac_f32_16x16x64_bf16 v[148:151], a[240:243], v[204:211], v39
    s_add_u32 m0, m0, 896
    v_min_u32 v0, 75497472, v0
    v_smfmac_f32_16x16x64_bf16 v[152:155], a[208:211], v[196:203], v35 abid:1
    ds_write_b32 v253, v0
    s_waitcnt vmcnt(7)
    v_mov_b32 v0, 162048
    v_smfmac_f32_16x16x64_bf16 v[152:155], a[244:247], v[204:211], v39 abid:1
    buffer_load_dwordx4 v5, s[8:11], s22 offen offset:896 nt lds
    s_and_b32 s30, s27, 7
    s_waitcnt lgkmcnt(7)
    s_cbranch_scc1 M_ov0
M_ovr0L:
    v_smfmac_f32_16x16x64_bf16 v[156:159], a[212:215], v[196:203], v50 abid:1
    s_and_b32 s30, s27, 56
    s_cbranch_scc1 M_ov1
M_ovr1L:
    v_smfmac_f32_16x16x64_bf16 v[156:159], a[248:251], v[204:211], v51
    ds_read_b128 v[196:199], v1 offset:18432
    s_and_b32 s30, s27, 448
    s_cbranch_scc1 M_ov2
M_ovr2L:
    v_smfmac_f32_16x16x64_bf16 v[124:127], a[252:255], v[220:227], v40
    ds_read_b128 v[200:203], v2 offset:18432
    v_smfmac_f32_16x16x64_bf16 v[124:127], v[88:91], v[228:235], v44
    ds_read_b128 v[204:207], v1 offset:19456
    v_smfmac_f32_16x16x64_bf16 v[128:131], v[56:59], v[220:227], v40 abid:1
    ds_read_b128 v[208:211], v2 offset:19456
    v_smfmac_f32_16x16x64_bf16 v[128:131], v[92:95], v[228:235], v44 abid:1
    s_waitcnt lgkmcnt(4)
    s_barrier
    v_xad_u32 v236, v236, v3, v4
    v_smfmac_f32_16x16x64_bf16 v[156:159], v[240:243], v[244:251], v10
    ds_read_b32 v0, v0
    v_xad_u32 v237, v237, v3, v4
    v_smfmac_f32_16x16x64_bf16 v[192:195], v[240:243], v[244:251], v10 abid:1
    ds_read2st64_b32 v[244:245], v236 offset0:0 offset1:72
    ds_read_b128 v[240:243], v8 offset:7168
    v_xad_u32 v238, v238, v3, v4
    v_smfmac_f32_16x16x64_bf16 v[132:135], v[60:63], v[220:227], v41
    ds_read2st64_b32 v[246:247], v237 offset0:0 offset1:72
    v_xad_u32 v239, v239, v3, v4
    v_smfmac_f32_16x16x64_bf16 v[132:135], v[96:99], v[228:235], v45
    ds_read2st64_b32 v[248:249], v238 offset0:0 offset1:72
    s_add_u32 m0, m0, 896
    v_smfmac_f32_16x16x64_bf16 v[136:139], v[64:67], v[220:227], v41 abid:1
    ds_read2st64_b32 v[250:251], v239 offset0:0 offset1:72
    ds_read_b128 v[236:239], v9 offset:9536
    s_waitcnt vmcnt(6)
    v_smfmac_f32_16x16x64_bf16 v[136:139], v[100:103], v[228:235], v45 abid:1
    buffer_load_dwordx4 v5, s[8:11], s22 offen offset:1024 nt lds
    s_waitcnt lgkmcnt(6)
    v_readfirstlane_b32 s88, v0
    v_smfmac_f32_16x16x64_bf16 v[140:143], v[68:71], v[220:227], v42
    s_cmp_lt_u32 s88, 75497472
    s_cselect_b32 s10, 75497472, 0
    v_smfmac_f32_16x16x64_bf16 v[140:143], v[104:107], v[228:235], v46
    v_smfmac_f32_16x16x64_bf16 v[144:147], v[72:75], v[220:227], v42 abid:1
    ds_read_b128 v[212:215], v1 offset:20480
    v_smfmac_f32_16x16x64_bf16 v[144:147], v[108:111], v[228:235], v46 abid:1
    ds_read_b128 v[216:219], v2 offset:20480
    v_smfmac_f32_16x16x64_bf16 v[148:151], v[76:79], v[220:227], v43
    v_smfmac_f32_16x16x64_bf16 v[148:151], v[112:115], v[228:235], v47
    v_smfmac_f32_16x16x64_bf16 v[152:155], v[80:83], v[220:227], v43 abid:1
    v_smfmac_f32_16x16x64_bf16 v[152:155], v[116:119], v[228:235], v47 abid:1
    s_waitcnt lgkmcnt(2)
    v_xad_u32 v236, v236, v3, v4
    v_smfmac_f32_16x16x64_bf16 v[152:155], v[240:243], v[244:251], v10
    v_xad_u32 v237, v237, v3, v4
    v_smfmac_f32_16x16x64_bf16 v[188:191], v[240:243], v[244:251], v10 abid:1
    s_cmp_gt_u32 s46, 1
    s_cbranch_scc1 M_slow
M_slowrL:
    v_xad_u32 v238, v238, v3, v4
    v_smfmac_f32_16x16x64_bf16 v[156:159], v[84:87], v[220:227], v51 abid:1
    ds_read2st64_b32 v[244:245], v236 offset0:0 offset1:72
    ds_read_b128 v[240:243], v8 offset:5120
    v_xad_u32 v239, v239, v3, v4
    v_smfmac_f32_16x16x64_bf16 v[156:159], v[120:123], v[228:235], v52
    ds_read2st64_b32 v[246:247], v237 offset0:0 offset1:72
    ds_read_b128 v[220:223], v1 offset:21504
    v_smfmac_f32_16x16x64_bf16 v[160:163], a[0:3], v[196:203], v12
    ds_read2st64_b32 v[248:249], v238 offset0:0 offset1:72
    ds_read_b128 v[224:227], v2 offset:21504
    v_smfmac_f32_16x16x64_bf16 v[160:163], a[36:39], v[204:211], v16
    ds_read2st64_b32 v[250:251], v239 offset0:0 offset1:72
    ds_read_b128 v[236:239], v9 offset:9600
    s_waitcnt lgkmcnt(8)
    v_smfmac_f32_16x16x64_bf16 v[160:163], a[72:75], v[212:219], v20
    ds_read_b128 v[228:231], v1 offset:22528
    v_smfmac_f32_16x16x64_bf16 v[164:167], a[4:7], v[196:203], v12 abid:1
    ds_read_b128 v[232:235], v2 offset:22528
    v_cvt_pk_bf16_f32 v156, v156, v157
    v_smfmac_f32_16x16x64_bf16 v[164:167], a[40:43], v[204:211], v16 abid:1
    s_mov_b32 m0, s28
    v_cvt_pk_bf16_f32 v157, v158, v159
    v_smfmac_f32_16x16x64_bf16 v[164:167], a[76:79], v[212:219], v20 abid:1
    ds_write_b64 v252, v[156:157] offset:25728
    ds_read_b128 v[156:159], v9 offset:10752
    s_waitcnt vmcnt(7)
    v_smfmac_f32_16x16x64_bf16 v[168:171], a[8:11], v[196:203], v13
    buffer_load_dwordx4 v5, s[8:11], s88 offen offset:0 nt lds
    v_smfmac_f32_16x16x64_bf16 v[168:171], a[44:47], v[204:211], v17
    v_cvt_pk_bf16_f32 v124, v124, v125
    v_smfmac_f32_16x16x64_bf16 v[168:171], a[80:83], v[212:219], v21
    s_waitcnt lgkmcnt(4)
    v_xad_u32 v236, v236, v3, v4
    v_smfmac_f32_16x16x64_bf16 v[144:147], v[240:243], v[244:251], v10
    v_xad_u32 v237, v237, v3, v4
    v_smfmac_f32_16x16x64_bf16 v[180:183], v[240:243], v[244:251], v10 abid:1
    ds_read2st64_b32 v[244:245], v236 offset0:0 offset1:72
    ds_read_b128 v[240:243], v8 offset:6144
    v_xad_u32 v238, v238, v3, v4
    v_smfmac_f32_16x16x64_bf16 v[172:175], a[12:15], v[196:203], v13 abid:1
    ds_read2st64_b32 v[246:247], v237 offset0:0 offset1:72
    v_xad_u32 v239, v239, v3, v4
    v_smfmac_f32_16x16x64_bf16 v[172:175], a[48:51], v[204:211], v17 abid:1
    ds_read2st64_b32 v[248:249], v238 offset0:0 offset1:72
    v_cvt_pk_bf16_f32 v125, v126, v127
    v_smfmac_f32_16x16x64_bf16 v[172:175], a[84:87], v[212:219], v21 abid:1
    ds_read2st64_b32 v[250:251], v239 offset0:0 offset1:72
    ds_read_b128 v[236:239], v9 offset:9472
    v_cvt_pk_bf16_f32 v126, v128, v129
    v_smfmac_f32_16x16x64_bf16 v[176:179], a[16:19], v[196:203], v14
    v_cvt_pk_bf16_f32 v127, v130, v131
    v_smfmac_f32_16x16x64_bf16 v[176:179], a[52:55], v[204:211], v18
    v_cvt_pk_bf16_f32 v132, v132, v133
    v_smfmac_f32_16x16x64_bf16 v[176:179], a[88:91], v[212:219], v22
    v_cvt_pk_bf16_f32 v133, v134, v135
    v_smfmac_f32_16x16x64_bf16 v[180:183], a[20:23], v[196:203], v14 abid:1
    s_add_u32 m0, m0, 896
    v_cvt_pk_bf16_f32 v134, v136, v137
    v_smfmac_f32_16x16x64_bf16 v[180:183], a[56:59], v[204:211], v18 abid:1
    s_waitcnt vmcnt(6)
    buffer_load_dwordx4 v5, s[8:11], s88 offen offset:128 nt lds
    v_cvt_pk_bf16_f32 v135, v138, v139
    v_smfmac_f32_16x16x64_bf16 v[180:183], a[92:95], v[212:219], v22 abid:1
    ds_read_b128 v[136:139], v9 offset:10432
    v_cndmask_b32_dpp v128, v124, v132, vcc row_ror:8 row_mask:0xf bank_mask:0xf
    v_smfmac_f32_16x16x64_bf16 v[184:187], a[24:27], v[196:203], v15
    v_cndmask_b32_dpp v129, v125, v133, vcc row_ror:8 row_mask:0xf bank_mask:0xf
    v_smfmac_f32_16x16x64_bf16 v[184:187], a[60:63], v[204:211], v19
    v_cndmask_b32_dpp v130, v126, v134, vcc row_ror:8 row_mask:0xf bank_mask:0xf
    v_smfmac_f32_16x16x64_bf16 v[184:187], a[96:99], v[212:219], v23
    s_waitcnt lgkmcnt(1)
    v_xad_u32 v236, v236, v3, v4
    v_smfmac_f32_16x16x64_bf16 v[148:151], v[240:243], v[244:251], v10
    v_xad_u32 v237, v237, v3, v4
    v_smfmac_f32_16x16x64_bf16 v[184:187], v[240:243], v[244:251], v10 abid:1
    ds_read2st64_b32 v[244:245], v236 offset0:0 offset1:72
    ds_read_b128 v[240:243], v8 offset:4096
    v_xad_u32 v238, v238, v3, v4
    v_smfmac_f32_16x16x64_bf16 v[188:191], a[28:31], v[196:203], v15 abid:1
    ds_read2st64_b32 v[246:247], v237 offset0:0 offset1:72
    v_xad_u32 v239, v239, v3, v4
    v_smfmac_f32_16x16x64_bf16 v[188:191], a[64:67], v[204:211], v19 abid:1
    ds_read2st64_b32 v[248:249], v238 offset0:0 offset1:72
    v_cndmask_b32_dpp v131, v127, v135, vcc row_ror:8 row_mask:0xf bank_mask:0xf
    v_smfmac_f32_16x16x64_bf16 v[188:191], a[100:103], v[212:219], v23 abid:1
    ds_read2st64_b32 v[250:251], v239 offset0:0 offset1:72
    s_waitcnt vmcnt(7)
    buffer_store_dwordx4 v[128:131], v6, s[12:15], s59 offen offset:0 sc1
    v_smfmac_f32_16x16x64_bf16 v[192:195], a[32:35], v[196:203], v48
    v_mov_b32_dpp v124, v132 row_ror:8 row_mask:0xf bank_mask:0xc
    v_smfmac_f32_16x16x64_bf16 v[192:195], a[68:71], v[204:211], v48 abid:1
    v_mov_b32_dpp v125, v133 row_ror:8 row_mask:0xf bank_mask:0xc
    v_smfmac_f32_16x16x64_bf16 v[192:195], a[104:107], v[212:219], v49
    ds_read_b128 v[196:199], v1 offset:23552
    v_mov_b32_dpp v126, v134 row_ror:8 row_mask:0xf bank_mask:0xc
    v_smfmac_f32_16x16x64_bf16 v[160:163], a[108:111], v[220:227], v24
    ds_read_b128 v[200:203], v2 offset:23552
    v_mov_b32_dpp v127, v135 row_ror:8 row_mask:0xf bank_mask:0xc
    v_smfmac_f32_16x16x64_bf16 v[160:163], a[144:147], v[228:235], v28
    ds_read_b128 v[204:207], v1 offset:24576
    s_waitcnt vmcnt(6)
    buffer_store_dwordx4 v[124:127], v6, s[12:15], s24 offen offset:0 sc1
    v_smfmac_f32_16x16x64_bf16 v[164:167], a[112:115], v[220:227], v24 abid:1
    ds_read_b128 v[208:211], v2 offset:24576
    ds_read_b128 v[128:131], v9 offset:10304
    ds_read_b128 v[132:135], v9 offset:10368
    v_smfmac_f32_16x16x64_bf16 v[164:167], a[148:151], v[228:235], v28 abid:1
    ds_read_b128 v[124:127], v9 offset:10240
    v_smfmac_f32_16x16x64_bf16 v[168:171], a[116:119], v[220:227], v25
    v_smfmac_f32_16x16x64_bf16 v[168:171], a[152:155], v[228:235], v29
    s_waitcnt lgkmcnt(7)
    v_smfmac_f32_16x16x64_bf16 v[140:143], v[240:243], v[244:251], v10
    v_smfmac_f32_16x16x64_bf16 v[176:179], v[240:243], v[244:251], v10 abid:1
    v_smfmac_f32_16x16x64_bf16 v[172:175], a[120:123], v[220:227], v25 abid:1
    s_add_u32 s28, s28, 36864
    s_cmp_ge_u32 s28, 110592
    s_cselect_b32 s28, s26, s28
    v_smfmac_f32_16x16x64_bf16 v[172:175], a[156:159], v[228:235], v29 abid:1
    s_add_u32 s30, s25, 36864
    s_cmp_eq_u32 s30, 110592
    s_cselect_b32 s30, 0, s30
    v_smfmac_f32_16x16x64_bf16 v[176:179], a[124:127], v[220:227], v26
    s_sub_u32 s31, s30, s25
    s_mov_b32 s25, s30
    s_mov_b32 s90, s22
    v_smfmac_f32_16x16x64_bf16 v[176:179], a[160:163], v[228:235], v30
    s_mov_b32 s22, s88
    s_add_u32 s91, s91, 1
    s_cmp_lt_u32 s20, 2
    v_smfmac_f32_16x16x64_bf16 v[180:183], a[128:131], v[220:227], v26 abid:1
    s_cselect_b32 s66, s23, s24
    s_add_u32 s66, s66, s95
    v_smfmac_f32_16x16x64_bf16 v[180:183], a[164:167], v[228:235], v30 abid:1
    v_cvt_pk_bf16_f32 v140, v140, v141
    v_smfmac_f32_16x16x64_bf16 v[184:187], a[132:135], v[220:227], v27
    s_add_u32 m0, m0, 896
    v_cvt_pk_bf16_f32 v141, v142, v143
    v_smfmac_f32_16x16x64_bf16 v[184:187], a[168:171], v[228:235], v31
    s_waitcnt vmcnt(7)
    buffer_load_dwordx4 v5, s[8:11], s88 offen offset:256 nt lds
    v_cvt_pk_bf16_f32 v142, v144, v145
    v_smfmac_f32_16x16x64_bf16 v[188:191], a[136:139], v[220:227], v27 abid:1
    v_cvt_pk_bf16_f32 v143, v146, v147
    v_smfmac_f32_16x16x64_bf16 v[188:191], a[172:175], v[228:235], v31 abid:1
    v_cvt_pk_bf16_f32 v148, v148, v149
    v_smfmac_f32_16x16x64_bf16 v[192:195], a[140:143], v[220:227], v49 abid:1
    v_cvt_pk_bf16_f32 v149, v150, v151
    v_smfmac_f32_16x16x64_bf16 v[192:195], a[176:179], v[228:235], v50
    ds_read_b128 v[220:223], v1 offset:25600
    s_waitcnt lgkmcnt(6)
    v_cvt_pk_bf16_f32 v150, v152, v153
    v_smfmac_f32_16x16x64_bf16 v[160:163], a[180:183], v[196:203], v32
    ds_read_b128 v[224:227], v2 offset:25600
    s_waitcnt lgkmcnt(5)
    v_cvt_pk_bf16_f32 v151, v154, v155
    v_smfmac_f32_16x16x64_bf16 v[160:163], a[216:219], v[204:211], v36
    ds_read_b128 v[228:231], v1 offset:26624
    ds_read_b128 v[152:155], v9 offset:10688
    v_cndmask_b32_dpp v144, v140, v148, vcc row_ror:8 row_mask:0xf bank_mask:0xf
    v_smfmac_f32_16x16x64_bf16 v[164:167], a[184:187], v[196:203], v32 abid:1
    ds_read_b128 v[232:235], v2 offset:26624
    v_cndmask_b32_dpp v145, v141, v149, vcc row_ror:8 row_mask:0xf bank_mask:0xf
    v_smfmac_f32_16x16x64_bf16 v[164:167], a[220:223], v[204:211], v36 abid:1
    s_add_u32 m0, m0, 896
    v_cndmask_b32_dpp v146, v142, v150, vcc row_ror:8 row_mask:0xf bank_mask:0xf
    v_smfmac_f32_16x16x64_bf16 v[168:171], a[188:191], v[196:203], v33
    s_waitcnt vmcnt(6)
    buffer_load_dwordx4 v5, s[8:11], s88 offen offset:384 nt lds
    v_cndmask_b32_dpp v147, v143, v151, vcc row_ror:8 row_mask:0xf bank_mask:0xf
    v_smfmac_f32_16x16x64_bf16 v[168:171], a[224:227], v[204:211], v37
    s_waitcnt vmcnt(7)
    buffer_store_dwordx4 v[144:147], v6, s[12:15], s59 offen offset:128 sc1
    v_mov_b32_dpp v140, v148 row_ror:8 row_mask:0xf bank_mask:0xc
    v_smfmac_f32_16x16x64_bf16 v[172:175], a[192:195], v[196:203], v33 abid:1
    v_mov_b32_dpp v141, v149 row_ror:8 row_mask:0xf bank_mask:0xc
    v_smfmac_f32_16x16x64_bf16 v[172:175], a[228:231], v[204:211], v37 abid:1
    v_mov_b32_dpp v142, v150 row_ror:8 row_mask:0xf bank_mask:0xc
    v_smfmac_f32_16x16x64_bf16 v[176:179], a[196:199], v[196:203], v34
    v_mov_b32_dpp v143, v151 row_ror:8 row_mask:0xf bank_mask:0xc
    v_smfmac_f32_16x16x64_bf16 v[176:179], a[232:235], v[204:211], v38
    s_waitcnt vmcnt(6)
    buffer_store_dwordx4 v[140:143], v6, s[12:15], s24 offen offset:128 sc1
    ds_read_b128 v[144:147], v9 offset:10560
    v_smfmac_f32_16x16x64_bf16 v[180:183], a[200:203], v[196:203], v34 abid:1
    ds_read_b128 v[148:151], v9 offset:10624
    ds_read_b128 v[140:143], v9 offset:10496
    v_add_u32 v4, s31, v4
    v_smfmac_f32_16x16x64_bf16 v[180:183], a[236:239], v[204:211], v38 abid:1
    v_add_u32 v1, s31, v1
    v_smfmac_f32_16x16x64_bf16 v[184:187], a[204:207], v[196:203], v35
    v_add_u32 v2, s31, v2
    v_smfmac_f32_16x16x64_bf16 v[184:187], a[240:243], v[204:211], v39
    v_smfmac_f32_16x16x64_bf16 v[188:191], a[208:211], v[196:203], v35 abid:1
    v_smfmac_f32_16x16x64_bf16 v[188:191], a[244:247], v[204:211], v39 abid:1
    v_smfmac_f32_16x16x64_bf16 v[192:195], a[212:215], v[196:203], v50 abid:1
    v_smfmac_f32_16x16x64_bf16 v[192:195], a[248:251], v[204:211], v51
    s_branch M_top
M_bE0:
    v_smfmac_f32_16x16x64_bf16 v[164:167], v[56:59], v[220:227], v40 abid:1
    ds_read_b128 v[204:207], v1 offset:1024
    v_smfmac_f32_16x16x64_bf16 v[164:167], v[92:95], v[228:235], v44 abid:1
    ds_read_b128 v[208:211], v2 offset:1024
    v_mov_b32 v0, 1
    v_smfmac_f32_16x16x64_bf16 v[168:171], v[60:63], v[220:227], v41
    ds_read_b128 v[212:215], v1 offset:2048
    v_smfmac_f32_16x16x64_bf16 v[168:171], v[96:99], v[228:235], v45
    ds_read_b128 v[216:219], v2 offset:2048
    v_smfmac_f32_16x16x64_bf16 v[172:175], v[64:67], v[220:227], v41 abid:1
    s_waitcnt vmcnt(5)
    s_waitcnt lgkmcnt(6)
    buffer_store_dwordx4 v[244:247], v7, s[12:15], s66 offen sc1
    v_smfmac_f32_16x16x64_bf16 v[172:175], v[100:103], v[228:235], v45 abid:1
    ds_read_b128 v[236:239], v9 offset:9408
    v_smfmac_f32_16x16x64_bf16 v[176:179], v[68:71], v[220:227], v42
    s_waitcnt vmcnt(6)
    buffer_atomic_add v0, v253, s[16:19], s92 offen sc0 sc1
    s_mov_b32 s21, 2
    v_smfmac_f32_16x16x64_bf16 v[176:179], v[104:107], v[228:235], v46
    v_smfmac_f32_16x16x64_bf16 v[180:183], v[72:75], v[220:227], v42 abid:1
    v_cvt_pk_bf16_f32 v160, v160, v161
    v_smfmac_f32_16x16x64_bf16 v[180:183], v[108:111], v[228:235], v46 abid:1
    v_cvt_pk_bf16_f32 v161, v162, v163
    v_smfmac_f32_16x16x64_bf16 v[184:187], v[76:79], v[220:227], v43
    v_cvt_pk_bf16_f32 v162, v164, v165
    v_smfmac_f32_16x16x64_bf16 v[184:187], v[112:115], v[228:235], v47
    v_cvt_pk_bf16_f32 v163, v166, v167
    v_smfmac_f32_16x16x64_bf16 v[188:191], v[80:83], v[220:227], v43 abid:1
    s_add_u32 m0, m0, 896
    v_cvt_pk_bf16_f32 v168, v168, v169
    v_smfmac_f32_16x16x64_bf16 v[188:191], v[116:119], v[228:235], v47 abid:1
    s_waitcnt vmcnt(5)
    buffer_load_dwordx4 v5, s[8:11], s22 offen offset:512 nt lds
    v_cvt_pk_bf16_f32 v169, v170, v171
    v_smfmac_f32_16x16x64_bf16 v[192:195], v[84:87], v[220:227], v51 abid:1
    v_cvt_pk_bf16_f32 v170, v172, v173
    v_smfmac_f32_16x16x64_bf16 v[192:195], v[120:123], v[228:235], v52
    ds_read_b128 v[220:223], v1 offset:3072
    s_waitcnt lgkmcnt(6)
    v_cvt_pk_bf16_f32 v171, v174, v175
    v_smfmac_f32_16x16x64_bf16 v[124:127], a[0:3], v[196:203], v12
    ds_read_b128 v[224:227], v2 offset:3072
    ds_read_b128 v[172:175], v9 offset:10432
    s_waitcnt lgkmcnt(6)
    v_cndmask_b32_dpp v164, v160, v168, vcc row_ror:8 row_mask:0xf bank_mask:0xf
    v_smfmac_f32_16x16x64_bf16 v[124:127], a[36:39], v[204:211], v16
    ds_read_b128 v[228:231], v1 offset:4096
    s_waitcnt lgkmcnt(5)
    v_cndmask_b32_dpp v165, v161, v169, vcc row_ror:8 row_mask:0xf bank_mask:0xf
    v_smfmac_f32_16x16x64_bf16 v[124:127], a[72:75], v[212:219], v20
    ds_read_b128 v[232:235], v2 offset:4096
    v_cndmask_b32_dpp v166, v162, v170, vcc row_ror:8 row_mask:0xf bank_mask:0xf
    v_smfmac_f32_16x16x64_bf16 v[128:131], a[4:7], v[196:203], v12 abid:1
    s_barrier
    v_cndmask_b32_dpp v167, v163, v171, vcc row_ror:8 row_mask:0xf bank_mask:0xf
    v_smfmac_f32_16x16x64_bf16 v[128:131], a[40:43], v[204:211], v16 abid:1
    s_waitcnt vmcnt(6)
    buffer_store_dwordx4 v[164:167], v6, s[12:15], s58 offen offset:0 sc1
    s_waitcnt lgkmcnt(5)
    v_xad_u32 v236, v236, v3, v4
    v_smfmac_f32_16x16x64_bf16 v[128:131], a[76:79], v[212:219], v20 abid:1
    v_xad_u32 v237, v237, v3, v4
    v_smfmac_f32_16x16x64_bf16 v[132:135], a[8:11], v[196:203], v13
    ds_read2st64_b32 v[244:245], v236 offset0:0 offset1:72
    ds_read_b128 v[240:243], v8 offset:3072
    v_xad_u32 v238, v238, v3, v4
    v_smfmac_f32_16x16x64_bf16 v[132:135], a[44:47], v[204:211], v17
    ds_read2st64_b32 v[246:247], v237 offset0:0 offset1:72
    v_xad_u32 v239, v239, v3, v4
    v_smfmac_f32_16x16x64_bf16 v[132:135], a[80:83], v[212:219], v21
    ds_read2st64_b32 v[248:249], v238 offset0:0 offset1:72
    v_mov_b32_dpp v160, v168 row_ror:8 row_mask:0xf bank_mask:0xc
    v_smfmac_f32_16x16x64_bf16 v[136:139], a[12:15], v[196:203], v13 abid:1
    ds_read2st64_b32 v[250:251], v239 offset0:0 offset1:72
    ds_read_b128 v[236:239], v9 offset:9280
    v_mov_b32_dpp v161, v169 row_ror:8 row_mask:0xf bank_mask:0xc
    v_smfmac_f32_16x16x64_bf16 v[136:139], a[48:51], v[204:211], v17 abid:1
    v_mov_b32_dpp v162, v170 row_ror:8 row_mask:0xf bank_mask:0xc
    v_smfmac_f32_16x16x64_bf16 v[136:139], a[84:87], v[212:219], v21 abid:1
    v_mov_b32_dpp v163, v171 row_ror:8 row_mask:0xf bank_mask:0xc
    v_smfmac_f32_16x16x64_bf16 v[140:143], a[16:19], v[196:203], v14
    s_waitcnt vmcnt(5)
    buffer_store_dwordx4 v[160:163], v6, s[12:15], s23 offen offset:0 sc1
    ds_read_b128 v[164:167], v9 offset:10304
    v_smfmac_f32_16x16x64_bf16 v[140:143], a[52:55], v[204:211], v18
    ds_read_b128 v[168:171], v9 offset:10368
    ds_read_b128 v[160:163], v9 offset:10240
    v_smfmac_f32_16x16x64_bf16 v[140:143], a[88:91], v[212:219], v22
    v_smfmac_f32_16x16x64_bf16 v[144:147], a[20:23], v[196:203], v14 abid:1
    v_smfmac_f32_16x16x64_bf16 v[144:147], a[56:59], v[204:211], v18 abid:1
    v_smfmac_f32_16x16x64_bf16 v[144:147], a[92:95], v[212:219], v22 abid:1
    s_waitcnt lgkmcnt(3)
    v_xad_u32 v236, v236, v3, v4
    v_smfmac_f32_16x16x64_bf16 v[136:139], v[240:243], v[244:251], v10
    v_xad_u32 v237, v237, v3, v4
    v_smfmac_f32_16x16x64_bf16 v[172:175], v[240:243], v[244:251], v10 abid:1
    ds_read2st64_b32 v[244:245], v236 offset0:0 offset1:72
    ds_read_b128 v[240:243], v8 offset:1024
    v_xad_u32 v238, v238, v3, v4
    v_smfmac_f32_16x16x64_bf16 v[148:151], a[24:27], v[196:203], v15
    ds_read2st64_b32 v[246:247], v237 offset0:0 offset1:72
    v_xad_u32 v239, v239, v3, v4
    v_smfmac_f32_16x16x64_bf16 v[148:151], a[60:63], v[204:211], v19
    ds_read2st64_b32 v[248:249], v238 offset0:0 offset1:72
    v_cvt_pk_bf16_f32 v192, v192, v193
    v_smfmac_f32_16x16x64_bf16 v[148:151], a[96:99], v[212:219], v23
    ds_read2st64_b32 v[250:251], v239 offset0:0 offset1:72
    ds_read_b128 v[236:239], v9 offset:9344
    v_cvt_pk_bf16_f32 v193, v194, v195
    v_smfmac_f32_16x16x64_bf16 v[152:155], a[28:31], v[196:203], v15 abid:1
    ds_write_b64 v252, v[192:193] offset:0
    ds_read_b128 v[192:195], v9 offset:10752
    v_smfmac_f32_16x16x64_bf16 v[152:155], a[64:67], v[204:211], v19 abid:1
    s_add_u32 m0, m0, 896
    v_smfmac_f32_16x16x64_bf16 v[152:155], a[100:103], v[212:219], v23 abid:1
    s_waitcnt vmcnt(6)
    buffer_load_dwordx4 v5, s[8:11], s22 offen offset:640 nt lds
    v_smfmac_f32_16x16x64_bf16 v[156:159], a[32:35], v[196:203], v48
    v_smfmac_f32_16x16x64_bf16 v[156:159], a[68:71], v[204:211], v48 abid:1
    v_smfmac_f32_16x16x64_bf16 v[156:159], a[104:107], v[212:219], v49
    ds_read_b128 v[196:199], v1 offset:5120
    v_cvt_pk_bf16_f32 v176, v176, v177
    v_smfmac_f32_16x16x64_bf16 v[124:127], a[108:111], v[220:227], v24
    ds_read_b128 v[200:203], v2 offset:5120
    v_cvt_pk_bf16_f32 v177, v178, v179
    v_smfmac_f32_16x16x64_bf16 v[124:127], a[144:147], v[228:235], v28
    ds_read_b128 v[204:207], v1 offset:6144
    ds_read_b128 v[216:219], v9 offset:9792
    v_cvt_pk_bf16_f32 v178, v180, v181
    v_smfmac_f32_16x16x64_bf16 v[128:131], a[112:115], v[220:227], v24 abid:1
    ds_read_b128 v[208:211], v2 offset:6144
    v_cvt_pk_bf16_f32 v179, v182, v183
    v_smfmac_f32_16x16x64_bf16 v[128:131], a[148:151], v[228:235], v28 abid:1
    s_waitcnt lgkmcnt(7)
    v_xad_u32 v236, v236, v3, v4
    v_smfmac_f32_16x16x64_bf16 v[128:131], v[240:243], v[244:251], v10
    s_add_u32 m0, m0, 896
    v_xad_u32 v237, v237, v3, v4
    v_smfmac_f32_16x16x64_bf16 v[164:167], v[240:243], v[244:251], v10 abid:1
    ds_read2st64_b32 v[244:245], v236 offset0:0 offset1:72
    ds_read_b128 v[240:243], v8 offset:2048
    v_xad_u32 v238, v238, v3, v4
    v_smfmac_f32_16x16x64_bf16 v[132:135], a[116:119], v[220:227], v25
    ds_read2st64_b32 v[246:247], v237 offset0:0 offset1:72
    s_waitcnt vmcnt(5)
    v_xad_u32 v239, v239, v3, v4
    v_smfmac_f32_16x16x64_bf16 v[132:135], a[152:155], v[228:235], v29
    ds_read2st64_b32 v[248:249], v238 offset0:0 offset1:72
    buffer_load_dwordx4 v5, s[8:11], s22 offen offset:768 nt lds
    v_cvt_pk_bf16_f32 v184, v184, v185
    v_smfmac_f32_16x16x64_bf16 v[136:139], a[120:123], v[220:227], v25 abid:1
    ds_read2st64_b32 v[250:251], v239 offset0:0 offset1:72
    ds_read_b128 v[236:239], v9 offset:9216
    v_cvt_pk_bf16_f32 v185, v186, v187
    v_smfmac_f32_16x16x64_bf16 v[136:139], a[156:159], v[228:235], v29 abid:1
    v_cvt_pk_bf16_f32 v186, v188, v189
    v_smfmac_f32_16x16x64_bf16 v[140:143], a[124:127], v[220:227], v26
    v_cvt_pk_bf16_f32 v187, v190, v191
    v_smfmac_f32_16x16x64_bf16 v[140:143], a[160:163], v[228:235], v30
    ds_read_b128 v[188:191], v9 offset:10688
    v_cndmask_b32_dpp v180, v176, v184, vcc row_ror:8 row_mask:0xf bank_mask:0xf
    v_smfmac_f32_16x16x64_bf16 v[144:147], a[128:131], v[220:227], v26 abid:1
    v_cndmask_b32_dpp v181, v177, v185, vcc row_ror:8 row_mask:0xf bank_mask:0xf
    v_smfmac_f32_16x16x64_bf16 v[144:147], a[164:167], v[228:235], v30 abid:1
    v_cndmask_b32_dpp v182, v178, v186, vcc row_ror:8 row_mask:0xf bank_mask:0xf
    v_smfmac_f32_16x16x64_bf16 v[148:151], a[132:135], v[220:227], v27
    v_cndmask_b32_dpp v183, v179, v187, vcc row_ror:8 row_mask:0xf bank_mask:0xf
    v_smfmac_f32_16x16x64_bf16 v[148:151], a[168:171], v[228:235], v31
    s_waitcnt vmcnt(6)
    buffer_store_dwordx4 v[180:183], v6, s[12:15], s58 offen offset:128 sc1
    v_mov_b32_dpp v176, v184 row_ror:8 row_mask:0xf bank_mask:0xc
    v_smfmac_f32_16x16x64_bf16 v[152:155], a[136:139], v[220:227], v27 abid:1
    v_mov_b32_dpp v177, v185 row_ror:8 row_mask:0xf bank_mask:0xc
    v_smfmac_f32_16x16x64_bf16 v[152:155], a[172:175], v[228:235], v31 abid:1
    s_waitcnt lgkmcnt(1)
    v_xad_u32 v236, v236, v3, v4
    v_smfmac_f32_16x16x64_bf16 v[132:135], v[240:243], v[244:251], v10
    v_xad_u32 v237, v237, v3, v4
    v_smfmac_f32_16x16x64_bf16 v[168:171], v[240:243], v[244:251], v10 abid:1
    ds_read2st64_b32 v[244:245], v236 offset0:0 offset1:72
    ds_read_b128 v[240:243], v8 offset:0
    v_xad_u32 v238, v238, v3, v4
    v_smfmac_f32_16x16x64_bf16 v[156:159], a[140:143], v[220:227], v49 abid:1
    ds_read2st64_b32 v[246:247], v237 offset0:0 offset1:72
    v_xad_u32 v239, v239, v3, v4
    v_smfmac_f32_16x16x64_bf16 v[156:159], a[176:179], v[228:235], v50
    ds_read2st64_b32 v[248:249], v238 offset0:0 offset1:72
    ds_read_b128 v[220:223], v1 offset:7168
    v_mov_b32_dpp v178, v186 row_ror:8 row_mask:0xf bank_mask:0xc
    v_smfmac_f32_16x16x64_bf16 v[124:127], a[180:183], v[196:203], v32
    ds_read2st64_b32 v[250:251], v239 offset0:0 offset1:72
    ds_read_b128 v[236:239], v9 offset:9728
    v_mov_b32_dpp v179, v187 row_ror:8 row_mask:0xf bank_mask:0xc
    v_smfmac_f32_16x16x64_bf16 v[124:127], a[216:219], v[204:211], v36
    ds_read_b128 v[224:227], v2 offset:7168
    s_waitcnt vmcnt(5)
    buffer_store_dwordx4 v[176:179], v6, s[12:15], s23 offen offset:128 sc1
    v_smfmac_f32_16x16x64_bf16 v[128:131], a[184:187], v[196:203], v32 abid:1
    ds_read_b128 v[228:231], v1 offset:8192
    ds_read_b128 v[180:183], v9 offset:10560
    ds_read_b128 v[184:187], v9 offset:10624
    v_smfmac_f32_16x16x64_bf16 v[128:131], a[220:223], v[204:211], v36 abid:1
    ds_read_b128 v[232:235], v2 offset:8192
    ds_read_b128 v[176:179], v9 offset:10496
    v_and_b32 v212, 0x3fff, v216
    v_smfmac_f32_16x16x64_bf16 v[132:135], a[188:191], v[196:203], v33
    v_and_b32 v214, 0x3fff, v218
    v_smfmac_f32_16x16x64_bf16 v[132:135], a[224:227], v[204:211], v37
    v_xad_u32 v212, v212, v3, v4
    v_smfmac_f32_16x16x64_bf16 v[136:139], a[192:195], v[196:203], v33 abid:1
    ds_read2st64_b32 v[212:213], v212 offset0:0 offset1:72
    v_xad_u32 v214, v214, v3, v4
    v_smfmac_f32_16x16x64_bf16 v[136:139], a[228:231], v[204:211], v37 abid:1
    ds_read2st64_b32 v[214:215], v214 offset0:0 offset1:72
    v_smfmac_f32_16x16x64_bf16 v[140:143], a[196:199], v[196:203], v34
    v_smfmac_f32_16x16x64_bf16 v[140:143], a[232:235], v[204:211], v38
    s_waitcnt vmcnt(7)
    s_waitcnt lgkmcnt(8)
    v_xad_u32 v236, v236, v3, v4
    v_smfmac_f32_16x16x64_bf16 v[124:127], v[240:243], v[244:251], v10
    v_xad_u32 v237, v237, v3, v4
    v_smfmac_f32_16x16x64_bf16 v[160:163], v[240:243], v[244:251], v10 abid:1
    ds_read2st64_b32 v[244:245], v236 offset0:0 offset1:72
    ds_read_b128 v[240:243], v8 offset:8192
    v_xad_u32 v238, v238, v3, v4
    v_smfmac_f32_16x16x64_bf16 v[144:147], a[200:203], v[196:203], v34 abid:1
    ds_read2st64_b32 v[246:247], v237 offset0:0 offset1:72
    v_xad_u32 v239, v239, v3, v4
    v_smfmac_f32_16x16x64_bf16 v[144:147], a[236:239], v[204:211], v38 abid:1
    ds_read2st64_b32 v[248:249], v238 offset0:0 offset1:72
    v_mul_u32_u24 v0, s94, v0
    v_smfmac_f32_16x16x64_bf16 v[148:151], a[204:207], v[196:203], v35
    ds_read2st64_b32 v[250:251], v239 offset0:0 offset1:72
    ds_read_b128 v[236:239], v9 offset:9664
    v_add_u32 v0, s93, v0
    v_smfmac_f32_16x16x64_bf16 v[148:151], a[240:243], v[204:211], v39
    s_add_u32 m0, m0, 896
    v_min_u32 v0, 75497472, v0
    v_smfmac_f32_16x16x64_bf16 v[152:155], a[208:211], v[196:203], v35 abid:1
    ds_write_b32 v253, v0
    s_waitcnt vmcnt(6)
    v_mov_b32 v0, 162048
    v_smfmac_f32_16x16x64_bf16 v[152:155], a[244:247], v[204:211], v39 abid:1
    buffer_load_dwordx4 v5, s[8:11], s22 offen offset:896 nt lds
    s_and_b32 s30, s27, 7
    s_waitcnt lgkmcnt(7)
    s_cbranch_scc1 M_ov0
M_ovr0E0:
    v_smfmac_f32_16x16x64_bf16 v[156:159], a[212:215], v[196:203], v50 abid:1
    s_and_b32 s30, s27, 56
    s_cbranch_scc1 M_ov1
M_ovr1E0:
    v_smfmac_f32_16x16x64_bf16 v[156:159], a[248:251], v[204:211], v51
    ds_read_b128 v[196:199], v1 offset:18432
    s_and_b32 s30, s27, 448
    s_cbranch_scc1 M_ov2
M_ovr2E0:
    v_smfmac_f32_16x16x64_bf16 v[124:127], a[252:255], v[220:227], v40
    ds_read_b128 v[200:203], v2 offset:18432
    v_smfmac_f32_16x16x64_bf16 v[124:127], v[88:91], v[228:235], v44
    ds_read_b128 v[204:207], v1 offset:19456
    v_smfmac_f32_16x16x64_bf16 v[128:131], v[56:59], v[220:227], v40 abid:1
    ds_read_b128 v[208:211], v2 offset:19456
    v_smfmac_f32_16x16x64_bf16 v[128:131], v[92:95], v[228:235], v44 abid:1
    s_waitcnt lgkmcnt(4)
    s_barrier
    v_xad_u32 v236, v236, v3, v4
    v_smfmac_f32_16x16x64_bf16 v[156:159], v[240:243], v[244:251], v10
    ds_read_b32 v0, v0
    v_xad_u32 v237, v237, v3, v4
    v_smfmac_f32_16x16x64_bf16 v[192:195], v[240:243], v[244:251], v10 abid:1
    ds_read2st64_b32 v[244:245], v236 offset0:0 offset1:72
    ds_read_b128 v[240:243], v8 offset:7168
    v_xad_u32 v238, v238, v3, v4
    v_smfmac_f32_16x16x64_bf16 v[132:135], v[60:63], v[220:227], v41
    ds_read2st64_b32 v[246:247], v237 offset0:0 offset1:72
    v_xad_u32 v239, v239, v3, v4
    v_smfmac_f32_16x16x64_bf16 v[132:135], v[96:99], v[228:235], v45
    ds_read2st64_b32 v[248:249], v238 offset0:0 offset1:72
    s_add_u32 m0, m0, 896
    v_smfmac_f32_16x16x64_bf16 v[136:139], v[64:67], v[220:227], v41 abid:1
    ds_read2st64_b32 v[250:251], v239 offset0:0 offset1:72
    ds_read_b128 v[236:239], v9 offset:9536
    s_waitcnt vmcnt(5)
    v_smfmac_f32_16x16x64_bf16 v[136:139], v[100:103], v[228:235], v45 abid:1
    buffer_load_dwordx4 v5, s[8:11], s22 offen offset:1024 nt lds
    s_waitcnt lgkmcnt(6)
    v_readfirstlane_b32 s88, v0
    v_smfmac_f32_16x16x64_bf16 v[140:143], v[68:71], v[220:227], v42
    s_cmp_lt_u32 s88, 75497472
    s_cselect_b32 s10, 75497472, 0
    v_smfmac_f32_16x16x64_bf16 v[140:143], v[104:107], v[228:235], v46
    v_smfmac_f32_16x16x64_bf16 v[144:147], v[72:75], v[220:227], v42 abid:1
    ds_read_b128 v[212:215], v1 offset:20480
    v_smfmac_f32_16x16x64_bf16 v[144:147], v[108:111], v[228:235], v46 abid:1
    ds_read_b128 v[216:219], v2 offset:20480
    v_smfmac_f32_16x16x64_bf16 v[148:151], v[76:79], v[220:227], v43
    v_smfmac_f32_16x16x64_bf16 v[148:151], v[112:115], v[228:235], v47
    v_smfmac_f32_16x16x64_bf16 v[152:155], v[80:83], v[220:227], v43 abid:1
    v_smfmac_f32_16x16x64_bf16 v[152:155], v[116:119], v[228:235], v47 abid:1
    s_waitcnt lgkmcnt(2)
    v_xad_u32 v236, v236, v3, v4
    v_smfmac_f32_16x16x64_bf16 v[152:155], v[240:243], v[244:251], v10
    v_xad_u32 v237, v237, v3, v4
    v_smfmac_f32_16x16x64_bf16 v[188:191], v[240:243], v[244:251], v10 abid:1
    s_cmp_gt_u32 s46, 1
    s_cbranch_scc1 M_slow
M_slowrE0:
    v_xad_u32 v238, v238, v3, v4
    v_smfmac_f32_16x16x64_bf16 v[156:159], v[84:87], v[220:227], v51 abid:1
    ds_read2st64_b32 v[244:245], v236 offset0:0 offset1:72
    ds_read_b128 v[240:243], v8 offset:5120
    v_xad_u32 v239, v239, v3, v4
    v_smfmac_f32_16x16x64_bf16 v[156:159], v[120:123], v[228:235], v52
    ds_read2st64_b32 v[246:247], v237 offset0:0 offset1:72
    ds_read_b128 v[220:223], v1 offset:21504
    v_smfmac_f32_16x16x64_bf16 v[160:163], a[0:3], v[196:203], v12
    ds_read2st64_b32 v[248:249], v238 offset0:0 offset1:72
    ds_read_b128 v[224:227], v2 offset:21504
    v_smfmac_f32_16x16x64_bf16 v[160:163], a[36:39], v[204:211], v16
    ds_read2st64_b32 v[250:251], v239 offset0:0 offset1:72
    ds_read_b128 v[236:239], v9 offset:9600
    s_waitcnt lgkmcnt(8)
    v_smfmac_f32_16x16x64_bf16 v[160:163], a[72:75], v[212:219], v20
    ds_read_b128 v[228:231], v1 offset:22528
    v_smfmac_f32_16x16x64_bf16 v[164:167], a[4:7], v[196:203], v12 abid:1
    ds_read_b128 v[232:235], v2 offset:22528
    v_cvt_pk_bf16_f32 v156, v156, v157
    v_smfmac_f32_16x16x64_bf16 v[164:167], a[40:43], v[204:211], v16 abid:1
    s_mov_b32 m0, s28
    v_cvt_pk_bf16_f32 v157, v158, v159
    v_smfmac_f32_16x16x64_bf16 v[164:167], a[76:79], v[212:219], v20 abid:1
    ds_write_b64 v252, v[156:157] offset:25728
    ds_read_b128 v[156:159], v9 offset:10752
    s_waitcnt vmcnt(6)
    v_smfmac_f32_16x16x64_bf16 v[168:171], a[8:11], v[196:203], v13
    buffer_load_dwordx4 v5, s[8:11], s88 offen offset:0 nt lds
    v_smfmac_f32_16x16x64_bf16 v[168:171], a[44:47], v[204:211], v17
    v_cvt_pk_bf16_f32 v124, v124, v125
    v_smfmac_f32_16x16x64_bf16 v[168:171], a[80:83], v[212:219], v21
    s_waitcnt lgkmcnt(4)
    v_xad_u32 v236, v236, v3, v4
    v_smfmac_f32_16x16x64_bf16 v[144:147], v[240:243], v[244:251], v10
    v_xad_u32 v237, v237, v3, v4
    v_smfmac_f32_16x16x64_bf16 v[180:183], v[240:243], v[244:251], v10 abid:1
    ds_read2st64_b32 v[244:245], v236 offset0:0 offset1:72
    ds_read_b128 v[240:243], v8 offset:6144
    v_xad_u32 v238, v238, v3, v4
    v_smfmac_f32_16x16x64_bf16 v[172:175], a[12:15], v[196:203], v13 abid:1
    ds_read2st64_b32 v[246:247], v237 offset0:0 offset1:72
    v_xad_u32 v239, v239, v3, v4
    v_smfmac_f32_16x16x64_bf16 v[172:175], a[48:51], v[204:211], v17 abid:1
    ds_read2st64_b32 v[248:249], v238 offset0:0 offset1:72
    v_cvt_pk_bf16_f32 v125, v126, v127
    v_smfmac_f32_16x16x64_bf16 v[172:175], a[84:87], v[212:219], v21 abid:1
    ds_read2st64_b32 v[250:251], v239 offset0:0 offset1:72
    ds_read_b128 v[236:239], v9 offset:9472
    v_cvt_pk_bf16_f32 v126, v128, v129
    v_smfmac_f32_16x16x64_bf16 v[176:179], a[16:19], v[196:203], v14
    v_cvt_pk_bf16_f32 v127, v130, v131
    v_smfmac_f32_16x16x64_bf16 v[176:179], a[52:55], v[204:211], v18
    v_cvt_pk_bf16_f32 v132, v132, v133
    v_smfmac_f32_16x16x64_bf16 v[176:179], a[88:91], v[212:219], v22
    v_cvt_pk_bf16_f32 v133, v134, v135
    v_smfmac_f32_16x16x64_bf16 v[180:183], a[20:23], v[196:203], v14 abid:1
    s_add_u32 m0, m0, 896
    v_cvt_pk_bf16_f32 v134, v136, v137
    v_smfmac_f32_16x16x64_bf16 v[180:183], a[56:59], v[204:211], v18 abid:1
    s_waitcnt vmcnt(5)
    buffer_load_dwordx4 v5, s[8:11], s88 offen offset:128 nt lds
    v_cvt_pk_bf16_f32 v135, v138, v139
    v_smfmac_f32_16x16x64_bf16 v[180:183], a[92:95], v[212:219], v22 abid:1
    ds_read_b128 v[136:139], v9 offset:10432
    v_cndmask_b32_dpp v128, v124, v132, vcc row_ror:8 row_mask:0xf bank_mask:0xf
    v_smfmac_f32_16x16x64_bf16 v[184:187], a[24:27], v[196:203], v15
    v_cndmask_b32_dpp v129, v125, v133, vcc row_ror:8 row_mask:0xf bank_mask:0xf
    v_smfmac_f32_16x16x64_bf16 v[184:187], a[60:63], v[204:211], v19
    v_cndmask_b32_dpp v130, v126, v134, vcc row_ror:8 row_mask:0xf bank_mask:0xf
    v_smfmac_f32_16x16x64_bf16 v[184:187], a[96:99], v[212:219], v23
    s_waitcnt lgkmcnt(1)
    v_xad_u32 v236, v236, v3, v4
    v_smfmac_f32_16x16x64_bf16 v[148:151], v[240:243], v[244:251], v10
    v_xad_u32 v237, v237, v3, v4
    v_smfmac_f32_16x16x64_bf16 v[184:187], v[240:243], v[244:251], v10 abid:1
    ds_read2st64_b32 v[244:245], v236 offset0:0 offset1:72
    ds_read_b128 v[240:243], v8 offset:4096
    v_xad_u32 v238, v238, v3, v4
    v_smfmac_f32_16x16x64_bf16 v[188:191], a[28:31], v[196:203], v15 abid:1
    ds_read2st64_b32 v[246:247], v237 offset0:0 offset1:72
    v_xad_u32 v239, v239, v3, v4
    v_smfmac_f32_16x16x64_bf16 v[188:191], a[64:67], v[204:211], v19 abid:1
    ds_read2st64_b32 v[248:249], v238 offset0:0 offset1:72
    v_cndmask_b32_dpp v131, v127, v135, vcc row_ror:8 row_mask:0xf bank_mask:0xf
    v_smfmac_f32_16x16x64_bf16 v[188:191], a[100:103], v[212:219], v23 abid:1
    ds_read2st64_b32 v[250:251], v239 offset0:0 offset1:72
    s_waitcnt vmcnt(6)
    buffer_store_dwordx4 v[128:131], v6, s[12:15], s59 offen offset:0 sc1
    v_smfmac_f32_16x16x64_bf16 v[192:195], a[32:35], v[196:203], v48
    v_mov_b32_dpp v124, v132 row_ror:8 row_mask:0xf bank_mask:0xc
    v_smfmac_f32_16x16x64_bf16 v[192:195], a[68:71], v[204:211], v48 abid:1
    v_mov_b32_dpp v125, v133 row_ror:8 row_mask:0xf bank_mask:0xc
    v_smfmac_f32_16x16x64_bf16 v[192:195], a[104:107], v[212:219], v49
    ds_read_b128 v[196:199], v1 offset:23552
    v_mov_b32_dpp v126, v134 row_ror:8 row_mask:0xf bank_mask:0xc
    v_smfmac_f32_16x16x64_bf16 v[160:163], a[108:111], v[220:227], v24
    ds_read_b128 v[200:203], v2 offset:23552
    v_mov_b32_dpp v127, v135 row_ror:8 row_mask:0xf bank_mask:0xc
    v_smfmac_f32_16x16x64_bf16 v[160:163], a[144:147], v[228:235], v28
    ds_read_b128 v[204:207], v1 offset:24576
    s_waitcnt vmcnt(5)
    buffer_store_dwordx4 v[124:127], v6, s[12:15], s24 offen offset:0 sc1
    v_smfmac_f32_16x16x64_bf16 v[164:167], a[112:115], v[220:227], v24 abid:1
    ds_read_b128 v[208:211], v2 offset:24576
    ds_read_b128 v[128:131], v9 offset:10304
    ds_read_b128 v[132:135], v9 offset:10368
    v_smfmac_f32_16x16x64_bf16 v[164:167], a[148:151], v[228:235], v28 abid:1
    ds_read_b128 v[124:127], v9 offset:10240
    v_smfmac_f32_16x16x64_bf16 v[168:171], a[116:119], v[220:227], v25
    v_smfmac_f32_16x16x64_bf16 v[168:171], a[152:155], v[228:235], v29
    s_waitcnt lgkmcnt(7)
    v_smfmac_f32_16x16x64_bf16 v[140:143], v[240:243], v[244:251], v10
    v_smfmac_f32_16x16x64_bf16 v[176:179], v[240:243], v[244:251], v10 abid:1
    v_smfmac_f32_16x16x64_bf16 v[172:175], a[120:123], v[220:227], v25 abid:1
    s_add_u32 s28, s28, 36864
    s_cmp_ge_u32 s28, 110592
    s_cselect_b32 s28, s26, s28
    v_smfmac_f32_16x16x64_bf16 v[172:175], a[156:159], v[228:235], v29 abid:1
    s_add_u32 s30, s25, 36864
    s_cmp_eq_u32 s30, 110592
    s_cselect_b32 s30, 0, s30
    v_smfmac_f32_16x16x64_bf16 v[176:179], a[124:127], v[220:227], v26
    s_sub_u32 s31, s30, s25
    s_mov_b32 s25, s30
    s_mov_b32 s90, s22
    v_smfmac_f32_16x16x64_bf16 v[176:179], a[160:163], v[228:235], v30
    s_mov_b32 s22, s88
    s_add_u32 s91, s91, 1
    s_cmp_lt_u32 s20, 2
    v_smfmac_f32_16x16x64_bf16 v[180:183], a[128:131], v[220:227], v26 abid:1
    s_cselect_b32 s66, s23, s24
    s_add_u32 s66, s66, s95
    v_smfmac_f32_16x16x64_bf16 v[180:183], a[164:167], v[228:235], v30 abid:1
    v_cvt_pk_bf16_f32 v140, v140, v141
    v_smfmac_f32_16x16x64_bf16 v[184:187], a[132:135], v[220:227], v27
    s_add_u32 m0, m0, 896
    v_cvt_pk_bf16_f32 v141, v142, v143
    v_smfmac_f32_16x16x64_bf16 v[184:187], a[168:171], v[228:235], v31
    s_waitcnt vmcnt(6)
    buffer_load_dwordx4 v5, s[8:11], s88 offen offset:256 nt lds
    v_cvt_pk_bf16_f32 v142, v144, v145
    v_smfmac_f32_16x16x64_bf16 v[188:191], a[136:139], v[220:227], v27 abid:1
    v_cvt_pk_bf16_f32 v143, v146, v147
    v_smfmac_f32_16x16x64_bf16 v[188:191], a[172:175], v[228:235], v31 abid:1
    v_cvt_pk_bf16_f32 v148, v148, v149
    v_smfmac_f32_16x16x64_bf16 v[192:195], a[140:143], v[220:227], v49 abid:1
    v_cvt_pk_bf16_f32 v149, v150, v151
    v_smfmac_f32_16x16x64_bf16 v[192:195], a[176:179], v[228:235], v50
    ds_read_b128 v[220:223], v1 offset:25600
    s_waitcnt lgkmcnt(6)
    v_cvt_pk_bf16_f32 v150, v152, v153
    v_smfmac_f32_16x16x64_bf16 v[160:163], a[180:183], v[196:203], v32
    ds_read_b128 v[224:227], v2 offset:25600
    s_waitcnt lgkmcnt(5)
    v_cvt_pk_bf16_f32 v151, v154, v155
    v_smfmac_f32_16x16x64_bf16 v[160:163], a[216:219], v[204:211], v36
    ds_read_b128 v[228:231], v1 offset:26624
    ds_read_b128 v[152:155], v9 offset:10688
    v_cndmask_b32_dpp v144, v140, v148, vcc row_ror:8 row_mask:0xf bank_mask:0xf
    v_smfmac_f32_16x16x64_bf16 v[164:167], a[184:187], v[196:203], v32 abid:1
    ds_read_b128 v[232:235], v2 offset:26624
    v_cndmask_b32_dpp v145, v141, v149, vcc row_ror:8 row_mask:0xf bank_mask:0xf
    v_smfmac_f32_16x16x64_bf16 v[164:167], a[220:223], v[204:211], v36 abid:1
    s_add_u32 m0, m0, 896
    v_cndmask_b32_dpp v146, v142, v150, vcc row_ror:8 row_mask:0xf bank_mask:0xf
    v_smfmac_f32_16x16x64_bf16 v[168:171], a[188:191], v[196:203], v33
    s_waitcnt vmcnt(5)
    buffer_load_dwordx4 v5, s[8:11], s88 offen offset:384 nt lds
    v_cndmask_b32_dpp v147, v143, v151, vcc row_ror:8 row_mask:0xf bank_mask:0xf
    v_smfmac_f32_16x16x64_bf16 v[168:171], a[224:227], v[204:211], v37
    s_waitcnt vmcnt(6)
    buffer_store_dwordx4 v[144:147], v6, s[12:15], s59 offen offset:128 sc1
    v_mov_b32_dpp v140, v148 row_ror:8 row_mask:0xf bank_mask:0xc
    v_smfmac_f32_16x16x64_bf16 v[172:175], a[192:195], v[196:203], v33 abid:1
    v_mov_b32_dpp v141, v149 row_ror:8 row_mask:0xf bank_mask:0xc
    v_smfmac_f32_16x16x64_bf16 v[172:175], a[228:231], v[204:211], v37 abid:1
    v_mov_b32_dpp v142, v150 row_ror:8 row_mask:0xf bank_mask:0xc
    v_smfmac_f32_16x16x64_bf16 v[176:179], a[196:199], v[196:203], v34
    v_mov_b32_dpp v143, v151 row_ror:8 row_mask:0xf bank_mask:0xc
    v_smfmac_f32_16x16x64_bf16 v[176:179], a[232:235], v[204:211], v38
    s_waitcnt vmcnt(5)
    buffer_store_dwordx4 v[140:143], v6, s[12:15], s24 offen offset:128 sc1
    ds_read_b128 v[144:147], v9 offset:10560
    v_smfmac_f32_16x16x64_bf16 v[180:183], a[200:203], v[196:203], v34 abid:1
    ds_read_b128 v[148:151], v9 offset:10624
    ds_read_b128 v[140:143], v9 offset:10496
    v_add_u32 v4, s31, v4
    v_smfmac_f32_16x16x64_bf16 v[180:183], a[236:239], v[204:211], v38 abid:1
    v_add_u32 v1, s31, v1
    v_smfmac_f32_16x16x64_bf16 v[184:187], a[204:207], v[196:203], v35
    v_add_u32 v2, s31, v2
    v_smfmac_f32_16x16x64_bf16 v[184:187], a[240:243], v[204:211], v39
    v_smfmac_f32_16x16x64_bf16 v[188:191], a[208:211], v[196:203], v35 abid:1
    v_smfmac_f32_16x16x64_bf16 v[188:191], a[244:247], v[204:211], v39 abid:1
    v_smfmac_f32_16x16x64_bf16 v[192:195], a[212:215], v[196:203], v50 abid:1
    v_smfmac_f32_16x16x64_bf16 v[192:195], a[248:251], v[204:211], v51
    s_branch M_top
M_bF:
    v_smfmac_f32_16x16x64_bf16 v[164:167], v[56:59], v[220:227], v40 abid:1
    ds_read_b128 v[204:207], v1 offset:1024
    v_smfmac_f32_16x16x64_bf16 v[164:167], v[92:95], v[228:235], v44 abid:1
    ds_read_b128 v[208:211], v2 offset:1024
    v_smfmac_f32_16x16x64_bf16 v[168:171], v[60:63], v[220:227], v41
    ds_read_b128 v[212:215], v1 offset:2048
    v_smfmac_f32_16x16x64_bf16 v[168:171], v[96:99], v[228:235], v45
    ds_read_b128 v[216:219], v2 offset:2048
    v_smfmac_f32_16x16x64_bf16 v[172:175], v[64:67], v[220:227], v41 abid:1
    s_waitcnt lgkmcnt(6)
    buffer_store_dwordx4 v[244:247], v7, s[12:15], s66 offen sc1
    v_smfmac_f32_16x16x64_bf16 v[172:175], v[100:103], v[228:235], v45 abid:1
    ds_read_b128 v[236:239], v9 offset:9408
    v_smfmac_f32_16x16x64_bf16 v[176:179], v[68:71], v[220:227], v42
    s_mov_b32 s21, 3
    v_smfmac_f32_16x16x64_bf16 v[176:179], v[104:107], v[228:235], v46
    v_smfmac_f32_16x16x64_bf16 v[180:183], v[72:75], v[220:227], v42 abid:1
    v_cvt_pk_bf16_f32 v160, v160, v161
    v_smfmac_f32_16x16x64_bf16 v[180:183], v[108:111], v[228:235], v46 abid:1
    v_cvt_pk_bf16_f32 v161, v162, v163
    v_smfmac_f32_16x16x64_bf16 v[184:187], v[76:79], v[220:227], v43
    v_cvt_pk_bf16_f32 v162, v164, v165
    v_smfmac_f32_16x16x64_bf16 v[184:187], v[112:115], v[228:235], v47
    v_cvt_pk_bf16_f32 v163, v166, v167
    v_smfmac_f32_16x16x64_bf16 v[188:191], v[80:83], v[220:227], v43 abid:1
    v_cvt_pk_bf16_f32 v168, v168, v169
    v_smfmac_f32_16x16x64_bf16 v[188:191], v[116:119], v[228:235], v47 abid:1
    v_cvt_pk_bf16_f32 v169, v170, v171
    v_smfmac_f32_16x16x64_bf16 v[192:195], v[84:87], v[220:227], v51 abid:1
    v_cvt_pk_bf16_f32 v170, v172, v173
    v_smfmac_f32_16x16x64_bf16 v[192:195], v[120:123], v[228:235], v52
    ds_read_b128 v[220:223], v1 offset:3072
    s_waitcnt lgkmcnt(6)
    v_cvt_pk_bf16_f32 v171, v174, v175
    v_smfmac_f32_16x16x64_bf16 v[124:127], a[0:3], v[196:203], v12
    ds_read_b128 v[224:227], v2 offset:3072
    ds_read_b128 v[172:175], v9 offset:10432
    s_waitcnt lgkmcnt(6)
    v_cndmask_b32_dpp v164, v160, v168, vcc row_ror:8 row_mask:0xf bank_mask:0xf
    v_smfmac_f32_16x16x64_bf16 v[124:127], a[36:39], v[204:211], v16
    ds_read_b128 v[228:231], v1 offset:4096
    s_waitcnt lgkmcnt(5)
    v_cndmask_b32_dpp v165, v161, v169, vcc row_ror:8 row_mask:0xf bank_mask:0xf
    v_smfmac_f32_16x16x64_bf16 v[124:127], a[72:75], v[212:219], v20
    ds_read_b128 v[232:235], v2 offset:4096
    s_waitcnt lgkmcnt(5)
    v_xad_u32 v236, v236, v3, v4
    v_smfmac_f32_16x16x64_bf16 v[128:131], a[4:7], v[196:203], v12 abid:1
    s_barrier
    v_xad_u32 v237, v237, v3, v4
    v_smfmac_f32_16x16x64_bf16 v[128:131], a[40:43], v[204:211], v16 abid:1
    ds_read2st64_b32 v[244:245], v236 offset0:0 offset1:72
    ds_read_b128 v[240:243], v8 offset:3072
    v_xad_u32 v238, v238, v3, v4
    v_smfmac_f32_16x16x64_bf16 v[128:131], a[76:79], v[212:219], v20 abid:1
    ds_read2st64_b32 v[246:247], v237 offset0:0 offset1:72
    v_xad_u32 v239, v239, v3, v4
    v_smfmac_f32_16x16x64_bf16 v[132:135], a[8:11], v[196:203], v13
    ds_read2st64_b32 v[248:249], v238 offset0:0 offset1:72
    v_cndmask_b32_dpp v166, v162, v170, vcc row_ror:8 row_mask:0xf bank_mask:0xf
    v_smfmac_f32_16x16x64_bf16 v[132:135], a[44:47], v[204:211], v17
    ds_read2st64_b32 v[250:251], v239 offset0:0 offset1:72
    ds_read_b128 v[236:239], v9 offset:9280
    v_cndmask_b32_dpp v167, v163, v171, vcc row_ror:8 row_mask:0xf bank_mask:0xf
    v_smfmac_f32_16x16x64_bf16 v[132:135], a[80:83], v[212:219], v21
    buffer_store_dwordx4 v[164:167], v6, s[12:15], s58 offen offset:0 sc1
    v_mov_b32_dpp v160, v168 row_ror:8 row_mask:0xf bank_mask:0xc
    v_smfmac_f32_16x16x64_bf16 v[136:139], a[12:15], v[196:203], v13 abid:1
    v_mov_b32_dpp v161, v169 row_ror:8 row_mask:0xf bank_mask:0xc
    v_smfmac_f32_16x16x64_bf16 v[136:139], a[48:51], v[204:211], v17 abid:1
    v_mov_b32_dpp v162, v170 row_ror:8 row_mask:0xf bank_mask:0xc
    v_smfmac_f32_16x16x64_bf16 v[136:139], a[84:87], v[212:219], v21 abid:1
    v_mov_b32_dpp v163, v171 row_ror:8 row_mask:0xf bank_mask:0xc
    v_smfmac_f32_16x16x64_bf16 v[140:143], a[16:19], v[196:203], v14
    buffer_store_dwordx4 v[160:163], v6, s[12:15], s23 offen offset:0 sc1
    ds_read_b128 v[164:167], v9 offset:10304
    ds_read_b128 v[168:171], v9 offset:10368
    v_smfmac_f32_16x16x64_bf16 v[140:143], a[52:55], v[204:211], v18
    ds_read_b128 v[160:163], v9 offset:10240
    v_smfmac_f32_16x16x64_bf16 v[140:143], a[88:91], v[212:219], v22
    s_waitcnt lgkmcnt(3)
    v_xad_u32 v236, v236, v3, v4
    v_smfmac_f32_16x16x64_bf16 v[136:139], v[240:243], v[244:251], v10
    v_xad_u32 v237, v237, v3, v4
    v_smfmac_f32_16x16x64_bf16 v[172:175], v[240:243], v[244:251], v10 abid:1
    ds_read2st64_b32 v[244:245], v236 offset0:0 offset1:72
    ds_read_b128 v[240:243], v8 offset:1024
    v_xad_u32 v238, v238, v3, v4
    v_smfmac_f32_16x16x64_bf16 v[144:147], a[20:23], v[196:203], v14 abid:1
    ds_read2st64_b32 v[246:247], v237 offset0:0 offset1:72
    v_xad_u32 v239, v239, v3, v4
    v_smfmac_f32_16x16x64_bf16 v[144:147], a[56:59], v[204:211], v18 abid:1
    ds_read2st64_b32 v[248:249], v238 offset0:0 offset1:72
    v_smfmac_f32_16x16x64_bf16 v[144:147], a[92:95], v[212:219], v22 abid:1
    ds_read2st64_b32 v[250:251], v239 offset0:0 offset1:72
    ds_read_b128 v[236:239], v9 offset:9344
    v_smfmac_f32_16x16x64_bf16 v[148:151], a[24:27], v[196:203], v15
    v_cvt_pk_bf16_f32 v192, v192, v193
    v_smfmac_f32_16x16x64_bf16 v[148:151], a[60:63], v[204:211], v19
    v_cvt_pk_bf16_f32 v193, v194, v195
    v_smfmac_f32_16x16x64_bf16 v[148:151], a[96:99], v[212:219], v23
    ds_write_b64 v252, v[192:193] offset:0
    ds_read_b128 v[192:195], v9 offset:10752
    v_smfmac_f32_16x16x64_bf16 v[152:155], a[28:31], v[196:203], v15 abid:1
    v_smfmac_f32_16x16x64_bf16 v[152:155], a[64:67], v[204:211], v19 abid:1
    v_smfmac_f32_16x16x64_bf16 v[152:155], a[100:103], v[212:219], v23 abid:1
    v_smfmac_f32_16x16x64_bf16 v[156:159], a[32:35], v[196:203], v48
    v_smfmac_f32_16x16x64_bf16 v[156:159], a[68:71], v[204:211], v48 abid:1
    v_smfmac_f32_16x16x64_bf16 v[156:159], a[104:107], v[212:219], v49
    s_waitcnt lgkmcnt(2)
    v_xad_u32 v236, v236, v3, v4
    v_smfmac_f32_16x16x64_bf16 v[128:131], v[240:243], v[244:251], v10
    ds_read_b128 v[196:199], v1 offset:5120
    v_xad_u32 v237, v237, v3, v4
    v_smfmac_f32_16x16x64_bf16 v[164:167], v[240:243], v[244:251], v10 abid:1
    ds_read2st64_b32 v[244:245], v236 offset0:0 offset1:72
    ds_read_b128 v[240:243], v8 offset:2048
    v_xad_u32 v238, v238, v3, v4
    v_smfmac_f32_16x16x64_bf16 v[124:127], a[108:111], v[220:227], v24
    ds_read2st64_b32 v[246:247], v237 offset0:0 offset1:72
    v_xad_u32 v239, v239, v3, v4
    v_smfmac_f32_16x16x64_bf16 v[124:127], a[144:147], v[228:235], v28
    ds_read2st64_b32 v[248:249], v238 offset0:0 offset1:72
    ds_read_b128 v[200:203], v2 offset:5120
    v_cvt_pk_bf16_f32 v176, v176, v177
    v_smfmac_f32_16x16x64_bf16 v[128:131], a[112:115], v[220:227], v24 abid:1
    ds_read2st64_b32 v[250:251], v239 offset0:0 offset1:72
    ds_read_b128 v[236:239], v9 offset:9216
    v_cvt_pk_bf16_f32 v177, v178, v179
    v_smfmac_f32_16x16x64_bf16 v[128:131], a[148:151], v[228:235], v28 abid:1
    ds_read_b128 v[204:207], v1 offset:6144
    ds_read_b128 v[216:219], v9 offset:9792
    v_cvt_pk_bf16_f32 v178, v180, v181
    v_smfmac_f32_16x16x64_bf16 v[132:135], a[116:119], v[220:227], v25
    ds_read_b128 v[208:211], v2 offset:6144
    v_cvt_pk_bf16_f32 v179, v182, v183
    v_smfmac_f32_16x16x64_bf16 v[132:135], a[152:155], v[228:235], v29
    v_cvt_pk_bf16_f32 v184, v184, v185
    v_smfmac_f32_16x16x64_bf16 v[136:139], a[120:123], v[220:227], v25 abid:1
    v_cvt_pk_bf16_f32 v185, v186, v187
    v_smfmac_f32_16x16x64_bf16 v[136:139], a[156:159], v[228:235], v29 abid:1
    v_cvt_pk_bf16_f32 v186, v188, v189
    v_smfmac_f32_16x16x64_bf16 v[140:143], a[124:127], v[220:227], v26
    v_cvt_pk_bf16_f32 v187, v190, v191
    v_smfmac_f32_16x16x64_bf16 v[140:143], a[160:163], v[228:235], v30
    ds_read_b128 v[188:191], v9 offset:10688
    s_waitcnt lgkmcnt(4)
    v_xad_u32 v236, v236, v3, v4
    v_smfmac_f32_16x16x64_bf16 v[132:135], v[240:243], v[244:251], v10
    v_xad_u32 v237, v237, v3, v4
    v_smfmac_f32_16x16x64_bf16 v[168:171], v[240:243], v[244:251], v10 abid:1
    ds_read2st64_b32 v[244:245], v236 offset0:0 offset1:72
    ds_read_b128 v[240:243], v8 offset:0
    v_xad_u32 v238, v238, v3, v4
    v_smfmac_f32_16x16x64_bf16 v[144:147], a[128:131], v[220:227], v26 abid:1
    ds_read2st64_b32 v[246:247], v237 offset0:0 offset1:72
    v_xad_u32 v239, v239, v3, v4
    v_smfmac_f32_16x16x64_bf16 v[144:147], a[164:167], v[228:235], v30 abid:1
    ds_read2st64_b32 v[248:249], v238 offset0:0 offset1:72
    v_cndmask_b32_dpp v180, v176, v184, vcc row_ror:8 row_mask:0xf bank_mask:0xf
    v_smfmac_f32_16x16x64_bf16 v[148:151], a[132:135], v[220:227], v27
    ds_read2st64_b32 v[250:251], v239 offset0:0 offset1:72
    ds_read_b128 v[236:239], v9 offset:9728
    v_cndmask_b32_dpp v181, v177, v185, vcc row_ror:8 row_mask:0xf bank_mask:0xf
    v_smfmac_f32_16x16x64_bf16 v[148:151], a[168:171], v[228:235], v31
    v_cndmask_b32_dpp v182, v178, v186, vcc row_ror:8 row_mask:0xf bank_mask:0xf
    v_smfmac_f32_16x16x64_bf16 v[152:155], a[136:139], v[220:227], v27 abid:1
    v_cndmask_b32_dpp v183, v179, v187, vcc row_ror:8 row_mask:0xf bank_mask:0xf
    v_smfmac_f32_16x16x64_bf16 v[152:155], a[172:175], v[228:235], v31 abid:1
    buffer_store_dwordx4 v[180:183], v6, s[12:15], s58 offen offset:128 sc1
    v_mov_b32_dpp v176, v184 row_ror:8 row_mask:0xf bank_mask:0xc
    v_smfmac_f32_16x16x64_bf16 v[156:159], a[140:143], v[220:227], v49 abid:1
    v_mov_b32_dpp v177, v185 row_ror:8 row_mask:0xf bank_mask:0xc
    v_smfmac_f32_16x16x64_bf16 v[156:159], a[176:179], v[228:235], v50
    ds_read_b128 v[220:223], v1 offset:7168
    v_mov_b32_dpp v178, v186 row_ror:8 row_mask:0xf bank_mask:0xc
    v_smfmac_f32_16x16x64_bf16 v[124:127], a[180:183], v[196:203], v32
    ds_read_b128 v[224:227], v2 offset:7168
    s_waitcnt lgkmcnt(9)
    v_mov_b32_dpp v179, v187 row_ror:8 row_mask:0xf bank_mask:0xc
    v_smfmac_f32_16x16x64_bf16 v[124:127], a[216:219], v[204:211], v36
    ds_read_b128 v[228:231], v1 offset:8192
    buffer_store_dwordx4 v[176:179], v6, s[12:15], s23 offen offset:128 sc1
    ds_read_b128 v[180:183], v9 offset:10560
    v_smfmac_f32_16x16x64_bf16 v[128:131], a[184:187], v[196:203], v32 abid:1
    ds_read_b128 v[232:235], v2 offset:8192
    ds_read_b128 v[184:187], v9 offset:10624
    ds_read_b128 v[176:179], v9 offset:10496
    v_smfmac_f32_16x16x64_bf16 v[128:131], a[220:223], v[204:211], v36 abid:1
    s_waitcnt lgkmcnt(7)
    v_xad_u32 v236, v236, v3, v4
    v_smfmac_f32_16x16x64_bf16 v[124:127], v[240:243], v[244:251], v10
    v_xad_u32 v237, v237, v3, v4
    v_smfmac_f32_16x16x64_bf16 v[160:163], v[240:243], v[244:251], v10 abid:1
    ds_read2st64_b32 v[244:245], v236 offset0:0 offset1:72
    ds_read_b128 v[240:243], v8 offset:8192
    v_xad_u32 v238, v238, v3, v4
    v_smfmac_f32_16x16x64_bf16 v[132:135], a[188:191], v[196:203], v33
    ds_read2st64_b32 v[246:247], v237 offset0:0 offset1:72
    v_xad_u32 v239, v239, v3, v4
    v_smfmac_f32_16x16x64_bf16 v[132:135], a[224:227], v[204:211], v37
    ds_read2st64_b32 v[248:249], v238 offset0:0 offset1:72
    v_and_b32 v212, 0x3fff, v216
    v_smfmac_f32_16x16x64_bf16 v[136:139], a[192:195], v[196:203], v33 abid:1
    ds_read2st64_b32 v[250:251], v239 offset0:0 offset1:72
    ds_read_b128 v[236:239], v9 offset:9664
    v_and_b32 v214, 0x3fff, v218
    v_smfmac_f32_16x16x64_bf16 v[136:139], a[228:231], v[204:211], v37 abid:1
    v_xad_u32 v212, v212, v3, v4
    v_smfmac_f32_16x16x64_bf16 v[140:143], a[196:199], v[196:203], v34
    ds_read2st64_b32 v[212:213], v212 offset0:0 offset1:72
    v_xad_u32 v214, v214, v3, v4
    v_smfmac_f32_16x16x64_bf16 v[140:143], a[232:235], v[204:211], v38
    ds_read2st64_b32 v[214:215], v214 offset0:0 offset1:72
    v_smfmac_f32_16x16x64_bf16 v[144:147], a[200:203], v[196:203], v34 abid:1
    v_smfmac_f32_16x16x64_bf16 v[144:147], a[236:239], v[204:211], v38 abid:1
    v_smfmac_f32_16x16x64_bf16 v[148:151], a[204:207], v[196:203], v35
    v_smfmac_f32_16x16x64_bf16 v[148:151], a[240:243], v[204:211], v39
    s_waitcnt lgkmcnt(2)
    v_xad_u32 v236, v236, v3, v4
    v_smfmac_f32_16x16x64_bf16 v[156:159], v[240:243], v[244:251], v10
    s_and_b32 s30, s27, 7
    s_waitcnt lgkmcnt(0)
    s_cbranch_scc1 M_ov0
M_ovr0F:
    v_xad_u32 v237, v237, v3, v4
    v_smfmac_f32_16x16x64_bf16 v[192:195], v[240:243], v[244:251], v10 abid:1
    ds_read2st64_b32 v[244:245], v236 offset0:0 offset1:72
    ds_read_b128 v[240:243], v8 offset:7168
    v_xad_u32 v238, v238, v3, v4
    v_smfmac_f32_16x16x64_bf16 v[152:155], a[208:211], v[196:203], v35 abid:1
    ds_read2st64_b32 v[246:247], v237 offset0:0 offset1:72
    v_xad_u32 v239, v239, v3, v4
    v_smfmac_f32_16x16x64_bf16 v[152:155], a[244:247], v[204:211], v39 abid:1
    ds_read2st64_b32 v[248:249], v238 offset0:0 offset1:72
    s_and_b32 s30, s27, 56
    s_cbranch_scc1 M_ov1
M_ovr1F:
    v_smfmac_f32_16x16x64_bf16 v[156:159], a[212:215], v[196:203], v50 abid:1
    ds_read2st64_b32 v[250:251], v239 offset0:0 offset1:72
    ds_read_b128 v[236:239], v9 offset:9536
    v_smfmac_f32_16x16x64_bf16 v[156:159], a[248:251], v[204:211], v51
    ds_read_b128 v[196:199], v1 offset:18432
    s_and_b32 s30, s27, 448
    s_cbranch_scc1 M_ov2
M_ovr2F:
    v_smfmac_f32_16x16x64_bf16 v[124:127], a[252:255], v[220:227], v40
    ds_read_b128 v[200:203], v2 offset:18432
    v_smfmac_f32_16x16x64_bf16 v[124:127], v[88:91], v[228:235], v44
    ds_read_b128 v[204:207], v1 offset:19456
    v_smfmac_f32_16x16x64_bf16 v[128:131], v[56:59], v[220:227], v40 abid:1
    ds_read_b128 v[208:211], v2 offset:19456
    v_smfmac_f32_16x16x64_bf16 v[128:131], v[92:95], v[228:235], v44 abid:1
    s_cmp_lt_u32 s20, 2
    s_cselect_b32 s66, s23, s24
    s_add_u32 s66, s66, s95
    v_smfmac_f32_16x16x64_bf16 v[132:135], v[60:63], v[220:227], v41
    s_add_u32 s23, s24, 18432
    s_add_u32 s58, s24, 27648
    s_add_u32 s67, s23, s95
    v_smfmac_f32_16x16x64_bf16 v[132:135], v[96:99], v[228:235], v45
    v_smfmac_f32_16x16x64_bf16 v[136:139], v[64:67], v[220:227], v41 abid:1
    v_smfmac_f32_16x16x64_bf16 v[136:139], v[100:103], v[228:235], v45 abid:1
    s_waitcnt lgkmcnt(4)
    v_xad_u32 v236, v236, v3, v4
    v_smfmac_f32_16x16x64_bf16 v[152:155], v[240:243], v[244:251], v10
    v_xad_u32 v237, v237, v3, v4
    v_smfmac_f32_16x16x64_bf16 v[188:191], v[240:243], v[244:251], v10 abid:1
    s_cmp_gt_u32 s46, 1
    s_cbranch_scc1 M_slow
M_slowrF:
    v_xad_u32 v238, v238, v3, v4
    v_smfmac_f32_16x16x64_bf16 v[140:143], v[68:71], v[220:227], v42
    ds_read2st64_b32 v[244:245], v236 offset0:0 offset1:72
    ds_read_b128 v[240:243], v8 offset:5120
    v_xad_u32 v239, v239, v3, v4
    v_smfmac_f32_16x16x64_bf16 v[140:143], v[104:107], v[228:235], v46
    ds_read2st64_b32 v[246:247], v237 offset0:0 offset1:72
    v_smfmac_f32_16x16x64_bf16 v[144:147], v[72:75], v[220:227], v42 abid:1
    ds_read2st64_b32 v[248:249], v238 offset0:0 offset1:72
    ds_read_b128 v[212:215], v1 offset:20480
    v_smfmac_f32_16x16x64_bf16 v[144:147], v[108:111], v[228:235], v46 abid:1
    ds_read2st64_b32 v[250:251], v239 offset0:0 offset1:72
    ds_read_b128 v[236:239], v9 offset:9600
    v_smfmac_f32_16x16x64_bf16 v[148:151], v[76:79], v[220:227], v43
    ds_read_b128 v[216:219], v2 offset:20480
    v_smfmac_f32_16x16x64_bf16 v[148:151], v[112:115], v[228:235], v47
    v_smfmac_f32_16x16x64_bf16 v[152:155], v[80:83], v[220:227], v43 abid:1
    v_smfmac_f32_16x16x64_bf16 v[152:155], v[116:119], v[228:235], v47 abid:1
    v_smfmac_f32_16x16x64_bf16 v[156:159], v[84:87], v[220:227], v51 abid:1
    v_smfmac_f32_16x16x64_bf16 v[156:159], v[120:123], v[228:235], v52
    ds_read_b128 v[220:223], v1 offset:21504
    s_waitcnt lgkmcnt(2)
    v_xad_u32 v236, v236, v3, v4
    v_smfmac_f32_16x16x64_bf16 v[144:147], v[240:243], v[244:251], v10
    ds_read_b128 v[224:227], v2 offset:21504
    v_xad_u32 v237, v237, v3, v4
    v_smfmac_f32_16x16x64_bf16 v[180:183], v[240:243], v[244:251], v10 abid:1
    ds_read2st64_b32 v[244:245], v236 offset0:0 offset1:72
    ds_read_b128 v[240:243], v8 offset:6144
    v_xad_u32 v238, v238, v3, v4
    v_smfmac_f32_16x16x64_bf16 v[192:195], a[32:35], v[196:203], v48
    ds_read2st64_b32 v[246:247], v237 offset0:0 offset1:72
    ds_read_b128 v[228:231], v1 offset:22528
    v_xad_u32 v239, v239, v3, v4
    v_smfmac_f32_16x16x64_bf16 v[192:195], a[68:71], v[204:211], v48 abid:1
    ds_read2st64_b32 v[248:249], v238 offset0:0 offset1:72
    ds_read_b128 v[232:235], v2 offset:22528
    s_waitcnt lgkmcnt(8)
    v_cvt_pk_bf16_f32 v124, v124, v125
    v_smfmac_f32_16x16x64_bf16 v[192:195], a[104:107], v[212:219], v49
    ds_read2st64_b32 v[250:251], v239 offset0:0 offset1:72
    ds_read_b128 v[236:239], v9 offset:9472
    v_cvt_pk_bf16_f32 v125, v126, v127
    v_smfmac_f32_16x16x64_bf16 v[160:163], a[0:3], v[196:203], v12
    v_cvt_pk_bf16_f32 v126, v128, v129
    v_smfmac_f32_16x16x64_bf16 v[160:163], a[36:39], v[204:211], v16
    v_cvt_pk_bf16_f32 v127, v130, v131
    v_smfmac_f32_16x16x64_bf16 v[160:163], a[72:75], v[212:219], v20
    v_cvt_pk_bf16_f32 v156, v156, v157
    v_smfmac_f32_16x16x64_bf16 v[164:167], a[4:7], v[196:203], v12 abid:1
    v_cvt_pk_bf16_f32 v157, v158, v159
    v_smfmac_f32_16x16x64_bf16 v[164:167], a[40:43], v[204:211], v16 abid:1
    ds_write_b64 v252, v[156:157] offset:25728
    v_cvt_pk_bf16_f32 v132, v132, v133
    v_smfmac_f32_16x16x64_bf16 v[164:167], a[76:79], v[212:219], v20 abid:1
    v_cvt_pk_bf16_f32 v133, v134, v135
    v_smfmac_f32_16x16x64_bf16 v[168:171], a[8:11], v[196:203], v13
    v_cvt_pk_bf16_f32 v134, v136, v137
    v_smfmac_f32_16x16x64_bf16 v[168:171], a[44:47], v[204:211], v17
    v_cvt_pk_bf16_f32 v135, v138, v139
    v_smfmac_f32_16x16x64_bf16 v[168:171], a[80:83], v[212:219], v21
    s_waitcnt lgkmcnt(1)
    v_xad_u32 v236, v236, v3, v4
    v_smfmac_f32_16x16x64_bf16 v[148:151], v[240:243], v[244:251], v10
    v_xad_u32 v237, v237, v3, v4
    v_smfmac_f32_16x16x64_bf16 v[184:187], v[240:243], v[244:251], v10 abid:1
    ds_read2st64_b32 v[244:245], v236 offset0:0 offset1:72
    ds_read_b128 v[240:243], v8 offset:4096
    v_xad_u32 v238, v238, v3, v4
    v_smfmac_f32_16x16x64_bf16 v[172:175], a[12:15], v[196:203], v13 abid:1
    ds_read2st64_b32 v[246:247], v237 offset0:0 offset1:72
    v_xad_u32 v239, v239, v3, v4
    v_smfmac_f32_16x16x64_bf16 v[172:175], a[48:51], v[204:211], v17 abid:1
    ds_read2st64_b32 v[248:249], v238 offset0:0 offset1:72
    v_cndmask_b32_dpp v128, v124, v132, vcc row_ror:8 row_mask:0xf bank_mask:0xf
    v_smfmac_f32_16x16x64_bf16 v[172:175], a[84:87], v[212:219], v21 abid:1
    ds_read2st64_b32 v[250:251], v239 offset0:0 offset1:72
    ds_read_b128 v[196:199], v1 offset:23552
    v_cndmask_b32_dpp v129, v125, v133, vcc row_ror:8 row_mask:0xf bank_mask:0xf
    v_smfmac_f32_16x16x64_bf16 v[192:195], a[140:143], v[220:227], v49 abid:1
    ds_read_b128 v[200:203], v2 offset:23552
    v_cndmask_b32_dpp v130, v126, v134, vcc row_ror:8 row_mask:0xf bank_mask:0xf
    v_smfmac_f32_16x16x64_bf16 v[192:195], a[176:179], v[228:235], v50
    ds_read_b128 v[204:207], v1 offset:24576
    v_cndmask_b32_dpp v131, v127, v135, vcc row_ror:8 row_mask:0xf bank_mask:0xf
    v_smfmac_f32_16x16x64_bf16 v[160:163], a[108:111], v[220:227], v24
    ds_read_b128 v[208:211], v2 offset:24576
    buffer_store_dwordx4 v[128:131], v6, s[12:15], s59 offen offset:0 sc1
    v_mov_b32_dpp v124, v132 row_ror:8 row_mask:0xf bank_mask:0xc
    v_smfmac_f32_16x16x64_bf16 v[160:163], a[144:147], v[228:235], v28
    s_waitcnt lgkmcnt(9)
    s_barrier
    ds_read_b128 v[236:239], v8 offset:10816
    v_mov_b32_dpp v125, v133 row_ror:8 row_mask:0xf bank_mask:0xc
    v_smfmac_f32_16x16x64_bf16 v[164:167], a[112:115], v[220:227], v24 abid:1
    ds_read_b128 v[212:215], v1 offset:20480
    v_mov_b32_dpp v126, v134 row_ror:8 row_mask:0xf bank_mask:0xc
    v_smfmac_f32_16x16x64_bf16 v[164:167], a[148:151], v[228:235], v28 abid:1
    ds_read_b128 v[216:219], v2 offset:20480
    v_mov_b32_dpp v127, v135 row_ror:8 row_mask:0xf bank_mask:0xc
    v_smfmac_f32_16x16x64_bf16 v[168:171], a[116:119], v[220:227], v25
    buffer_store_dwordx4 v[124:127], v6, s[12:15], s24 offen offset:0 sc1
    v_smfmac_f32_16x16x64_bf16 v[168:171], a[152:155], v[228:235], v29
    s_waitcnt lgkmcnt(7)
    v_smfmac_f32_16x16x64_bf16 v[140:143], v[240:243], v[244:251], v10
    v_smfmac_f32_16x16x64_bf16 v[176:179], v[240:243], v[244:251], v10 abid:1
    s_waitcnt lgkmcnt(2)
    buffer_store_dwordx4 v[236:239], v7, s[12:15], s66 offen sc1
    v_smfmac_f32_16x16x64_bf16 v[172:175], a[120:123], v[220:227], v25 abid:1
    v_smfmac_f32_16x16x64_bf16 v[172:175], a[156:159], v[228:235], v29 abid:1
    ds_read_b128 v[220:223], v1 offset:25600
    v_smfmac_f32_16x16x64_bf16 v[192:195], a[212:215], v[196:203], v50 abid:1
    ds_read_b128 v[224:227], v2 offset:25600
    v_cvt_pk_bf16_f32 v140, v140, v141
    v_smfmac_f32_16x16x64_bf16 v[192:195], a[248:251], v[204:211], v51
    ds_read_b128 v[228:231], v1 offset:26624
    v_cvt_pk_bf16_f32 v141, v142, v143
    v_smfmac_f32_16x16x64_bf16 v[160:163], a[180:183], v[196:203], v32
    ds_read_b128 v[232:235], v2 offset:26624
    v_cvt_pk_bf16_f32 v142, v144, v145
    v_smfmac_f32_16x16x64_bf16 v[160:163], a[216:219], v[204:211], v36
    v_cvt_pk_bf16_f32 v143, v146, v147
    v_smfmac_f32_16x16x64_bf16 v[164:167], a[184:187], v[196:203], v32 abid:1
    v_cvt_pk_bf16_f32 v148, v148, v149
    v_smfmac_f32_16x16x64_bf16 v[164:167], a[220:223], v[204:211], v36 abid:1
    v_cvt_pk_bf16_f32 v149, v150, v151
    v_smfmac_f32_16x16x64_bf16 v[168:171], a[188:191], v[196:203], v33
    v_cvt_pk_bf16_f32 v150, v152, v153
    v_smfmac_f32_16x16x64_bf16 v[168:171], a[224:227], v[204:211], v37
    v_cvt_pk_bf16_f32 v151, v154, v155
    v_smfmac_f32_16x16x64_bf16 v[172:175], a[192:195], v[196:203], v33 abid:1
    v_cndmask_b32_dpp v144, v140, v148, vcc row_ror:8 row_mask:0xf bank_mask:0xf
    v_smfmac_f32_16x16x64_bf16 v[172:175], a[228:231], v[204:211], v37 abid:1
    ds_read_b128 v[196:199], v1 offset:18432
    s_waitcnt lgkmcnt(3)
    v_cndmask_b32_dpp v145, v141, v149, vcc row_ror:8 row_mask:0xf bank_mask:0xf
    v_smfmac_f32_16x16x64_bf16 v[192:195], v[84:87], v[220:227], v51 abid:1
    ds_read_b128 v[200:203], v2 offset:18432
    s_waitcnt lgkmcnt(2)
    v_cndmask_b32_dpp v146, v142, v150, vcc row_ror:8 row_mask:0xf bank_mask:0xf
    v_smfmac_f32_16x16x64_bf16 v[192:195], v[120:123], v[228:235], v52
    ds_read_b128 v[204:207], v1 offset:19456
    v_cndmask_b32_dpp v147, v143, v151, vcc row_ror:8 row_mask:0xf bank_mask:0xf
    v_smfmac_f32_16x16x64_bf16 v[160:163], a[252:255], v[220:227], v40
    ds_read_b128 v[208:211], v2 offset:19456
    buffer_store_dwordx4 v[144:147], v6, s[12:15], s59 offen offset:128 sc1
    v_mov_b32_dpp v140, v148 row_ror:8 row_mask:0xf bank_mask:0xc
    v_smfmac_f32_16x16x64_bf16 v[160:163], v[88:91], v[228:235], v44
    v_mov_b32_dpp v141, v149 row_ror:8 row_mask:0xf bank_mask:0xc
    v_smfmac_f32_16x16x64_bf16 v[164:167], v[56:59], v[220:227], v40 abid:1
    v_mov_b32_dpp v142, v150 row_ror:8 row_mask:0xf bank_mask:0xc
    v_smfmac_f32_16x16x64_bf16 v[164:167], v[92:95], v[228:235], v44 abid:1
    v_mov_b32_dpp v143, v151 row_ror:8 row_mask:0xf bank_mask:0xc
    v_smfmac_f32_16x16x64_bf16 v[168:171], v[60:63], v[220:227], v41
    buffer_store_dwordx4 v[140:143], v6, s[12:15], s24 offen offset:128 sc1
    v_cvt_pk_bf16_f32 v192, v192, v193
    v_smfmac_f32_16x16x64_bf16 v[168:171], v[96:99], v[228:235], v45
    v_cvt_pk_bf16_f32 v193, v194, v195
    v_smfmac_f32_16x16x64_bf16 v[172:175], v[64:67], v[220:227], v41 abid:1
    ds_write_b64 v252, v[192:193] offset:1024
    v_smfmac_f32_16x16x64_bf16 v[172:175], v[100:103], v[228:235], v45 abid:1
    ds_read_b128 v[220:223], v1 offset:21504
    s_waitcnt lgkmcnt(4)
    v_smfmac_f32_16x16x64_bf16 v[176:179], a[16:19], v[196:203], v14
    ds_read_b128 v[224:227], v2 offset:21504
    s_waitcnt lgkmcnt(3)
    v_smfmac_f32_16x16x64_bf16 v[176:179], a[52:55], v[204:211], v18
    ds_read_b128 v[228:231], v1 offset:22528
    v_smfmac_f32_16x16x64_bf16 v[176:179], a[88:91], v[212:219], v22
    ds_read_b128 v[232:235], v2 offset:22528
    s_waitcnt lgkmcnt(4)
    s_barrier
    ds_read_b128 v[236:239], v8 offset:11840
    v_smfmac_f32_16x16x64_bf16 v[180:183], a[20:23], v[196:203], v14 abid:1
    v_cvt_pk_bf16_f32 v160, v160, v161
    v_smfmac_f32_16x16x64_bf16 v[180:183], a[56:59], v[204:211], v18 abid:1
    v_cvt_pk_bf16_f32 v161, v162, v163
    v_smfmac_f32_16x16x64_bf16 v[180:183], a[92:95], v[212:219], v22 abid:1
    v_cvt_pk_bf16_f32 v162, v164, v165
    v_smfmac_f32_16x16x64_bf16 v[184:187], a[24:27], v[196:203], v15
    v_cvt_pk_bf16_f32 v163, v166, v167
    v_smfmac_f32_16x16x64_bf16 v[184:187], a[60:63], v[204:211], v19
    v_cvt_pk_bf16_f32 v168, v168, v169
    v_smfmac_f32_16x16x64_bf16 v[184:187], a[96:99], v[212:219], v23
    s_cmp_lt_u32 s20, 2
    s_waitcnt lgkmcnt(0)
    s_cbranch_scc0 M_fx
    buffer_store_dwordx4 v[236:239], v7, s[12:15], s67 offen sc1
M_fx:
    v_smfmac_f32_16x16x64_bf16 v[188:191], a[28:31], v[196:203], v15 abid:1
    v_cvt_pk_bf16_f32 v169, v170, v171
    v_smfmac_f32_16x16x64_bf16 v[188:191], a[64:67], v[204:211], v19 abid:1
    v_cvt_pk_bf16_f32 v170, v172, v173
    v_smfmac_f32_16x16x64_bf16 v[188:191], a[100:103], v[212:219], v23 abid:1
    ds_read_b128 v[196:199], v1 offset:23552
    v_cvt_pk_bf16_f32 v171, v174, v175
    v_smfmac_f32_16x16x64_bf16 v[176:179], a[124:127], v[220:227], v26
    ds_read_b128 v[200:203], v2 offset:23552
    v_cndmask_b32_dpp v164, v160, v168, vcc row_ror:8 row_mask:0xf bank_mask:0xf
    v_smfmac_f32_16x16x64_bf16 v[176:179], a[160:163], v[228:235], v30
    ds_read_b128 v[204:207], v1 offset:24576
    v_cndmask_b32_dpp v165, v161, v169, vcc row_ror:8 row_mask:0xf bank_mask:0xf
    v_smfmac_f32_16x16x64_bf16 v[180:183], a[128:131], v[220:227], v26 abid:1
    ds_read_b128 v[208:211], v2 offset:24576
    v_cndmask_b32_dpp v166, v162, v170, vcc row_ror:8 row_mask:0xf bank_mask:0xf
    v_smfmac_f32_16x16x64_bf16 v[180:183], a[164:167], v[228:235], v30 abid:1
    v_cndmask_b32_dpp v167, v163, v171, vcc row_ror:8 row_mask:0xf bank_mask:0xf
    v_smfmac_f32_16x16x64_bf16 v[184:187], a[132:135], v[220:227], v27
    buffer_store_dwordx4 v[164:167], v6, s[12:15], s58 offen offset:0 sc1
    v_mov_b32_dpp v160, v168 row_ror:8 row_mask:0xf bank_mask:0xc
    v_smfmac_f32_16x16x64_bf16 v[184:187], a[168:171], v[228:235], v31
    v_mov_b32_dpp v161, v169 row_ror:8 row_mask:0xf bank_mask:0xc
    v_smfmac_f32_16x16x64_bf16 v[188:191], a[136:139], v[220:227], v27 abid:1
    v_mov_b32_dpp v162, v170 row_ror:8 row_mask:0xf bank_mask:0xc
    v_smfmac_f32_16x16x64_bf16 v[188:191], a[172:175], v[228:235], v31 abid:1
    ds_read_b128 v[220:223], v1 offset:25600
    s_waitcnt lgkmcnt(3)
    v_mov_b32_dpp v163, v171 row_ror:8 row_mask:0xf bank_mask:0xc
    v_smfmac_f32_16x16x64_bf16 v[176:179], a[196:199], v[196:203], v34
    ds_read_b128 v[224:227], v2 offset:25600
    buffer_store_dwordx4 v[160:163], v6, s[12:15], s23 offen offset:0 sc1
    s_waitcnt lgkmcnt(2)
    v_smfmac_f32_16x16x64_bf16 v[176:179], a[232:235], v[204:211], v38
    ds_read_b128 v[228:231], v1 offset:26624
    v_smfmac_f32_16x16x64_bf16 v[180:183], a[200:203], v[196:203], v34 abid:1
    ds_read_b128 v[232:235], v2 offset:26624
    v_smfmac_f32_16x16x64_bf16 v[180:183], a[236:239], v[204:211], v38 abid:1
    v_smfmac_f32_16x16x64_bf16 v[184:187], a[204:207], v[196:203], v35
    v_smfmac_f32_16x16x64_bf16 v[184:187], a[240:243], v[204:211], v39
    v_smfmac_f32_16x16x64_bf16 v[188:191], a[208:211], v[196:203], v35 abid:1
    v_smfmac_f32_16x16x64_bf16 v[188:191], a[244:247], v[204:211], v39 abid:1
    s_waitcnt lgkmcnt(2)
    v_smfmac_f32_16x16x64_bf16 v[176:179], v[68:71], v[220:227], v42
    s_waitcnt lgkmcnt(0)
    v_smfmac_f32_16x16x64_bf16 v[176:179], v[104:107], v[228:235], v46
    v_smfmac_f32_16x16x64_bf16 v[180:183], v[72:75], v[220:227], v42 abid:1
    v_smfmac_f32_16x16x64_bf16 v[180:183], v[108:111], v[228:235], v46 abid:1
    v_smfmac_f32_16x16x64_bf16 v[184:187], v[76:79], v[220:227], v43
    v_smfmac_f32_16x16x64_bf16 v[184:187], v[112:115], v[228:235], v47
    v_smfmac_f32_16x16x64_bf16 v[188:191], v[80:83], v[220:227], v43 abid:1
    v_smfmac_f32_16x16x64_bf16 v[188:191], v[116:119], v[228:235], v47 abid:1
    s_nop 1
    v_cvt_pk_bf16_f32 v176, v176, v177
    v_cvt_pk_bf16_f32 v177, v178, v179
    v_cvt_pk_bf16_f32 v178, v180, v181
    v_cvt_pk_bf16_f32 v179, v182, v183
    v_cvt_pk_bf16_f32 v184, v184, v185
    v_cvt_pk_bf16_f32 v185, v186, v187
    v_cvt_pk_bf16_f32 v186, v188, v189
    v_cvt_pk_bf16_f32 v187, v190, v191
    v_cndmask_b32_dpp v180, v176, v184, vcc row_ror:8 row_mask:0xf bank_mask:0xf
    v_cndmask_b32_dpp v181, v177, v185, vcc row_ror:8 row_mask:0xf bank_mask:0xf
    v_cndmask_b32_dpp v182, v178, v186, vcc row_ror:8 row_mask:0xf bank_mask:0xf
    v_cndmask_b32_dpp v183, v179, v187, vcc row_ror:8 row_mask:0xf bank_mask:0xf
    buffer_store_dwordx4 v[180:183], v6, s[12:15], s58 offen offset:128 sc1
    v_mov_b32_dpp v176, v184 row_ror:8 row_mask:0xf bank_mask:0xc
    v_mov_b32_dpp v177, v185 row_ror:8 row_mask:0xf bank_mask:0xc
    v_mov_b32_dpp v178, v186 row_ror:8 row_mask:0xf bank_mask:0xc
    v_mov_b32_dpp v179, v187 row_ror:8 row_mask:0xf bank_mask:0xc
    buffer_store_dwordx4 v[176:179], v6, s[12:15], s23 offen offset:128 sc1
M_end:
    s_endpgm
M_pf_spin:
    s_sleep 1
    buffer_load_dword v0, off, s[16:19], s96 sc1
    s_add_u32 s31, s31, 1
    s_waitcnt vmcnt(0)
    v_readfirstlane_b32 s30, v0
    s_nop 0
    s_sub_u32 s30, s30, s100
    s_cmp_eq_u32 s30, 27
    s_cbranch_scc1 M_pf_ok
    s_cmp_lt_u32 s31, 24
    s_cbranch_scc1 M_pf_spin
    s_cmp_eq_u32 s98, 0
    s_cbranch_scc1 M_pf_spin2
    s_mov_b32 s98, 0
    v_mov_b32 v0, 1
    s_mov_b64 exec, 1
    buffer_atomic_add v0, off, s[68:71], 0 offset:0 sc1
    s_mov_b64 exec, -1
    s_nop 3
M_pf_spin2:
    s_sleep 16
    buffer_load_dword v0, off, s[68:71], 0 offset:0 sc1
    s_add_u32 s31, s31, 1
    s_cmp_ge_u32 s31, 131072
    s_cbranch_scc1 M_end
    s_waitcnt vmcnt(0)
    v_readfirstlane_b32 s30, v0
    s_nop 0
    s_cmp_eq_u32 s30, 81
    s_cbranch_scc0 M_pf_spin2
    s_branch M_pf_ok
M_ovb:
    s_mov_b32 s33, 0
    v_subrev_u32 v74, 16, v68
    v_mov_b32 v75, s33
    v_cmp_gt_u32 s[44:45], 48, v74
    s_nop 1
    v_mbcnt_lo_u32_b32 v75, s44, v75
    v_mbcnt_hi_u32_b32 v75, s45, v75
    s_bcnt1_i32_b64 s34, s[44:45]
    v_min_u32 v75, 32, v75
    s_add_u32 s33, s33, s34
    v_lshl_add_u32 v75, v75, 3, s48
    v_cndmask_b32 v75, v82, v75, s[44:45]
    ds_write_b64 v75, v[56:57]
    v_subrev_u32 v74, 16, v69
    v_mov_b32 v75, s33
    v_cmp_gt_u32 s[44:45], 48, v74
    s_nop 1
    v_mbcnt_lo_u32_b32 v75, s44, v75
    v_mbcnt_hi_u32_b32 v75, s45, v75
    s_bcnt1_i32_b64 s34, s[44:45]
    v_min_u32 v75, 32, v75
    s_add_u32 s33, s33, s34
    v_lshl_add_u32 v75, v75, 3, s48
    v_cndmask_b32 v75, v82, v75, s[44:45]
    ds_write_b64 v75, v[58:59]
    v_subrev_u32 v74, 16, v70
    v_mov_b32 v75, s33
    v_cmp_gt_u32 s[44:45], 48, v74
    s_nop 1
    v_mbcnt_lo_u32_b32 v75, s44, v75
    v_mbcnt_hi_u32_b32 v75, s45, v75
    s_bcnt1_i32_b64 s34, s[44:45]
    v_min_u32 v75, 32, v75
    s_add_u32 s33, s33, s34
    v_lshl_add_u32 v75, v75, 3, s48
    v_cndmask_b32 v75, v82, v75, s[44:45]
    ds_write_b64 v75, v[60:61]
    v_subrev_u32 v74, 16, v71
    v_mov_b32 v75, s33
    v_cmp_gt_u32 s[44:45], 48, v74
    s_nop 1
    v_mbcnt_lo_u32_b32 v75, s44, v75
    v_mbcnt_hi_u32_b32 v75, s45, v75
    s_bcnt1_i32_b64 s34, s[44:45]
    v_min_u32 v75, 32, v75
    s_add_u32 s33, s33, s34
    v_lshl_add_u32 v75, v75, 3, s48
    v_cndmask_b32 v75, v82, v75, s[44:45]
    ds_write_b64 v75, v[62:63]
    v_subrev_u32 v74, 16, v72
    v_mov_b32 v75, s33
    v_cmp_gt_u32 s[44:45], 48, v74
    s_nop 1
    v_mbcnt_lo_u32_b32 v75, s44, v75
    v_mbcnt_hi_u32_b32 v75, s45, v75
    s_bcnt1_i32_b64 s34, s[44:45]
    v_min_u32 v75, 32, v75
    s_add_u32 s33, s33, s34
    v_lshl_add_u32 v75, v75, 3, s48
    v_cndmask_b32 v75, v82, v75, s[44:45]
    ds_write_b64 v75, v[64:65]
    v_subrev_u32 v74, 16, v73
    v_mov_b32 v75, s33
    v_cmp_gt_u32 s[44:45], 48, v74
    s_nop 1
    v_mbcnt_lo_u32_b32 v75, s44, v75
    v_mbcnt_hi_u32_b32 v75, s45, v75
    s_bcnt1_i32_b64 s34, s[44:45]
    v_min_u32 v75, 32, v75
    s_add_u32 s33, s33, s34
    v_lshl_add_u32 v75, v75, 3, s48
    v_cndmask_b32 v75, v82, v75, s[44:45]
    ds_write_b64 v75, v[66:67]
    s_add_u32 s46, s33, 7
    s_lshr_b32 s46, s46, 3
    s_cmp_gt_u32 s33, 32
    s_cselect_b32 s32, 1, s32
    s_cmp_eq_u32 s32, 0
    s_cbranch_scc1 M_ovbr
    s_mov_b32 s27, 0
    s_mov_b32 s46, 0x80000000
    v_mov_b32 v244, 0
    v_mov_b32 v245, 0
    v_mov_b32 v246, 0
    v_mov_b32 v247, 0
    ds_write_b128 v8, v[244:247] offset:0
    ds_write_b128 v8, v[244:247] offset:1024
    ds_write_b128 v8, v[244:247] offset:2048
    ds_write_b128 v8, v[244:247] offset:3072
    ds_write_b128 v8, v[244:247] offset:4096
    ds_write_b128 v8, v[244:247] offset:5120
    ds_write_b128 v8, v[244:247] offset:6144
    ds_write_b128 v8, v[244:247] offset:7168
    ds_write_b128 v8, v[244:247] offset:8192
    s_waitcnt lgkmcnt(0)
    s_branch M_ovbr
M_ov0:
    s_bitcmp1_b32 s27, 0
    s_cbranch_scc0 M_ovs0
    v_bfe_u32 v53, v11, 4, 4
    v_lshrrev_b32 v54, 18, v216
    v_lshrrev_b32 v55, 18, v218
    v_or_b32 v53, 0, v53
    v_cmp_eq_u32 s[44:45], v54, v53
    v_cmp_eq_u32 s[54:55], v55, v53
    s_nop 0
    v_cndmask_b32 v54, 0, v217, s[44:45]
    v_cndmask_b32 v55, 0, v219, s[54:55]
    s_nop 1
    v_smfmac_f32_16x16x32_bf16 v[124:127], v[54:55], v[212:215], v10
    v_smfmac_f32_16x16x32_bf16 v[160:163], v[54:55], v[212:215], v10 abid:2
M_ovs0:
    s_bitcmp1_b32 s27, 1
    s_cbranch_scc0 M_ovs1
    v_bfe_u32 v53, v11, 4, 4
    v_lshrrev_b32 v54, 18, v216
    v_lshrrev_b32 v55, 18, v218
    v_or_b32 v53, 64, v53
    v_cmp_eq_u32 s[44:45], v54, v53
    v_cmp_eq_u32 s[54:55], v55, v53
    s_nop 0
    v_cndmask_b32 v54, 0, v217, s[44:45]
    v_cndmask_b32 v55, 0, v219, s[54:55]
    s_nop 1
    v_smfmac_f32_16x16x32_bf16 v[128:131], v[54:55], v[212:215], v10
    v_smfmac_f32_16x16x32_bf16 v[164:167], v[54:55], v[212:215], v10 abid:2
M_ovs1:
    s_bitcmp1_b32 s27, 2
    s_cbranch_scc0 M_ovs2
    v_bfe_u32 v53, v11, 4, 4
    v_lshrrev_b32 v54, 18, v216
    v_lshrrev_b32 v55, 18, v218
    v_or_b32 v53, 128, v53
    v_cmp_eq_u32 s[44:45], v54, v53
    v_cmp_eq_u32 s[54:55], v55, v53
    s_nop 0
    v_cndmask_b32 v54, 0, v217, s[44:45]
    v_cndmask_b32 v55, 0, v219, s[54:55]
    s_nop 1
    v_smfmac_f32_16x16x32_bf16 v[132:135], v[54:55], v[212:215], v10
    v_smfmac_f32_16x16x32_bf16 v[168:171], v[54:55], v[212:215], v10 abid:2
M_ovs2:
    s_nop 3
    s_cmp_eq_u32 s21, 1
    s_cbranch_scc1 M_ovr0L
    s_cmp_eq_u32 s21, 2
    s_cbranch_scc1 M_ovr0E0
    s_cmp_eq_u32 s21, 3
    s_cbranch_scc1 M_ovr0F
    s_branch M_ovp0
M_ov1:
    s_bitcmp1_b32 s27, 3
    s_cbranch_scc0 M_ovs3
    v_bfe_u32 v53, v11, 4, 4
    v_lshrrev_b32 v54, 18, v216
    v_lshrrev_b32 v55, 18, v218
    v_or_b32 v53, 192, v53
    v_cmp_eq_u32 s[44:45], v54, v53
    v_cmp_eq_u32 s[54:55], v55, v53
    s_nop 0
    v_cndmask_b32 v54, 0, v217, s[44:45]
    v_cndmask_b32 v55, 0, v219, s[54:55]
    s_nop 1
    v_smfmac_f32_16x16x32_bf16 v[136:139], v[54:55], v[212:215], v10
    v_smfmac_f32_16x16x32_bf16 v[172:175], v[54:55], v[212:215], v10 abid:2
M_ovs3:
    s_bitcmp1_b32 s27, 4
    s_cbranch_scc0 M_ovs4
    v_bfe_u32 v53, v11, 4, 4
    v_lshrrev_b32 v54, 18, v216
    v_lshrrev_b32 v55, 18, v218
    v_or_b32 v53, 256, v53
    v_cmp_eq_u32 s[44:45], v54, v53
    v_cmp_eq_u32 s[54:55], v55, v53
    s_nop 0
    v_cndmask_b32 v54, 0, v217, s[44:45]
    v_cndmask_b32 v55, 0, v219, s[54:55]
    s_nop 1
    v_smfmac_f32_16x16x32_bf16 v[140:143], v[54:55], v[212:215], v10
    v_smfmac_f32_16x16x32_bf16 v[176:179], v[54:55], v[212:215], v10 abid:2
M_ovs4:
    s_bitcmp1_b32 s27, 5
    s_cbranch_scc0 M_ovs5
    v_bfe_u32 v53, v11, 4, 4
    v_lshrrev_b32 v54, 18, v216
    v_lshrrev_b32 v55, 18, v218
    v_or_b32 v53, 320, v53
    v_cmp_eq_u32 s[44:45], v54, v53
    v_cmp_eq_u32 s[54:55], v55, v53
    s_nop 0
    v_cndmask_b32 v54, 0, v217, s[44:45]
    v_cndmask_b32 v55, 0, v219, s[54:55]
    s_nop 1
    v_smfmac_f32_16x16x32_bf16 v[144:147], v[54:55], v[212:215], v10
    v_smfmac_f32_16x16x32_bf16 v[180:183], v[54:55], v[212:215], v10 abid:2
M_ovs5:
    s_nop 3
    s_cmp_eq_u32 s21, 1
    s_cbranch_scc1 M_ovr1L
    s_cmp_eq_u32 s21, 2
    s_cbranch_scc1 M_ovr1E0
    s_cmp_eq_u32 s21, 3
    s_cbranch_scc1 M_ovr1F
    s_branch M_ovp1
M_ov2:
    s_bitcmp1_b32 s27, 6
    s_cbranch_scc0 M_ovs6
    v_bfe_u32 v53, v11, 4, 4
    v_lshrrev_b32 v54, 18, v216
    v_lshrrev_b32 v55, 18, v218
    v_or_b32 v53, 384, v53
    v_cmp_eq_u32 s[44:45], v54, v53
    v_cmp_eq_u32 s[54:55], v55, v53
    s_nop 0
    v_cndmask_b32 v54, 0, v217, s[44:45]
    v_cndmask_b32 v55, 0, v219, s[54:55]
    s_nop 1
    v_smfmac_f32_16x16x32_bf16 v[148:151], v[54:55], v[212:215], v10
    v_smfmac_f32_16x16x32_bf16 v[184:187], v[54:55], v[212:215], v10 abid:2
M_ovs6:
    s_bitcmp1_b32 s27, 7
    s_cbranch_scc0 M_ovs7
    v_bfe_u32 v53, v11, 4, 4
    v_lshrrev_b32 v54, 18, v216
    v_lshrrev_b32 v55, 18, v218
    v_or_b32 v53, 448, v53
    v_cmp_eq_u32 s[44:45], v54, v53
    v_cmp_eq_u32 s[54:55], v55, v53
    s_nop 0
    v_cndmask_b32 v54, 0, v217, s[44:45]
    v_cndmask_b32 v55, 0, v219, s[54:55]
    s_nop 1
    v_smfmac_f32_16x16x32_bf16 v[152:155], v[54:55], v[212:215], v10
    v_smfmac_f32_16x16x32_bf16 v[188:191], v[54:55], v[212:215], v10 abid:2
M_ovs7:
    s_bitcmp1_b32 s27, 8
    s_cbranch_scc0 M_ovs8
    v_bfe_u32 v53, v11, 4, 4
    v_lshrrev_b32 v54, 18, v216
    v_lshrrev_b32 v55, 18, v218
    v_or_b32 v53, 512, v53
    v_cmp_eq_u32 s[44:45], v54, v53
    v_cmp_eq_u32 s[54:55], v55, v53
    s_nop 0
    v_cndmask_b32 v54, 0, v217, s[44:45]
    v_cndmask_b32 v55, 0, v219, s[54:55]
    s_nop 1
    v_smfmac_f32_16x16x32_bf16 v[156:159], v[54:55], v[212:215], v10
    v_smfmac_f32_16x16x32_bf16 v[192:195], v[54:55], v[212:215], v10 abid:2
M_ovs8:
    s_nop 3
    s_cmp_eq_u32 s21, 1
    s_cbranch_scc1 M_ovr2L
    s_cmp_eq_u32 s21, 2
    s_cbranch_scc1 M_ovr2E0
    s_cmp_eq_u32 s21, 3
    s_cbranch_scc1 M_ovr2F
    s_branch M_ovp2
M_slow:
    s_bitcmp1_b32 s46, 31
    s_cbranch_scc1 M_dense
    s_mov_b32 s56, 1
M_sl:
    s_lshl_b32 s57, s56, 6
    v_add_u32 v240, s57, v9
    ds_read_b128 v[248:251], v240 offset:9792
    s_waitcnt lgkmcnt(0)
    v_and_b32 v240, 0x3fff, v248
    v_and_b32 v241, 0x3fff, v250
    v_xad_u32 v240, v240, v3, v4
    v_xad_u32 v241, v241, v3, v4
    ds_read2st64_b32 v[244:245], v240 offset0:0 offset1:72
    ds_read2st64_b32 v[246:247], v241 offset0:0 offset1:72
    s_waitcnt lgkmcnt(0)
    s_bitcmp1_b32 s27, 0
    s_cbranch_scc0 M_sle0
    v_bfe_u32 v53, v11, 4, 4
    v_lshrrev_b32 v242, 18, v248
    v_lshrrev_b32 v243, 18, v250
    v_or_b32 v53, 0, v53
    v_cmp_eq_u32 s[44:45], v242, v53
    v_cmp_eq_u32 s[54:55], v243, v53
    s_nop 0
    v_cndmask_b32 v242, 0, v249, s[44:45]
    v_cndmask_b32 v243, 0, v251, s[54:55]
    s_nop 1
    v_smfmac_f32_16x16x32_bf16 v[124:127], v[242:243], v[244:247], v10
    v_smfmac_f32_16x16x32_bf16 v[160:163], v[242:243], v[244:247], v10 abid:2
M_sle0:
    s_bitcmp1_b32 s27, 1
    s_cbranch_scc0 M_sle1
    v_bfe_u32 v53, v11, 4, 4
    v_lshrrev_b32 v242, 18, v248
    v_lshrrev_b32 v243, 18, v250
    v_or_b32 v53, 64, v53
    v_cmp_eq_u32 s[44:45], v242, v53
    v_cmp_eq_u32 s[54:55], v243, v53
    s_nop 0
    v_cndmask_b32 v242, 0, v249, s[44:45]
    v_cndmask_b32 v243, 0, v251, s[54:55]
    s_nop 1
    v_smfmac_f32_16x16x32_bf16 v[128:131], v[242:243], v[244:247], v10
    v_smfmac_f32_16x16x32_bf16 v[164:167], v[242:243], v[244:247], v10 abid:2
M_sle1:
    s_bitcmp1_b32 s27, 2
    s_cbranch_scc0 M_sle2
    v_bfe_u32 v53, v11, 4, 4
    v_lshrrev_b32 v242, 18, v248
    v_lshrrev_b32 v243, 18, v250
    v_or_b32 v53, 128, v53
    v_cmp_eq_u32 s[44:45], v242, v53
    v_cmp_eq_u32 s[54:55], v243, v53
    s_nop 0
    v_cndmask_b32 v242, 0, v249, s[44:45]
    v_cndmask_b32 v243, 0, v251, s[54:55]
    s_nop 1
    v_smfmac_f32_16x16x32_bf16 v[132:135], v[242:243], v[244:247], v10
    v_smfmac_f32_16x16x32_bf16 v[168:171], v[242:243], v[244:247], v10 abid:2
M_sle2:
    s_bitcmp1_b32 s27, 3
    s_cbranch_scc0 M_sle3
    v_bfe_u32 v53, v11, 4, 4
    v_lshrrev_b32 v242, 18, v248
    v_lshrrev_b32 v243, 18, v250
    v_or_b32 v53, 192, v53
    v_cmp_eq_u32 s[44:45], v242, v53
    v_cmp_eq_u32 s[54:55], v243, v53
    s_nop 0
    v_cndmask_b32 v242, 0, v249, s[44:45]
    v_cndmask_b32 v243, 0, v251, s[54:55]
    s_nop 1
    v_smfmac_f32_16x16x32_bf16 v[136:139], v[242:243], v[244:247], v10
    v_smfmac_f32_16x16x32_bf16 v[172:175], v[242:243], v[244:247], v10 abid:2
M_sle3:
    s_bitcmp1_b32 s27, 4
    s_cbranch_scc0 M_sle4
    v_bfe_u32 v53, v11, 4, 4
    v_lshrrev_b32 v242, 18, v248
    v_lshrrev_b32 v243, 18, v250
    v_or_b32 v53, 256, v53
    v_cmp_eq_u32 s[44:45], v242, v53
    v_cmp_eq_u32 s[54:55], v243, v53
    s_nop 0
    v_cndmask_b32 v242, 0, v249, s[44:45]
    v_cndmask_b32 v243, 0, v251, s[54:55]
    s_nop 1
    v_smfmac_f32_16x16x32_bf16 v[140:143], v[242:243], v[244:247], v10
    v_smfmac_f32_16x16x32_bf16 v[176:179], v[242:243], v[244:247], v10 abid:2
M_sle4:
    s_bitcmp1_b32 s27, 5
    s_cbranch_scc0 M_sle5
    v_bfe_u32 v53, v11, 4, 4
    v_lshrrev_b32 v242, 18, v248
    v_lshrrev_b32 v243, 18, v250
    v_or_b32 v53, 320, v53
    v_cmp_eq_u32 s[44:45], v242, v53
    v_cmp_eq_u32 s[54:55], v243, v53
    s_nop 0
    v_cndmask_b32 v242, 0, v249, s[44:45]
    v_cndmask_b32 v243, 0, v251, s[54:55]
    s_nop 1
    v_smfmac_f32_16x16x32_bf16 v[144:147], v[242:243], v[244:247], v10
    v_smfmac_f32_16x16x32_bf16 v[180:183], v[242:243], v[244:247], v10 abid:2
M_sle5:
    s_bitcmp1_b32 s27, 6
    s_cbranch_scc0 M_sle6
    v_bfe_u32 v53, v11, 4, 4
    v_lshrrev_b32 v242, 18, v248
    v_lshrrev_b32 v243, 18, v250
    v_or_b32 v53, 384, v53
    v_cmp_eq_u32 s[44:45], v242, v53
    v_cmp_eq_u32 s[54:55], v243, v53
    s_nop 0
    v_cndmask_b32 v242, 0, v249, s[44:45]
    v_cndmask_b32 v243, 0, v251, s[54:55]
    s_nop 1
    v_smfmac_f32_16x16x32_bf16 v[148:151], v[242:243], v[244:247], v10
    v_smfmac_f32_16x16x32_bf16 v[184:187], v[242:243], v[244:247], v10 abid:2
M_sle6:
    s_bitcmp1_b32 s27, 7
    s_cbranch_scc0 M_sle7
    v_bfe_u32 v53, v11, 4, 4
    v_lshrrev_b32 v242, 18, v248
    v_lshrrev_b32 v243, 18, v250
    v_or_b32 v53, 448, v53
    v_cmp_eq_u32 s[44:45], v242, v53
    v_cmp_eq_u32 s[54:55], v243, v53
    s_nop 0
    v_cndmask_b32 v242, 0, v249, s[44:45]
    v_cndmask_b32 v243, 0, v251, s[54:55]
    s_nop 1
    v_smfmac_f32_16x16x32_bf16 v[152:155], v[242:243], v[244:247], v10
    v_smfmac_f32_16x16x32_bf16 v[188:191], v[242:243], v[244:247], v10 abid:2
M_sle7:
    s_bitcmp1_b32 s27, 8
    s_cbranch_scc0 M_sle8
    v_bfe_u32 v53, v11, 4, 4
    v_lshrrev_b32 v242, 18, v248
    v_lshrrev_b32 v243, 18, v250
    v_or_b32 v53, 512, v53
    v_cmp_eq_u32 s[44:45], v242, v53
    v_cmp_eq_u32 s[54:55], v243, v53
    s_nop 0
    v_cndmask_b32 v242, 0, v249, s[44:45]
    v_cndmask_b32 v243, 0, v251, s[54:55]
    s_nop 1
    v_smfmac_f32_16x16x32_bf16 v[156:159], v[242:243], v[244:247], v10
    v_smfmac_f32_16x16x32_bf16 v[192:195], v[242:243], v[244:247], v10 abid:2
M_sle8:
    s_add_u32 s56, s56, 1
    s_cmp_lt_u32 s56, s46
    s_cbranch_scc1 M_sl
M_slx:
    s_nop 7
    s_cmp_eq_u32 s21, 1
    s_cbranch_scc1 M_slowrL
    s_cmp_eq_u32 s21, 2
    s_cbranch_scc1 M_slowrE0
    s_cmp_eq_u32 s21, 3
    s_cbranch_scc1 M_slowrF
    s_branch M_slowr0
M_dense:
    s_mul_i32 s57, s20, 82944
    s_add_u32 s57, s57, 389120
    s_mov_b32 s56, 0
    v_mov_b32 v53, v1
    v_mov_b32 v55, v2
M_dn0:
    ds_read_b128 v[244:247], v53 offset:0
    ds_read_b128 v[248:251], v55 offset:0
    v_add_u32 v53, 1024, v53
    v_add_u32 v55, 1024, v55
    buffer_load_dwordx4 v[240:243], v11, s[16:19], s57 offen sc1
    s_add_u32 s57, s57, 1024
    s_waitcnt vmcnt(0) lgkmcnt(0)
    v_smfmac_f32_16x16x64_bf16 v[124:127], v[240:243], v[244:251], v10
    buffer_load_dwordx4 v[240:243], v11, s[16:19], s57 offen sc1
    s_add_u32 s57, s57, 1024
    s_waitcnt vmcnt(0) lgkmcnt(0)
    v_smfmac_f32_16x16x64_bf16 v[128:131], v[240:243], v[244:251], v10
    buffer_load_dwordx4 v[240:243], v11, s[16:19], s57 offen sc1
    s_add_u32 s57, s57, 1024
    s_waitcnt vmcnt(0) lgkmcnt(0)
    v_smfmac_f32_16x16x64_bf16 v[132:135], v[240:243], v[244:251], v10
    buffer_load_dwordx4 v[240:243], v11, s[16:19], s57 offen sc1
    s_add_u32 s57, s57, 1024
    s_waitcnt vmcnt(0) lgkmcnt(0)
    v_smfmac_f32_16x16x64_bf16 v[136:139], v[240:243], v[244:251], v10
    buffer_load_dwordx4 v[240:243], v11, s[16:19], s57 offen sc1
    s_add_u32 s57, s57, 1024
    s_waitcnt vmcnt(0) lgkmcnt(0)
    v_smfmac_f32_16x16x64_bf16 v[140:143], v[240:243], v[244:251], v10
    buffer_load_dwordx4 v[240:243], v11, s[16:19], s57 offen sc1
    s_add_u32 s57, s57, 1024
    s_waitcnt vmcnt(0) lgkmcnt(0)
    v_smfmac_f32_16x16x64_bf16 v[144:147], v[240:243], v[244:251], v10
    buffer_load_dwordx4 v[240:243], v11, s[16:19], s57 offen sc1
    s_add_u32 s57, s57, 1024
    s_waitcnt vmcnt(0) lgkmcnt(0)
    v_smfmac_f32_16x16x64_bf16 v[148:151], v[240:243], v[244:251], v10
    buffer_load_dwordx4 v[240:243], v11, s[16:19], s57 offen sc1
    s_add_u32 s57, s57, 1024
    s_waitcnt vmcnt(0) lgkmcnt(0)
    v_smfmac_f32_16x16x64_bf16 v[152:155], v[240:243], v[244:251], v10
    buffer_load_dwordx4 v[240:243], v11, s[16:19], s57 offen sc1
    s_add_u32 s57, s57, 1024
    s_waitcnt vmcnt(0) lgkmcnt(0)
    v_smfmac_f32_16x16x64_bf16 v[156:159], v[240:243], v[244:251], v10
    s_add_u32 s56, s56, 1
    s_cmp_lt_u32 s56, 9
    s_cbranch_scc1 M_dn0
    s_mul_i32 s57, s20, 82944
    s_add_u32 s57, s57, 389120
    s_mov_b32 s56, 0
    v_mov_b32 v53, v1
    v_mov_b32 v55, v2
M_dn1:
    ds_read_b128 v[244:247], v53 offset:18432
    ds_read_b128 v[248:251], v55 offset:18432
    v_add_u32 v53, 1024, v53
    v_add_u32 v55, 1024, v55
    buffer_load_dwordx4 v[240:243], v11, s[16:19], s57 offen sc1
    s_add_u32 s57, s57, 1024
    s_waitcnt vmcnt(0) lgkmcnt(0)
    v_smfmac_f32_16x16x64_bf16 v[160:163], v[240:243], v[244:251], v10
    buffer_load_dwordx4 v[240:243], v11, s[16:19], s57 offen sc1
    s_add_u32 s57, s57, 1024
    s_waitcnt vmcnt(0) lgkmcnt(0)
    v_smfmac_f32_16x16x64_bf16 v[164:167], v[240:243], v[244:251], v10
    buffer_load_dwordx4 v[240:243], v11, s[16:19], s57 offen sc1
    s_add_u32 s57, s57, 1024
    s_waitcnt vmcnt(0) lgkmcnt(0)
    v_smfmac_f32_16x16x64_bf16 v[168:171], v[240:243], v[244:251], v10
    buffer_load_dwordx4 v[240:243], v11, s[16:19], s57 offen sc1
    s_add_u32 s57, s57, 1024
    s_waitcnt vmcnt(0) lgkmcnt(0)
    v_smfmac_f32_16x16x64_bf16 v[172:175], v[240:243], v[244:251], v10
    buffer_load_dwordx4 v[240:243], v11, s[16:19], s57 offen sc1
    s_add_u32 s57, s57, 1024
    s_waitcnt vmcnt(0) lgkmcnt(0)
    v_smfmac_f32_16x16x64_bf16 v[176:179], v[240:243], v[244:251], v10
    buffer_load_dwordx4 v[240:243], v11, s[16:19], s57 offen sc1
    s_add_u32 s57, s57, 1024
    s_waitcnt vmcnt(0) lgkmcnt(0)
    v_smfmac_f32_16x16x64_bf16 v[180:183], v[240:243], v[244:251], v10
    buffer_load_dwordx4 v[240:243], v11, s[16:19], s57 offen sc1
    s_add_u32 s57, s57, 1024
    s_waitcnt vmcnt(0) lgkmcnt(0)
    v_smfmac_f32_16x16x64_bf16 v[184:187], v[240:243], v[244:251], v10
    buffer_load_dwordx4 v[240:243], v11, s[16:19], s57 offen sc1
    s_add_u32 s57, s57, 1024
    s_waitcnt vmcnt(0) lgkmcnt(0)
    v_smfmac_f32_16x16x64_bf16 v[188:191], v[240:243], v[244:251], v10
    buffer_load_dwordx4 v[240:243], v11, s[16:19], s57 offen sc1
    s_add_u32 s57, s57, 1024
    s_waitcnt vmcnt(0) lgkmcnt(0)
    v_smfmac_f32_16x16x64_bf16 v[192:195], v[240:243], v[244:251], v10
    s_add_u32 s56, s56, 1
    s_cmp_lt_u32 s56, 9
    s_cbranch_scc1 M_dn1
    s_branch M_slx
M_codeend:
.section .rodata,"a"
.p2align 6
.amdhsa_kernel standalone__structured_sparse_n_m__ragged_kernel
  .amdhsa_next_free_vgpr 512
  .amdhsa_next_free_sgpr 102
  .amdhsa_accum_offset 256
  .amdhsa_group_segment_fixed_size 0
  .amdhsa_kernarg_size 48
  .amdhsa_user_sgpr_count 2
  .amdhsa_user_sgpr_kernarg_segment_ptr 1
  .amdhsa_system_sgpr_workgroup_id_x 1
  .amdhsa_float_denorm_mode_32 3
.end_amdhsa_kernel
```

```asm
; @launch grid=(256,1,1) block=(256,1,1) lds=162064
.amdgcn_target "amdgcn-amd-amdhsa--gfx950"
.text
.globl standalone__structured_sparse_n_m__ragged_kernel
.p2align 8
.type standalone__structured_sparse_n_m__ragged_kernel,@function
standalone__structured_sparse_n_m__ragged_kernel:
    s_cmp_ge_u32 s2, 256
    s_cbranch_scc1 M_end
    s_load_dwordx8 s[72:79], s[0:1], 0
    s_load_dwordx4 s[80:83], s[0:1], 32
    s_getpc_b64 s[84:85]
    s_lshr_b32 s30, s2, 3
    s_and_b32 s30, s30, 15
    s_lshl_b32 s30, s30, 11
    s_and_b32 s84, s84, 0xffffff00
    s_cmp_ge_u32 s2, 88
    s_cselect_b32 s86, M_codeend-standalone__structured_sparse_n_m__ragged_kernel, 0
    s_mov_b32 s87, 0x20000
    v_lshlrev_b32 v254, 3, v0
    s_mov_b32 exec_lo, 0x00010001
    s_mov_b32 exec_hi, 0x00010001
    buffer_load_dword v254, v254, s[84:87], s30 offen
    s_mov_b64 exec, -1
    v_lshrrev_b32 v20, 6, v0
    v_and_b32 v12, 63, v0
    v_readfirstlane_b32 s20, v20
    v_lshrrev_b32 v22, 3, v0
    v_mul_u32_u24 v22, 1152, v22
    v_lshrrev_b32 v23, 4, v0
    v_xor_b32 v23, v23, v0
    v_and_b32 v23, 7, v23
    v_lshl_add_u32 v5, v23, 4, v22
    v_lshrrev_b32 v13, 4, v12
    v_and_b32 v14, 15, v12
    v_lshlrev_b32 v11, 4, v12
    v_lshlrev_b32 v54, 3, v12
    v_lshlrev_b32 v25, 4, v13
    v_lshlrev_b32 v26, 3, v13
    s_mov_b32 s6, 663552
    s_mov_b32 s7, 0x20000
    s_mov_b32 s10, 75497472
    s_mov_b32 s11, s7
    s_mov_b32 s18, 738304
    s_mov_b32 s19, s7
    s_movk_i32 s70, 256
    s_mov_b32 s71, s7
    s_movk_i32 s86, 1152
    s_mov_b32 s87, s7
    s_mov_b32 s98, 0
    s_mul_i32 s96, s20, 16
    s_and_b32 s97, s2, 15
    s_add_u32 s96, s96, s97
    s_lshl_b32 s96, s96, 8
    s_add_u32 s96, s96, 721920
    s_mul_i32 s22, s2, 36864
    s_mul_i32 s26, s20, 9216
    s_mov_b32 s24, s22
    s_mov_b32 s42, s26
    s_lshl_b32 s28, s20, 8
    s_lshl_b32 s29, s20, 5
    s_cmp_lt_u32 s2, 81
    s_cbranch_scc0 M_x1
    s_mul_i32 s32, s2, 57
    s_lshr_b32 s32, s32, 9
    s_mul_i32 s33, s32, 9
    s_sub_u32 s33, s2, s33
    s_mul_i32 s54, s32, 73728
    s_lshl_b32 s35, s33, 7
    s_add_u32 s54, s54, s35
    s_add_u32 s55, s54, 36864
    s_lshl_b32 s36, s20, 10
    s_add_u32 m0, s36, 73728
    s_lshr_b32 s30, s33, 1
    s_and_b32 s31, s33, 1
    s_lshl_b32 s37, s32, 8
    s_lshl_b32 s38, s31, 7
    s_add_u32 s37, s37, s38
    s_lshl_b32 s38, s32, 6
    s_add_u32 s38, s38, 2304
    s_cmp_lt_u32 s33, 8
    s_cselect_b32 s30, s30, s20
    s_cselect_b32 s37, s37, s38
    s_cselect_b32 s44, 0xff, 15
    s_cselect_b32 s45, s20, 3
    s_cmp_eq_u32 s45, 3
    s_cselect_b32 s99, 738304, 0
    s_mul_i32 s48, s30, 97280
    s_add_u32 s37, s37, s48
    v_mov_b32 v44, 2.0
    v_mov_b32 v45, 0
    v_mov_b32 v46, 2.0
    v_mov_b32 v47, 0
    s_waitcnt lgkmcnt(0)
    s_mov_b64 s[4:5], s[74:75]
    buffer_load_dwordx4 v5, s[4:7], s54 offen lds
    s_add_u32 m0, m0, 4096
    s_mov_b32 s45, 0
    buffer_load_dwordx4 v5, s[4:7], s55 offen lds
    s_mov_b64 s[16:17], s[82:83]
    s_mov_b64 s[8:9], s[72:73]
    s_mov_b64 s[84:85], s[76:77]
    s_mov_b64 s[68:69], s[80:81]
    v_mov_b32 v10, 0
    s_mov_b64 exec, 1
    buffer_atomic_add v10, off, s[16:19], s96 sc0 sc1
    s_mov_b64 exec, -1
    s_mov_b64 exec, s[44:45]
    s_mov_b32 s18, s99
    buffer_store_dwordx4 v[44:47], v11, s[16:19], s37 offen sc1
    s_mov_b32 s18, 738304
    s_mov_b64 exec, -1
    buffer_load_dwordx4 v[196:199], v25, s[84:87], s28 offen offset:0
    buffer_load_dwordx4 v[200:203], v25, s[84:87], s28 offen offset:64
    buffer_load_dwordx4 v[204:207], v25, s[84:87], s28 offen offset:128
    buffer_load_dwordx4 v[208:211], v25, s[84:87], s28 offen offset:192
    buffer_load_dwordx2 v[212:213], v26, s[84:87], s29 offen offset:1024
    s_mov_b32 m0, s42
    s_nop 0
    buffer_load_dwordx4 v5, s[8:11], s22 offen offset:0 nt lds
    s_add_u32 m0, m0, 896
    s_nop 0
    buffer_load_dwordx4 v5, s[8:11], s22 offen offset:128 nt lds
    s_add_u32 m0, m0, 896
    s_nop 0
    buffer_load_dwordx4 v5, s[8:11], s22 offen offset:256 nt lds
    s_add_u32 m0, m0, 896
    s_nop 0
    buffer_load_dwordx4 v5, s[8:11], s22 offen offset:384 nt lds
    s_lshl_b32 s34, s31, 2
    s_add_u32 s34, s34, s20
    s_lshr_b32 s35, s20, 1
    s_lshl_b32 s35, s35, 6
    s_and_b32 s36, s20, 1
    s_lshl_b32 s36, s36, 3
    s_add_u32 s35, s35, s36
    s_lshl_b32 s36, s20, 5
    s_mul_i32 s39, s32, 10240
    s_add_u32 s39, s39, 5120
    s_lshl_b32 s40, s34, 1
    s_add_u32 s40, s40, s39
    s_lshl_b32 s38, s32, 1
    s_cmp_eq_u32 s32, 8
    s_cselect_b32 s38, 1024, s38
    s_add_u32 s38, s38, 3072
    s_cmp_lt_u32 s33, 8
    s_cselect_b32 s34, s34, 8
    s_cselect_b32 s35, s35, s36
    s_cselect_b32 s36, 4, 3
    s_cselect_b32 s40, s40, s38
    s_cselect_b32 s46, 0, s20
    s_cselect_b32 s47, 16, 8
    s_add_u32 s40, s40, s48
    s_lshl_b32 s38, s34, 10
    s_add_u32 s39, s39, s38
    s_add_u32 s39, s39, s48
    s_add_u32 s39, s39, 1024
    v_and_b32 v15, 3, v14
    v_lshlrev_b32 v15, s36, v15
    v_add_u32 v15, s35, v15
    v_lshrrev_b32 v16, 3, v14
    v_lshlrev_b32 v16, 4, v16
    v_xor_b32 v15, v15, v16
    v_lshrrev_b32 v16, 2, v14
    v_lshl_add_u32 v16, v13, 4, v16
    v_lshl_add_u32 v15, v16, 7, v15
    v_add_u32 v24, 73728, v15
    v_xor_b32 v27, 32, v24
    v_xor_b32 v28, 64, v24
    v_xor_b32 v29, 0x60, v24
    s_lshl_b32 s31, s46, 2
    s_add_u32 s31, s31, 81920
    v_mov_b32 v60, s31
    v_mov_b32 v61, 1
    ds_write_b32 v60, v61
    s_mul_i32 s49, s30, 81
    s_mul_i32 s31, s32, 9
    s_add_u32 s49, s49, s31
    s_add_u32 s49, s49, s34
    s_lshl_b32 s49, s49, 10
    s_add_u32 s49, s49, 389120
    s_lshl_b32 s31, s34, 24
    s_lshl_b32 s38, s32, 10
    s_add_u32 s31, s31, s38
    v_lshlrev_b32 v31, 18, v14
    v_lshl_add_u32 v31, v13, 5, v31
    v_add_u32 v31, s31, v31
    s_mov_b32 s50, 3437096686
    s_mov_b32 s51, 1150609561
    s_mov_b32 s52, 0x00010001
    s_mov_b32 s53, 0x00200010
    s_mov_b32 s38, 0x0202
    s_mul_i32 s57, s30, 4096
    s_add_u32 s57, s57, 721920
    s_cmp_eq_u32 s33, 8
    s_cselect_b32 s56, 0, s20
    s_cmp_eq_u32 s20, 0
    s_cselect_b32 s98, 1, 0
    v_add_u32 v74, 81984, v54
    v_lshl_add_u32 v73, s20, 1, v74
    v_mov_b32 v41, 0x01000100
    v_mov_b32 v40, 0
    v_mov_b32 v63, -2.0
    s_waitcnt vmcnt(11) lgkmcnt(0)
    s_barrier
    ds_read_b64_tr_b16 v[16:17], v24
    ds_read_b64_tr_b16 v[18:19], v27 offset:512
    ds_read_b64_tr_b16 v[20:21], v28 offset:1024
    ds_read_b64_tr_b16 v[22:23], v29 offset:1536
    s_waitcnt lgkmcnt(3)
    v_and_b32 v44, 0x7fff7fff, v16
    v_and_b32 v45, 0x7fff7fff, v17
    v_pk_max_u16 v46, v44, v45
    v_pk_min_u16 v47, v44, v45
    v_pk_min_u16 v46, v46, v46 op_sel:[0,1] op_sel_hi:[1,0]
    v_pk_max_u16 v47, v47, v47 op_sel:[0,1] op_sel_hi:[1,0]
    v_pk_max_u16 v46, v46, s52
    v_pk_max_u16 v46, v46, v47
    v_pk_sub_i16 v44, v44, v46
    v_pk_sub_i16 v45, v45, v46
    v_pk_ashrrev_i16 v44, 15, v44 op_sel_hi:[0,1]
    v_pk_ashrrev_i16 v45, 15, v45 op_sel_hi:[0,1]
    v_alignbit_b32 v47, -1, v44, 16
    v_alignbit_b32 v46, v45, v45, 16
    v_and_b32 v48, 0x00080004, v44
    v_bitop3_b32 v46, v45, v46, v47 bitop3:0xe8
    v_and_or_b32 v64, v45, s53, v48
    v_bitop3_b32 v36, v16, v44, v46 bitop3:0x10
    v_min_u32 v68, 1, v36
    s_waitcnt lgkmcnt(2)
    v_and_b32 v44, 0x7fff7fff, v18
    v_and_b32 v45, 0x7fff7fff, v19
    v_pk_max_u16 v46, v44, v45
    v_pk_min_u16 v47, v44, v45
    v_pk_min_u16 v46, v46, v46 op_sel:[0,1] op_sel_hi:[1,0]
    v_pk_max_u16 v47, v47, v47 op_sel:[0,1] op_sel_hi:[1,0]
    v_pk_max_u16 v46, v46, s52
    v_pk_max_u16 v46, v46, v47
    v_pk_sub_i16 v44, v44, v46
    v_pk_sub_i16 v45, v45, v46
    v_pk_ashrrev_i16 v44, 15, v44 op_sel_hi:[0,1]
    v_pk_ashrrev_i16 v45, 15, v45 op_sel_hi:[0,1]
    v_alignbit_b32 v47, -1, v44, 16
    v_alignbit_b32 v46, v45, v45, 16
    v_and_b32 v48, 0x00080004, v44
    v_bitop3_b32 v46, v45, v46, v47 bitop3:0xe8
    v_and_or_b32 v65, v45, s53, v48
    v_bitop3_b32 v37, v18, v44, v46 bitop3:0x10
    v_min_u32 v69, 1, v37
    s_waitcnt lgkmcnt(1)
    v_and_b32 v44, 0x7fff7fff, v20
    v_and_b32 v45, 0x7fff7fff, v21
    v_pk_max_u16 v46, v44, v45
    v_pk_min_u16 v47, v44, v45
    v_pk_min_u16 v46, v46, v46 op_sel:[0,1] op_sel_hi:[1,0]
    v_pk_max_u16 v47, v47, v47 op_sel:[0,1] op_sel_hi:[1,0]
    v_pk_max_u16 v46, v46, s52
    v_pk_max_u16 v46, v46, v47
    v_pk_sub_i16 v44, v44, v46
    v_pk_sub_i16 v45, v45, v46
    v_pk_ashrrev_i16 v44, 15, v44 op_sel_hi:[0,1]
    v_pk_ashrrev_i16 v45, 15, v45 op_sel_hi:[0,1]
    v_alignbit_b32 v47, -1, v44, 16
    v_alignbit_b32 v46, v45, v45, 16
    v_and_b32 v48, 0x00080004, v44
    v_bitop3_b32 v46, v45, v46, v47 bitop3:0xe8
    v_and_or_b32 v66, v45, s53, v48
    v_bitop3_b32 v38, v20, v44, v46 bitop3:0x10
    v_min_u32 v70, 1, v38
    s_waitcnt lgkmcnt(0)
    v_and_b32 v44, 0x7fff7fff, v22
    v_and_b32 v45, 0x7fff7fff, v23
    v_pk_max_u16 v46, v44, v45
    v_pk_min_u16 v47, v44, v45
    v_pk_min_u16 v46, v46, v46 op_sel:[0,1] op_sel_hi:[1,0]
    v_pk_max_u16 v47, v47, v47 op_sel:[0,1] op_sel_hi:[1,0]
    v_pk_max_u16 v46, v46, s52
    v_pk_max_u16 v46, v46, v47
    v_pk_sub_i16 v44, v44, v46
    v_pk_sub_i16 v45, v45, v46
    v_pk_ashrrev_i16 v44, 15, v44 op_sel_hi:[0,1]
    v_pk_ashrrev_i16 v45, 15, v45 op_sel_hi:[0,1]
    v_alignbit_b32 v47, -1, v44, 16
    v_alignbit_b32 v46, v45, v45, 16
    v_and_b32 v48, 0x00080004, v44
    v_bitop3_b32 v46, v45, v46, v47 bitop3:0xe8
    v_and_or_b32 v67, v45, s53, v48
    v_bitop3_b32 v39, v22, v44, v46 bitop3:0x10
    v_min_u32 v71, 1, v39
    v_add_u32 v72, v68, v69
    v_add3_u32 v72, v72, v70, v71
    buffer_store_dwordx4 v[36:39], v11, s[16:19], s49 offen sc1
    v_cmp_ne_u32 vcc, 0, v72
    s_and_saveexec_b64 s[44:45], vcc
    ds_add_rtn_u32 v62, v60, v72
    s_mov_b64 exec, -1
    v_lshrrev_b32 v48, 16, v64
    v_or_b32 v48, v48, v64
    v_lshrrev_b64 v[52:53], v48, s[50:51]
    v_and_b32 v64, 15, v52
    v_lshl_or_b32 v40, v64, 0, v40
    v_lshrrev_b32 v48, 16, v65
    v_or_b32 v48, v48, v65
    v_lshrrev_b64 v[52:53], v48, s[50:51]
    v_and_b32 v65, 15, v52
    v_lshl_or_b32 v40, v65, 4, v40
    v_lshrrev_b32 v48, 16, v66
    v_or_b32 v48, v48, v66
    v_lshrrev_b64 v[52:53], v48, s[50:51]
    v_and_b32 v66, 15, v52
    v_lshl_or_b32 v40, v66, 8, v40
    v_lshrrev_b32 v48, 16, v67
    v_or_b32 v48, v48, v67
    v_lshrrev_b64 v[52:53], v48, s[50:51]
    v_and_b32 v67, 15, v52
    v_lshl_or_b32 v40, v67, 12, v40
    ds_write_b16 v73, v40
    v_mul_u32_u24 v46, 0x4001, v64
    v_and_b32 v46, 0x30003, v46
    v_mad_u32_u24 v46, v46, s38, v41
    v_perm_b32 v32, v17, v16, v46
    v_mul_u32_u24 v46, 0x4001, v65
    v_and_b32 v46, 0x30003, v46
    v_mad_u32_u24 v46, v46, s38, v41
    v_perm_b32 v33, v19, v18, v46
    s_waitcnt vmcnt(10) lgkmcnt(0)
    s_barrier
    ds_read_b64 v[50:51], v74
    v_mul_u32_u24 v46, 0x4001, v66
    v_and_b32 v46, 0x30003, v46
    v_mad_u32_u24 v46, v46, s38, v41
    v_perm_b32 v34, v21, v20, v46
    v_mul_u32_u24 v46, 0x4001, v67
    v_and_b32 v46, 0x30003, v46
    v_mad_u32_u24 v46, v46, s38, v41
    v_perm_b32 v35, v23, v22, v46
    buffer_store_dwordx4 v[32:35], v11, s[16:19], s39 offen sc1
    s_cmp_eq_u32 s33, 8
    s_cbranch_scc0 F_i1
    buffer_store_short v40, v11, s[16:19], s40 offen sc1
    s_branch F_i2
F_i1:
    s_cmp_eq_u32 s20, 0
    s_cbranch_scc0 F_i2
    s_waitcnt lgkmcnt(0)
    buffer_store_dwordx2 v[50:51], v11, s[16:19], s40 offen sc1
F_i2:
    s_cbranch_vccz F_z
    v_cmp_ne_u32 vcc, 0, v36
    s_and_saveexec_b64 s[44:45], vcc
    s_cbranch_execz F_e0
    v_cmp_gt_u32 vcc, s47, v62
    v_add_u32 v42, 0, v31
    v_lshlrev_b32 v44, 3, v62
    v_add_u32 v62, 1, v62
    v_cndmask_b32 v42, v63, v42, vcc
    v_cndmask_b32 v43, 0, v36, vcc
    v_cndmask_b32 v44, 0, v44, vcc
    buffer_store_dwordx2 v[42:43], v44, s[16:19], s37 offen sc1
F_e0:
    s_mov_b64 exec, -1
    v_cmp_ne_u32 vcc, 0, v37
    s_and_saveexec_b64 s[44:45], vcc
    s_cbranch_execz F_e1
    v_cmp_gt_u32 vcc, s47, v62
    v_add_u32 v42, 8, v31
    v_lshlrev_b32 v44, 3, v62
    v_add_u32 v62, 1, v62
    v_cndmask_b32 v42, v63, v42, vcc
    v_cndmask_b32 v43, 0, v37, vcc
    v_cndmask_b32 v44, 0, v44, vcc
    buffer_store_dwordx2 v[42:43], v44, s[16:19], s37 offen sc1
F_e1:
    s_mov_b64 exec, -1
    v_cmp_ne_u32 vcc, 0, v38
    s_and_saveexec_b64 s[44:45], vcc
    s_cbranch_execz F_e2
    v_cmp_gt_u32 vcc, s47, v62
    v_add_u32 v42, 16, v31
    v_lshlrev_b32 v44, 3, v62
    v_add_u32 v62, 1, v62
    v_cndmask_b32 v42, v63, v42, vcc
    v_cndmask_b32 v43, 0, v38, vcc
    v_cndmask_b32 v44, 0, v44, vcc
    buffer_store_dwordx2 v[42:43], v44, s[16:19], s37 offen sc1
F_e2:
    s_mov_b64 exec, -1
    v_cmp_ne_u32 vcc, 0, v39
    s_and_saveexec_b64 s[44:45], vcc
    s_cbranch_execz F_e3
    v_cmp_gt_u32 vcc, s47, v62
    v_add_u32 v42, 24, v31
    v_lshlrev_b32 v44, 3, v62
    v_add_u32 v62, 1, v62
    v_cndmask_b32 v42, v63, v42, vcc
    v_cndmask_b32 v43, 0, v39, vcc
    v_cndmask_b32 v44, 0, v44, vcc
    buffer_store_dwordx2 v[42:43], v44, s[16:19], s37 offen sc1
F_e3:
    s_mov_b64 exec, -1
F_z:
    s_cmp_lg_u32 s2, 0
    s_cbranch_scc1 M_set
    v_mov_b32 v64, 0
    v_mov_b32 v65, 0
    v_mov_b32 v66, 0
    v_mov_b32 v67, 0
    s_mov_b32 s40, 720896
    buffer_store_dwordx4 v[64:67], v11, s[16:19], s40 offen sc1
    s_branch M_set
F_sig:
    v_lshlrev_b32 v30, 8, v12
    s_waitcnt vmcnt(0)
    s_barrier
    s_cmp_lg_u32 s56, 0
    s_cbranch_scc1 F_end
    s_mov_b64 exec, 65535
    buffer_atomic_add v61, v30, s[16:19], s57 offen sc1
    s_mov_b64 exec, -1
F_end:
    s_add_u32 m0, m0, 896
    s_nop 0
    buffer_load_dwordx4 v5, s[8:11], s22 offen offset:512 nt lds
    s_add_u32 m0, m0, 896
    s_nop 0
    buffer_load_dwordx4 v5, s[8:11], s22 offen offset:640 nt lds
    s_add_u32 m0, m0, 896
    s_nop 0
    buffer_load_dwordx4 v5, s[8:11], s22 offen offset:768 nt lds
    s_branch M_x2
M_x1:
    s_waitcnt lgkmcnt(0)
    s_mov_b64 s[4:5], s[74:75]
    s_mov_b64 s[16:17], s[82:83]
    s_mov_b64 s[8:9], s[72:73]
    s_mov_b64 s[84:85], s[76:77]
    s_mov_b64 s[68:69], s[80:81]
    v_mov_b32 v10, 0
    s_mov_b64 exec, 1
    buffer_atomic_add v10, off, s[16:19], s96 sc0 sc1
    s_mov_b64 exec, -1
    buffer_load_dwordx4 v[196:199], v25, s[84:87], s28 offen offset:0
    buffer_load_dwordx4 v[200:203], v25, s[84:87], s28 offen offset:64
    buffer_load_dwordx4 v[204:207], v25, s[84:87], s28 offen offset:128
    buffer_load_dwordx4 v[208:211], v25, s[84:87], s28 offen offset:192
    buffer_load_dwordx2 v[212:213], v26, s[84:87], s29 offen offset:1024
    s_mov_b32 m0, s42
    s_nop 0
    buffer_load_dwordx4 v5, s[8:11], s22 offen offset:0 nt lds
    s_add_u32 m0, m0, 896
    s_nop 0
    buffer_load_dwordx4 v5, s[8:11], s22 offen offset:128 nt lds
    s_add_u32 m0, m0, 896
    s_nop 0
    buffer_load_dwordx4 v5, s[8:11], s22 offen offset:256 nt lds
    s_add_u32 m0, m0, 896
    s_nop 0
    buffer_load_dwordx4 v5, s[8:11], s22 offen offset:384 nt lds
    s_add_u32 m0, m0, 896
    s_nop 0
    buffer_load_dwordx4 v5, s[8:11], s22 offen offset:512 nt lds
    s_add_u32 m0, m0, 896
    s_nop 0
    buffer_load_dwordx4 v5, s[8:11], s22 offen offset:640 nt lds
    s_add_u32 m0, m0, 896
    s_nop 0
    buffer_load_dwordx4 v5, s[8:11], s22 offen offset:768 nt lds
M_set:
    s_mov_b32 s12, s78
    s_mov_b32 s13, s79
    s_mov_b32 s14, 75497472
    s_mov_b32 s15, 0x20000
    s_mul_i32 s29, s20, 12864
    s_add_u32 s29, s29, 110592
    v_lshrrev_b32 v24, 1, v14
    v_and_b32 v27, 7, v14
    v_lshlrev_b32 v22, 7, v27
    v_lshl_or_b32 v3, v24, 4, v22
    v_lshrrev_b32 v23, 3, v14
    v_mul_u32_u24 v4, 9216, v23
    v_xad_u32 v1, v25, v3, v4
    v_xor_b32 v2, 64, v1
    v_add_u32 v9, s29, v25
    v_add_u32 v8, s29, v11
    v_mul_u32_u24 v24, 1152, v27
    v_lshl_add_u32 v24, v23, 6, v24
    v_add3_u32 v6, v24, v25, s28
    v_lshrrev_b32 v24, 3, v12
    v_xor_b32 v28, v24, v12
    v_and_b32 v28, 7, v28
    v_mul_u32_u24 v24, 1152, v24
    v_lshl_add_u32 v24, v28, 4, v24
    v_add_u32 v7, 1024, v24
    s_lshl_b32 s30, s20, 1
    v_lshrrev_b32 v24, 1, v13
    v_add_u32 v24, s30, v24
    v_xor_b32 v24, v24, v27
    v_lshl_add_u32 v24, v24, 4, v22
    v_and_b32 v28, 8, v26
    v_mul_u32_u24 v29, 12864, v23
    v_add3_u32 v24, v24, v28, v29
    v_add_u32 v53, 121408, v24
    s_lshr_b32 s30, s2, 3
    s_and_b32 s30, s30, 3
    s_mul_i32 s92, s30, 256
    s_add_u32 s92, s92, 558848
    s_add_u32 s30, s30, 768
    s_mul_i32 s93, s30, 36864
    s_mov_b32 s94, 147456
    s_and_b32 s95, s20, 1
    s_mul_i32 s95, s95, 9216
    s_add_u32 s59, s24, 9216
    s_mul_i32 s43, s20, 97280
    s_add_u32 s47, s29, 9216
    s_add_u32 s48, s29, 9792
    s_add_u32 s49, s29, 10112
    s_add_u32 s54, s29, 1073751872
    s_add_u32 s38, s26, 73728
    s_add_u32 s35, s38, 1024
    s_add_u32 s39, s38, 1536
    s_mov_b32 s40, s48
    s_add_u32 s41, s48, 256
    s_mov_b32 s50, 3130536464
    s_mov_b32 s51, 4275861076
    s_mov_b32 s52, 3696531472
    s_mov_b32 s53, 4269193778
    v_mov_b32 v16, 0
    v_mov_b32 v17, 0
    v_mov_b32 v18, 0
    v_mov_b32 v19, 0
    v_cmp_gt_u32 s[44:45], 36, v12
    v_and_b32 v20, 8, v54
    s_nop 0
    v_cndmask_b32 v20, 0, v20, s[44:45]
    v_mov_b32 v21, v20
    v_mov_b32 v22, v20
    v_mov_b32 v23, v20
    v_mov_b32 v64, 1073741824
    v_mov_b32 v65, 0
    v_mov_b32 v66, 1073741824
    v_mov_b32 v67, 0
    v_lshl_add_u32 v84, v12, 2, s49
    v_add_u32 v55, s38, v54
    v_add_u32 v24, s38, v11
    ds_write_b128 v8, v[16:19] offset:0
    ds_write_b128 v8, v[16:19] offset:1024
    ds_write_b128 v8, v[16:19] offset:2048
    ds_write_b128 v8, v[16:19] offset:3072
    ds_write_b128 v8, v[16:19] offset:4096
    ds_write_b128 v8, v[16:19] offset:5120
    ds_write_b128 v8, v[16:19] offset:6144
    ds_write_b128 v8, v[16:19] offset:7168
    ds_write_b128 v8, v[16:19] offset:8192
    ds_write_b128 v24, v[64:67]
    ds_write_b128 v24, v[64:67] offset:1024
    ds_write_b128 v8, v[20:23] offset:9216
    s_cmp_lt_u32 s2, 81
    s_cbranch_scc1 F_sig
M_x2:
    s_add_u32 m0, m0, 896
    s_nop 0
    buffer_load_dwordx4 v5, s[8:11], s22 offen offset:896 nt lds
    s_add_u32 m0, m0, 896
    s_nop 0
    buffer_load_dwordx4 v5, s[8:11], s22 offen offset:1024 nt lds
    s_add_u32 s22, s22, 9437184
    s_add_u32 s42, s42, 36864
    s_mov_b32 m0, s42
    s_nop 0
    buffer_load_dwordx4 v5, s[8:11], s22 offen offset:0 nt lds
    s_add_u32 m0, m0, 896
    s_nop 0
    buffer_load_dwordx4 v5, s[8:11], s22 offen offset:128 nt lds
    s_add_u32 m0, m0, 896
    s_nop 0
    buffer_load_dwordx4 v5, s[8:11], s22 offen offset:256 nt lds
    s_add_u32 m0, m0, 896
    s_nop 0
    buffer_load_dwordx4 v5, s[8:11], s22 offen offset:384 nt lds
    s_add_u32 m0, m0, 896
    s_nop 0
    buffer_load_dwordx4 v5, s[8:11], s22 offen offset:512 nt lds
    s_add_u32 m0, m0, 896
    s_nop 0
    buffer_load_dwordx4 v5, s[8:11], s22 offen offset:640 nt lds
    s_add_u32 m0, m0, 896
    s_nop 0
    buffer_load_dwordx4 v5, s[8:11], s22 offen offset:768 nt lds
    s_add_u32 m0, m0, 896
    s_nop 0
    buffer_load_dwordx4 v5, s[8:11], s22 offen offset:896 nt lds
    s_add_u32 m0, m0, 896
    s_nop 0
    buffer_load_dwordx4 v5, s[8:11], s22 offen offset:1024 nt lds
    s_add_u32 s22, s22, 9437184
    s_add_u32 s42, s42, 36864
    s_waitcnt vmcnt(3)
    v_mov_b32 v0, 0
    s_mov_b64 exec, 1
    buffer_atomic_add v0, off, s[16:19], s96 sc0 sc1
    s_mov_b64 exec, -1
    v_readlane_b32 s100, v10, 0
    v_mov_b32 v10, 0xeeee4444
    v_lshlrev_b32 v124, 16, v196
    v_and_b32 v125, 0xffff0000, v196
    v_lshlrev_b32 v126, 16, v197
    v_and_b32 v127, 0xffff0000, v197
    v_lshlrev_b32 v128, 16, v198
    v_and_b32 v129, 0xffff0000, v198
    v_lshlrev_b32 v130, 16, v199
    v_and_b32 v131, 0xffff0000, v199
    v_lshlrev_b32 v132, 16, v200
    v_and_b32 v133, 0xffff0000, v200
    v_lshlrev_b32 v134, 16, v201
    v_and_b32 v135, 0xffff0000, v201
    v_lshlrev_b32 v136, 16, v202
    v_and_b32 v137, 0xffff0000, v202
    v_lshlrev_b32 v138, 16, v203
    v_and_b32 v139, 0xffff0000, v203
    v_lshlrev_b32 v140, 16, v204
    v_and_b32 v141, 0xffff0000, v204
    v_lshlrev_b32 v142, 16, v205
    v_and_b32 v143, 0xffff0000, v205
    v_lshlrev_b32 v144, 16, v206
    v_and_b32 v145, 0xffff0000, v206
    v_lshlrev_b32 v146, 16, v207
    v_and_b32 v147, 0xffff0000, v207
    v_lshlrev_b32 v148, 16, v208
    v_and_b32 v149, 0xffff0000, v208
    v_lshlrev_b32 v150, 16, v209
    v_and_b32 v151, 0xffff0000, v209
    v_lshlrev_b32 v152, 16, v210
    v_and_b32 v153, 0xffff0000, v210
    v_lshlrev_b32 v154, 16, v211
    v_and_b32 v155, 0xffff0000, v211
    v_lshlrev_b32 v156, 16, v212
    v_and_b32 v157, 0xffff0000, v212
    v_lshlrev_b32 v158, 16, v213
    v_and_b32 v159, 0xffff0000, v213
    s_mov_b32 exec_lo, 0x00010001
    s_mov_b32 exec_hi, 0x00010001
    ds_write_b128 v9, v[124:127] offset:10240
    ds_write_b128 v9, v[128:131] offset:10304
    ds_write_b128 v9, v[132:135] offset:10368
    ds_write_b128 v9, v[136:139] offset:10432
    ds_write_b128 v9, v[140:143] offset:10496
    ds_write_b128 v9, v[144:147] offset:10560
    ds_write_b128 v9, v[148:151] offset:10624
    ds_write_b128 v9, v[152:155] offset:10688
    ds_write_b128 v9, v[156:159] offset:10752
    s_mov_b64 exec, -1
    s_mul_i32 s30, s20, 256
    s_add_u32 s30, s30, s2
    s_sub_u32 s30, s30, 0
    s_cmp_lt_u32 s2, 0
    s_cselect_b32 s30, 1023, s30
    s_lshl_b32 s30, s30, 1
    v_lshrrev_b32 v244, 5, v12
    v_add_u32 v248, s30, v244
    v_mul_u32_u24 v245, 7282, v248
    v_lshrrev_b32 v245, 20, v245
    v_mul_u32_u24 v246, 144, v245
    v_sub_u32 v244, v248, v246
    v_mul_u32_u24 v246, 16, v245
    v_sub_u32 v247, v244, v246
    v_cmp_lt_u32 s[30:31], v244, v246
    v_subrev_u32 v246, 1, v245
    v_sub_u32 v245, 8, v245
    v_cndmask_b32 v244, v247, v244, s[30:31]
    v_cndmask_b32 v245, v245, v246, s[30:31]
    v_sub_u32 v244, 2047, v244
    v_cmp_gt_u32 vcc, 720, v248
    v_subrev_u32 v248, 720, v248
    v_mul_u32_u24 v246, 7282, v248
    v_lshrrev_b32 v246, 16, v246
    v_mul_u32_u24 v247, 9, v246
    v_sub_u32 v247, v248, v247
    v_add_u32 v246, 2048, v246
    v_cndmask_b32 v244, v246, v244, vcc
    v_cndmask_b32 v245, v247, v245, vcc
    v_mul_u32_u24 v244, 36864, v244
    v_lshl_add_u32 v244, v245, 7, v244
    v_and_b32 v245, 31, v12
    v_mul_u32_u24 v245, 1152, v245
    v_add_u32 v249, v244, v245
    s_mov_b32 vcc_lo, 0xff00ff00
    s_mov_b32 vcc_hi, 0xff00ff00
    s_waitcnt vmcnt(0)
    v_readfirstlane_b32 s30, v0
    s_mov_b32 s31, 0
    s_sub_u32 s30, s30, s100
    s_cmp_eq_u32 s30, 27
    s_cbranch_scc0 M_pf_spin
M_pf_ok:
    v_mov_b32 v0, v249
    buffer_load_dwordx4 v[56:59], v11, s[16:19], s43 offen offset:0 sc1
    buffer_load_dwordx4 v[60:63], v11, s[16:19], s43 offen offset:1024 sc1
    s_mov_b32 exec_hi, 0xfffff
    buffer_load_dwordx4 v[64:67], v11, s[16:19], s43 offen offset:2048 sc1
    s_mov_b32 exec_hi, -1
    buffer_load_dwordx4 v[48:51], v11, s[16:19], s43 offen offset:3072 sc1
    s_add_u32 s43, s43, 4096
    buffer_load_dword v52, v11, s[16:19], s43 offen offset:0 sc1
    buffer_load_dwordx4 v[12:15], v11, s[16:19], s43 offen offset:1024 sc1
    buffer_load_dwordx4 a[0:3], v11, s[16:19], s43 offen offset:2048 sc1
    buffer_load_dwordx4 a[4:7], v11, s[16:19], s43 offen offset:3072 sc1
    s_add_u32 s43, s43, 4096
    buffer_load_dwordx4 a[8:11], v11, s[16:19], s43 offen offset:0 sc1
    buffer_load_dwordx4 a[12:15], v11, s[16:19], s43 offen offset:1024 sc1
    buffer_load_dwordx4 a[16:19], v11, s[16:19], s43 offen offset:2048 sc1
    buffer_load_dwordx4 a[20:23], v11, s[16:19], s43 offen offset:3072 sc1
    s_add_u32 s43, s43, 4096
    buffer_load_dwordx4 a[24:27], v11, s[16:19], s43 offen offset:0 sc1
    buffer_load_dwordx4 a[28:31], v11, s[16:19], s43 offen offset:1024 sc1
    buffer_load_dwordx4 a[32:35], v11, s[16:19], s43 offen offset:2048 sc1
    buffer_load_dwordx4 v[16:19], v11, s[16:19], s43 offen offset:3072 sc1
    s_add_u32 s43, s43, 4096
    buffer_load_dwordx4 a[36:39], v11, s[16:19], s43 offen offset:0 sc1
    buffer_load_dwordx4 a[40:43], v11, s[16:19], s43 offen offset:1024 sc1
    buffer_load_dwordx4 a[44:47], v11, s[16:19], s43 offen offset:2048 sc1
    ds_read_b128 v[160:163], v9 offset:10240
    ds_read_b128 v[164:167], v9 offset:10304
    ds_read_b128 v[168:171], v9 offset:10368
    ds_read_b128 v[172:175], v9 offset:10432
    ds_read_b128 v[176:179], v9 offset:10496
    ds_read_b128 v[180:183], v9 offset:10560
    ds_read_b128 v[184:187], v9 offset:10624
    ds_read_b128 v[188:191], v9 offset:10688
    ds_read_b128 v[192:195], v9 offset:10752
    s_cmp_eq_u32 s98, 0
    s_cbranch_scc1 M_cnt
    s_mov_b32 s98, 0
    v_mov_b32 v250, 1
    s_mov_b64 exec, 1
    buffer_atomic_add v250, off, s[68:71], 0 offset:0 sc1
    s_mov_b64 exec, -1
    s_nop 3
M_cnt:
    s_waitcnt vmcnt(12)
    s_barrier
    ds_read_b128 v[196:199], v1 offset:0
    ds_read_b128 v[200:203], v2 offset:0
    ds_read_b128 v[228:231], v1 offset:18432
    ds_read_b128 v[232:235], v2 offset:18432
    s_waitcnt lgkmcnt(2)
    v_smfmac_f32_16x16x64_bf16 v[124:127], a[0:3], v[196:203], v12
    buffer_load_dwordx4 a[48:51], v11, s[16:19], s43 offen offset:3072 sc1
    s_waitcnt lgkmcnt(0)
    v_mov_b32 v82, s54
    v_smfmac_f32_16x16x64_bf16 v[160:163], a[0:3], v[228:235], v12
    ds_read_b128 v[204:207], v1 offset:1024
    ds_read_b128 v[208:211], v2 offset:1024
    v_or3_b32 v78, v56, v60, v64
    v_cmp_gt_i32 s[32:33], 0, v78
    v_cmp_gt_u32 s[36:37], 2.0, v56
    s_nop 1
    v_mbcnt_lo_u32_b32 v74, s36, 0
    v_mbcnt_hi_u32_b32 v74, s37, v74
    s_waitcnt vmcnt(12)
    v_lshl_add_u32 v74, v74, 3, s38
    v_smfmac_f32_16x16x64_bf16 v[128:131], a[4:7], v[196:203], v12 abid:1
    s_add_u32 s43, s43, 4096
    buffer_load_dwordx4 a[52:55], v11, s[16:19], s43 offen offset:0 sc1
    v_min_u32 v74, s39, v74
    v_smfmac_f32_16x16x64_bf16 v[164:167], a[4:7], v[228:235], v12 abid:1
    ds_read_b128 v[220:223], v1 offset:19456
    ds_read_b128 v[224:227], v2 offset:19456
    s_waitcnt vmcnt(12)
    v_cndmask_b32 v74, v82, v74, s[36:37]
    v_smfmac_f32_16x16x64_bf16 v[132:135], a[8:11], v[196:203], v13
    buffer_load_dwordx4 a[56:59], v11, s[16:19], s43 offen offset:1024 sc1
    ds_write_b64 v74, v[56:57]
    s_bcnt1_i32_b64 s30, s[36:37]
    s_lshl3_add_u32 s38, s30, s38
    v_cmp_gt_u32 s[44:45], 2.0, v58
    v_smfmac_f32_16x16x64_bf16 v[168:171], a[8:11], v[228:235], v13
    s_nop 0
    v_mbcnt_lo_u32_b32 v75, s44, 0
    v_mbcnt_hi_u32_b32 v75, s45, v75
    v_lshl_add_u32 v75, v75, 3, s38
    v_min_u32 v75, s39, v75
    s_waitcnt vmcnt(12)
    v_cndmask_b32 v75, v82, v75, s[44:45]
    v_smfmac_f32_16x16x64_bf16 v[136:139], a[12:15], v[196:203], v13 abid:1
    buffer_load_dwordx4 a[60:63], v11, s[16:19], s43 offen offset:2048 sc1
    ds_write_b64 v75, v[58:59]
    s_bcnt1_i32_b64 s30, s[44:45]
    s_lshl3_add_u32 s38, s30, s38
    v_cmp_gt_u32 s[36:37], 2.0, v60
    v_smfmac_f32_16x16x64_bf16 v[172:175], a[12:15], v[228:235], v13 abid:1
    s_nop 0
    v_mbcnt_lo_u32_b32 v74, s36, 0
    v_mbcnt_hi_u32_b32 v74, s37, v74
    s_waitcnt vmcnt(12)
    v_lshl_add_u32 v74, v74, 3, s38
    v_smfmac_f32_16x16x64_bf16 v[140:143], a[16:19], v[196:203], v14
    buffer_load_dwordx4 a[64:67], v11, s[16:19], s43 offen offset:3072 sc1
    v_min_u32 v74, s39, v74
    v_smfmac_f32_16x16x64_bf16 v[176:179], a[16:19], v[228:235], v14
    s_waitcnt vmcnt(12)
    v_cndmask_b32 v74, v82, v74, s[36:37]
    v_smfmac_f32_16x16x64_bf16 v[144:147], a[20:23], v[196:203], v14 abid:1
    s_add_u32 s43, s43, 4096
    buffer_load_dwordx4 a[68:71], v11, s[16:19], s43 offen offset:0 sc1
    ds_write_b64 v74, v[60:61]
    s_bcnt1_i32_b64 s30, s[36:37]
    s_lshl3_add_u32 s38, s30, s38
    v_cmp_gt_u32 s[44:45], 2.0, v62
    v_smfmac_f32_16x16x64_bf16 v[180:183], a[20:23], v[228:235], v14 abid:1
    s_nop 0
    v_mbcnt_lo_u32_b32 v75, s44, 0
    v_mbcnt_hi_u32_b32 v75, s45, v75
    v_lshl_add_u32 v75, v75, 3, s38
    v_min_u32 v75, s39, v75
    s_waitcnt vmcnt(12)
    v_cndmask_b32 v75, v82, v75, s[44:45]
    v_smfmac_f32_16x16x64_bf16 v[148:151], a[24:27], v[196:203], v15
    buffer_load_dwordx4 v[20:23], v11, s[16:19], s43 offen offset:1024 sc1
    buffer_load_dwordx4 a[72:75], v11, s[16:19], s43 offen offset:2048 sc1
    ds_write_b64 v75, v[62:63]
    s_bcnt1_i32_b64 s30, s[44:45]
    s_lshl3_add_u32 s38, s30, s38
    v_cmp_gt_u32 s[36:37], 2.0, v64
    v_smfmac_f32_16x16x64_bf16 v[184:187], a[24:27], v[228:235], v15
    s_nop 0
    v_mbcnt_lo_u32_b32 v74, s36, 0
    v_mbcnt_hi_u32_b32 v74, s37, v74
    s_waitcnt vmcnt(13)
    v_lshl_add_u32 v74, v74, 3, s38
    v_smfmac_f32_16x16x64_bf16 v[152:155], a[28:31], v[196:203], v15 abid:1
    buffer_load_dwordx4 a[76:79], v11, s[16:19], s43 offen offset:3072 sc1
    v_min_u32 v74, s39, v74
    v_smfmac_f32_16x16x64_bf16 v[188:191], a[28:31], v[228:235], v15 abid:1
    s_waitcnt vmcnt(13)
    v_cndmask_b32 v74, v82, v74, s[36:37]
    v_smfmac_f32_16x16x64_bf16 v[156:159], a[32:35], v[196:203], v48
    s_add_u32 s43, s43, 4096
    buffer_load_dwordx4 a[80:83], v11, s[16:19], s43 offen offset:0 sc1
    ds_write_b64 v74, v[64:65]
    s_bcnt1_i32_b64 s30, s[36:37]
    s_lshl3_add_u32 s38, s30, s38
    v_cmp_gt_u32 s[44:45], 2.0, v66
    v_smfmac_f32_16x16x64_bf16 v[192:195], a[32:35], v[228:235], v48
    s_nop 0
    v_mbcnt_lo_u32_b32 v75, s44, 0
    v_mbcnt_hi_u32_b32 v75, s45, v75
    v_lshl_add_u32 v75, v75, 3, s38
    v_min_u32 v75, s39, v75
    s_waitcnt vmcnt(12)
    s_waitcnt lgkmcnt(7)
    v_cndmask_b32 v75, v82, v75, s[44:45]
    v_smfmac_f32_16x16x64_bf16 v[124:127], a[36:39], v[204:211], v16
    buffer_load_dwordx4 a[84:87], v11, s[16:19], s43 offen offset:1024 sc1
    ds_write_b64 v75, v[66:67]
    s_bcnt1_i32_b64 s30, s[44:45]
    s_lshl3_add_u32 s38, s30, s38
    ds_read_b64 v[56:57], v55 offset:0
    ds_read_b64 v[58:59], v55 offset:512
    ds_read_b64 v[60:61], v55 offset:1024
    s_waitcnt lgkmcnt(9)
    v_smfmac_f32_16x16x64_bf16 v[160:163], a[36:39], v[220:227], v16
    ds_read_b128 v[196:199], v1 offset:2048
    ds_read_b128 v[200:203], v2 offset:2048
    s_waitcnt vmcnt(12)
    v_smfmac_f32_16x16x64_bf16 v[128:131], a[40:43], v[204:211], v16 abid:1
    buffer_load_dwordx4 a[88:91], v11, s[16:19], s43 offen offset:2048 sc1
    v_smfmac_f32_16x16x64_bf16 v[164:167], a[40:43], v[220:227], v16 abid:1
    ds_read_b128 v[228:231], v1 offset:20480
    ds_read_b128 v[232:235], v2 offset:20480
    s_waitcnt vmcnt(12)
    v_smfmac_f32_16x16x64_bf16 v[132:135], a[44:47], v[204:211], v17
    buffer_load_dwordx4 a[92:95], v11, s[16:19], s43 offen offset:3072 sc1
    s_waitcnt lgkmcnt(6)
    v_bfe_u32 v74, v56, 24, 4
    v_smfmac_f32_16x16x64_bf16 v[168:171], a[44:47], v[220:227], v17
    v_lshlrev_b32 v75, 1, v56
    v_lshl_add_u32 v74, v74, 2, s49
    s_waitcnt vmcnt(12)
    v_and_b32 v75, 16, v75
    v_smfmac_f32_16x16x64_bf16 v[136:139], a[48:51], v[204:211], v17 abid:1
    s_add_u32 s43, s43, 4096
    buffer_load_dwordx4 a[96:99], v11, s[16:19], s43 offen offset:0 sc1
    v_and_or_b32 v74, v56, 2.0, v74
    v_smfmac_f32_16x16x64_bf16 v[172:175], a[48:51], v[220:227], v17 abid:1
    s_waitcnt vmcnt(12)
    v_lshlrev_b32 v75, v75, 1
    v_smfmac_f32_16x16x64_bf16 v[140:143], a[52:55], v[204:211], v18
    buffer_load_dwordx4 a[100:103], v11, s[16:19], s43 offen offset:1024 sc1
    ds_add_rtn_u32 v68, v74, v75
    s_waitcnt lgkmcnt(6)
    v_bfe_u32 v76, v58, 24, 4
    v_smfmac_f32_16x16x64_bf16 v[176:179], a[52:55], v[220:227], v18
    v_lshlrev_b32 v77, 1, v58
    v_lshl_add_u32 v76, v76, 2, s49
    v_and_b32 v77, 16, v77
    v_and_or_b32 v76, v58, 2.0, v76
    s_waitcnt vmcnt(12)
    v_lshlrev_b32 v77, v77, 1
    v_smfmac_f32_16x16x64_bf16 v[144:147], a[56:59], v[204:211], v18 abid:1
    buffer_load_dwordx4 a[104:107], v11, s[16:19], s43 offen offset:2048 sc1
    ds_add_rtn_u32 v69, v76, v77
    s_waitcnt lgkmcnt(6)
    s_cmp_gt_u32 s38, s35
    s_cbranch_scc1 M_r3
M_r3r:
    ds_read_b32 v81, v84
    v_and_b32 v74, 8, v56
    v_smfmac_f32_16x16x64_bf16 v[180:183], a[56:59], v[220:227], v18 abid:1
    v_lshrrev_b32 v77, 14, v56
    v_cmp_ne_u32 s[44:45], 0, v74
    v_and_b32 v80, 0x3cf0, v77
    s_waitcnt lgkmcnt(2)
    v_lshrrev_b32 v75, 16, v68
    s_waitcnt vmcnt(12)
    v_and_b32 v76, 0xffff, v68
    v_smfmac_f32_16x16x64_bf16 v[148:151], a[60:63], v[204:211], v19
    buffer_load_dwordx4 v[24:27], v11, s[16:19], s43 offen offset:3072 sc1
    s_add_u32 s43, s43, 4096
    buffer_load_dwordx4 a[108:111], v11, s[16:19], s43 offen offset:0 sc1
    v_sub_u32 v74, 15, v75
    v_smfmac_f32_16x16x64_bf16 v[184:187], a[60:63], v[220:227], v19
    v_and_b32 v68, 2.0, v56
    v_add3_u32 v68, v76, v75, v68
    v_cndmask_b32 v74, v76, v74, s[44:45]
    v_cmp_gt_u32 s[44:45], 16, v68
    s_waitcnt vmcnt(13)
    v_cmp_gt_u32 s[36:37], 2.0, v68
    v_smfmac_f32_16x16x64_bf16 v[152:155], a[64:67], v[204:211], v19 abid:1
    buffer_load_dwordx4 a[112:115], v11, s[16:19], s43 offen offset:1024 sc1
    v_lshlrev_b32 v74, 2, v74
    v_smfmac_f32_16x16x64_bf16 v[188:191], a[64:67], v[220:227], v19 abid:1
    s_waitcnt vmcnt(13)
    v_lshrrev_b64 v[76:77], v74, s[50:51]
    v_smfmac_f32_16x16x64_bf16 v[156:159], a[68:71], v[204:211], v48 abid:1
    buffer_load_dwordx4 a[116:119], v11, s[16:19], s43 offen offset:2048 sc1
    s_andn2_b64 s[36:37], s[36:37], s[44:45]
    v_lshrrev_b64 v[78:79], v74, s[52:53]
    v_smfmac_f32_16x16x64_bf16 v[192:195], a[68:71], v[220:227], v48 abid:1
    v_bfe_u32 v74, v56, 24, 4
    v_mbcnt_lo_u32_b32 v75, s36, 0
    v_and_b32 v76, 15, v76
    v_mbcnt_hi_u32_b32 v75, s37, v75
    v_and_b32 v78, 15, v78
    s_waitcnt vmcnt(12)
    v_lshl_add_u32 v75, v75, 3, s40
    v_smfmac_f32_16x16x64_bf16 v[124:127], a[72:75], v[196:203], v20
    buffer_load_dwordx4 a[120:123], v11, s[16:19], s43 offen offset:3072 sc1
    v_lshl_add_u32 v76, v74, 4, v76
    v_smfmac_f32_16x16x64_bf16 v[160:163], a[72:75], v[228:235], v20
    ds_read_b128 v[204:207], v1 offset:3072
    ds_read_b128 v[208:211], v2 offset:3072
    v_min_u32 v75, s41, v75
    v_mul_u32_u24 v78, 68, v78
    s_waitcnt vmcnt(12)
    v_cndmask_b32 v75, v82, v75, s[36:37]
    v_smfmac_f32_16x16x64_bf16 v[128:131], a[76:79], v[196:203], v20 abid:1
    s_add_u32 s43, s43, 4096
    buffer_load_dwordx4 a[124:127], v11, s[16:19], s43 offen offset:0 sc1
    ds_write_b64 v75, v[56:57]
    s_bcnt1_i32_b64 s30, s[36:37]
    s_lshl3_add_u32 s40, s30, s40
    v_lshl_add_u32 v76, v76, 2, s47
    v_smfmac_f32_16x16x64_bf16 v[164:167], a[76:79], v[228:235], v20 abid:1
    ds_read_b128 v[220:223], v1 offset:21504
    ds_read_b128 v[224:227], v2 offset:21504
    v_and_b32 v78, 0x30c, v78
    v_cndmask_b32 v76, v82, v76, s[44:45]
    v_add3_u32 v77, v80, v78, s29
    v_and_b32 v78, 0x3fff, v56
    s_waitcnt vmcnt(12)
    v_cndmask_b32 v74, v82, v77, s[44:45]
    v_smfmac_f32_16x16x64_bf16 v[132:135], a[80:83], v[196:203], v21
    buffer_load_dwordx4 a[128:131], v11, s[16:19], s43 offen offset:1024 sc1
    ds_write_b32 v76, v78
    ds_write_b32 v74, v57
    v_and_b32 v74, 8, v58
    v_smfmac_f32_16x16x64_bf16 v[168:171], a[80:83], v[228:235], v21
    v_lshrrev_b32 v77, 14, v58
    v_cmp_ne_u32 s[44:45], 0, v74
    v_and_b32 v80, 0x3cf0, v77
    s_waitcnt lgkmcnt(8)
    s_waitcnt vmcnt(12)
    v_lshrrev_b32 v75, 16, v69
    v_smfmac_f32_16x16x64_bf16 v[136:139], a[84:87], v[196:203], v21 abid:1
    buffer_load_dwordx4 a[132:135], v11, s[16:19], s43 offen offset:2048 sc1
    v_and_b32 v76, 0xffff, v69
    v_smfmac_f32_16x16x64_bf16 v[172:175], a[84:87], v[228:235], v21 abid:1
    v_sub_u32 v74, 15, v75
    v_and_b32 v69, 2.0, v58
    v_add3_u32 v69, v76, v75, v69
    v_cndmask_b32 v74, v76, v74, s[44:45]
    s_waitcnt vmcnt(12)
    v_cmp_gt_u32 s[44:45], 16, v69
    v_smfmac_f32_16x16x64_bf16 v[140:143], a[88:91], v[196:203], v22
    buffer_load_dwordx4 a[136:139], v11, s[16:19], s43 offen offset:3072 sc1
    v_cmp_gt_u32 s[36:37], 2.0, v69
    v_smfmac_f32_16x16x64_bf16 v[176:179], a[88:91], v[228:235], v22
    v_lshlrev_b32 v74, 2, v74
    s_waitcnt vmcnt(12)
    v_lshrrev_b64 v[76:77], v74, s[50:51]
    v_smfmac_f32_16x16x64_bf16 v[144:147], a[92:95], v[196:203], v22 abid:1
    s_add_u32 s43, s43, 4096
    buffer_load_dwordx4 a[140:143], v11, s[16:19], s43 offen offset:0 sc1
    s_andn2_b64 s[36:37], s[36:37], s[44:45]
    v_lshrrev_b64 v[78:79], v74, s[52:53]
    v_smfmac_f32_16x16x64_bf16 v[180:183], a[92:95], v[228:235], v22 abid:1
    v_bfe_u32 v74, v58, 24, 4
    v_mbcnt_lo_u32_b32 v75, s36, 0
    v_and_b32 v76, 15, v76
    v_mbcnt_hi_u32_b32 v75, s37, v75
    v_and_b32 v78, 15, v78
    s_waitcnt vmcnt(12)
    v_lshl_add_u32 v75, v75, 3, s40
    v_smfmac_f32_16x16x64_bf16 v[148:151], a[96:99], v[196:203], v23
    buffer_load_dwordx4 v[28:31], v11, s[16:19], s43 offen offset:1024 sc1
    buffer_load_dwordx4 a[144:147], v11, s[16:19], s43 offen offset:2048 sc1
    v_lshl_add_u32 v76, v74, 4, v76
    v_smfmac_f32_16x16x64_bf16 v[184:187], a[96:99], v[228:235], v23
    v_min_u32 v75, s41, v75
    v_mul_u32_u24 v78, 68, v78
    s_waitcnt vmcnt(13)
    v_cndmask_b32 v75, v82, v75, s[36:37]
    v_smfmac_f32_16x16x64_bf16 v[152:155], a[100:103], v[196:203], v23 abid:1
    buffer_load_dwordx4 a[148:151], v11, s[16:19], s43 offen offset:3072 sc1
    ds_write_b64 v75, v[58:59]
    s_bcnt1_i32_b64 s30, s[36:37]
    s_lshl3_add_u32 s40, s30, s40
    v_lshl_add_u32 v76, v76, 2, s47
    v_smfmac_f32_16x16x64_bf16 v[188:191], a[100:103], v[228:235], v23 abid:1
    v_and_b32 v78, 0x30c, v78
    v_cndmask_b32 v76, v82, v76, s[44:45]
    v_add3_u32 v77, v80, v78, s29
    v_and_b32 v78, 0x3fff, v58
    s_waitcnt vmcnt(13)
    v_cndmask_b32 v74, v82, v77, s[44:45]
    v_smfmac_f32_16x16x64_bf16 v[156:159], a[104:107], v[196:203], v49
    s_add_u32 s43, s43, 4096
    buffer_load_dwordx4 a[152:155], v11, s[16:19], s43 offen offset:0 sc1
    ds_write_b32 v76, v78
    ds_write_b32 v74, v59
    s_waitcnt lgkmcnt(10)
    v_lshrrev_b32 v74, 16, v81
    v_smfmac_f32_16x16x64_bf16 v[192:195], a[104:107], v[228:235], v49
    v_and_b32 v81, 0xffff, v81
    v_add_u32 v81, v81, v74
    s_waitcnt vmcnt(12)
    s_waitcnt lgkmcnt(8)
    v_cmp_lt_u32 s[34:35], 16, v81
    v_smfmac_f32_16x16x64_bf16 v[124:127], a[108:111], v[204:211], v24
    buffer_load_dwordx4 a[156:159], v11, s[16:19], s43 offen offset:1024 sc1
    s_sub_u32 s46, s40, s48
    s_add_u32 s46, s46, 56
    s_lshr_b32 s46, s46, 6
    s_mov_b32 s21, 0
    s_and_b32 s27, s34, 0x1ff
    s_cmp_gt_u32 s46, 4
    s_cselect_b32 s32, 1, s32
    s_or_b32 s32, s32, s33
    s_cbranch_scc1 M_dn
M_dnr:
    ds_read_b128 v[56:59], v9 offset:9792
    s_waitcnt lgkmcnt(6)
    v_smfmac_f32_16x16x64_bf16 v[160:163], a[108:111], v[220:227], v24
    ds_read_b128 v[196:199], v1 offset:4096
    ds_read_b128 v[200:203], v2 offset:4096
    s_waitcnt vmcnt(12)
    v_smfmac_f32_16x16x64_bf16 v[128:131], a[112:115], v[204:211], v24 abid:1
    buffer_load_dwordx4 a[160:163], v11, s[16:19], s43 offen offset:2048 sc1
    s_bcnt1_i32_b32 s30, s27
    s_cmp_gt_u32 s30, 3
    s_cselect_b32 s34, 0, s27
    s_cselect_b32 s80, 0, 1
    s_getpc_b64 s[36:37]
M_pc:
    v_bfe_u32 v74, v11, 4, 4
    v_smfmac_f32_16x16x64_bf16 v[164:167], a[112:115], v[220:227], v24 abid:1
    ds_read_b128 v[228:231], v1 offset:22528
    ds_read_b128 v[232:235], v2 offset:22528
    s_ff1_i32_b32 s81, s34
    s_bitset0_b32 s34, s81
    s_mul_i32 s30, s81, 20
    s_add_u32 s31, s30, M_ovc0-M_pc
    s_add_u32 s30, s30, M_ovl0-M_pc
    s_cmp_lg_u32 s34, 0
    s_cselect_b32 s30, s31, s30
    s_cmp_lt_i32 s81, 0
    s_cselect_b32 s30, M_ovn-M_pc, s30
    s_waitcnt vmcnt(12)
    v_smfmac_f32_16x16x64_bf16 v[132:135], a[116:119], v[204:211], v25
    buffer_load_dwordx4 a[164:167], v11, s[16:19], s43 offen offset:3072 sc1
    s_add_u32 s72, s36, s30
    s_addc_u32 s73, s37, 0
    s_ff1_i32_b32 s82, s34
    s_bitset0_b32 s34, s82
    s_mul_i32 s30, s82, 20
    s_add_u32 s31, s30, M_ovc1-M_pc
    s_add_u32 s30, s30, M_ovl1-M_pc
    s_cmp_lg_u32 s34, 0
    s_cselect_b32 s30, s31, s30
    s_cmp_lt_i32 s82, 0
    s_cselect_b32 s30, M_ovn-M_pc, s30
    s_add_u32 s74, s36, s30
    s_addc_u32 s75, s37, 0
    s_ff1_i32_b32 s83, s34
    s_bitset0_b32 s34, s83
    s_mul_i32 s30, s83, 20
    v_smfmac_f32_16x16x64_bf16 v[168:171], a[116:119], v[220:227], v25
    s_waitcnt vmcnt(12)
    v_smfmac_f32_16x16x64_bf16 v[136:139], a[120:123], v[204:211], v25 abid:1
    s_add_u32 s43, s43, 4096
    buffer_load_dwordx4 a[168:171], v11, s[16:19], s43 offen offset:0 sc1
    s_add_u32 s31, s30, M_ovc1-M_pc
    s_add_u32 s30, s30, M_ovl2-M_pc
    s_cmp_lg_u32 s34, 0
    s_cselect_b32 s30, s31, s30
    s_cmp_lt_i32 s83, 0
    s_cselect_b32 s30, M_ovn-M_pc, s30
    s_add_u32 s76, s36, s30
    s_addc_u32 s77, s37, 0
    s_waitcnt lgkmcnt(4)
    v_lshrrev_b32 v76, 18, v56
    v_smfmac_f32_16x16x64_bf16 v[172:175], a[120:123], v[220:227], v25 abid:1
    v_lshrrev_b32 v77, 18, v58
    s_waitcnt vmcnt(12)
    v_and_b32 v78, 0x3fff, v56
    v_smfmac_f32_16x16x64_bf16 v[140:143], a[124:127], v[204:211], v26
    buffer_load_dwordx4 a[172:175], v11, s[16:19], s43 offen offset:1024 sc1
    v_and_b32 v79, 0x3fff, v58
    v_smfmac_f32_16x16x64_bf16 v[176:179], a[124:127], v[220:227], v26
    ds_write_b64 v9, v[78:79] offset:10056
    v_lshl_or_b32 v75, s81, 6, v74
    v_cmp_eq_u32 s[44:45], v76, v75
    v_cmp_eq_u32 s[36:37], v77, v75
    s_nop 0
    s_waitcnt vmcnt(12)
    v_cndmask_b32 v54, 0, v57, s[44:45]
    v_smfmac_f32_16x16x64_bf16 v[144:147], a[128:131], v[204:211], v26 abid:1
    buffer_load_dwordx4 a[176:179], v11, s[16:19], s43 offen offset:2048 sc1
    v_cndmask_b32 v55, 0, v59, s[36:37]
    v_smfmac_f32_16x16x64_bf16 v[180:183], a[128:131], v[220:227], v26 abid:1
    v_lshl_or_b32 v75, s82, 6, v74
    v_cmp_eq_u32 s[44:45], v76, v75
    v_cmp_eq_u32 s[36:37], v77, v75
    s_nop 0
    v_cndmask_b32 v252, 0, v57, s[44:45]
    s_waitcnt vmcnt(12)
    v_cndmask_b32 v253, 0, v59, s[36:37]
    v_smfmac_f32_16x16x64_bf16 v[148:151], a[132:135], v[204:211], v27
    buffer_load_dwordx4 v[32:35], v11, s[16:19], s43 offen offset:3072 sc1
    s_add_u32 s43, s43, 4096
    buffer_load_dwordx4 a[180:183], v11, s[16:19], s43 offen offset:0 sc1
    v_lshl_or_b32 v75, s83, 6, v74
    v_smfmac_f32_16x16x64_bf16 v[184:187], a[132:135], v[220:227], v27
    v_cmp_eq_u32 s[44:45], v76, v75
    v_cmp_eq_u32 s[36:37], v77, v75
    s_nop 0
    v_cndmask_b32 v254, 0, v57, s[44:45]
    s_waitcnt vmcnt(13)
    v_cndmask_b32 v255, 0, v59, s[36:37]
    v_smfmac_f32_16x16x64_bf16 v[152:155], a[136:139], v[204:211], v27 abid:1
    buffer_load_dwordx4 a[184:187], v11, s[16:19], s43 offen offset:1024 sc1
    ds_read_b128 v[236:239], v9 offset:9408
    ds_read_b64 v[216:217], v9 offset:10056
    v_smfmac_f32_16x16x64_bf16 v[188:191], a[136:139], v[220:227], v27 abid:1
    s_waitcnt vmcnt(13)
    v_smfmac_f32_16x16x64_bf16 v[156:159], a[140:143], v[204:211], v49 abid:1
    buffer_load_dwordx4 a[188:191], v11, s[16:19], s43 offen offset:2048 sc1
    s_waitcnt lgkmcnt(1)
    v_xad_u32 v236, v236, v3, v4
    v_smfmac_f32_16x16x64_bf16 v[192:195], a[140:143], v[220:227], v49 abid:1
    s_waitcnt vmcnt(12)
    v_xad_u32 v237, v237, v3, v4
    v_smfmac_f32_16x16x64_bf16 v[124:127], a[144:147], v[196:203], v28
    buffer_load_dwordx4 a[192:195], v11, s[16:19], s43 offen offset:3072 sc1
    ds_read2st64_b32 v[244:245], v236 offset0:0 offset1:72
    ds_read2st64_b32 v[246:247], v237 offset0:0 offset1:72
    v_xad_u32 v238, v238, v3, v4
    v_smfmac_f32_16x16x64_bf16 v[160:163], a[144:147], v[228:235], v28
    ds_read_b128 v[204:207], v1 offset:5120
    ds_read_b128 v[208:211], v2 offset:5120
    s_waitcnt vmcnt(12)
    v_xad_u32 v239, v239, v3, v4
    v_smfmac_f32_16x16x64_bf16 v[128:131], a[148:151], v[196:203], v28 abid:1
    s_add_u32 s43, s43, 4096
    buffer_load_dwordx4 a[196:199], v11, s[16:19], s43 offen offset:0 sc1
    ds_read2st64_b32 v[248:249], v238 offset0:0 offset1:72
    ds_read2st64_b32 v[250:251], v239 offset0:0 offset1:72
    ds_read_b128 v[240:243], v8 offset:3072
    ds_read_b128 v[236:239], v9 offset:9280
    s_waitcnt lgkmcnt(8)
    v_xad_u32 v212, v216, v3, v4
    v_smfmac_f32_16x16x64_bf16 v[164:167], a[148:151], v[228:235], v28 abid:1
    ds_read_b128 v[220:223], v1 offset:23552
    ds_read_b128 v[224:227], v2 offset:23552
    ds_read2st64_b32 v[212:213], v212 offset0:0 offset1:72
    s_waitcnt vmcnt(12)
    v_xad_u32 v214, v217, v3, v4
    v_smfmac_f32_16x16x64_bf16 v[132:135], a[152:155], v[196:203], v29
    buffer_load_dwordx4 a[200:203], v11, s[16:19], s43 offen offset:1024 sc1
    ds_read2st64_b32 v[214:215], v214 offset0:0 offset1:72
    v_smfmac_f32_16x16x64_bf16 v[168:171], a[152:155], v[228:235], v29
    s_waitcnt vmcnt(12)
    v_smfmac_f32_16x16x64_bf16 v[136:139], a[156:159], v[196:203], v29 abid:1
    buffer_load_dwordx4 a[204:207], v11, s[16:19], s43 offen offset:2048 sc1
    v_smfmac_f32_16x16x64_bf16 v[172:175], a[156:159], v[228:235], v29 abid:1
    s_waitcnt vmcnt(12)
    v_smfmac_f32_16x16x64_bf16 v[140:143], a[160:163], v[196:203], v30
    buffer_load_dwordx4 a[208:211], v11, s[16:19], s43 offen offset:3072 sc1
    s_waitcnt lgkmcnt(5)
    v_smfmac_f32_16x16x64_bf16 v[136:139], v[240:243], v[244:251], v10
    v_smfmac_f32_16x16x64_bf16 v[172:175], v[240:243], v[244:251], v10 abid:1
    s_waitcnt lgkmcnt(4)
    v_xad_u32 v236, v236, v3, v4
    v_smfmac_f32_16x16x64_bf16 v[176:179], a[160:163], v[228:235], v30
    s_waitcnt vmcnt(12)
    v_xad_u32 v237, v237, v3, v4
    v_smfmac_f32_16x16x64_bf16 v[144:147], a[164:167], v[196:203], v30 abid:1
    s_add_u32 s43, s43, 4096
    buffer_load_dwordx4 a[212:215], v11, s[16:19], s43 offen offset:0 sc1
    ds_read2st64_b32 v[244:245], v236 offset0:0 offset1:72
    ds_read2st64_b32 v[246:247], v237 offset0:0 offset1:72
    v_xad_u32 v238, v238, v3, v4
    v_smfmac_f32_16x16x64_bf16 v[180:183], a[164:167], v[228:235], v30 abid:1
    s_waitcnt vmcnt(12)
    v_xad_u32 v239, v239, v3, v4
    v_smfmac_f32_16x16x64_bf16 v[148:151], a[168:171], v[196:203], v31
    buffer_load_dwordx4 v[36:39], v11, s[16:19], s43 offen offset:1024 sc1
    buffer_load_dwordx4 a[216:219], v11, s[16:19], s43 offen offset:2048 sc1
    ds_read2st64_b32 v[248:249], v238 offset0:0 offset1:72
    ds_read2st64_b32 v[250:251], v239 offset0:0 offset1:72
    ds_read_b128 v[240:243], v8 offset:1024
    ds_read_b128 v[236:239], v9 offset:9344
    v_smfmac_f32_16x16x64_bf16 v[184:187], a[168:171], v[228:235], v31
    s_waitcnt vmcnt(13)
    v_smfmac_f32_16x16x64_bf16 v[152:155], a[172:175], v[196:203], v31 abid:1
    buffer_load_dwordx4 a[220:223], v11, s[16:19], s43 offen offset:3072 sc1
    s_waitcnt lgkmcnt(6)
    s_cmp_lt_i32 s81, 0
    s_cbranch_scc1 M_ovr0
    s_swappc_b64 s[78:79], s[72:73]
M_ovr0:
    v_smfmac_f32_16x16x64_bf16 v[188:191], a[172:175], v[228:235], v31 abid:1
    s_waitcnt vmcnt(13)
    v_smfmac_f32_16x16x64_bf16 v[156:159], a[176:179], v[196:203], v50
    s_add_u32 s43, s43, 4096
    buffer_load_dwordx4 a[224:227], v11, s[16:19], s43 offen offset:0 sc1
    v_smfmac_f32_16x16x64_bf16 v[192:195], a[176:179], v[228:235], v50
    s_waitcnt vmcnt(12)
    v_smfmac_f32_16x16x64_bf16 v[124:127], a[180:183], v[204:211], v32
    buffer_load_dwordx4 a[228:231], v11, s[16:19], s43 offen offset:1024 sc1
    s_waitcnt lgkmcnt(1)
    v_smfmac_f32_16x16x64_bf16 v[128:131], v[240:243], v[244:251], v10
    v_smfmac_f32_16x16x64_bf16 v[164:167], v[240:243], v[244:251], v10 abid:1
    s_waitcnt lgkmcnt(0)
    v_xad_u32 v236, v236, v3, v4
    v_smfmac_f32_16x16x64_bf16 v[160:163], a[180:183], v[220:227], v32
    ds_read_b128 v[196:199], v1 offset:6144
    ds_read_b128 v[200:203], v2 offset:6144
    s_waitcnt vmcnt(12)
    v_xad_u32 v237, v237, v3, v4
    v_smfmac_f32_16x16x64_bf16 v[128:131], a[184:187], v[204:211], v32 abid:1
    buffer_load_dwordx4 a[232:235], v11, s[16:19], s43 offen offset:2048 sc1
    ds_read2st64_b32 v[244:245], v236 offset0:0 offset1:72
    ds_read2st64_b32 v[246:247], v237 offset0:0 offset1:72
    v_xad_u32 v238, v238, v3, v4
    v_smfmac_f32_16x16x64_bf16 v[164:167], a[184:187], v[220:227], v32 abid:1
    ds_read_b128 v[228:231], v1 offset:24576
    ds_read_b128 v[232:235], v2 offset:24576
    s_waitcnt vmcnt(12)
    v_xad_u32 v239, v239, v3, v4
    v_smfmac_f32_16x16x64_bf16 v[132:135], a[188:191], v[204:211], v33
    buffer_load_dwordx4 a[236:239], v11, s[16:19], s43 offen offset:3072 sc1
    ds_read2st64_b32 v[248:249], v238 offset0:0 offset1:72
    ds_read2st64_b32 v[250:251], v239 offset0:0 offset1:72
    ds_read_b128 v[240:243], v8 offset:2048
    ds_read_b128 v[236:239], v9 offset:9216
    v_smfmac_f32_16x16x64_bf16 v[168:171], a[188:191], v[220:227], v33
    s_waitcnt vmcnt(12)
    v_smfmac_f32_16x16x64_bf16 v[136:139], a[192:195], v[204:211], v33 abid:1
    s_add_u32 s43, s43, 4096
    buffer_load_dwordx4 a[240:243], v11, s[16:19], s43 offen offset:0 sc1
    v_smfmac_f32_16x16x64_bf16 v[172:175], a[192:195], v[220:227], v33 abid:1
    s_waitcnt vmcnt(12)
    v_smfmac_f32_16x16x64_bf16 v[140:143], a[196:199], v[204:211], v34
    buffer_load_dwordx4 a[244:247], v11, s[16:19], s43 offen offset:1024 sc1
    v_smfmac_f32_16x16x64_bf16 v[176:179], a[196:199], v[220:227], v34
    s_waitcnt vmcnt(12)
    v_smfmac_f32_16x16x64_bf16 v[144:147], a[200:203], v[204:211], v34 abid:1
    buffer_load_dwordx4 a[248:251], v11, s[16:19], s43 offen offset:2048 sc1
    s_waitcnt lgkmcnt(1)
    v_smfmac_f32_16x16x64_bf16 v[132:135], v[240:243], v[244:251], v10
    v_smfmac_f32_16x16x64_bf16 v[168:171], v[240:243], v[244:251], v10 abid:1
    s_waitcnt lgkmcnt(0)
    v_xad_u32 v236, v236, v3, v4
    v_smfmac_f32_16x16x64_bf16 v[180:183], a[200:203], v[220:227], v34 abid:1
    s_waitcnt vmcnt(12)
    v_xad_u32 v237, v237, v3, v4
    v_smfmac_f32_16x16x64_bf16 v[148:151], a[204:207], v[204:211], v35
    buffer_load_dwordx4 v[40:43], v11, s[16:19], s43 offen offset:3072 sc1
    s_add_u32 s43, s43, 4096
    buffer_load_dwordx4 a[252:255], v11, s[16:19], s43 offen offset:0 sc1
    ds_read2st64_b32 v[244:245], v236 offset0:0 offset1:72
    ds_read2st64_b32 v[246:247], v237 offset0:0 offset1:72
    v_xad_u32 v238, v238, v3, v4
    v_smfmac_f32_16x16x64_bf16 v[184:187], a[204:207], v[220:227], v35
    s_waitcnt vmcnt(13)
    v_xad_u32 v239, v239, v3, v4
    v_smfmac_f32_16x16x64_bf16 v[152:155], a[208:211], v[204:211], v35 abid:1
    buffer_load_dwordx4 v[56:59], v11, s[16:19], s43 offen offset:1024 sc1
    ds_read2st64_b32 v[248:249], v238 offset0:0 offset1:72
    ds_read2st64_b32 v[250:251], v239 offset0:0 offset1:72
    ds_read_b128 v[240:243], v8 offset:0
    ds_read_b128 v[236:239], v9 offset:9728
    v_smfmac_f32_16x16x64_bf16 v[188:191], a[208:211], v[220:227], v35 abid:1
    s_waitcnt vmcnt(13)
    v_smfmac_f32_16x16x64_bf16 v[156:159], a[212:215], v[204:211], v50 abid:1
    buffer_load_dwordx4 v[60:63], v11, s[16:19], s43 offen offset:2048 sc1
    v_smfmac_f32_16x16x64_bf16 v[192:195], a[212:215], v[220:227], v50 abid:1
    s_waitcnt vmcnt(12)
    v_smfmac_f32_16x16x64_bf16 v[124:127], a[216:219], v[196:203], v36
    buffer_load_dwordx4 v[64:67], v11, s[16:19], s43 offen offset:3072 sc1
    v_smfmac_f32_16x16x64_bf16 v[160:163], a[216:219], v[228:235], v36
    ds_read_b128 v[204:207], v1 offset:7168
    ds_read_b128 v[208:211], v2 offset:7168
    s_waitcnt vmcnt(12)
    v_smfmac_f32_16x16x64_bf16 v[128:131], a[220:223], v[196:203], v36 abid:1
    s_add_u32 s43, s43, 4096
    buffer_load_dwordx4 v[68:71], v11, s[16:19], s43 offen offset:0 sc1
    s_waitcnt lgkmcnt(3)
    v_smfmac_f32_16x16x64_bf16 v[124:127], v[240:243], v[244:251], v10
    v_smfmac_f32_16x16x64_bf16 v[160:163], v[240:243], v[244:251], v10 abid:1
    s_waitcnt lgkmcnt(2)
    v_xad_u32 v236, v236, v3, v4
    v_smfmac_f32_16x16x64_bf16 v[164:167], a[220:223], v[228:235], v36 abid:1
    ds_read_b128 v[220:223], v1 offset:25600
    ds_read_b128 v[224:227], v2 offset:25600
    s_waitcnt vmcnt(12)
    v_xad_u32 v237, v237, v3, v4
    v_smfmac_f32_16x16x64_bf16 v[132:135], a[224:227], v[196:203], v37
    buffer_load_dwordx4 v[72:75], v11, s[16:19], s43 offen offset:1024 sc1
    ds_read2st64_b32 v[244:245], v236 offset0:0 offset1:72
    ds_read2st64_b32 v[246:247], v237 offset0:0 offset1:72
    v_xad_u32 v238, v238, v3, v4
    v_smfmac_f32_16x16x64_bf16 v[168:171], a[224:227], v[228:235], v37
    s_waitcnt vmcnt(12)
    v_xad_u32 v239, v239, v3, v4
    v_smfmac_f32_16x16x64_bf16 v[136:139], a[228:231], v[196:203], v37 abid:1
    buffer_load_dwordx4 v[76:79], v11, s[16:19], s43 offen offset:2048 sc1
    ds_read2st64_b32 v[248:249], v238 offset0:0 offset1:72
    ds_read2st64_b32 v[250:251], v239 offset0:0 offset1:72
    ds_read_b128 v[240:243], v8 offset:8192
    ds_read_b128 v[236:239], v9 offset:9664
    v_smfmac_f32_16x16x64_bf16 v[172:175], a[228:231], v[228:235], v37 abid:1
    s_waitcnt vmcnt(12)
    v_smfmac_f32_16x16x64_bf16 v[140:143], a[232:235], v[196:203], v38
    buffer_load_dwordx4 v[80:83], v11, s[16:19], s43 offen offset:3072 sc1
    v_smfmac_f32_16x16x64_bf16 v[176:179], a[232:235], v[228:235], v38
    s_waitcnt vmcnt(12)
    v_smfmac_f32_16x16x64_bf16 v[144:147], a[236:239], v[196:203], v38 abid:1
    s_add_u32 s43, s43, 4096
    buffer_load_dwordx4 v[84:87], v11, s[16:19], s43 offen offset:0 sc1
    v_smfmac_f32_16x16x64_bf16 v[180:183], a[236:239], v[228:235], v38 abid:1
    s_waitcnt vmcnt(12)
    v_smfmac_f32_16x16x64_bf16 v[148:151], a[240:243], v[196:203], v39
    buffer_load_dwordx4 v[44:47], v11, s[16:19], s43 offen offset:1024 sc1
    buffer_load_dwordx4 v[88:91], v11, s[16:19], s43 offen offset:2048 sc1
    s_waitcnt lgkmcnt(1)
    v_smfmac_f32_16x16x64_bf16 v[156:159], v[240:243], v[244:251], v10
    v_smfmac_f32_16x16x64_bf16 v[192:195], v[240:243], v[244:251], v10 abid:1
    s_waitcnt lgkmcnt(0)
    v_xad_u32 v236, v236, v3, v4
    v_smfmac_f32_16x16x64_bf16 v[184:187], a[240:243], v[228:235], v39
    s_waitcnt vmcnt(13)
    v_xad_u32 v237, v237, v3, v4
    v_smfmac_f32_16x16x64_bf16 v[152:155], a[244:247], v[196:203], v39 abid:1
    buffer_load_dwordx4 v[92:95], v11, s[16:19], s43 offen offset:3072 sc1
    ds_read2st64_b32 v[244:245], v236 offset0:0 offset1:72
    ds_read2st64_b32 v[246:247], v237 offset0:0 offset1:72
    v_xad_u32 v238, v238, v3, v4
    v_smfmac_f32_16x16x64_bf16 v[188:191], a[244:247], v[228:235], v39 abid:1
    s_waitcnt vmcnt(13)
    v_xad_u32 v239, v239, v3, v4
    v_smfmac_f32_16x16x64_bf16 v[156:159], a[248:251], v[196:203], v51
    s_add_u32 s43, s43, 4096
    buffer_load_dwordx4 v[96:99], v11, s[16:19], s43 offen offset:0 sc1
    ds_read2st64_b32 v[248:249], v238 offset0:0 offset1:72
    ds_read2st64_b32 v[250:251], v239 offset0:0 offset1:72
    ds_read_b128 v[240:243], v8 offset:7168
    ds_read_b128 v[236:239], v9 offset:9536
    v_smfmac_f32_16x16x64_bf16 v[192:195], a[248:251], v[228:235], v51
    s_waitcnt vmcnt(12)
    v_smfmac_f32_16x16x64_bf16 v[124:127], a[252:255], v[204:211], v40
    buffer_load_dwordx4 v[100:103], v11, s[16:19], s43 offen offset:1024 sc1
    ds_read_b128 v[196:199], v1 offset:8192
    ds_read_b128 v[200:203], v2 offset:8192
    s_waitcnt vmcnt(12)
    v_smfmac_f32_16x16x64_bf16 v[128:131], v[56:59], v[204:211], v40 abid:1
    buffer_load_dwordx4 v[104:107], v11, s[16:19], s43 offen offset:2048 sc1
    ds_read_b128 v[228:231], v1 offset:26624
    ds_read_b128 v[232:235], v2 offset:26624
    s_waitcnt vmcnt(12)
    v_smfmac_f32_16x16x64_bf16 v[132:135], v[60:63], v[204:211], v41
    buffer_load_dwordx4 v[108:111], v11, s[16:19], s43 offen offset:3072 sc1
    s_waitcnt lgkmcnt(5)
    v_smfmac_f32_16x16x64_bf16 v[152:155], v[240:243], v[244:251], v10
    v_smfmac_f32_16x16x64_bf16 v[188:191], v[240:243], v[244:251], v10 abid:1
    s_waitcnt lgkmcnt(4)
    v_xad_u32 v236, v236, v3, v4
    s_waitcnt vmcnt(12)
    v_xad_u32 v237, v237, v3, v4
    v_smfmac_f32_16x16x64_bf16 v[136:139], v[64:67], v[204:211], v41 abid:1
    s_add_u32 s43, s43, 4096
    buffer_load_dwordx4 v[112:115], v11, s[16:19], s43 offen offset:0 sc1
    ds_read2st64_b32 v[244:245], v236 offset0:0 offset1:72
    ds_read2st64_b32 v[246:247], v237 offset0:0 offset1:72
    v_xad_u32 v238, v238, v3, v4
    s_waitcnt vmcnt(12)
    v_xad_u32 v239, v239, v3, v4
    v_smfmac_f32_16x16x64_bf16 v[140:143], v[68:71], v[204:211], v42
    buffer_load_dwordx4 v[116:119], v11, s[16:19], s43 offen offset:1024 sc1
    ds_read2st64_b32 v[248:249], v238 offset0:0 offset1:72
    ds_read2st64_b32 v[250:251], v239 offset0:0 offset1:72
    ds_read_b128 v[240:243], v8 offset:5120
    ds_read_b128 v[236:239], v9 offset:9600
    s_waitcnt vmcnt(12)
    v_smfmac_f32_16x16x64_bf16 v[144:147], v[72:75], v[204:211], v42 abid:1
    buffer_load_dwordx4 v[120:123], v11, s[16:19], s43 offen offset:2048 sc1
    s_waitcnt vmcnt(12)
    v_smfmac_f32_16x16x64_bf16 v[148:151], v[76:79], v[204:211], v43
    s_add_u32 m0, s29, 11840
    s_nop 0
    buffer_load_dword v0, s[8:11], 0 offen lds
    s_mov_b32 m0, s42
    s_nop 0
    buffer_load_dwordx4 v5, s[8:11], s22 offen offset:0 nt lds
    s_waitcnt vmcnt(13)
    v_smfmac_f32_16x16x64_bf16 v[152:155], v[80:83], v[204:211], v43 abid:1
    s_add_u32 m0, m0, 896
    s_nop 0
    buffer_load_dwordx4 v5, s[8:11], s22 offen offset:128 nt lds
    s_waitcnt lgkmcnt(1)
    v_smfmac_f32_16x16x64_bf16 v[144:147], v[240:243], v[244:251], v10
    v_smfmac_f32_16x16x64_bf16 v[180:183], v[240:243], v[244:251], v10 abid:1
    s_waitcnt lgkmcnt(0)
    v_xad_u32 v236, v236, v3, v4
    s_waitcnt vmcnt(13)
    v_xad_u32 v237, v237, v3, v4
    v_smfmac_f32_16x16x64_bf16 v[156:159], v[84:87], v[204:211], v51 abid:1
    s_add_u32 m0, m0, 896
    s_nop 0
    buffer_load_dwordx4 v5, s[8:11], s22 offen offset:256 nt lds
    ds_read2st64_b32 v[244:245], v236 offset0:0 offset1:72
    ds_read2st64_b32 v[246:247], v237 offset0:0 offset1:72
    v_xad_u32 v238, v238, v3, v4
    s_waitcnt vmcnt(12)
    v_xad_u32 v239, v239, v3, v4
    v_smfmac_f32_16x16x64_bf16 v[124:127], v[88:91], v[196:203], v44
    s_add_u32 m0, m0, 896
    s_nop 0
    buffer_load_dwordx4 v5, s[8:11], s22 offen offset:384 nt lds
    ds_read2st64_b32 v[248:249], v238 offset0:0 offset1:72
    ds_read2st64_b32 v[250:251], v239 offset0:0 offset1:72
    ds_read_b128 v[240:243], v8 offset:6144
    ds_read_b128 v[236:239], v9 offset:9472
    s_waitcnt vmcnt(12)
    v_smfmac_f32_16x16x64_bf16 v[128:131], v[92:95], v[196:203], v44 abid:1
    s_waitcnt vmcnt(11)
    v_smfmac_f32_16x16x64_bf16 v[132:135], v[96:99], v[196:203], v45
    s_waitcnt vmcnt(10)
    v_smfmac_f32_16x16x64_bf16 v[136:139], v[100:103], v[196:203], v45 abid:1
    s_waitcnt lgkmcnt(1)
    v_smfmac_f32_16x16x64_bf16 v[148:151], v[240:243], v[244:251], v10
    v_smfmac_f32_16x16x64_bf16 v[184:187], v[240:243], v[244:251], v10 abid:1
    s_waitcnt lgkmcnt(0)
    v_xad_u32 v236, v236, v3, v4
    s_waitcnt vmcnt(9)
    v_xad_u32 v237, v237, v3, v4
    v_smfmac_f32_16x16x64_bf16 v[140:143], v[104:107], v[196:203], v46
    ds_read2st64_b32 v[244:245], v236 offset0:0 offset1:72
    ds_read2st64_b32 v[246:247], v237 offset0:0 offset1:72
    v_xad_u32 v238, v238, v3, v4
    s_waitcnt vmcnt(8)
    v_xad_u32 v239, v239, v3, v4
    v_smfmac_f32_16x16x64_bf16 v[144:147], v[108:111], v[196:203], v46 abid:1
    ds_read2st64_b32 v[248:249], v238 offset0:0 offset1:72
    ds_read2st64_b32 v[250:251], v239 offset0:0 offset1:72
    ds_read_b128 v[240:243], v8 offset:4096
    s_waitcnt vmcnt(7)
    v_smfmac_f32_16x16x64_bf16 v[148:151], v[112:115], v[196:203], v47
    s_waitcnt vmcnt(6)
    v_smfmac_f32_16x16x64_bf16 v[152:155], v[116:119], v[196:203], v47 abid:1
    s_waitcnt vmcnt(5)
    v_smfmac_f32_16x16x64_bf16 v[156:159], v[120:123], v[196:203], v52
    s_waitcnt lgkmcnt(0)
    v_smfmac_f32_16x16x64_bf16 v[140:143], v[240:243], v[244:251], v10
    v_smfmac_f32_16x16x64_bf16 v[176:179], v[240:243], v[244:251], v10 abid:1
    s_cmp_gt_u32 s46, s80
    s_cbranch_scc1 M_slow
M_slowr0:
    s_cmp_eq_u32 s20, 0
    s_mov_b32 s31, 1073903880
    s_cselect_b32 s30, 162048, s31
    v_mov_b32 v11, s31
    v_writelane_b32 v11, s30, 0
    v_cvt_pk_bf16_f32 v124, v124, v125
    v_cvt_pk_bf16_f32 v125, v126, v127
    v_cvt_pk_bf16_f32 v126, v128, v129
    v_cvt_pk_bf16_f32 v127, v130, v131
    v_cvt_pk_bf16_f32 v132, v132, v133
    v_cvt_pk_bf16_f32 v133, v134, v135
    v_cvt_pk_bf16_f32 v134, v136, v137
    v_cvt_pk_bf16_f32 v135, v138, v139
    ds_read_b128 v[136:139], v9 offset:10432
    v_cndmask_b32_dpp v128, v124, v132, vcc row_ror:8 row_mask:0xf bank_mask:0xf
    v_cndmask_b32_dpp v129, v125, v133, vcc row_ror:8 row_mask:0xf bank_mask:0xf
    v_cndmask_b32_dpp v130, v126, v134, vcc row_ror:8 row_mask:0xf bank_mask:0xf
    v_cndmask_b32_dpp v131, v127, v135, vcc row_ror:8 row_mask:0xf bank_mask:0xf
    buffer_store_dwordx4 v[128:131], v6, s[12:15], s59 offen offset:0 sc1
    v_mov_b32_dpp v124, v132 row_ror:8 row_mask:0xf bank_mask:0xc
    v_mov_b32_dpp v125, v133 row_ror:8 row_mask:0xf bank_mask:0xc
    v_mov_b32_dpp v126, v134 row_ror:8 row_mask:0xf bank_mask:0xc
    v_mov_b32_dpp v127, v135 row_ror:8 row_mask:0xf bank_mask:0xc
    buffer_store_dwordx4 v[124:127], v6, s[12:15], s24 offen offset:0 sc1
    ds_read_b128 v[128:131], v9 offset:10304
    ds_read_b128 v[132:135], v9 offset:10368
    ds_read_b128 v[124:127], v9 offset:10240
    v_cvt_pk_bf16_f32 v140, v140, v141
    v_cvt_pk_bf16_f32 v141, v142, v143
    v_cvt_pk_bf16_f32 v142, v144, v145
    v_cvt_pk_bf16_f32 v143, v146, v147
    v_cvt_pk_bf16_f32 v148, v148, v149
    v_cvt_pk_bf16_f32 v149, v150, v151
    v_cvt_pk_bf16_f32 v150, v152, v153
    v_cvt_pk_bf16_f32 v151, v154, v155
    ds_read_b128 v[152:155], v9 offset:10688
    v_cndmask_b32_dpp v144, v140, v148, vcc row_ror:8 row_mask:0xf bank_mask:0xf
    v_cndmask_b32_dpp v145, v141, v149, vcc row_ror:8 row_mask:0xf bank_mask:0xf
    v_cndmask_b32_dpp v146, v142, v150, vcc row_ror:8 row_mask:0xf bank_mask:0xf
    v_cndmask_b32_dpp v147, v143, v151, vcc row_ror:8 row_mask:0xf bank_mask:0xf
    buffer_store_dwordx4 v[144:147], v6, s[12:15], s59 offen offset:128 sc1
    v_mov_b32_dpp v140, v148 row_ror:8 row_mask:0xf bank_mask:0xc
    v_mov_b32_dpp v141, v149 row_ror:8 row_mask:0xf bank_mask:0xc
    v_mov_b32_dpp v142, v150 row_ror:8 row_mask:0xf bank_mask:0xc
    v_mov_b32_dpp v143, v151 row_ror:8 row_mask:0xf bank_mask:0xc
    buffer_store_dwordx4 v[140:143], v6, s[12:15], s24 offen offset:128 sc1
    ds_read_b128 v[144:147], v9 offset:10560
    ds_read_b128 v[148:151], v9 offset:10624
    ds_read_b128 v[140:143], v9 offset:10496
    v_cvt_pk_bf16_f32 v156, v156, v157
    v_cvt_pk_bf16_f32 v157, v158, v159
    ds_write_b64 v53, v[156:157] offset:25728
    ds_read_b128 v[156:159], v9 offset:10752
    s_mov_b32 s91, 0
    s_mov_b32 s25, 36864
    s_add_u32 s90, s24, 9437184
    s_mov_b32 s28, s26
    s_add_u32 s23, s24, 18432
    s_cmp_lt_u32 s20, 2
    s_cselect_b32 s66, s23, s24
    s_add_u32 s66, s66, s95
    v_add_u32 v4, 36864, v4
    v_add_u32 v1, 36864, v1
    v_add_u32 v2, 36864, v2
    s_branch M_top1
M_top:
    s_waitcnt vmcnt(8)
M_top1:
    s_add_u32 s23, s24, 18432
    s_add_u32 s58, s24, 27648
    s_mov_b32 s24, s90
    s_add_u32 s59, s90, 9216
    s_waitcnt lgkmcnt(0)
    s_barrier
    ds_read_b128 v[244:247], v8 offset:10816
    v_smfmac_f32_16x16x64_bf16 v[160:163], a[252:255], v[220:227], v40
    ds_read_b128 v[196:199], v1 offset:0
    v_smfmac_f32_16x16x64_bf16 v[160:163], v[88:91], v[228:235], v44
    ds_read_b128 v[200:203], v2 offset:0
    s_cmp_lt_u32 s22, 75497472
    s_cbranch_scc0 M_bF
    s_cmp_lt_u32 s91, 2
    s_cbranch_scc1 M_bE0
M_bL:
    v_smfmac_f32_16x16x64_bf16 v[164:167], v[56:59], v[220:227], v40 abid:1
    ds_read_b128 v[204:207], v1 offset:1024
    v_smfmac_f32_16x16x64_bf16 v[164:167], v[92:95], v[228:235], v44 abid:1
    ds_read_b128 v[208:211], v2 offset:1024
    v_mov_b32 v0, 1
    v_smfmac_f32_16x16x64_bf16 v[168:171], v[60:63], v[220:227], v41
    ds_read_b128 v[212:215], v1 offset:2048
    v_smfmac_f32_16x16x64_bf16 v[168:171], v[96:99], v[228:235], v45
    ds_read_b128 v[216:219], v2 offset:2048
    v_smfmac_f32_16x16x64_bf16 v[172:175], v[64:67], v[220:227], v41 abid:1
    s_waitcnt vmcnt(6)
    s_waitcnt lgkmcnt(6)
    buffer_store_dwordx4 v[244:247], v7, s[12:15], s66 offen sc1
    v_smfmac_f32_16x16x64_bf16 v[172:175], v[100:103], v[228:235], v45 abid:1
    ds_read_b128 v[236:239], v9 offset:9408
    v_smfmac_f32_16x16x64_bf16 v[176:179], v[68:71], v[220:227], v42
    s_waitcnt vmcnt(7)
    buffer_atomic_add v0, v11, s[16:19], s92 offen sc0 sc1
    s_mov_b32 s21, 1
    v_smfmac_f32_16x16x64_bf16 v[176:179], v[104:107], v[228:235], v46
    v_smfmac_f32_16x16x64_bf16 v[180:183], v[72:75], v[220:227], v42 abid:1
    v_cvt_pk_bf16_f32 v160, v160, v161
    v_smfmac_f32_16x16x64_bf16 v[180:183], v[108:111], v[228:235], v46 abid:1
    v_cvt_pk_bf16_f32 v161, v162, v163
    v_smfmac_f32_16x16x64_bf16 v[184:187], v[76:79], v[220:227], v43
    v_cvt_pk_bf16_f32 v162, v164, v165
    v_smfmac_f32_16x16x64_bf16 v[184:187], v[112:115], v[228:235], v47
    v_cvt_pk_bf16_f32 v163, v166, v167
    v_smfmac_f32_16x16x64_bf16 v[188:191], v[80:83], v[220:227], v43 abid:1
    s_add_u32 m0, m0, 896
    v_cvt_pk_bf16_f32 v168, v168, v169
    v_smfmac_f32_16x16x64_bf16 v[188:191], v[116:119], v[228:235], v47 abid:1
    s_waitcnt vmcnt(6)
    buffer_load_dwordx4 v5, s[8:11], s22 offen offset:512 nt lds
    v_cvt_pk_bf16_f32 v169, v170, v171
    v_smfmac_f32_16x16x64_bf16 v[192:195], v[84:87], v[220:227], v51 abid:1
    v_cvt_pk_bf16_f32 v170, v172, v173
    v_smfmac_f32_16x16x64_bf16 v[192:195], v[120:123], v[228:235], v52
    ds_read_b128 v[220:223], v1 offset:3072
    s_waitcnt lgkmcnt(6)
    v_cvt_pk_bf16_f32 v171, v174, v175
    v_smfmac_f32_16x16x64_bf16 v[124:127], a[0:3], v[196:203], v12
    ds_read_b128 v[224:227], v2 offset:3072
    ds_read_b128 v[172:175], v9 offset:10432
    s_waitcnt lgkmcnt(6)
    v_cndmask_b32_dpp v164, v160, v168, vcc row_ror:8 row_mask:0xf bank_mask:0xf
    v_smfmac_f32_16x16x64_bf16 v[124:127], a[36:39], v[204:211], v16
    ds_read_b128 v[228:231], v1 offset:4096
    s_waitcnt lgkmcnt(5)
    v_cndmask_b32_dpp v165, v161, v169, vcc row_ror:8 row_mask:0xf bank_mask:0xf
    v_smfmac_f32_16x16x64_bf16 v[124:127], a[72:75], v[212:219], v20
    ds_read_b128 v[232:235], v2 offset:4096
    v_cndmask_b32_dpp v166, v162, v170, vcc row_ror:8 row_mask:0xf bank_mask:0xf
    v_smfmac_f32_16x16x64_bf16 v[128:131], a[4:7], v[196:203], v12 abid:1
    s_barrier
    v_cndmask_b32_dpp v167, v163, v171, vcc row_ror:8 row_mask:0xf bank_mask:0xf
    v_smfmac_f32_16x16x64_bf16 v[128:131], a[40:43], v[204:211], v16 abid:1
    s_waitcnt vmcnt(7)
    buffer_store_dwordx4 v[164:167], v6, s[12:15], s58 offen offset:0 sc1
    s_waitcnt lgkmcnt(5)
    v_xad_u32 v236, v236, v3, v4
    v_smfmac_f32_16x16x64_bf16 v[128:131], a[76:79], v[212:219], v20 abid:1
    v_xad_u32 v237, v237, v3, v4
    v_smfmac_f32_16x16x64_bf16 v[132:135], a[8:11], v[196:203], v13
    ds_read2st64_b32 v[244:245], v236 offset0:0 offset1:72
    ds_read_b128 v[240:243], v8 offset:3072
    v_xad_u32 v238, v238, v3, v4
    v_smfmac_f32_16x16x64_bf16 v[132:135], a[44:47], v[204:211], v17
    ds_read2st64_b32 v[246:247], v237 offset0:0 offset1:72
    v_xad_u32 v239, v239, v3, v4
    v_smfmac_f32_16x16x64_bf16 v[132:135], a[80:83], v[212:219], v21
    ds_read2st64_b32 v[248:249], v238 offset0:0 offset1:72
    v_mov_b32_dpp v160, v168 row_ror:8 row_mask:0xf bank_mask:0xc
    v_smfmac_f32_16x16x64_bf16 v[136:139], a[12:15], v[196:203], v13 abid:1
    ds_read2st64_b32 v[250:251], v239 offset0:0 offset1:72
    ds_read_b128 v[236:239], v9 offset:9280
    v_mov_b32_dpp v161, v169 row_ror:8 row_mask:0xf bank_mask:0xc
    v_smfmac_f32_16x16x64_bf16 v[136:139], a[48:51], v[204:211], v17 abid:1
    v_mov_b32_dpp v162, v170 row_ror:8 row_mask:0xf bank_mask:0xc
    v_smfmac_f32_16x16x64_bf16 v[136:139], a[84:87], v[212:219], v21 abid:1
    v_mov_b32_dpp v163, v171 row_ror:8 row_mask:0xf bank_mask:0xc
    v_smfmac_f32_16x16x64_bf16 v[140:143], a[16:19], v[196:203], v14
    s_waitcnt vmcnt(6)
    buffer_store_dwordx4 v[160:163], v6, s[12:15], s23 offen offset:0 sc1
    ds_read_b128 v[164:167], v9 offset:10304
    v_smfmac_f32_16x16x64_bf16 v[140:143], a[52:55], v[204:211], v18
    ds_read_b128 v[168:171], v9 offset:10368
    ds_read_b128 v[160:163], v9 offset:10240
    v_smfmac_f32_16x16x64_bf16 v[140:143], a[88:91], v[212:219], v22
    v_smfmac_f32_16x16x64_bf16 v[144:147], a[20:23], v[196:203], v14 abid:1
    v_smfmac_f32_16x16x64_bf16 v[144:147], a[56:59], v[204:211], v18 abid:1
    v_smfmac_f32_16x16x64_bf16 v[144:147], a[92:95], v[212:219], v22 abid:1
    s_waitcnt lgkmcnt(3)
    v_xad_u32 v236, v236, v3, v4
    v_smfmac_f32_16x16x64_bf16 v[136:139], v[240:243], v[244:251], v10
    v_xad_u32 v237, v237, v3, v4
    v_smfmac_f32_16x16x64_bf16 v[172:175], v[240:243], v[244:251], v10 abid:1
    ds_read2st64_b32 v[244:245], v236 offset0:0 offset1:72
    ds_read_b128 v[240:243], v8 offset:1024
    v_xad_u32 v238, v238, v3, v4
    v_smfmac_f32_16x16x64_bf16 v[148:151], a[24:27], v[196:203], v15
    ds_read2st64_b32 v[246:247], v237 offset0:0 offset1:72
    v_xad_u32 v239, v239, v3, v4
    v_smfmac_f32_16x16x64_bf16 v[148:151], a[60:63], v[204:211], v19
    ds_read2st64_b32 v[248:249], v238 offset0:0 offset1:72
    v_cvt_pk_bf16_f32 v192, v192, v193
    v_smfmac_f32_16x16x64_bf16 v[148:151], a[96:99], v[212:219], v23
    ds_read2st64_b32 v[250:251], v239 offset0:0 offset1:72
    ds_read_b128 v[236:239], v9 offset:9344
    v_cvt_pk_bf16_f32 v193, v194, v195
    v_smfmac_f32_16x16x64_bf16 v[152:155], a[28:31], v[196:203], v15 abid:1
    ds_write_b64 v53, v[192:193] offset:0
    ds_read_b128 v[192:195], v9 offset:10752
    v_smfmac_f32_16x16x64_bf16 v[152:155], a[64:67], v[204:211], v19 abid:1
    s_add_u32 m0, m0, 896
    v_smfmac_f32_16x16x64_bf16 v[152:155], a[100:103], v[212:219], v23 abid:1
    s_waitcnt vmcnt(7)
    buffer_load_dwordx4 v5, s[8:11], s22 offen offset:640 nt lds
    v_smfmac_f32_16x16x64_bf16 v[156:159], a[32:35], v[196:203], v48
    v_smfmac_f32_16x16x64_bf16 v[156:159], a[68:71], v[204:211], v48 abid:1
    v_smfmac_f32_16x16x64_bf16 v[156:159], a[104:107], v[212:219], v49
    ds_read_b128 v[196:199], v1 offset:5120
    v_cvt_pk_bf16_f32 v176, v176, v177
    v_smfmac_f32_16x16x64_bf16 v[124:127], a[108:111], v[220:227], v24
    ds_read_b128 v[200:203], v2 offset:5120
    v_cvt_pk_bf16_f32 v177, v178, v179
    v_smfmac_f32_16x16x64_bf16 v[124:127], a[144:147], v[228:235], v28
    ds_read_b128 v[204:207], v1 offset:6144
    ds_read_b64 v[216:217], v9 offset:10056
    v_cvt_pk_bf16_f32 v178, v180, v181
    v_smfmac_f32_16x16x64_bf16 v[128:131], a[112:115], v[220:227], v24 abid:1
    ds_read_b128 v[208:211], v2 offset:6144
    v_cvt_pk_bf16_f32 v179, v182, v183
    v_smfmac_f32_16x16x64_bf16 v[128:131], a[148:151], v[228:235], v28 abid:1
    s_waitcnt lgkmcnt(7)
    v_xad_u32 v236, v236, v3, v4
    v_smfmac_f32_16x16x64_bf16 v[128:131], v[240:243], v[244:251], v10
    s_add_u32 m0, m0, 896
    v_xad_u32 v237, v237, v3, v4
    v_smfmac_f32_16x16x64_bf16 v[164:167], v[240:243], v[244:251], v10 abid:1
    ds_read2st64_b32 v[244:245], v236 offset0:0 offset1:72
    ds_read_b128 v[240:243], v8 offset:2048
    v_xad_u32 v238, v238, v3, v4
    v_smfmac_f32_16x16x64_bf16 v[132:135], a[116:119], v[220:227], v25
    ds_read2st64_b32 v[246:247], v237 offset0:0 offset1:72
    s_waitcnt vmcnt(6)
    v_xad_u32 v239, v239, v3, v4
    v_smfmac_f32_16x16x64_bf16 v[132:135], a[152:155], v[228:235], v29
    ds_read2st64_b32 v[248:249], v238 offset0:0 offset1:72
    buffer_load_dwordx4 v5, s[8:11], s22 offen offset:768 nt lds
    v_cvt_pk_bf16_f32 v184, v184, v185
    v_smfmac_f32_16x16x64_bf16 v[136:139], a[120:123], v[220:227], v25 abid:1
    ds_read2st64_b32 v[250:251], v239 offset0:0 offset1:72
    ds_read_b128 v[236:239], v9 offset:9216
    v_cvt_pk_bf16_f32 v185, v186, v187
    v_smfmac_f32_16x16x64_bf16 v[136:139], a[156:159], v[228:235], v29 abid:1
    v_cvt_pk_bf16_f32 v186, v188, v189
    v_smfmac_f32_16x16x64_bf16 v[140:143], a[124:127], v[220:227], v26
    v_cvt_pk_bf16_f32 v187, v190, v191
    v_smfmac_f32_16x16x64_bf16 v[140:143], a[160:163], v[228:235], v30
    ds_read_b128 v[188:191], v9 offset:10688
    v_cndmask_b32_dpp v180, v176, v184, vcc row_ror:8 row_mask:0xf bank_mask:0xf
    v_smfmac_f32_16x16x64_bf16 v[144:147], a[128:131], v[220:227], v26 abid:1
    v_cndmask_b32_dpp v181, v177, v185, vcc row_ror:8 row_mask:0xf bank_mask:0xf
    v_smfmac_f32_16x16x64_bf16 v[144:147], a[164:167], v[228:235], v30 abid:1
    v_cndmask_b32_dpp v182, v178, v186, vcc row_ror:8 row_mask:0xf bank_mask:0xf
    v_smfmac_f32_16x16x64_bf16 v[148:151], a[132:135], v[220:227], v27
    v_cndmask_b32_dpp v183, v179, v187, vcc row_ror:8 row_mask:0xf bank_mask:0xf
    v_smfmac_f32_16x16x64_bf16 v[148:151], a[168:171], v[228:235], v31
    s_waitcnt vmcnt(7)
    buffer_store_dwordx4 v[180:183], v6, s[12:15], s58 offen offset:128 sc1
    v_mov_b32_dpp v176, v184 row_ror:8 row_mask:0xf bank_mask:0xc
    v_smfmac_f32_16x16x64_bf16 v[152:155], a[136:139], v[220:227], v27 abid:1
    v_mov_b32_dpp v177, v185 row_ror:8 row_mask:0xf bank_mask:0xc
    v_smfmac_f32_16x16x64_bf16 v[152:155], a[172:175], v[228:235], v31 abid:1
    s_waitcnt lgkmcnt(1)
    v_xad_u32 v236, v236, v3, v4
    v_smfmac_f32_16x16x64_bf16 v[132:135], v[240:243], v[244:251], v10
    v_xad_u32 v237, v237, v3, v4
    v_smfmac_f32_16x16x64_bf16 v[168:171], v[240:243], v[244:251], v10 abid:1
    ds_read2st64_b32 v[244:245], v236 offset0:0 offset1:72
    ds_read_b128 v[240:243], v8 offset:0
    v_xad_u32 v238, v238, v3, v4
    v_smfmac_f32_16x16x64_bf16 v[156:159], a[140:143], v[220:227], v49 abid:1
    ds_read2st64_b32 v[246:247], v237 offset0:0 offset1:72
    v_xad_u32 v239, v239, v3, v4
    v_smfmac_f32_16x16x64_bf16 v[156:159], a[176:179], v[228:235], v50
    ds_read2st64_b32 v[248:249], v238 offset0:0 offset1:72
    ds_read_b128 v[220:223], v1 offset:7168
    v_mov_b32_dpp v178, v186 row_ror:8 row_mask:0xf bank_mask:0xc
    v_smfmac_f32_16x16x64_bf16 v[124:127], a[180:183], v[196:203], v32
    ds_read2st64_b32 v[250:251], v239 offset0:0 offset1:72
    ds_read_b128 v[236:239], v9 offset:9728
    v_mov_b32_dpp v179, v187 row_ror:8 row_mask:0xf bank_mask:0xc
    v_smfmac_f32_16x16x64_bf16 v[124:127], a[216:219], v[204:211], v36
    ds_read_b128 v[224:227], v2 offset:7168
    s_waitcnt vmcnt(6)
    buffer_store_dwordx4 v[176:179], v6, s[12:15], s23 offen offset:128 sc1
    v_smfmac_f32_16x16x64_bf16 v[128:131], a[184:187], v[196:203], v32 abid:1
    ds_read_b128 v[228:231], v1 offset:8192
    ds_read_b128 v[180:183], v9 offset:10560
    ds_read_b128 v[184:187], v9 offset:10624
    v_smfmac_f32_16x16x64_bf16 v[128:131], a[220:223], v[204:211], v36 abid:1
    ds_read_b128 v[232:235], v2 offset:8192
    ds_read_b128 v[176:179], v9 offset:10496
    v_xad_u32 v212, v216, v3, v4
    v_smfmac_f32_16x16x64_bf16 v[132:135], a[188:191], v[196:203], v33
    ds_read2st64_b32 v[212:213], v212 offset0:0 offset1:72
    v_xad_u32 v214, v217, v3, v4
    v_smfmac_f32_16x16x64_bf16 v[132:135], a[224:227], v[204:211], v37
    ds_read2st64_b32 v[214:215], v214 offset0:0 offset1:72
    v_smfmac_f32_16x16x64_bf16 v[136:139], a[192:195], v[196:203], v33 abid:1
    v_smfmac_f32_16x16x64_bf16 v[136:139], a[228:231], v[204:211], v37 abid:1
    v_smfmac_f32_16x16x64_bf16 v[140:143], a[196:199], v[196:203], v34
    v_smfmac_f32_16x16x64_bf16 v[140:143], a[232:235], v[204:211], v38
    s_waitcnt vmcnt(7)
    s_waitcnt lgkmcnt(8)
    v_xad_u32 v236, v236, v3, v4
    v_smfmac_f32_16x16x64_bf16 v[124:127], v[240:243], v[244:251], v10
    v_xad_u32 v237, v237, v3, v4
    v_smfmac_f32_16x16x64_bf16 v[160:163], v[240:243], v[244:251], v10 abid:1
    ds_read2st64_b32 v[244:245], v236 offset0:0 offset1:72
    ds_read_b128 v[240:243], v8 offset:8192
    v_xad_u32 v238, v238, v3, v4
    v_smfmac_f32_16x16x64_bf16 v[144:147], a[200:203], v[196:203], v34 abid:1
    ds_read2st64_b32 v[246:247], v237 offset0:0 offset1:72
    v_xad_u32 v239, v239, v3, v4
    v_smfmac_f32_16x16x64_bf16 v[144:147], a[236:239], v[204:211], v38 abid:1
    ds_read2st64_b32 v[248:249], v238 offset0:0 offset1:72
    v_mul_u32_u24 v0, s94, v0
    v_smfmac_f32_16x16x64_bf16 v[148:151], a[204:207], v[196:203], v35
    ds_read2st64_b32 v[250:251], v239 offset0:0 offset1:72
    ds_read_b128 v[236:239], v9 offset:9664
    v_add_u32 v0, s93, v0
    v_smfmac_f32_16x16x64_bf16 v[148:151], a[240:243], v[204:211], v39
    s_add_u32 m0, m0, 896
    v_min_u32 v0, 75497472, v0
    v_smfmac_f32_16x16x64_bf16 v[152:155], a[208:211], v[196:203], v35 abid:1
    ds_write_b32 v11, v0
    s_waitcnt vmcnt(7)
    v_mov_b32 v0, 162048
    v_smfmac_f32_16x16x64_bf16 v[152:155], a[244:247], v[204:211], v39 abid:1
    buffer_load_dwordx4 v5, s[8:11], s22 offen offset:896 nt lds
    v_smfmac_f32_16x16x64_bf16 v[156:159], a[212:215], v[196:203], v50 abid:1
    s_waitcnt lgkmcnt(7)
    s_cmp_lt_i32 s81, 0
    s_cbranch_scc1 M_ovrL
    s_swappc_b64 s[78:79], s[72:73]
M_ovrL:
    v_smfmac_f32_16x16x64_bf16 v[156:159], a[248:251], v[204:211], v51
    ds_read_b128 v[196:199], v1 offset:18432
    v_smfmac_f32_16x16x64_bf16 v[124:127], a[252:255], v[220:227], v40
    ds_read_b128 v[200:203], v2 offset:18432
    v_smfmac_f32_16x16x64_bf16 v[124:127], v[88:91], v[228:235], v44
    ds_read_b128 v[204:207], v1 offset:19456
    v_smfmac_f32_16x16x64_bf16 v[128:131], v[56:59], v[220:227], v40 abid:1
    ds_read_b128 v[208:211], v2 offset:19456
    v_smfmac_f32_16x16x64_bf16 v[128:131], v[92:95], v[228:235], v44 abid:1
    s_waitcnt lgkmcnt(4)
    s_barrier
    v_xad_u32 v236, v236, v3, v4
    v_smfmac_f32_16x16x64_bf16 v[156:159], v[240:243], v[244:251], v10
    ds_read_b32 v0, v0
    v_xad_u32 v237, v237, v3, v4
    v_smfmac_f32_16x16x64_bf16 v[192:195], v[240:243], v[244:251], v10 abid:1
    ds_read2st64_b32 v[244:245], v236 offset0:0 offset1:72
    ds_read_b128 v[240:243], v8 offset:7168
    v_xad_u32 v238, v238, v3, v4
    v_smfmac_f32_16x16x64_bf16 v[132:135], v[60:63], v[220:227], v41
    ds_read2st64_b32 v[246:247], v237 offset0:0 offset1:72
    v_xad_u32 v239, v239, v3, v4
    v_smfmac_f32_16x16x64_bf16 v[132:135], v[96:99], v[228:235], v45
    ds_read2st64_b32 v[248:249], v238 offset0:0 offset1:72
    s_add_u32 m0, m0, 896
    v_smfmac_f32_16x16x64_bf16 v[136:139], v[64:67], v[220:227], v41 abid:1
    ds_read2st64_b32 v[250:251], v239 offset0:0 offset1:72
    ds_read_b128 v[236:239], v9 offset:9536
    s_waitcnt vmcnt(6)
    v_smfmac_f32_16x16x64_bf16 v[136:139], v[100:103], v[228:235], v45 abid:1
    buffer_load_dwordx4 v5, s[8:11], s22 offen offset:1024 nt lds
    s_waitcnt lgkmcnt(6)
    v_readfirstlane_b32 s88, v0
    v_smfmac_f32_16x16x64_bf16 v[140:143], v[68:71], v[220:227], v42
    s_cmp_lt_u32 s88, 75497472
    s_cselect_b32 s10, 75497472, 0
    v_smfmac_f32_16x16x64_bf16 v[140:143], v[104:107], v[228:235], v46
    v_smfmac_f32_16x16x64_bf16 v[144:147], v[72:75], v[220:227], v42 abid:1
    ds_read_b128 v[212:215], v1 offset:20480
    v_smfmac_f32_16x16x64_bf16 v[144:147], v[108:111], v[228:235], v46 abid:1
    ds_read_b128 v[216:219], v2 offset:20480
    v_smfmac_f32_16x16x64_bf16 v[148:151], v[76:79], v[220:227], v43
    v_smfmac_f32_16x16x64_bf16 v[148:151], v[112:115], v[228:235], v47
    v_smfmac_f32_16x16x64_bf16 v[152:155], v[80:83], v[220:227], v43 abid:1
    v_smfmac_f32_16x16x64_bf16 v[152:155], v[116:119], v[228:235], v47 abid:1
    s_waitcnt lgkmcnt(2)
    v_xad_u32 v236, v236, v3, v4
    v_smfmac_f32_16x16x64_bf16 v[152:155], v[240:243], v[244:251], v10
    v_xad_u32 v237, v237, v3, v4
    v_smfmac_f32_16x16x64_bf16 v[188:191], v[240:243], v[244:251], v10 abid:1
    s_cmp_gt_u32 s46, s80
    s_cbranch_scc1 M_slow
M_slowrL:
    v_xad_u32 v238, v238, v3, v4
    v_smfmac_f32_16x16x64_bf16 v[156:159], v[84:87], v[220:227], v51 abid:1
    ds_read2st64_b32 v[244:245], v236 offset0:0 offset1:72
    ds_read_b128 v[240:243], v8 offset:5120
    v_xad_u32 v239, v239, v3, v4
    v_smfmac_f32_16x16x64_bf16 v[156:159], v[120:123], v[228:235], v52
    ds_read2st64_b32 v[246:247], v237 offset0:0 offset1:72
    ds_read_b128 v[220:223], v1 offset:21504
    v_smfmac_f32_16x16x64_bf16 v[160:163], a[0:3], v[196:203], v12
    ds_read2st64_b32 v[248:249], v238 offset0:0 offset1:72
    ds_read_b128 v[224:227], v2 offset:21504
    v_smfmac_f32_16x16x64_bf16 v[160:163], a[36:39], v[204:211], v16
    ds_read2st64_b32 v[250:251], v239 offset0:0 offset1:72
    ds_read_b128 v[236:239], v9 offset:9600
    s_waitcnt lgkmcnt(8)
    v_smfmac_f32_16x16x64_bf16 v[160:163], a[72:75], v[212:219], v20
    ds_read_b128 v[228:231], v1 offset:22528
    v_smfmac_f32_16x16x64_bf16 v[164:167], a[4:7], v[196:203], v12 abid:1
    ds_read_b128 v[232:235], v2 offset:22528
    v_cvt_pk_bf16_f32 v156, v156, v157
    v_smfmac_f32_16x16x64_bf16 v[164:167], a[40:43], v[204:211], v16 abid:1
    s_mov_b32 m0, s28
    v_cvt_pk_bf16_f32 v157, v158, v159
    v_smfmac_f32_16x16x64_bf16 v[164:167], a[76:79], v[212:219], v20 abid:1
    ds_write_b64 v53, v[156:157] offset:25728
    ds_read_b128 v[156:159], v9 offset:10752
    s_waitcnt vmcnt(7)
    v_smfmac_f32_16x16x64_bf16 v[168:171], a[8:11], v[196:203], v13
    buffer_load_dwordx4 v5, s[8:11], s88 offen offset:0 nt lds
    v_smfmac_f32_16x16x64_bf16 v[168:171], a[44:47], v[204:211], v17
    v_cvt_pk_bf16_f32 v124, v124, v125
    v_smfmac_f32_16x16x64_bf16 v[168:171], a[80:83], v[212:219], v21
    s_waitcnt lgkmcnt(4)
    v_xad_u32 v236, v236, v3, v4
    v_smfmac_f32_16x16x64_bf16 v[144:147], v[240:243], v[244:251], v10
    v_xad_u32 v237, v237, v3, v4
    v_smfmac_f32_16x16x64_bf16 v[180:183], v[240:243], v[244:251], v10 abid:1
    ds_read2st64_b32 v[244:245], v236 offset0:0 offset1:72
    ds_read_b128 v[240:243], v8 offset:6144
    v_xad_u32 v238, v238, v3, v4
    v_smfmac_f32_16x16x64_bf16 v[172:175], a[12:15], v[196:203], v13 abid:1
    ds_read2st64_b32 v[246:247], v237 offset0:0 offset1:72
    v_xad_u32 v239, v239, v3, v4
    v_smfmac_f32_16x16x64_bf16 v[172:175], a[48:51], v[204:211], v17 abid:1
    ds_read2st64_b32 v[248:249], v238 offset0:0 offset1:72
    v_cvt_pk_bf16_f32 v125, v126, v127
    v_smfmac_f32_16x16x64_bf16 v[172:175], a[84:87], v[212:219], v21 abid:1
    ds_read2st64_b32 v[250:251], v239 offset0:0 offset1:72
    ds_read_b128 v[236:239], v9 offset:9472
    v_cvt_pk_bf16_f32 v126, v128, v129
    v_smfmac_f32_16x16x64_bf16 v[176:179], a[16:19], v[196:203], v14
    v_cvt_pk_bf16_f32 v127, v130, v131
    v_smfmac_f32_16x16x64_bf16 v[176:179], a[52:55], v[204:211], v18
    v_cvt_pk_bf16_f32 v132, v132, v133
    v_smfmac_f32_16x16x64_bf16 v[176:179], a[88:91], v[212:219], v22
    v_cvt_pk_bf16_f32 v133, v134, v135
    v_smfmac_f32_16x16x64_bf16 v[180:183], a[20:23], v[196:203], v14 abid:1
    s_add_u32 m0, m0, 896
    v_cvt_pk_bf16_f32 v134, v136, v137
    v_smfmac_f32_16x16x64_bf16 v[180:183], a[56:59], v[204:211], v18 abid:1
    s_waitcnt vmcnt(6)
    buffer_load_dwordx4 v5, s[8:11], s88 offen offset:128 nt lds
    v_cvt_pk_bf16_f32 v135, v138, v139
    v_smfmac_f32_16x16x64_bf16 v[180:183], a[92:95], v[212:219], v22 abid:1
    ds_read_b128 v[136:139], v9 offset:10432
    v_cndmask_b32_dpp v128, v124, v132, vcc row_ror:8 row_mask:0xf bank_mask:0xf
    v_smfmac_f32_16x16x64_bf16 v[184:187], a[24:27], v[196:203], v15
    v_cndmask_b32_dpp v129, v125, v133, vcc row_ror:8 row_mask:0xf bank_mask:0xf
    v_smfmac_f32_16x16x64_bf16 v[184:187], a[60:63], v[204:211], v19
    v_cndmask_b32_dpp v130, v126, v134, vcc row_ror:8 row_mask:0xf bank_mask:0xf
    v_smfmac_f32_16x16x64_bf16 v[184:187], a[96:99], v[212:219], v23
    s_waitcnt lgkmcnt(1)
    v_xad_u32 v236, v236, v3, v4
    v_smfmac_f32_16x16x64_bf16 v[148:151], v[240:243], v[244:251], v10
    v_xad_u32 v237, v237, v3, v4
    v_smfmac_f32_16x16x64_bf16 v[184:187], v[240:243], v[244:251], v10 abid:1
    ds_read2st64_b32 v[244:245], v236 offset0:0 offset1:72
    ds_read_b128 v[240:243], v8 offset:4096
    v_xad_u32 v238, v238, v3, v4
    v_smfmac_f32_16x16x64_bf16 v[188:191], a[28:31], v[196:203], v15 abid:1
    ds_read2st64_b32 v[246:247], v237 offset0:0 offset1:72
    v_xad_u32 v239, v239, v3, v4
    v_smfmac_f32_16x16x64_bf16 v[188:191], a[64:67], v[204:211], v19 abid:1
    ds_read2st64_b32 v[248:249], v238 offset0:0 offset1:72
    v_cndmask_b32_dpp v131, v127, v135, vcc row_ror:8 row_mask:0xf bank_mask:0xf
    v_smfmac_f32_16x16x64_bf16 v[188:191], a[100:103], v[212:219], v23 abid:1
    ds_read2st64_b32 v[250:251], v239 offset0:0 offset1:72
    s_waitcnt vmcnt(7)
    buffer_store_dwordx4 v[128:131], v6, s[12:15], s59 offen offset:0 sc1
    v_smfmac_f32_16x16x64_bf16 v[192:195], a[32:35], v[196:203], v48
    v_mov_b32_dpp v124, v132 row_ror:8 row_mask:0xf bank_mask:0xc
    v_smfmac_f32_16x16x64_bf16 v[192:195], a[68:71], v[204:211], v48 abid:1
    v_mov_b32_dpp v125, v133 row_ror:8 row_mask:0xf bank_mask:0xc
    v_smfmac_f32_16x16x64_bf16 v[192:195], a[104:107], v[212:219], v49
    ds_read_b128 v[196:199], v1 offset:23552
    v_mov_b32_dpp v126, v134 row_ror:8 row_mask:0xf bank_mask:0xc
    v_smfmac_f32_16x16x64_bf16 v[160:163], a[108:111], v[220:227], v24
    ds_read_b128 v[200:203], v2 offset:23552
    v_mov_b32_dpp v127, v135 row_ror:8 row_mask:0xf bank_mask:0xc
    v_smfmac_f32_16x16x64_bf16 v[160:163], a[144:147], v[228:235], v28
    ds_read_b128 v[204:207], v1 offset:24576
    s_waitcnt vmcnt(6)
    buffer_store_dwordx4 v[124:127], v6, s[12:15], s24 offen offset:0 sc1
    v_smfmac_f32_16x16x64_bf16 v[164:167], a[112:115], v[220:227], v24 abid:1
    ds_read_b128 v[208:211], v2 offset:24576
    ds_read_b128 v[128:131], v9 offset:10304
    ds_read_b128 v[132:135], v9 offset:10368
    v_smfmac_f32_16x16x64_bf16 v[164:167], a[148:151], v[228:235], v28 abid:1
    ds_read_b128 v[124:127], v9 offset:10240
    v_smfmac_f32_16x16x64_bf16 v[168:171], a[116:119], v[220:227], v25
    v_smfmac_f32_16x16x64_bf16 v[168:171], a[152:155], v[228:235], v29
    s_waitcnt lgkmcnt(7)
    v_smfmac_f32_16x16x64_bf16 v[140:143], v[240:243], v[244:251], v10
    v_smfmac_f32_16x16x64_bf16 v[176:179], v[240:243], v[244:251], v10 abid:1
    v_smfmac_f32_16x16x64_bf16 v[172:175], a[120:123], v[220:227], v25 abid:1
    s_add_u32 s28, s28, 36864
    s_cmp_ge_u32 s28, 110592
    s_cselect_b32 s28, s26, s28
    v_smfmac_f32_16x16x64_bf16 v[172:175], a[156:159], v[228:235], v29 abid:1
    s_add_u32 s30, s25, 36864
    s_cmp_eq_u32 s30, 110592
    s_cselect_b32 s30, 0, s30
    v_smfmac_f32_16x16x64_bf16 v[176:179], a[124:127], v[220:227], v26
    s_sub_u32 s31, s30, s25
    s_mov_b32 s25, s30
    s_mov_b32 s90, s22
    v_smfmac_f32_16x16x64_bf16 v[176:179], a[160:163], v[228:235], v30
    s_mov_b32 s22, s88
    s_add_u32 s91, s91, 1
    s_cmp_lt_u32 s20, 2
    v_smfmac_f32_16x16x64_bf16 v[180:183], a[128:131], v[220:227], v26 abid:1
    s_cselect_b32 s66, s23, s24
    s_add_u32 s66, s66, s95
    v_smfmac_f32_16x16x64_bf16 v[180:183], a[164:167], v[228:235], v30 abid:1
    v_cvt_pk_bf16_f32 v140, v140, v141
    v_smfmac_f32_16x16x64_bf16 v[184:187], a[132:135], v[220:227], v27
    s_add_u32 m0, m0, 896
    v_cvt_pk_bf16_f32 v141, v142, v143
    v_smfmac_f32_16x16x64_bf16 v[184:187], a[168:171], v[228:235], v31
    s_waitcnt vmcnt(7)
    buffer_load_dwordx4 v5, s[8:11], s88 offen offset:256 nt lds
    v_cvt_pk_bf16_f32 v142, v144, v145
    v_smfmac_f32_16x16x64_bf16 v[188:191], a[136:139], v[220:227], v27 abid:1
    v_cvt_pk_bf16_f32 v143, v146, v147
    v_smfmac_f32_16x16x64_bf16 v[188:191], a[172:175], v[228:235], v31 abid:1
    v_cvt_pk_bf16_f32 v148, v148, v149
    v_smfmac_f32_16x16x64_bf16 v[192:195], a[140:143], v[220:227], v49 abid:1
    v_cvt_pk_bf16_f32 v149, v150, v151
    v_smfmac_f32_16x16x64_bf16 v[192:195], a[176:179], v[228:235], v50
    ds_read_b128 v[220:223], v1 offset:25600
    s_waitcnt lgkmcnt(6)
    v_cvt_pk_bf16_f32 v150, v152, v153
    v_smfmac_f32_16x16x64_bf16 v[160:163], a[180:183], v[196:203], v32
    ds_read_b128 v[224:227], v2 offset:25600
    s_waitcnt lgkmcnt(5)
    v_cvt_pk_bf16_f32 v151, v154, v155
    v_smfmac_f32_16x16x64_bf16 v[160:163], a[216:219], v[204:211], v36
    ds_read_b128 v[228:231], v1 offset:26624
    ds_read_b128 v[152:155], v9 offset:10688
    v_cndmask_b32_dpp v144, v140, v148, vcc row_ror:8 row_mask:0xf bank_mask:0xf
    v_smfmac_f32_16x16x64_bf16 v[164:167], a[184:187], v[196:203], v32 abid:1
    ds_read_b128 v[232:235], v2 offset:26624
    v_cndmask_b32_dpp v145, v141, v149, vcc row_ror:8 row_mask:0xf bank_mask:0xf
    v_smfmac_f32_16x16x64_bf16 v[164:167], a[220:223], v[204:211], v36 abid:1
    s_add_u32 m0, m0, 896
    v_cndmask_b32_dpp v146, v142, v150, vcc row_ror:8 row_mask:0xf bank_mask:0xf
    v_smfmac_f32_16x16x64_bf16 v[168:171], a[188:191], v[196:203], v33
    s_waitcnt vmcnt(6)
    buffer_load_dwordx4 v5, s[8:11], s88 offen offset:384 nt lds
    v_cndmask_b32_dpp v147, v143, v151, vcc row_ror:8 row_mask:0xf bank_mask:0xf
    v_smfmac_f32_16x16x64_bf16 v[168:171], a[224:227], v[204:211], v37
    s_waitcnt vmcnt(7)
    buffer_store_dwordx4 v[144:147], v6, s[12:15], s59 offen offset:128 sc1
    v_mov_b32_dpp v140, v148 row_ror:8 row_mask:0xf bank_mask:0xc
    v_smfmac_f32_16x16x64_bf16 v[172:175], a[192:195], v[196:203], v33 abid:1
    v_mov_b32_dpp v141, v149 row_ror:8 row_mask:0xf bank_mask:0xc
    v_smfmac_f32_16x16x64_bf16 v[172:175], a[228:231], v[204:211], v37 abid:1
    v_mov_b32_dpp v142, v150 row_ror:8 row_mask:0xf bank_mask:0xc
    v_smfmac_f32_16x16x64_bf16 v[176:179], a[196:199], v[196:203], v34
    v_mov_b32_dpp v143, v151 row_ror:8 row_mask:0xf bank_mask:0xc
    v_smfmac_f32_16x16x64_bf16 v[176:179], a[232:235], v[204:211], v38
    s_waitcnt vmcnt(6)
    buffer_store_dwordx4 v[140:143], v6, s[12:15], s24 offen offset:128 sc1
    ds_read_b128 v[144:147], v9 offset:10560
    v_smfmac_f32_16x16x64_bf16 v[180:183], a[200:203], v[196:203], v34 abid:1
    ds_read_b128 v[148:151], v9 offset:10624
    ds_read_b128 v[140:143], v9 offset:10496
    v_add_u32 v4, s31, v4
    v_smfmac_f32_16x16x64_bf16 v[180:183], a[236:239], v[204:211], v38 abid:1
    v_add_u32 v1, s31, v1
    v_smfmac_f32_16x16x64_bf16 v[184:187], a[204:207], v[196:203], v35
    v_add_u32 v2, s31, v2
    v_smfmac_f32_16x16x64_bf16 v[184:187], a[240:243], v[204:211], v39
    v_smfmac_f32_16x16x64_bf16 v[188:191], a[208:211], v[196:203], v35 abid:1
    v_smfmac_f32_16x16x64_bf16 v[188:191], a[244:247], v[204:211], v39 abid:1
    v_smfmac_f32_16x16x64_bf16 v[192:195], a[212:215], v[196:203], v50 abid:1
    v_smfmac_f32_16x16x64_bf16 v[192:195], a[248:251], v[204:211], v51
    s_branch M_top
M_bE0:
    v_smfmac_f32_16x16x64_bf16 v[164:167], v[56:59], v[220:227], v40 abid:1
    ds_read_b128 v[204:207], v1 offset:1024
    v_smfmac_f32_16x16x64_bf16 v[164:167], v[92:95], v[228:235], v44 abid:1
    ds_read_b128 v[208:211], v2 offset:1024
    v_mov_b32 v0, 1
    v_smfmac_f32_16x16x64_bf16 v[168:171], v[60:63], v[220:227], v41
    ds_read_b128 v[212:215], v1 offset:2048
    v_smfmac_f32_16x16x64_bf16 v[168:171], v[96:99], v[228:235], v45
    ds_read_b128 v[216:219], v2 offset:2048
    v_smfmac_f32_16x16x64_bf16 v[172:175], v[64:67], v[220:227], v41 abid:1
    s_waitcnt vmcnt(5)
    s_waitcnt lgkmcnt(6)
    buffer_store_dwordx4 v[244:247], v7, s[12:15], s66 offen sc1
    v_smfmac_f32_16x16x64_bf16 v[172:175], v[100:103], v[228:235], v45 abid:1
    ds_read_b128 v[236:239], v9 offset:9408
    v_smfmac_f32_16x16x64_bf16 v[176:179], v[68:71], v[220:227], v42
    s_waitcnt vmcnt(6)
    buffer_atomic_add v0, v11, s[16:19], s92 offen sc0 sc1
    s_mov_b32 s21, 2
    v_smfmac_f32_16x16x64_bf16 v[176:179], v[104:107], v[228:235], v46
    v_smfmac_f32_16x16x64_bf16 v[180:183], v[72:75], v[220:227], v42 abid:1
    v_cvt_pk_bf16_f32 v160, v160, v161
    v_smfmac_f32_16x16x64_bf16 v[180:183], v[108:111], v[228:235], v46 abid:1
    v_cvt_pk_bf16_f32 v161, v162, v163
    v_smfmac_f32_16x16x64_bf16 v[184:187], v[76:79], v[220:227], v43
    v_cvt_pk_bf16_f32 v162, v164, v165
    v_smfmac_f32_16x16x64_bf16 v[184:187], v[112:115], v[228:235], v47
    v_cvt_pk_bf16_f32 v163, v166, v167
    v_smfmac_f32_16x16x64_bf16 v[188:191], v[80:83], v[220:227], v43 abid:1
    s_add_u32 m0, m0, 896
    v_cvt_pk_bf16_f32 v168, v168, v169
    v_smfmac_f32_16x16x64_bf16 v[188:191], v[116:119], v[228:235], v47 abid:1
    s_waitcnt vmcnt(5)
    buffer_load_dwordx4 v5, s[8:11], s22 offen offset:512 nt lds
    v_cvt_pk_bf16_f32 v169, v170, v171
    v_smfmac_f32_16x16x64_bf16 v[192:195], v[84:87], v[220:227], v51 abid:1
    v_cvt_pk_bf16_f32 v170, v172, v173
    v_smfmac_f32_16x16x64_bf16 v[192:195], v[120:123], v[228:235], v52
    ds_read_b128 v[220:223], v1 offset:3072
    s_waitcnt lgkmcnt(6)
    v_cvt_pk_bf16_f32 v171, v174, v175
    v_smfmac_f32_16x16x64_bf16 v[124:127], a[0:3], v[196:203], v12
    ds_read_b128 v[224:227], v2 offset:3072
    ds_read_b128 v[172:175], v9 offset:10432
    s_waitcnt lgkmcnt(6)
    v_cndmask_b32_dpp v164, v160, v168, vcc row_ror:8 row_mask:0xf bank_mask:0xf
    v_smfmac_f32_16x16x64_bf16 v[124:127], a[36:39], v[204:211], v16
    ds_read_b128 v[228:231], v1 offset:4096
    s_waitcnt lgkmcnt(5)
    v_cndmask_b32_dpp v165, v161, v169, vcc row_ror:8 row_mask:0xf bank_mask:0xf
    v_smfmac_f32_16x16x64_bf16 v[124:127], a[72:75], v[212:219], v20
    ds_read_b128 v[232:235], v2 offset:4096
    v_cndmask_b32_dpp v166, v162, v170, vcc row_ror:8 row_mask:0xf bank_mask:0xf
    v_smfmac_f32_16x16x64_bf16 v[128:131], a[4:7], v[196:203], v12 abid:1
    s_barrier
    v_cndmask_b32_dpp v167, v163, v171, vcc row_ror:8 row_mask:0xf bank_mask:0xf
    v_smfmac_f32_16x16x64_bf16 v[128:131], a[40:43], v[204:211], v16 abid:1
    s_waitcnt vmcnt(6)
    buffer_store_dwordx4 v[164:167], v6, s[12:15], s58 offen offset:0 sc1
    s_waitcnt lgkmcnt(5)
    v_xad_u32 v236, v236, v3, v4
    v_smfmac_f32_16x16x64_bf16 v[128:131], a[76:79], v[212:219], v20 abid:1
    v_xad_u32 v237, v237, v3, v4
    v_smfmac_f32_16x16x64_bf16 v[132:135], a[8:11], v[196:203], v13
    ds_read2st64_b32 v[244:245], v236 offset0:0 offset1:72
    ds_read_b128 v[240:243], v8 offset:3072
    v_xad_u32 v238, v238, v3, v4
    v_smfmac_f32_16x16x64_bf16 v[132:135], a[44:47], v[204:211], v17
    ds_read2st64_b32 v[246:247], v237 offset0:0 offset1:72
    v_xad_u32 v239, v239, v3, v4
    v_smfmac_f32_16x16x64_bf16 v[132:135], a[80:83], v[212:219], v21
    ds_read2st64_b32 v[248:249], v238 offset0:0 offset1:72
    v_mov_b32_dpp v160, v168 row_ror:8 row_mask:0xf bank_mask:0xc
    v_smfmac_f32_16x16x64_bf16 v[136:139], a[12:15], v[196:203], v13 abid:1
    ds_read2st64_b32 v[250:251], v239 offset0:0 offset1:72
    ds_read_b128 v[236:239], v9 offset:9280
    v_mov_b32_dpp v161, v169 row_ror:8 row_mask:0xf bank_mask:0xc
    v_smfmac_f32_16x16x64_bf16 v[136:139], a[48:51], v[204:211], v17 abid:1
    v_mov_b32_dpp v162, v170 row_ror:8 row_mask:0xf bank_mask:0xc
    v_smfmac_f32_16x16x64_bf16 v[136:139], a[84:87], v[212:219], v21 abid:1
    v_mov_b32_dpp v163, v171 row_ror:8 row_mask:0xf bank_mask:0xc
    v_smfmac_f32_16x16x64_bf16 v[140:143], a[16:19], v[196:203], v14
    s_waitcnt vmcnt(5)
    buffer_store_dwordx4 v[160:163], v6, s[12:15], s23 offen offset:0 sc1
    ds_read_b128 v[164:167], v9 offset:10304
    v_smfmac_f32_16x16x64_bf16 v[140:143], a[52:55], v[204:211], v18
    ds_read_b128 v[168:171], v9 offset:10368
    ds_read_b128 v[160:163], v9 offset:10240
    v_smfmac_f32_16x16x64_bf16 v[140:143], a[88:91], v[212:219], v22
    v_smfmac_f32_16x16x64_bf16 v[144:147], a[20:23], v[196:203], v14 abid:1
    v_smfmac_f32_16x16x64_bf16 v[144:147], a[56:59], v[204:211], v18 abid:1
    v_smfmac_f32_16x16x64_bf16 v[144:147], a[92:95], v[212:219], v22 abid:1
    s_waitcnt lgkmcnt(3)
    v_xad_u32 v236, v236, v3, v4
    v_smfmac_f32_16x16x64_bf16 v[136:139], v[240:243], v[244:251], v10
    v_xad_u32 v237, v237, v3, v4
    v_smfmac_f32_16x16x64_bf16 v[172:175], v[240:243], v[244:251], v10 abid:1
    ds_read2st64_b32 v[244:245], v236 offset0:0 offset1:72
    ds_read_b128 v[240:243], v8 offset:1024
    v_xad_u32 v238, v238, v3, v4
    v_smfmac_f32_16x16x64_bf16 v[148:151], a[24:27], v[196:203], v15
    ds_read2st64_b32 v[246:247], v237 offset0:0 offset1:72
    v_xad_u32 v239, v239, v3, v4
    v_smfmac_f32_16x16x64_bf16 v[148:151], a[60:63], v[204:211], v19
    ds_read2st64_b32 v[248:249], v238 offset0:0 offset1:72
    v_cvt_pk_bf16_f32 v192, v192, v193
    v_smfmac_f32_16x16x64_bf16 v[148:151], a[96:99], v[212:219], v23
    ds_read2st64_b32 v[250:251], v239 offset0:0 offset1:72
    ds_read_b128 v[236:239], v9 offset:9344
    v_cvt_pk_bf16_f32 v193, v194, v195
    v_smfmac_f32_16x16x64_bf16 v[152:155], a[28:31], v[196:203], v15 abid:1
    ds_write_b64 v53, v[192:193] offset:0
    ds_read_b128 v[192:195], v9 offset:10752
    v_smfmac_f32_16x16x64_bf16 v[152:155], a[64:67], v[204:211], v19 abid:1
    s_add_u32 m0, m0, 896
    v_smfmac_f32_16x16x64_bf16 v[152:155], a[100:103], v[212:219], v23 abid:1
    s_waitcnt vmcnt(6)
    buffer_load_dwordx4 v5, s[8:11], s22 offen offset:640 nt lds
    v_smfmac_f32_16x16x64_bf16 v[156:159], a[32:35], v[196:203], v48
    v_smfmac_f32_16x16x64_bf16 v[156:159], a[68:71], v[204:211], v48 abid:1
    v_smfmac_f32_16x16x64_bf16 v[156:159], a[104:107], v[212:219], v49
    ds_read_b128 v[196:199], v1 offset:5120
    v_cvt_pk_bf16_f32 v176, v176, v177
    v_smfmac_f32_16x16x64_bf16 v[124:127], a[108:111], v[220:227], v24
    ds_read_b128 v[200:203], v2 offset:5120
    v_cvt_pk_bf16_f32 v177, v178, v179
    v_smfmac_f32_16x16x64_bf16 v[124:127], a[144:147], v[228:235], v28
    ds_read_b128 v[204:207], v1 offset:6144
    ds_read_b64 v[216:217], v9 offset:10056
    v_cvt_pk_bf16_f32 v178, v180, v181
    v_smfmac_f32_16x16x64_bf16 v[128:131], a[112:115], v[220:227], v24 abid:1
    ds_read_b128 v[208:211], v2 offset:6144
    v_cvt_pk_bf16_f32 v179, v182, v183
    v_smfmac_f32_16x16x64_bf16 v[128:131], a[148:151], v[228:235], v28 abid:1
    s_waitcnt lgkmcnt(7)
    v_xad_u32 v236, v236, v3, v4
    v_smfmac_f32_16x16x64_bf16 v[128:131], v[240:243], v[244:251], v10
    s_add_u32 m0, m0, 896
    v_xad_u32 v237, v237, v3, v4
    v_smfmac_f32_16x16x64_bf16 v[164:167], v[240:243], v[244:251], v10 abid:1
    ds_read2st64_b32 v[244:245], v236 offset0:0 offset1:72
    ds_read_b128 v[240:243], v8 offset:2048
    v_xad_u32 v238, v238, v3, v4
    v_smfmac_f32_16x16x64_bf16 v[132:135], a[116:119], v[220:227], v25
    ds_read2st64_b32 v[246:247], v237 offset0:0 offset1:72
    s_waitcnt vmcnt(5)
    v_xad_u32 v239, v239, v3, v4
    v_smfmac_f32_16x16x64_bf16 v[132:135], a[152:155], v[228:235], v29
    ds_read2st64_b32 v[248:249], v238 offset0:0 offset1:72
    buffer_load_dwordx4 v5, s[8:11], s22 offen offset:768 nt lds
    v_cvt_pk_bf16_f32 v184, v184, v185
    v_smfmac_f32_16x16x64_bf16 v[136:139], a[120:123], v[220:227], v25 abid:1
    ds_read2st64_b32 v[250:251], v239 offset0:0 offset1:72
    ds_read_b128 v[236:239], v9 offset:9216
    v_cvt_pk_bf16_f32 v185, v186, v187
    v_smfmac_f32_16x16x64_bf16 v[136:139], a[156:159], v[228:235], v29 abid:1
    v_cvt_pk_bf16_f32 v186, v188, v189
    v_smfmac_f32_16x16x64_bf16 v[140:143], a[124:127], v[220:227], v26
    v_cvt_pk_bf16_f32 v187, v190, v191
    v_smfmac_f32_16x16x64_bf16 v[140:143], a[160:163], v[228:235], v30
    ds_read_b128 v[188:191], v9 offset:10688
    v_cndmask_b32_dpp v180, v176, v184, vcc row_ror:8 row_mask:0xf bank_mask:0xf
    v_smfmac_f32_16x16x64_bf16 v[144:147], a[128:131], v[220:227], v26 abid:1
    v_cndmask_b32_dpp v181, v177, v185, vcc row_ror:8 row_mask:0xf bank_mask:0xf
    v_smfmac_f32_16x16x64_bf16 v[144:147], a[164:167], v[228:235], v30 abid:1
    v_cndmask_b32_dpp v182, v178, v186, vcc row_ror:8 row_mask:0xf bank_mask:0xf
    v_smfmac_f32_16x16x64_bf16 v[148:151], a[132:135], v[220:227], v27
    v_cndmask_b32_dpp v183, v179, v187, vcc row_ror:8 row_mask:0xf bank_mask:0xf
    v_smfmac_f32_16x16x64_bf16 v[148:151], a[168:171], v[228:235], v31
    s_waitcnt vmcnt(6)
    buffer_store_dwordx4 v[180:183], v6, s[12:15], s58 offen offset:128 sc1
    v_mov_b32_dpp v176, v184 row_ror:8 row_mask:0xf bank_mask:0xc
    v_smfmac_f32_16x16x64_bf16 v[152:155], a[136:139], v[220:227], v27 abid:1
    v_mov_b32_dpp v177, v185 row_ror:8 row_mask:0xf bank_mask:0xc
    v_smfmac_f32_16x16x64_bf16 v[152:155], a[172:175], v[228:235], v31 abid:1
    s_waitcnt lgkmcnt(1)
    v_xad_u32 v236, v236, v3, v4
    v_smfmac_f32_16x16x64_bf16 v[132:135], v[240:243], v[244:251], v10
    v_xad_u32 v237, v237, v3, v4
    v_smfmac_f32_16x16x64_bf16 v[168:171], v[240:243], v[244:251], v10 abid:1
    ds_read2st64_b32 v[244:245], v236 offset0:0 offset1:72
    ds_read_b128 v[240:243], v8 offset:0
    v_xad_u32 v238, v238, v3, v4
    v_smfmac_f32_16x16x64_bf16 v[156:159], a[140:143], v[220:227], v49 abid:1
    ds_read2st64_b32 v[246:247], v237 offset0:0 offset1:72
    v_xad_u32 v239, v239, v3, v4
    v_smfmac_f32_16x16x64_bf16 v[156:159], a[176:179], v[228:235], v50
    ds_read2st64_b32 v[248:249], v238 offset0:0 offset1:72
    ds_read_b128 v[220:223], v1 offset:7168
    v_mov_b32_dpp v178, v186 row_ror:8 row_mask:0xf bank_mask:0xc
    v_smfmac_f32_16x16x64_bf16 v[124:127], a[180:183], v[196:203], v32
    ds_read2st64_b32 v[250:251], v239 offset0:0 offset1:72
    ds_read_b128 v[236:239], v9 offset:9728
    v_mov_b32_dpp v179, v187 row_ror:8 row_mask:0xf bank_mask:0xc
    v_smfmac_f32_16x16x64_bf16 v[124:127], a[216:219], v[204:211], v36
    ds_read_b128 v[224:227], v2 offset:7168
    s_waitcnt vmcnt(5)
    buffer_store_dwordx4 v[176:179], v6, s[12:15], s23 offen offset:128 sc1
    v_smfmac_f32_16x16x64_bf16 v[128:131], a[184:187], v[196:203], v32 abid:1
    ds_read_b128 v[228:231], v1 offset:8192
    ds_read_b128 v[180:183], v9 offset:10560
    ds_read_b128 v[184:187], v9 offset:10624
    v_smfmac_f32_16x16x64_bf16 v[128:131], a[220:223], v[204:211], v36 abid:1
    ds_read_b128 v[232:235], v2 offset:8192
    ds_read_b128 v[176:179], v9 offset:10496
    v_xad_u32 v212, v216, v3, v4
    v_smfmac_f32_16x16x64_bf16 v[132:135], a[188:191], v[196:203], v33
    ds_read2st64_b32 v[212:213], v212 offset0:0 offset1:72
    v_xad_u32 v214, v217, v3, v4
    v_smfmac_f32_16x16x64_bf16 v[132:135], a[224:227], v[204:211], v37
    ds_read2st64_b32 v[214:215], v214 offset0:0 offset1:72
    v_smfmac_f32_16x16x64_bf16 v[136:139], a[192:195], v[196:203], v33 abid:1
    v_smfmac_f32_16x16x64_bf16 v[136:139], a[228:231], v[204:211], v37 abid:1
    v_smfmac_f32_16x16x64_bf16 v[140:143], a[196:199], v[196:203], v34
    v_smfmac_f32_16x16x64_bf16 v[140:143], a[232:235], v[204:211], v38
    s_waitcnt vmcnt(7)
    s_waitcnt lgkmcnt(8)
    v_xad_u32 v236, v236, v3, v4
    v_smfmac_f32_16x16x64_bf16 v[124:127], v[240:243], v[244:251], v10
    v_xad_u32 v237, v237, v3, v4
    v_smfmac_f32_16x16x64_bf16 v[160:163], v[240:243], v[244:251], v10 abid:1
    ds_read2st64_b32 v[244:245], v236 offset0:0 offset1:72
    ds_read_b128 v[240:243], v8 offset:8192
    v_xad_u32 v238, v238, v3, v4
    v_smfmac_f32_16x16x64_bf16 v[144:147], a[200:203], v[196:203], v34 abid:1
    ds_read2st64_b32 v[246:247], v237 offset0:0 offset1:72
    v_xad_u32 v239, v239, v3, v4
    v_smfmac_f32_16x16x64_bf16 v[144:147], a[236:239], v[204:211], v38 abid:1
    ds_read2st64_b32 v[248:249], v238 offset0:0 offset1:72
    v_mul_u32_u24 v0, s94, v0
    v_smfmac_f32_16x16x64_bf16 v[148:151], a[204:207], v[196:203], v35
    ds_read2st64_b32 v[250:251], v239 offset0:0 offset1:72
    ds_read_b128 v[236:239], v9 offset:9664
    v_add_u32 v0, s93, v0
    v_smfmac_f32_16x16x64_bf16 v[148:151], a[240:243], v[204:211], v39
    s_add_u32 m0, m0, 896
    v_min_u32 v0, 75497472, v0
    v_smfmac_f32_16x16x64_bf16 v[152:155], a[208:211], v[196:203], v35 abid:1
    ds_write_b32 v11, v0
    s_waitcnt vmcnt(6)
    v_mov_b32 v0, 162048
    v_smfmac_f32_16x16x64_bf16 v[152:155], a[244:247], v[204:211], v39 abid:1
    buffer_load_dwordx4 v5, s[8:11], s22 offen offset:896 nt lds
    v_smfmac_f32_16x16x64_bf16 v[156:159], a[212:215], v[196:203], v50 abid:1
    s_waitcnt lgkmcnt(7)
    s_cmp_lt_i32 s81, 0
    s_cbranch_scc1 M_ovrE0
    s_swappc_b64 s[78:79], s[72:73]
M_ovrE0:
    v_smfmac_f32_16x16x64_bf16 v[156:159], a[248:251], v[204:211], v51
    ds_read_b128 v[196:199], v1 offset:18432
    v_smfmac_f32_16x16x64_bf16 v[124:127], a[252:255], v[220:227], v40
    ds_read_b128 v[200:203], v2 offset:18432
    v_smfmac_f32_16x16x64_bf16 v[124:127], v[88:91], v[228:235], v44
    ds_read_b128 v[204:207], v1 offset:19456
    v_smfmac_f32_16x16x64_bf16 v[128:131], v[56:59], v[220:227], v40 abid:1
    ds_read_b128 v[208:211], v2 offset:19456
    v_smfmac_f32_16x16x64_bf16 v[128:131], v[92:95], v[228:235], v44 abid:1
    s_waitcnt lgkmcnt(4)
    s_barrier
    v_xad_u32 v236, v236, v3, v4
    v_smfmac_f32_16x16x64_bf16 v[156:159], v[240:243], v[244:251], v10
    ds_read_b32 v0, v0
    v_xad_u32 v237, v237, v3, v4
    v_smfmac_f32_16x16x64_bf16 v[192:195], v[240:243], v[244:251], v10 abid:1
    ds_read2st64_b32 v[244:245], v236 offset0:0 offset1:72
    ds_read_b128 v[240:243], v8 offset:7168
    v_xad_u32 v238, v238, v3, v4
    v_smfmac_f32_16x16x64_bf16 v[132:135], v[60:63], v[220:227], v41
    ds_read2st64_b32 v[246:247], v237 offset0:0 offset1:72
    v_xad_u32 v239, v239, v3, v4
    v_smfmac_f32_16x16x64_bf16 v[132:135], v[96:99], v[228:235], v45
    ds_read2st64_b32 v[248:249], v238 offset0:0 offset1:72
    s_add_u32 m0, m0, 896
    v_smfmac_f32_16x16x64_bf16 v[136:139], v[64:67], v[220:227], v41 abid:1
    ds_read2st64_b32 v[250:251], v239 offset0:0 offset1:72
    ds_read_b128 v[236:239], v9 offset:9536
    s_waitcnt vmcnt(5)
    v_smfmac_f32_16x16x64_bf16 v[136:139], v[100:103], v[228:235], v45 abid:1
    buffer_load_dwordx4 v5, s[8:11], s22 offen offset:1024 nt lds
    s_waitcnt lgkmcnt(6)
    v_readfirstlane_b32 s88, v0
    v_smfmac_f32_16x16x64_bf16 v[140:143], v[68:71], v[220:227], v42
    s_cmp_lt_u32 s88, 75497472
    s_cselect_b32 s10, 75497472, 0
    v_smfmac_f32_16x16x64_bf16 v[140:143], v[104:107], v[228:235], v46
    v_smfmac_f32_16x16x64_bf16 v[144:147], v[72:75], v[220:227], v42 abid:1
    ds_read_b128 v[212:215], v1 offset:20480
    v_smfmac_f32_16x16x64_bf16 v[144:147], v[108:111], v[228:235], v46 abid:1
    ds_read_b128 v[216:219], v2 offset:20480
    v_smfmac_f32_16x16x64_bf16 v[148:151], v[76:79], v[220:227], v43
    v_smfmac_f32_16x16x64_bf16 v[148:151], v[112:115], v[228:235], v47
    v_smfmac_f32_16x16x64_bf16 v[152:155], v[80:83], v[220:227], v43 abid:1
    v_smfmac_f32_16x16x64_bf16 v[152:155], v[116:119], v[228:235], v47 abid:1
    s_waitcnt lgkmcnt(2)
    v_xad_u32 v236, v236, v3, v4
    v_smfmac_f32_16x16x64_bf16 v[152:155], v[240:243], v[244:251], v10
    v_xad_u32 v237, v237, v3, v4
    v_smfmac_f32_16x16x64_bf16 v[188:191], v[240:243], v[244:251], v10 abid:1
    s_cmp_gt_u32 s46, s80
    s_cbranch_scc1 M_slow
M_slowrE0:
    v_xad_u32 v238, v238, v3, v4
    v_smfmac_f32_16x16x64_bf16 v[156:159], v[84:87], v[220:227], v51 abid:1
    ds_read2st64_b32 v[244:245], v236 offset0:0 offset1:72
    ds_read_b128 v[240:243], v8 offset:5120
    v_xad_u32 v239, v239, v3, v4
    v_smfmac_f32_16x16x64_bf16 v[156:159], v[120:123], v[228:235], v52
    ds_read2st64_b32 v[246:247], v237 offset0:0 offset1:72
    ds_read_b128 v[220:223], v1 offset:21504
    v_smfmac_f32_16x16x64_bf16 v[160:163], a[0:3], v[196:203], v12
    ds_read2st64_b32 v[248:249], v238 offset0:0 offset1:72
    ds_read_b128 v[224:227], v2 offset:21504
    v_smfmac_f32_16x16x64_bf16 v[160:163], a[36:39], v[204:211], v16
    ds_read2st64_b32 v[250:251], v239 offset0:0 offset1:72
    ds_read_b128 v[236:239], v9 offset:9600
    s_waitcnt lgkmcnt(8)
    v_smfmac_f32_16x16x64_bf16 v[160:163], a[72:75], v[212:219], v20
    ds_read_b128 v[228:231], v1 offset:22528
    v_smfmac_f32_16x16x64_bf16 v[164:167], a[4:7], v[196:203], v12 abid:1
    ds_read_b128 v[232:235], v2 offset:22528
    v_cvt_pk_bf16_f32 v156, v156, v157
    v_smfmac_f32_16x16x64_bf16 v[164:167], a[40:43], v[204:211], v16 abid:1
    s_mov_b32 m0, s28
    v_cvt_pk_bf16_f32 v157, v158, v159
    v_smfmac_f32_16x16x64_bf16 v[164:167], a[76:79], v[212:219], v20 abid:1
    ds_write_b64 v53, v[156:157] offset:25728
    ds_read_b128 v[156:159], v9 offset:10752
    s_waitcnt vmcnt(6)
    v_smfmac_f32_16x16x64_bf16 v[168:171], a[8:11], v[196:203], v13
    buffer_load_dwordx4 v5, s[8:11], s88 offen offset:0 nt lds
    v_smfmac_f32_16x16x64_bf16 v[168:171], a[44:47], v[204:211], v17
    v_cvt_pk_bf16_f32 v124, v124, v125
    v_smfmac_f32_16x16x64_bf16 v[168:171], a[80:83], v[212:219], v21
    s_waitcnt lgkmcnt(4)
    v_xad_u32 v236, v236, v3, v4
    v_smfmac_f32_16x16x64_bf16 v[144:147], v[240:243], v[244:251], v10
    v_xad_u32 v237, v237, v3, v4
    v_smfmac_f32_16x16x64_bf16 v[180:183], v[240:243], v[244:251], v10 abid:1
    ds_read2st64_b32 v[244:245], v236 offset0:0 offset1:72
    ds_read_b128 v[240:243], v8 offset:6144
    v_xad_u32 v238, v238, v3, v4
    v_smfmac_f32_16x16x64_bf16 v[172:175], a[12:15], v[196:203], v13 abid:1
    ds_read2st64_b32 v[246:247], v237 offset0:0 offset1:72
    v_xad_u32 v239, v239, v3, v4
    v_smfmac_f32_16x16x64_bf16 v[172:175], a[48:51], v[204:211], v17 abid:1
    ds_read2st64_b32 v[248:249], v238 offset0:0 offset1:72
    v_cvt_pk_bf16_f32 v125, v126, v127
    v_smfmac_f32_16x16x64_bf16 v[172:175], a[84:87], v[212:219], v21 abid:1
    ds_read2st64_b32 v[250:251], v239 offset0:0 offset1:72
    ds_read_b128 v[236:239], v9 offset:9472
    v_cvt_pk_bf16_f32 v126, v128, v129
    v_smfmac_f32_16x16x64_bf16 v[176:179], a[16:19], v[196:203], v14
    v_cvt_pk_bf16_f32 v127, v130, v131
    v_smfmac_f32_16x16x64_bf16 v[176:179], a[52:55], v[204:211], v18
    v_cvt_pk_bf16_f32 v132, v132, v133
    v_smfmac_f32_16x16x64_bf16 v[176:179], a[88:91], v[212:219], v22
    v_cvt_pk_bf16_f32 v133, v134, v135
    v_smfmac_f32_16x16x64_bf16 v[180:183], a[20:23], v[196:203], v14 abid:1
    s_add_u32 m0, m0, 896
    v_cvt_pk_bf16_f32 v134, v136, v137
    v_smfmac_f32_16x16x64_bf16 v[180:183], a[56:59], v[204:211], v18 abid:1
    s_waitcnt vmcnt(5)
    buffer_load_dwordx4 v5, s[8:11], s88 offen offset:128 nt lds
    v_cvt_pk_bf16_f32 v135, v138, v139
    v_smfmac_f32_16x16x64_bf16 v[180:183], a[92:95], v[212:219], v22 abid:1
    ds_read_b128 v[136:139], v9 offset:10432
    v_cndmask_b32_dpp v128, v124, v132, vcc row_ror:8 row_mask:0xf bank_mask:0xf
    v_smfmac_f32_16x16x64_bf16 v[184:187], a[24:27], v[196:203], v15
    v_cndmask_b32_dpp v129, v125, v133, vcc row_ror:8 row_mask:0xf bank_mask:0xf
    v_smfmac_f32_16x16x64_bf16 v[184:187], a[60:63], v[204:211], v19
    v_cndmask_b32_dpp v130, v126, v134, vcc row_ror:8 row_mask:0xf bank_mask:0xf
    v_smfmac_f32_16x16x64_bf16 v[184:187], a[96:99], v[212:219], v23
    s_waitcnt lgkmcnt(1)
    v_xad_u32 v236, v236, v3, v4
    v_smfmac_f32_16x16x64_bf16 v[148:151], v[240:243], v[244:251], v10
    v_xad_u32 v237, v237, v3, v4
    v_smfmac_f32_16x16x64_bf16 v[184:187], v[240:243], v[244:251], v10 abid:1
    ds_read2st64_b32 v[244:245], v236 offset0:0 offset1:72
    ds_read_b128 v[240:243], v8 offset:4096
    v_xad_u32 v238, v238, v3, v4
    v_smfmac_f32_16x16x64_bf16 v[188:191], a[28:31], v[196:203], v15 abid:1
    ds_read2st64_b32 v[246:247], v237 offset0:0 offset1:72
    v_xad_u32 v239, v239, v3, v4
    v_smfmac_f32_16x16x64_bf16 v[188:191], a[64:67], v[204:211], v19 abid:1
    ds_read2st64_b32 v[248:249], v238 offset0:0 offset1:72
    v_cndmask_b32_dpp v131, v127, v135, vcc row_ror:8 row_mask:0xf bank_mask:0xf
    v_smfmac_f32_16x16x64_bf16 v[188:191], a[100:103], v[212:219], v23 abid:1
    ds_read2st64_b32 v[250:251], v239 offset0:0 offset1:72
    s_waitcnt vmcnt(6)
    buffer_store_dwordx4 v[128:131], v6, s[12:15], s59 offen offset:0 sc1
    v_smfmac_f32_16x16x64_bf16 v[192:195], a[32:35], v[196:203], v48
    v_mov_b32_dpp v124, v132 row_ror:8 row_mask:0xf bank_mask:0xc
    v_smfmac_f32_16x16x64_bf16 v[192:195], a[68:71], v[204:211], v48 abid:1
    v_mov_b32_dpp v125, v133 row_ror:8 row_mask:0xf bank_mask:0xc
    v_smfmac_f32_16x16x64_bf16 v[192:195], a[104:107], v[212:219], v49
    ds_read_b128 v[196:199], v1 offset:23552
    v_mov_b32_dpp v126, v134 row_ror:8 row_mask:0xf bank_mask:0xc
    v_smfmac_f32_16x16x64_bf16 v[160:163], a[108:111], v[220:227], v24
    ds_read_b128 v[200:203], v2 offset:23552
    v_mov_b32_dpp v127, v135 row_ror:8 row_mask:0xf bank_mask:0xc
    v_smfmac_f32_16x16x64_bf16 v[160:163], a[144:147], v[228:235], v28
    ds_read_b128 v[204:207], v1 offset:24576
    s_waitcnt vmcnt(5)
    buffer_store_dwordx4 v[124:127], v6, s[12:15], s24 offen offset:0 sc1
    v_smfmac_f32_16x16x64_bf16 v[164:167], a[112:115], v[220:227], v24 abid:1
    ds_read_b128 v[208:211], v2 offset:24576
    ds_read_b128 v[128:131], v9 offset:10304
    ds_read_b128 v[132:135], v9 offset:10368
    v_smfmac_f32_16x16x64_bf16 v[164:167], a[148:151], v[228:235], v28 abid:1
    ds_read_b128 v[124:127], v9 offset:10240
    v_smfmac_f32_16x16x64_bf16 v[168:171], a[116:119], v[220:227], v25
    v_smfmac_f32_16x16x64_bf16 v[168:171], a[152:155], v[228:235], v29
    s_waitcnt lgkmcnt(7)
    v_smfmac_f32_16x16x64_bf16 v[140:143], v[240:243], v[244:251], v10
    v_smfmac_f32_16x16x64_bf16 v[176:179], v[240:243], v[244:251], v10 abid:1
    v_smfmac_f32_16x16x64_bf16 v[172:175], a[120:123], v[220:227], v25 abid:1
    s_add_u32 s28, s28, 36864
    s_cmp_ge_u32 s28, 110592
    s_cselect_b32 s28, s26, s28
    v_smfmac_f32_16x16x64_bf16 v[172:175], a[156:159], v[228:235], v29 abid:1
    s_add_u32 s30, s25, 36864
    s_cmp_eq_u32 s30, 110592
    s_cselect_b32 s30, 0, s30
    v_smfmac_f32_16x16x64_bf16 v[176:179], a[124:127], v[220:227], v26
    s_sub_u32 s31, s30, s25
    s_mov_b32 s25, s30
    s_mov_b32 s90, s22
    v_smfmac_f32_16x16x64_bf16 v[176:179], a[160:163], v[228:235], v30
    s_mov_b32 s22, s88
    s_add_u32 s91, s91, 1
    s_cmp_lt_u32 s20, 2
    v_smfmac_f32_16x16x64_bf16 v[180:183], a[128:131], v[220:227], v26 abid:1
    s_cselect_b32 s66, s23, s24
    s_add_u32 s66, s66, s95
    v_smfmac_f32_16x16x64_bf16 v[180:183], a[164:167], v[228:235], v30 abid:1
    v_cvt_pk_bf16_f32 v140, v140, v141
    v_smfmac_f32_16x16x64_bf16 v[184:187], a[132:135], v[220:227], v27
    s_add_u32 m0, m0, 896
    v_cvt_pk_bf16_f32 v141, v142, v143
    v_smfmac_f32_16x16x64_bf16 v[184:187], a[168:171], v[228:235], v31
    s_waitcnt vmcnt(6)
    buffer_load_dwordx4 v5, s[8:11], s88 offen offset:256 nt lds
    v_cvt_pk_bf16_f32 v142, v144, v145
    v_smfmac_f32_16x16x64_bf16 v[188:191], a[136:139], v[220:227], v27 abid:1
    v_cvt_pk_bf16_f32 v143, v146, v147
    v_smfmac_f32_16x16x64_bf16 v[188:191], a[172:175], v[228:235], v31 abid:1
    v_cvt_pk_bf16_f32 v148, v148, v149
    v_smfmac_f32_16x16x64_bf16 v[192:195], a[140:143], v[220:227], v49 abid:1
    v_cvt_pk_bf16_f32 v149, v150, v151
    v_smfmac_f32_16x16x64_bf16 v[192:195], a[176:179], v[228:235], v50
    ds_read_b128 v[220:223], v1 offset:25600
    s_waitcnt lgkmcnt(6)
    v_cvt_pk_bf16_f32 v150, v152, v153
    v_smfmac_f32_16x16x64_bf16 v[160:163], a[180:183], v[196:203], v32
    ds_read_b128 v[224:227], v2 offset:25600
    s_waitcnt lgkmcnt(5)
    v_cvt_pk_bf16_f32 v151, v154, v155
    v_smfmac_f32_16x16x64_bf16 v[160:163], a[216:219], v[204:211], v36
    ds_read_b128 v[228:231], v1 offset:26624
    ds_read_b128 v[152:155], v9 offset:10688
    v_cndmask_b32_dpp v144, v140, v148, vcc row_ror:8 row_mask:0xf bank_mask:0xf
    v_smfmac_f32_16x16x64_bf16 v[164:167], a[184:187], v[196:203], v32 abid:1
    ds_read_b128 v[232:235], v2 offset:26624
    v_cndmask_b32_dpp v145, v141, v149, vcc row_ror:8 row_mask:0xf bank_mask:0xf
    v_smfmac_f32_16x16x64_bf16 v[164:167], a[220:223], v[204:211], v36 abid:1
    s_add_u32 m0, m0, 896
    v_cndmask_b32_dpp v146, v142, v150, vcc row_ror:8 row_mask:0xf bank_mask:0xf
    v_smfmac_f32_16x16x64_bf16 v[168:171], a[188:191], v[196:203], v33
    s_waitcnt vmcnt(5)
    buffer_load_dwordx4 v5, s[8:11], s88 offen offset:384 nt lds
    v_cndmask_b32_dpp v147, v143, v151, vcc row_ror:8 row_mask:0xf bank_mask:0xf
    v_smfmac_f32_16x16x64_bf16 v[168:171], a[224:227], v[204:211], v37
    s_waitcnt vmcnt(6)
    buffer_store_dwordx4 v[144:147], v6, s[12:15], s59 offen offset:128 sc1
    v_mov_b32_dpp v140, v148 row_ror:8 row_mask:0xf bank_mask:0xc
    v_smfmac_f32_16x16x64_bf16 v[172:175], a[192:195], v[196:203], v33 abid:1
    v_mov_b32_dpp v141, v149 row_ror:8 row_mask:0xf bank_mask:0xc
    v_smfmac_f32_16x16x64_bf16 v[172:175], a[228:231], v[204:211], v37 abid:1
    v_mov_b32_dpp v142, v150 row_ror:8 row_mask:0xf bank_mask:0xc
    v_smfmac_f32_16x16x64_bf16 v[176:179], a[196:199], v[196:203], v34
    v_mov_b32_dpp v143, v151 row_ror:8 row_mask:0xf bank_mask:0xc
    v_smfmac_f32_16x16x64_bf16 v[176:179], a[232:235], v[204:211], v38
    s_waitcnt vmcnt(5)
    buffer_store_dwordx4 v[140:143], v6, s[12:15], s24 offen offset:128 sc1
    ds_read_b128 v[144:147], v9 offset:10560
    v_smfmac_f32_16x16x64_bf16 v[180:183], a[200:203], v[196:203], v34 abid:1
    ds_read_b128 v[148:151], v9 offset:10624
    ds_read_b128 v[140:143], v9 offset:10496
    v_add_u32 v4, s31, v4
    v_smfmac_f32_16x16x64_bf16 v[180:183], a[236:239], v[204:211], v38 abid:1
    v_add_u32 v1, s31, v1
    v_smfmac_f32_16x16x64_bf16 v[184:187], a[204:207], v[196:203], v35
    v_add_u32 v2, s31, v2
    v_smfmac_f32_16x16x64_bf16 v[184:187], a[240:243], v[204:211], v39
    v_smfmac_f32_16x16x64_bf16 v[188:191], a[208:211], v[196:203], v35 abid:1
    v_smfmac_f32_16x16x64_bf16 v[188:191], a[244:247], v[204:211], v39 abid:1
    v_smfmac_f32_16x16x64_bf16 v[192:195], a[212:215], v[196:203], v50 abid:1
    v_smfmac_f32_16x16x64_bf16 v[192:195], a[248:251], v[204:211], v51
    s_branch M_top
M_bF:
    v_smfmac_f32_16x16x64_bf16 v[164:167], v[56:59], v[220:227], v40 abid:1
    ds_read_b128 v[204:207], v1 offset:1024
    v_smfmac_f32_16x16x64_bf16 v[164:167], v[92:95], v[228:235], v44 abid:1
    ds_read_b128 v[208:211], v2 offset:1024
    v_smfmac_f32_16x16x64_bf16 v[168:171], v[60:63], v[220:227], v41
    ds_read_b128 v[212:215], v1 offset:2048
    v_smfmac_f32_16x16x64_bf16 v[168:171], v[96:99], v[228:235], v45
    ds_read_b128 v[216:219], v2 offset:2048
    v_smfmac_f32_16x16x64_bf16 v[172:175], v[64:67], v[220:227], v41 abid:1
    s_waitcnt lgkmcnt(6)
    buffer_store_dwordx4 v[244:247], v7, s[12:15], s66 offen sc1
    v_smfmac_f32_16x16x64_bf16 v[172:175], v[100:103], v[228:235], v45 abid:1
    ds_read_b128 v[236:239], v9 offset:9408
    v_smfmac_f32_16x16x64_bf16 v[176:179], v[68:71], v[220:227], v42
    s_mov_b32 s21, 3
    v_smfmac_f32_16x16x64_bf16 v[176:179], v[104:107], v[228:235], v46
    v_smfmac_f32_16x16x64_bf16 v[180:183], v[72:75], v[220:227], v42 abid:1
    v_cvt_pk_bf16_f32 v160, v160, v161
    v_smfmac_f32_16x16x64_bf16 v[180:183], v[108:111], v[228:235], v46 abid:1
    v_cvt_pk_bf16_f32 v161, v162, v163
    v_smfmac_f32_16x16x64_bf16 v[184:187], v[76:79], v[220:227], v43
    v_cvt_pk_bf16_f32 v162, v164, v165
    v_smfmac_f32_16x16x64_bf16 v[184:187], v[112:115], v[228:235], v47
    v_cvt_pk_bf16_f32 v163, v166, v167
    v_smfmac_f32_16x16x64_bf16 v[188:191], v[80:83], v[220:227], v43 abid:1
    v_cvt_pk_bf16_f32 v168, v168, v169
    v_smfmac_f32_16x16x64_bf16 v[188:191], v[116:119], v[228:235], v47 abid:1
    v_cvt_pk_bf16_f32 v169, v170, v171
    v_smfmac_f32_16x16x64_bf16 v[192:195], v[84:87], v[220:227], v51 abid:1
    v_cvt_pk_bf16_f32 v170, v172, v173
    v_smfmac_f32_16x16x64_bf16 v[192:195], v[120:123], v[228:235], v52
    ds_read_b128 v[220:223], v1 offset:3072
    s_waitcnt lgkmcnt(6)
    v_cvt_pk_bf16_f32 v171, v174, v175
    v_smfmac_f32_16x16x64_bf16 v[124:127], a[0:3], v[196:203], v12
    ds_read_b128 v[224:227], v2 offset:3072
    ds_read_b128 v[172:175], v9 offset:10432
    s_waitcnt lgkmcnt(6)
    v_cndmask_b32_dpp v164, v160, v168, vcc row_ror:8 row_mask:0xf bank_mask:0xf
    v_smfmac_f32_16x16x64_bf16 v[124:127], a[36:39], v[204:211], v16
    ds_read_b128 v[228:231], v1 offset:4096
    s_waitcnt lgkmcnt(5)
    v_cndmask_b32_dpp v165, v161, v169, vcc row_ror:8 row_mask:0xf bank_mask:0xf
    v_smfmac_f32_16x16x64_bf16 v[124:127], a[72:75], v[212:219], v20
    ds_read_b128 v[232:235], v2 offset:4096
    s_waitcnt lgkmcnt(5)
    v_xad_u32 v236, v236, v3, v4
    v_smfmac_f32_16x16x64_bf16 v[128:131], a[4:7], v[196:203], v12 abid:1
    s_barrier
    v_xad_u32 v237, v237, v3, v4
    v_smfmac_f32_16x16x64_bf16 v[128:131], a[40:43], v[204:211], v16 abid:1
    ds_read2st64_b32 v[244:245], v236 offset0:0 offset1:72
    ds_read_b128 v[240:243], v8 offset:3072
    v_xad_u32 v238, v238, v3, v4
    v_smfmac_f32_16x16x64_bf16 v[128:131], a[76:79], v[212:219], v20 abid:1
    ds_read2st64_b32 v[246:247], v237 offset0:0 offset1:72
    v_xad_u32 v239, v239, v3, v4
    v_smfmac_f32_16x16x64_bf16 v[132:135], a[8:11], v[196:203], v13
    ds_read2st64_b32 v[248:249], v238 offset0:0 offset1:72
    v_cndmask_b32_dpp v166, v162, v170, vcc row_ror:8 row_mask:0xf bank_mask:0xf
    v_smfmac_f32_16x16x64_bf16 v[132:135], a[44:47], v[204:211], v17
    ds_read2st64_b32 v[250:251], v239 offset0:0 offset1:72
    ds_read_b128 v[236:239], v9 offset:9280
    v_cndmask_b32_dpp v167, v163, v171, vcc row_ror:8 row_mask:0xf bank_mask:0xf
    v_smfmac_f32_16x16x64_bf16 v[132:135], a[80:83], v[212:219], v21
    buffer_store_dwordx4 v[164:167], v6, s[12:15], s58 offen offset:0 sc1
    v_mov_b32_dpp v160, v168 row_ror:8 row_mask:0xf bank_mask:0xc
    v_smfmac_f32_16x16x64_bf16 v[136:139], a[12:15], v[196:203], v13 abid:1
    v_mov_b32_dpp v161, v169 row_ror:8 row_mask:0xf bank_mask:0xc
    v_smfmac_f32_16x16x64_bf16 v[136:139], a[48:51], v[204:211], v17 abid:1
    v_mov_b32_dpp v162, v170 row_ror:8 row_mask:0xf bank_mask:0xc
    v_smfmac_f32_16x16x64_bf16 v[136:139], a[84:87], v[212:219], v21 abid:1
    v_mov_b32_dpp v163, v171 row_ror:8 row_mask:0xf bank_mask:0xc
    v_smfmac_f32_16x16x64_bf16 v[140:143], a[16:19], v[196:203], v14
    buffer_store_dwordx4 v[160:163], v6, s[12:15], s23 offen offset:0 sc1
    ds_read_b128 v[164:167], v9 offset:10304
    ds_read_b128 v[168:171], v9 offset:10368
    v_smfmac_f32_16x16x64_bf16 v[140:143], a[52:55], v[204:211], v18
    ds_read_b128 v[160:163], v9 offset:10240
    v_smfmac_f32_16x16x64_bf16 v[140:143], a[88:91], v[212:219], v22
    s_waitcnt lgkmcnt(3)
    v_xad_u32 v236, v236, v3, v4
    v_smfmac_f32_16x16x64_bf16 v[136:139], v[240:243], v[244:251], v10
    v_xad_u32 v237, v237, v3, v4
    v_smfmac_f32_16x16x64_bf16 v[172:175], v[240:243], v[244:251], v10 abid:1
    ds_read2st64_b32 v[244:245], v236 offset0:0 offset1:72
    ds_read_b128 v[240:243], v8 offset:1024
    v_xad_u32 v238, v238, v3, v4
    v_smfmac_f32_16x16x64_bf16 v[144:147], a[20:23], v[196:203], v14 abid:1
    ds_read2st64_b32 v[246:247], v237 offset0:0 offset1:72
    v_xad_u32 v239, v239, v3, v4
    v_smfmac_f32_16x16x64_bf16 v[144:147], a[56:59], v[204:211], v18 abid:1
    ds_read2st64_b32 v[248:249], v238 offset0:0 offset1:72
    v_smfmac_f32_16x16x64_bf16 v[144:147], a[92:95], v[212:219], v22 abid:1
    ds_read2st64_b32 v[250:251], v239 offset0:0 offset1:72
    ds_read_b128 v[236:239], v9 offset:9344
    v_smfmac_f32_16x16x64_bf16 v[148:151], a[24:27], v[196:203], v15
    v_cvt_pk_bf16_f32 v192, v192, v193
    v_smfmac_f32_16x16x64_bf16 v[148:151], a[60:63], v[204:211], v19
    v_cvt_pk_bf16_f32 v193, v194, v195
    v_smfmac_f32_16x16x64_bf16 v[148:151], a[96:99], v[212:219], v23
    ds_write_b64 v53, v[192:193] offset:0
    ds_read_b128 v[192:195], v9 offset:10752
    v_smfmac_f32_16x16x64_bf16 v[152:155], a[28:31], v[196:203], v15 abid:1
    v_smfmac_f32_16x16x64_bf16 v[152:155], a[64:67], v[204:211], v19 abid:1
    v_smfmac_f32_16x16x64_bf16 v[152:155], a[100:103], v[212:219], v23 abid:1
    v_smfmac_f32_16x16x64_bf16 v[156:159], a[32:35], v[196:203], v48
    v_smfmac_f32_16x16x64_bf16 v[156:159], a[68:71], v[204:211], v48 abid:1
    v_smfmac_f32_16x16x64_bf16 v[156:159], a[104:107], v[212:219], v49
    s_waitcnt lgkmcnt(2)
    v_xad_u32 v236, v236, v3, v4
    v_smfmac_f32_16x16x64_bf16 v[128:131], v[240:243], v[244:251], v10
    ds_read_b128 v[196:199], v1 offset:5120
    v_xad_u32 v237, v237, v3, v4
    v_smfmac_f32_16x16x64_bf16 v[164:167], v[240:243], v[244:251], v10 abid:1
    ds_read2st64_b32 v[244:245], v236 offset0:0 offset1:72
    ds_read_b128 v[240:243], v8 offset:2048
    v_xad_u32 v238, v238, v3, v4
    v_smfmac_f32_16x16x64_bf16 v[124:127], a[108:111], v[220:227], v24
    ds_read2st64_b32 v[246:247], v237 offset0:0 offset1:72
    v_xad_u32 v239, v239, v3, v4
    v_smfmac_f32_16x16x64_bf16 v[124:127], a[144:147], v[228:235], v28
    ds_read2st64_b32 v[248:249], v238 offset0:0 offset1:72
    ds_read_b128 v[200:203], v2 offset:5120
    v_cvt_pk_bf16_f32 v176, v176, v177
    v_smfmac_f32_16x16x64_bf16 v[128:131], a[112:115], v[220:227], v24 abid:1
    ds_read2st64_b32 v[250:251], v239 offset0:0 offset1:72
    ds_read_b128 v[236:239], v9 offset:9216
    v_cvt_pk_bf16_f32 v177, v178, v179
    v_smfmac_f32_16x16x64_bf16 v[128:131], a[148:151], v[228:235], v28 abid:1
    ds_read_b128 v[204:207], v1 offset:6144
    ds_read_b64 v[216:217], v9 offset:10056
    v_cvt_pk_bf16_f32 v178, v180, v181
    v_smfmac_f32_16x16x64_bf16 v[132:135], a[116:119], v[220:227], v25
    ds_read_b128 v[208:211], v2 offset:6144
    v_cvt_pk_bf16_f32 v179, v182, v183
    v_smfmac_f32_16x16x64_bf16 v[132:135], a[152:155], v[228:235], v29
    v_cvt_pk_bf16_f32 v184, v184, v185
    v_smfmac_f32_16x16x64_bf16 v[136:139], a[120:123], v[220:227], v25 abid:1
    v_cvt_pk_bf16_f32 v185, v186, v187
    v_smfmac_f32_16x16x64_bf16 v[136:139], a[156:159], v[228:235], v29 abid:1
    v_cvt_pk_bf16_f32 v186, v188, v189
    v_smfmac_f32_16x16x64_bf16 v[140:143], a[124:127], v[220:227], v26
    v_cvt_pk_bf16_f32 v187, v190, v191
    v_smfmac_f32_16x16x64_bf16 v[140:143], a[160:163], v[228:235], v30
    ds_read_b128 v[188:191], v9 offset:10688
    s_waitcnt lgkmcnt(4)
    v_xad_u32 v236, v236, v3, v4
    v_smfmac_f32_16x16x64_bf16 v[132:135], v[240:243], v[244:251], v10
    v_xad_u32 v237, v237, v3, v4
    v_smfmac_f32_16x16x64_bf16 v[168:171], v[240:243], v[244:251], v10 abid:1
    ds_read2st64_b32 v[244:245], v236 offset0:0 offset1:72
    ds_read_b128 v[240:243], v8 offset:0
    v_xad_u32 v238, v238, v3, v4
    v_smfmac_f32_16x16x64_bf16 v[144:147], a[128:131], v[220:227], v26 abid:1
    ds_read2st64_b32 v[246:247], v237 offset0:0 offset1:72
    v_xad_u32 v239, v239, v3, v4
    v_smfmac_f32_16x16x64_bf16 v[144:147], a[164:167], v[228:235], v30 abid:1
    ds_read2st64_b32 v[248:249], v238 offset0:0 offset1:72
    v_cndmask_b32_dpp v180, v176, v184, vcc row_ror:8 row_mask:0xf bank_mask:0xf
    v_smfmac_f32_16x16x64_bf16 v[148:151], a[132:135], v[220:227], v27
    ds_read2st64_b32 v[250:251], v239 offset0:0 offset1:72
    ds_read_b128 v[236:239], v9 offset:9728
    v_cndmask_b32_dpp v181, v177, v185, vcc row_ror:8 row_mask:0xf bank_mask:0xf
    v_smfmac_f32_16x16x64_bf16 v[148:151], a[168:171], v[228:235], v31
    v_cndmask_b32_dpp v182, v178, v186, vcc row_ror:8 row_mask:0xf bank_mask:0xf
    v_smfmac_f32_16x16x64_bf16 v[152:155], a[136:139], v[220:227], v27 abid:1
    v_cndmask_b32_dpp v183, v179, v187, vcc row_ror:8 row_mask:0xf bank_mask:0xf
    v_smfmac_f32_16x16x64_bf16 v[152:155], a[172:175], v[228:235], v31 abid:1
    buffer_store_dwordx4 v[180:183], v6, s[12:15], s58 offen offset:128 sc1
    v_mov_b32_dpp v176, v184 row_ror:8 row_mask:0xf bank_mask:0xc
    v_smfmac_f32_16x16x64_bf16 v[156:159], a[140:143], v[220:227], v49 abid:1
    v_mov_b32_dpp v177, v185 row_ror:8 row_mask:0xf bank_mask:0xc
    v_smfmac_f32_16x16x64_bf16 v[156:159], a[176:179], v[228:235], v50
    ds_read_b128 v[220:223], v1 offset:7168
    v_mov_b32_dpp v178, v186 row_ror:8 row_mask:0xf bank_mask:0xc
    v_smfmac_f32_16x16x64_bf16 v[124:127], a[180:183], v[196:203], v32
    ds_read_b128 v[224:227], v2 offset:7168
    s_waitcnt lgkmcnt(9)
    v_mov_b32_dpp v179, v187 row_ror:8 row_mask:0xf bank_mask:0xc
    v_smfmac_f32_16x16x64_bf16 v[124:127], a[216:219], v[204:211], v36
    ds_read_b128 v[228:231], v1 offset:8192
    buffer_store_dwordx4 v[176:179], v6, s[12:15], s23 offen offset:128 sc1
    ds_read_b128 v[180:183], v9 offset:10560
    v_smfmac_f32_16x16x64_bf16 v[128:131], a[184:187], v[196:203], v32 abid:1
    ds_read_b128 v[232:235], v2 offset:8192
    ds_read_b128 v[184:187], v9 offset:10624
    ds_read_b128 v[176:179], v9 offset:10496
    v_smfmac_f32_16x16x64_bf16 v[128:131], a[220:223], v[204:211], v36 abid:1
    s_waitcnt lgkmcnt(7)
    v_xad_u32 v236, v236, v3, v4
    v_smfmac_f32_16x16x64_bf16 v[124:127], v[240:243], v[244:251], v10
    v_xad_u32 v237, v237, v3, v4
    v_smfmac_f32_16x16x64_bf16 v[160:163], v[240:243], v[244:251], v10 abid:1
    ds_read2st64_b32 v[244:245], v236 offset0:0 offset1:72
    ds_read_b128 v[240:243], v8 offset:8192
    v_xad_u32 v238, v238, v3, v4
    v_smfmac_f32_16x16x64_bf16 v[132:135], a[188:191], v[196:203], v33
    ds_read2st64_b32 v[246:247], v237 offset0:0 offset1:72
    v_xad_u32 v239, v239, v3, v4
    v_smfmac_f32_16x16x64_bf16 v[132:135], a[224:227], v[204:211], v37
    ds_read2st64_b32 v[248:249], v238 offset0:0 offset1:72
    v_xad_u32 v212, v216, v3, v4
    v_smfmac_f32_16x16x64_bf16 v[136:139], a[192:195], v[196:203], v33 abid:1
    ds_read2st64_b32 v[250:251], v239 offset0:0 offset1:72
    ds_read_b128 v[236:239], v9 offset:9664
    ds_read2st64_b32 v[212:213], v212 offset0:0 offset1:72
    v_smfmac_f32_16x16x64_bf16 v[136:139], a[228:231], v[204:211], v37 abid:1
    v_xad_u32 v214, v217, v3, v4
    v_smfmac_f32_16x16x64_bf16 v[140:143], a[196:199], v[196:203], v34
    ds_read2st64_b32 v[214:215], v214 offset0:0 offset1:72
    v_smfmac_f32_16x16x64_bf16 v[140:143], a[232:235], v[204:211], v38
    v_smfmac_f32_16x16x64_bf16 v[144:147], a[200:203], v[196:203], v34 abid:1
    v_smfmac_f32_16x16x64_bf16 v[144:147], a[236:239], v[204:211], v38 abid:1
    v_smfmac_f32_16x16x64_bf16 v[148:151], a[204:207], v[196:203], v35
    v_smfmac_f32_16x16x64_bf16 v[148:151], a[240:243], v[204:211], v39
    s_waitcnt lgkmcnt(2)
    v_xad_u32 v236, v236, v3, v4
    v_smfmac_f32_16x16x64_bf16 v[156:159], v[240:243], v[244:251], v10
    v_xad_u32 v237, v237, v3, v4
    v_smfmac_f32_16x16x64_bf16 v[192:195], v[240:243], v[244:251], v10 abid:1
    ds_read2st64_b32 v[244:245], v236 offset0:0 offset1:72
    ds_read_b128 v[240:243], v8 offset:7168
    v_xad_u32 v238, v238, v3, v4
    v_smfmac_f32_16x16x64_bf16 v[152:155], a[208:211], v[196:203], v35 abid:1
    ds_read2st64_b32 v[246:247], v237 offset0:0 offset1:72
    v_xad_u32 v239, v239, v3, v4
    v_smfmac_f32_16x16x64_bf16 v[152:155], a[244:247], v[204:211], v39 abid:1
    ds_read2st64_b32 v[248:249], v238 offset0:0 offset1:72
    v_smfmac_f32_16x16x64_bf16 v[156:159], a[212:215], v[196:203], v50 abid:1
    ds_read2st64_b32 v[250:251], v239 offset0:0 offset1:72
    ds_read_b128 v[236:239], v9 offset:9536
    v_smfmac_f32_16x16x64_bf16 v[156:159], a[248:251], v[204:211], v51
    ds_read_b128 v[196:199], v1 offset:18432
    v_smfmac_f32_16x16x64_bf16 v[124:127], a[252:255], v[220:227], v40
    ds_read_b128 v[200:203], v2 offset:18432
    v_smfmac_f32_16x16x64_bf16 v[124:127], v[88:91], v[228:235], v44
    ds_read_b128 v[204:207], v1 offset:19456
    v_smfmac_f32_16x16x64_bf16 v[128:131], v[56:59], v[220:227], v40 abid:1
    ds_read_b128 v[208:211], v2 offset:19456
    v_smfmac_f32_16x16x64_bf16 v[128:131], v[92:95], v[228:235], v44 abid:1
    s_waitcnt lgkmcnt(10)
    s_cmp_lt_i32 s81, 0
    s_cbranch_scc1 M_ovrF
    s_swappc_b64 s[78:79], s[72:73]
M_ovrF:
    v_smfmac_f32_16x16x64_bf16 v[132:135], v[60:63], v[220:227], v41
    s_cmp_lt_u32 s20, 2
    s_cselect_b32 s66, s23, s24
    s_add_u32 s66, s66, s95
    v_smfmac_f32_16x16x64_bf16 v[132:135], v[96:99], v[228:235], v45
    s_add_u32 s23, s24, 18432
    s_add_u32 s58, s24, 27648
    s_add_u32 s67, s23, s95
    v_smfmac_f32_16x16x64_bf16 v[136:139], v[64:67], v[220:227], v41 abid:1
    v_smfmac_f32_16x16x64_bf16 v[136:139], v[100:103], v[228:235], v45 abid:1
    s_waitcnt lgkmcnt(4)
    v_xad_u32 v236, v236, v3, v4
    v_smfmac_f32_16x16x64_bf16 v[152:155], v[240:243], v[244:251], v10
    v_xad_u32 v237, v237, v3, v4
    v_smfmac_f32_16x16x64_bf16 v[188:191], v[240:243], v[244:251], v10 abid:1
    s_cmp_gt_u32 s46, s80
    s_cbranch_scc1 M_slow
M_slowrF:
    v_xad_u32 v238, v238, v3, v4
    v_smfmac_f32_16x16x64_bf16 v[140:143], v[68:71], v[220:227], v42
    ds_read2st64_b32 v[244:245], v236 offset0:0 offset1:72
    ds_read_b128 v[240:243], v8 offset:5120
    v_xad_u32 v239, v239, v3, v4
    v_smfmac_f32_16x16x64_bf16 v[140:143], v[104:107], v[228:235], v46
    ds_read2st64_b32 v[246:247], v237 offset0:0 offset1:72
    v_smfmac_f32_16x16x64_bf16 v[144:147], v[72:75], v[220:227], v42 abid:1
    ds_read2st64_b32 v[248:249], v238 offset0:0 offset1:72
    ds_read_b128 v[212:215], v1 offset:20480
    v_smfmac_f32_16x16x64_bf16 v[144:147], v[108:111], v[228:235], v46 abid:1
    ds_read2st64_b32 v[250:251], v239 offset0:0 offset1:72
    ds_read_b128 v[236:239], v9 offset:9600
    v_smfmac_f32_16x16x64_bf16 v[148:151], v[76:79], v[220:227], v43
    ds_read_b128 v[216:219], v2 offset:20480
    v_smfmac_f32_16x16x64_bf16 v[148:151], v[112:115], v[228:235], v47
    v_smfmac_f32_16x16x64_bf16 v[152:155], v[80:83], v[220:227], v43 abid:1
    v_smfmac_f32_16x16x64_bf16 v[152:155], v[116:119], v[228:235], v47 abid:1
    v_smfmac_f32_16x16x64_bf16 v[156:159], v[84:87], v[220:227], v51 abid:1
    v_smfmac_f32_16x16x64_bf16 v[156:159], v[120:123], v[228:235], v52
    ds_read_b128 v[220:223], v1 offset:21504
    s_waitcnt lgkmcnt(2)
    v_xad_u32 v236, v236, v3, v4
    v_smfmac_f32_16x16x64_bf16 v[144:147], v[240:243], v[244:251], v10
    ds_read_b128 v[224:227], v2 offset:21504
    v_xad_u32 v237, v237, v3, v4
    v_smfmac_f32_16x16x64_bf16 v[180:183], v[240:243], v[244:251], v10 abid:1
    ds_read2st64_b32 v[244:245], v236 offset0:0 offset1:72
    ds_read_b128 v[240:243], v8 offset:6144
    v_xad_u32 v238, v238, v3, v4
    v_smfmac_f32_16x16x64_bf16 v[192:195], a[32:35], v[196:203], v48
    ds_read2st64_b32 v[246:247], v237 offset0:0 offset1:72
    ds_read_b128 v[228:231], v1 offset:22528
    v_xad_u32 v239, v239, v3, v4
    v_smfmac_f32_16x16x64_bf16 v[192:195], a[68:71], v[204:211], v48 abid:1
    ds_read2st64_b32 v[248:249], v238 offset0:0 offset1:72
    ds_read_b128 v[232:235], v2 offset:22528
    s_waitcnt lgkmcnt(8)
    v_cvt_pk_bf16_f32 v124, v124, v125
    v_smfmac_f32_16x16x64_bf16 v[192:195], a[104:107], v[212:219], v49
    ds_read2st64_b32 v[250:251], v239 offset0:0 offset1:72
    ds_read_b128 v[236:239], v9 offset:9472
    v_cvt_pk_bf16_f32 v125, v126, v127
    v_smfmac_f32_16x16x64_bf16 v[160:163], a[0:3], v[196:203], v12
    v_cvt_pk_bf16_f32 v126, v128, v129
    v_smfmac_f32_16x16x64_bf16 v[160:163], a[36:39], v[204:211], v16
    v_cvt_pk_bf16_f32 v127, v130, v131
    v_smfmac_f32_16x16x64_bf16 v[160:163], a[72:75], v[212:219], v20
    v_cvt_pk_bf16_f32 v156, v156, v157
    v_smfmac_f32_16x16x64_bf16 v[164:167], a[4:7], v[196:203], v12 abid:1
    v_cvt_pk_bf16_f32 v157, v158, v159
    v_smfmac_f32_16x16x64_bf16 v[164:167], a[40:43], v[204:211], v16 abid:1
    ds_write_b64 v53, v[156:157] offset:25728
    v_cvt_pk_bf16_f32 v132, v132, v133
    v_smfmac_f32_16x16x64_bf16 v[164:167], a[76:79], v[212:219], v20 abid:1
    v_cvt_pk_bf16_f32 v133, v134, v135
    v_smfmac_f32_16x16x64_bf16 v[168:171], a[8:11], v[196:203], v13
    v_cvt_pk_bf16_f32 v134, v136, v137
    v_smfmac_f32_16x16x64_bf16 v[168:171], a[44:47], v[204:211], v17
    v_cvt_pk_bf16_f32 v135, v138, v139
    v_smfmac_f32_16x16x64_bf16 v[168:171], a[80:83], v[212:219], v21
    s_waitcnt lgkmcnt(1)
    v_xad_u32 v236, v236, v3, v4
    v_smfmac_f32_16x16x64_bf16 v[148:151], v[240:243], v[244:251], v10
    v_xad_u32 v237, v237, v3, v4
    v_smfmac_f32_16x16x64_bf16 v[184:187], v[240:243], v[244:251], v10 abid:1
    ds_read2st64_b32 v[244:245], v236 offset0:0 offset1:72
    ds_read_b128 v[240:243], v8 offset:4096
    v_xad_u32 v238, v238, v3, v4
    v_smfmac_f32_16x16x64_bf16 v[172:175], a[12:15], v[196:203], v13 abid:1
    ds_read2st64_b32 v[246:247], v237 offset0:0 offset1:72
    v_xad_u32 v239, v239, v3, v4
    v_smfmac_f32_16x16x64_bf16 v[172:175], a[48:51], v[204:211], v17 abid:1
    ds_read2st64_b32 v[248:249], v238 offset0:0 offset1:72
    v_cndmask_b32_dpp v128, v124, v132, vcc row_ror:8 row_mask:0xf bank_mask:0xf
    v_smfmac_f32_16x16x64_bf16 v[172:175], a[84:87], v[212:219], v21 abid:1
    ds_read2st64_b32 v[250:251], v239 offset0:0 offset1:72
    ds_read_b128 v[196:199], v1 offset:23552
    v_cndmask_b32_dpp v129, v125, v133, vcc row_ror:8 row_mask:0xf bank_mask:0xf
    v_smfmac_f32_16x16x64_bf16 v[192:195], a[140:143], v[220:227], v49 abid:1
    ds_read_b128 v[200:203], v2 offset:23552
    v_cndmask_b32_dpp v130, v126, v134, vcc row_ror:8 row_mask:0xf bank_mask:0xf
    v_smfmac_f32_16x16x64_bf16 v[192:195], a[176:179], v[228:235], v50
    ds_read_b128 v[204:207], v1 offset:24576
    v_cndmask_b32_dpp v131, v127, v135, vcc row_ror:8 row_mask:0xf bank_mask:0xf
    v_smfmac_f32_16x16x64_bf16 v[160:163], a[108:111], v[220:227], v24
    ds_read_b128 v[208:211], v2 offset:24576
    buffer_store_dwordx4 v[128:131], v6, s[12:15], s59 offen offset:0 sc1
    v_mov_b32_dpp v124, v132 row_ror:8 row_mask:0xf bank_mask:0xc
    v_smfmac_f32_16x16x64_bf16 v[160:163], a[144:147], v[228:235], v28
    s_waitcnt lgkmcnt(9)
    s_barrier
    ds_read_b128 v[236:239], v8 offset:10816
    v_mov_b32_dpp v125, v133 row_ror:8 row_mask:0xf bank_mask:0xc
    v_smfmac_f32_16x16x64_bf16 v[164:167], a[112:115], v[220:227], v24 abid:1
    ds_read_b128 v[212:215], v1 offset:20480
    v_mov_b32_dpp v126, v134 row_ror:8 row_mask:0xf bank_mask:0xc
    v_smfmac_f32_16x16x64_bf16 v[164:167], a[148:151], v[228:235], v28 abid:1
    ds_read_b128 v[216:219], v2 offset:20480
    v_mov_b32_dpp v127, v135 row_ror:8 row_mask:0xf bank_mask:0xc
    v_smfmac_f32_16x16x64_bf16 v[168:171], a[116:119], v[220:227], v25
    buffer_store_dwordx4 v[124:127], v6, s[12:15], s24 offen offset:0 sc1
    v_smfmac_f32_16x16x64_bf16 v[168:171], a[152:155], v[228:235], v29
    s_waitcnt lgkmcnt(7)
    v_smfmac_f32_16x16x64_bf16 v[140:143], v[240:243], v[244:251], v10
    v_smfmac_f32_16x16x64_bf16 v[176:179], v[240:243], v[244:251], v10 abid:1
    s_waitcnt lgkmcnt(2)
    buffer_store_dwordx4 v[236:239], v7, s[12:15], s66 offen sc1
    v_smfmac_f32_16x16x64_bf16 v[172:175], a[120:123], v[220:227], v25 abid:1
    v_smfmac_f32_16x16x64_bf16 v[172:175], a[156:159], v[228:235], v29 abid:1
    ds_read_b128 v[220:223], v1 offset:25600
    v_smfmac_f32_16x16x64_bf16 v[192:195], a[212:215], v[196:203], v50 abid:1
    ds_read_b128 v[224:227], v2 offset:25600
    v_cvt_pk_bf16_f32 v140, v140, v141
    v_smfmac_f32_16x16x64_bf16 v[192:195], a[248:251], v[204:211], v51
    ds_read_b128 v[228:231], v1 offset:26624
    v_cvt_pk_bf16_f32 v141, v142, v143
    v_smfmac_f32_16x16x64_bf16 v[160:163], a[180:183], v[196:203], v32
    ds_read_b128 v[232:235], v2 offset:26624
    v_cvt_pk_bf16_f32 v142, v144, v145
    v_smfmac_f32_16x16x64_bf16 v[160:163], a[216:219], v[204:211], v36
    v_cvt_pk_bf16_f32 v143, v146, v147
    v_smfmac_f32_16x16x64_bf16 v[164:167], a[184:187], v[196:203], v32 abid:1
    v_cvt_pk_bf16_f32 v148, v148, v149
    v_smfmac_f32_16x16x64_bf16 v[164:167], a[220:223], v[204:211], v36 abid:1
    v_cvt_pk_bf16_f32 v149, v150, v151
    v_smfmac_f32_16x16x64_bf16 v[168:171], a[188:191], v[196:203], v33
    v_cvt_pk_bf16_f32 v150, v152, v153
    v_smfmac_f32_16x16x64_bf16 v[168:171], a[224:227], v[204:211], v37
    v_cvt_pk_bf16_f32 v151, v154, v155
    v_smfmac_f32_16x16x64_bf16 v[172:175], a[192:195], v[196:203], v33 abid:1
    v_cndmask_b32_dpp v144, v140, v148, vcc row_ror:8 row_mask:0xf bank_mask:0xf
    v_smfmac_f32_16x16x64_bf16 v[172:175], a[228:231], v[204:211], v37 abid:1
    ds_read_b128 v[196:199], v1 offset:18432
    s_waitcnt lgkmcnt(3)
    v_cndmask_b32_dpp v145, v141, v149, vcc row_ror:8 row_mask:0xf bank_mask:0xf
    v_smfmac_f32_16x16x64_bf16 v[192:195], v[84:87], v[220:227], v51 abid:1
    ds_read_b128 v[200:203], v2 offset:18432
    s_waitcnt lgkmcnt(2)
    v_cndmask_b32_dpp v146, v142, v150, vcc row_ror:8 row_mask:0xf bank_mask:0xf
    v_smfmac_f32_16x16x64_bf16 v[192:195], v[120:123], v[228:235], v52
    ds_read_b128 v[204:207], v1 offset:19456
    v_cndmask_b32_dpp v147, v143, v151, vcc row_ror:8 row_mask:0xf bank_mask:0xf
    v_smfmac_f32_16x16x64_bf16 v[160:163], a[252:255], v[220:227], v40
    ds_read_b128 v[208:211], v2 offset:19456
    buffer_store_dwordx4 v[144:147], v6, s[12:15], s59 offen offset:128 sc1
    v_mov_b32_dpp v140, v148 row_ror:8 row_mask:0xf bank_mask:0xc
    v_smfmac_f32_16x16x64_bf16 v[160:163], v[88:91], v[228:235], v44
    v_mov_b32_dpp v141, v149 row_ror:8 row_mask:0xf bank_mask:0xc
    v_smfmac_f32_16x16x64_bf16 v[164:167], v[56:59], v[220:227], v40 abid:1
    v_mov_b32_dpp v142, v150 row_ror:8 row_mask:0xf bank_mask:0xc
    v_smfmac_f32_16x16x64_bf16 v[164:167], v[92:95], v[228:235], v44 abid:1
    v_mov_b32_dpp v143, v151 row_ror:8 row_mask:0xf bank_mask:0xc
    v_smfmac_f32_16x16x64_bf16 v[168:171], v[60:63], v[220:227], v41
    buffer_store_dwordx4 v[140:143], v6, s[12:15], s24 offen offset:128 sc1
    v_cvt_pk_bf16_f32 v192, v192, v193
    v_smfmac_f32_16x16x64_bf16 v[168:171], v[96:99], v[228:235], v45
    v_cvt_pk_bf16_f32 v193, v194, v195
    v_smfmac_f32_16x16x64_bf16 v[172:175], v[64:67], v[220:227], v41 abid:1
    ds_write_b64 v53, v[192:193] offset:1024
    v_smfmac_f32_16x16x64_bf16 v[172:175], v[100:103], v[228:235], v45 abid:1
    ds_read_b128 v[220:223], v1 offset:21504
    s_waitcnt lgkmcnt(4)
    v_smfmac_f32_16x16x64_bf16 v[176:179], a[16:19], v[196:203], v14
    ds_read_b128 v[224:227], v2 offset:21504
    s_waitcnt lgkmcnt(3)
    v_smfmac_f32_16x16x64_bf16 v[176:179], a[52:55], v[204:211], v18
    ds_read_b128 v[228:231], v1 offset:22528
    v_smfmac_f32_16x16x64_bf16 v[176:179], a[88:91], v[212:219], v22
    ds_read_b128 v[232:235], v2 offset:22528
    s_waitcnt lgkmcnt(4)
    s_barrier
    ds_read_b128 v[236:239], v8 offset:11840
    v_smfmac_f32_16x16x64_bf16 v[180:183], a[20:23], v[196:203], v14 abid:1
    v_cvt_pk_bf16_f32 v160, v160, v161
    v_smfmac_f32_16x16x64_bf16 v[180:183], a[56:59], v[204:211], v18 abid:1
    v_cvt_pk_bf16_f32 v161, v162, v163
    v_smfmac_f32_16x16x64_bf16 v[180:183], a[92:95], v[212:219], v22 abid:1
    v_cvt_pk_bf16_f32 v162, v164, v165
    v_smfmac_f32_16x16x64_bf16 v[184:187], a[24:27], v[196:203], v15
    v_cvt_pk_bf16_f32 v163, v166, v167
    v_smfmac_f32_16x16x64_bf16 v[184:187], a[60:63], v[204:211], v19
    v_cvt_pk_bf16_f32 v168, v168, v169
    v_smfmac_f32_16x16x64_bf16 v[184:187], a[96:99], v[212:219], v23
    s_cmp_lt_u32 s20, 2
    s_waitcnt lgkmcnt(0)
    s_cbranch_scc0 M_fx
    buffer_store_dwordx4 v[236:239], v7, s[12:15], s67 offen sc1
M_fx:
    v_smfmac_f32_16x16x64_bf16 v[188:191], a[28:31], v[196:203], v15 abid:1
    v_cvt_pk_bf16_f32 v169, v170, v171
    v_smfmac_f32_16x16x64_bf16 v[188:191], a[64:67], v[204:211], v19 abid:1
    v_cvt_pk_bf16_f32 v170, v172, v173
    v_smfmac_f32_16x16x64_bf16 v[188:191], a[100:103], v[212:219], v23 abid:1
    ds_read_b128 v[196:199], v1 offset:23552
    v_cvt_pk_bf16_f32 v171, v174, v175
    v_smfmac_f32_16x16x64_bf16 v[176:179], a[124:127], v[220:227], v26
    ds_read_b128 v[200:203], v2 offset:23552
    v_cndmask_b32_dpp v164, v160, v168, vcc row_ror:8 row_mask:0xf bank_mask:0xf
    v_smfmac_f32_16x16x64_bf16 v[176:179], a[160:163], v[228:235], v30
    ds_read_b128 v[204:207], v1 offset:24576
    v_cndmask_b32_dpp v165, v161, v169, vcc row_ror:8 row_mask:0xf bank_mask:0xf
    v_smfmac_f32_16x16x64_bf16 v[180:183], a[128:131], v[220:227], v26 abid:1
    ds_read_b128 v[208:211], v2 offset:24576
    v_cndmask_b32_dpp v166, v162, v170, vcc row_ror:8 row_mask:0xf bank_mask:0xf
    v_smfmac_f32_16x16x64_bf16 v[180:183], a[164:167], v[228:235], v30 abid:1
    v_cndmask_b32_dpp v167, v163, v171, vcc row_ror:8 row_mask:0xf bank_mask:0xf
    v_smfmac_f32_16x16x64_bf16 v[184:187], a[132:135], v[220:227], v27
    buffer_store_dwordx4 v[164:167], v6, s[12:15], s58 offen offset:0 sc1
    v_mov_b32_dpp v160, v168 row_ror:8 row_mask:0xf bank_mask:0xc
    v_smfmac_f32_16x16x64_bf16 v[184:187], a[168:171], v[228:235], v31
    v_mov_b32_dpp v161, v169 row_ror:8 row_mask:0xf bank_mask:0xc
    v_smfmac_f32_16x16x64_bf16 v[188:191], a[136:139], v[220:227], v27 abid:1
    v_mov_b32_dpp v162, v170 row_ror:8 row_mask:0xf bank_mask:0xc
    v_smfmac_f32_16x16x64_bf16 v[188:191], a[172:175], v[228:235], v31 abid:1
    ds_read_b128 v[220:223], v1 offset:25600
    s_waitcnt lgkmcnt(3)
    v_mov_b32_dpp v163, v171 row_ror:8 row_mask:0xf bank_mask:0xc
    v_smfmac_f32_16x16x64_bf16 v[176:179], a[196:199], v[196:203], v34
    ds_read_b128 v[224:227], v2 offset:25600
    buffer_store_dwordx4 v[160:163], v6, s[12:15], s23 offen offset:0 sc1
    s_waitcnt lgkmcnt(2)
    v_smfmac_f32_16x16x64_bf16 v[176:179], a[232:235], v[204:211], v38
    ds_read_b128 v[228:231], v1 offset:26624
    v_smfmac_f32_16x16x64_bf16 v[180:183], a[200:203], v[196:203], v34 abid:1
    ds_read_b128 v[232:235], v2 offset:26624
    v_smfmac_f32_16x16x64_bf16 v[180:183], a[236:239], v[204:211], v38 abid:1
    v_smfmac_f32_16x16x64_bf16 v[184:187], a[204:207], v[196:203], v35
    v_smfmac_f32_16x16x64_bf16 v[184:187], a[240:243], v[204:211], v39
    v_smfmac_f32_16x16x64_bf16 v[188:191], a[208:211], v[196:203], v35 abid:1
    v_smfmac_f32_16x16x64_bf16 v[188:191], a[244:247], v[204:211], v39 abid:1
    s_waitcnt lgkmcnt(2)
    v_smfmac_f32_16x16x64_bf16 v[176:179], v[68:71], v[220:227], v42
    s_waitcnt lgkmcnt(0)
    v_smfmac_f32_16x16x64_bf16 v[176:179], v[104:107], v[228:235], v46
    v_smfmac_f32_16x16x64_bf16 v[180:183], v[72:75], v[220:227], v42 abid:1
    v_smfmac_f32_16x16x64_bf16 v[180:183], v[108:111], v[228:235], v46 abid:1
    v_smfmac_f32_16x16x64_bf16 v[184:187], v[76:79], v[220:227], v43
    v_smfmac_f32_16x16x64_bf16 v[184:187], v[112:115], v[228:235], v47
    v_smfmac_f32_16x16x64_bf16 v[188:191], v[80:83], v[220:227], v43 abid:1
    v_smfmac_f32_16x16x64_bf16 v[188:191], v[116:119], v[228:235], v47 abid:1
    s_nop 1
    v_cvt_pk_bf16_f32 v176, v176, v177
    v_cvt_pk_bf16_f32 v177, v178, v179
    v_cvt_pk_bf16_f32 v178, v180, v181
    v_cvt_pk_bf16_f32 v179, v182, v183
    v_cvt_pk_bf16_f32 v184, v184, v185
    v_cvt_pk_bf16_f32 v185, v186, v187
    v_cvt_pk_bf16_f32 v186, v188, v189
    v_cvt_pk_bf16_f32 v187, v190, v191
    v_cndmask_b32_dpp v180, v176, v184, vcc row_ror:8 row_mask:0xf bank_mask:0xf
    v_cndmask_b32_dpp v181, v177, v185, vcc row_ror:8 row_mask:0xf bank_mask:0xf
    v_cndmask_b32_dpp v182, v178, v186, vcc row_ror:8 row_mask:0xf bank_mask:0xf
    v_cndmask_b32_dpp v183, v179, v187, vcc row_ror:8 row_mask:0xf bank_mask:0xf
    buffer_store_dwordx4 v[180:183], v6, s[12:15], s58 offen offset:128 sc1
    v_mov_b32_dpp v176, v184 row_ror:8 row_mask:0xf bank_mask:0xc
    v_mov_b32_dpp v177, v185 row_ror:8 row_mask:0xf bank_mask:0xc
    v_mov_b32_dpp v178, v186 row_ror:8 row_mask:0xf bank_mask:0xc
    v_mov_b32_dpp v179, v187 row_ror:8 row_mask:0xf bank_mask:0xc
    buffer_store_dwordx4 v[176:179], v6, s[12:15], s23 offen offset:128 sc1
M_end:
    s_endpgm
M_pf_spin:
    s_sleep 4
    v_mov_b32 v0, 0
    s_mov_b64 exec, 1
    buffer_atomic_add v0, off, s[16:19], s96 sc0 sc1
    s_mov_b64 exec, -1
    s_add_u32 s31, s31, 1
    s_waitcnt vmcnt(0)
    v_readfirstlane_b32 s30, v0
    s_nop 0
    s_sub_u32 s30, s30, s100
    s_cmp_eq_u32 s30, 27
    s_cbranch_scc1 M_pf_ok
    s_cmp_lt_u32 s31, 24
    s_cbranch_scc1 M_pf_spin
    s_cmp_eq_u32 s98, 0
    s_cbranch_scc1 M_pf_spin2
    s_mov_b32 s98, 0
    v_mov_b32 v250, 1
    s_mov_b64 exec, 1
    buffer_atomic_add v250, off, s[68:71], 0 offset:0 sc1
    s_mov_b64 exec, -1
    s_nop 3
M_pf_spin2:
    s_sleep 16
    buffer_load_dword v0, off, s[68:71], 0 offset:0 sc1
    s_add_u32 s31, s31, 1
    s_cmp_ge_u32 s31, 131072
    s_cbranch_scc1 M_end
    s_waitcnt vmcnt(0)
    v_readfirstlane_b32 s30, v0
    s_nop 0
    s_cmp_eq_u32 s30, 81
    s_cbranch_scc0 M_pf_spin2
    s_branch M_pf_ok
M_r3:
    v_bfe_u32 v74, v60, 24, 4
    v_lshlrev_b32 v75, 1, v60
    v_lshl_add_u32 v74, v74, 2, s49
    v_and_b32 v75, 16, v75
    v_and_or_b32 v74, v60, 2.0, v74
    v_lshlrev_b32 v75, v75, 1
    ds_add_rtn_u32 v70, v74, v75
    v_and_b32 v74, 8, v60
    v_lshrrev_b32 v77, 14, v60
    v_cmp_ne_u32 s[44:45], 0, v74
    v_and_b32 v80, 0x3cf0, v77
    s_waitcnt lgkmcnt(0)
    v_lshrrev_b32 v75, 16, v70
    v_and_b32 v76, 0xffff, v70
    v_sub_u32 v74, 15, v75
    v_and_b32 v70, 2.0, v60
    v_add3_u32 v70, v76, v75, v70
    v_cndmask_b32 v74, v76, v74, s[44:45]
    v_cmp_gt_u32 s[44:45], 16, v70
    v_cmp_gt_u32 s[36:37], 2.0, v70
    v_lshlrev_b32 v74, 2, v74
    v_lshrrev_b64 v[76:77], v74, s[50:51]
    s_andn2_b64 s[36:37], s[36:37], s[44:45]
    v_lshrrev_b64 v[78:79], v74, s[52:53]
    v_bfe_u32 v74, v60, 24, 4
    v_mbcnt_lo_u32_b32 v75, s36, 0
    v_and_b32 v76, 15, v76
    v_mbcnt_hi_u32_b32 v75, s37, v75
    v_and_b32 v78, 15, v78
    v_lshl_add_u32 v75, v75, 3, s40
    v_lshl_add_u32 v76, v74, 4, v76
    v_min_u32 v75, s41, v75
    v_mul_u32_u24 v78, 68, v78
    v_cndmask_b32 v75, v82, v75, s[36:37]
    ds_write_b64 v75, v[60:61]
    s_bcnt1_i32_b64 s30, s[36:37]
    s_lshl3_add_u32 s40, s30, s40
    v_lshl_add_u32 v76, v76, 2, s47
    v_and_b32 v78, 0x30c, v78
    v_cndmask_b32 v76, v82, v76, s[44:45]
    v_add3_u32 v77, v80, v78, s29
    v_and_b32 v78, 0x3fff, v60
    v_cndmask_b32 v74, v82, v77, s[44:45]
    ds_write_b32 v76, v78
    ds_write_b32 v74, v61
    s_cmp_gt_u32 s38, s39
    s_cselect_b32 s32, 1, s32
    s_branch M_r3r
M_dn:
    s_mov_b32 s27, 0
    s_mov_b32 s46, 0x80000000
    v_mov_b32 v244, 0
    v_mov_b32 v245, 0
    v_mov_b32 v246, 0
    v_mov_b32 v247, 0
    ds_write_b128 v8, v[244:247] offset:0
    ds_write_b128 v8, v[244:247] offset:1024
    ds_write_b128 v8, v[244:247] offset:2048
    ds_write_b128 v8, v[244:247] offset:3072
    ds_write_b128 v8, v[244:247] offset:4096
    ds_write_b128 v8, v[244:247] offset:5120
    ds_write_b128 v8, v[244:247] offset:6144
    ds_write_b128 v8, v[244:247] offset:7168
    ds_write_b128 v8, v[244:247] offset:8192
    s_waitcnt lgkmcnt(0)
    s_branch M_dnr
M_ovc0:
    v_smfmac_f32_16x16x32_bf16 v[124:127], v[54:55], v[212:215], v10
    v_smfmac_f32_16x16x32_bf16 v[160:163], v[54:55], v[212:215], v10 abid:2
    s_setpc_b64 s[74:75]
    v_smfmac_f32_16x16x32_bf16 v[128:131], v[54:55], v[212:215], v10
    v_smfmac_f32_16x16x32_bf16 v[164:167], v[54:55], v[212:215], v10 abid:2
    s_setpc_b64 s[74:75]
    v_smfmac_f32_16x16x32_bf16 v[132:135], v[54:55], v[212:215], v10
    v_smfmac_f32_16x16x32_bf16 v[168:171], v[54:55], v[212:215], v10 abid:2
    s_setpc_b64 s[74:75]
    v_smfmac_f32_16x16x32_bf16 v[136:139], v[54:55], v[212:215], v10
    v_smfmac_f32_16x16x32_bf16 v[172:175], v[54:55], v[212:215], v10 abid:2
    s_setpc_b64 s[74:75]
    v_smfmac_f32_16x16x32_bf16 v[140:143], v[54:55], v[212:215], v10
    v_smfmac_f32_16x16x32_bf16 v[176:179], v[54:55], v[212:215], v10 abid:2
    s_setpc_b64 s[74:75]
    v_smfmac_f32_16x16x32_bf16 v[144:147], v[54:55], v[212:215], v10
    v_smfmac_f32_16x16x32_bf16 v[180:183], v[54:55], v[212:215], v10 abid:2
    s_setpc_b64 s[74:75]
    v_smfmac_f32_16x16x32_bf16 v[148:151], v[54:55], v[212:215], v10
    v_smfmac_f32_16x16x32_bf16 v[184:187], v[54:55], v[212:215], v10 abid:2
    s_setpc_b64 s[74:75]
    v_smfmac_f32_16x16x32_bf16 v[152:155], v[54:55], v[212:215], v10
    v_smfmac_f32_16x16x32_bf16 v[188:191], v[54:55], v[212:215], v10 abid:2
    s_setpc_b64 s[74:75]
    v_smfmac_f32_16x16x32_bf16 v[156:159], v[54:55], v[212:215], v10
    v_smfmac_f32_16x16x32_bf16 v[192:195], v[54:55], v[212:215], v10 abid:2
    s_setpc_b64 s[74:75]
M_ovl0:
    v_smfmac_f32_16x16x32_bf16 v[124:127], v[54:55], v[212:215], v10
    v_smfmac_f32_16x16x32_bf16 v[160:163], v[54:55], v[212:215], v10 abid:2
    s_setpc_b64 s[78:79]
    v_smfmac_f32_16x16x32_bf16 v[128:131], v[54:55], v[212:215], v10
    v_smfmac_f32_16x16x32_bf16 v[164:167], v[54:55], v[212:215], v10 abid:2
    s_setpc_b64 s[78:79]
    v_smfmac_f32_16x16x32_bf16 v[132:135], v[54:55], v[212:215], v10
    v_smfmac_f32_16x16x32_bf16 v[168:171], v[54:55], v[212:215], v10 abid:2
    s_setpc_b64 s[78:79]
    v_smfmac_f32_16x16x32_bf16 v[136:139], v[54:55], v[212:215], v10
    v_smfmac_f32_16x16x32_bf16 v[172:175], v[54:55], v[212:215], v10 abid:2
    s_setpc_b64 s[78:79]
    v_smfmac_f32_16x16x32_bf16 v[140:143], v[54:55], v[212:215], v10
    v_smfmac_f32_16x16x32_bf16 v[176:179], v[54:55], v[212:215], v10 abid:2
    s_setpc_b64 s[78:79]
    v_smfmac_f32_16x16x32_bf16 v[144:147], v[54:55], v[212:215], v10
    v_smfmac_f32_16x16x32_bf16 v[180:183], v[54:55], v[212:215], v10 abid:2
    s_setpc_b64 s[78:79]
    v_smfmac_f32_16x16x32_bf16 v[148:151], v[54:55], v[212:215], v10
    v_smfmac_f32_16x16x32_bf16 v[184:187], v[54:55], v[212:215], v10 abid:2
    s_setpc_b64 s[78:79]
    v_smfmac_f32_16x16x32_bf16 v[152:155], v[54:55], v[212:215], v10
    v_smfmac_f32_16x16x32_bf16 v[188:191], v[54:55], v[212:215], v10 abid:2
    s_setpc_b64 s[78:79]
    v_smfmac_f32_16x16x32_bf16 v[156:159], v[54:55], v[212:215], v10
    v_smfmac_f32_16x16x32_bf16 v[192:195], v[54:55], v[212:215], v10 abid:2
    s_setpc_b64 s[78:79]
M_ovc1:
    v_smfmac_f32_16x16x32_bf16 v[124:127], v[252:253], v[212:215], v10
    v_smfmac_f32_16x16x32_bf16 v[160:163], v[252:253], v[212:215], v10 abid:2
    s_setpc_b64 s[76:77]
    v_smfmac_f32_16x16x32_bf16 v[128:131], v[252:253], v[212:215], v10
    v_smfmac_f32_16x16x32_bf16 v[164:167], v[252:253], v[212:215], v10 abid:2
    s_setpc_b64 s[76:77]
    v_smfmac_f32_16x16x32_bf16 v[132:135], v[252:253], v[212:215], v10
    v_smfmac_f32_16x16x32_bf16 v[168:171], v[252:253], v[212:215], v10 abid:2
    s_setpc_b64 s[76:77]
    v_smfmac_f32_16x16x32_bf16 v[136:139], v[252:253], v[212:215], v10
    v_smfmac_f32_16x16x32_bf16 v[172:175], v[252:253], v[212:215], v10 abid:2
    s_setpc_b64 s[76:77]
    v_smfmac_f32_16x16x32_bf16 v[140:143], v[252:253], v[212:215], v10
    v_smfmac_f32_16x16x32_bf16 v[176:179], v[252:253], v[212:215], v10 abid:2
    s_setpc_b64 s[76:77]
    v_smfmac_f32_16x16x32_bf16 v[144:147], v[252:253], v[212:215], v10
    v_smfmac_f32_16x16x32_bf16 v[180:183], v[252:253], v[212:215], v10 abid:2
    s_setpc_b64 s[76:77]
    v_smfmac_f32_16x16x32_bf16 v[148:151], v[252:253], v[212:215], v10
    v_smfmac_f32_16x16x32_bf16 v[184:187], v[252:253], v[212:215], v10 abid:2
    s_setpc_b64 s[76:77]
    v_smfmac_f32_16x16x32_bf16 v[152:155], v[252:253], v[212:215], v10
    v_smfmac_f32_16x16x32_bf16 v[188:191], v[252:253], v[212:215], v10 abid:2
    s_setpc_b64 s[76:77]
    v_smfmac_f32_16x16x32_bf16 v[156:159], v[252:253], v[212:215], v10
    v_smfmac_f32_16x16x32_bf16 v[192:195], v[252:253], v[212:215], v10 abid:2
    s_setpc_b64 s[76:77]
M_ovl1:
    v_smfmac_f32_16x16x32_bf16 v[124:127], v[252:253], v[212:215], v10
    v_smfmac_f32_16x16x32_bf16 v[160:163], v[252:253], v[212:215], v10 abid:2
    s_setpc_b64 s[78:79]
    v_smfmac_f32_16x16x32_bf16 v[128:131], v[252:253], v[212:215], v10
    v_smfmac_f32_16x16x32_bf16 v[164:167], v[252:253], v[212:215], v10 abid:2
    s_setpc_b64 s[78:79]
    v_smfmac_f32_16x16x32_bf16 v[132:135], v[252:253], v[212:215], v10
    v_smfmac_f32_16x16x32_bf16 v[168:171], v[252:253], v[212:215], v10 abid:2
    s_setpc_b64 s[78:79]
    v_smfmac_f32_16x16x32_bf16 v[136:139], v[252:253], v[212:215], v10
    v_smfmac_f32_16x16x32_bf16 v[172:175], v[252:253], v[212:215], v10 abid:2
    s_setpc_b64 s[78:79]
    v_smfmac_f32_16x16x32_bf16 v[140:143], v[252:253], v[212:215], v10
    v_smfmac_f32_16x16x32_bf16 v[176:179], v[252:253], v[212:215], v10 abid:2
    s_setpc_b64 s[78:79]
    v_smfmac_f32_16x16x32_bf16 v[144:147], v[252:253], v[212:215], v10
    v_smfmac_f32_16x16x32_bf16 v[180:183], v[252:253], v[212:215], v10 abid:2
    s_setpc_b64 s[78:79]
    v_smfmac_f32_16x16x32_bf16 v[148:151], v[252:253], v[212:215], v10
    v_smfmac_f32_16x16x32_bf16 v[184:187], v[252:253], v[212:215], v10 abid:2
    s_setpc_b64 s[78:79]
    v_smfmac_f32_16x16x32_bf16 v[152:155], v[252:253], v[212:215], v10
    v_smfmac_f32_16x16x32_bf16 v[188:191], v[252:253], v[212:215], v10 abid:2
    s_setpc_b64 s[78:79]
    v_smfmac_f32_16x16x32_bf16 v[156:159], v[252:253], v[212:215], v10
    v_smfmac_f32_16x16x32_bf16 v[192:195], v[252:253], v[212:215], v10 abid:2
    s_setpc_b64 s[78:79]
M_ovl2:
    v_smfmac_f32_16x16x32_bf16 v[124:127], v[254:255], v[212:215], v10
    v_smfmac_f32_16x16x32_bf16 v[160:163], v[254:255], v[212:215], v10 abid:2
    s_setpc_b64 s[78:79]
    v_smfmac_f32_16x16x32_bf16 v[128:131], v[254:255], v[212:215], v10
    v_smfmac_f32_16x16x32_bf16 v[164:167], v[254:255], v[212:215], v10 abid:2
    s_setpc_b64 s[78:79]
    v_smfmac_f32_16x16x32_bf16 v[132:135], v[254:255], v[212:215], v10
    v_smfmac_f32_16x16x32_bf16 v[168:171], v[254:255], v[212:215], v10 abid:2
    s_setpc_b64 s[78:79]
    v_smfmac_f32_16x16x32_bf16 v[136:139], v[254:255], v[212:215], v10
    v_smfmac_f32_16x16x32_bf16 v[172:175], v[254:255], v[212:215], v10 abid:2
    s_setpc_b64 s[78:79]
    v_smfmac_f32_16x16x32_bf16 v[140:143], v[254:255], v[212:215], v10
    v_smfmac_f32_16x16x32_bf16 v[176:179], v[254:255], v[212:215], v10 abid:2
    s_setpc_b64 s[78:79]
    v_smfmac_f32_16x16x32_bf16 v[144:147], v[254:255], v[212:215], v10
    v_smfmac_f32_16x16x32_bf16 v[180:183], v[254:255], v[212:215], v10 abid:2
    s_setpc_b64 s[78:79]
    v_smfmac_f32_16x16x32_bf16 v[148:151], v[254:255], v[212:215], v10
    v_smfmac_f32_16x16x32_bf16 v[184:187], v[254:255], v[212:215], v10 abid:2
    s_setpc_b64 s[78:79]
    v_smfmac_f32_16x16x32_bf16 v[152:155], v[254:255], v[212:215], v10
    v_smfmac_f32_16x16x32_bf16 v[188:191], v[254:255], v[212:215], v10 abid:2
    s_setpc_b64 s[78:79]
    v_smfmac_f32_16x16x32_bf16 v[156:159], v[254:255], v[212:215], v10
    v_smfmac_f32_16x16x32_bf16 v[192:195], v[254:255], v[212:215], v10 abid:2
    s_setpc_b64 s[78:79]
M_ovn:
    s_setpc_b64 s[78:79]
M_slow:
    s_bitcmp1_b32 s46, 31
    s_cbranch_scc1 M_dense
    s_mov_b32 s56, s80
M_sl:
    s_lshl_b32 s57, s56, 6
    v_add_u32 v240, s57, v9
    ds_read_b128 v[248:251], v240 offset:9792
    s_waitcnt lgkmcnt(0)
    v_and_b32 v240, 0x3fff, v248
    v_and_b32 v241, 0x3fff, v250
    v_xad_u32 v240, v240, v3, v4
    v_xad_u32 v241, v241, v3, v4
    ds_read2st64_b32 v[244:245], v240 offset0:0 offset1:72
    ds_read2st64_b32 v[246:247], v241 offset0:0 offset1:72
    v_subrev_u32 v240, s29, v8
    v_bfe_u32 v240, v240, 4, 4
    s_waitcnt lgkmcnt(0)
    s_bitcmp1_b32 s27, 0
    s_cbranch_scc0 M_sle0
    v_lshrrev_b32 v242, 18, v248
    v_lshrrev_b32 v243, 18, v250
    v_or_b32 v241, 0, v240
    v_cmp_eq_u32 s[44:45], v242, v241
    v_cmp_eq_u32 s[54:55], v243, v241
    s_nop 0
    v_cndmask_b32 v242, 0, v249, s[44:45]
    v_cndmask_b32 v243, 0, v251, s[54:55]
    s_nop 1
    v_smfmac_f32_16x16x32_bf16 v[124:127], v[242:243], v[244:247], v10
    v_smfmac_f32_16x16x32_bf16 v[160:163], v[242:243], v[244:247], v10 abid:2
M_sle0:
    s_bitcmp1_b32 s27, 1
    s_cbranch_scc0 M_sle1
    v_lshrrev_b32 v242, 18, v248
    v_lshrrev_b32 v243, 18, v250
    v_or_b32 v241, 64, v240
    v_cmp_eq_u32 s[44:45], v242, v241
    v_cmp_eq_u32 s[54:55], v243, v241
    s_nop 0
    v_cndmask_b32 v242, 0, v249, s[44:45]
    v_cndmask_b32 v243, 0, v251, s[54:55]
    s_nop 1
    v_smfmac_f32_16x16x32_bf16 v[128:131], v[242:243], v[244:247], v10
    v_smfmac_f32_16x16x32_bf16 v[164:167], v[242:243], v[244:247], v10 abid:2
M_sle1:
    s_bitcmp1_b32 s27, 2
    s_cbranch_scc0 M_sle2
    v_lshrrev_b32 v242, 18, v248
    v_lshrrev_b32 v243, 18, v250
    v_or_b32 v241, 128, v240
    v_cmp_eq_u32 s[44:45], v242, v241
    v_cmp_eq_u32 s[54:55], v243, v241
    s_nop 0
    v_cndmask_b32 v242, 0, v249, s[44:45]
    v_cndmask_b32 v243, 0, v251, s[54:55]
    s_nop 1
    v_smfmac_f32_16x16x32_bf16 v[132:135], v[242:243], v[244:247], v10
    v_smfmac_f32_16x16x32_bf16 v[168:171], v[242:243], v[244:247], v10 abid:2
M_sle2:
    s_bitcmp1_b32 s27, 3
    s_cbranch_scc0 M_sle3
    v_lshrrev_b32 v242, 18, v248
    v_lshrrev_b32 v243, 18, v250
    v_or_b32 v241, 192, v240
    v_cmp_eq_u32 s[44:45], v242, v241
    v_cmp_eq_u32 s[54:55], v243, v241
    s_nop 0
    v_cndmask_b32 v242, 0, v249, s[44:45]
    v_cndmask_b32 v243, 0, v251, s[54:55]
    s_nop 1
    v_smfmac_f32_16x16x32_bf16 v[136:139], v[242:243], v[244:247], v10
    v_smfmac_f32_16x16x32_bf16 v[172:175], v[242:243], v[244:247], v10 abid:2
M_sle3:
    s_bitcmp1_b32 s27, 4
    s_cbranch_scc0 M_sle4
    v_lshrrev_b32 v242, 18, v248
    v_lshrrev_b32 v243, 18, v250
    v_or_b32 v241, 256, v240
    v_cmp_eq_u32 s[44:45], v242, v241
    v_cmp_eq_u32 s[54:55], v243, v241
    s_nop 0
    v_cndmask_b32 v242, 0, v249, s[44:45]
    v_cndmask_b32 v243, 0, v251, s[54:55]
    s_nop 1
    v_smfmac_f32_16x16x32_bf16 v[140:143], v[242:243], v[244:247], v10
    v_smfmac_f32_16x16x32_bf16 v[176:179], v[242:243], v[244:247], v10 abid:2
M_sle4:
    s_bitcmp1_b32 s27, 5
    s_cbranch_scc0 M_sle5
    v_lshrrev_b32 v242, 18, v248
    v_lshrrev_b32 v243, 18, v250
    v_or_b32 v241, 320, v240
    v_cmp_eq_u32 s[44:45], v242, v241
    v_cmp_eq_u32 s[54:55], v243, v241
    s_nop 0
    v_cndmask_b32 v242, 0, v249, s[44:45]
    v_cndmask_b32 v243, 0, v251, s[54:55]
    s_nop 1
    v_smfmac_f32_16x16x32_bf16 v[144:147], v[242:243], v[244:247], v10
    v_smfmac_f32_16x16x32_bf16 v[180:183], v[242:243], v[244:247], v10 abid:2
M_sle5:
    s_bitcmp1_b32 s27, 6
    s_cbranch_scc0 M_sle6
    v_lshrrev_b32 v242, 18, v248
    v_lshrrev_b32 v243, 18, v250
    v_or_b32 v241, 384, v240
    v_cmp_eq_u32 s[44:45], v242, v241
    v_cmp_eq_u32 s[54:55], v243, v241
    s_nop 0
    v_cndmask_b32 v242, 0, v249, s[44:45]
    v_cndmask_b32 v243, 0, v251, s[54:55]
    s_nop 1
    v_smfmac_f32_16x16x32_bf16 v[148:151], v[242:243], v[244:247], v10
    v_smfmac_f32_16x16x32_bf16 v[184:187], v[242:243], v[244:247], v10 abid:2
M_sle6:
    s_bitcmp1_b32 s27, 7
    s_cbranch_scc0 M_sle7
    v_lshrrev_b32 v242, 18, v248
    v_lshrrev_b32 v243, 18, v250
    v_or_b32 v241, 448, v240
    v_cmp_eq_u32 s[44:45], v242, v241
    v_cmp_eq_u32 s[54:55], v243, v241
    s_nop 0
    v_cndmask_b32 v242, 0, v249, s[44:45]
    v_cndmask_b32 v243, 0, v251, s[54:55]
    s_nop 1
    v_smfmac_f32_16x16x32_bf16 v[152:155], v[242:243], v[244:247], v10
    v_smfmac_f32_16x16x32_bf16 v[188:191], v[242:243], v[244:247], v10 abid:2
M_sle7:
    s_bitcmp1_b32 s27, 8
    s_cbranch_scc0 M_sle8
    v_lshrrev_b32 v242, 18, v248
    v_lshrrev_b32 v243, 18, v250
    v_or_b32 v241, 512, v240
    v_cmp_eq_u32 s[44:45], v242, v241
    v_cmp_eq_u32 s[54:55], v243, v241
    s_nop 0
    v_cndmask_b32 v242, 0, v249, s[44:45]
    v_cndmask_b32 v243, 0, v251, s[54:55]
    s_nop 1
    v_smfmac_f32_16x16x32_bf16 v[156:159], v[242:243], v[244:247], v10
    v_smfmac_f32_16x16x32_bf16 v[192:195], v[242:243], v[244:247], v10 abid:2
M_sle8:
    s_add_u32 s56, s56, 1
    s_cmp_lt_u32 s56, s46
    s_cbranch_scc1 M_sl
M_slx:
    s_nop 7
    s_cmp_eq_u32 s21, 1
    s_cbranch_scc1 M_slowrL
    s_cmp_eq_u32 s21, 2
    s_cbranch_scc1 M_slowrE0
    s_cmp_eq_u32 s21, 3
    s_cbranch_scc1 M_slowrF
    s_branch M_slowr0
M_dense:
    s_mul_i32 s57, s20, 82944
    s_add_u32 s57, s57, 389120
    s_mov_b32 s56, 0
    v_mov_b32 v54, v1
    v_mov_b32 v55, v2
    v_subrev_u32 v252, s29, v8
M_dn0:
    ds_read_b128 v[244:247], v54 offset:0
    ds_read_b128 v[248:251], v55 offset:0
    v_add_u32 v54, 1024, v54
    v_add_u32 v55, 1024, v55
    buffer_load_dwordx4 v[240:243], v252, s[16:19], s57 offen sc1
    s_add_u32 s57, s57, 1024
    s_waitcnt vmcnt(0) lgkmcnt(0)
    v_smfmac_f32_16x16x64_bf16 v[124:127], v[240:243], v[244:251], v10
    buffer_load_dwordx4 v[240:243], v252, s[16:19], s57 offen sc1
    s_add_u32 s57, s57, 1024
    s_waitcnt vmcnt(0) lgkmcnt(0)
    v_smfmac_f32_16x16x64_bf16 v[128:131], v[240:243], v[244:251], v10
    buffer_load_dwordx4 v[240:243], v252, s[16:19], s57 offen sc1
    s_add_u32 s57, s57, 1024
    s_waitcnt vmcnt(0) lgkmcnt(0)
    v_smfmac_f32_16x16x64_bf16 v[132:135], v[240:243], v[244:251], v10
    buffer_load_dwordx4 v[240:243], v252, s[16:19], s57 offen sc1
    s_add_u32 s57, s57, 1024
    s_waitcnt vmcnt(0) lgkmcnt(0)
    v_smfmac_f32_16x16x64_bf16 v[136:139], v[240:243], v[244:251], v10
    buffer_load_dwordx4 v[240:243], v252, s[16:19], s57 offen sc1
    s_add_u32 s57, s57, 1024
    s_waitcnt vmcnt(0) lgkmcnt(0)
    v_smfmac_f32_16x16x64_bf16 v[140:143], v[240:243], v[244:251], v10
    buffer_load_dwordx4 v[240:243], v252, s[16:19], s57 offen sc1
    s_add_u32 s57, s57, 1024
    s_waitcnt vmcnt(0) lgkmcnt(0)
    v_smfmac_f32_16x16x64_bf16 v[144:147], v[240:243], v[244:251], v10
    buffer_load_dwordx4 v[240:243], v252, s[16:19], s57 offen sc1
    s_add_u32 s57, s57, 1024
    s_waitcnt vmcnt(0) lgkmcnt(0)
    v_smfmac_f32_16x16x64_bf16 v[148:151], v[240:243], v[244:251], v10
    buffer_load_dwordx4 v[240:243], v252, s[16:19], s57 offen sc1
    s_add_u32 s57, s57, 1024
    s_waitcnt vmcnt(0) lgkmcnt(0)
    v_smfmac_f32_16x16x64_bf16 v[152:155], v[240:243], v[244:251], v10
    buffer_load_dwordx4 v[240:243], v252, s[16:19], s57 offen sc1
    s_add_u32 s57, s57, 1024
    s_waitcnt vmcnt(0) lgkmcnt(0)
    v_smfmac_f32_16x16x64_bf16 v[156:159], v[240:243], v[244:251], v10
    s_add_u32 s56, s56, 1
    s_cmp_lt_u32 s56, 9
    s_cbranch_scc1 M_dn0
    s_mul_i32 s57, s20, 82944
    s_add_u32 s57, s57, 389120
    s_mov_b32 s56, 0
    v_mov_b32 v54, v1
    v_mov_b32 v55, v2
    v_subrev_u32 v252, s29, v8
M_dn1:
    ds_read_b128 v[244:247], v54 offset:18432
    ds_read_b128 v[248:251], v55 offset:18432
    v_add_u32 v54, 1024, v54
    v_add_u32 v55, 1024, v55
    buffer_load_dwordx4 v[240:243], v252, s[16:19], s57 offen sc1
    s_add_u32 s57, s57, 1024
    s_waitcnt vmcnt(0) lgkmcnt(0)
    v_smfmac_f32_16x16x64_bf16 v[160:163], v[240:243], v[244:251], v10
    buffer_load_dwordx4 v[240:243], v252, s[16:19], s57 offen sc1
    s_add_u32 s57, s57, 1024
    s_waitcnt vmcnt(0) lgkmcnt(0)
    v_smfmac_f32_16x16x64_bf16 v[164:167], v[240:243], v[244:251], v10
    buffer_load_dwordx4 v[240:243], v252, s[16:19], s57 offen sc1
    s_add_u32 s57, s57, 1024
    s_waitcnt vmcnt(0) lgkmcnt(0)
    v_smfmac_f32_16x16x64_bf16 v[168:171], v[240:243], v[244:251], v10
    buffer_load_dwordx4 v[240:243], v252, s[16:19], s57 offen sc1
    s_add_u32 s57, s57, 1024
    s_waitcnt vmcnt(0) lgkmcnt(0)
    v_smfmac_f32_16x16x64_bf16 v[172:175], v[240:243], v[244:251], v10
    buffer_load_dwordx4 v[240:243], v252, s[16:19], s57 offen sc1
    s_add_u32 s57, s57, 1024
    s_waitcnt vmcnt(0) lgkmcnt(0)
    v_smfmac_f32_16x16x64_bf16 v[176:179], v[240:243], v[244:251], v10
    buffer_load_dwordx4 v[240:243], v252, s[16:19], s57 offen sc1
    s_add_u32 s57, s57, 1024
    s_waitcnt vmcnt(0) lgkmcnt(0)
    v_smfmac_f32_16x16x64_bf16 v[180:183], v[240:243], v[244:251], v10
    buffer_load_dwordx4 v[240:243], v252, s[16:19], s57 offen sc1
    s_add_u32 s57, s57, 1024
    s_waitcnt vmcnt(0) lgkmcnt(0)
    v_smfmac_f32_16x16x64_bf16 v[184:187], v[240:243], v[244:251], v10
    buffer_load_dwordx4 v[240:243], v252, s[16:19], s57 offen sc1
    s_add_u32 s57, s57, 1024
    s_waitcnt vmcnt(0) lgkmcnt(0)
    v_smfmac_f32_16x16x64_bf16 v[188:191], v[240:243], v[244:251], v10
    buffer_load_dwordx4 v[240:243], v252, s[16:19], s57 offen sc1
    s_add_u32 s57, s57, 1024
    s_waitcnt vmcnt(0) lgkmcnt(0)
    v_smfmac_f32_16x16x64_bf16 v[192:195], v[240:243], v[244:251], v10
    s_add_u32 s56, s56, 1
    s_cmp_lt_u32 s56, 9
    s_cbranch_scc1 M_dn1
    s_branch M_slx
M_codeend:
.section .rodata,"a"
.p2align 6
.amdhsa_kernel standalone__structured_sparse_n_m__ragged_kernel
  .amdhsa_next_free_vgpr 512
  .amdhsa_next_free_sgpr 102
  .amdhsa_accum_offset 256
  .amdhsa_group_segment_fixed_size 0
  .amdhsa_kernarg_size 48
  .amdhsa_user_sgpr_count 2
  .amdhsa_user_sgpr_kernarg_segment_ptr 1
  .amdhsa_system_sgpr_workgroup_id_x 1
  .amdhsa_float_denorm_mode_32 3
.end_amdhsa_kernel
```

```asm
; @launch grid=(256,1,1) block=(256,1,1) lds=162064
.amdgcn_target "amdgcn-amd-amdhsa--gfx950"
.text
.globl standalone__structured_sparse_n_m__ragged_kernel
.p2align 8
.type standalone__structured_sparse_n_m__ragged_kernel,@function
standalone__structured_sparse_n_m__ragged_kernel:
    s_cmp_ge_u32 s2, 256
    s_cbranch_scc1 M_end
    s_load_dwordx8 s[72:79], s[0:1], 0
    s_load_dwordx4 s[80:83], s[0:1], 32
    s_getpc_b64 s[84:85]
    s_lshr_b32 s30, s2, 3
    s_and_b32 s30, s30, 15
    s_lshl_b32 s30, s30, 11
    s_and_b32 s84, s84, 0xffffff00
    s_cmp_ge_u32 s2, 88
    s_cselect_b32 s86, M_codeend-standalone__structured_sparse_n_m__ragged_kernel, 0
    s_mov_b32 s87, 0x20000
    v_lshlrev_b32 v254, 3, v0
    s_mov_b32 exec_lo, 0x00010001
    s_mov_b32 exec_hi, 0x00010001
    buffer_load_dword v254, v254, s[84:87], s30 offen
    s_mov_b64 exec, -1
    v_lshrrev_b32 v20, 6, v0
    v_and_b32 v12, 63, v0
    v_readfirstlane_b32 s20, v20
    v_lshrrev_b32 v22, 3, v0
    v_mul_u32_u24 v22, 1152, v22
    v_lshrrev_b32 v23, 4, v0
    v_xor_b32 v23, v23, v0
    v_and_b32 v23, 7, v23
    v_lshl_add_u32 v5, v23, 4, v22
    v_lshrrev_b32 v13, 4, v12
    v_and_b32 v14, 15, v12
    v_lshlrev_b32 v11, 4, v12
    v_lshlrev_b32 v54, 3, v12
    v_lshlrev_b32 v25, 4, v13
    v_lshlrev_b32 v26, 3, v13
    s_mov_b32 s6, 663552
    s_mov_b32 s7, 0x20000
    s_mov_b32 s10, 75497472
    s_mov_b32 s11, s7
    s_mov_b32 s18, 742400
    s_mov_b32 s19, s7
    s_movk_i32 s70, 256
    s_mov_b32 s71, s7
    s_movk_i32 s86, 1152
    s_mov_b32 s87, s7
    s_mov_b32 s98, 0
    s_mul_i32 s96, s20, 16
    s_and_b32 s97, s2, 15
    s_add_u32 s96, s96, s97
    s_lshl_b32 s96, s96, 8
    s_add_u32 s96, s96, 726016
    s_mul_i32 s22, s2, 36864
    s_mul_i32 s26, s20, 9216
    s_mov_b32 s24, s22
    s_mov_b32 s42, s26
    s_lshl_b32 s28, s20, 8
    s_lshl_b32 s29, s20, 5
    s_cmp_lt_u32 s2, 81
    s_cbranch_scc0 M_x1
    s_mul_i32 s32, s2, 57
    s_lshr_b32 s32, s32, 9
    s_mul_i32 s33, s32, 9
    s_sub_u32 s33, s2, s33
    s_mul_i32 s54, s32, 73728
    s_lshl_b32 s35, s33, 7
    s_add_u32 s54, s54, s35
    s_add_u32 s55, s54, 36864
    s_lshl_b32 s36, s20, 10
    s_add_u32 m0, s36, 73728
    s_lshr_b32 s30, s33, 1
    s_and_b32 s31, s33, 1
    s_lshl1_add_u32 s37, s32, s31
    s_mul_i32 s37, s37, 176
    s_mul_i32 s38, s32, 96
    s_add_u32 s38, s38, 3168
    s_cmp_lt_u32 s33, 8
    s_cselect_b32 s30, s30, s20
    s_cselect_b32 s37, s37, s38
    s_cselect_b32 s44, 2047, 63
    s_cselect_b32 s45, s20, 3
    s_cmp_eq_u32 s45, 3
    s_cselect_b32 s99, 742400, 0
    s_mul_i32 s48, s30, 98304
    s_add_u32 s37, s37, s48
    v_mov_b32 v44, 2.0
    v_mov_b32 v45, 0
    v_mov_b32 v46, 2.0
    v_mov_b32 v47, 0
    s_waitcnt lgkmcnt(0)
    s_mov_b64 s[4:5], s[74:75]
    buffer_load_dwordx4 v5, s[4:7], s54 offen lds
    s_add_u32 m0, m0, 4096
    s_mov_b32 s45, 0
    buffer_load_dwordx4 v5, s[4:7], s55 offen lds
    s_mov_b64 s[16:17], s[82:83]
    s_mov_b64 s[8:9], s[72:73]
    s_mov_b64 s[84:85], s[76:77]
    s_mov_b64 s[68:69], s[80:81]
    v_mov_b32 v10, 0
    s_mov_b64 exec, 1
    buffer_atomic_add v10, off, s[16:19], s96 sc0 sc1
    s_mov_b64 exec, -1
    s_mov_b64 exec, s[44:45]
    s_mov_b32 s18, s99
    buffer_store_dwordx4 v[44:47], v11, s[16:19], s37 offen sc1
    s_mov_b32 s18, 742400
    s_mov_b64 exec, -1
    buffer_load_dwordx4 v[196:199], v25, s[84:87], s28 offen offset:0
    buffer_load_dwordx4 v[200:203], v25, s[84:87], s28 offen offset:64
    buffer_load_dwordx4 v[204:207], v25, s[84:87], s28 offen offset:128
    buffer_load_dwordx4 v[208:211], v25, s[84:87], s28 offen offset:192
    buffer_load_dwordx2 v[212:213], v26, s[84:87], s29 offen offset:1024
    s_mov_b32 m0, s42
    s_nop 0
    buffer_load_dwordx4 v5, s[8:11], s22 offen offset:0 nt lds
    s_add_u32 m0, m0, 896
    s_nop 0
    buffer_load_dwordx4 v5, s[8:11], s22 offen offset:128 nt lds
    s_add_u32 m0, m0, 896
    s_nop 0
    buffer_load_dwordx4 v5, s[8:11], s22 offen offset:256 nt lds
    s_add_u32 m0, m0, 896
    s_nop 0
    buffer_load_dwordx4 v5, s[8:11], s22 offen offset:384 nt lds
    s_lshl_b32 s34, s31, 2
    s_add_u32 s34, s34, s20
    s_lshr_b32 s35, s20, 1
    s_lshl_b32 s35, s35, 6
    s_and_b32 s36, s20, 1
    s_lshl_b32 s36, s36, 3
    s_add_u32 s35, s35, s36
    s_lshl_b32 s36, s20, 5
    s_mul_i32 s39, s32, 10240
    s_add_u32 s39, s39, 6144
    s_lshl_b32 s40, s34, 1
    s_add_u32 s40, s40, s39
    s_lshl_b32 s38, s32, 1
    s_cmp_eq_u32 s32, 8
    s_cselect_b32 s38, 1024, s38
    s_add_u32 s38, s38, 4096
    s_cmp_lt_u32 s33, 8
    s_cselect_b32 s34, s34, 8
    s_cselect_b32 s35, s35, s36
    s_cselect_b32 s36, 4, 3
    s_cselect_b32 s40, s40, s38
    s_cselect_b32 s46, 0, s20
    s_cselect_b32 s47, 22, 12
    s_add_u32 s40, s40, s48
    s_lshl_b32 s38, s34, 10
    s_add_u32 s39, s39, s38
    s_add_u32 s39, s39, s48
    s_add_u32 s39, s39, 1024
    v_and_b32 v15, 3, v14
    v_lshlrev_b32 v15, s36, v15
    v_add_u32 v15, s35, v15
    v_lshrrev_b32 v16, 3, v14
    v_lshlrev_b32 v16, 4, v16
    v_xor_b32 v15, v15, v16
    v_lshrrev_b32 v16, 2, v14
    v_lshl_add_u32 v16, v13, 4, v16
    v_lshl_add_u32 v15, v16, 7, v15
    v_add_u32 v24, 73728, v15
    v_xor_b32 v27, 32, v24
    v_xor_b32 v28, 64, v24
    v_xor_b32 v29, 0x60, v24
    s_lshl_b32 s31, s46, 2
    s_add_u32 s31, s31, 81920
    v_mov_b32 v60, s31
    v_mov_b32 v61, 1
    ds_write_b32 v60, v61
    s_mul_i32 s49, s30, 81
    s_mul_i32 s31, s32, 9
    s_add_u32 s49, s49, s31
    s_add_u32 s49, s49, s34
    s_lshl_b32 s49, s49, 10
    s_add_u32 s49, s49, 393216
    s_lshl_b32 s31, s34, 24
    s_lshl_b32 s38, s32, 10
    s_add_u32 s31, s31, s38
    v_lshlrev_b32 v31, 18, v14
    v_lshl_add_u32 v31, v13, 5, v31
    v_add_u32 v31, s31, v31
    s_mov_b32 s50, 3437096686
    s_mov_b32 s51, 1150609561
    s_mov_b32 s52, 0x00010001
    s_mov_b32 s53, 0x00200010
    s_mov_b32 s38, 0x0202
    s_mul_i32 s57, s30, 4096
    s_add_u32 s57, s57, 726016
    s_cmp_eq_u32 s33, 8
    s_cselect_b32 s56, 0, s20
    s_cmp_eq_u32 s20, 0
    s_cselect_b32 s98, 1, 0
    v_add_u32 v74, 81984, v54
    v_lshl_add_u32 v73, s20, 1, v74
    v_mov_b32 v41, 0x01000100
    v_mov_b32 v40, 0
    v_mov_b32 v63, -2.0
    s_waitcnt vmcnt(11) lgkmcnt(0)
    s_barrier
    ds_read_b64_tr_b16 v[16:17], v24
    ds_read_b64_tr_b16 v[18:19], v27 offset:512
    ds_read_b64_tr_b16 v[20:21], v28 offset:1024
    ds_read_b64_tr_b16 v[22:23], v29 offset:1536
    s_waitcnt lgkmcnt(3)
    v_and_b32 v44, 0x7fff7fff, v16
    v_and_b32 v45, 0x7fff7fff, v17
    v_pk_max_u16 v46, v44, v45
    v_pk_min_u16 v47, v44, v45
    v_pk_min_u16 v46, v46, v46 op_sel:[0,1] op_sel_hi:[1,0]
    v_pk_max_u16 v47, v47, v47 op_sel:[0,1] op_sel_hi:[1,0]
    v_pk_max_u16 v46, v46, s52
    v_pk_max_u16 v46, v46, v47
    v_pk_sub_i16 v44, v44, v46
    v_pk_sub_i16 v45, v45, v46
    v_pk_ashrrev_i16 v44, 15, v44 op_sel_hi:[0,1]
    v_pk_ashrrev_i16 v45, 15, v45 op_sel_hi:[0,1]
    v_alignbit_b32 v47, -1, v44, 16
    v_alignbit_b32 v46, v45, v45, 16
    v_and_b32 v48, 0x00080004, v44
    v_bitop3_b32 v46, v45, v46, v47 bitop3:0xe8
    v_and_or_b32 v64, v45, s53, v48
    v_bitop3_b32 v36, v16, v44, v46 bitop3:0x10
    v_min_u32 v68, 1, v36
    s_waitcnt lgkmcnt(2)
    v_and_b32 v44, 0x7fff7fff, v18
    v_and_b32 v45, 0x7fff7fff, v19
    v_pk_max_u16 v46, v44, v45
    v_pk_min_u16 v47, v44, v45
    v_pk_min_u16 v46, v46, v46 op_sel:[0,1] op_sel_hi:[1,0]
    v_pk_max_u16 v47, v47, v47 op_sel:[0,1] op_sel_hi:[1,0]
    v_pk_max_u16 v46, v46, s52
    v_pk_max_u16 v46, v46, v47
    v_pk_sub_i16 v44, v44, v46
    v_pk_sub_i16 v45, v45, v46
    v_pk_ashrrev_i16 v44, 15, v44 op_sel_hi:[0,1]
    v_pk_ashrrev_i16 v45, 15, v45 op_sel_hi:[0,1]
    v_alignbit_b32 v47, -1, v44, 16
    v_alignbit_b32 v46, v45, v45, 16
    v_and_b32 v48, 0x00080004, v44
    v_bitop3_b32 v46, v45, v46, v47 bitop3:0xe8
    v_and_or_b32 v65, v45, s53, v48
    v_bitop3_b32 v37, v18, v44, v46 bitop3:0x10
    v_min_u32 v69, 1, v37
    s_waitcnt lgkmcnt(1)
    v_and_b32 v44, 0x7fff7fff, v20
    v_and_b32 v45, 0x7fff7fff, v21
    v_pk_max_u16 v46, v44, v45
    v_pk_min_u16 v47, v44, v45
    v_pk_min_u16 v46, v46, v46 op_sel:[0,1] op_sel_hi:[1,0]
    v_pk_max_u16 v47, v47, v47 op_sel:[0,1] op_sel_hi:[1,0]
    v_pk_max_u16 v46, v46, s52
    v_pk_max_u16 v46, v46, v47
    v_pk_sub_i16 v44, v44, v46
    v_pk_sub_i16 v45, v45, v46
    v_pk_ashrrev_i16 v44, 15, v44 op_sel_hi:[0,1]
    v_pk_ashrrev_i16 v45, 15, v45 op_sel_hi:[0,1]
    v_alignbit_b32 v47, -1, v44, 16
    v_alignbit_b32 v46, v45, v45, 16
    v_and_b32 v48, 0x00080004, v44
    v_bitop3_b32 v46, v45, v46, v47 bitop3:0xe8
    v_and_or_b32 v66, v45, s53, v48
    v_bitop3_b32 v38, v20, v44, v46 bitop3:0x10
    v_min_u32 v70, 1, v38
    s_waitcnt lgkmcnt(0)
    v_and_b32 v44, 0x7fff7fff, v22
    v_and_b32 v45, 0x7fff7fff, v23
    v_pk_max_u16 v46, v44, v45
    v_pk_min_u16 v47, v44, v45
    v_pk_min_u16 v46, v46, v46 op_sel:[0,1] op_sel_hi:[1,0]
    v_pk_max_u16 v47, v47, v47 op_sel:[0,1] op_sel_hi:[1,0]
    v_pk_max_u16 v46, v46, s52
    v_pk_max_u16 v46, v46, v47
    v_pk_sub_i16 v44, v44, v46
    v_pk_sub_i16 v45, v45, v46
    v_pk_ashrrev_i16 v44, 15, v44 op_sel_hi:[0,1]
    v_pk_ashrrev_i16 v45, 15, v45 op_sel_hi:[0,1]
    v_alignbit_b32 v47, -1, v44, 16
    v_alignbit_b32 v46, v45, v45, 16
    v_and_b32 v48, 0x00080004, v44
    v_bitop3_b32 v46, v45, v46, v47 bitop3:0xe8
    v_and_or_b32 v67, v45, s53, v48
    v_bitop3_b32 v39, v22, v44, v46 bitop3:0x10
    v_min_u32 v71, 1, v39
    v_add_u32 v72, v68, v69
    v_add3_u32 v72, v72, v70, v71
    buffer_store_dwordx4 v[36:39], v11, s[16:19], s49 offen sc1
    v_cmp_ne_u32 vcc, 0, v72
    s_and_saveexec_b64 s[44:45], vcc
    ds_add_rtn_u32 v62, v60, v72
    s_mov_b64 exec, -1
    v_lshrrev_b32 v48, 16, v64
    v_or_b32 v48, v48, v64
    v_lshrrev_b64 v[52:53], v48, s[50:51]
    v_and_b32 v64, 15, v52
    v_lshl_or_b32 v40, v64, 0, v40
    v_lshrrev_b32 v48, 16, v65
    v_or_b32 v48, v48, v65
    v_lshrrev_b64 v[52:53], v48, s[50:51]
    v_and_b32 v65, 15, v52
    v_lshl_or_b32 v40, v65, 4, v40
    v_lshrrev_b32 v48, 16, v66
    v_or_b32 v48, v48, v66
    v_lshrrev_b64 v[52:53], v48, s[50:51]
    v_and_b32 v66, 15, v52
    v_lshl_or_b32 v40, v66, 8, v40
    v_lshrrev_b32 v48, 16, v67
    v_or_b32 v48, v48, v67
    v_lshrrev_b64 v[52:53], v48, s[50:51]
    v_and_b32 v67, 15, v52
    v_lshl_or_b32 v40, v67, 12, v40
    ds_write_b16 v73, v40
    v_mul_u32_u24 v46, 0x4001, v64
    v_and_b32 v46, 0x30003, v46
    v_mad_u32_u24 v46, v46, s38, v41
    v_perm_b32 v32, v17, v16, v46
    v_mul_u32_u24 v46, 0x4001, v65
    v_and_b32 v46, 0x30003, v46
    v_mad_u32_u24 v46, v46, s38, v41
    v_perm_b32 v33, v19, v18, v46
    s_waitcnt vmcnt(10) lgkmcnt(0)
    s_barrier
    ds_read_b64 v[50:51], v74
    v_mul_u32_u24 v46, 0x4001, v66
    v_and_b32 v46, 0x30003, v46
    v_mad_u32_u24 v46, v46, s38, v41
    v_perm_b32 v34, v21, v20, v46
    v_mul_u32_u24 v46, 0x4001, v67
    v_and_b32 v46, 0x30003, v46
    v_mad_u32_u24 v46, v46, s38, v41
    v_perm_b32 v35, v23, v22, v46
    buffer_store_dwordx4 v[32:35], v11, s[16:19], s39 offen sc1
    s_cmp_eq_u32 s33, 8
    s_cbranch_scc0 F_i1
    buffer_store_short v40, v11, s[16:19], s40 offen sc1
    s_branch F_i2
F_i1:
    s_cmp_eq_u32 s20, 0
    s_cbranch_scc0 F_i2
    s_waitcnt lgkmcnt(0)
    buffer_store_dwordx2 v[50:51], v11, s[16:19], s40 offen sc1
F_i2:
    s_cbranch_vccz F_z
    v_cmp_ne_u32 vcc, 0, v36
    s_and_saveexec_b64 s[44:45], vcc
    s_cbranch_execz F_e0
    v_cmp_gt_u32 vcc, s47, v62
    v_add_u32 v42, 0, v31
    v_lshlrev_b32 v44, 3, v62
    v_add_u32 v62, 1, v62
    v_cndmask_b32 v42, v63, v42, vcc
    v_cndmask_b32 v43, 0, v36, vcc
    v_cndmask_b32 v44, 0, v44, vcc
    buffer_store_dwordx2 v[42:43], v44, s[16:19], s37 offen sc1
F_e0:
    s_mov_b64 exec, -1
    v_cmp_ne_u32 vcc, 0, v37
    s_and_saveexec_b64 s[44:45], vcc
    s_cbranch_execz F_e1
    v_cmp_gt_u32 vcc, s47, v62
    v_add_u32 v42, 8, v31
    v_lshlrev_b32 v44, 3, v62
    v_add_u32 v62, 1, v62
    v_cndmask_b32 v42, v63, v42, vcc
    v_cndmask_b32 v43, 0, v37, vcc
    v_cndmask_b32 v44, 0, v44, vcc
    buffer_store_dwordx2 v[42:43], v44, s[16:19], s37 offen sc1
F_e1:
    s_mov_b64 exec, -1
    v_cmp_ne_u32 vcc, 0, v38
    s_and_saveexec_b64 s[44:45], vcc
    s_cbranch_execz F_e2
    v_cmp_gt_u32 vcc, s47, v62
    v_add_u32 v42, 16, v31
    v_lshlrev_b32 v44, 3, v62
    v_add_u32 v62, 1, v62
    v_cndmask_b32 v42, v63, v42, vcc
    v_cndmask_b32 v43, 0, v38, vcc
    v_cndmask_b32 v44, 0, v44, vcc
    buffer_store_dwordx2 v[42:43], v44, s[16:19], s37 offen sc1
F_e2:
    s_mov_b64 exec, -1
    v_cmp_ne_u32 vcc, 0, v39
    s_and_saveexec_b64 s[44:45], vcc
    s_cbranch_execz F_e3
    v_cmp_gt_u32 vcc, s47, v62
    v_add_u32 v42, 24, v31
    v_lshlrev_b32 v44, 3, v62
    v_add_u32 v62, 1, v62
    v_cndmask_b32 v42, v63, v42, vcc
    v_cndmask_b32 v43, 0, v39, vcc
    v_cndmask_b32 v44, 0, v44, vcc
    buffer_store_dwordx2 v[42:43], v44, s[16:19], s37 offen sc1
F_e3:
    s_mov_b64 exec, -1
F_z:
    s_cmp_lg_u32 s2, 0
    s_cbranch_scc1 M_set
    v_mov_b32 v64, 0
    v_mov_b32 v65, 0
    v_mov_b32 v66, 0
    v_mov_b32 v67, 0
    s_mov_b32 s40, 724992
    buffer_store_dwordx4 v[64:67], v11, s[16:19], s40 offen sc1
    s_branch M_set
F_sig:
    v_lshlrev_b32 v30, 8, v12
    s_waitcnt vmcnt(0)
    s_barrier
    s_cmp_lg_u32 s56, 0
    s_cbranch_scc1 F_end
    s_mov_b64 exec, 65535
    buffer_atomic_add v61, v30, s[16:19], s57 offen sc1
    s_mov_b64 exec, -1
F_end:
    s_add_u32 m0, m0, 896
    s_nop 0
    buffer_load_dwordx4 v5, s[8:11], s22 offen offset:512 nt lds
    s_add_u32 m0, m0, 896
    s_nop 0
    buffer_load_dwordx4 v5, s[8:11], s22 offen offset:640 nt lds
    s_add_u32 m0, m0, 896
    s_nop 0
    buffer_load_dwordx4 v5, s[8:11], s22 offen offset:768 nt lds
    s_branch M_x2
M_x1:
    s_waitcnt lgkmcnt(0)
    s_mov_b64 s[4:5], s[74:75]
    s_mov_b64 s[16:17], s[82:83]
    s_mov_b64 s[8:9], s[72:73]
    s_mov_b64 s[84:85], s[76:77]
    s_mov_b64 s[68:69], s[80:81]
    v_mov_b32 v10, 0
    s_mov_b64 exec, 1
    buffer_atomic_add v10, off, s[16:19], s96 sc0 sc1
    s_mov_b64 exec, -1
    buffer_load_dwordx4 v[196:199], v25, s[84:87], s28 offen offset:0
    buffer_load_dwordx4 v[200:203], v25, s[84:87], s28 offen offset:64
    buffer_load_dwordx4 v[204:207], v25, s[84:87], s28 offen offset:128
    buffer_load_dwordx4 v[208:211], v25, s[84:87], s28 offen offset:192
    buffer_load_dwordx2 v[212:213], v26, s[84:87], s29 offen offset:1024
    s_mov_b32 m0, s42
    s_nop 0
    buffer_load_dwordx4 v5, s[8:11], s22 offen offset:0 nt lds
    s_add_u32 m0, m0, 896
    s_nop 0
    buffer_load_dwordx4 v5, s[8:11], s22 offen offset:128 nt lds
    s_add_u32 m0, m0, 896
    s_nop 0
    buffer_load_dwordx4 v5, s[8:11], s22 offen offset:256 nt lds
    s_add_u32 m0, m0, 896
    s_nop 0
    buffer_load_dwordx4 v5, s[8:11], s22 offen offset:384 nt lds
    s_add_u32 m0, m0, 896
    s_nop 0
    buffer_load_dwordx4 v5, s[8:11], s22 offen offset:512 nt lds
    s_add_u32 m0, m0, 896
    s_nop 0
    buffer_load_dwordx4 v5, s[8:11], s22 offen offset:640 nt lds
    s_add_u32 m0, m0, 896
    s_nop 0
    buffer_load_dwordx4 v5, s[8:11], s22 offen offset:768 nt lds
M_set:
    s_mov_b32 s12, s78
    s_mov_b32 s13, s79
    s_mov_b32 s14, 75497472
    s_mov_b32 s15, 0x20000
    s_mul_i32 s29, s20, 12864
    s_add_u32 s29, s29, 110592
    v_lshrrev_b32 v24, 1, v14
    v_and_b32 v27, 7, v14
    v_lshlrev_b32 v22, 7, v27
    v_lshl_or_b32 v3, v24, 4, v22
    v_lshrrev_b32 v23, 3, v14
    v_mul_u32_u24 v4, 9216, v23
    v_xad_u32 v1, v25, v3, v4
    v_xor_b32 v2, 64, v1
    v_add_u32 v9, s29, v25
    v_add_u32 v8, s29, v11
    v_mul_u32_u24 v24, 1152, v27
    v_lshl_add_u32 v24, v23, 6, v24
    v_add3_u32 v6, v24, v25, s28
    v_lshrrev_b32 v24, 3, v12
    v_xor_b32 v28, v24, v12
    v_and_b32 v28, 7, v28
    v_mul_u32_u24 v24, 1152, v24
    v_lshl_add_u32 v24, v28, 4, v24
    v_add_u32 v7, 1024, v24
    s_lshl_b32 s30, s20, 1
    v_lshrrev_b32 v24, 1, v13
    v_add_u32 v24, s30, v24
    v_xor_b32 v24, v24, v27
    v_lshl_add_u32 v24, v24, 4, v22
    v_and_b32 v28, 8, v26
    v_mul_u32_u24 v29, 12864, v23
    v_add3_u32 v24, v24, v28, v29
    v_add_u32 v53, 121408, v24
    s_lshr_b32 s30, s2, 3
    s_and_b32 s30, s30, 3
    s_mul_i32 s92, s30, 256
    s_add_u32 s92, s92, 562944
    s_add_u32 s30, s30, 768
    s_mul_i32 s93, s30, 36864
    s_mov_b32 s94, 147456
    s_and_b32 s95, s20, 1
    s_mul_i32 s95, s95, 9216
    s_add_u32 s59, s24, 9216
    s_mul_i32 s43, s20, 98304
    s_add_u32 s47, s29, 9216
    s_add_u32 s48, s29, 9792
    s_add_u32 s49, s29, 10112
    s_add_u32 s54, s29, 1073751872
    s_add_u32 s38, s26, 73728
    s_add_u32 s35, s38, 1024
    s_add_u32 s39, s38, 1536
    s_mov_b32 s40, s48
    s_add_u32 s41, s48, 256
    s_mov_b32 s50, 3130536464
    s_mov_b32 s51, 1164430831
    s_mov_b32 s52, 3696531472
    s_mov_b32 s53, 598435823
    v_mov_b32 v16, 0
    v_mov_b32 v17, 0
    v_mov_b32 v18, 0
    v_mov_b32 v19, 0
    v_cmp_gt_u32 s[44:45], 36, v12
    v_mov_b32 v20, 2.0
    s_nop 0
    v_cndmask_b32 v20, 0, v20, s[44:45]
    v_mov_b32 v21, v20
    v_mov_b32 v22, v20
    v_mov_b32 v23, v20
    v_mov_b32 v68, 1073741824
    v_mov_b32 v69, 0
    v_mov_b32 v70, 1073741824
    v_mov_b32 v71, 0
    v_lshl_add_u32 v84, v12, 2, s49
    v_add_u32 v55, s38, v54
    v_add_u32 v24, s38, v11
    ds_write_b128 v8, v[16:19] offset:0
    ds_write_b128 v8, v[16:19] offset:1024
    ds_write_b128 v8, v[16:19] offset:2048
    ds_write_b128 v8, v[16:19] offset:3072
    ds_write_b128 v8, v[16:19] offset:4096
    ds_write_b128 v8, v[16:19] offset:5120
    ds_write_b128 v8, v[16:19] offset:6144
    ds_write_b128 v8, v[16:19] offset:7168
    ds_write_b128 v8, v[16:19] offset:8192
    ds_write_b128 v24, v[68:71]
    ds_write_b128 v24, v[68:71] offset:1024
    ds_write_b128 v8, v[20:23] offset:9216
    s_cmp_lt_u32 s2, 81
    s_cbranch_scc1 F_sig
M_x2:
    s_add_u32 m0, m0, 896
    s_nop 0
    buffer_load_dwordx4 v5, s[8:11], s22 offen offset:896 nt lds
    s_add_u32 m0, m0, 896
    s_nop 0
    buffer_load_dwordx4 v5, s[8:11], s22 offen offset:1024 nt lds
    s_add_u32 s22, s22, 9437184
    s_add_u32 s42, s42, 36864
    s_mov_b32 m0, s42
    s_nop 0
    buffer_load_dwordx4 v5, s[8:11], s22 offen offset:0 nt lds
    s_add_u32 m0, m0, 896
    s_nop 0
    buffer_load_dwordx4 v5, s[8:11], s22 offen offset:128 nt lds
    s_add_u32 m0, m0, 896
    s_nop 0
    buffer_load_dwordx4 v5, s[8:11], s22 offen offset:256 nt lds
    s_add_u32 m0, m0, 896
    s_nop 0
    buffer_load_dwordx4 v5, s[8:11], s22 offen offset:384 nt lds
    s_add_u32 m0, m0, 896
    s_nop 0
    buffer_load_dwordx4 v5, s[8:11], s22 offen offset:512 nt lds
    s_add_u32 m0, m0, 896
    s_nop 0
    buffer_load_dwordx4 v5, s[8:11], s22 offen offset:640 nt lds
    s_add_u32 m0, m0, 896
    s_nop 0
    buffer_load_dwordx4 v5, s[8:11], s22 offen offset:768 nt lds
    s_add_u32 m0, m0, 896
    s_nop 0
    buffer_load_dwordx4 v5, s[8:11], s22 offen offset:896 nt lds
    s_add_u32 m0, m0, 896
    s_nop 0
    buffer_load_dwordx4 v5, s[8:11], s22 offen offset:1024 nt lds
    s_add_u32 s22, s22, 9437184
    s_add_u32 s42, s42, 36864
    s_waitcnt vmcnt(3)
    v_mov_b32 v0, 0
    s_mov_b64 exec, 1
    buffer_atomic_add v0, off, s[16:19], s96 sc0 sc1
    s_mov_b64 exec, -1
    v_readlane_b32 s100, v10, 0
    v_mov_b32 v10, 0xeeee4444
    v_lshlrev_b32 v124, 16, v196
    v_and_b32 v125, 0xffff0000, v196
    v_lshlrev_b32 v126, 16, v197
    v_and_b32 v127, 0xffff0000, v197
    v_lshlrev_b32 v128, 16, v198
    v_and_b32 v129, 0xffff0000, v198
    v_lshlrev_b32 v130, 16, v199
    v_and_b32 v131, 0xffff0000, v199
    v_lshlrev_b32 v132, 16, v200
    v_and_b32 v133, 0xffff0000, v200
    v_lshlrev_b32 v134, 16, v201
    v_and_b32 v135, 0xffff0000, v201
    v_lshlrev_b32 v136, 16, v202
    v_and_b32 v137, 0xffff0000, v202
    v_lshlrev_b32 v138, 16, v203
    v_and_b32 v139, 0xffff0000, v203
    v_lshlrev_b32 v140, 16, v204
    v_and_b32 v141, 0xffff0000, v204
    v_lshlrev_b32 v142, 16, v205
    v_and_b32 v143, 0xffff0000, v205
    v_lshlrev_b32 v144, 16, v206
    v_and_b32 v145, 0xffff0000, v206
    v_lshlrev_b32 v146, 16, v207
    v_and_b32 v147, 0xffff0000, v207
    v_lshlrev_b32 v148, 16, v208
    v_and_b32 v149, 0xffff0000, v208
    v_lshlrev_b32 v150, 16, v209
    v_and_b32 v151, 0xffff0000, v209
    v_lshlrev_b32 v152, 16, v210
    v_and_b32 v153, 0xffff0000, v210
    v_lshlrev_b32 v154, 16, v211
    v_and_b32 v155, 0xffff0000, v211
    v_lshlrev_b32 v156, 16, v212
    v_and_b32 v157, 0xffff0000, v212
    v_lshlrev_b32 v158, 16, v213
    v_and_b32 v159, 0xffff0000, v213
    s_mov_b32 exec_lo, 0x00010001
    s_mov_b32 exec_hi, 0x00010001
    ds_write_b128 v9, v[124:127] offset:10240
    ds_write_b128 v9, v[128:131] offset:10304
    ds_write_b128 v9, v[132:135] offset:10368
    ds_write_b128 v9, v[136:139] offset:10432
    ds_write_b128 v9, v[140:143] offset:10496
    ds_write_b128 v9, v[144:147] offset:10560
    ds_write_b128 v9, v[148:151] offset:10624
    ds_write_b128 v9, v[152:155] offset:10688
    ds_write_b128 v9, v[156:159] offset:10752
    s_mov_b64 exec, -1
    s_mul_i32 s30, s20, 256
    s_add_u32 s30, s30, s2
    s_sub_u32 s30, s30, 0
    s_cmp_lt_u32 s2, 0
    s_cselect_b32 s30, 1023, s30
    s_lshl_b32 s30, s30, 1
    v_lshrrev_b32 v244, 5, v12
    v_add_u32 v248, s30, v244
    v_mov_b32 v244, -1
    v_mov_b32 v245, 0
    v_subrev_u32 v246, 704, v248
    v_cmp_gt_u32 vcc, 16, v246
    v_mov_b32 v247, 0
    s_nop 0
    v_cndmask_b32 v244, v244, v246, vcc
    v_cndmask_b32 v245, v245, v247, vcc
    v_subrev_u32 v246, 672, v248
    v_cmp_gt_u32 vcc, 32, v246
    v_mov_b32 v247, 1
    s_nop 0
    v_cndmask_b32 v244, v244, v246, vcc
    v_cndmask_b32 v245, v245, v247, vcc
    v_subrev_u32 v246, 624, v248
    v_cmp_gt_u32 vcc, 48, v246
    v_mov_b32 v247, 2
    s_nop 0
    v_cndmask_b32 v244, v244, v246, vcc
    v_cndmask_b32 v245, v245, v247, vcc
    v_subrev_u32 v246, 560, v248
    v_cmp_gt_u32 vcc, 64, v246
    v_mov_b32 v247, 3
    s_nop 0
    v_cndmask_b32 v244, v244, v246, vcc
    v_cndmask_b32 v245, v245, v247, vcc
    v_subrev_u32 v246, 480, v248
    v_cmp_gt_u32 vcc, 80, v246
    v_mov_b32 v247, 4
    s_nop 0
    v_cndmask_b32 v244, v244, v246, vcc
    v_cndmask_b32 v245, v245, v247, vcc
    v_subrev_u32 v246, 384, v248
    v_cmp_gt_u32 vcc, 96, v246
    v_mov_b32 v247, 5
    s_nop 0
    v_cndmask_b32 v244, v244, v246, vcc
    v_cndmask_b32 v245, v245, v247, vcc
    v_subrev_u32 v246, 272, v248
    v_cmp_gt_u32 vcc, 112, v246
    v_mov_b32 v247, 6
    s_nop 0
    v_cndmask_b32 v244, v244, v246, vcc
    v_cndmask_b32 v245, v245, v247, vcc
    v_subrev_u32 v246, 144, v248
    v_cmp_gt_u32 vcc, 128, v246
    v_mov_b32 v247, 7
    s_nop 0
    v_cndmask_b32 v244, v244, v246, vcc
    v_cndmask_b32 v245, v245, v247, vcc
    v_subrev_u32 v246, 0, v248
    v_cmp_gt_u32 vcc, 144, v246
    v_mov_b32 v247, 8
    s_nop 0
    v_cndmask_b32 v244, v244, v246, vcc
    v_cndmask_b32 v245, v245, v247, vcc
    v_sub_u32 v244, 2047, v244
    v_mul_u32_u24 v244, 36864, v244
    v_lshl_add_u32 v244, v245, 7, v244
    v_and_b32 v245, 31, v12
    v_mul_u32_u24 v245, 1152, v245
    v_add_u32 v249, v244, v245
    s_mov_b32 vcc_lo, 0xff00ff00
    s_mov_b32 vcc_hi, 0xff00ff00
    s_waitcnt vmcnt(0)
    v_readfirstlane_b32 s30, v0
    s_mov_b32 s31, 0
    s_sub_u32 s30, s30, s100
    s_cmp_eq_u32 s30, 27
    s_cbranch_scc0 M_pf_spin
M_pf_ok:
    v_mov_b32 v0, v249
    buffer_load_dwordx4 v[56:59], v11, s[16:19], s43 offen offset:0 sc1
    buffer_load_dwordx4 v[60:63], v11, s[16:19], s43 offen offset:1024 sc1
    buffer_load_dwordx4 v[64:67], v11, s[16:19], s43 offen offset:2048 sc1
    s_mov_b32 exec_hi, 268435455
    buffer_load_dwordx4 v[68:71], v11, s[16:19], s43 offen offset:3072 sc1
    s_mov_b32 exec_hi, -1
    s_add_u32 s43, s43, 4096
    buffer_load_dwordx4 v[48:51], v11, s[16:19], s43 offen offset:0 sc1
    buffer_load_dword v52, v11, s[16:19], s43 offen offset:1024 sc1
    buffer_load_dwordx4 v[12:15], v11, s[16:19], s43 offen offset:2048 sc1
    buffer_load_dwordx4 a[0:3], v11, s[16:19], s43 offen offset:3072 sc1
    s_add_u32 s43, s43, 4096
    buffer_load_dwordx4 a[4:7], v11, s[16:19], s43 offen offset:0 sc1
    buffer_load_dwordx4 a[8:11], v11, s[16:19], s43 offen offset:1024 sc1
    buffer_load_dwordx4 a[12:15], v11, s[16:19], s43 offen offset:2048 sc1
    buffer_load_dwordx4 a[16:19], v11, s[16:19], s43 offen offset:3072 sc1
    s_add_u32 s43, s43, 4096
    buffer_load_dwordx4 a[20:23], v11, s[16:19], s43 offen offset:0 sc1
    buffer_load_dwordx4 a[24:27], v11, s[16:19], s43 offen offset:1024 sc1
    buffer_load_dwordx4 a[28:31], v11, s[16:19], s43 offen offset:2048 sc1
    buffer_load_dwordx4 a[32:35], v11, s[16:19], s43 offen offset:3072 sc1
    s_add_u32 s43, s43, 4096
    buffer_load_dwordx4 v[16:19], v11, s[16:19], s43 offen offset:0 sc1
    buffer_load_dwordx4 a[36:39], v11, s[16:19], s43 offen offset:1024 sc1
    buffer_load_dwordx4 a[40:43], v11, s[16:19], s43 offen offset:2048 sc1
    buffer_load_dwordx4 a[44:47], v11, s[16:19], s43 offen offset:3072 sc1
    ds_read_b128 v[160:163], v9 offset:10240
    ds_read_b128 v[164:167], v9 offset:10304
    ds_read_b128 v[168:171], v9 offset:10368
    ds_read_b128 v[172:175], v9 offset:10432
    ds_read_b128 v[176:179], v9 offset:10496
    ds_read_b128 v[180:183], v9 offset:10560
    ds_read_b128 v[184:187], v9 offset:10624
    ds_read_b128 v[188:191], v9 offset:10688
    ds_read_b128 v[192:195], v9 offset:10752
    s_cmp_eq_u32 s98, 0
    s_cbranch_scc1 M_cnt
    s_mov_b32 s98, 0
    v_mov_b32 v250, 1
    s_mov_b64 exec, 1
    buffer_atomic_add v250, off, s[68:71], 0 offset:0 sc1
    s_mov_b64 exec, -1
    s_nop 3
M_cnt:
    s_waitcnt vmcnt(12)
    s_barrier
    ds_read_b128 v[196:199], v1 offset:0
    ds_read_b128 v[200:203], v2 offset:0
    ds_read_b128 v[228:231], v1 offset:18432
    ds_read_b128 v[232:235], v2 offset:18432
    s_waitcnt lgkmcnt(2)
    v_smfmac_f32_16x16x64_bf16 v[124:127], a[0:3], v[196:203], v12
    s_add_u32 s43, s43, 4096
    buffer_load_dwordx4 a[48:51], v11, s[16:19], s43 offen offset:0 sc1
    s_waitcnt lgkmcnt(0)
    v_mov_b32 v82, s54
    v_smfmac_f32_16x16x64_bf16 v[160:163], a[0:3], v[228:235], v12
    ds_read_b128 v[204:207], v1 offset:1024
    ds_read_b128 v[208:211], v2 offset:1024
    v_or3_b32 v78, v56, v60, v64
    v_or_b32 v78, v78, v68
    v_cmp_gt_i32 s[32:33], 0, v78
    v_cmp_gt_u32 s[36:37], 2.0, v56
    s_nop 1
    v_mbcnt_lo_u32_b32 v74, s36, 0
    s_waitcnt vmcnt(12)
    v_mbcnt_hi_u32_b32 v74, s37, v74
    v_smfmac_f32_16x16x64_bf16 v[128:131], a[4:7], v[196:203], v12 abid:1
    buffer_load_dwordx4 a[52:55], v11, s[16:19], s43 offen offset:1024 sc1
    v_lshl_add_u32 v74, v74, 3, s38
    v_smfmac_f32_16x16x64_bf16 v[164:167], a[4:7], v[228:235], v12 abid:1
    ds_read_b128 v[220:223], v1 offset:19456
    ds_read_b128 v[224:227], v2 offset:19456
    v_min_u32 v74, s39, v74
    s_waitcnt vmcnt(12)
    v_cndmask_b32 v74, v82, v74, s[36:37]
    v_smfmac_f32_16x16x64_bf16 v[132:135], a[8:11], v[196:203], v13
    buffer_load_dwordx4 a[56:59], v11, s[16:19], s43 offen offset:2048 sc1
    ds_write_b64 v74, v[56:57]
    s_bcnt1_i32_b64 s30, s[36:37]
    s_lshl3_add_u32 s38, s30, s38
    v_cmp_gt_u32 s[44:45], 2.0, v58
    v_smfmac_f32_16x16x64_bf16 v[168:171], a[8:11], v[228:235], v13
    s_nop 0
    v_mbcnt_lo_u32_b32 v75, s44, 0
    v_mbcnt_hi_u32_b32 v75, s45, v75
    v_lshl_add_u32 v75, v75, 3, s38
    v_min_u32 v75, s39, v75
    s_waitcnt vmcnt(12)
    v_cndmask_b32 v75, v82, v75, s[44:45]
    v_smfmac_f32_16x16x64_bf16 v[136:139], a[12:15], v[196:203], v13 abid:1
    buffer_load_dwordx4 a[60:63], v11, s[16:19], s43 offen offset:3072 sc1
    ds_write_b64 v75, v[58:59]
    s_bcnt1_i32_b64 s30, s[44:45]
    s_lshl3_add_u32 s38, s30, s38
    v_cmp_gt_u32 s[36:37], 2.0, v60
    v_smfmac_f32_16x16x64_bf16 v[172:175], a[12:15], v[228:235], v13 abid:1
    s_nop 0
    v_mbcnt_lo_u32_b32 v74, s36, 0
    v_mbcnt_hi_u32_b32 v74, s37, v74
    v_lshl_add_u32 v74, v74, 3, s38
    s_waitcnt vmcnt(12)
    v_min_u32 v74, s39, v74
    v_smfmac_f32_16x16x64_bf16 v[140:143], a[16:19], v[196:203], v14
    s_add_u32 s43, s43, 4096
    buffer_load_dwordx4 a[64:67], v11, s[16:19], s43 offen offset:0 sc1
    v_cndmask_b32 v74, v82, v74, s[36:37]
    v_smfmac_f32_16x16x64_bf16 v[176:179], a[16:19], v[228:235], v14
    ds_write_b64 v74, v[60:61]
    s_bcnt1_i32_b64 s30, s[36:37]
    s_lshl3_add_u32 s38, s30, s38
    v_cmp_gt_u32 s[44:45], 2.0, v62
    s_nop 1
    v_mbcnt_lo_u32_b32 v75, s44, 0
    s_waitcnt vmcnt(12)
    v_mbcnt_hi_u32_b32 v75, s45, v75
    v_smfmac_f32_16x16x64_bf16 v[144:147], a[20:23], v[196:203], v14 abid:1
    buffer_load_dwordx4 a[68:71], v11, s[16:19], s43 offen offset:1024 sc1
    v_lshl_add_u32 v75, v75, 3, s38
    v_smfmac_f32_16x16x64_bf16 v[180:183], a[20:23], v[228:235], v14 abid:1
    v_min_u32 v75, s39, v75
    s_waitcnt vmcnt(12)
    v_cndmask_b32 v75, v82, v75, s[44:45]
    v_smfmac_f32_16x16x64_bf16 v[148:151], a[24:27], v[196:203], v15
    buffer_load_dwordx4 v[20:23], v11, s[16:19], s43 offen offset:2048 sc1
    buffer_load_dwordx4 a[72:75], v11, s[16:19], s43 offen offset:3072 sc1
    ds_write_b64 v75, v[62:63]
    s_bcnt1_i32_b64 s30, s[44:45]
    s_lshl3_add_u32 s38, s30, s38
    v_cmp_gt_u32 s[36:37], 2.0, v64
    v_smfmac_f32_16x16x64_bf16 v[184:187], a[24:27], v[228:235], v15
    s_nop 0
    v_mbcnt_lo_u32_b32 v74, s36, 0
    v_mbcnt_hi_u32_b32 v74, s37, v74
    v_lshl_add_u32 v74, v74, 3, s38
    v_min_u32 v74, s39, v74
    s_waitcnt vmcnt(13)
    v_cndmask_b32 v74, v82, v74, s[36:37]
    v_smfmac_f32_16x16x64_bf16 v[152:155], a[28:31], v[196:203], v15 abid:1
    s_add_u32 s43, s43, 4096
    buffer_load_dwordx4 a[76:79], v11, s[16:19], s43 offen offset:0 sc1
    ds_write_b64 v74, v[64:65]
    s_bcnt1_i32_b64 s30, s[36:37]
    s_lshl3_add_u32 s38, s30, s38
    v_cmp_gt_u32 s[44:45], 2.0, v66
    v_smfmac_f32_16x16x64_bf16 v[188:191], a[28:31], v[228:235], v15 abid:1
    s_nop 0
    v_mbcnt_lo_u32_b32 v75, s44, 0
    v_mbcnt_hi_u32_b32 v75, s45, v75
    v_lshl_add_u32 v75, v75, 3, s38
    s_waitcnt vmcnt(13)
    v_min_u32 v75, s39, v75
    v_smfmac_f32_16x16x64_bf16 v[156:159], a[32:35], v[196:203], v48
    buffer_load_dwordx4 a[80:83], v11, s[16:19], s43 offen offset:1024 sc1
    v_cndmask_b32 v75, v82, v75, s[44:45]
    v_smfmac_f32_16x16x64_bf16 v[192:195], a[32:35], v[228:235], v48
    ds_write_b64 v75, v[66:67]
    s_bcnt1_i32_b64 s30, s[44:45]
    s_lshl3_add_u32 s38, s30, s38
    v_cmp_gt_u32 s[36:37], 2.0, v68
    s_nop 1
    s_waitcnt vmcnt(12)
    s_waitcnt lgkmcnt(8)
    v_mbcnt_lo_u32_b32 v74, s36, 0
    v_smfmac_f32_16x16x64_bf16 v[124:127], a[36:39], v[204:211], v16
    buffer_load_dwordx4 a[84:87], v11, s[16:19], s43 offen offset:2048 sc1
    s_waitcnt lgkmcnt(6)
    v_mbcnt_hi_u32_b32 v74, s37, v74
    v_smfmac_f32_16x16x64_bf16 v[160:163], a[36:39], v[220:227], v16
    ds_read_b128 v[196:199], v1 offset:2048
    ds_read_b128 v[200:203], v2 offset:2048
    v_lshl_add_u32 v74, v74, 3, s38
    v_min_u32 v74, s39, v74
    s_waitcnt vmcnt(12)
    v_cndmask_b32 v74, v82, v74, s[36:37]
    v_smfmac_f32_16x16x64_bf16 v[128:131], a[40:43], v[204:211], v16 abid:1
    buffer_load_dwordx4 a[88:91], v11, s[16:19], s43 offen offset:3072 sc1
    ds_write_b64 v74, v[68:69]
    s_bcnt1_i32_b64 s30, s[36:37]
    s_lshl3_add_u32 s38, s30, s38
    v_cmp_gt_u32 s[44:45], 2.0, v70
    v_smfmac_f32_16x16x64_bf16 v[164:167], a[40:43], v[220:227], v16 abid:1
    ds_read_b128 v[228:231], v1 offset:20480
    ds_read_b128 v[232:235], v2 offset:20480
    v_mbcnt_lo_u32_b32 v75, s44, 0
    v_mbcnt_hi_u32_b32 v75, s45, v75
    v_lshl_add_u32 v75, v75, 3, s38
    v_min_u32 v75, s39, v75
    s_waitcnt vmcnt(12)
    v_cndmask_b32 v75, v82, v75, s[44:45]
    v_smfmac_f32_16x16x64_bf16 v[132:135], a[44:47], v[204:211], v17
    s_add_u32 s43, s43, 4096
    buffer_load_dwordx4 a[92:95], v11, s[16:19], s43 offen offset:0 sc1
    ds_write_b64 v75, v[70:71]
    s_bcnt1_i32_b64 s30, s[44:45]
    s_lshl3_add_u32 s38, s30, s38
    ds_read_b64 v[56:57], v55 offset:0
    ds_read_b64 v[58:59], v55 offset:512
    ds_read_b64 v[60:61], v55 offset:1024
    v_smfmac_f32_16x16x64_bf16 v[168:171], a[44:47], v[220:227], v17
    s_waitcnt vmcnt(12)
    v_smfmac_f32_16x16x64_bf16 v[136:139], a[48:51], v[204:211], v17 abid:1
    buffer_load_dwordx4 a[96:99], v11, s[16:19], s43 offen offset:1024 sc1
    v_smfmac_f32_16x16x64_bf16 v[172:175], a[48:51], v[220:227], v17 abid:1
    s_waitcnt vmcnt(12)
    v_smfmac_f32_16x16x64_bf16 v[140:143], a[52:55], v[204:211], v18
    buffer_load_dwordx4 a[100:103], v11, s[16:19], s43 offen offset:2048 sc1
    s_waitcnt lgkmcnt(2)
    v_bfe_u32 v74, v56, 24, 4
    v_smfmac_f32_16x16x64_bf16 v[176:179], a[52:55], v[220:227], v18
    v_lshlrev_b32 v75, 1, v56
    v_lshl_add_u32 v74, v74, 2, s49
    v_and_b32 v75, 16, v75
    s_waitcnt vmcnt(12)
    v_and_or_b32 v74, v56, 2.0, v74
    v_smfmac_f32_16x16x64_bf16 v[144:147], a[56:59], v[204:211], v18 abid:1
    buffer_load_dwordx4 a[104:107], v11, s[16:19], s43 offen offset:3072 sc1
    v_lshlrev_b32 v75, v75, 1
    v_smfmac_f32_16x16x64_bf16 v[180:183], a[56:59], v[220:227], v18 abid:1
    ds_add_rtn_u32 v62, v74, v75
    s_waitcnt lgkmcnt(2)
    v_bfe_u32 v76, v58, 24, 4
    v_lshlrev_b32 v77, 1, v58
    v_lshl_add_u32 v76, v76, 2, s49
    s_waitcnt vmcnt(12)
    v_and_b32 v77, 16, v77
    v_smfmac_f32_16x16x64_bf16 v[148:151], a[60:63], v[204:211], v19
    s_add_u32 s43, s43, 4096
    buffer_load_dwordx4 v[24:27], v11, s[16:19], s43 offen offset:0 sc1
    buffer_load_dwordx4 a[108:111], v11, s[16:19], s43 offen offset:1024 sc1
    v_and_or_b32 v76, v58, 2.0, v76
    v_smfmac_f32_16x16x64_bf16 v[184:187], a[60:63], v[220:227], v19
    s_waitcnt vmcnt(13)
    v_lshlrev_b32 v77, v77, 1
    v_smfmac_f32_16x16x64_bf16 v[152:155], a[64:67], v[204:211], v19 abid:1
    buffer_load_dwordx4 a[112:115], v11, s[16:19], s43 offen offset:2048 sc1
    ds_add_rtn_u32 v63, v76, v77
    s_waitcnt lgkmcnt(2)
    s_cmp_gt_u32 s38, s35
    s_cbranch_scc1 M_r3
M_r3r:
    ds_read_b32 v81, v84
    v_and_b32 v74, 8, v56
    v_smfmac_f32_16x16x64_bf16 v[188:191], a[64:67], v[220:227], v19 abid:1
    v_lshrrev_b32 v77, 14, v56
    v_cmp_ne_u32 s[44:45], 0, v74
    v_and_b32 v80, 0x3cf0, v77
    s_waitcnt lgkmcnt(2)
    v_lshrrev_b32 v75, 16, v62
    v_and_b32 v76, 0xffff, v62
    s_waitcnt vmcnt(13)
    v_sub_u32 v74, 15, v75
    v_smfmac_f32_16x16x64_bf16 v[156:159], a[68:71], v[204:211], v48 abid:1
    buffer_load_dwordx4 a[116:119], v11, s[16:19], s43 offen offset:3072 sc1
    v_and_b32 v62, 2.0, v56
    v_smfmac_f32_16x16x64_bf16 v[192:195], a[68:71], v[220:227], v48 abid:1
    v_add3_u32 v62, v76, v75, v62
    v_cndmask_b32 v74, v76, v74, s[44:45]
    v_cmp_gt_u32 s[44:45], 16, v62
    v_cmp_gt_u32 s[36:37], 2.0, v62
    v_lshlrev_b32 v74, 2, v74
    s_waitcnt vmcnt(12)
    v_lshrrev_b64 v[76:77], v74, s[50:51]
    v_smfmac_f32_16x16x64_bf16 v[124:127], a[72:75], v[196:203], v20
    s_add_u32 s43, s43, 4096
    buffer_load_dwordx4 a[120:123], v11, s[16:19], s43 offen offset:0 sc1
    s_andn2_b64 s[36:37], s[36:37], s[44:45]
    v_lshrrev_b64 v[78:79], v74, s[52:53]
    v_smfmac_f32_16x16x64_bf16 v[160:163], a[72:75], v[228:235], v20
    ds_read_b128 v[204:207], v1 offset:3072
    ds_read_b128 v[208:211], v2 offset:3072
    v_bfe_u32 v74, v56, 24, 4
    v_mbcnt_lo_u32_b32 v75, s36, 0
    v_and_b32 v76, 15, v76
    v_mbcnt_hi_u32_b32 v75, s37, v75
    v_and_b32 v78, 15, v78
    s_waitcnt vmcnt(12)
    v_lshl_add_u32 v75, v75, 3, s40
    v_smfmac_f32_16x16x64_bf16 v[128:131], a[76:79], v[196:203], v20 abid:1
    buffer_load_dwordx4 a[124:127], v11, s[16:19], s43 offen offset:1024 sc1
    v_lshl_add_u32 v76, v74, 4, v76
    v_smfmac_f32_16x16x64_bf16 v[164:167], a[76:79], v[228:235], v20 abid:1
    ds_read_b128 v[220:223], v1 offset:21504
    ds_read_b128 v[224:227], v2 offset:21504
    v_min_u32 v75, s41, v75
    v_mul_u32_u24 v78, 68, v78
    s_waitcnt vmcnt(12)
    v_cndmask_b32 v75, v82, v75, s[36:37]
    v_smfmac_f32_16x16x64_bf16 v[132:135], a[80:83], v[196:203], v21
    buffer_load_dwordx4 a[128:131], v11, s[16:19], s43 offen offset:2048 sc1
    ds_write_b64 v75, v[56:57]
    s_bcnt1_i32_b64 s30, s[36:37]
    s_lshl3_add_u32 s40, s30, s40
    v_lshl_add_u32 v76, v76, 2, s47
    v_smfmac_f32_16x16x64_bf16 v[168:171], a[80:83], v[228:235], v21
    v_and_b32 v78, 0x30c, v78
    v_cndmask_b32 v76, v82, v76, s[44:45]
    v_add3_u32 v77, v80, v78, s29
    v_and_b32 v78, 0x3fff, v56
    s_waitcnt vmcnt(12)
    v_cndmask_b32 v74, v82, v77, s[44:45]
    v_smfmac_f32_16x16x64_bf16 v[136:139], a[84:87], v[196:203], v21 abid:1
    buffer_load_dwordx4 a[132:135], v11, s[16:19], s43 offen offset:3072 sc1
    ds_write_b32 v76, v78
    ds_write_b32 v74, v57
    v_and_b32 v74, 8, v58
    v_smfmac_f32_16x16x64_bf16 v[172:175], a[84:87], v[228:235], v21 abid:1
    v_lshrrev_b32 v77, 14, v58
    v_cmp_ne_u32 s[44:45], 0, v74
    v_and_b32 v80, 0x3cf0, v77
    s_waitcnt lgkmcnt(8)
    s_waitcnt vmcnt(12)
    v_lshrrev_b32 v75, 16, v63
    v_smfmac_f32_16x16x64_bf16 v[140:143], a[88:91], v[196:203], v22
    s_add_u32 s43, s43, 4096
    buffer_load_dwordx4 a[136:139], v11, s[16:19], s43 offen offset:0 sc1
    v_and_b32 v76, 0xffff, v63
    v_smfmac_f32_16x16x64_bf16 v[176:179], a[88:91], v[228:235], v22
    v_sub_u32 v74, 15, v75
    v_and_b32 v63, 2.0, v58
    v_add3_u32 v63, v76, v75, v63
    v_cndmask_b32 v74, v76, v74, s[44:45]
    s_waitcnt vmcnt(12)
    v_cmp_gt_u32 s[44:45], 16, v63
    v_smfmac_f32_16x16x64_bf16 v[144:147], a[92:95], v[196:203], v22 abid:1
    buffer_load_dwordx4 a[140:143], v11, s[16:19], s43 offen offset:1024 sc1
    v_cmp_gt_u32 s[36:37], 2.0, v63
    v_smfmac_f32_16x16x64_bf16 v[180:183], a[92:95], v[228:235], v22 abid:1
    v_lshlrev_b32 v74, 2, v74
    s_waitcnt vmcnt(12)
    v_lshrrev_b64 v[76:77], v74, s[50:51]
    v_smfmac_f32_16x16x64_bf16 v[148:151], a[96:99], v[196:203], v23
    buffer_load_dwordx4 v[28:31], v11, s[16:19], s43 offen offset:2048 sc1
    buffer_load_dwordx4 a[144:147], v11, s[16:19], s43 offen offset:3072 sc1
    s_andn2_b64 s[36:37], s[36:37], s[44:45]
    v_lshrrev_b64 v[78:79], v74, s[52:53]
    v_smfmac_f32_16x16x64_bf16 v[184:187], a[96:99], v[228:235], v23
    v_bfe_u32 v74, v58, 24, 4
    v_mbcnt_lo_u32_b32 v75, s36, 0
    v_and_b32 v76, 15, v76
    v_mbcnt_hi_u32_b32 v75, s37, v75
    v_and_b32 v78, 15, v78
    s_waitcnt vmcnt(13)
    v_lshl_add_u32 v75, v75, 3, s40
    v_smfmac_f32_16x16x64_bf16 v[152:155], a[100:103], v[196:203], v23 abid:1
    s_add_u32 s43, s43, 4096
    buffer_load_dwordx4 a[148:151], v11, s[16:19], s43 offen offset:0 sc1
    v_lshl_add_u32 v76, v74, 4, v76
    v_smfmac_f32_16x16x64_bf16 v[188:191], a[100:103], v[228:235], v23 abid:1
    v_min_u32 v75, s41, v75
    v_mul_u32_u24 v78, 68, v78
    s_waitcnt vmcnt(13)
    v_cndmask_b32 v75, v82, v75, s[36:37]
    v_smfmac_f32_16x16x64_bf16 v[156:159], a[104:107], v[196:203], v49
    buffer_load_dwordx4 a[152:155], v11, s[16:19], s43 offen offset:1024 sc1
    ds_write_b64 v75, v[58:59]
    s_bcnt1_i32_b64 s30, s[36:37]
    s_lshl3_add_u32 s40, s30, s40
    v_lshl_add_u32 v76, v76, 2, s47
    v_smfmac_f32_16x16x64_bf16 v[192:195], a[104:107], v[228:235], v49
    v_and_b32 v78, 0x30c, v78
    v_cndmask_b32 v76, v82, v76, s[44:45]
    v_add3_u32 v77, v80, v78, s29
    v_and_b32 v78, 0x3fff, v58
    s_waitcnt vmcnt(12)
    s_waitcnt lgkmcnt(6)
    v_cndmask_b32 v74, v82, v77, s[44:45]
    v_smfmac_f32_16x16x64_bf16 v[124:127], a[108:111], v[204:211], v24
    buffer_load_dwordx4 a[156:159], v11, s[16:19], s43 offen offset:2048 sc1
    ds_write_b32 v76, v78
    ds_write_b32 v74, v59
    s_waitcnt lgkmcnt(6)
    v_lshrrev_b32 v74, 16, v81
    v_smfmac_f32_16x16x64_bf16 v[160:163], a[108:111], v[220:227], v24
    ds_read_b128 v[196:199], v1 offset:4096
    ds_read_b128 v[200:203], v2 offset:4096
    v_and_b32 v81, 0xffff, v81
    v_add_u32 v81, v81, v74
    s_waitcnt vmcnt(12)
    v_cmp_lt_u32 s[34:35], 16, v81
    v_smfmac_f32_16x16x64_bf16 v[128:131], a[112:115], v[204:211], v24 abid:1
    buffer_load_dwordx4 a[160:163], v11, s[16:19], s43 offen offset:3072 sc1
    s_sub_u32 s46, s40, s48
    s_add_u32 s46, s46, 56
    s_lshr_b32 s46, s46, 6
    s_mov_b32 s21, 0
    s_and_b32 s27, s34, 0x1ff
    s_cmp_gt_u32 s46, 4
    s_cselect_b32 s32, 1, s32
    s_or_b32 s32, s32, s33
    s_cbranch_scc1 M_dn
M_dnr:
    ds_read_b128 v[56:59], v9 offset:9792
    s_bcnt1_i32_b32 s30, s27
    s_cmp_gt_u32 s30, 3
    s_cselect_b32 s34, 0, s27
    s_cselect_b32 s80, 0, 1
    s_getpc_b64 s[36:37]
M_pc:
    v_bfe_u32 v74, v11, 4, 4
    v_smfmac_f32_16x16x64_bf16 v[164:167], a[112:115], v[220:227], v24 abid:1
    ds_read_b128 v[228:231], v1 offset:22528
    ds_read_b128 v[232:235], v2 offset:22528
    s_waitcnt vmcnt(12)
    v_smfmac_f32_16x16x64_bf16 v[132:135], a[116:119], v[204:211], v25
    s_add_u32 s43, s43, 4096
    buffer_load_dwordx4 a[164:167], v11, s[16:19], s43 offen offset:0 sc1
    s_ff1_i32_b32 s81, s34
    s_bitset0_b32 s34, s81
    s_mul_i32 s30, s81, 20
    s_add_u32 s31, s30, M_ovc0-M_pc
    s_add_u32 s30, s30, M_ovl0-M_pc
    s_cmp_lg_u32 s34, 0
    s_cselect_b32 s30, s31, s30
    s_cmp_lt_i32 s81, 0
    s_cselect_b32 s30, M_ovn-M_pc, s30
    s_add_u32 s72, s36, s30
    s_addc_u32 s73, s37, 0
    s_ff1_i32_b32 s82, s34
    s_bitset0_b32 s34, s82
    s_mul_i32 s30, s82, 20
    s_add_u32 s31, s30, M_ovc1-M_pc
    s_add_u32 s30, s30, M_ovl1-M_pc
    s_cmp_lg_u32 s34, 0
    s_cselect_b32 s30, s31, s30
    s_cmp_lt_i32 s82, 0
    s_cselect_b32 s30, M_ovn-M_pc, s30
    v_smfmac_f32_16x16x64_bf16 v[168:171], a[116:119], v[220:227], v25
    s_waitcnt vmcnt(12)
    v_smfmac_f32_16x16x64_bf16 v[136:139], a[120:123], v[204:211], v25 abid:1
    buffer_load_dwordx4 a[168:171], v11, s[16:19], s43 offen offset:1024 sc1
    s_add_u32 s74, s36, s30
    s_addc_u32 s75, s37, 0
    s_ff1_i32_b32 s83, s34
    s_bitset0_b32 s34, s83
    s_mul_i32 s30, s83, 20
    s_add_u32 s31, s30, M_ovc1-M_pc
    s_add_u32 s30, s30, M_ovl2-M_pc
    s_cmp_lg_u32 s34, 0
    s_cselect_b32 s30, s31, s30
    s_cmp_lt_i32 s83, 0
    s_cselect_b32 s30, M_ovn-M_pc, s30
    s_add_u32 s76, s36, s30
    s_addc_u32 s77, s37, 0
    s_waitcnt lgkmcnt(2)
    v_lshrrev_b32 v76, 18, v56
    v_smfmac_f32_16x16x64_bf16 v[172:175], a[120:123], v[220:227], v25 abid:1
    s_waitcnt vmcnt(12)
    v_lshrrev_b32 v77, 18, v58
    v_smfmac_f32_16x16x64_bf16 v[140:143], a[124:127], v[204:211], v26
    buffer_load_dwordx4 a[172:175], v11, s[16:19], s43 offen offset:2048 sc1
    v_and_b32 v78, 0x3fff, v56
    v_smfmac_f32_16x16x64_bf16 v[176:179], a[124:127], v[220:227], v26
    s_waitcnt vmcnt(12)
    v_and_b32 v79, 0x3fff, v58
    v_smfmac_f32_16x16x64_bf16 v[144:147], a[128:131], v[204:211], v26 abid:1
    buffer_load_dwordx4 a[176:179], v11, s[16:19], s43 offen offset:3072 sc1
    ds_write_b64 v9, v[78:79] offset:10056
    v_lshl_or_b32 v75, s81, 6, v74
    v_smfmac_f32_16x16x64_bf16 v[180:183], a[128:131], v[220:227], v26 abid:1
    v_cmp_eq_u32 s[44:45], v76, v75
    v_cmp_eq_u32 s[36:37], v77, v75
    s_nop 0
    v_cndmask_b32 v54, 0, v57, s[44:45]
    v_cndmask_b32 v55, 0, v59, s[36:37]
    v_lshl_or_b32 v75, s82, 6, v74
    s_waitcnt vmcnt(12)
    v_cmp_eq_u32 s[44:45], v76, v75
    v_smfmac_f32_16x16x64_bf16 v[148:151], a[132:135], v[204:211], v27
    s_add_u32 s43, s43, 4096
    buffer_load_dwordx4 v[32:35], v11, s[16:19], s43 offen offset:0 sc1
    buffer_load_dwordx4 a[180:183], v11, s[16:19], s43 offen offset:1024 sc1
    v_cmp_eq_u32 s[36:37], v77, v75
    v_smfmac_f32_16x16x64_bf16 v[184:187], a[132:135], v[220:227], v27
    v_cndmask_b32 v252, 0, v57, s[44:45]
    v_cndmask_b32 v253, 0, v59, s[36:37]
    v_lshl_or_b32 v75, s83, 6, v74
    v_cmp_eq_u32 s[44:45], v76, v75
    v_cmp_eq_u32 s[36:37], v77, v75
    s_nop 0
    s_waitcnt vmcnt(13)
    v_cndmask_b32 v254, 0, v57, s[44:45]
    v_smfmac_f32_16x16x64_bf16 v[152:155], a[136:139], v[204:211], v27 abid:1
    buffer_load_dwordx4 a[184:187], v11, s[16:19], s43 offen offset:2048 sc1
    v_cndmask_b32 v255, 0, v59, s[36:37]
    v_smfmac_f32_16x16x64_bf16 v[188:191], a[136:139], v[220:227], v27 abid:1
    ds_read_b128 v[236:239], v9 offset:9408
    ds_read_b64 v[216:217], v9 offset:10056
    s_waitcnt vmcnt(13)
    v_smfmac_f32_16x16x64_bf16 v[156:159], a[140:143], v[204:211], v49 abid:1
    buffer_load_dwordx4 a[188:191], v11, s[16:19], s43 offen offset:3072 sc1
    s_waitcnt lgkmcnt(1)
    v_xad_u32 v236, v236, v3, v4
    v_smfmac_f32_16x16x64_bf16 v[192:195], a[140:143], v[220:227], v49 abid:1
    s_waitcnt vmcnt(12)
    v_xad_u32 v237, v237, v3, v4
    v_smfmac_f32_16x16x64_bf16 v[124:127], a[144:147], v[196:203], v28
    s_add_u32 s43, s43, 4096
    buffer_load_dwordx4 a[192:195], v11, s[16:19], s43 offen offset:0 sc1
    ds_read2st64_b32 v[244:245], v236 offset0:0 offset1:72
    ds_read2st64_b32 v[246:247], v237 offset0:0 offset1:72
    v_xad_u32 v238, v238, v3, v4
    v_smfmac_f32_16x16x64_bf16 v[160:163], a[144:147], v[228:235], v28
    ds_read_b128 v[204:207], v1 offset:5120
    ds_read_b128 v[208:211], v2 offset:5120
    s_waitcnt vmcnt(12)
    v_xad_u32 v239, v239, v3, v4
    v_smfmac_f32_16x16x64_bf16 v[128:131], a[148:151], v[196:203], v28 abid:1
    buffer_load_dwordx4 a[196:199], v11, s[16:19], s43 offen offset:1024 sc1
    ds_read2st64_b32 v[248:249], v238 offset0:0 offset1:72
    ds_read2st64_b32 v[250:251], v239 offset0:0 offset1:72
    ds_read_b128 v[240:243], v8 offset:3072
    ds_read_b128 v[236:239], v9 offset:9280
    s_waitcnt lgkmcnt(8)
    v_xad_u32 v212, v216, v3, v4
    v_smfmac_f32_16x16x64_bf16 v[164:167], a[148:151], v[228:235], v28 abid:1
    ds_read_b128 v[220:223], v1 offset:23552
    ds_read_b128 v[224:227], v2 offset:23552
    ds_read2st64_b32 v[212:213], v212 offset0:0 offset1:72
    s_waitcnt vmcnt(12)
    v_xad_u32 v214, v217, v3, v4
    v_smfmac_f32_16x16x64_bf16 v[132:135], a[152:155], v[196:203], v29
    buffer_load_dwordx4 a[200:203], v11, s[16:19], s43 offen offset:2048 sc1
    ds_read2st64_b32 v[214:215], v214 offset0:0 offset1:72
    v_smfmac_f32_16x16x64_bf16 v[168:171], a[152:155], v[228:235], v29
    s_waitcnt vmcnt(12)
    v_smfmac_f32_16x16x64_bf16 v[136:139], a[156:159], v[196:203], v29 abid:1
    buffer_load_dwordx4 a[204:207], v11, s[16:19], s43 offen offset:3072 sc1
    v_smfmac_f32_16x16x64_bf16 v[172:175], a[156:159], v[228:235], v29 abid:1
    s_waitcnt vmcnt(12)
    v_smfmac_f32_16x16x64_bf16 v[140:143], a[160:163], v[196:203], v30
    s_add_u32 s43, s43, 4096
    buffer_load_dwordx4 a[208:211], v11, s[16:19], s43 offen offset:0 sc1
    s_waitcnt lgkmcnt(5)
    v_smfmac_f32_16x16x64_bf16 v[136:139], v[240:243], v[244:251], v10
    v_smfmac_f32_16x16x64_bf16 v[172:175], v[240:243], v[244:251], v10 abid:1
    s_waitcnt lgkmcnt(4)
    v_xad_u32 v236, v236, v3, v4
    v_smfmac_f32_16x16x64_bf16 v[176:179], a[160:163], v[228:235], v30
    s_waitcnt vmcnt(12)
    v_xad_u32 v237, v237, v3, v4
    v_smfmac_f32_16x16x64_bf16 v[144:147], a[164:167], v[196:203], v30 abid:1
    buffer_load_dwordx4 a[212:215], v11, s[16:19], s43 offen offset:1024 sc1
    ds_read2st64_b32 v[244:245], v236 offset0:0 offset1:72
    ds_read2st64_b32 v[246:247], v237 offset0:0 offset1:72
    v_xad_u32 v238, v238, v3, v4
    v_smfmac_f32_16x16x64_bf16 v[180:183], a[164:167], v[228:235], v30 abid:1
    s_waitcnt vmcnt(12)
    v_xad_u32 v239, v239, v3, v4
    v_smfmac_f32_16x16x64_bf16 v[148:151], a[168:171], v[196:203], v31
    buffer_load_dwordx4 v[36:39], v11, s[16:19], s43 offen offset:2048 sc1
    buffer_load_dwordx4 a[216:219], v11, s[16:19], s43 offen offset:3072 sc1
    ds_read2st64_b32 v[248:249], v238 offset0:0 offset1:72
    ds_read2st64_b32 v[250:251], v239 offset0:0 offset1:72
    ds_read_b128 v[240:243], v8 offset:1024
    ds_read_b128 v[236:239], v9 offset:9344
    v_smfmac_f32_16x16x64_bf16 v[184:187], a[168:171], v[228:235], v31
    s_waitcnt vmcnt(13)
    v_smfmac_f32_16x16x64_bf16 v[152:155], a[172:175], v[196:203], v31 abid:1
    s_add_u32 s43, s43, 4096
    buffer_load_dwordx4 a[220:223], v11, s[16:19], s43 offen offset:0 sc1
    s_waitcnt lgkmcnt(6)
    s_cmp_lt_i32 s81, 0
    s_cbranch_scc1 M_ovr0
    s_swappc_b64 s[78:79], s[72:73]
M_ovr0:
    v_smfmac_f32_16x16x64_bf16 v[188:191], a[172:175], v[228:235], v31 abid:1
    s_waitcnt vmcnt(13)
    v_smfmac_f32_16x16x64_bf16 v[156:159], a[176:179], v[196:203], v50
    buffer_load_dwordx4 a[224:227], v11, s[16:19], s43 offen offset:1024 sc1
    v_smfmac_f32_16x16x64_bf16 v[192:195], a[176:179], v[228:235], v50
    s_waitcnt vmcnt(12)
    v_smfmac_f32_16x16x64_bf16 v[124:127], a[180:183], v[204:211], v32
    buffer_load_dwordx4 a[228:231], v11, s[16:19], s43 offen offset:2048 sc1
    s_waitcnt lgkmcnt(1)
    v_smfmac_f32_16x16x64_bf16 v[128:131], v[240:243], v[244:251], v10
    v_smfmac_f32_16x16x64_bf16 v[164:167], v[240:243], v[244:251], v10 abid:1
    s_waitcnt lgkmcnt(0)
    v_xad_u32 v236, v236, v3, v4
    v_smfmac_f32_16x16x64_bf16 v[160:163], a[180:183], v[220:227], v32
    ds_read_b128 v[196:199], v1 offset:6144
    ds_read_b128 v[200:203], v2 offset:6144
    s_waitcnt vmcnt(12)
    v_xad_u32 v237, v237, v3, v4
    v_smfmac_f32_16x16x64_bf16 v[128:131], a[184:187], v[204:211], v32 abid:1
    buffer_load_dwordx4 a[232:235], v11, s[16:19], s43 offen offset:3072 sc1
    ds_read2st64_b32 v[244:245], v236 offset0:0 offset1:72
    ds_read2st64_b32 v[246:247], v237 offset0:0 offset1:72
    v_xad_u32 v238, v238, v3, v4
    v_smfmac_f32_16x16x64_bf16 v[164:167], a[184:187], v[220:227], v32 abid:1
    ds_read_b128 v[228:231], v1 offset:24576
    ds_read_b128 v[232:235], v2 offset:24576
    s_waitcnt vmcnt(12)
    v_xad_u32 v239, v239, v3, v4
    v_smfmac_f32_16x16x64_bf16 v[132:135], a[188:191], v[204:211], v33
    s_add_u32 s43, s43, 4096
    buffer_load_dwordx4 a[236:239], v11, s[16:19], s43 offen offset:0 sc1
    ds_read2st64_b32 v[248:249], v238 offset0:0 offset1:72
    ds_read2st64_b32 v[250:251], v239 offset0:0 offset1:72
    ds_read_b128 v[240:243], v8 offset:2048
    ds_read_b128 v[236:239], v9 offset:9216
    v_smfmac_f32_16x16x64_bf16 v[168:171], a[188:191], v[220:227], v33
    s_waitcnt vmcnt(12)
    v_smfmac_f32_16x16x64_bf16 v[136:139], a[192:195], v[204:211], v33 abid:1
    buffer_load_dwordx4 a[240:243], v11, s[16:19], s43 offen offset:1024 sc1
    v_smfmac_f32_16x16x64_bf16 v[172:175], a[192:195], v[220:227], v33 abid:1
    s_waitcnt vmcnt(12)
    v_smfmac_f32_16x16x64_bf16 v[140:143], a[196:199], v[204:211], v34
    buffer_load_dwordx4 a[244:247], v11, s[16:19], s43 offen offset:2048 sc1
    v_smfmac_f32_16x16x64_bf16 v[176:179], a[196:199], v[220:227], v34
    s_waitcnt vmcnt(12)
    v_smfmac_f32_16x16x64_bf16 v[144:147], a[200:203], v[204:211], v34 abid:1
    buffer_load_dwordx4 a[248:251], v11, s[16:19], s43 offen offset:3072 sc1
    s_waitcnt lgkmcnt(1)
    v_smfmac_f32_16x16x64_bf16 v[132:135], v[240:243], v[244:251], v10
    v_smfmac_f32_16x16x64_bf16 v[168:171], v[240:243], v[244:251], v10 abid:1
    s_waitcnt lgkmcnt(0)
    v_xad_u32 v236, v236, v3, v4
    v_smfmac_f32_16x16x64_bf16 v[180:183], a[200:203], v[220:227], v34 abid:1
    s_waitcnt vmcnt(12)
    v_xad_u32 v237, v237, v3, v4
    v_smfmac_f32_16x16x64_bf16 v[148:151], a[204:207], v[204:211], v35
    s_add_u32 s43, s43, 4096
    buffer_load_dwordx4 v[40:43], v11, s[16:19], s43 offen offset:0 sc1
    buffer_load_dwordx4 a[252:255], v11, s[16:19], s43 offen offset:1024 sc1
    ds_read2st64_b32 v[244:245], v236 offset0:0 offset1:72
    ds_read2st64_b32 v[246:247], v237 offset0:0 offset1:72
    v_xad_u32 v238, v238, v3, v4
    v_smfmac_f32_16x16x64_bf16 v[184:187], a[204:207], v[220:227], v35
    s_waitcnt vmcnt(13)
    v_xad_u32 v239, v239, v3, v4
    v_smfmac_f32_16x16x64_bf16 v[152:155], a[208:211], v[204:211], v35 abid:1
    buffer_load_dwordx4 v[56:59], v11, s[16:19], s43 offen offset:2048 sc1
    ds_read2st64_b32 v[248:249], v238 offset0:0 offset1:72
    ds_read2st64_b32 v[250:251], v239 offset0:0 offset1:72
    ds_read_b128 v[240:243], v8 offset:0
    ds_read_b128 v[236:239], v9 offset:9728
    v_smfmac_f32_16x16x64_bf16 v[188:191], a[208:211], v[220:227], v35 abid:1
    s_waitcnt vmcnt(13)
    v_smfmac_f32_16x16x64_bf16 v[156:159], a[212:215], v[204:211], v50 abid:1
    buffer_load_dwordx4 v[60:63], v11, s[16:19], s43 offen offset:3072 sc1
    v_smfmac_f32_16x16x64_bf16 v[192:195], a[212:215], v[220:227], v50 abid:1
    s_waitcnt vmcnt(12)
    v_smfmac_f32_16x16x64_bf16 v[124:127], a[216:219], v[196:203], v36
    s_add_u32 s43, s43, 4096
    buffer_load_dwordx4 v[64:67], v11, s[16:19], s43 offen offset:0 sc1
    v_smfmac_f32_16x16x64_bf16 v[160:163], a[216:219], v[228:235], v36
    ds_read_b128 v[204:207], v1 offset:7168
    ds_read_b128 v[208:211], v2 offset:7168
    s_waitcnt vmcnt(12)
    v_smfmac_f32_16x16x64_bf16 v[128:131], a[220:223], v[196:203], v36 abid:1
    buffer_load_dwordx4 v[68:71], v11, s[16:19], s43 offen offset:1024 sc1
    s_waitcnt lgkmcnt(3)
    v_smfmac_f32_16x16x64_bf16 v[124:127], v[240:243], v[244:251], v10
    v_smfmac_f32_16x16x64_bf16 v[160:163], v[240:243], v[244:251], v10 abid:1
    s_waitcnt lgkmcnt(2)
    v_xad_u32 v236, v236, v3, v4
    v_smfmac_f32_16x16x64_bf16 v[164:167], a[220:223], v[228:235], v36 abid:1
    ds_read_b128 v[220:223], v1 offset:25600
    ds_read_b128 v[224:227], v2 offset:25600
    s_waitcnt vmcnt(12)
    v_xad_u32 v237, v237, v3, v4
    v_smfmac_f32_16x16x64_bf16 v[132:135], a[224:227], v[196:203], v37
    buffer_load_dwordx4 v[72:75], v11, s[16:19], s43 offen offset:2048 sc1
    ds_read2st64_b32 v[244:245], v236 offset0:0 offset1:72
    ds_read2st64_b32 v[246:247], v237 offset0:0 offset1:72
    v_xad_u32 v238, v238, v3, v4
    v_smfmac_f32_16x16x64_bf16 v[168:171], a[224:227], v[228:235], v37
    s_waitcnt vmcnt(12)
    v_xad_u32 v239, v239, v3, v4
    v_smfmac_f32_16x16x64_bf16 v[136:139], a[228:231], v[196:203], v37 abid:1
    buffer_load_dwordx4 v[76:79], v11, s[16:19], s43 offen offset:3072 sc1
    ds_read2st64_b32 v[248:249], v238 offset0:0 offset1:72
    ds_read2st64_b32 v[250:251], v239 offset0:0 offset1:72
    ds_read_b128 v[240:243], v8 offset:8192
    ds_read_b128 v[236:239], v9 offset:9664
    v_smfmac_f32_16x16x64_bf16 v[172:175], a[228:231], v[228:235], v37 abid:1
    s_waitcnt vmcnt(12)
    v_smfmac_f32_16x16x64_bf16 v[140:143], a[232:235], v[196:203], v38
    s_add_u32 s43, s43, 4096
    buffer_load_dwordx4 v[80:83], v11, s[16:19], s43 offen offset:0 sc1
    v_smfmac_f32_16x16x64_bf16 v[176:179], a[232:235], v[228:235], v38
    s_waitcnt vmcnt(12)
    v_smfmac_f32_16x16x64_bf16 v[144:147], a[236:239], v[196:203], v38 abid:1
    buffer_load_dwordx4 v[84:87], v11, s[16:19], s43 offen offset:1024 sc1
    v_smfmac_f32_16x16x64_bf16 v[180:183], a[236:239], v[228:235], v38 abid:1
    s_waitcnt vmcnt(12)
    v_smfmac_f32_16x16x64_bf16 v[148:151], a[240:243], v[196:203], v39
    buffer_load_dwordx4 v[44:47], v11, s[16:19], s43 offen offset:2048 sc1
    buffer_load_dwordx4 v[88:91], v11, s[16:19], s43 offen offset:3072 sc1
    s_waitcnt lgkmcnt(1)
    v_smfmac_f32_16x16x64_bf16 v[156:159], v[240:243], v[244:251], v10
    v_smfmac_f32_16x16x64_bf16 v[192:195], v[240:243], v[244:251], v10 abid:1
    s_waitcnt lgkmcnt(0)
    v_xad_u32 v236, v236, v3, v4
    v_smfmac_f32_16x16x64_bf16 v[184:187], a[240:243], v[228:235], v39
    s_waitcnt vmcnt(13)
    v_xad_u32 v237, v237, v3, v4
    v_smfmac_f32_16x16x64_bf16 v[152:155], a[244:247], v[196:203], v39 abid:1
    s_add_u32 s43, s43, 4096
    buffer_load_dwordx4 v[92:95], v11, s[16:19], s43 offen offset:0 sc1
    ds_read2st64_b32 v[244:245], v236 offset0:0 offset1:72
    ds_read2st64_b32 v[246:247], v237 offset0:0 offset1:72
    v_xad_u32 v238, v238, v3, v4
    v_smfmac_f32_16x16x64_bf16 v[188:191], a[244:247], v[228:235], v39 abid:1
    s_waitcnt vmcnt(13)
    v_xad_u32 v239, v239, v3, v4
    v_smfmac_f32_16x16x64_bf16 v[156:159], a[248:251], v[196:203], v51
    buffer_load_dwordx4 v[96:99], v11, s[16:19], s43 offen offset:1024 sc1
    ds_read2st64_b32 v[248:249], v238 offset0:0 offset1:72
    ds_read2st64_b32 v[250:251], v239 offset0:0 offset1:72
    ds_read_b128 v[240:243], v8 offset:7168
    ds_read_b128 v[236:239], v9 offset:9536
    v_smfmac_f32_16x16x64_bf16 v[192:195], a[248:251], v[228:235], v51
    s_waitcnt vmcnt(12)
    v_smfmac_f32_16x16x64_bf16 v[124:127], a[252:255], v[204:211], v40
    buffer_load_dwordx4 v[100:103], v11, s[16:19], s43 offen offset:2048 sc1
    ds_read_b128 v[196:199], v1 offset:8192
    ds_read_b128 v[200:203], v2 offset:8192
    s_waitcnt vmcnt(12)
    v_smfmac_f32_16x16x64_bf16 v[128:131], v[56:59], v[204:211], v40 abid:1
    buffer_load_dwordx4 v[104:107], v11, s[16:19], s43 offen offset:3072 sc1
    ds_read_b128 v[228:231], v1 offset:26624
    ds_read_b128 v[232:235], v2 offset:26624
    s_waitcnt vmcnt(12)
    v_smfmac_f32_16x16x64_bf16 v[132:135], v[60:63], v[204:211], v41
    s_add_u32 s43, s43, 4096
    buffer_load_dwordx4 v[108:111], v11, s[16:19], s43 offen offset:0 sc1
    s_waitcnt lgkmcnt(5)
    v_smfmac_f32_16x16x64_bf16 v[152:155], v[240:243], v[244:251], v10
    v_smfmac_f32_16x16x64_bf16 v[188:191], v[240:243], v[244:251], v10 abid:1
    s_waitcnt lgkmcnt(4)
    v_xad_u32 v236, v236, v3, v4
    s_waitcnt vmcnt(12)
    v_xad_u32 v237, v237, v3, v4
    v_smfmac_f32_16x16x64_bf16 v[136:139], v[64:67], v[204:211], v41 abid:1
    buffer_load_dwordx4 v[112:115], v11, s[16:19], s43 offen offset:1024 sc1
    ds_read2st64_b32 v[244:245], v236 offset0:0 offset1:72
    ds_read2st64_b32 v[246:247], v237 offset0:0 offset1:72
    v_xad_u32 v238, v238, v3, v4
    s_waitcnt vmcnt(12)
    v_xad_u32 v239, v239, v3, v4
    v_smfmac_f32_16x16x64_bf16 v[140:143], v[68:71], v[204:211], v42
    buffer_load_dwordx4 v[116:119], v11, s[16:19], s43 offen offset:2048 sc1
    ds_read2st64_b32 v[248:249], v238 offset0:0 offset1:72
    ds_read2st64_b32 v[250:251], v239 offset0:0 offset1:72
    ds_read_b128 v[240:243], v8 offset:5120
    ds_read_b128 v[236:239], v9 offset:9600
    s_waitcnt vmcnt(12)
    v_smfmac_f32_16x16x64_bf16 v[144:147], v[72:75], v[204:211], v42 abid:1
    buffer_load_dwordx4 v[120:123], v11, s[16:19], s43 offen offset:3072 sc1
    s_waitcnt vmcnt(12)
    v_smfmac_f32_16x16x64_bf16 v[148:151], v[76:79], v[204:211], v43
    s_add_u32 m0, s29, 11840
    s_nop 0
    buffer_load_dword v0, s[8:11], 0 offen lds
    s_mov_b32 m0, s42
    s_nop 0
    buffer_load_dwordx4 v5, s[8:11], s22 offen offset:0 nt lds
    s_waitcnt vmcnt(13)
    v_smfmac_f32_16x16x64_bf16 v[152:155], v[80:83], v[204:211], v43 abid:1
    s_add_u32 m0, m0, 896
    s_nop 0
    buffer_load_dwordx4 v5, s[8:11], s22 offen offset:128 nt lds
    s_waitcnt lgkmcnt(1)
    v_smfmac_f32_16x16x64_bf16 v[144:147], v[240:243], v[244:251], v10
    v_smfmac_f32_16x16x64_bf16 v[180:183], v[240:243], v[244:251], v10 abid:1
    s_waitcnt lgkmcnt(0)
    v_xad_u32 v236, v236, v3, v4
    s_waitcnt vmcnt(13)
    v_xad_u32 v237, v237, v3, v4
    v_smfmac_f32_16x16x64_bf16 v[156:159], v[84:87], v[204:211], v51 abid:1
    s_add_u32 m0, m0, 896
    s_nop 0
    buffer_load_dwordx4 v5, s[8:11], s22 offen offset:256 nt lds
    ds_read2st64_b32 v[244:245], v236 offset0:0 offset1:72
    ds_read2st64_b32 v[246:247], v237 offset0:0 offset1:72
    v_xad_u32 v238, v238, v3, v4
    s_waitcnt vmcnt(12)
    v_xad_u32 v239, v239, v3, v4
    v_smfmac_f32_16x16x64_bf16 v[124:127], v[88:91], v[196:203], v44
    s_add_u32 m0, m0, 896
    s_nop 0
    buffer_load_dwordx4 v5, s[8:11], s22 offen offset:384 nt lds
    ds_read2st64_b32 v[248:249], v238 offset0:0 offset1:72
    ds_read2st64_b32 v[250:251], v239 offset0:0 offset1:72
    ds_read_b128 v[240:243], v8 offset:6144
    ds_read_b128 v[236:239], v9 offset:9472
    s_waitcnt vmcnt(12)
    v_smfmac_f32_16x16x64_bf16 v[128:131], v[92:95], v[196:203], v44 abid:1
    s_waitcnt vmcnt(11)
    v_smfmac_f32_16x16x64_bf16 v[132:135], v[96:99], v[196:203], v45
    s_waitcnt vmcnt(10)
    v_smfmac_f32_16x16x64_bf16 v[136:139], v[100:103], v[196:203], v45 abid:1
    s_waitcnt lgkmcnt(1)
    v_smfmac_f32_16x16x64_bf16 v[148:151], v[240:243], v[244:251], v10
    v_smfmac_f32_16x16x64_bf16 v[184:187], v[240:243], v[244:251], v10 abid:1
    s_waitcnt lgkmcnt(0)
    v_xad_u32 v236, v236, v3, v4
    s_waitcnt vmcnt(9)
    v_xad_u32 v237, v237, v3, v4
    v_smfmac_f32_16x16x64_bf16 v[140:143], v[104:107], v[196:203], v46
    ds_read2st64_b32 v[244:245], v236 offset0:0 offset1:72
    ds_read2st64_b32 v[246:247], v237 offset0:0 offset1:72
    v_xad_u32 v238, v238, v3, v4
    s_waitcnt vmcnt(8)
    v_xad_u32 v239, v239, v3, v4
    v_smfmac_f32_16x16x64_bf16 v[144:147], v[108:111], v[196:203], v46 abid:1
    ds_read2st64_b32 v[248:249], v238 offset0:0 offset1:72
    ds_read2st64_b32 v[250:251], v239 offset0:0 offset1:72
    ds_read_b128 v[240:243], v8 offset:4096
    s_waitcnt vmcnt(7)
    v_smfmac_f32_16x16x64_bf16 v[148:151], v[112:115], v[196:203], v47
    s_waitcnt vmcnt(6)
    v_smfmac_f32_16x16x64_bf16 v[152:155], v[116:119], v[196:203], v47 abid:1
    s_waitcnt vmcnt(5)
    v_smfmac_f32_16x16x64_bf16 v[156:159], v[120:123], v[196:203], v52
    s_waitcnt lgkmcnt(0)
    v_smfmac_f32_16x16x64_bf16 v[140:143], v[240:243], v[244:251], v10
    v_smfmac_f32_16x16x64_bf16 v[176:179], v[240:243], v[244:251], v10 abid:1
    s_cmp_gt_u32 s46, s80
    s_cbranch_scc1 M_slow
M_slowr0:
    s_cmp_eq_u32 s20, 0
    s_mov_b32 s31, 1073903880
    s_cselect_b32 s30, 162048, s31
    v_mov_b32 v11, s31
    v_writelane_b32 v11, s30, 0
    v_cvt_pk_bf16_f32 v124, v124, v125
    v_cvt_pk_bf16_f32 v125, v126, v127
    v_cvt_pk_bf16_f32 v126, v128, v129
    v_cvt_pk_bf16_f32 v127, v130, v131
    v_cvt_pk_bf16_f32 v132, v132, v133
    v_cvt_pk_bf16_f32 v133, v134, v135
    v_cvt_pk_bf16_f32 v134, v136, v137
    v_cvt_pk_bf16_f32 v135, v138, v139
    ds_read_b128 v[136:139], v9 offset:10432
    v_cndmask_b32_dpp v128, v124, v132, vcc row_ror:8 row_mask:0xf bank_mask:0xf
    v_cndmask_b32_dpp v129, v125, v133, vcc row_ror:8 row_mask:0xf bank_mask:0xf
    v_cndmask_b32_dpp v130, v126, v134, vcc row_ror:8 row_mask:0xf bank_mask:0xf
    v_cndmask_b32_dpp v131, v127, v135, vcc row_ror:8 row_mask:0xf bank_mask:0xf
    buffer_store_dwordx4 v[128:131], v6, s[12:15], s59 offen offset:0 sc1
    v_mov_b32_dpp v124, v132 row_ror:8 row_mask:0xf bank_mask:0xc
    v_mov_b32_dpp v125, v133 row_ror:8 row_mask:0xf bank_mask:0xc
    v_mov_b32_dpp v126, v134 row_ror:8 row_mask:0xf bank_mask:0xc
    v_mov_b32_dpp v127, v135 row_ror:8 row_mask:0xf bank_mask:0xc
    buffer_store_dwordx4 v[124:127], v6, s[12:15], s24 offen offset:0 sc1
    ds_read_b128 v[128:131], v9 offset:10304
    ds_read_b128 v[132:135], v9 offset:10368
    ds_read_b128 v[124:127], v9 offset:10240
    v_cvt_pk_bf16_f32 v140, v140, v141
    v_cvt_pk_bf16_f32 v141, v142, v143
    v_cvt_pk_bf16_f32 v142, v144, v145
    v_cvt_pk_bf16_f32 v143, v146, v147
    v_cvt_pk_bf16_f32 v148, v148, v149
    v_cvt_pk_bf16_f32 v149, v150, v151
    v_cvt_pk_bf16_f32 v150, v152, v153
    v_cvt_pk_bf16_f32 v151, v154, v155
    ds_read_b128 v[152:155], v9 offset:10688
    v_cndmask_b32_dpp v144, v140, v148, vcc row_ror:8 row_mask:0xf bank_mask:0xf
    v_cndmask_b32_dpp v145, v141, v149, vcc row_ror:8 row_mask:0xf bank_mask:0xf
    v_cndmask_b32_dpp v146, v142, v150, vcc row_ror:8 row_mask:0xf bank_mask:0xf
    v_cndmask_b32_dpp v147, v143, v151, vcc row_ror:8 row_mask:0xf bank_mask:0xf
    buffer_store_dwordx4 v[144:147], v6, s[12:15], s59 offen offset:128 sc1
    v_mov_b32_dpp v140, v148 row_ror:8 row_mask:0xf bank_mask:0xc
    v_mov_b32_dpp v141, v149 row_ror:8 row_mask:0xf bank_mask:0xc
    v_mov_b32_dpp v142, v150 row_ror:8 row_mask:0xf bank_mask:0xc
    v_mov_b32_dpp v143, v151 row_ror:8 row_mask:0xf bank_mask:0xc
    buffer_store_dwordx4 v[140:143], v6, s[12:15], s24 offen offset:128 sc1
    ds_read_b128 v[144:147], v9 offset:10560
    ds_read_b128 v[148:151], v9 offset:10624
    ds_read_b128 v[140:143], v9 offset:10496
    v_cvt_pk_bf16_f32 v156, v156, v157
    v_cvt_pk_bf16_f32 v157, v158, v159
    ds_write_b64 v53, v[156:157] offset:25728
    ds_read_b128 v[156:159], v9 offset:10752
    s_mov_b32 s89, 0
    s_mov_b32 s101, 34209792
    s_mov_b32 s91, 0
    s_mov_b32 s25, 36864
    s_add_u32 s90, s24, 9437184
    s_mov_b32 s28, s26
    s_add_u32 s23, s24, 18432
    s_cmp_lt_u32 s20, 2
    s_cselect_b32 s66, s23, s24
    s_add_u32 s66, s66, s95
    v_add_u32 v4, 36864, v4
    v_add_u32 v1, 36864, v1
    v_add_u32 v2, 36864, v2
M_top:
M_top1:
    s_add_u32 s23, s24, 18432
    s_add_u32 s58, s24, 27648
    s_mov_b32 s24, s90
    s_add_u32 s59, s90, 9216
    s_waitcnt lgkmcnt(0)
    s_barrier
    ds_read_b128 v[244:247], v8 offset:10816
    v_smfmac_f32_16x16x64_bf16 v[160:163], a[252:255], v[220:227], v40
    ds_read_b128 v[196:199], v1 offset:0
    v_smfmac_f32_16x16x64_bf16 v[160:163], v[88:91], v[228:235], v44
    ds_read_b128 v[200:203], v2 offset:0
    s_cmp_lt_u32 s22, 75497472
    s_cbranch_scc0 M_bF
    s_cmp_lt_u32 s91, 2
    s_cbranch_scc1 M_bE0
M_bL:
    v_smfmac_f32_16x16x64_bf16 v[164:167], v[56:59], v[220:227], v40 abid:1
    ds_read_b128 v[204:207], v1 offset:1024
    v_smfmac_f32_16x16x64_bf16 v[164:167], v[92:95], v[228:235], v44 abid:1
    ds_read_b128 v[208:211], v2 offset:1024
    v_mov_b32 v0, 1
    v_smfmac_f32_16x16x64_bf16 v[168:171], v[60:63], v[220:227], v41
    ds_read_b128 v[212:215], v1 offset:2048
    v_smfmac_f32_16x16x64_bf16 v[168:171], v[96:99], v[228:235], v45
    ds_read_b128 v[216:219], v2 offset:2048
    v_smfmac_f32_16x16x64_bf16 v[172:175], v[64:67], v[220:227], v41 abid:1
    s_waitcnt vmcnt(6)
    s_waitcnt lgkmcnt(6)
    buffer_store_dwordx4 v[244:247], v7, s[12:15], s66 offen sc1
    v_smfmac_f32_16x16x64_bf16 v[172:175], v[100:103], v[228:235], v45 abid:1
    ds_read_b128 v[236:239], v9 offset:9408
    v_smfmac_f32_16x16x64_bf16 v[176:179], v[68:71], v[220:227], v42
    s_waitcnt vmcnt(7)
    buffer_atomic_add v0, v11, s[16:19], s92 offen sc0 sc1
    s_mov_b32 s21, 1
    v_smfmac_f32_16x16x64_bf16 v[176:179], v[104:107], v[228:235], v46
    v_smfmac_f32_16x16x64_bf16 v[180:183], v[72:75], v[220:227], v42 abid:1
    v_cvt_pk_bf16_f32 v160, v160, v161
    v_smfmac_f32_16x16x64_bf16 v[180:183], v[108:111], v[228:235], v46 abid:1
    v_cvt_pk_bf16_f32 v161, v162, v163
    v_smfmac_f32_16x16x64_bf16 v[184:187], v[76:79], v[220:227], v43
    v_cvt_pk_bf16_f32 v162, v164, v165
    v_smfmac_f32_16x16x64_bf16 v[184:187], v[112:115], v[228:235], v47
    v_cvt_pk_bf16_f32 v163, v166, v167
    v_smfmac_f32_16x16x64_bf16 v[188:191], v[80:83], v[220:227], v43 abid:1
    s_add_u32 m0, m0, 896
    v_cvt_pk_bf16_f32 v168, v168, v169
    v_smfmac_f32_16x16x64_bf16 v[188:191], v[116:119], v[228:235], v47 abid:1
    s_waitcnt vmcnt(6)
    buffer_load_dwordx4 v5, s[8:11], s22 offen offset:512 nt lds
    v_cvt_pk_bf16_f32 v169, v170, v171
    v_smfmac_f32_16x16x64_bf16 v[192:195], v[84:87], v[220:227], v51 abid:1
    v_cvt_pk_bf16_f32 v170, v172, v173
    v_smfmac_f32_16x16x64_bf16 v[192:195], v[120:123], v[228:235], v52
    ds_read_b128 v[220:223], v1 offset:3072
    s_waitcnt lgkmcnt(6)
    v_cvt_pk_bf16_f32 v171, v174, v175
    v_smfmac_f32_16x16x64_bf16 v[124:127], a[0:3], v[196:203], v12
    ds_read_b128 v[224:227], v2 offset:3072
    ds_read_b128 v[172:175], v9 offset:10432
    s_waitcnt lgkmcnt(6)
    v_cndmask_b32_dpp v164, v160, v168, vcc row_ror:8 row_mask:0xf bank_mask:0xf
    v_smfmac_f32_16x16x64_bf16 v[124:127], a[36:39], v[204:211], v16
    ds_read_b128 v[228:231], v1 offset:4096
    s_waitcnt lgkmcnt(5)
    v_cndmask_b32_dpp v165, v161, v169, vcc row_ror:8 row_mask:0xf bank_mask:0xf
    v_smfmac_f32_16x16x64_bf16 v[124:127], a[72:75], v[212:219], v20
    ds_read_b128 v[232:235], v2 offset:4096
    v_cndmask_b32_dpp v166, v162, v170, vcc row_ror:8 row_mask:0xf bank_mask:0xf
    v_smfmac_f32_16x16x64_bf16 v[128:131], a[4:7], v[196:203], v12 abid:1
    s_barrier
    v_cndmask_b32_dpp v167, v163, v171, vcc row_ror:8 row_mask:0xf bank_mask:0xf
    v_smfmac_f32_16x16x64_bf16 v[128:131], a[40:43], v[204:211], v16 abid:1
    s_waitcnt vmcnt(7)
    buffer_store_dwordx4 v[164:167], v6, s[12:15], s58 offen offset:0 sc1
    s_waitcnt lgkmcnt(5)
    v_xad_u32 v236, v236, v3, v4
    v_smfmac_f32_16x16x64_bf16 v[128:131], a[76:79], v[212:219], v20 abid:1
    v_xad_u32 v237, v237, v3, v4
    v_smfmac_f32_16x16x64_bf16 v[132:135], a[8:11], v[196:203], v13
    ds_read2st64_b32 v[244:245], v236 offset0:0 offset1:72
    ds_read_b128 v[240:243], v8 offset:3072
    v_xad_u32 v238, v238, v3, v4
    v_smfmac_f32_16x16x64_bf16 v[132:135], a[44:47], v[204:211], v17
    ds_read2st64_b32 v[246:247], v237 offset0:0 offset1:72
    v_xad_u32 v239, v239, v3, v4
    v_smfmac_f32_16x16x64_bf16 v[132:135], a[80:83], v[212:219], v21
    ds_read2st64_b32 v[248:249], v238 offset0:0 offset1:72
    v_mov_b32_dpp v160, v168 row_ror:8 row_mask:0xf bank_mask:0xc
    v_smfmac_f32_16x16x64_bf16 v[136:139], a[12:15], v[196:203], v13 abid:1
    ds_read2st64_b32 v[250:251], v239 offset0:0 offset1:72
    ds_read_b128 v[236:239], v9 offset:9280
    v_mov_b32_dpp v161, v169 row_ror:8 row_mask:0xf bank_mask:0xc
    v_smfmac_f32_16x16x64_bf16 v[136:139], a[48:51], v[204:211], v17 abid:1
    v_mov_b32_dpp v162, v170 row_ror:8 row_mask:0xf bank_mask:0xc
    v_smfmac_f32_16x16x64_bf16 v[136:139], a[84:87], v[212:219], v21 abid:1
    v_mov_b32_dpp v163, v171 row_ror:8 row_mask:0xf bank_mask:0xc
    v_smfmac_f32_16x16x64_bf16 v[140:143], a[16:19], v[196:203], v14
    s_waitcnt vmcnt(6)
    buffer_store_dwordx4 v[160:163], v6, s[12:15], s23 offen offset:0 sc1
    ds_read_b128 v[164:167], v9 offset:10304
    v_smfmac_f32_16x16x64_bf16 v[140:143], a[52:55], v[204:211], v18
    ds_read_b128 v[168:171], v9 offset:10368
    ds_read_b128 v[160:163], v9 offset:10240
    v_smfmac_f32_16x16x64_bf16 v[140:143], a[88:91], v[212:219], v22
    v_smfmac_f32_16x16x64_bf16 v[144:147], a[20:23], v[196:203], v14 abid:1
    v_smfmac_f32_16x16x64_bf16 v[144:147], a[56:59], v[204:211], v18 abid:1
    v_smfmac_f32_16x16x64_bf16 v[144:147], a[92:95], v[212:219], v22 abid:1
    s_waitcnt lgkmcnt(3)
    v_xad_u32 v236, v236, v3, v4
    v_smfmac_f32_16x16x64_bf16 v[136:139], v[240:243], v[244:251], v10
    v_xad_u32 v237, v237, v3, v4
    v_smfmac_f32_16x16x64_bf16 v[172:175], v[240:243], v[244:251], v10 abid:1
    ds_read2st64_b32 v[244:245], v236 offset0:0 offset1:72
    ds_read_b128 v[240:243], v8 offset:1024
    v_xad_u32 v238, v238, v3, v4
    v_smfmac_f32_16x16x64_bf16 v[148:151], a[24:27], v[196:203], v15
    ds_read2st64_b32 v[246:247], v237 offset0:0 offset1:72
    v_xad_u32 v239, v239, v3, v4
    v_smfmac_f32_16x16x64_bf16 v[148:151], a[60:63], v[204:211], v19
    ds_read2st64_b32 v[248:249], v238 offset0:0 offset1:72
    v_cvt_pk_bf16_f32 v192, v192, v193
    v_smfmac_f32_16x16x64_bf16 v[148:151], a[96:99], v[212:219], v23
    ds_read2st64_b32 v[250:251], v239 offset0:0 offset1:72
    ds_read_b128 v[236:239], v9 offset:9344
    v_cvt_pk_bf16_f32 v193, v194, v195
    v_smfmac_f32_16x16x64_bf16 v[152:155], a[28:31], v[196:203], v15 abid:1
    ds_write_b64 v53, v[192:193] offset:0
    ds_read_b128 v[192:195], v9 offset:10752
    v_smfmac_f32_16x16x64_bf16 v[152:155], a[64:67], v[204:211], v19 abid:1
    s_add_u32 m0, m0, 896
    v_smfmac_f32_16x16x64_bf16 v[152:155], a[100:103], v[212:219], v23 abid:1
    s_waitcnt vmcnt(7)
    buffer_load_dwordx4 v5, s[8:11], s22 offen offset:640 nt lds
    v_smfmac_f32_16x16x64_bf16 v[156:159], a[32:35], v[196:203], v48
    v_smfmac_f32_16x16x64_bf16 v[156:159], a[68:71], v[204:211], v48 abid:1
    v_smfmac_f32_16x16x64_bf16 v[156:159], a[104:107], v[212:219], v49
    ds_read_b128 v[196:199], v1 offset:5120
    v_cvt_pk_bf16_f32 v176, v176, v177
    v_smfmac_f32_16x16x64_bf16 v[124:127], a[108:111], v[220:227], v24
    ds_read_b128 v[200:203], v2 offset:5120
    v_cvt_pk_bf16_f32 v177, v178, v179
    v_smfmac_f32_16x16x64_bf16 v[124:127], a[144:147], v[228:235], v28
    ds_read_b128 v[204:207], v1 offset:6144
    ds_read_b64 v[216:217], v9 offset:10056
    v_cvt_pk_bf16_f32 v178, v180, v181
    v_smfmac_f32_16x16x64_bf16 v[128:131], a[112:115], v[220:227], v24 abid:1
    ds_read_b128 v[208:211], v2 offset:6144
    v_cvt_pk_bf16_f32 v179, v182, v183
    v_smfmac_f32_16x16x64_bf16 v[128:131], a[148:151], v[228:235], v28 abid:1
    s_waitcnt lgkmcnt(7)
    v_xad_u32 v236, v236, v3, v4
    v_smfmac_f32_16x16x64_bf16 v[128:131], v[240:243], v[244:251], v10
    s_add_u32 m0, m0, 896
    v_xad_u32 v237, v237, v3, v4
    v_smfmac_f32_16x16x64_bf16 v[164:167], v[240:243], v[244:251], v10 abid:1
    ds_read2st64_b32 v[244:245], v236 offset0:0 offset1:72
    ds_read_b128 v[240:243], v8 offset:2048
    v_xad_u32 v238, v238, v3, v4
    v_smfmac_f32_16x16x64_bf16 v[132:135], a[116:119], v[220:227], v25
    ds_read2st64_b32 v[246:247], v237 offset0:0 offset1:72
    s_waitcnt vmcnt(6)
    v_xad_u32 v239, v239, v3, v4
    v_smfmac_f32_16x16x64_bf16 v[132:135], a[152:155], v[228:235], v29
    ds_read2st64_b32 v[248:249], v238 offset0:0 offset1:72
    buffer_load_dwordx4 v5, s[8:11], s22 offen offset:768 nt lds
    v_cvt_pk_bf16_f32 v184, v184, v185
    v_smfmac_f32_16x16x64_bf16 v[136:139], a[120:123], v[220:227], v25 abid:1
    ds_read2st64_b32 v[250:251], v239 offset0:0 offset1:72
    ds_read_b128 v[236:239], v9 offset:9216
    v_cvt_pk_bf16_f32 v185, v186, v187
    v_smfmac_f32_16x16x64_bf16 v[136:139], a[156:159], v[228:235], v29 abid:1
    v_cvt_pk_bf16_f32 v186, v188, v189
    v_smfmac_f32_16x16x64_bf16 v[140:143], a[124:127], v[220:227], v26
    v_cvt_pk_bf16_f32 v187, v190, v191
    v_smfmac_f32_16x16x64_bf16 v[140:143], a[160:163], v[228:235], v30
    ds_read_b128 v[188:191], v9 offset:10688
    v_cndmask_b32_dpp v180, v176, v184, vcc row_ror:8 row_mask:0xf bank_mask:0xf
    v_smfmac_f32_16x16x64_bf16 v[144:147], a[128:131], v[220:227], v26 abid:1
    v_cndmask_b32_dpp v181, v177, v185, vcc row_ror:8 row_mask:0xf bank_mask:0xf
    v_smfmac_f32_16x16x64_bf16 v[144:147], a[164:167], v[228:235], v30 abid:1
    v_cndmask_b32_dpp v182, v178, v186, vcc row_ror:8 row_mask:0xf bank_mask:0xf
    v_smfmac_f32_16x16x64_bf16 v[148:151], a[132:135], v[220:227], v27
    v_cndmask_b32_dpp v183, v179, v187, vcc row_ror:8 row_mask:0xf bank_mask:0xf
    v_smfmac_f32_16x16x64_bf16 v[148:151], a[168:171], v[228:235], v31
    s_waitcnt vmcnt(7)
    buffer_store_dwordx4 v[180:183], v6, s[12:15], s58 offen offset:128 sc1
    v_mov_b32_dpp v176, v184 row_ror:8 row_mask:0xf bank_mask:0xc
    v_smfmac_f32_16x16x64_bf16 v[152:155], a[136:139], v[220:227], v27 abid:1
    v_mov_b32_dpp v177, v185 row_ror:8 row_mask:0xf bank_mask:0xc
    v_smfmac_f32_16x16x64_bf16 v[152:155], a[172:175], v[228:235], v31 abid:1
    s_waitcnt lgkmcnt(1)
    v_xad_u32 v236, v236, v3, v4
    v_smfmac_f32_16x16x64_bf16 v[132:135], v[240:243], v[244:251], v10
    v_xad_u32 v237, v237, v3, v4
    v_smfmac_f32_16x16x64_bf16 v[168:171], v[240:243], v[244:251], v10 abid:1
    ds_read2st64_b32 v[244:245], v236 offset0:0 offset1:72
    ds_read_b128 v[240:243], v8 offset:0
    v_xad_u32 v238, v238, v3, v4
    v_smfmac_f32_16x16x64_bf16 v[156:159], a[140:143], v[220:227], v49 abid:1
    ds_read2st64_b32 v[246:247], v237 offset0:0 offset1:72
    v_xad_u32 v239, v239, v3, v4
    v_smfmac_f32_16x16x64_bf16 v[156:159], a[176:179], v[228:235], v50
    ds_read2st64_b32 v[248:249], v238 offset0:0 offset1:72
    ds_read_b128 v[220:223], v1 offset:7168
    v_mov_b32_dpp v178, v186 row_ror:8 row_mask:0xf bank_mask:0xc
    v_smfmac_f32_16x16x64_bf16 v[124:127], a[180:183], v[196:203], v32
    ds_read2st64_b32 v[250:251], v239 offset0:0 offset1:72
    ds_read_b128 v[236:239], v9 offset:9728
    v_mov_b32_dpp v179, v187 row_ror:8 row_mask:0xf bank_mask:0xc
    v_smfmac_f32_16x16x64_bf16 v[124:127], a[216:219], v[204:211], v36
    ds_read_b128 v[224:227], v2 offset:7168
    s_waitcnt vmcnt(6)
    buffer_store_dwordx4 v[176:179], v6, s[12:15], s23 offen offset:128 sc1
    v_smfmac_f32_16x16x64_bf16 v[128:131], a[184:187], v[196:203], v32 abid:1
    ds_read_b128 v[228:231], v1 offset:8192
    ds_read_b128 v[180:183], v9 offset:10560
    ds_read_b128 v[184:187], v9 offset:10624
    v_smfmac_f32_16x16x64_bf16 v[128:131], a[220:223], v[204:211], v36 abid:1
    ds_read_b128 v[232:235], v2 offset:8192
    ds_read_b128 v[176:179], v9 offset:10496
    v_xad_u32 v212, v216, v3, v4
    v_smfmac_f32_16x16x64_bf16 v[132:135], a[188:191], v[196:203], v33
    ds_read2st64_b32 v[212:213], v212 offset0:0 offset1:72
    v_xad_u32 v214, v217, v3, v4
    v_smfmac_f32_16x16x64_bf16 v[132:135], a[224:227], v[204:211], v37
    ds_read2st64_b32 v[214:215], v214 offset0:0 offset1:72
    v_smfmac_f32_16x16x64_bf16 v[136:139], a[192:195], v[196:203], v33 abid:1
    v_smfmac_f32_16x16x64_bf16 v[136:139], a[228:231], v[204:211], v37 abid:1
    v_smfmac_f32_16x16x64_bf16 v[140:143], a[196:199], v[196:203], v34
    v_smfmac_f32_16x16x64_bf16 v[140:143], a[232:235], v[204:211], v38
    s_waitcnt vmcnt(7)
    s_waitcnt lgkmcnt(8)
    v_xad_u32 v236, v236, v3, v4
    v_smfmac_f32_16x16x64_bf16 v[124:127], v[240:243], v[244:251], v10
    v_xad_u32 v237, v237, v3, v4
    v_smfmac_f32_16x16x64_bf16 v[160:163], v[240:243], v[244:251], v10 abid:1
    ds_read2st64_b32 v[244:245], v236 offset0:0 offset1:72
    ds_read_b128 v[240:243], v8 offset:8192
    v_xad_u32 v238, v238, v3, v4
    v_smfmac_f32_16x16x64_bf16 v[144:147], a[200:203], v[196:203], v34 abid:1
    ds_read2st64_b32 v[246:247], v237 offset0:0 offset1:72
    v_xad_u32 v239, v239, v3, v4
    v_smfmac_f32_16x16x64_bf16 v[144:147], a[236:239], v[204:211], v38 abid:1
    ds_read2st64_b32 v[248:249], v238 offset0:0 offset1:72
    v_mul_u32_u24 v0, s94, v0
    v_smfmac_f32_16x16x64_bf16 v[148:151], a[204:207], v[196:203], v35
    ds_read2st64_b32 v[250:251], v239 offset0:0 offset1:72
    ds_read_b128 v[236:239], v9 offset:9664
    v_add_u32 v0, s93, v0
    v_smfmac_f32_16x16x64_bf16 v[148:151], a[240:243], v[204:211], v39
    s_add_u32 m0, m0, 896
    v_min_u32 v0, 75497472, v0
    v_smfmac_f32_16x16x64_bf16 v[152:155], a[208:211], v[196:203], v35 abid:1
    ds_write_b32 v11, v0
    s_waitcnt vmcnt(7)
    v_mov_b32 v0, 162048
    v_smfmac_f32_16x16x64_bf16 v[152:155], a[244:247], v[204:211], v39 abid:1
    buffer_load_dwordx4 v5, s[8:11], s22 offen offset:896 nt lds
    v_smfmac_f32_16x16x64_bf16 v[156:159], a[212:215], v[196:203], v50 abid:1
    s_waitcnt lgkmcnt(7)
    s_cmp_lt_i32 s81, 0
    s_cbranch_scc1 M_ovrL
    s_swappc_b64 s[78:79], s[72:73]
M_ovrL:
    v_smfmac_f32_16x16x64_bf16 v[156:159], a[248:251], v[204:211], v51
    ds_read_b128 v[196:199], v1 offset:18432
    v_smfmac_f32_16x16x64_bf16 v[124:127], a[252:255], v[220:227], v40
    ds_read_b128 v[200:203], v2 offset:18432
    v_smfmac_f32_16x16x64_bf16 v[124:127], v[88:91], v[228:235], v44
    ds_read_b128 v[204:207], v1 offset:19456
    v_smfmac_f32_16x16x64_bf16 v[128:131], v[56:59], v[220:227], v40 abid:1
    ds_read_b128 v[208:211], v2 offset:19456
    v_smfmac_f32_16x16x64_bf16 v[128:131], v[92:95], v[228:235], v44 abid:1
    s_waitcnt lgkmcnt(4)
    s_barrier
    v_xad_u32 v236, v236, v3, v4
    v_smfmac_f32_16x16x64_bf16 v[156:159], v[240:243], v[244:251], v10
    ds_read_b32 v0, v0
    v_xad_u32 v237, v237, v3, v4
    v_smfmac_f32_16x16x64_bf16 v[192:195], v[240:243], v[244:251], v10 abid:1
    ds_read2st64_b32 v[244:245], v236 offset0:0 offset1:72
    ds_read_b128 v[240:243], v8 offset:7168
    v_xad_u32 v238, v238, v3, v4
    v_smfmac_f32_16x16x64_bf16 v[132:135], v[60:63], v[220:227], v41
    ds_read2st64_b32 v[246:247], v237 offset0:0 offset1:72
    v_xad_u32 v239, v239, v3, v4
    v_smfmac_f32_16x16x64_bf16 v[132:135], v[96:99], v[228:235], v45
    ds_read2st64_b32 v[248:249], v238 offset0:0 offset1:72
    s_add_u32 m0, m0, 896
    v_smfmac_f32_16x16x64_bf16 v[136:139], v[64:67], v[220:227], v41 abid:1
    ds_read2st64_b32 v[250:251], v239 offset0:0 offset1:72
    ds_read_b128 v[236:239], v9 offset:9536
    s_waitcnt vmcnt(6)
    v_smfmac_f32_16x16x64_bf16 v[136:139], v[100:103], v[228:235], v45 abid:1
    buffer_load_dwordx4 v5, s[8:11], s22 offen offset:1024 nt lds
    s_waitcnt lgkmcnt(6)
    v_readfirstlane_b32 s88, v0
    v_smfmac_f32_16x16x64_bf16 v[140:143], v[68:71], v[220:227], v42
    s_cmp_lt_u32 s88, 75497472
    s_cselect_b32 s10, 75497472, 0
    v_smfmac_f32_16x16x64_bf16 v[140:143], v[104:107], v[228:235], v46
    v_smfmac_f32_16x16x64_bf16 v[144:147], v[72:75], v[220:227], v42 abid:1
    ds_read_b128 v[212:215], v1 offset:20480
    v_smfmac_f32_16x16x64_bf16 v[144:147], v[108:111], v[228:235], v46 abid:1
    ds_read_b128 v[216:219], v2 offset:20480
    v_smfmac_f32_16x16x64_bf16 v[148:151], v[76:79], v[220:227], v43
    v_smfmac_f32_16x16x64_bf16 v[148:151], v[112:115], v[228:235], v47
    v_smfmac_f32_16x16x64_bf16 v[152:155], v[80:83], v[220:227], v43 abid:1
    v_smfmac_f32_16x16x64_bf16 v[152:155], v[116:119], v[228:235], v47 abid:1
    s_waitcnt lgkmcnt(2)
    v_xad_u32 v236, v236, v3, v4
    v_smfmac_f32_16x16x64_bf16 v[152:155], v[240:243], v[244:251], v10
    v_xad_u32 v237, v237, v3, v4
    v_smfmac_f32_16x16x64_bf16 v[188:191], v[240:243], v[244:251], v10 abid:1
    s_cmp_gt_u32 s46, s80
    s_cbranch_scc1 M_slow
M_slowrL:
    v_xad_u32 v238, v238, v3, v4
    v_smfmac_f32_16x16x64_bf16 v[156:159], v[84:87], v[220:227], v51 abid:1
    ds_read2st64_b32 v[244:245], v236 offset0:0 offset1:72
    ds_read_b128 v[240:243], v8 offset:5120
    v_xad_u32 v239, v239, v3, v4
    v_smfmac_f32_16x16x64_bf16 v[156:159], v[120:123], v[228:235], v52
    ds_read2st64_b32 v[246:247], v237 offset0:0 offset1:72
    ds_read_b128 v[220:223], v1 offset:21504
    v_smfmac_f32_16x16x64_bf16 v[160:163], a[0:3], v[196:203], v12
    ds_read2st64_b32 v[248:249], v238 offset0:0 offset1:72
    ds_read_b128 v[224:227], v2 offset:21504
    v_smfmac_f32_16x16x64_bf16 v[160:163], a[36:39], v[204:211], v16
    ds_read2st64_b32 v[250:251], v239 offset0:0 offset1:72
    ds_read_b128 v[236:239], v9 offset:9600
    s_waitcnt lgkmcnt(8)
    v_smfmac_f32_16x16x64_bf16 v[160:163], a[72:75], v[212:219], v20
    ds_read_b128 v[228:231], v1 offset:22528
    v_smfmac_f32_16x16x64_bf16 v[164:167], a[4:7], v[196:203], v12 abid:1
    ds_read_b128 v[232:235], v2 offset:22528
    v_cvt_pk_bf16_f32 v156, v156, v157
    v_smfmac_f32_16x16x64_bf16 v[164:167], a[40:43], v[204:211], v16 abid:1
    s_mov_b32 m0, s28
    v_cvt_pk_bf16_f32 v157, v158, v159
    v_smfmac_f32_16x16x64_bf16 v[164:167], a[76:79], v[212:219], v20 abid:1
    ds_write_b64 v53, v[156:157] offset:25728
    ds_read_b128 v[156:159], v9 offset:10752
    s_waitcnt vmcnt(7)
    v_smfmac_f32_16x16x64_bf16 v[168:171], a[8:11], v[196:203], v13
    buffer_load_dwordx4 v5, s[8:11], s88 offen offset:0 nt lds
    v_smfmac_f32_16x16x64_bf16 v[168:171], a[44:47], v[204:211], v17
    v_cvt_pk_bf16_f32 v124, v124, v125
    v_smfmac_f32_16x16x64_bf16 v[168:171], a[80:83], v[212:219], v21
    s_waitcnt lgkmcnt(4)
    v_xad_u32 v236, v236, v3, v4
    v_smfmac_f32_16x16x64_bf16 v[144:147], v[240:243], v[244:251], v10
    v_xad_u32 v237, v237, v3, v4
    v_smfmac_f32_16x16x64_bf16 v[180:183], v[240:243], v[244:251], v10 abid:1
    ds_read2st64_b32 v[244:245], v236 offset0:0 offset1:72
    ds_read_b128 v[240:243], v8 offset:6144
    v_xad_u32 v238, v238, v3, v4
    v_smfmac_f32_16x16x64_bf16 v[172:175], a[12:15], v[196:203], v13 abid:1
    ds_read2st64_b32 v[246:247], v237 offset0:0 offset1:72
    v_xad_u32 v239, v239, v3, v4
    v_smfmac_f32_16x16x64_bf16 v[172:175], a[48:51], v[204:211], v17 abid:1
    ds_read2st64_b32 v[248:249], v238 offset0:0 offset1:72
    v_cvt_pk_bf16_f32 v125, v126, v127
    v_smfmac_f32_16x16x64_bf16 v[172:175], a[84:87], v[212:219], v21 abid:1
    ds_read2st64_b32 v[250:251], v239 offset0:0 offset1:72
    ds_read_b128 v[236:239], v9 offset:9472
    v_cvt_pk_bf16_f32 v126, v128, v129
    v_smfmac_f32_16x16x64_bf16 v[176:179], a[16:19], v[196:203], v14
    v_cvt_pk_bf16_f32 v127, v130, v131
    v_smfmac_f32_16x16x64_bf16 v[176:179], a[52:55], v[204:211], v18
    v_cvt_pk_bf16_f32 v132, v132, v133
    v_smfmac_f32_16x16x64_bf16 v[176:179], a[88:91], v[212:219], v22
    v_cvt_pk_bf16_f32 v133, v134, v135
    v_smfmac_f32_16x16x64_bf16 v[180:183], a[20:23], v[196:203], v14 abid:1
    s_add_u32 m0, m0, 896
    v_cvt_pk_bf16_f32 v134, v136, v137
    v_smfmac_f32_16x16x64_bf16 v[180:183], a[56:59], v[204:211], v18 abid:1
    s_waitcnt vmcnt(6)
    buffer_load_dwordx4 v5, s[8:11], s88 offen offset:128 nt lds
    v_cvt_pk_bf16_f32 v135, v138, v139
    v_smfmac_f32_16x16x64_bf16 v[180:183], a[92:95], v[212:219], v22 abid:1
    ds_read_b128 v[136:139], v9 offset:10432
    v_cndmask_b32_dpp v128, v124, v132, vcc row_ror:8 row_mask:0xf bank_mask:0xf
    v_smfmac_f32_16x16x64_bf16 v[184:187], a[24:27], v[196:203], v15
    v_cndmask_b32_dpp v129, v125, v133, vcc row_ror:8 row_mask:0xf bank_mask:0xf
    v_smfmac_f32_16x16x64_bf16 v[184:187], a[60:63], v[204:211], v19
    v_cndmask_b32_dpp v130, v126, v134, vcc row_ror:8 row_mask:0xf bank_mask:0xf
    v_smfmac_f32_16x16x64_bf16 v[184:187], a[96:99], v[212:219], v23
    s_waitcnt lgkmcnt(1)
    v_xad_u32 v236, v236, v3, v4
    v_smfmac_f32_16x16x64_bf16 v[148:151], v[240:243], v[244:251], v10
    v_xad_u32 v237, v237, v3, v4
    v_smfmac_f32_16x16x64_bf16 v[184:187], v[240:243], v[244:251], v10 abid:1
    ds_read2st64_b32 v[244:245], v236 offset0:0 offset1:72
    ds_read_b128 v[240:243], v8 offset:4096
    v_xad_u32 v238, v238, v3, v4
    v_smfmac_f32_16x16x64_bf16 v[188:191], a[28:31], v[196:203], v15 abid:1
    ds_read2st64_b32 v[246:247], v237 offset0:0 offset1:72
    v_xad_u32 v239, v239, v3, v4
    v_smfmac_f32_16x16x64_bf16 v[188:191], a[64:67], v[204:211], v19 abid:1
    ds_read2st64_b32 v[248:249], v238 offset0:0 offset1:72
    v_cndmask_b32_dpp v131, v127, v135, vcc row_ror:8 row_mask:0xf bank_mask:0xf
    v_smfmac_f32_16x16x64_bf16 v[188:191], a[100:103], v[212:219], v23 abid:1
    ds_read2st64_b32 v[250:251], v239 offset0:0 offset1:72
    s_waitcnt vmcnt(7)
    buffer_store_dwordx4 v[128:131], v6, s[12:15], s59 offen offset:0 sc1
    v_smfmac_f32_16x16x64_bf16 v[192:195], a[32:35], v[196:203], v48
    v_mov_b32_dpp v124, v132 row_ror:8 row_mask:0xf bank_mask:0xc
    v_smfmac_f32_16x16x64_bf16 v[192:195], a[68:71], v[204:211], v48 abid:1
    v_mov_b32_dpp v125, v133 row_ror:8 row_mask:0xf bank_mask:0xc
    v_smfmac_f32_16x16x64_bf16 v[192:195], a[104:107], v[212:219], v49
    ds_read_b128 v[196:199], v1 offset:23552
    v_mov_b32_dpp v126, v134 row_ror:8 row_mask:0xf bank_mask:0xc
    v_smfmac_f32_16x16x64_bf16 v[160:163], a[108:111], v[220:227], v24
    ds_read_b128 v[200:203], v2 offset:23552
    v_mov_b32_dpp v127, v135 row_ror:8 row_mask:0xf bank_mask:0xc
    v_smfmac_f32_16x16x64_bf16 v[160:163], a[144:147], v[228:235], v28
    ds_read_b128 v[204:207], v1 offset:24576
    s_waitcnt vmcnt(6)
    buffer_store_dwordx4 v[124:127], v6, s[12:15], s24 offen offset:0 sc1
    v_smfmac_f32_16x16x64_bf16 v[164:167], a[112:115], v[220:227], v24 abid:1
    ds_read_b128 v[208:211], v2 offset:24576
    ds_read_b128 v[128:131], v9 offset:10304
    ds_read_b128 v[132:135], v9 offset:10368
    v_smfmac_f32_16x16x64_bf16 v[164:167], a[148:151], v[228:235], v28 abid:1
    ds_read_b128 v[124:127], v9 offset:10240
    v_smfmac_f32_16x16x64_bf16 v[168:171], a[116:119], v[220:227], v25
    v_smfmac_f32_16x16x64_bf16 v[168:171], a[152:155], v[228:235], v29
    s_waitcnt lgkmcnt(7)
    v_smfmac_f32_16x16x64_bf16 v[140:143], v[240:243], v[244:251], v10
    v_smfmac_f32_16x16x64_bf16 v[176:179], v[240:243], v[244:251], v10 abid:1
    v_smfmac_f32_16x16x64_bf16 v[172:175], a[120:123], v[220:227], v25 abid:1
    s_add_u32 s28, s28, 36864
    s_cmp_ge_u32 s28, 110592
    s_cselect_b32 s28, s26, s28
    v_smfmac_f32_16x16x64_bf16 v[172:175], a[156:159], v[228:235], v29 abid:1
    s_add_u32 s30, s25, 36864
    s_cmp_eq_u32 s30, 110592
    s_cselect_b32 s30, 0, s30
    v_smfmac_f32_16x16x64_bf16 v[176:179], a[124:127], v[220:227], v26
    s_sub_u32 s31, s30, s25
    s_mov_b32 s25, s30
    s_mov_b32 s90, s22
    v_smfmac_f32_16x16x64_bf16 v[176:179], a[160:163], v[228:235], v30
    s_mov_b32 s22, s88
    s_add_u32 s91, s91, 1
    s_cmp_lt_u32 s20, 2
    v_smfmac_f32_16x16x64_bf16 v[180:183], a[128:131], v[220:227], v26 abid:1
    s_cselect_b32 s66, s23, s24
    s_add_u32 s66, s66, s95
    v_smfmac_f32_16x16x64_bf16 v[180:183], a[164:167], v[228:235], v30 abid:1
    v_cvt_pk_bf16_f32 v140, v140, v141
    v_smfmac_f32_16x16x64_bf16 v[184:187], a[132:135], v[220:227], v27
    s_add_u32 m0, m0, 896
    v_cvt_pk_bf16_f32 v141, v142, v143
    v_smfmac_f32_16x16x64_bf16 v[184:187], a[168:171], v[228:235], v31
    s_waitcnt vmcnt(7)
    buffer_load_dwordx4 v5, s[8:11], s88 offen offset:256 nt lds
    v_cvt_pk_bf16_f32 v142, v144, v145
    v_smfmac_f32_16x16x64_bf16 v[188:191], a[136:139], v[220:227], v27 abid:1
    v_cvt_pk_bf16_f32 v143, v146, v147
    v_smfmac_f32_16x16x64_bf16 v[188:191], a[172:175], v[228:235], v31 abid:1
    v_cvt_pk_bf16_f32 v148, v148, v149
    v_smfmac_f32_16x16x64_bf16 v[192:195], a[140:143], v[220:227], v49 abid:1
    v_cvt_pk_bf16_f32 v149, v150, v151
    v_smfmac_f32_16x16x64_bf16 v[192:195], a[176:179], v[228:235], v50
    ds_read_b128 v[220:223], v1 offset:25600
    s_waitcnt lgkmcnt(6)
    v_cvt_pk_bf16_f32 v150, v152, v153
    v_smfmac_f32_16x16x64_bf16 v[160:163], a[180:183], v[196:203], v32
    ds_read_b128 v[224:227], v2 offset:25600
    s_waitcnt lgkmcnt(5)
    v_cvt_pk_bf16_f32 v151, v154, v155
    v_smfmac_f32_16x16x64_bf16 v[160:163], a[216:219], v[204:211], v36
    ds_read_b128 v[228:231], v1 offset:26624
    ds_read_b128 v[152:155], v9 offset:10688
    v_cndmask_b32_dpp v144, v140, v148, vcc row_ror:8 row_mask:0xf bank_mask:0xf
    v_smfmac_f32_16x16x64_bf16 v[164:167], a[184:187], v[196:203], v32 abid:1
    ds_read_b128 v[232:235], v2 offset:26624
    v_cndmask_b32_dpp v145, v141, v149, vcc row_ror:8 row_mask:0xf bank_mask:0xf
    v_smfmac_f32_16x16x64_bf16 v[164:167], a[220:223], v[204:211], v36 abid:1
    s_add_u32 m0, m0, 896
    v_cndmask_b32_dpp v146, v142, v150, vcc row_ror:8 row_mask:0xf bank_mask:0xf
    v_smfmac_f32_16x16x64_bf16 v[168:171], a[188:191], v[196:203], v33
    s_waitcnt vmcnt(6)
    buffer_load_dwordx4 v5, s[8:11], s88 offen offset:384 nt lds
    v_cndmask_b32_dpp v147, v143, v151, vcc row_ror:8 row_mask:0xf bank_mask:0xf
    v_smfmac_f32_16x16x64_bf16 v[168:171], a[224:227], v[204:211], v37
    s_waitcnt vmcnt(7)
    buffer_store_dwordx4 v[144:147], v6, s[12:15], s59 offen offset:128 sc1
    v_mov_b32_dpp v140, v148 row_ror:8 row_mask:0xf bank_mask:0xc
    v_smfmac_f32_16x16x64_bf16 v[172:175], a[192:195], v[196:203], v33 abid:1
    v_mov_b32_dpp v141, v149 row_ror:8 row_mask:0xf bank_mask:0xc
    v_smfmac_f32_16x16x64_bf16 v[172:175], a[228:231], v[204:211], v37 abid:1
    v_mov_b32_dpp v142, v150 row_ror:8 row_mask:0xf bank_mask:0xc
    v_smfmac_f32_16x16x64_bf16 v[176:179], a[196:199], v[196:203], v34
    v_mov_b32_dpp v143, v151 row_ror:8 row_mask:0xf bank_mask:0xc
    v_smfmac_f32_16x16x64_bf16 v[176:179], a[232:235], v[204:211], v38
    s_waitcnt vmcnt(6)
    buffer_store_dwordx4 v[140:143], v6, s[12:15], s24 offen offset:128 sc1
    ds_read_b128 v[144:147], v9 offset:10560
    v_smfmac_f32_16x16x64_bf16 v[180:183], a[200:203], v[196:203], v34 abid:1
    ds_read_b128 v[148:151], v9 offset:10624
    ds_read_b128 v[140:143], v9 offset:10496
    v_add_u32 v4, s31, v4
    v_smfmac_f32_16x16x64_bf16 v[180:183], a[236:239], v[204:211], v38 abid:1
    v_add_u32 v1, s31, v1
    v_smfmac_f32_16x16x64_bf16 v[184:187], a[204:207], v[196:203], v35
    v_add_u32 v2, s31, v2
    v_smfmac_f32_16x16x64_bf16 v[184:187], a[240:243], v[204:211], v39
    v_smfmac_f32_16x16x64_bf16 v[188:191], a[208:211], v[196:203], v35 abid:1
    v_smfmac_f32_16x16x64_bf16 v[188:191], a[244:247], v[204:211], v39 abid:1
    v_smfmac_f32_16x16x64_bf16 v[192:195], a[212:215], v[196:203], v50 abid:1
    v_smfmac_f32_16x16x64_bf16 v[192:195], a[248:251], v[204:211], v51
    s_waitcnt vmcnt(8)
    s_branch M_top1
M_bE0:
    v_smfmac_f32_16x16x64_bf16 v[164:167], v[56:59], v[220:227], v40 abid:1
    ds_read_b128 v[204:207], v1 offset:1024
    v_smfmac_f32_16x16x64_bf16 v[164:167], v[92:95], v[228:235], v44 abid:1
    ds_read_b128 v[208:211], v2 offset:1024
    v_mov_b32 v0, 1
    v_smfmac_f32_16x16x64_bf16 v[168:171], v[60:63], v[220:227], v41
    ds_read_b128 v[212:215], v1 offset:2048
    v_smfmac_f32_16x16x64_bf16 v[168:171], v[96:99], v[228:235], v45
    ds_read_b128 v[216:219], v2 offset:2048
    v_smfmac_f32_16x16x64_bf16 v[172:175], v[64:67], v[220:227], v41 abid:1
    s_waitcnt vmcnt(5)
    s_waitcnt lgkmcnt(6)
    buffer_store_dwordx4 v[244:247], v7, s[12:15], s66 offen sc1
    v_smfmac_f32_16x16x64_bf16 v[172:175], v[100:103], v[228:235], v45 abid:1
    ds_read_b128 v[236:239], v9 offset:9408
    v_smfmac_f32_16x16x64_bf16 v[176:179], v[68:71], v[220:227], v42
    s_waitcnt vmcnt(6)
    buffer_atomic_add v0, v11, s[16:19], s92 offen sc0 sc1
    s_mov_b32 s21, 2
    v_smfmac_f32_16x16x64_bf16 v[176:179], v[104:107], v[228:235], v46
    v_smfmac_f32_16x16x64_bf16 v[180:183], v[72:75], v[220:227], v42 abid:1
    v_cvt_pk_bf16_f32 v160, v160, v161
    v_smfmac_f32_16x16x64_bf16 v[180:183], v[108:111], v[228:235], v46 abid:1
    v_cvt_pk_bf16_f32 v161, v162, v163
    v_smfmac_f32_16x16x64_bf16 v[184:187], v[76:79], v[220:227], v43
    v_cvt_pk_bf16_f32 v162, v164, v165
    v_smfmac_f32_16x16x64_bf16 v[184:187], v[112:115], v[228:235], v47
    v_cvt_pk_bf16_f32 v163, v166, v167
    v_smfmac_f32_16x16x64_bf16 v[188:191], v[80:83], v[220:227], v43 abid:1
    s_add_u32 m0, m0, 896
    v_cvt_pk_bf16_f32 v168, v168, v169
    v_smfmac_f32_16x16x64_bf16 v[188:191], v[116:119], v[228:235], v47 abid:1
    s_waitcnt vmcnt(5)
    buffer_load_dwordx4 v5, s[8:11], s22 offen offset:512 nt lds
    v_cvt_pk_bf16_f32 v169, v170, v171
    v_smfmac_f32_16x16x64_bf16 v[192:195], v[84:87], v[220:227], v51 abid:1
    v_cvt_pk_bf16_f32 v170, v172, v173
    v_smfmac_f32_16x16x64_bf16 v[192:195], v[120:123], v[228:235], v52
    ds_read_b128 v[220:223], v1 offset:3072
    s_waitcnt lgkmcnt(6)
    v_cvt_pk_bf16_f32 v171, v174, v175
    v_smfmac_f32_16x16x64_bf16 v[124:127], a[0:3], v[196:203], v12
    ds_read_b128 v[224:227], v2 offset:3072
    ds_read_b128 v[172:175], v9 offset:10432
    s_waitcnt lgkmcnt(6)
    v_cndmask_b32_dpp v164, v160, v168, vcc row_ror:8 row_mask:0xf bank_mask:0xf
    v_smfmac_f32_16x16x64_bf16 v[124:127], a[36:39], v[204:211], v16
    ds_read_b128 v[228:231], v1 offset:4096
    s_waitcnt lgkmcnt(5)
    v_cndmask_b32_dpp v165, v161, v169, vcc row_ror:8 row_mask:0xf bank_mask:0xf
    v_smfmac_f32_16x16x64_bf16 v[124:127], a[72:75], v[212:219], v20
    ds_read_b128 v[232:235], v2 offset:4096
    v_cndmask_b32_dpp v166, v162, v170, vcc row_ror:8 row_mask:0xf bank_mask:0xf
    v_smfmac_f32_16x16x64_bf16 v[128:131], a[4:7], v[196:203], v12 abid:1
    s_barrier
    v_cndmask_b32_dpp v167, v163, v171, vcc row_ror:8 row_mask:0xf bank_mask:0xf
    v_smfmac_f32_16x16x64_bf16 v[128:131], a[40:43], v[204:211], v16 abid:1
    s_waitcnt vmcnt(6)
    buffer_store_dwordx4 v[164:167], v6, s[12:15], s58 offen offset:0 sc1
    s_waitcnt lgkmcnt(5)
    v_xad_u32 v236, v236, v3, v4
    v_smfmac_f32_16x16x64_bf16 v[128:131], a[76:79], v[212:219], v20 abid:1
    v_xad_u32 v237, v237, v3, v4
    v_smfmac_f32_16x16x64_bf16 v[132:135], a[8:11], v[196:203], v13
    ds_read2st64_b32 v[244:245], v236 offset0:0 offset1:72
    ds_read_b128 v[240:243], v8 offset:3072
    v_xad_u32 v238, v238, v3, v4
    v_smfmac_f32_16x16x64_bf16 v[132:135], a[44:47], v[204:211], v17
    ds_read2st64_b32 v[246:247], v237 offset0:0 offset1:72
    v_xad_u32 v239, v239, v3, v4
    v_smfmac_f32_16x16x64_bf16 v[132:135], a[80:83], v[212:219], v21
    ds_read2st64_b32 v[248:249], v238 offset0:0 offset1:72
    v_mov_b32_dpp v160, v168 row_ror:8 row_mask:0xf bank_mask:0xc
    v_smfmac_f32_16x16x64_bf16 v[136:139], a[12:15], v[196:203], v13 abid:1
    ds_read2st64_b32 v[250:251], v239 offset0:0 offset1:72
    ds_read_b128 v[236:239], v9 offset:9280
    v_mov_b32_dpp v161, v169 row_ror:8 row_mask:0xf bank_mask:0xc
    v_smfmac_f32_16x16x64_bf16 v[136:139], a[48:51], v[204:211], v17 abid:1
    v_mov_b32_dpp v162, v170 row_ror:8 row_mask:0xf bank_mask:0xc
    v_smfmac_f32_16x16x64_bf16 v[136:139], a[84:87], v[212:219], v21 abid:1
    v_mov_b32_dpp v163, v171 row_ror:8 row_mask:0xf bank_mask:0xc
    v_smfmac_f32_16x16x64_bf16 v[140:143], a[16:19], v[196:203], v14
    s_waitcnt vmcnt(5)
    buffer_store_dwordx4 v[160:163], v6, s[12:15], s23 offen offset:0 sc1
    ds_read_b128 v[164:167], v9 offset:10304
    v_smfmac_f32_16x16x64_bf16 v[140:143], a[52:55], v[204:211], v18
    ds_read_b128 v[168:171], v9 offset:10368
    ds_read_b128 v[160:163], v9 offset:10240
    v_smfmac_f32_16x16x64_bf16 v[140:143], a[88:91], v[212:219], v22
    v_smfmac_f32_16x16x64_bf16 v[144:147], a[20:23], v[196:203], v14 abid:1
    v_smfmac_f32_16x16x64_bf16 v[144:147], a[56:59], v[204:211], v18 abid:1
    v_smfmac_f32_16x16x64_bf16 v[144:147], a[92:95], v[212:219], v22 abid:1
    s_waitcnt lgkmcnt(3)
    v_xad_u32 v236, v236, v3, v4
    v_smfmac_f32_16x16x64_bf16 v[136:139], v[240:243], v[244:251], v10
    v_xad_u32 v237, v237, v3, v4
    v_smfmac_f32_16x16x64_bf16 v[172:175], v[240:243], v[244:251], v10 abid:1
    ds_read2st64_b32 v[244:245], v236 offset0:0 offset1:72
    ds_read_b128 v[240:243], v8 offset:1024
    v_xad_u32 v238, v238, v3, v4
    v_smfmac_f32_16x16x64_bf16 v[148:151], a[24:27], v[196:203], v15
    ds_read2st64_b32 v[246:247], v237 offset0:0 offset1:72
    v_xad_u32 v239, v239, v3, v4
    v_smfmac_f32_16x16x64_bf16 v[148:151], a[60:63], v[204:211], v19
    ds_read2st64_b32 v[248:249], v238 offset0:0 offset1:72
    v_cvt_pk_bf16_f32 v192, v192, v193
    v_smfmac_f32_16x16x64_bf16 v[148:151], a[96:99], v[212:219], v23
    ds_read2st64_b32 v[250:251], v239 offset0:0 offset1:72
    ds_read_b128 v[236:239], v9 offset:9344
    v_cvt_pk_bf16_f32 v193, v194, v195
    v_smfmac_f32_16x16x64_bf16 v[152:155], a[28:31], v[196:203], v15 abid:1
    ds_write_b64 v53, v[192:193] offset:0
    ds_read_b128 v[192:195], v9 offset:10752
    v_smfmac_f32_16x16x64_bf16 v[152:155], a[64:67], v[204:211], v19 abid:1
    s_add_u32 m0, m0, 896
    v_smfmac_f32_16x16x64_bf16 v[152:155], a[100:103], v[212:219], v23 abid:1
    s_waitcnt vmcnt(6)
    buffer_load_dwordx4 v5, s[8:11], s22 offen offset:640 nt lds
    v_smfmac_f32_16x16x64_bf16 v[156:159], a[32:35], v[196:203], v48
    v_smfmac_f32_16x16x64_bf16 v[156:159], a[68:71], v[204:211], v48 abid:1
    v_smfmac_f32_16x16x64_bf16 v[156:159], a[104:107], v[212:219], v49
    ds_read_b128 v[196:199], v1 offset:5120
    v_cvt_pk_bf16_f32 v176, v176, v177
    v_smfmac_f32_16x16x64_bf16 v[124:127], a[108:111], v[220:227], v24
    ds_read_b128 v[200:203], v2 offset:5120
    v_cvt_pk_bf16_f32 v177, v178, v179
    v_smfmac_f32_16x16x64_bf16 v[124:127], a[144:147], v[228:235], v28
    ds_read_b128 v[204:207], v1 offset:6144
    ds_read_b64 v[216:217], v9 offset:10056
    v_cvt_pk_bf16_f32 v178, v180, v181
    v_smfmac_f32_16x16x64_bf16 v[128:131], a[112:115], v[220:227], v24 abid:1
    ds_read_b128 v[208:211], v2 offset:6144
    v_cvt_pk_bf16_f32 v179, v182, v183
    v_smfmac_f32_16x16x64_bf16 v[128:131], a[148:151], v[228:235], v28 abid:1
    s_waitcnt lgkmcnt(7)
    v_xad_u32 v236, v236, v3, v4
    v_smfmac_f32_16x16x64_bf16 v[128:131], v[240:243], v[244:251], v10
    s_add_u32 m0, m0, 896
    v_xad_u32 v237, v237, v3, v4
    v_smfmac_f32_16x16x64_bf16 v[164:167], v[240:243], v[244:251], v10 abid:1
    ds_read2st64_b32 v[244:245], v236 offset0:0 offset1:72
    ds_read_b128 v[240:243], v8 offset:2048
    v_xad_u32 v238, v238, v3, v4
    v_smfmac_f32_16x16x64_bf16 v[132:135], a[116:119], v[220:227], v25
    ds_read2st64_b32 v[246:247], v237 offset0:0 offset1:72
    s_waitcnt vmcnt(5)
    v_xad_u32 v239, v239, v3, v4
    v_smfmac_f32_16x16x64_bf16 v[132:135], a[152:155], v[228:235], v29
    ds_read2st64_b32 v[248:249], v238 offset0:0 offset1:72
    buffer_load_dwordx4 v5, s[8:11], s22 offen offset:768 nt lds
    v_cvt_pk_bf16_f32 v184, v184, v185
    v_smfmac_f32_16x16x64_bf16 v[136:139], a[120:123], v[220:227], v25 abid:1
    ds_read2st64_b32 v[250:251], v239 offset0:0 offset1:72
    ds_read_b128 v[236:239], v9 offset:9216
    v_cvt_pk_bf16_f32 v185, v186, v187
    v_smfmac_f32_16x16x64_bf16 v[136:139], a[156:159], v[228:235], v29 abid:1
    v_cvt_pk_bf16_f32 v186, v188, v189
    v_smfmac_f32_16x16x64_bf16 v[140:143], a[124:127], v[220:227], v26
    v_cvt_pk_bf16_f32 v187, v190, v191
    v_smfmac_f32_16x16x64_bf16 v[140:143], a[160:163], v[228:235], v30
    ds_read_b128 v[188:191], v9 offset:10688
    v_cndmask_b32_dpp v180, v176, v184, vcc row_ror:8 row_mask:0xf bank_mask:0xf
    v_smfmac_f32_16x16x64_bf16 v[144:147], a[128:131], v[220:227], v26 abid:1
    v_cndmask_b32_dpp v181, v177, v185, vcc row_ror:8 row_mask:0xf bank_mask:0xf
    v_smfmac_f32_16x16x64_bf16 v[144:147], a[164:167], v[228:235], v30 abid:1
    v_cndmask_b32_dpp v182, v178, v186, vcc row_ror:8 row_mask:0xf bank_mask:0xf
    v_smfmac_f32_16x16x64_bf16 v[148:151], a[132:135], v[220:227], v27
    v_cndmask_b32_dpp v183, v179, v187, vcc row_ror:8 row_mask:0xf bank_mask:0xf
    v_smfmac_f32_16x16x64_bf16 v[148:151], a[168:171], v[228:235], v31
    s_waitcnt vmcnt(6)
    buffer_store_dwordx4 v[180:183], v6, s[12:15], s58 offen offset:128 sc1
    v_mov_b32_dpp v176, v184 row_ror:8 row_mask:0xf bank_mask:0xc
    v_smfmac_f32_16x16x64_bf16 v[152:155], a[136:139], v[220:227], v27 abid:1
    v_mov_b32_dpp v177, v185 row_ror:8 row_mask:0xf bank_mask:0xc
    v_smfmac_f32_16x16x64_bf16 v[152:155], a[172:175], v[228:235], v31 abid:1
    s_waitcnt lgkmcnt(1)
    v_xad_u32 v236, v236, v3, v4
    v_smfmac_f32_16x16x64_bf16 v[132:135], v[240:243], v[244:251], v10
    v_xad_u32 v237, v237, v3, v4
    v_smfmac_f32_16x16x64_bf16 v[168:171], v[240:243], v[244:251], v10 abid:1
    ds_read2st64_b32 v[244:245], v236 offset0:0 offset1:72
    ds_read_b128 v[240:243], v8 offset:0
    v_xad_u32 v238, v238, v3, v4
    v_smfmac_f32_16x16x64_bf16 v[156:159], a[140:143], v[220:227], v49 abid:1
    ds_read2st64_b32 v[246:247], v237 offset0:0 offset1:72
    v_xad_u32 v239, v239, v3, v4
    v_smfmac_f32_16x16x64_bf16 v[156:159], a[176:179], v[228:235], v50
    ds_read2st64_b32 v[248:249], v238 offset0:0 offset1:72
    ds_read_b128 v[220:223], v1 offset:7168
    v_mov_b32_dpp v178, v186 row_ror:8 row_mask:0xf bank_mask:0xc
    v_smfmac_f32_16x16x64_bf16 v[124:127], a[180:183], v[196:203], v32
    ds_read2st64_b32 v[250:251], v239 offset0:0 offset1:72
    ds_read_b128 v[236:239], v9 offset:9728
    v_mov_b32_dpp v179, v187 row_ror:8 row_mask:0xf bank_mask:0xc
    v_smfmac_f32_16x16x64_bf16 v[124:127], a[216:219], v[204:211], v36
    ds_read_b128 v[224:227], v2 offset:7168
    s_waitcnt vmcnt(5)
    buffer_store_dwordx4 v[176:179], v6, s[12:15], s23 offen offset:128 sc1
    v_smfmac_f32_16x16x64_bf16 v[128:131], a[184:187], v[196:203], v32 abid:1
    ds_read_b128 v[228:231], v1 offset:8192
    ds_read_b128 v[180:183], v9 offset:10560
    ds_read_b128 v[184:187], v9 offset:10624
    v_smfmac_f32_16x16x64_bf16 v[128:131], a[220:223], v[204:211], v36 abid:1
    ds_read_b128 v[232:235], v2 offset:8192
    ds_read_b128 v[176:179], v9 offset:10496
    v_xad_u32 v212, v216, v3, v4
    v_smfmac_f32_16x16x64_bf16 v[132:135], a[188:191], v[196:203], v33
    ds_read2st64_b32 v[212:213], v212 offset0:0 offset1:72
    v_xad_u32 v214, v217, v3, v4
    v_smfmac_f32_16x16x64_bf16 v[132:135], a[224:227], v[204:211], v37
    ds_read2st64_b32 v[214:215], v214 offset0:0 offset1:72
    v_smfmac_f32_16x16x64_bf16 v[136:139], a[192:195], v[196:203], v33 abid:1
    v_smfmac_f32_16x16x64_bf16 v[136:139], a[228:231], v[204:211], v37 abid:1
    v_smfmac_f32_16x16x64_bf16 v[140:143], a[196:199], v[196:203], v34
    v_smfmac_f32_16x16x64_bf16 v[140:143], a[232:235], v[204:211], v38
    s_waitcnt vmcnt(7)
    s_waitcnt lgkmcnt(8)
    v_xad_u32 v236, v236, v3, v4
    v_smfmac_f32_16x16x64_bf16 v[124:127], v[240:243], v[244:251], v10
    v_xad_u32 v237, v237, v3, v4
    v_smfmac_f32_16x16x64_bf16 v[160:163], v[240:243], v[244:251], v10 abid:1
    ds_read2st64_b32 v[244:245], v236 offset0:0 offset1:72
    ds_read_b128 v[240:243], v8 offset:8192
    v_xad_u32 v238, v238, v3, v4
    v_smfmac_f32_16x16x64_bf16 v[144:147], a[200:203], v[196:203], v34 abid:1
    ds_read2st64_b32 v[246:247], v237 offset0:0 offset1:72
    v_xad_u32 v239, v239, v3, v4
    v_smfmac_f32_16x16x64_bf16 v[144:147], a[236:239], v[204:211], v38 abid:1
    ds_read2st64_b32 v[248:249], v238 offset0:0 offset1:72
    v_mul_u32_u24 v0, s94, v0
    v_smfmac_f32_16x16x64_bf16 v[148:151], a[204:207], v[196:203], v35
    ds_read2st64_b32 v[250:251], v239 offset0:0 offset1:72
    ds_read_b128 v[236:239], v9 offset:9664
    v_add_u32 v0, s93, v0
    v_smfmac_f32_16x16x64_bf16 v[148:151], a[240:243], v[204:211], v39
    s_add_u32 m0, m0, 896
    v_min_u32 v0, 75497472, v0
    v_smfmac_f32_16x16x64_bf16 v[152:155], a[208:211], v[196:203], v35 abid:1
    ds_write_b32 v11, v0
    s_waitcnt vmcnt(6)
    v_mov_b32 v0, 162048
    v_smfmac_f32_16x16x64_bf16 v[152:155], a[244:247], v[204:211], v39 abid:1
    buffer_load_dwordx4 v5, s[8:11], s22 offen offset:896 nt lds
    v_smfmac_f32_16x16x64_bf16 v[156:159], a[212:215], v[196:203], v50 abid:1
    s_waitcnt lgkmcnt(7)
    s_cmp_lt_i32 s81, 0
    s_cbranch_scc1 M_ovrE0
    s_swappc_b64 s[78:79], s[72:73]
M_ovrE0:
    v_smfmac_f32_16x16x64_bf16 v[156:159], a[248:251], v[204:211], v51
    ds_read_b128 v[196:199], v1 offset:18432
    v_smfmac_f32_16x16x64_bf16 v[124:127], a[252:255], v[220:227], v40
    ds_read_b128 v[200:203], v2 offset:18432
    v_smfmac_f32_16x16x64_bf16 v[124:127], v[88:91], v[228:235], v44
    ds_read_b128 v[204:207], v1 offset:19456
    v_smfmac_f32_16x16x64_bf16 v[128:131], v[56:59], v[220:227], v40 abid:1
    ds_read_b128 v[208:211], v2 offset:19456
    v_smfmac_f32_16x16x64_bf16 v[128:131], v[92:95], v[228:235], v44 abid:1
    s_waitcnt lgkmcnt(4)
    s_barrier
    v_xad_u32 v236, v236, v3, v4
    v_smfmac_f32_16x16x64_bf16 v[156:159], v[240:243], v[244:251], v10
    ds_read_b32 v0, v0
    v_xad_u32 v237, v237, v3, v4
    v_smfmac_f32_16x16x64_bf16 v[192:195], v[240:243], v[244:251], v10 abid:1
    ds_read2st64_b32 v[244:245], v236 offset0:0 offset1:72
    ds_read_b128 v[240:243], v8 offset:7168
    v_xad_u32 v238, v238, v3, v4
    v_smfmac_f32_16x16x64_bf16 v[132:135], v[60:63], v[220:227], v41
    ds_read2st64_b32 v[246:247], v237 offset0:0 offset1:72
    v_xad_u32 v239, v239, v3, v4
    v_smfmac_f32_16x16x64_bf16 v[132:135], v[96:99], v[228:235], v45
    ds_read2st64_b32 v[248:249], v238 offset0:0 offset1:72
    s_add_u32 m0, m0, 896
    v_smfmac_f32_16x16x64_bf16 v[136:139], v[64:67], v[220:227], v41 abid:1
    ds_read2st64_b32 v[250:251], v239 offset0:0 offset1:72
    ds_read_b128 v[236:239], v9 offset:9536
    s_waitcnt vmcnt(5)
    v_smfmac_f32_16x16x64_bf16 v[136:139], v[100:103], v[228:235], v45 abid:1
    buffer_load_dwordx4 v5, s[8:11], s22 offen offset:1024 nt lds
    s_waitcnt lgkmcnt(6)
    v_readfirstlane_b32 s88, v0
    v_smfmac_f32_16x16x64_bf16 v[140:143], v[68:71], v[220:227], v42
    s_cmp_lt_u32 s88, 75497472
    s_cselect_b32 s10, 75497472, 0
    v_smfmac_f32_16x16x64_bf16 v[140:143], v[104:107], v[228:235], v46
    v_smfmac_f32_16x16x64_bf16 v[144:147], v[72:75], v[220:227], v42 abid:1
    ds_read_b128 v[212:215], v1 offset:20480
    v_smfmac_f32_16x16x64_bf16 v[144:147], v[108:111], v[228:235], v46 abid:1
    ds_read_b128 v[216:219], v2 offset:20480
    v_smfmac_f32_16x16x64_bf16 v[148:151], v[76:79], v[220:227], v43
    v_smfmac_f32_16x16x64_bf16 v[148:151], v[112:115], v[228:235], v47
    v_smfmac_f32_16x16x64_bf16 v[152:155], v[80:83], v[220:227], v43 abid:1
    v_smfmac_f32_16x16x64_bf16 v[152:155], v[116:119], v[228:235], v47 abid:1
    s_waitcnt lgkmcnt(2)
    v_xad_u32 v236, v236, v3, v4
    v_smfmac_f32_16x16x64_bf16 v[152:155], v[240:243], v[244:251], v10
    v_xad_u32 v237, v237, v3, v4
    v_smfmac_f32_16x16x64_bf16 v[188:191], v[240:243], v[244:251], v10 abid:1
    s_cmp_gt_u32 s46, s80
    s_cbranch_scc1 M_slow
M_slowrE0:
    v_xad_u32 v238, v238, v3, v4
    v_smfmac_f32_16x16x64_bf16 v[156:159], v[84:87], v[220:227], v51 abid:1
    ds_read2st64_b32 v[244:245], v236 offset0:0 offset1:72
    ds_read_b128 v[240:243], v8 offset:5120
    v_xad_u32 v239, v239, v3, v4
    v_smfmac_f32_16x16x64_bf16 v[156:159], v[120:123], v[228:235], v52
    ds_read2st64_b32 v[246:247], v237 offset0:0 offset1:72
    ds_read_b128 v[220:223], v1 offset:21504
    v_smfmac_f32_16x16x64_bf16 v[160:163], a[0:3], v[196:203], v12
    ds_read2st64_b32 v[248:249], v238 offset0:0 offset1:72
    ds_read_b128 v[224:227], v2 offset:21504
    v_smfmac_f32_16x16x64_bf16 v[160:163], a[36:39], v[204:211], v16
    ds_read2st64_b32 v[250:251], v239 offset0:0 offset1:72
    ds_read_b128 v[236:239], v9 offset:9600
    s_waitcnt lgkmcnt(8)
    v_smfmac_f32_16x16x64_bf16 v[160:163], a[72:75], v[212:219], v20
    ds_read_b128 v[228:231], v1 offset:22528
    v_smfmac_f32_16x16x64_bf16 v[164:167], a[4:7], v[196:203], v12 abid:1
    ds_read_b128 v[232:235], v2 offset:22528
    v_cvt_pk_bf16_f32 v156, v156, v157
    v_smfmac_f32_16x16x64_bf16 v[164:167], a[40:43], v[204:211], v16 abid:1
    s_mov_b32 m0, s28
    v_cvt_pk_bf16_f32 v157, v158, v159
    v_smfmac_f32_16x16x64_bf16 v[164:167], a[76:79], v[212:219], v20 abid:1
    ds_write_b64 v53, v[156:157] offset:25728
    ds_read_b128 v[156:159], v9 offset:10752
    s_waitcnt vmcnt(6)
    v_smfmac_f32_16x16x64_bf16 v[168:171], a[8:11], v[196:203], v13
    buffer_load_dwordx4 v5, s[8:11], s88 offen offset:0 nt lds
    v_smfmac_f32_16x16x64_bf16 v[168:171], a[44:47], v[204:211], v17
    v_cvt_pk_bf16_f32 v124, v124, v125
    v_smfmac_f32_16x16x64_bf16 v[168:171], a[80:83], v[212:219], v21
    s_waitcnt lgkmcnt(4)
    v_xad_u32 v236, v236, v3, v4
    v_smfmac_f32_16x16x64_bf16 v[144:147], v[240:243], v[244:251], v10
    v_xad_u32 v237, v237, v3, v4
    v_smfmac_f32_16x16x64_bf16 v[180:183], v[240:243], v[244:251], v10 abid:1
    ds_read2st64_b32 v[244:245], v236 offset0:0 offset1:72
    ds_read_b128 v[240:243], v8 offset:6144
    v_xad_u32 v238, v238, v3, v4
    v_smfmac_f32_16x16x64_bf16 v[172:175], a[12:15], v[196:203], v13 abid:1
    ds_read2st64_b32 v[246:247], v237 offset0:0 offset1:72
    v_xad_u32 v239, v239, v3, v4
    v_smfmac_f32_16x16x64_bf16 v[172:175], a[48:51], v[204:211], v17 abid:1
    ds_read2st64_b32 v[248:249], v238 offset0:0 offset1:72
    v_cvt_pk_bf16_f32 v125, v126, v127
    v_smfmac_f32_16x16x64_bf16 v[172:175], a[84:87], v[212:219], v21 abid:1
    ds_read2st64_b32 v[250:251], v239 offset0:0 offset1:72
    ds_read_b128 v[236:239], v9 offset:9472
    v_cvt_pk_bf16_f32 v126, v128, v129
    v_smfmac_f32_16x16x64_bf16 v[176:179], a[16:19], v[196:203], v14
    v_cvt_pk_bf16_f32 v127, v130, v131
    v_smfmac_f32_16x16x64_bf16 v[176:179], a[52:55], v[204:211], v18
    v_cvt_pk_bf16_f32 v132, v132, v133
    v_smfmac_f32_16x16x64_bf16 v[176:179], a[88:91], v[212:219], v22
    v_cvt_pk_bf16_f32 v133, v134, v135
    v_smfmac_f32_16x16x64_bf16 v[180:183], a[20:23], v[196:203], v14 abid:1
    s_add_u32 m0, m0, 896
    v_cvt_pk_bf16_f32 v134, v136, v137
    v_smfmac_f32_16x16x64_bf16 v[180:183], a[56:59], v[204:211], v18 abid:1
    s_waitcnt vmcnt(5)
    buffer_load_dwordx4 v5, s[8:11], s88 offen offset:128 nt lds
    v_cvt_pk_bf16_f32 v135, v138, v139
    v_smfmac_f32_16x16x64_bf16 v[180:183], a[92:95], v[212:219], v22 abid:1
    ds_read_b128 v[136:139], v9 offset:10432
    v_cndmask_b32_dpp v128, v124, v132, vcc row_ror:8 row_mask:0xf bank_mask:0xf
    v_smfmac_f32_16x16x64_bf16 v[184:187], a[24:27], v[196:203], v15
    v_cndmask_b32_dpp v129, v125, v133, vcc row_ror:8 row_mask:0xf bank_mask:0xf
    v_smfmac_f32_16x16x64_bf16 v[184:187], a[60:63], v[204:211], v19
    v_cndmask_b32_dpp v130, v126, v134, vcc row_ror:8 row_mask:0xf bank_mask:0xf
    v_smfmac_f32_16x16x64_bf16 v[184:187], a[96:99], v[212:219], v23
    s_waitcnt lgkmcnt(1)
    v_xad_u32 v236, v236, v3, v4
    v_smfmac_f32_16x16x64_bf16 v[148:151], v[240:243], v[244:251], v10
    v_xad_u32 v237, v237, v3, v4
    v_smfmac_f32_16x16x64_bf16 v[184:187], v[240:243], v[244:251], v10 abid:1
    ds_read2st64_b32 v[244:245], v236 offset0:0 offset1:72
    ds_read_b128 v[240:243], v8 offset:4096
    v_xad_u32 v238, v238, v3, v4
    v_smfmac_f32_16x16x64_bf16 v[188:191], a[28:31], v[196:203], v15 abid:1
    ds_read2st64_b32 v[246:247], v237 offset0:0 offset1:72
    v_xad_u32 v239, v239, v3, v4
    v_smfmac_f32_16x16x64_bf16 v[188:191], a[64:67], v[204:211], v19 abid:1
    ds_read2st64_b32 v[248:249], v238 offset0:0 offset1:72
    v_cndmask_b32_dpp v131, v127, v135, vcc row_ror:8 row_mask:0xf bank_mask:0xf
    v_smfmac_f32_16x16x64_bf16 v[188:191], a[100:103], v[212:219], v23 abid:1
    ds_read2st64_b32 v[250:251], v239 offset0:0 offset1:72
    s_waitcnt vmcnt(6)
    buffer_store_dwordx4 v[128:131], v6, s[12:15], s59 offen offset:0 sc1
    v_smfmac_f32_16x16x64_bf16 v[192:195], a[32:35], v[196:203], v48
    v_mov_b32_dpp v124, v132 row_ror:8 row_mask:0xf bank_mask:0xc
    v_smfmac_f32_16x16x64_bf16 v[192:195], a[68:71], v[204:211], v48 abid:1
    v_mov_b32_dpp v125, v133 row_ror:8 row_mask:0xf bank_mask:0xc
    v_smfmac_f32_16x16x64_bf16 v[192:195], a[104:107], v[212:219], v49
    ds_read_b128 v[196:199], v1 offset:23552
    v_mov_b32_dpp v126, v134 row_ror:8 row_mask:0xf bank_mask:0xc
    v_smfmac_f32_16x16x64_bf16 v[160:163], a[108:111], v[220:227], v24
    ds_read_b128 v[200:203], v2 offset:23552
    v_mov_b32_dpp v127, v135 row_ror:8 row_mask:0xf bank_mask:0xc
    v_smfmac_f32_16x16x64_bf16 v[160:163], a[144:147], v[228:235], v28
    ds_read_b128 v[204:207], v1 offset:24576
    s_waitcnt vmcnt(5)
    buffer_store_dwordx4 v[124:127], v6, s[12:15], s24 offen offset:0 sc1
    v_smfmac_f32_16x16x64_bf16 v[164:167], a[112:115], v[220:227], v24 abid:1
    ds_read_b128 v[208:211], v2 offset:24576
    ds_read_b128 v[128:131], v9 offset:10304
    ds_read_b128 v[132:135], v9 offset:10368
    v_smfmac_f32_16x16x64_bf16 v[164:167], a[148:151], v[228:235], v28 abid:1
    ds_read_b128 v[124:127], v9 offset:10240
    v_smfmac_f32_16x16x64_bf16 v[168:171], a[116:119], v[220:227], v25
    v_smfmac_f32_16x16x64_bf16 v[168:171], a[152:155], v[228:235], v29
    s_waitcnt lgkmcnt(7)
    v_smfmac_f32_16x16x64_bf16 v[140:143], v[240:243], v[244:251], v10
    v_smfmac_f32_16x16x64_bf16 v[176:179], v[240:243], v[244:251], v10 abid:1
    v_smfmac_f32_16x16x64_bf16 v[172:175], a[120:123], v[220:227], v25 abid:1
    s_add_u32 s28, s28, 36864
    s_cmp_ge_u32 s28, 110592
    s_cselect_b32 s28, s26, s28
    v_smfmac_f32_16x16x64_bf16 v[172:175], a[156:159], v[228:235], v29 abid:1
    s_add_u32 s30, s25, 36864
    s_cmp_eq_u32 s30, 110592
    s_cselect_b32 s30, 0, s30
    v_smfmac_f32_16x16x64_bf16 v[176:179], a[124:127], v[220:227], v26
    s_sub_u32 s31, s30, s25
    s_mov_b32 s25, s30
    s_mov_b32 s90, s22
    v_smfmac_f32_16x16x64_bf16 v[176:179], a[160:163], v[228:235], v30
    s_mov_b32 s22, s88
    s_add_u32 s91, s91, 1
    s_cmp_lt_u32 s20, 2
    v_smfmac_f32_16x16x64_bf16 v[180:183], a[128:131], v[220:227], v26 abid:1
    s_cselect_b32 s66, s23, s24
    s_add_u32 s66, s66, s95
    v_smfmac_f32_16x16x64_bf16 v[180:183], a[164:167], v[228:235], v30 abid:1
    v_cvt_pk_bf16_f32 v140, v140, v141
    v_smfmac_f32_16x16x64_bf16 v[184:187], a[132:135], v[220:227], v27
    s_add_u32 m0, m0, 896
    v_cvt_pk_bf16_f32 v141, v142, v143
    v_smfmac_f32_16x16x64_bf16 v[184:187], a[168:171], v[228:235], v31
    s_waitcnt vmcnt(6)
    buffer_load_dwordx4 v5, s[8:11], s88 offen offset:256 nt lds
    v_cvt_pk_bf16_f32 v142, v144, v145
    v_smfmac_f32_16x16x64_bf16 v[188:191], a[136:139], v[220:227], v27 abid:1
    v_cvt_pk_bf16_f32 v143, v146, v147
    v_smfmac_f32_16x16x64_bf16 v[188:191], a[172:175], v[228:235], v31 abid:1
    v_cvt_pk_bf16_f32 v148, v148, v149
    v_smfmac_f32_16x16x64_bf16 v[192:195], a[140:143], v[220:227], v49 abid:1
    v_cvt_pk_bf16_f32 v149, v150, v151
    v_smfmac_f32_16x16x64_bf16 v[192:195], a[176:179], v[228:235], v50
    ds_read_b128 v[220:223], v1 offset:25600
    s_waitcnt lgkmcnt(6)
    v_cvt_pk_bf16_f32 v150, v152, v153
    v_smfmac_f32_16x16x64_bf16 v[160:163], a[180:183], v[196:203], v32
    ds_read_b128 v[224:227], v2 offset:25600
    s_waitcnt lgkmcnt(5)
    v_cvt_pk_bf16_f32 v151, v154, v155
    v_smfmac_f32_16x16x64_bf16 v[160:163], a[216:219], v[204:211], v36
    ds_read_b128 v[228:231], v1 offset:26624
    ds_read_b128 v[152:155], v9 offset:10688
    v_cndmask_b32_dpp v144, v140, v148, vcc row_ror:8 row_mask:0xf bank_mask:0xf
    v_smfmac_f32_16x16x64_bf16 v[164:167], a[184:187], v[196:203], v32 abid:1
    ds_read_b128 v[232:235], v2 offset:26624
    v_cndmask_b32_dpp v145, v141, v149, vcc row_ror:8 row_mask:0xf bank_mask:0xf
    v_smfmac_f32_16x16x64_bf16 v[164:167], a[220:223], v[204:211], v36 abid:1
    s_add_u32 m0, m0, 896
    v_cndmask_b32_dpp v146, v142, v150, vcc row_ror:8 row_mask:0xf bank_mask:0xf
    v_smfmac_f32_16x16x64_bf16 v[168:171], a[188:191], v[196:203], v33
    s_waitcnt vmcnt(5)
    buffer_load_dwordx4 v5, s[8:11], s88 offen offset:384 nt lds
    v_cndmask_b32_dpp v147, v143, v151, vcc row_ror:8 row_mask:0xf bank_mask:0xf
    v_smfmac_f32_16x16x64_bf16 v[168:171], a[224:227], v[204:211], v37
    s_waitcnt vmcnt(6)
    buffer_store_dwordx4 v[144:147], v6, s[12:15], s59 offen offset:128 sc1
    v_mov_b32_dpp v140, v148 row_ror:8 row_mask:0xf bank_mask:0xc
    v_smfmac_f32_16x16x64_bf16 v[172:175], a[192:195], v[196:203], v33 abid:1
    v_mov_b32_dpp v141, v149 row_ror:8 row_mask:0xf bank_mask:0xc
    v_smfmac_f32_16x16x64_bf16 v[172:175], a[228:231], v[204:211], v37 abid:1
    v_mov_b32_dpp v142, v150 row_ror:8 row_mask:0xf bank_mask:0xc
    v_smfmac_f32_16x16x64_bf16 v[176:179], a[196:199], v[196:203], v34
    v_mov_b32_dpp v143, v151 row_ror:8 row_mask:0xf bank_mask:0xc
    v_smfmac_f32_16x16x64_bf16 v[176:179], a[232:235], v[204:211], v38
    s_waitcnt vmcnt(5)
    buffer_store_dwordx4 v[140:143], v6, s[12:15], s24 offen offset:128 sc1
    ds_read_b128 v[144:147], v9 offset:10560
    v_smfmac_f32_16x16x64_bf16 v[180:183], a[200:203], v[196:203], v34 abid:1
    ds_read_b128 v[148:151], v9 offset:10624
    ds_read_b128 v[140:143], v9 offset:10496
    v_add_u32 v4, s31, v4
    v_smfmac_f32_16x16x64_bf16 v[180:183], a[236:239], v[204:211], v38 abid:1
    v_add_u32 v1, s31, v1
    v_smfmac_f32_16x16x64_bf16 v[184:187], a[204:207], v[196:203], v35
    v_add_u32 v2, s31, v2
    v_smfmac_f32_16x16x64_bf16 v[184:187], a[240:243], v[204:211], v39
    v_smfmac_f32_16x16x64_bf16 v[188:191], a[208:211], v[196:203], v35 abid:1
    v_smfmac_f32_16x16x64_bf16 v[188:191], a[244:247], v[204:211], v39 abid:1
    v_smfmac_f32_16x16x64_bf16 v[192:195], a[212:215], v[196:203], v50 abid:1
    v_smfmac_f32_16x16x64_bf16 v[192:195], a[248:251], v[204:211], v51
    s_waitcnt vmcnt(8)
    s_branch M_top1
M_bF:
    v_smfmac_f32_16x16x64_bf16 v[164:167], v[56:59], v[220:227], v40 abid:1
    ds_read_b128 v[204:207], v1 offset:1024
    v_smfmac_f32_16x16x64_bf16 v[164:167], v[92:95], v[228:235], v44 abid:1
    ds_read_b128 v[208:211], v2 offset:1024
    v_smfmac_f32_16x16x64_bf16 v[168:171], v[60:63], v[220:227], v41
    ds_read_b128 v[212:215], v1 offset:2048
    v_smfmac_f32_16x16x64_bf16 v[168:171], v[96:99], v[228:235], v45
    ds_read_b128 v[216:219], v2 offset:2048
    v_smfmac_f32_16x16x64_bf16 v[172:175], v[64:67], v[220:227], v41 abid:1
    s_waitcnt lgkmcnt(6)
    buffer_store_dwordx4 v[244:247], v7, s[12:15], s66 offen sc1
    v_smfmac_f32_16x16x64_bf16 v[172:175], v[100:103], v[228:235], v45 abid:1
    ds_read_b128 v[236:239], v9 offset:9408
    v_smfmac_f32_16x16x64_bf16 v[176:179], v[68:71], v[220:227], v42
    s_mov_b32 s21, 3
    v_smfmac_f32_16x16x64_bf16 v[176:179], v[104:107], v[228:235], v46
    v_smfmac_f32_16x16x64_bf16 v[180:183], v[72:75], v[220:227], v42 abid:1
    v_cvt_pk_bf16_f32 v160, v160, v161
    v_smfmac_f32_16x16x64_bf16 v[180:183], v[108:111], v[228:235], v46 abid:1
    v_cvt_pk_bf16_f32 v161, v162, v163
    v_smfmac_f32_16x16x64_bf16 v[184:187], v[76:79], v[220:227], v43
    v_cvt_pk_bf16_f32 v162, v164, v165
    v_smfmac_f32_16x16x64_bf16 v[184:187], v[112:115], v[228:235], v47
    v_cvt_pk_bf16_f32 v163, v166, v167
    v_smfmac_f32_16x16x64_bf16 v[188:191], v[80:83], v[220:227], v43 abid:1
    v_cvt_pk_bf16_f32 v168, v168, v169
    v_smfmac_f32_16x16x64_bf16 v[188:191], v[116:119], v[228:235], v47 abid:1
    v_cvt_pk_bf16_f32 v169, v170, v171
    v_smfmac_f32_16x16x64_bf16 v[192:195], v[84:87], v[220:227], v51 abid:1
    v_cvt_pk_bf16_f32 v170, v172, v173
    v_smfmac_f32_16x16x64_bf16 v[192:195], v[120:123], v[228:235], v52
    ds_read_b128 v[220:223], v1 offset:3072
    s_waitcnt lgkmcnt(6)
    v_cvt_pk_bf16_f32 v171, v174, v175
    v_smfmac_f32_16x16x64_bf16 v[124:127], a[0:3], v[196:203], v12
    ds_read_b128 v[224:227], v2 offset:3072
    ds_read_b128 v[172:175], v9 offset:10432
    s_waitcnt lgkmcnt(6)
    v_cndmask_b32_dpp v164, v160, v168, vcc row_ror:8 row_mask:0xf bank_mask:0xf
    v_smfmac_f32_16x16x64_bf16 v[124:127], a[36:39], v[204:211], v16
    ds_read_b128 v[228:231], v1 offset:4096
    s_waitcnt lgkmcnt(5)
    v_cndmask_b32_dpp v165, v161, v169, vcc row_ror:8 row_mask:0xf bank_mask:0xf
    v_smfmac_f32_16x16x64_bf16 v[124:127], a[72:75], v[212:219], v20
    ds_read_b128 v[232:235], v2 offset:4096
    s_waitcnt lgkmcnt(5)
    v_xad_u32 v236, v236, v3, v4
    v_smfmac_f32_16x16x64_bf16 v[128:131], a[4:7], v[196:203], v12 abid:1
    s_barrier
    v_xad_u32 v237, v237, v3, v4
    v_smfmac_f32_16x16x64_bf16 v[128:131], a[40:43], v[204:211], v16 abid:1
    ds_read2st64_b32 v[244:245], v236 offset0:0 offset1:72
    ds_read_b128 v[240:243], v8 offset:3072
    v_xad_u32 v238, v238, v3, v4
    v_smfmac_f32_16x16x64_bf16 v[128:131], a[76:79], v[212:219], v20 abid:1
    ds_read2st64_b32 v[246:247], v237 offset0:0 offset1:72
    v_xad_u32 v239, v239, v3, v4
    v_smfmac_f32_16x16x64_bf16 v[132:135], a[8:11], v[196:203], v13
    ds_read2st64_b32 v[248:249], v238 offset0:0 offset1:72
    v_cndmask_b32_dpp v166, v162, v170, vcc row_ror:8 row_mask:0xf bank_mask:0xf
    v_smfmac_f32_16x16x64_bf16 v[132:135], a[44:47], v[204:211], v17
    ds_read2st64_b32 v[250:251], v239 offset0:0 offset1:72
    ds_read_b128 v[236:239], v9 offset:9280
    v_cndmask_b32_dpp v167, v163, v171, vcc row_ror:8 row_mask:0xf bank_mask:0xf
    v_smfmac_f32_16x16x64_bf16 v[132:135], a[80:83], v[212:219], v21
    buffer_store_dwordx4 v[164:167], v6, s[12:15], s58 offen offset:0 sc1
    v_mov_b32_dpp v160, v168 row_ror:8 row_mask:0xf bank_mask:0xc
    v_smfmac_f32_16x16x64_bf16 v[136:139], a[12:15], v[196:203], v13 abid:1
    v_mov_b32_dpp v161, v169 row_ror:8 row_mask:0xf bank_mask:0xc
    v_smfmac_f32_16x16x64_bf16 v[136:139], a[48:51], v[204:211], v17 abid:1
    v_mov_b32_dpp v162, v170 row_ror:8 row_mask:0xf bank_mask:0xc
    v_smfmac_f32_16x16x64_bf16 v[136:139], a[84:87], v[212:219], v21 abid:1
    v_mov_b32_dpp v163, v171 row_ror:8 row_mask:0xf bank_mask:0xc
    v_smfmac_f32_16x16x64_bf16 v[140:143], a[16:19], v[196:203], v14
    buffer_store_dwordx4 v[160:163], v6, s[12:15], s23 offen offset:0 sc1
    ds_read_b128 v[164:167], v9 offset:10304
    ds_read_b128 v[168:171], v9 offset:10368
    v_smfmac_f32_16x16x64_bf16 v[140:143], a[52:55], v[204:211], v18
    ds_read_b128 v[160:163], v9 offset:10240
    v_smfmac_f32_16x16x64_bf16 v[140:143], a[88:91], v[212:219], v22
    s_waitcnt lgkmcnt(3)
    v_xad_u32 v236, v236, v3, v4
    v_smfmac_f32_16x16x64_bf16 v[136:139], v[240:243], v[244:251], v10
    v_xad_u32 v237, v237, v3, v4
    v_smfmac_f32_16x16x64_bf16 v[172:175], v[240:243], v[244:251], v10 abid:1
    ds_read2st64_b32 v[244:245], v236 offset0:0 offset1:72
    ds_read_b128 v[240:243], v8 offset:1024
    v_xad_u32 v238, v238, v3, v4
    v_smfmac_f32_16x16x64_bf16 v[144:147], a[20:23], v[196:203], v14 abid:1
    ds_read2st64_b32 v[246:247], v237 offset0:0 offset1:72
    v_xad_u32 v239, v239, v3, v4
    v_smfmac_f32_16x16x64_bf16 v[144:147], a[56:59], v[204:211], v18 abid:1
    ds_read2st64_b32 v[248:249], v238 offset0:0 offset1:72
    v_smfmac_f32_16x16x64_bf16 v[144:147], a[92:95], v[212:219], v22 abid:1
    ds_read2st64_b32 v[250:251], v239 offset0:0 offset1:72
    ds_read_b128 v[236:239], v9 offset:9344
    v_smfmac_f32_16x16x64_bf16 v[148:151], a[24:27], v[196:203], v15
    v_cvt_pk_bf16_f32 v192, v192, v193
    v_smfmac_f32_16x16x64_bf16 v[148:151], a[60:63], v[204:211], v19
    v_cvt_pk_bf16_f32 v193, v194, v195
    v_smfmac_f32_16x16x64_bf16 v[148:151], a[96:99], v[212:219], v23
    ds_write_b64 v53, v[192:193] offset:0
    ds_read_b128 v[192:195], v9 offset:10752
    v_smfmac_f32_16x16x64_bf16 v[152:155], a[28:31], v[196:203], v15 abid:1
    v_smfmac_f32_16x16x64_bf16 v[152:155], a[64:67], v[204:211], v19 abid:1
    v_smfmac_f32_16x16x64_bf16 v[152:155], a[100:103], v[212:219], v23 abid:1
    v_smfmac_f32_16x16x64_bf16 v[156:159], a[32:35], v[196:203], v48
    v_smfmac_f32_16x16x64_bf16 v[156:159], a[68:71], v[204:211], v48 abid:1
    v_smfmac_f32_16x16x64_bf16 v[156:159], a[104:107], v[212:219], v49
    s_waitcnt lgkmcnt(2)
    v_xad_u32 v236, v236, v3, v4
    v_smfmac_f32_16x16x64_bf16 v[128:131], v[240:243], v[244:251], v10
    ds_read_b128 v[196:199], v1 offset:5120
    v_xad_u32 v237, v237, v3, v4
    v_smfmac_f32_16x16x64_bf16 v[164:167], v[240:243], v[244:251], v10 abid:1
    ds_read2st64_b32 v[244:245], v236 offset0:0 offset1:72
    ds_read_b128 v[240:243], v8 offset:2048
    v_xad_u32 v238, v238, v3, v4
    v_smfmac_f32_16x16x64_bf16 v[124:127], a[108:111], v[220:227], v24
    ds_read2st64_b32 v[246:247], v237 offset0:0 offset1:72
    v_xad_u32 v239, v239, v3, v4
    v_smfmac_f32_16x16x64_bf16 v[124:127], a[144:147], v[228:235], v28
    ds_read2st64_b32 v[248:249], v238 offset0:0 offset1:72
    ds_read_b128 v[200:203], v2 offset:5120
    v_cvt_pk_bf16_f32 v176, v176, v177
    v_smfmac_f32_16x16x64_bf16 v[128:131], a[112:115], v[220:227], v24 abid:1
    ds_read2st64_b32 v[250:251], v239 offset0:0 offset1:72
    ds_read_b128 v[236:239], v9 offset:9216
    v_cvt_pk_bf16_f32 v177, v178, v179
    v_smfmac_f32_16x16x64_bf16 v[128:131], a[148:151], v[228:235], v28 abid:1
    ds_read_b128 v[204:207], v1 offset:6144
    ds_read_b64 v[216:217], v9 offset:10056
    v_cvt_pk_bf16_f32 v178, v180, v181
    v_smfmac_f32_16x16x64_bf16 v[132:135], a[116:119], v[220:227], v25
    ds_read_b128 v[208:211], v2 offset:6144
    v_cvt_pk_bf16_f32 v179, v182, v183
    v_smfmac_f32_16x16x64_bf16 v[132:135], a[152:155], v[228:235], v29
    v_cvt_pk_bf16_f32 v184, v184, v185
    v_smfmac_f32_16x16x64_bf16 v[136:139], a[120:123], v[220:227], v25 abid:1
    v_cvt_pk_bf16_f32 v185, v186, v187
    v_smfmac_f32_16x16x64_bf16 v[136:139], a[156:159], v[228:235], v29 abid:1
    v_cvt_pk_bf16_f32 v186, v188, v189
    v_smfmac_f32_16x16x64_bf16 v[140:143], a[124:127], v[220:227], v26
    v_cvt_pk_bf16_f32 v187, v190, v191
    v_smfmac_f32_16x16x64_bf16 v[140:143], a[160:163], v[228:235], v30
    ds_read_b128 v[188:191], v9 offset:10688
    s_waitcnt lgkmcnt(4)
    v_xad_u32 v236, v236, v3, v4
    v_smfmac_f32_16x16x64_bf16 v[132:135], v[240:243], v[244:251], v10
    v_xad_u32 v237, v237, v3, v4
    v_smfmac_f32_16x16x64_bf16 v[168:171], v[240:243], v[244:251], v10 abid:1
    ds_read2st64_b32 v[244:245], v236 offset0:0 offset1:72
    ds_read_b128 v[240:243], v8 offset:0
    v_xad_u32 v238, v238, v3, v4
    v_smfmac_f32_16x16x64_bf16 v[144:147], a[128:131], v[220:227], v26 abid:1
    ds_read2st64_b32 v[246:247], v237 offset0:0 offset1:72
    v_xad_u32 v239, v239, v3, v4
    v_smfmac_f32_16x16x64_bf16 v[144:147], a[164:167], v[228:235], v30 abid:1
    ds_read2st64_b32 v[248:249], v238 offset0:0 offset1:72
    v_cndmask_b32_dpp v180, v176, v184, vcc row_ror:8 row_mask:0xf bank_mask:0xf
    v_smfmac_f32_16x16x64_bf16 v[148:151], a[132:135], v[220:227], v27
    ds_read2st64_b32 v[250:251], v239 offset0:0 offset1:72
    ds_read_b128 v[236:239], v9 offset:9728
    v_cndmask_b32_dpp v181, v177, v185, vcc row_ror:8 row_mask:0xf bank_mask:0xf
    v_smfmac_f32_16x16x64_bf16 v[148:151], a[168:171], v[228:235], v31
    v_cndmask_b32_dpp v182, v178, v186, vcc row_ror:8 row_mask:0xf bank_mask:0xf
    v_smfmac_f32_16x16x64_bf16 v[152:155], a[136:139], v[220:227], v27 abid:1
    v_cndmask_b32_dpp v183, v179, v187, vcc row_ror:8 row_mask:0xf bank_mask:0xf
    v_smfmac_f32_16x16x64_bf16 v[152:155], a[172:175], v[228:235], v31 abid:1
    buffer_store_dwordx4 v[180:183], v6, s[12:15], s58 offen offset:128 sc1
    v_mov_b32_dpp v176, v184 row_ror:8 row_mask:0xf bank_mask:0xc
    v_smfmac_f32_16x16x64_bf16 v[156:159], a[140:143], v[220:227], v49 abid:1
    v_mov_b32_dpp v177, v185 row_ror:8 row_mask:0xf bank_mask:0xc
    v_smfmac_f32_16x16x64_bf16 v[156:159], a[176:179], v[228:235], v50
    ds_read_b128 v[220:223], v1 offset:7168
    v_mov_b32_dpp v178, v186 row_ror:8 row_mask:0xf bank_mask:0xc
    v_smfmac_f32_16x16x64_bf16 v[124:127], a[180:183], v[196:203], v32
    ds_read_b128 v[224:227], v2 offset:7168
    s_waitcnt lgkmcnt(9)
    v_mov_b32_dpp v179, v187 row_ror:8 row_mask:0xf bank_mask:0xc
    v_smfmac_f32_16x16x64_bf16 v[124:127], a[216:219], v[204:211], v36
    ds_read_b128 v[228:231], v1 offset:8192
    buffer_store_dwordx4 v[176:179], v6, s[12:15], s23 offen offset:128 sc1
    ds_read_b128 v[180:183], v9 offset:10560
    v_smfmac_f32_16x16x64_bf16 v[128:131], a[184:187], v[196:203], v32 abid:1
    ds_read_b128 v[232:235], v2 offset:8192
    ds_read_b128 v[184:187], v9 offset:10624
    ds_read_b128 v[176:179], v9 offset:10496
    v_smfmac_f32_16x16x64_bf16 v[128:131], a[220:223], v[204:211], v36 abid:1
    s_waitcnt lgkmcnt(7)
    v_xad_u32 v236, v236, v3, v4
    v_smfmac_f32_16x16x64_bf16 v[124:127], v[240:243], v[244:251], v10
    v_xad_u32 v237, v237, v3, v4
    v_smfmac_f32_16x16x64_bf16 v[160:163], v[240:243], v[244:251], v10 abid:1
    ds_read2st64_b32 v[244:245], v236 offset0:0 offset1:72
    ds_read_b128 v[240:243], v8 offset:8192
    v_xad_u32 v238, v238, v3, v4
    v_smfmac_f32_16x16x64_bf16 v[132:135], a[188:191], v[196:203], v33
    ds_read2st64_b32 v[246:247], v237 offset0:0 offset1:72
    v_xad_u32 v239, v239, v3, v4
    v_smfmac_f32_16x16x64_bf16 v[132:135], a[224:227], v[204:211], v37
    ds_read2st64_b32 v[248:249], v238 offset0:0 offset1:72
    v_xad_u32 v212, v216, v3, v4
    v_smfmac_f32_16x16x64_bf16 v[136:139], a[192:195], v[196:203], v33 abid:1
    ds_read2st64_b32 v[250:251], v239 offset0:0 offset1:72
    ds_read_b128 v[236:239], v9 offset:9664
    ds_read2st64_b32 v[212:213], v212 offset0:0 offset1:72
    v_smfmac_f32_16x16x64_bf16 v[136:139], a[228:231], v[204:211], v37 abid:1
    v_xad_u32 v214, v217, v3, v4
    v_smfmac_f32_16x16x64_bf16 v[140:143], a[196:199], v[196:203], v34
    ds_read2st64_b32 v[214:215], v214 offset0:0 offset1:72
    v_smfmac_f32_16x16x64_bf16 v[140:143], a[232:235], v[204:211], v38
    v_smfmac_f32_16x16x64_bf16 v[144:147], a[200:203], v[196:203], v34 abid:1
    v_smfmac_f32_16x16x64_bf16 v[144:147], a[236:239], v[204:211], v38 abid:1
    v_smfmac_f32_16x16x64_bf16 v[148:151], a[204:207], v[196:203], v35
    v_smfmac_f32_16x16x64_bf16 v[148:151], a[240:243], v[204:211], v39
    s_waitcnt lgkmcnt(2)
    v_xad_u32 v236, v236, v3, v4
    v_smfmac_f32_16x16x64_bf16 v[156:159], v[240:243], v[244:251], v10
    v_xad_u32 v237, v237, v3, v4
    v_smfmac_f32_16x16x64_bf16 v[192:195], v[240:243], v[244:251], v10 abid:1
    ds_read2st64_b32 v[244:245], v236 offset0:0 offset1:72
    ds_read_b128 v[240:243], v8 offset:7168
    v_xad_u32 v238, v238, v3, v4
    v_smfmac_f32_16x16x64_bf16 v[152:155], a[208:211], v[196:203], v35 abid:1
    ds_read2st64_b32 v[246:247], v237 offset0:0 offset1:72
    v_xad_u32 v239, v239, v3, v4
    v_smfmac_f32_16x16x64_bf16 v[152:155], a[244:247], v[204:211], v39 abid:1
    ds_read2st64_b32 v[248:249], v238 offset0:0 offset1:72
    v_smfmac_f32_16x16x64_bf16 v[156:159], a[212:215], v[196:203], v50 abid:1
    ds_read2st64_b32 v[250:251], v239 offset0:0 offset1:72
    ds_read_b128 v[236:239], v9 offset:9536
    v_smfmac_f32_16x16x64_bf16 v[156:159], a[248:251], v[204:211], v51
    ds_read_b128 v[196:199], v1 offset:18432
    v_smfmac_f32_16x16x64_bf16 v[124:127], a[252:255], v[220:227], v40
    ds_read_b128 v[200:203], v2 offset:18432
    v_smfmac_f32_16x16x64_bf16 v[124:127], v[88:91], v[228:235], v44
    ds_read_b128 v[204:207], v1 offset:19456
    v_smfmac_f32_16x16x64_bf16 v[128:131], v[56:59], v[220:227], v40 abid:1
    ds_read_b128 v[208:211], v2 offset:19456
    v_smfmac_f32_16x16x64_bf16 v[128:131], v[92:95], v[228:235], v44 abid:1
    s_waitcnt lgkmcnt(10)
    s_cmp_lt_i32 s81, 0
    s_cbranch_scc1 M_ovrF
    s_swappc_b64 s[78:79], s[72:73]
M_ovrF:
    v_smfmac_f32_16x16x64_bf16 v[132:135], v[60:63], v[220:227], v41
    s_cmp_lt_u32 s20, 2
    s_cselect_b32 s66, s23, s24
    s_add_u32 s66, s66, s95
    v_smfmac_f32_16x16x64_bf16 v[132:135], v[96:99], v[228:235], v45
    s_add_u32 s23, s24, 18432
    s_add_u32 s58, s24, 27648
    s_add_u32 s67, s23, s95
    v_smfmac_f32_16x16x64_bf16 v[136:139], v[64:67], v[220:227], v41 abid:1
    v_smfmac_f32_16x16x64_bf16 v[136:139], v[100:103], v[228:235], v45 abid:1
    s_waitcnt lgkmcnt(4)
    v_xad_u32 v236, v236, v3, v4
    v_smfmac_f32_16x16x64_bf16 v[152:155], v[240:243], v[244:251], v10
    v_xad_u32 v237, v237, v3, v4
    v_smfmac_f32_16x16x64_bf16 v[188:191], v[240:243], v[244:251], v10 abid:1
    s_cmp_gt_u32 s46, s80
    s_cbranch_scc1 M_slow
M_slowrF:
    v_xad_u32 v238, v238, v3, v4
    v_smfmac_f32_16x16x64_bf16 v[140:143], v[68:71], v[220:227], v42
    ds_read2st64_b32 v[244:245], v236 offset0:0 offset1:72
    ds_read_b128 v[240:243], v8 offset:5120
    v_xad_u32 v239, v239, v3, v4
    v_smfmac_f32_16x16x64_bf16 v[140:143], v[104:107], v[228:235], v46
    ds_read2st64_b32 v[246:247], v237 offset0:0 offset1:72
    v_smfmac_f32_16x16x64_bf16 v[144:147], v[72:75], v[220:227], v42 abid:1
    ds_read2st64_b32 v[248:249], v238 offset0:0 offset1:72
    ds_read_b128 v[212:215], v1 offset:20480
    v_smfmac_f32_16x16x64_bf16 v[144:147], v[108:111], v[228:235], v46 abid:1
    ds_read2st64_b32 v[250:251], v239 offset0:0 offset1:72
    ds_read_b128 v[236:239], v9 offset:9600
    v_smfmac_f32_16x16x64_bf16 v[148:151], v[76:79], v[220:227], v43
    ds_read_b128 v[216:219], v2 offset:20480
    v_smfmac_f32_16x16x64_bf16 v[148:151], v[112:115], v[228:235], v47
    v_smfmac_f32_16x16x64_bf16 v[152:155], v[80:83], v[220:227], v43 abid:1
    v_smfmac_f32_16x16x64_bf16 v[152:155], v[116:119], v[228:235], v47 abid:1
    v_smfmac_f32_16x16x64_bf16 v[156:159], v[84:87], v[220:227], v51 abid:1
    v_smfmac_f32_16x16x64_bf16 v[156:159], v[120:123], v[228:235], v52
    ds_read_b128 v[220:223], v1 offset:21504
    s_waitcnt lgkmcnt(2)
    v_xad_u32 v236, v236, v3, v4
    v_smfmac_f32_16x16x64_bf16 v[144:147], v[240:243], v[244:251], v10
    ds_read_b128 v[224:227], v2 offset:21504
    v_xad_u32 v237, v237, v3, v4
    v_smfmac_f32_16x16x64_bf16 v[180:183], v[240:243], v[244:251], v10 abid:1
    ds_read2st64_b32 v[244:245], v236 offset0:0 offset1:72
    ds_read_b128 v[240:243], v8 offset:6144
    v_xad_u32 v238, v238, v3, v4
    v_smfmac_f32_16x16x64_bf16 v[192:195], a[32:35], v[196:203], v48
    ds_read2st64_b32 v[246:247], v237 offset0:0 offset1:72
    ds_read_b128 v[228:231], v1 offset:22528
    v_xad_u32 v239, v239, v3, v4
    v_smfmac_f32_16x16x64_bf16 v[192:195], a[68:71], v[204:211], v48 abid:1
    ds_read2st64_b32 v[248:249], v238 offset0:0 offset1:72
    ds_read_b128 v[232:235], v2 offset:22528
    s_waitcnt lgkmcnt(8)
    v_cvt_pk_bf16_f32 v124, v124, v125
    v_smfmac_f32_16x16x64_bf16 v[192:195], a[104:107], v[212:219], v49
    ds_read2st64_b32 v[250:251], v239 offset0:0 offset1:72
    ds_read_b128 v[236:239], v9 offset:9472
    v_cvt_pk_bf16_f32 v125, v126, v127
    v_smfmac_f32_16x16x64_bf16 v[160:163], a[0:3], v[196:203], v12
    v_cvt_pk_bf16_f32 v126, v128, v129
    v_smfmac_f32_16x16x64_bf16 v[160:163], a[36:39], v[204:211], v16
    v_cvt_pk_bf16_f32 v127, v130, v131
    v_smfmac_f32_16x16x64_bf16 v[160:163], a[72:75], v[212:219], v20
    v_cvt_pk_bf16_f32 v156, v156, v157
    v_smfmac_f32_16x16x64_bf16 v[164:167], a[4:7], v[196:203], v12 abid:1
    v_cvt_pk_bf16_f32 v157, v158, v159
    v_smfmac_f32_16x16x64_bf16 v[164:167], a[40:43], v[204:211], v16 abid:1
    ds_write_b64 v53, v[156:157] offset:25728
    v_cvt_pk_bf16_f32 v132, v132, v133
    v_smfmac_f32_16x16x64_bf16 v[164:167], a[76:79], v[212:219], v20 abid:1
    v_cvt_pk_bf16_f32 v133, v134, v135
    v_smfmac_f32_16x16x64_bf16 v[168:171], a[8:11], v[196:203], v13
    v_cvt_pk_bf16_f32 v134, v136, v137
    v_smfmac_f32_16x16x64_bf16 v[168:171], a[44:47], v[204:211], v17
    v_cvt_pk_bf16_f32 v135, v138, v139
    v_smfmac_f32_16x16x64_bf16 v[168:171], a[80:83], v[212:219], v21
    s_waitcnt lgkmcnt(1)
    v_xad_u32 v236, v236, v3, v4
    v_smfmac_f32_16x16x64_bf16 v[148:151], v[240:243], v[244:251], v10
    v_xad_u32 v237, v237, v3, v4
    v_smfmac_f32_16x16x64_bf16 v[184:187], v[240:243], v[244:251], v10 abid:1
    ds_read2st64_b32 v[244:245], v236 offset0:0 offset1:72
    ds_read_b128 v[240:243], v8 offset:4096
    v_xad_u32 v238, v238, v3, v4
    v_smfmac_f32_16x16x64_bf16 v[172:175], a[12:15], v[196:203], v13 abid:1
    ds_read2st64_b32 v[246:247], v237 offset0:0 offset1:72
    v_xad_u32 v239, v239, v3, v4
    v_smfmac_f32_16x16x64_bf16 v[172:175], a[48:51], v[204:211], v17 abid:1
    ds_read2st64_b32 v[248:249], v238 offset0:0 offset1:72
    v_cndmask_b32_dpp v128, v124, v132, vcc row_ror:8 row_mask:0xf bank_mask:0xf
    v_smfmac_f32_16x16x64_bf16 v[172:175], a[84:87], v[212:219], v21 abid:1
    ds_read2st64_b32 v[250:251], v239 offset0:0 offset1:72
    ds_read_b128 v[196:199], v1 offset:23552
    v_cndmask_b32_dpp v129, v125, v133, vcc row_ror:8 row_mask:0xf bank_mask:0xf
    v_smfmac_f32_16x16x64_bf16 v[192:195], a[140:143], v[220:227], v49 abid:1
    ds_read_b128 v[200:203], v2 offset:23552
    v_cndmask_b32_dpp v130, v126, v134, vcc row_ror:8 row_mask:0xf bank_mask:0xf
    v_smfmac_f32_16x16x64_bf16 v[192:195], a[176:179], v[228:235], v50
    ds_read_b128 v[204:207], v1 offset:24576
    v_cndmask_b32_dpp v131, v127, v135, vcc row_ror:8 row_mask:0xf bank_mask:0xf
    v_smfmac_f32_16x16x64_bf16 v[160:163], a[108:111], v[220:227], v24
    ds_read_b128 v[208:211], v2 offset:24576
    buffer_store_dwordx4 v[128:131], v6, s[12:15], s59 offen offset:0 sc1
    v_mov_b32_dpp v124, v132 row_ror:8 row_mask:0xf bank_mask:0xc
    v_smfmac_f32_16x16x64_bf16 v[160:163], a[144:147], v[228:235], v28
    s_waitcnt lgkmcnt(9)
    s_barrier
    ds_read_b128 v[236:239], v8 offset:10816
    v_mov_b32_dpp v125, v133 row_ror:8 row_mask:0xf bank_mask:0xc
    v_smfmac_f32_16x16x64_bf16 v[164:167], a[112:115], v[220:227], v24 abid:1
    ds_read_b128 v[212:215], v1 offset:20480
    v_mov_b32_dpp v126, v134 row_ror:8 row_mask:0xf bank_mask:0xc
    v_smfmac_f32_16x16x64_bf16 v[164:167], a[148:151], v[228:235], v28 abid:1
    ds_read_b128 v[216:219], v2 offset:20480
    v_mov_b32_dpp v127, v135 row_ror:8 row_mask:0xf bank_mask:0xc
    v_smfmac_f32_16x16x64_bf16 v[168:171], a[116:119], v[220:227], v25
    buffer_store_dwordx4 v[124:127], v6, s[12:15], s24 offen offset:0 sc1
    v_smfmac_f32_16x16x64_bf16 v[168:171], a[152:155], v[228:235], v29
    s_waitcnt lgkmcnt(7)
    v_smfmac_f32_16x16x64_bf16 v[140:143], v[240:243], v[244:251], v10
    v_smfmac_f32_16x16x64_bf16 v[176:179], v[240:243], v[244:251], v10 abid:1
    s_waitcnt lgkmcnt(2)
    buffer_store_dwordx4 v[236:239], v7, s[12:15], s66 offen sc1
    v_smfmac_f32_16x16x64_bf16 v[172:175], a[120:123], v[220:227], v25 abid:1
    v_smfmac_f32_16x16x64_bf16 v[172:175], a[156:159], v[228:235], v29 abid:1
    ds_read_b128 v[220:223], v1 offset:25600
    v_smfmac_f32_16x16x64_bf16 v[192:195], a[212:215], v[196:203], v50 abid:1
    ds_read_b128 v[224:227], v2 offset:25600
    v_cvt_pk_bf16_f32 v140, v140, v141
    v_smfmac_f32_16x16x64_bf16 v[192:195], a[248:251], v[204:211], v51
    ds_read_b128 v[228:231], v1 offset:26624
    v_cvt_pk_bf16_f32 v141, v142, v143
    v_smfmac_f32_16x16x64_bf16 v[160:163], a[180:183], v[196:203], v32
    ds_read_b128 v[232:235], v2 offset:26624
    v_cvt_pk_bf16_f32 v142, v144, v145
    v_smfmac_f32_16x16x64_bf16 v[160:163], a[216:219], v[204:211], v36
    v_cvt_pk_bf16_f32 v143, v146, v147
    v_smfmac_f32_16x16x64_bf16 v[164:167], a[184:187], v[196:203], v32 abid:1
    v_cvt_pk_bf16_f32 v148, v148, v149
    v_smfmac_f32_16x16x64_bf16 v[164:167], a[220:223], v[204:211], v36 abid:1
    v_cvt_pk_bf16_f32 v149, v150, v151
    v_smfmac_f32_16x16x64_bf16 v[168:171], a[188:191], v[196:203], v33
    v_cvt_pk_bf16_f32 v150, v152, v153
    v_smfmac_f32_16x16x64_bf16 v[168:171], a[224:227], v[204:211], v37
    v_cvt_pk_bf16_f32 v151, v154, v155
    v_smfmac_f32_16x16x64_bf16 v[172:175], a[192:195], v[196:203], v33 abid:1
    v_cndmask_b32_dpp v144, v140, v148, vcc row_ror:8 row_mask:0xf bank_mask:0xf
    v_smfmac_f32_16x16x64_bf16 v[172:175], a[228:231], v[204:211], v37 abid:1
    ds_read_b128 v[196:199], v1 offset:18432
    s_waitcnt lgkmcnt(3)
    v_cndmask_b32_dpp v145, v141, v149, vcc row_ror:8 row_mask:0xf bank_mask:0xf
    v_smfmac_f32_16x16x64_bf16 v[192:195], v[84:87], v[220:227], v51 abid:1
    ds_read_b128 v[200:203], v2 offset:18432
    s_waitcnt lgkmcnt(2)
    v_cndmask_b32_dpp v146, v142, v150, vcc row_ror:8 row_mask:0xf bank_mask:0xf
    v_smfmac_f32_16x16x64_bf16 v[192:195], v[120:123], v[228:235], v52
    ds_read_b128 v[204:207], v1 offset:19456
    v_cndmask_b32_dpp v147, v143, v151, vcc row_ror:8 row_mask:0xf bank_mask:0xf
    v_smfmac_f32_16x16x64_bf16 v[160:163], a[252:255], v[220:227], v40
    ds_read_b128 v[208:211], v2 offset:19456
    buffer_store_dwordx4 v[144:147], v6, s[12:15], s59 offen offset:128 sc1
    v_mov_b32_dpp v140, v148 row_ror:8 row_mask:0xf bank_mask:0xc
    v_smfmac_f32_16x16x64_bf16 v[160:163], v[88:91], v[228:235], v44
    v_mov_b32_dpp v141, v149 row_ror:8 row_mask:0xf bank_mask:0xc
    v_smfmac_f32_16x16x64_bf16 v[164:167], v[56:59], v[220:227], v40 abid:1
    v_mov_b32_dpp v142, v150 row_ror:8 row_mask:0xf bank_mask:0xc
    v_smfmac_f32_16x16x64_bf16 v[164:167], v[92:95], v[228:235], v44 abid:1
    v_mov_b32_dpp v143, v151 row_ror:8 row_mask:0xf bank_mask:0xc
    v_smfmac_f32_16x16x64_bf16 v[168:171], v[60:63], v[220:227], v41
    buffer_store_dwordx4 v[140:143], v6, s[12:15], s24 offen offset:128 sc1
    v_cvt_pk_bf16_f32 v192, v192, v193
    v_smfmac_f32_16x16x64_bf16 v[168:171], v[96:99], v[228:235], v45
    v_cvt_pk_bf16_f32 v193, v194, v195
    v_smfmac_f32_16x16x64_bf16 v[172:175], v[64:67], v[220:227], v41 abid:1
    ds_write_b64 v53, v[192:193] offset:1024
    v_smfmac_f32_16x16x64_bf16 v[172:175], v[100:103], v[228:235], v45 abid:1
    ds_read_b128 v[220:223], v1 offset:21504
    s_waitcnt lgkmcnt(4)
    v_smfmac_f32_16x16x64_bf16 v[176:179], a[16:19], v[196:203], v14
    ds_read_b128 v[224:227], v2 offset:21504
    s_waitcnt lgkmcnt(3)
    v_smfmac_f32_16x16x64_bf16 v[176:179], a[52:55], v[204:211], v18
    ds_read_b128 v[228:231], v1 offset:22528
    v_smfmac_f32_16x16x64_bf16 v[176:179], a[88:91], v[212:219], v22
    ds_read_b128 v[232:235], v2 offset:22528
    s_waitcnt lgkmcnt(4)
    s_barrier
    ds_read_b128 v[236:239], v8 offset:11840
    v_smfmac_f32_16x16x64_bf16 v[180:183], a[20:23], v[196:203], v14 abid:1
    v_cvt_pk_bf16_f32 v160, v160, v161
    v_smfmac_f32_16x16x64_bf16 v[180:183], a[56:59], v[204:211], v18 abid:1
    v_cvt_pk_bf16_f32 v161, v162, v163
    v_smfmac_f32_16x16x64_bf16 v[180:183], a[92:95], v[212:219], v22 abid:1
    v_cvt_pk_bf16_f32 v162, v164, v165
    v_smfmac_f32_16x16x64_bf16 v[184:187], a[24:27], v[196:203], v15
    v_cvt_pk_bf16_f32 v163, v166, v167
    v_smfmac_f32_16x16x64_bf16 v[184:187], a[60:63], v[204:211], v19
    v_cvt_pk_bf16_f32 v168, v168, v169
    v_smfmac_f32_16x16x64_bf16 v[184:187], a[96:99], v[212:219], v23
    s_cmp_lt_u32 s20, 2
    s_waitcnt lgkmcnt(0)
    s_cbranch_scc0 M_fx
    buffer_store_dwordx4 v[236:239], v7, s[12:15], s67 offen sc1
M_fx:
    v_smfmac_f32_16x16x64_bf16 v[188:191], a[28:31], v[196:203], v15 abid:1
    v_cvt_pk_bf16_f32 v169, v170, v171
    v_smfmac_f32_16x16x64_bf16 v[188:191], a[64:67], v[204:211], v19 abid:1
    v_cvt_pk_bf16_f32 v170, v172, v173
    v_smfmac_f32_16x16x64_bf16 v[188:191], a[100:103], v[212:219], v23 abid:1
    ds_read_b128 v[196:199], v1 offset:23552
    v_cvt_pk_bf16_f32 v171, v174, v175
    v_smfmac_f32_16x16x64_bf16 v[176:179], a[124:127], v[220:227], v26
    ds_read_b128 v[200:203], v2 offset:23552
    v_cndmask_b32_dpp v164, v160, v168, vcc row_ror:8 row_mask:0xf bank_mask:0xf
    v_smfmac_f32_16x16x64_bf16 v[176:179], a[160:163], v[228:235], v30
    ds_read_b128 v[204:207], v1 offset:24576
    v_cndmask_b32_dpp v165, v161, v169, vcc row_ror:8 row_mask:0xf bank_mask:0xf
    v_smfmac_f32_16x16x64_bf16 v[180:183], a[128:131], v[220:227], v26 abid:1
    ds_read_b128 v[208:211], v2 offset:24576
    v_cndmask_b32_dpp v166, v162, v170, vcc row_ror:8 row_mask:0xf bank_mask:0xf
    v_smfmac_f32_16x16x64_bf16 v[180:183], a[164:167], v[228:235], v30 abid:1
    v_cndmask_b32_dpp v167, v163, v171, vcc row_ror:8 row_mask:0xf bank_mask:0xf
    v_smfmac_f32_16x16x64_bf16 v[184:187], a[132:135], v[220:227], v27
    buffer_store_dwordx4 v[164:167], v6, s[12:15], s58 offen offset:0 sc1
    v_mov_b32_dpp v160, v168 row_ror:8 row_mask:0xf bank_mask:0xc
    v_smfmac_f32_16x16x64_bf16 v[184:187], a[168:171], v[228:235], v31
    v_mov_b32_dpp v161, v169 row_ror:8 row_mask:0xf bank_mask:0xc
    v_smfmac_f32_16x16x64_bf16 v[188:191], a[136:139], v[220:227], v27 abid:1
    v_mov_b32_dpp v162, v170 row_ror:8 row_mask:0xf bank_mask:0xc
    v_smfmac_f32_16x16x64_bf16 v[188:191], a[172:175], v[228:235], v31 abid:1
    ds_read_b128 v[220:223], v1 offset:25600
    s_waitcnt lgkmcnt(3)
    v_mov_b32_dpp v163, v171 row_ror:8 row_mask:0xf bank_mask:0xc
    v_smfmac_f32_16x16x64_bf16 v[176:179], a[196:199], v[196:203], v34
    ds_read_b128 v[224:227], v2 offset:25600
    buffer_store_dwordx4 v[160:163], v6, s[12:15], s23 offen offset:0 sc1
    s_waitcnt lgkmcnt(2)
    v_smfmac_f32_16x16x64_bf16 v[176:179], a[232:235], v[204:211], v38
    ds_read_b128 v[228:231], v1 offset:26624
    v_smfmac_f32_16x16x64_bf16 v[180:183], a[200:203], v[196:203], v34 abid:1
    ds_read_b128 v[232:235], v2 offset:26624
    v_smfmac_f32_16x16x64_bf16 v[180:183], a[236:239], v[204:211], v38 abid:1
    v_smfmac_f32_16x16x64_bf16 v[184:187], a[204:207], v[196:203], v35
    v_smfmac_f32_16x16x64_bf16 v[184:187], a[240:243], v[204:211], v39
    v_smfmac_f32_16x16x64_bf16 v[188:191], a[208:211], v[196:203], v35 abid:1
    v_smfmac_f32_16x16x64_bf16 v[188:191], a[244:247], v[204:211], v39 abid:1
    s_waitcnt lgkmcnt(2)
    v_smfmac_f32_16x16x64_bf16 v[176:179], v[68:71], v[220:227], v42
    s_waitcnt lgkmcnt(0)
    v_smfmac_f32_16x16x64_bf16 v[176:179], v[104:107], v[228:235], v46
    v_smfmac_f32_16x16x64_bf16 v[180:183], v[72:75], v[220:227], v42 abid:1
    v_smfmac_f32_16x16x64_bf16 v[180:183], v[108:111], v[228:235], v46 abid:1
    v_smfmac_f32_16x16x64_bf16 v[184:187], v[76:79], v[220:227], v43
    v_smfmac_f32_16x16x64_bf16 v[184:187], v[112:115], v[228:235], v47
    v_smfmac_f32_16x16x64_bf16 v[188:191], v[80:83], v[220:227], v43 abid:1
    v_smfmac_f32_16x16x64_bf16 v[188:191], v[116:119], v[228:235], v47 abid:1
    s_nop 1
    v_cvt_pk_bf16_f32 v176, v176, v177
    v_cvt_pk_bf16_f32 v177, v178, v179
    v_cvt_pk_bf16_f32 v178, v180, v181
    v_cvt_pk_bf16_f32 v179, v182, v183
    v_cvt_pk_bf16_f32 v184, v184, v185
    v_cvt_pk_bf16_f32 v185, v186, v187
    v_cvt_pk_bf16_f32 v186, v188, v189
    v_cvt_pk_bf16_f32 v187, v190, v191
    v_cndmask_b32_dpp v180, v176, v184, vcc row_ror:8 row_mask:0xf bank_mask:0xf
    v_cndmask_b32_dpp v181, v177, v185, vcc row_ror:8 row_mask:0xf bank_mask:0xf
    v_cndmask_b32_dpp v182, v178, v186, vcc row_ror:8 row_mask:0xf bank_mask:0xf
    v_cndmask_b32_dpp v183, v179, v187, vcc row_ror:8 row_mask:0xf bank_mask:0xf
    buffer_store_dwordx4 v[180:183], v6, s[12:15], s58 offen offset:128 sc1
    v_mov_b32_dpp v176, v184 row_ror:8 row_mask:0xf bank_mask:0xc
    v_mov_b32_dpp v177, v185 row_ror:8 row_mask:0xf bank_mask:0xc
    v_mov_b32_dpp v178, v186 row_ror:8 row_mask:0xf bank_mask:0xc
    v_mov_b32_dpp v179, v187 row_ror:8 row_mask:0xf bank_mask:0xc
    buffer_store_dwordx4 v[176:179], v6, s[12:15], s23 offen offset:128 sc1
M_end:
    s_endpgm
M_pf_spin:
    s_sleep 4
    v_mov_b32 v0, 0
    s_mov_b64 exec, 1
    buffer_atomic_add v0, off, s[16:19], s96 sc0 sc1
    s_mov_b64 exec, -1
    s_add_u32 s31, s31, 1
    s_waitcnt vmcnt(0)
    v_readfirstlane_b32 s30, v0
    s_nop 0
    s_sub_u32 s30, s30, s100
    s_cmp_eq_u32 s30, 27
    s_cbranch_scc1 M_pf_ok
    s_cmp_lt_u32 s31, 24
    s_cbranch_scc1 M_pf_spin
    s_cmp_eq_u32 s98, 0
    s_cbranch_scc1 M_pf_spin2
    s_mov_b32 s98, 0
    v_mov_b32 v250, 1
    s_mov_b64 exec, 1
    buffer_atomic_add v250, off, s[68:71], 0 offset:0 sc1
    s_mov_b64 exec, -1
    s_nop 3
M_pf_spin2:
    s_sleep 16
    buffer_load_dword v0, off, s[68:71], 0 offset:0 sc1
    s_add_u32 s31, s31, 1
    s_cmp_ge_u32 s31, 131072
    s_cbranch_scc1 M_end
    s_waitcnt vmcnt(0)
    v_readfirstlane_b32 s30, v0
    s_nop 0
    s_cmp_eq_u32 s30, 81
    s_cbranch_scc0 M_pf_spin2
    s_branch M_pf_ok
M_r3:
    v_bfe_u32 v74, v60, 24, 4
    v_lshlrev_b32 v75, 1, v60
    v_lshl_add_u32 v74, v74, 2, s49
    v_and_b32 v75, 16, v75
    v_and_or_b32 v74, v60, 2.0, v74
    v_lshlrev_b32 v75, v75, 1
    ds_add_rtn_u32 v64, v74, v75
    v_and_b32 v74, 8, v60
    v_lshrrev_b32 v77, 14, v60
    v_cmp_ne_u32 s[44:45], 0, v74
    v_and_b32 v80, 0x3cf0, v77
    s_waitcnt lgkmcnt(0)
    v_lshrrev_b32 v75, 16, v64
    v_and_b32 v76, 0xffff, v64
    v_sub_u32 v74, 15, v75
    v_and_b32 v64, 2.0, v60
    v_add3_u32 v64, v76, v75, v64
    v_cndmask_b32 v74, v76, v74, s[44:45]
    v_cmp_gt_u32 s[44:45], 16, v64
    v_cmp_gt_u32 s[36:37], 2.0, v64
    v_lshlrev_b32 v74, 2, v74
    v_lshrrev_b64 v[76:77], v74, s[50:51]
    s_andn2_b64 s[36:37], s[36:37], s[44:45]
    v_lshrrev_b64 v[78:79], v74, s[52:53]
    v_bfe_u32 v74, v60, 24, 4
    v_mbcnt_lo_u32_b32 v75, s36, 0
    v_and_b32 v76, 15, v76
    v_mbcnt_hi_u32_b32 v75, s37, v75
    v_and_b32 v78, 15, v78
    v_lshl_add_u32 v75, v75, 3, s40
    v_lshl_add_u32 v76, v74, 4, v76
    v_min_u32 v75, s41, v75
    v_mul_u32_u24 v78, 68, v78
    v_cndmask_b32 v75, v82, v75, s[36:37]
    ds_write_b64 v75, v[60:61]
    s_bcnt1_i32_b64 s30, s[36:37]
    s_lshl3_add_u32 s40, s30, s40
    v_lshl_add_u32 v76, v76, 2, s47
    v_and_b32 v78, 0x30c, v78
    v_cndmask_b32 v76, v82, v76, s[44:45]
    v_add3_u32 v77, v80, v78, s29
    v_and_b32 v78, 0x3fff, v60
    v_cndmask_b32 v74, v82, v77, s[44:45]
    ds_write_b32 v76, v78
    ds_write_b32 v74, v61
    s_cmp_gt_u32 s38, s39
    s_cselect_b32 s32, 1, s32
    s_branch M_r3r
M_dn:
    s_mov_b32 s27, 0
    s_mov_b32 s46, 0x80000000
    v_mov_b32 v244, 0
    v_mov_b32 v245, 0
    v_mov_b32 v246, 0
    v_mov_b32 v247, 0
    ds_write_b128 v8, v[244:247] offset:0
    ds_write_b128 v8, v[244:247] offset:1024
    ds_write_b128 v8, v[244:247] offset:2048
    ds_write_b128 v8, v[244:247] offset:3072
    ds_write_b128 v8, v[244:247] offset:4096
    ds_write_b128 v8, v[244:247] offset:5120
    ds_write_b128 v8, v[244:247] offset:6144
    ds_write_b128 v8, v[244:247] offset:7168
    ds_write_b128 v8, v[244:247] offset:8192
    s_waitcnt lgkmcnt(0)
    s_branch M_dnr
M_ovc0:
    v_smfmac_f32_16x16x32_bf16 v[124:127], v[54:55], v[212:215], v10
    v_smfmac_f32_16x16x32_bf16 v[160:163], v[54:55], v[212:215], v10 abid:2
    s_setpc_b64 s[74:75]
    v_smfmac_f32_16x16x32_bf16 v[128:131], v[54:55], v[212:215], v10
    v_smfmac_f32_16x16x32_bf16 v[164:167], v[54:55], v[212:215], v10 abid:2
    s_setpc_b64 s[74:75]
    v_smfmac_f32_16x16x32_bf16 v[132:135], v[54:55], v[212:215], v10
    v_smfmac_f32_16x16x32_bf16 v[168:171], v[54:55], v[212:215], v10 abid:2
    s_setpc_b64 s[74:75]
    v_smfmac_f32_16x16x32_bf16 v[136:139], v[54:55], v[212:215], v10
    v_smfmac_f32_16x16x32_bf16 v[172:175], v[54:55], v[212:215], v10 abid:2
    s_setpc_b64 s[74:75]
    v_smfmac_f32_16x16x32_bf16 v[140:143], v[54:55], v[212:215], v10
    v_smfmac_f32_16x16x32_bf16 v[176:179], v[54:55], v[212:215], v10 abid:2
    s_setpc_b64 s[74:75]
    v_smfmac_f32_16x16x32_bf16 v[144:147], v[54:55], v[212:215], v10
    v_smfmac_f32_16x16x32_bf16 v[180:183], v[54:55], v[212:215], v10 abid:2
    s_setpc_b64 s[74:75]
    v_smfmac_f32_16x16x32_bf16 v[148:151], v[54:55], v[212:215], v10
    v_smfmac_f32_16x16x32_bf16 v[184:187], v[54:55], v[212:215], v10 abid:2
    s_setpc_b64 s[74:75]
    v_smfmac_f32_16x16x32_bf16 v[152:155], v[54:55], v[212:215], v10
    v_smfmac_f32_16x16x32_bf16 v[188:191], v[54:55], v[212:215], v10 abid:2
    s_setpc_b64 s[74:75]
    v_smfmac_f32_16x16x32_bf16 v[156:159], v[54:55], v[212:215], v10
    v_smfmac_f32_16x16x32_bf16 v[192:195], v[54:55], v[212:215], v10 abid:2
    s_setpc_b64 s[74:75]
M_ovl0:
    v_smfmac_f32_16x16x32_bf16 v[124:127], v[54:55], v[212:215], v10
    v_smfmac_f32_16x16x32_bf16 v[160:163], v[54:55], v[212:215], v10 abid:2
    s_setpc_b64 s[78:79]
    v_smfmac_f32_16x16x32_bf16 v[128:131], v[54:55], v[212:215], v10
    v_smfmac_f32_16x16x32_bf16 v[164:167], v[54:55], v[212:215], v10 abid:2
    s_setpc_b64 s[78:79]
    v_smfmac_f32_16x16x32_bf16 v[132:135], v[54:55], v[212:215], v10
    v_smfmac_f32_16x16x32_bf16 v[168:171], v[54:55], v[212:215], v10 abid:2
    s_setpc_b64 s[78:79]
    v_smfmac_f32_16x16x32_bf16 v[136:139], v[54:55], v[212:215], v10
    v_smfmac_f32_16x16x32_bf16 v[172:175], v[54:55], v[212:215], v10 abid:2
    s_setpc_b64 s[78:79]
    v_smfmac_f32_16x16x32_bf16 v[140:143], v[54:55], v[212:215], v10
    v_smfmac_f32_16x16x32_bf16 v[176:179], v[54:55], v[212:215], v10 abid:2
    s_setpc_b64 s[78:79]
    v_smfmac_f32_16x16x32_bf16 v[144:147], v[54:55], v[212:215], v10
    v_smfmac_f32_16x16x32_bf16 v[180:183], v[54:55], v[212:215], v10 abid:2
    s_setpc_b64 s[78:79]
    v_smfmac_f32_16x16x32_bf16 v[148:151], v[54:55], v[212:215], v10
    v_smfmac_f32_16x16x32_bf16 v[184:187], v[54:55], v[212:215], v10 abid:2
    s_setpc_b64 s[78:79]
    v_smfmac_f32_16x16x32_bf16 v[152:155], v[54:55], v[212:215], v10
    v_smfmac_f32_16x16x32_bf16 v[188:191], v[54:55], v[212:215], v10 abid:2
    s_setpc_b64 s[78:79]
    v_smfmac_f32_16x16x32_bf16 v[156:159], v[54:55], v[212:215], v10
    v_smfmac_f32_16x16x32_bf16 v[192:195], v[54:55], v[212:215], v10 abid:2
    s_setpc_b64 s[78:79]
M_ovc1:
    v_smfmac_f32_16x16x32_bf16 v[124:127], v[252:253], v[212:215], v10
    v_smfmac_f32_16x16x32_bf16 v[160:163], v[252:253], v[212:215], v10 abid:2
    s_setpc_b64 s[76:77]
    v_smfmac_f32_16x16x32_bf16 v[128:131], v[252:253], v[212:215], v10
    v_smfmac_f32_16x16x32_bf16 v[164:167], v[252:253], v[212:215], v10 abid:2
    s_setpc_b64 s[76:77]
    v_smfmac_f32_16x16x32_bf16 v[132:135], v[252:253], v[212:215], v10
    v_smfmac_f32_16x16x32_bf16 v[168:171], v[252:253], v[212:215], v10 abid:2
    s_setpc_b64 s[76:77]
    v_smfmac_f32_16x16x32_bf16 v[136:139], v[252:253], v[212:215], v10
    v_smfmac_f32_16x16x32_bf16 v[172:175], v[252:253], v[212:215], v10 abid:2
    s_setpc_b64 s[76:77]
    v_smfmac_f32_16x16x32_bf16 v[140:143], v[252:253], v[212:215], v10
    v_smfmac_f32_16x16x32_bf16 v[176:179], v[252:253], v[212:215], v10 abid:2
    s_setpc_b64 s[76:77]
    v_smfmac_f32_16x16x32_bf16 v[144:147], v[252:253], v[212:215], v10
    v_smfmac_f32_16x16x32_bf16 v[180:183], v[252:253], v[212:215], v10 abid:2
    s_setpc_b64 s[76:77]
    v_smfmac_f32_16x16x32_bf16 v[148:151], v[252:253], v[212:215], v10
    v_smfmac_f32_16x16x32_bf16 v[184:187], v[252:253], v[212:215], v10 abid:2
    s_setpc_b64 s[76:77]
    v_smfmac_f32_16x16x32_bf16 v[152:155], v[252:253], v[212:215], v10
    v_smfmac_f32_16x16x32_bf16 v[188:191], v[252:253], v[212:215], v10 abid:2
    s_setpc_b64 s[76:77]
    v_smfmac_f32_16x16x32_bf16 v[156:159], v[252:253], v[212:215], v10
    v_smfmac_f32_16x16x32_bf16 v[192:195], v[252:253], v[212:215], v10 abid:2
    s_setpc_b64 s[76:77]
M_ovl1:
    v_smfmac_f32_16x16x32_bf16 v[124:127], v[252:253], v[212:215], v10
    v_smfmac_f32_16x16x32_bf16 v[160:163], v[252:253], v[212:215], v10 abid:2
    s_setpc_b64 s[78:79]
    v_smfmac_f32_16x16x32_bf16 v[128:131], v[252:253], v[212:215], v10
    v_smfmac_f32_16x16x32_bf16 v[164:167], v[252:253], v[212:215], v10 abid:2
    s_setpc_b64 s[78:79]
    v_smfmac_f32_16x16x32_bf16 v[132:135], v[252:253], v[212:215], v10
    v_smfmac_f32_16x16x32_bf16 v[168:171], v[252:253], v[212:215], v10 abid:2
    s_setpc_b64 s[78:79]
    v_smfmac_f32_16x16x32_bf16 v[136:139], v[252:253], v[212:215], v10
    v_smfmac_f32_16x16x32_bf16 v[172:175], v[252:253], v[212:215], v10 abid:2
    s_setpc_b64 s[78:79]
    v_smfmac_f32_16x16x32_bf16 v[140:143], v[252:253], v[212:215], v10
    v_smfmac_f32_16x16x32_bf16 v[176:179], v[252:253], v[212:215], v10 abid:2
    s_setpc_b64 s[78:79]
    v_smfmac_f32_16x16x32_bf16 v[144:147], v[252:253], v[212:215], v10
    v_smfmac_f32_16x16x32_bf16 v[180:183], v[252:253], v[212:215], v10 abid:2
    s_setpc_b64 s[78:79]
    v_smfmac_f32_16x16x32_bf16 v[148:151], v[252:253], v[212:215], v10
    v_smfmac_f32_16x16x32_bf16 v[184:187], v[252:253], v[212:215], v10 abid:2
    s_setpc_b64 s[78:79]
    v_smfmac_f32_16x16x32_bf16 v[152:155], v[252:253], v[212:215], v10
    v_smfmac_f32_16x16x32_bf16 v[188:191], v[252:253], v[212:215], v10 abid:2
    s_setpc_b64 s[78:79]
    v_smfmac_f32_16x16x32_bf16 v[156:159], v[252:253], v[212:215], v10
    v_smfmac_f32_16x16x32_bf16 v[192:195], v[252:253], v[212:215], v10 abid:2
    s_setpc_b64 s[78:79]
M_ovl2:
    v_smfmac_f32_16x16x32_bf16 v[124:127], v[254:255], v[212:215], v10
    v_smfmac_f32_16x16x32_bf16 v[160:163], v[254:255], v[212:215], v10 abid:2
    s_setpc_b64 s[78:79]
    v_smfmac_f32_16x16x32_bf16 v[128:131], v[254:255], v[212:215], v10
    v_smfmac_f32_16x16x32_bf16 v[164:167], v[254:255], v[212:215], v10 abid:2
    s_setpc_b64 s[78:79]
    v_smfmac_f32_16x16x32_bf16 v[132:135], v[254:255], v[212:215], v10
    v_smfmac_f32_16x16x32_bf16 v[168:171], v[254:255], v[212:215], v10 abid:2
    s_setpc_b64 s[78:79]
    v_smfmac_f32_16x16x32_bf16 v[136:139], v[254:255], v[212:215], v10
    v_smfmac_f32_16x16x32_bf16 v[172:175], v[254:255], v[212:215], v10 abid:2
    s_setpc_b64 s[78:79]
    v_smfmac_f32_16x16x32_bf16 v[140:143], v[254:255], v[212:215], v10
    v_smfmac_f32_16x16x32_bf16 v[176:179], v[254:255], v[212:215], v10 abid:2
    s_setpc_b64 s[78:79]
    v_smfmac_f32_16x16x32_bf16 v[144:147], v[254:255], v[212:215], v10
    v_smfmac_f32_16x16x32_bf16 v[180:183], v[254:255], v[212:215], v10 abid:2
    s_setpc_b64 s[78:79]
    v_smfmac_f32_16x16x32_bf16 v[148:151], v[254:255], v[212:215], v10
    v_smfmac_f32_16x16x32_bf16 v[184:187], v[254:255], v[212:215], v10 abid:2
    s_setpc_b64 s[78:79]
    v_smfmac_f32_16x16x32_bf16 v[152:155], v[254:255], v[212:215], v10
    v_smfmac_f32_16x16x32_bf16 v[188:191], v[254:255], v[212:215], v10 abid:2
    s_setpc_b64 s[78:79]
    v_smfmac_f32_16x16x32_bf16 v[156:159], v[254:255], v[212:215], v10
    v_smfmac_f32_16x16x32_bf16 v[192:195], v[254:255], v[212:215], v10 abid:2
    s_setpc_b64 s[78:79]
M_ovn:
    s_setpc_b64 s[78:79]
M_slow:
    s_bitcmp1_b32 s46, 31
    s_cbranch_scc1 M_dense
    s_mov_b32 s56, s80
M_sl:
    s_lshl_b32 s57, s56, 6
    v_add_u32 v240, s57, v9
    ds_read_b128 v[248:251], v240 offset:9792
    s_waitcnt lgkmcnt(0)
    v_and_b32 v240, 0x3fff, v248
    v_and_b32 v241, 0x3fff, v250
    v_xad_u32 v240, v240, v3, v4
    v_xad_u32 v241, v241, v3, v4
    ds_read2st64_b32 v[244:245], v240 offset0:0 offset1:72
    ds_read2st64_b32 v[246:247], v241 offset0:0 offset1:72
    v_subrev_u32 v240, s29, v8
    v_bfe_u32 v240, v240, 4, 4
    s_waitcnt lgkmcnt(0)
    s_bitcmp1_b32 s27, 0
    s_cbranch_scc0 M_sle0
    v_lshrrev_b32 v242, 18, v248
    v_lshrrev_b32 v243, 18, v250
    v_or_b32 v241, 0, v240
    v_cmp_eq_u32 s[44:45], v242, v241
    v_cmp_eq_u32 s[54:55], v243, v241
    s_nop 0
    v_cndmask_b32 v242, 0, v249, s[44:45]
    v_cndmask_b32 v243, 0, v251, s[54:55]
    s_nop 1
    v_smfmac_f32_16x16x32_bf16 v[124:127], v[242:243], v[244:247], v10
    v_smfmac_f32_16x16x32_bf16 v[160:163], v[242:243], v[244:247], v10 abid:2
M_sle0:
    s_bitcmp1_b32 s27, 1
    s_cbranch_scc0 M_sle1
    v_lshrrev_b32 v242, 18, v248
    v_lshrrev_b32 v243, 18, v250
    v_or_b32 v241, 64, v240
    v_cmp_eq_u32 s[44:45], v242, v241
    v_cmp_eq_u32 s[54:55], v243, v241
    s_nop 0
    v_cndmask_b32 v242, 0, v249, s[44:45]
    v_cndmask_b32 v243, 0, v251, s[54:55]
    s_nop 1
    v_smfmac_f32_16x16x32_bf16 v[128:131], v[242:243], v[244:247], v10
    v_smfmac_f32_16x16x32_bf16 v[164:167], v[242:243], v[244:247], v10 abid:2
M_sle1:
    s_bitcmp1_b32 s27, 2
    s_cbranch_scc0 M_sle2
    v_lshrrev_b32 v242, 18, v248
    v_lshrrev_b32 v243, 18, v250
    v_or_b32 v241, 128, v240
    v_cmp_eq_u32 s[44:45], v242, v241
    v_cmp_eq_u32 s[54:55], v243, v241
    s_nop 0
    v_cndmask_b32 v242, 0, v249, s[44:45]
    v_cndmask_b32 v243, 0, v251, s[54:55]
    s_nop 1
    v_smfmac_f32_16x16x32_bf16 v[132:135], v[242:243], v[244:247], v10
    v_smfmac_f32_16x16x32_bf16 v[168:171], v[242:243], v[244:247], v10 abid:2
M_sle2:
    s_bitcmp1_b32 s27, 3
    s_cbranch_scc0 M_sle3
    v_lshrrev_b32 v242, 18, v248
    v_lshrrev_b32 v243, 18, v250
    v_or_b32 v241, 192, v240
    v_cmp_eq_u32 s[44:45], v242, v241
    v_cmp_eq_u32 s[54:55], v243, v241
    s_nop 0
    v_cndmask_b32 v242, 0, v249, s[44:45]
    v_cndmask_b32 v243, 0, v251, s[54:55]
    s_nop 1
    v_smfmac_f32_16x16x32_bf16 v[136:139], v[242:243], v[244:247], v10
    v_smfmac_f32_16x16x32_bf16 v[172:175], v[242:243], v[244:247], v10 abid:2
M_sle3:
    s_bitcmp1_b32 s27, 4
    s_cbranch_scc0 M_sle4
    v_lshrrev_b32 v242, 18, v248
    v_lshrrev_b32 v243, 18, v250
    v_or_b32 v241, 256, v240
    v_cmp_eq_u32 s[44:45], v242, v241
    v_cmp_eq_u32 s[54:55], v243, v241
    s_nop 0
    v_cndmask_b32 v242, 0, v249, s[44:45]
    v_cndmask_b32 v243, 0, v251, s[54:55]
    s_nop 1
    v_smfmac_f32_16x16x32_bf16 v[140:143], v[242:243], v[244:247], v10
    v_smfmac_f32_16x16x32_bf16 v[176:179], v[242:243], v[244:247], v10 abid:2
M_sle4:
    s_bitcmp1_b32 s27, 5
    s_cbranch_scc0 M_sle5
    v_lshrrev_b32 v242, 18, v248
    v_lshrrev_b32 v243, 18, v250
    v_or_b32 v241, 320, v240
    v_cmp_eq_u32 s[44:45], v242, v241
    v_cmp_eq_u32 s[54:55], v243, v241
    s_nop 0
    v_cndmask_b32 v242, 0, v249, s[44:45]
    v_cndmask_b32 v243, 0, v251, s[54:55]
    s_nop 1
    v_smfmac_f32_16x16x32_bf16 v[144:147], v[242:243], v[244:247], v10
    v_smfmac_f32_16x16x32_bf16 v[180:183], v[242:243], v[244:247], v10 abid:2
M_sle5:
    s_bitcmp1_b32 s27, 6
    s_cbranch_scc0 M_sle6
    v_lshrrev_b32 v242, 18, v248
    v_lshrrev_b32 v243, 18, v250
    v_or_b32 v241, 384, v240
    v_cmp_eq_u32 s[44:45], v242, v241
    v_cmp_eq_u32 s[54:55], v243, v241
    s_nop 0
    v_cndmask_b32 v242, 0, v249, s[44:45]
    v_cndmask_b32 v243, 0, v251, s[54:55]
    s_nop 1
    v_smfmac_f32_16x16x32_bf16 v[148:151], v[242:243], v[244:247], v10
    v_smfmac_f32_16x16x32_bf16 v[184:187], v[242:243], v[244:247], v10 abid:2
M_sle6:
    s_bitcmp1_b32 s27, 7
    s_cbranch_scc0 M_sle7
    v_lshrrev_b32 v242, 18, v248
    v_lshrrev_b32 v243, 18, v250
    v_or_b32 v241, 448, v240
    v_cmp_eq_u32 s[44:45], v242, v241
    v_cmp_eq_u32 s[54:55], v243, v241
    s_nop 0
    v_cndmask_b32 v242, 0, v249, s[44:45]
    v_cndmask_b32 v243, 0, v251, s[54:55]
    s_nop 1
    v_smfmac_f32_16x16x32_bf16 v[152:155], v[242:243], v[244:247], v10
    v_smfmac_f32_16x16x32_bf16 v[188:191], v[242:243], v[244:247], v10 abid:2
M_sle7:
    s_bitcmp1_b32 s27, 8
    s_cbranch_scc0 M_sle8
    v_lshrrev_b32 v242, 18, v248
    v_lshrrev_b32 v243, 18, v250
    v_or_b32 v241, 512, v240
    v_cmp_eq_u32 s[44:45], v242, v241
    v_cmp_eq_u32 s[54:55], v243, v241
    s_nop 0
    v_cndmask_b32 v242, 0, v249, s[44:45]
    v_cndmask_b32 v243, 0, v251, s[54:55]
    s_nop 1
    v_smfmac_f32_16x16x32_bf16 v[156:159], v[242:243], v[244:247], v10
    v_smfmac_f32_16x16x32_bf16 v[192:195], v[242:243], v[244:247], v10 abid:2
M_sle8:
    s_add_u32 s56, s56, 1
    s_cmp_lt_u32 s56, s46
    s_cbranch_scc1 M_sl
M_slx:
    s_nop 7
    s_cmp_eq_u32 s21, 1
    s_cbranch_scc1 M_slowrL
    s_cmp_eq_u32 s21, 2
    s_cbranch_scc1 M_slowrE0
    s_cmp_eq_u32 s21, 3
    s_cbranch_scc1 M_slowrF
    s_branch M_slowr0
M_dense:
    s_mul_i32 s57, s20, 82944
    s_add_u32 s57, s57, 393216
    s_mov_b32 s56, 0
    v_mov_b32 v54, v1
    v_mov_b32 v55, v2
    v_subrev_u32 v252, s29, v8
M_dn0:
    ds_read_b128 v[244:247], v54 offset:0
    ds_read_b128 v[248:251], v55 offset:0
    v_add_u32 v54, 1024, v54
    v_add_u32 v55, 1024, v55
    buffer_load_dwordx4 v[240:243], v252, s[16:19], s57 offen sc1
    s_add_u32 s57, s57, 1024
    s_waitcnt vmcnt(0) lgkmcnt(0)
    v_smfmac_f32_16x16x64_bf16 v[124:127], v[240:243], v[244:251], v10
    buffer_load_dwordx4 v[240:243], v252, s[16:19], s57 offen sc1
    s_add_u32 s57, s57, 1024
    s_waitcnt vmcnt(0) lgkmcnt(0)
    v_smfmac_f32_16x16x64_bf16 v[128:131], v[240:243], v[244:251], v10
    buffer_load_dwordx4 v[240:243], v252, s[16:19], s57 offen sc1
    s_add_u32 s57, s57, 1024
    s_waitcnt vmcnt(0) lgkmcnt(0)
    v_smfmac_f32_16x16x64_bf16 v[132:135], v[240:243], v[244:251], v10
    buffer_load_dwordx4 v[240:243], v252, s[16:19], s57 offen sc1
    s_add_u32 s57, s57, 1024
    s_waitcnt vmcnt(0) lgkmcnt(0)
    v_smfmac_f32_16x16x64_bf16 v[136:139], v[240:243], v[244:251], v10
    buffer_load_dwordx4 v[240:243], v252, s[16:19], s57 offen sc1
    s_add_u32 s57, s57, 1024
    s_waitcnt vmcnt(0) lgkmcnt(0)
    v_smfmac_f32_16x16x64_bf16 v[140:143], v[240:243], v[244:251], v10
    buffer_load_dwordx4 v[240:243], v252, s[16:19], s57 offen sc1
    s_add_u32 s57, s57, 1024
    s_waitcnt vmcnt(0) lgkmcnt(0)
    v_smfmac_f32_16x16x64_bf16 v[144:147], v[240:243], v[244:251], v10
    buffer_load_dwordx4 v[240:243], v252, s[16:19], s57 offen sc1
    s_add_u32 s57, s57, 1024
    s_waitcnt vmcnt(0) lgkmcnt(0)
    v_smfmac_f32_16x16x64_bf16 v[148:151], v[240:243], v[244:251], v10
    buffer_load_dwordx4 v[240:243], v252, s[16:19], s57 offen sc1
    s_add_u32 s57, s57, 1024
    s_waitcnt vmcnt(0) lgkmcnt(0)
    v_smfmac_f32_16x16x64_bf16 v[152:155], v[240:243], v[244:251], v10
    buffer_load_dwordx4 v[240:243], v252, s[16:19], s57 offen sc1
    s_add_u32 s57, s57, 1024
    s_waitcnt vmcnt(0) lgkmcnt(0)
    v_smfmac_f32_16x16x64_bf16 v[156:159], v[240:243], v[244:251], v10
    s_add_u32 s56, s56, 1
    s_cmp_lt_u32 s56, 9
    s_cbranch_scc1 M_dn0
    s_mul_i32 s57, s20, 82944
    s_add_u32 s57, s57, 393216
    s_mov_b32 s56, 0
    v_mov_b32 v54, v1
    v_mov_b32 v55, v2
    v_subrev_u32 v252, s29, v8
M_dn1:
    ds_read_b128 v[244:247], v54 offset:18432
    ds_read_b128 v[248:251], v55 offset:18432
    v_add_u32 v54, 1024, v54
    v_add_u32 v55, 1024, v55
    buffer_load_dwordx4 v[240:243], v252, s[16:19], s57 offen sc1
    s_add_u32 s57, s57, 1024
    s_waitcnt vmcnt(0) lgkmcnt(0)
    v_smfmac_f32_16x16x64_bf16 v[160:163], v[240:243], v[244:251], v10
    buffer_load_dwordx4 v[240:243], v252, s[16:19], s57 offen sc1
    s_add_u32 s57, s57, 1024
    s_waitcnt vmcnt(0) lgkmcnt(0)
    v_smfmac_f32_16x16x64_bf16 v[164:167], v[240:243], v[244:251], v10
    buffer_load_dwordx4 v[240:243], v252, s[16:19], s57 offen sc1
    s_add_u32 s57, s57, 1024
    s_waitcnt vmcnt(0) lgkmcnt(0)
    v_smfmac_f32_16x16x64_bf16 v[168:171], v[240:243], v[244:251], v10
    buffer_load_dwordx4 v[240:243], v252, s[16:19], s57 offen sc1
    s_add_u32 s57, s57, 1024
    s_waitcnt vmcnt(0) lgkmcnt(0)
    v_smfmac_f32_16x16x64_bf16 v[172:175], v[240:243], v[244:251], v10
    buffer_load_dwordx4 v[240:243], v252, s[16:19], s57 offen sc1
    s_add_u32 s57, s57, 1024
    s_waitcnt vmcnt(0) lgkmcnt(0)
    v_smfmac_f32_16x16x64_bf16 v[176:179], v[240:243], v[244:251], v10
    buffer_load_dwordx4 v[240:243], v252, s[16:19], s57 offen sc1
    s_add_u32 s57, s57, 1024
    s_waitcnt vmcnt(0) lgkmcnt(0)
    v_smfmac_f32_16x16x64_bf16 v[180:183], v[240:243], v[244:251], v10
    buffer_load_dwordx4 v[240:243], v252, s[16:19], s57 offen sc1
    s_add_u32 s57, s57, 1024
    s_waitcnt vmcnt(0) lgkmcnt(0)
    v_smfmac_f32_16x16x64_bf16 v[184:187], v[240:243], v[244:251], v10
    buffer_load_dwordx4 v[240:243], v252, s[16:19], s57 offen sc1
    s_add_u32 s57, s57, 1024
    s_waitcnt vmcnt(0) lgkmcnt(0)
    v_smfmac_f32_16x16x64_bf16 v[188:191], v[240:243], v[244:251], v10
    buffer_load_dwordx4 v[240:243], v252, s[16:19], s57 offen sc1
    s_add_u32 s57, s57, 1024
    s_waitcnt vmcnt(0) lgkmcnt(0)
    v_smfmac_f32_16x16x64_bf16 v[192:195], v[240:243], v[244:251], v10
    s_add_u32 s56, s56, 1
    s_cmp_lt_u32 s56, 9
    s_cbranch_scc1 M_dn1
    s_branch M_slx
M_codeend:
.section .rodata,"a"
.p2align 6
.amdhsa_kernel standalone__structured_sparse_n_m__ragged_kernel
  .amdhsa_next_free_vgpr 512
  .amdhsa_next_free_sgpr 102
  .amdhsa_accum_offset 256
  .amdhsa_group_segment_fixed_size 0
  .amdhsa_kernarg_size 48
  .amdhsa_user_sgpr_count 2
  .amdhsa_user_sgpr_kernarg_segment_ptr 1
  .amdhsa_system_sgpr_workgroup_id_x 1
  .amdhsa_float_denorm_mode_32 3
.end_amdhsa_kernel
```

```asm
; @launch grid=(256,1,1) block=(256,1,1) lds=162064
.amdgcn_target "amdgcn-amd-amdhsa--gfx950"
.text
.globl standalone__structured_sparse_n_m__ragged_kernel
.p2align 8
.type standalone__structured_sparse_n_m__ragged_kernel,@function
standalone__structured_sparse_n_m__ragged_kernel:
    s_cmp_ge_u32 s2, 256
    s_cbranch_scc1 M_end
    s_load_dwordx8 s[72:79], s[0:1], 0
    s_load_dwordx4 s[80:83], s[0:1], 32
    s_getpc_b64 s[84:85]
    s_lshr_b32 s30, s2, 3
    s_and_b32 s30, s30, 15
    s_lshl_b32 s30, s30, 11
    s_and_b32 s84, s84, 0xffffff00
    s_cmp_ge_u32 s2, 88
    s_cselect_b32 s86, M_codeend-standalone__structured_sparse_n_m__ragged_kernel, 0
    s_mov_b32 s87, 0x20000
    v_lshlrev_b32 v254, 3, v0
    s_mov_b32 exec_lo, 0x00010001
    s_mov_b32 exec_hi, 0x00010001
    buffer_load_dword v254, v254, s[84:87], s30 offen
    s_mov_b64 exec, -1
    v_lshrrev_b32 v20, 6, v0
    v_and_b32 v12, 63, v0
    v_readfirstlane_b32 s20, v20
    v_lshrrev_b32 v22, 3, v0
    v_mul_u32_u24 v22, 1152, v22
    v_lshrrev_b32 v23, 4, v0
    v_xor_b32 v23, v23, v0
    v_and_b32 v23, 7, v23
    v_lshl_add_u32 v5, v23, 4, v22
    v_lshrrev_b32 v13, 4, v12
    v_and_b32 v14, 15, v12
    v_lshlrev_b32 v11, 4, v12
    v_lshlrev_b32 v54, 3, v12
    v_lshlrev_b32 v25, 4, v13
    v_lshlrev_b32 v26, 3, v13
    s_mov_b32 s6, 663552
    s_mov_b32 s7, 0x20000
    s_mov_b32 s10, 75497472
    s_mov_b32 s11, s7
    s_mov_b32 s18, 742400
    s_mov_b32 s19, s7
    s_movk_i32 s70, 256
    s_mov_b32 s71, s7
    s_movk_i32 s86, 1152
    s_mov_b32 s87, s7
    s_mov_b32 s98, 0
    s_mul_i32 s96, s20, 16
    s_and_b32 s97, s2, 15
    s_add_u32 s96, s96, s97
    s_lshl_b32 s96, s96, 8
    s_add_u32 s96, s96, 726016
    s_mul_i32 s22, s2, 36864
    s_mul_i32 s26, s20, 9216
    s_mov_b32 s24, s22
    s_mov_b32 s42, s26
    s_lshl_b32 s28, s20, 8
    s_lshl_b32 s29, s20, 5
    s_cmp_lt_u32 s2, 81
    s_cbranch_scc0 M_x1
    s_mul_i32 s32, s2, 57
    s_lshr_b32 s32, s32, 9
    s_mul_i32 s33, s32, 9
    s_sub_u32 s33, s2, s33
    s_mul_i32 s54, s32, 73728
    s_lshl_b32 s35, s33, 7
    s_add_u32 s54, s54, s35
    s_add_u32 s55, s54, 36864
    s_lshl_b32 s36, s20, 10
    s_add_u32 m0, s36, 73728
    s_lshr_b32 s30, s33, 1
    s_and_b32 s31, s33, 1
    s_lshl1_add_u32 s37, s32, s31
    s_mul_i32 s37, s37, 176
    s_mul_i32 s38, s32, 96
    s_add_u32 s38, s38, 3168
    s_cmp_lt_u32 s33, 8
    s_cselect_b32 s30, s30, s20
    s_cselect_b32 s37, s37, s38
    s_cselect_b32 s44, 2047, 63
    s_cselect_b32 s45, s20, 3
    s_cmp_eq_u32 s45, 3
    s_cselect_b32 s99, 742400, 0
    s_mul_i32 s48, s30, 98304
    s_add_u32 s37, s37, s48
    v_mov_b32 v44, 2.0
    v_mov_b32 v45, 0
    v_mov_b32 v46, 2.0
    v_mov_b32 v47, 0
    s_waitcnt lgkmcnt(0)
    s_mov_b64 s[4:5], s[74:75]
    buffer_load_dwordx4 v5, s[4:7], s54 offen lds
    s_add_u32 m0, m0, 4096
    s_mov_b32 s45, 0
    buffer_load_dwordx4 v5, s[4:7], s55 offen lds
    s_mov_b64 s[16:17], s[82:83]
    s_mov_b64 s[8:9], s[72:73]
    s_mov_b64 s[84:85], s[76:77]
    s_mov_b64 s[68:69], s[80:81]
    v_mov_b32 v10, 0
    s_mov_b64 exec, 1
    buffer_atomic_add v10, off, s[16:19], s96 sc0 sc1
    s_mov_b64 exec, -1
    s_mov_b64 exec, s[44:45]
    s_mov_b32 s18, s99
    buffer_store_dwordx4 v[44:47], v11, s[16:19], s37 offen sc1
    s_mov_b32 s18, 742400
    s_mov_b64 exec, -1
    buffer_load_dwordx4 v[196:199], v25, s[84:87], s28 offen offset:0
    buffer_load_dwordx4 v[200:203], v25, s[84:87], s28 offen offset:64
    buffer_load_dwordx4 v[204:207], v25, s[84:87], s28 offen offset:128
    buffer_load_dwordx4 v[208:211], v25, s[84:87], s28 offen offset:192
    buffer_load_dwordx2 v[212:213], v26, s[84:87], s29 offen offset:1024
    s_mov_b32 m0, s42
    s_nop 0
    buffer_load_dwordx4 v5, s[8:11], s22 offen offset:0 nt lds
    s_add_u32 m0, m0, 896
    s_nop 0
    buffer_load_dwordx4 v5, s[8:11], s22 offen offset:128 nt lds
    s_add_u32 m0, m0, 896
    s_nop 0
    buffer_load_dwordx4 v5, s[8:11], s22 offen offset:256 nt lds
    s_add_u32 m0, m0, 896
    s_nop 0
    buffer_load_dwordx4 v5, s[8:11], s22 offen offset:384 nt lds
    s_lshl_b32 s34, s31, 2
    s_add_u32 s34, s34, s20
    s_lshr_b32 s35, s20, 1
    s_lshl_b32 s35, s35, 6
    s_and_b32 s36, s20, 1
    s_lshl_b32 s36, s36, 3
    s_add_u32 s35, s35, s36
    s_lshl_b32 s36, s20, 5
    s_mul_i32 s39, s32, 10240
    s_add_u32 s39, s39, 6144
    s_lshl_b32 s40, s34, 1
    s_add_u32 s40, s40, s39
    s_lshl_b32 s38, s32, 1
    s_cmp_eq_u32 s32, 8
    s_cselect_b32 s38, 1024, s38
    s_add_u32 s38, s38, 4096
    s_cmp_lt_u32 s33, 8
    s_cselect_b32 s34, s34, 8
    s_cselect_b32 s35, s35, s36
    s_cselect_b32 s36, 4, 3
    s_cselect_b32 s40, s40, s38
    s_cselect_b32 s46, 0, s20
    s_cselect_b32 s47, 22, 12
    s_add_u32 s40, s40, s48
    s_lshl_b32 s38, s34, 10
    s_add_u32 s39, s39, s38
    s_add_u32 s39, s39, s48
    s_add_u32 s39, s39, 1024
    v_and_b32 v15, 3, v14
    v_lshlrev_b32 v15, s36, v15
    v_add_u32 v15, s35, v15
    v_lshrrev_b32 v16, 3, v14
    v_lshlrev_b32 v16, 4, v16
    v_xor_b32 v15, v15, v16
    v_lshrrev_b32 v16, 2, v14
    v_lshl_add_u32 v16, v13, 4, v16
    v_lshl_add_u32 v15, v16, 7, v15
    v_add_u32 v24, 73728, v15
    v_xor_b32 v27, 32, v24
    v_xor_b32 v28, 64, v24
    v_xor_b32 v29, 0x60, v24
    s_lshl_b32 s31, s46, 2
    s_add_u32 s31, s31, 81920
    v_mov_b32 v60, s31
    v_mov_b32 v61, 1
    ds_write_b32 v60, v61
    s_mul_i32 s49, s30, 81
    s_mul_i32 s31, s32, 9
    s_add_u32 s49, s49, s31
    s_add_u32 s49, s49, s34
    s_lshl_b32 s49, s49, 10
    s_add_u32 s49, s49, 393216
    s_lshl_b32 s31, s34, 24
    s_lshl_b32 s38, s32, 10
    s_add_u32 s31, s31, s38
    v_lshlrev_b32 v31, 18, v14
    v_lshl_add_u32 v31, v13, 5, v31
    v_add_u32 v31, s31, v31
    s_mov_b32 s50, 3437096686
    s_mov_b32 s51, 1150609561
    s_mov_b32 s52, 0x00010001
    s_mov_b32 s53, 0x00200010
    s_mov_b32 s38, 0x0202
    s_mul_i32 s57, s30, 4096
    s_add_u32 s57, s57, 726016
    s_cmp_eq_u32 s33, 8
    s_cselect_b32 s56, 0, s20
    s_cmp_eq_u32 s20, 0
    s_cselect_b32 s98, 1, 0
    v_add_u32 v74, 81984, v54
    v_lshl_add_u32 v73, s20, 1, v74
    v_mov_b32 v41, 0x01000100
    v_mov_b32 v40, 0
    v_mov_b32 v63, -2.0
    s_waitcnt vmcnt(11) lgkmcnt(0)
    s_barrier
    ds_read_b64_tr_b16 v[16:17], v24
    ds_read_b64_tr_b16 v[18:19], v27 offset:512
    ds_read_b64_tr_b16 v[20:21], v28 offset:1024
    ds_read_b64_tr_b16 v[22:23], v29 offset:1536
    s_waitcnt lgkmcnt(3)
    v_and_b32 v44, 0x7fff7fff, v16
    v_and_b32 v45, 0x7fff7fff, v17
    v_pk_max_u16 v46, v44, v45
    v_pk_min_u16 v47, v44, v45
    v_pk_min_u16 v46, v46, v46 op_sel:[0,1] op_sel_hi:[1,0]
    v_pk_max_u16 v47, v47, v47 op_sel:[0,1] op_sel_hi:[1,0]
    v_pk_max_u16 v46, v46, s52
    v_pk_max_u16 v46, v46, v47
    v_pk_sub_i16 v44, v44, v46
    v_pk_sub_i16 v45, v45, v46
    v_pk_ashrrev_i16 v44, 15, v44 op_sel_hi:[0,1]
    v_pk_ashrrev_i16 v45, 15, v45 op_sel_hi:[0,1]
    v_alignbit_b32 v47, -1, v44, 16
    v_alignbit_b32 v46, v45, v45, 16
    v_and_b32 v48, 0x00080004, v44
    v_bitop3_b32 v46, v45, v46, v47 bitop3:0xe8
    v_and_or_b32 v64, v45, s53, v48
    v_bitop3_b32 v36, v16, v44, v46 bitop3:0x10
    v_min_u32 v68, 1, v36
    s_waitcnt lgkmcnt(2)
    v_and_b32 v44, 0x7fff7fff, v18
    v_and_b32 v45, 0x7fff7fff, v19
    v_pk_max_u16 v46, v44, v45
    v_pk_min_u16 v47, v44, v45
    v_pk_min_u16 v46, v46, v46 op_sel:[0,1] op_sel_hi:[1,0]
    v_pk_max_u16 v47, v47, v47 op_sel:[0,1] op_sel_hi:[1,0]
    v_pk_max_u16 v46, v46, s52
    v_pk_max_u16 v46, v46, v47
    v_pk_sub_i16 v44, v44, v46
    v_pk_sub_i16 v45, v45, v46
    v_pk_ashrrev_i16 v44, 15, v44 op_sel_hi:[0,1]
    v_pk_ashrrev_i16 v45, 15, v45 op_sel_hi:[0,1]
    v_alignbit_b32 v47, -1, v44, 16
    v_alignbit_b32 v46, v45, v45, 16
    v_and_b32 v48, 0x00080004, v44
    v_bitop3_b32 v46, v45, v46, v47 bitop3:0xe8
    v_and_or_b32 v65, v45, s53, v48
    v_bitop3_b32 v37, v18, v44, v46 bitop3:0x10
    v_min_u32 v69, 1, v37
    s_waitcnt lgkmcnt(1)
    v_and_b32 v44, 0x7fff7fff, v20
    v_and_b32 v45, 0x7fff7fff, v21
    v_pk_max_u16 v46, v44, v45
    v_pk_min_u16 v47, v44, v45
    v_pk_min_u16 v46, v46, v46 op_sel:[0,1] op_sel_hi:[1,0]
    v_pk_max_u16 v47, v47, v47 op_sel:[0,1] op_sel_hi:[1,0]
    v_pk_max_u16 v46, v46, s52
    v_pk_max_u16 v46, v46, v47
    v_pk_sub_i16 v44, v44, v46
    v_pk_sub_i16 v45, v45, v46
    v_pk_ashrrev_i16 v44, 15, v44 op_sel_hi:[0,1]
    v_pk_ashrrev_i16 v45, 15, v45 op_sel_hi:[0,1]
    v_alignbit_b32 v47, -1, v44, 16
    v_alignbit_b32 v46, v45, v45, 16
    v_and_b32 v48, 0x00080004, v44
    v_bitop3_b32 v46, v45, v46, v47 bitop3:0xe8
    v_and_or_b32 v66, v45, s53, v48
    v_bitop3_b32 v38, v20, v44, v46 bitop3:0x10
    v_min_u32 v70, 1, v38
    s_waitcnt lgkmcnt(0)
    v_and_b32 v44, 0x7fff7fff, v22
    v_and_b32 v45, 0x7fff7fff, v23
    v_pk_max_u16 v46, v44, v45
    v_pk_min_u16 v47, v44, v45
    v_pk_min_u16 v46, v46, v46 op_sel:[0,1] op_sel_hi:[1,0]
    v_pk_max_u16 v47, v47, v47 op_sel:[0,1] op_sel_hi:[1,0]
    v_pk_max_u16 v46, v46, s52
    v_pk_max_u16 v46, v46, v47
    v_pk_sub_i16 v44, v44, v46
    v_pk_sub_i16 v45, v45, v46
    v_pk_ashrrev_i16 v44, 15, v44 op_sel_hi:[0,1]
    v_pk_ashrrev_i16 v45, 15, v45 op_sel_hi:[0,1]
    v_alignbit_b32 v47, -1, v44, 16
    v_alignbit_b32 v46, v45, v45, 16
    v_and_b32 v48, 0x00080004, v44
    v_bitop3_b32 v46, v45, v46, v47 bitop3:0xe8
    v_and_or_b32 v67, v45, s53, v48
    v_bitop3_b32 v39, v22, v44, v46 bitop3:0x10
    v_min_u32 v71, 1, v39
    v_add_u32 v72, v68, v69
    v_add3_u32 v72, v72, v70, v71
    buffer_store_dwordx4 v[36:39], v11, s[16:19], s49 offen sc1
    v_cmp_ne_u32 vcc, 0, v72
    s_and_saveexec_b64 s[44:45], vcc
    ds_add_rtn_u32 v62, v60, v72
    s_mov_b64 exec, -1
    v_lshrrev_b32 v48, 16, v64
    v_or_b32 v48, v48, v64
    v_lshrrev_b64 v[52:53], v48, s[50:51]
    v_and_b32 v64, 15, v52
    v_lshl_or_b32 v40, v64, 0, v40
    v_lshrrev_b32 v48, 16, v65
    v_or_b32 v48, v48, v65
    v_lshrrev_b64 v[52:53], v48, s[50:51]
    v_and_b32 v65, 15, v52
    v_lshl_or_b32 v40, v65, 4, v40
    v_lshrrev_b32 v48, 16, v66
    v_or_b32 v48, v48, v66
    v_lshrrev_b64 v[52:53], v48, s[50:51]
    v_and_b32 v66, 15, v52
    v_lshl_or_b32 v40, v66, 8, v40
    v_lshrrev_b32 v48, 16, v67
    v_or_b32 v48, v48, v67
    v_lshrrev_b64 v[52:53], v48, s[50:51]
    v_and_b32 v67, 15, v52
    v_lshl_or_b32 v40, v67, 12, v40
    v_lshrrev_b32 v44, 2, v40
    v_lshlrev_b32 v45, 2, v40
    s_movk_i32 s31, 0x3333
    v_not_b32 v47, v40
    v_bfi_b32 v44, s31, v44, v45
    s_movk_i32 s31, 0x1111
    s_nop 0
    v_mov_b32_dpp v47, v44 row_shr:4 row_mask:0xf bank_mask:0xf
    v_xor_b32 v47, v47, v40
    v_lshrrev_b32 v45, 1, v47
    v_or_b32 v47, v47, v45
    v_lshrrev_b32 v45, 2, v47
    v_bitop3_b32 v47, v47, v45, s31 bitop3:0x2a
    s_nop 1
    v_xor_b32_dpp v47, v47, v47 row_shr:4 row_mask:0xf bank_mask:0xe
    s_nop 1
    v_xor_b32_dpp v47, v47, v47 row_shr:8 row_mask:0xf bank_mask:0xc
    v_mul_u32_u24 v47, 15, v47
    v_bfi_b32 v40, v47, v44, v40
    ds_write_b16 v73, v40
    v_bfe_u32 v64, v40, 0, 4
    v_mul_u32_u24 v46, 0x4001, v64
    v_and_b32 v46, 0x30003, v46
    v_mad_u32_u24 v46, v46, s38, v41
    v_perm_b32 v32, v17, v16, v46
    v_bfe_u32 v65, v40, 4, 4
    v_mul_u32_u24 v46, 0x4001, v65
    v_and_b32 v46, 0x30003, v46
    v_mad_u32_u24 v46, v46, s38, v41
    v_perm_b32 v33, v19, v18, v46
    s_waitcnt vmcnt(10) lgkmcnt(0)
    s_barrier
    ds_read_b64 v[50:51], v74
    v_bfe_u32 v66, v40, 8, 4
    v_mul_u32_u24 v46, 0x4001, v66
    v_and_b32 v46, 0x30003, v46
    v_mad_u32_u24 v46, v46, s38, v41
    v_perm_b32 v34, v21, v20, v46
    v_bfe_u32 v67, v40, 12, 4
    v_mul_u32_u24 v46, 0x4001, v67
    v_and_b32 v46, 0x30003, v46
    v_mad_u32_u24 v46, v46, s38, v41
    v_perm_b32 v35, v23, v22, v46
    buffer_store_dwordx4 v[32:35], v11, s[16:19], s39 offen sc1
    s_cmp_eq_u32 s33, 8
    s_cbranch_scc0 F_i1
    buffer_store_short v40, v11, s[16:19], s40 offen sc1
    s_branch F_i2
F_i1:
    s_cmp_eq_u32 s20, 0
    s_cbranch_scc0 F_i2
    s_waitcnt lgkmcnt(0)
    buffer_store_dwordx2 v[50:51], v11, s[16:19], s40 offen sc1
F_i2:
    s_cbranch_vccz F_z
    v_cmp_ne_u32 vcc, 0, v36
    s_and_saveexec_b64 s[44:45], vcc
    s_cbranch_execz F_e0
    v_cmp_gt_u32 vcc, s47, v62
    v_add_u32 v42, 0, v31
    v_lshlrev_b32 v44, 3, v62
    v_add_u32 v62, 1, v62
    v_cndmask_b32 v42, v63, v42, vcc
    v_cndmask_b32 v43, 0, v36, vcc
    v_cndmask_b32 v44, 0, v44, vcc
    buffer_store_dwordx2 v[42:43], v44, s[16:19], s37 offen sc1
F_e0:
    s_mov_b64 exec, -1
    v_cmp_ne_u32 vcc, 0, v37
    s_and_saveexec_b64 s[44:45], vcc
    s_cbranch_execz F_e1
    v_cmp_gt_u32 vcc, s47, v62
    v_add_u32 v42, 8, v31
    v_lshlrev_b32 v44, 3, v62
    v_add_u32 v62, 1, v62
    v_cndmask_b32 v42, v63, v42, vcc
    v_cndmask_b32 v43, 0, v37, vcc
    v_cndmask_b32 v44, 0, v44, vcc
    buffer_store_dwordx2 v[42:43], v44, s[16:19], s37 offen sc1
F_e1:
    s_mov_b64 exec, -1
    v_cmp_ne_u32 vcc, 0, v38
    s_and_saveexec_b64 s[44:45], vcc
    s_cbranch_execz F_e2
    v_cmp_gt_u32 vcc, s47, v62
    v_add_u32 v42, 16, v31
    v_lshlrev_b32 v44, 3, v62
    v_add_u32 v62, 1, v62
    v_cndmask_b32 v42, v63, v42, vcc
    v_cndmask_b32 v43, 0, v38, vcc
    v_cndmask_b32 v44, 0, v44, vcc
    buffer_store_dwordx2 v[42:43], v44, s[16:19], s37 offen sc1
F_e2:
    s_mov_b64 exec, -1
    v_cmp_ne_u32 vcc, 0, v39
    s_and_saveexec_b64 s[44:45], vcc
    s_cbranch_execz F_e3
    v_cmp_gt_u32 vcc, s47, v62
    v_add_u32 v42, 24, v31
    v_lshlrev_b32 v44, 3, v62
    v_add_u32 v62, 1, v62
    v_cndmask_b32 v42, v63, v42, vcc
    v_cndmask_b32 v43, 0, v39, vcc
    v_cndmask_b32 v44, 0, v44, vcc
    buffer_store_dwordx2 v[42:43], v44, s[16:19], s37 offen sc1
F_e3:
    s_mov_b64 exec, -1
F_z:
    s_cmp_lg_u32 s2, 0
    s_cbranch_scc1 M_set
    v_mov_b32 v64, 0
    v_mov_b32 v65, 0
    v_mov_b32 v66, 0
    v_mov_b32 v67, 0
    s_mov_b32 s40, 724992
    buffer_store_dwordx4 v[64:67], v11, s[16:19], s40 offen sc1
    s_branch M_set
F_sig:
    v_lshlrev_b32 v30, 8, v12
    s_waitcnt vmcnt(0)
    s_barrier
    s_cmp_lg_u32 s56, 0
    s_cbranch_scc1 F_end
    s_mov_b64 exec, 65535
    buffer_atomic_add v61, v30, s[16:19], s57 offen sc1
    s_mov_b64 exec, -1
F_end:
    s_add_u32 m0, m0, 896
    s_nop 0
    buffer_load_dwordx4 v5, s[8:11], s22 offen offset:512 nt lds
    s_add_u32 m0, m0, 896
    s_nop 0
    buffer_load_dwordx4 v5, s[8:11], s22 offen offset:640 nt lds
    s_add_u32 m0, m0, 896
    s_nop 0
    buffer_load_dwordx4 v5, s[8:11], s22 offen offset:768 nt lds
    s_branch M_x2
M_x1:
    s_waitcnt lgkmcnt(0)
    s_mov_b64 s[4:5], s[74:75]
    s_mov_b64 s[16:17], s[82:83]
    s_mov_b64 s[8:9], s[72:73]
    s_mov_b64 s[84:85], s[76:77]
    s_mov_b64 s[68:69], s[80:81]
    v_mov_b32 v10, 0
    s_mov_b64 exec, 1
    buffer_atomic_add v10, off, s[16:19], s96 sc0 sc1
    s_mov_b64 exec, -1
    buffer_load_dwordx4 v[196:199], v25, s[84:87], s28 offen offset:0
    buffer_load_dwordx4 v[200:203], v25, s[84:87], s28 offen offset:64
    buffer_load_dwordx4 v[204:207], v25, s[84:87], s28 offen offset:128
    buffer_load_dwordx4 v[208:211], v25, s[84:87], s28 offen offset:192
    buffer_load_dwordx2 v[212:213], v26, s[84:87], s29 offen offset:1024
    s_mov_b32 m0, s42
    s_nop 0
    buffer_load_dwordx4 v5, s[8:11], s22 offen offset:0 nt lds
    s_add_u32 m0, m0, 896
    s_nop 0
    buffer_load_dwordx4 v5, s[8:11], s22 offen offset:128 nt lds
    s_add_u32 m0, m0, 896
    s_nop 0
    buffer_load_dwordx4 v5, s[8:11], s22 offen offset:256 nt lds
    s_add_u32 m0, m0, 896
    s_nop 0
    buffer_load_dwordx4 v5, s[8:11], s22 offen offset:384 nt lds
    s_add_u32 m0, m0, 896
    s_nop 0
    buffer_load_dwordx4 v5, s[8:11], s22 offen offset:512 nt lds
    s_add_u32 m0, m0, 896
    s_nop 0
    buffer_load_dwordx4 v5, s[8:11], s22 offen offset:640 nt lds
    s_add_u32 m0, m0, 896
    s_nop 0
    buffer_load_dwordx4 v5, s[8:11], s22 offen offset:768 nt lds
M_set:
    s_mov_b32 s12, s78
    s_mov_b32 s13, s79
    s_mov_b32 s14, 75497472
    s_mov_b32 s15, 0x20000
    s_mul_i32 s29, s20, 12864
    s_add_u32 s29, s29, 110592
    v_lshrrev_b32 v24, 1, v14
    v_and_b32 v27, 7, v14
    v_lshlrev_b32 v22, 7, v27
    v_lshl_or_b32 v3, v24, 4, v22
    v_lshrrev_b32 v23, 3, v14
    v_mul_u32_u24 v4, 9216, v23
    v_xad_u32 v1, v25, v3, v4
    v_xor_b32 v2, 64, v1
    v_add_u32 v9, s29, v25
    v_add_u32 v8, s29, v11
    v_mul_u32_u24 v24, 1152, v27
    v_lshl_add_u32 v24, v23, 6, v24
    v_add3_u32 v6, v24, v25, s28
    v_lshrrev_b32 v24, 3, v12
    v_xor_b32 v28, v24, v12
    v_and_b32 v28, 7, v28
    v_mul_u32_u24 v24, 1152, v24
    v_lshl_add_u32 v24, v28, 4, v24
    v_add_u32 v7, 1024, v24
    s_lshl_b32 s30, s20, 1
    v_lshrrev_b32 v24, 1, v13
    v_add_u32 v24, s30, v24
    v_xor_b32 v24, v24, v27
    v_lshl_add_u32 v24, v24, 4, v22
    v_and_b32 v28, 8, v26
    v_mul_u32_u24 v29, 12864, v23
    v_add3_u32 v24, v24, v28, v29
    v_add_u32 v53, 121408, v24
    s_lshr_b32 s30, s2, 3
    s_and_b32 s30, s30, 3
    s_mul_i32 s92, s30, 256
    s_add_u32 s92, s92, 562944
    s_add_u32 s30, s30, 768
    s_mul_i32 s93, s30, 36864
    s_mov_b32 s94, 147456
    s_and_b32 s95, s20, 1
    s_mul_i32 s95, s95, 9216
    s_add_u32 s59, s24, 9216
    s_mul_i32 s43, s20, 98304
    s_add_u32 s47, s29, 9216
    s_add_u32 s48, s29, 9792
    s_add_u32 s49, s29, 10112
    s_add_u32 s54, s29, 1073751872
    s_add_u32 s38, s26, 73728
    s_add_u32 s35, s38, 1024
    s_add_u32 s39, s38, 1536
    s_mov_b32 s40, s48
    s_add_u32 s41, s48, 256
    s_mov_b32 s50, 3130536464
    s_mov_b32 s51, 1164430831
    s_mov_b32 s52, 3696531472
    s_mov_b32 s53, 598435823
    v_mov_b32 v16, 0
    v_mov_b32 v17, 0
    v_mov_b32 v18, 0
    v_mov_b32 v19, 0
    v_cmp_gt_u32 s[44:45], 36, v12
    v_mov_b32 v20, 2.0
    s_nop 0
    v_cndmask_b32 v20, 0, v20, s[44:45]
    v_mov_b32 v21, v20
    v_mov_b32 v22, v20
    v_mov_b32 v23, v20
    v_mov_b32 v68, 1073741824
    v_mov_b32 v69, 0
    v_mov_b32 v70, 1073741824
    v_mov_b32 v71, 0
    v_lshl_add_u32 v84, v12, 2, s49
    v_add_u32 v55, s38, v54
    v_add_u32 v24, s38, v11
    ds_write_b128 v8, v[16:19] offset:0
    ds_write_b128 v8, v[16:19] offset:1024
    ds_write_b128 v8, v[16:19] offset:2048
    ds_write_b128 v8, v[16:19] offset:3072
    ds_write_b128 v8, v[16:19] offset:4096
    ds_write_b128 v8, v[16:19] offset:5120
    ds_write_b128 v8, v[16:19] offset:6144
    ds_write_b128 v8, v[16:19] offset:7168
    ds_write_b128 v8, v[16:19] offset:8192
    ds_write_b128 v24, v[68:71]
    ds_write_b128 v24, v[68:71] offset:1024
    ds_write_b128 v8, v[20:23] offset:9216
    s_cmp_lt_u32 s2, 81
    s_cbranch_scc1 F_sig
M_x2:
    s_add_u32 m0, m0, 896
    s_nop 0
    buffer_load_dwordx4 v5, s[8:11], s22 offen offset:896 nt lds
    s_add_u32 m0, m0, 896
    s_nop 0
    buffer_load_dwordx4 v5, s[8:11], s22 offen offset:1024 nt lds
    s_add_u32 s22, s22, 9437184
    s_add_u32 s42, s42, 36864
    s_mov_b32 m0, s42
    s_nop 0
    buffer_load_dwordx4 v5, s[8:11], s22 offen offset:0 nt lds
    s_add_u32 m0, m0, 896
    s_nop 0
    buffer_load_dwordx4 v5, s[8:11], s22 offen offset:128 nt lds
    s_add_u32 m0, m0, 896
    s_nop 0
    buffer_load_dwordx4 v5, s[8:11], s22 offen offset:256 nt lds
    s_add_u32 m0, m0, 896
    s_nop 0
    buffer_load_dwordx4 v5, s[8:11], s22 offen offset:384 nt lds
    s_add_u32 m0, m0, 896
    s_nop 0
    buffer_load_dwordx4 v5, s[8:11], s22 offen offset:512 nt lds
    s_add_u32 m0, m0, 896
    s_nop 0
    buffer_load_dwordx4 v5, s[8:11], s22 offen offset:640 nt lds
    s_add_u32 m0, m0, 896
    s_nop 0
    buffer_load_dwordx4 v5, s[8:11], s22 offen offset:768 nt lds
    s_add_u32 m0, m0, 896
    s_nop 0
    buffer_load_dwordx4 v5, s[8:11], s22 offen offset:896 nt lds
    s_add_u32 m0, m0, 896
    s_nop 0
    buffer_load_dwordx4 v5, s[8:11], s22 offen offset:1024 nt lds
    s_add_u32 s22, s22, 9437184
    s_add_u32 s42, s42, 36864
    s_waitcnt vmcnt(3)
    v_mov_b32 v0, 0
    s_mov_b64 exec, 1
    buffer_atomic_add v0, off, s[16:19], s96 sc0 sc1
    s_mov_b64 exec, -1
    v_readlane_b32 s100, v10, 0
    v_mov_b32 v10, 0xeeee4444
    v_lshlrev_b32 v124, 16, v196
    v_and_b32 v125, 0xffff0000, v196
    v_lshlrev_b32 v126, 16, v197
    v_and_b32 v127, 0xffff0000, v197
    v_lshlrev_b32 v128, 16, v198
    v_and_b32 v129, 0xffff0000, v198
    v_lshlrev_b32 v130, 16, v199
    v_and_b32 v131, 0xffff0000, v199
    v_lshlrev_b32 v132, 16, v200
    v_and_b32 v133, 0xffff0000, v200
    v_lshlrev_b32 v134, 16, v201
    v_and_b32 v135, 0xffff0000, v201
    v_lshlrev_b32 v136, 16, v202
    v_and_b32 v137, 0xffff0000, v202
    v_lshlrev_b32 v138, 16, v203
    v_and_b32 v139, 0xffff0000, v203
    v_lshlrev_b32 v140, 16, v204
    v_and_b32 v141, 0xffff0000, v204
    v_lshlrev_b32 v142, 16, v205
    v_and_b32 v143, 0xffff0000, v205
    v_lshlrev_b32 v144, 16, v206
    v_and_b32 v145, 0xffff0000, v206
    v_lshlrev_b32 v146, 16, v207
    v_and_b32 v147, 0xffff0000, v207
    v_lshlrev_b32 v148, 16, v208
    v_and_b32 v149, 0xffff0000, v208
    v_lshlrev_b32 v150, 16, v209
    v_and_b32 v151, 0xffff0000, v209
    v_lshlrev_b32 v152, 16, v210
    v_and_b32 v153, 0xffff0000, v210
    v_lshlrev_b32 v154, 16, v211
    v_and_b32 v155, 0xffff0000, v211
    v_lshlrev_b32 v156, 16, v212
    v_and_b32 v157, 0xffff0000, v212
    v_lshlrev_b32 v158, 16, v213
    v_and_b32 v159, 0xffff0000, v213
    s_mov_b32 exec_lo, 0x00010001
    s_mov_b32 exec_hi, 0x00010001
    ds_write_b128 v9, v[124:127] offset:10240
    ds_write_b128 v9, v[128:131] offset:10304
    ds_write_b128 v9, v[132:135] offset:10368
    ds_write_b128 v9, v[136:139] offset:10432
    ds_write_b128 v9, v[140:143] offset:10496
    ds_write_b128 v9, v[144:147] offset:10560
    ds_write_b128 v9, v[148:151] offset:10624
    ds_write_b128 v9, v[152:155] offset:10688
    ds_write_b128 v9, v[156:159] offset:10752
    s_mov_b64 exec, -1
    s_mul_i32 s30, s20, 256
    s_add_u32 s30, s30, s2
    s_sub_u32 s30, s30, 0
    s_cmp_lt_u32 s2, 0
    s_cselect_b32 s30, 1023, s30
    s_lshl_b32 s30, s30, 1
    v_lshrrev_b32 v244, 5, v12
    v_add_u32 v248, s30, v244
    v_mov_b32 v244, -1
    v_mov_b32 v245, 0
    v_subrev_u32 v246, 704, v248
    v_cmp_gt_u32 vcc, 16, v246
    v_mov_b32 v247, 0
    s_nop 0
    v_cndmask_b32 v244, v244, v246, vcc
    v_cndmask_b32 v245, v245, v247, vcc
    v_subrev_u32 v246, 672, v248
    v_cmp_gt_u32 vcc, 32, v246
    v_mov_b32 v247, 1
    s_nop 0
    v_cndmask_b32 v244, v244, v246, vcc
    v_cndmask_b32 v245, v245, v247, vcc
    v_subrev_u32 v246, 624, v248
    v_cmp_gt_u32 vcc, 48, v246
    v_mov_b32 v247, 2
    s_nop 0
    v_cndmask_b32 v244, v244, v246, vcc
    v_cndmask_b32 v245, v245, v247, vcc
    v_subrev_u32 v246, 560, v248
    v_cmp_gt_u32 vcc, 64, v246
    v_mov_b32 v247, 3
    s_nop 0
    v_cndmask_b32 v244, v244, v246, vcc
    v_cndmask_b32 v245, v245, v247, vcc
    v_subrev_u32 v246, 480, v248
    v_cmp_gt_u32 vcc, 80, v246
    v_mov_b32 v247, 4
    s_nop 0
    v_cndmask_b32 v244, v244, v246, vcc
    v_cndmask_b32 v245, v245, v247, vcc
    v_subrev_u32 v246, 384, v248
    v_cmp_gt_u32 vcc, 96, v246
    v_mov_b32 v247, 5
    s_nop 0
    v_cndmask_b32 v244, v244, v246, vcc
    v_cndmask_b32 v245, v245, v247, vcc
    v_subrev_u32 v246, 272, v248
    v_cmp_gt_u32 vcc, 112, v246
    v_mov_b32 v247, 6
    s_nop 0
    v_cndmask_b32 v244, v244, v246, vcc
    v_cndmask_b32 v245, v245, v247, vcc
    v_subrev_u32 v246, 144, v248
    v_cmp_gt_u32 vcc, 128, v246
    v_mov_b32 v247, 7
    s_nop 0
    v_cndmask_b32 v244, v244, v246, vcc
    v_cndmask_b32 v245, v245, v247, vcc
    v_subrev_u32 v246, 0, v248
    v_cmp_gt_u32 vcc, 144, v246
    v_mov_b32 v247, 8
    s_nop 0
    v_cndmask_b32 v244, v244, v246, vcc
    v_cndmask_b32 v245, v245, v247, vcc
    v_sub_u32 v244, 2047, v244
    v_mul_u32_u24 v244, 36864, v244
    v_lshl_add_u32 v244, v245, 7, v244
    v_and_b32 v245, 31, v12
    v_mul_u32_u24 v245, 1152, v245
    v_add_u32 v249, v244, v245
    s_mov_b32 vcc_lo, 0xff00ff00
    s_mov_b32 vcc_hi, 0xff00ff00
    s_waitcnt vmcnt(0)
    v_readfirstlane_b32 s30, v0
    s_mov_b32 s31, 0
    s_sub_u32 s30, s30, s100
    s_cmp_eq_u32 s30, 27
    s_cbranch_scc0 M_pf_spin
M_pf_ok:
    v_mov_b32 v0, v249
    buffer_load_dwordx4 v[56:59], v11, s[16:19], s43 offen offset:0 sc1
    buffer_load_dwordx4 v[60:63], v11, s[16:19], s43 offen offset:1024 sc1
    buffer_load_dwordx4 v[64:67], v11, s[16:19], s43 offen offset:2048 sc1
    s_mov_b32 exec_hi, 268435455
    buffer_load_dwordx4 v[68:71], v11, s[16:19], s43 offen offset:3072 sc1
    s_mov_b32 exec_hi, -1
    s_add_u32 s43, s43, 4096
    buffer_load_dwordx4 v[48:51], v11, s[16:19], s43 offen offset:0 sc1
    buffer_load_dword v52, v11, s[16:19], s43 offen offset:1024 sc1
    buffer_load_dwordx4 v[12:15], v11, s[16:19], s43 offen offset:2048 sc1
    buffer_load_dwordx4 a[0:3], v11, s[16:19], s43 offen offset:3072 sc1
    s_add_u32 s43, s43, 4096
    buffer_load_dwordx4 a[4:7], v11, s[16:19], s43 offen offset:0 sc1
    buffer_load_dwordx4 a[8:11], v11, s[16:19], s43 offen offset:1024 sc1
    buffer_load_dwordx4 a[12:15], v11, s[16:19], s43 offen offset:2048 sc1
    buffer_load_dwordx4 a[16:19], v11, s[16:19], s43 offen offset:3072 sc1
    s_add_u32 s43, s43, 4096
    buffer_load_dwordx4 a[20:23], v11, s[16:19], s43 offen offset:0 sc1
    buffer_load_dwordx4 a[24:27], v11, s[16:19], s43 offen offset:1024 sc1
    buffer_load_dwordx4 a[28:31], v11, s[16:19], s43 offen offset:2048 sc1
    buffer_load_dwordx4 a[32:35], v11, s[16:19], s43 offen offset:3072 sc1
    s_add_u32 s43, s43, 4096
    buffer_load_dwordx4 v[16:19], v11, s[16:19], s43 offen offset:0 sc1
    buffer_load_dwordx4 a[36:39], v11, s[16:19], s43 offen offset:1024 sc1
    buffer_load_dwordx4 a[40:43], v11, s[16:19], s43 offen offset:2048 sc1
    buffer_load_dwordx4 a[44:47], v11, s[16:19], s43 offen offset:3072 sc1
    ds_read_b128 v[160:163], v9 offset:10240
    ds_read_b128 v[164:167], v9 offset:10304
    ds_read_b128 v[168:171], v9 offset:10368
    ds_read_b128 v[172:175], v9 offset:10432
    ds_read_b128 v[176:179], v9 offset:10496
    ds_read_b128 v[180:183], v9 offset:10560
    ds_read_b128 v[184:187], v9 offset:10624
    ds_read_b128 v[188:191], v9 offset:10688
    ds_read_b128 v[192:195], v9 offset:10752
    s_cmp_eq_u32 s98, 0
    s_cbranch_scc1 M_cnt
    s_mov_b32 s98, 0
    v_mov_b32 v250, 1
    s_mov_b64 exec, 1
    buffer_atomic_add v250, off, s[68:71], 0 offset:0 sc1
    s_mov_b64 exec, -1
    s_nop 3
M_cnt:
    s_waitcnt vmcnt(12)
    s_barrier
    ds_read_b128 v[196:199], v1 offset:0
    ds_read_b128 v[200:203], v2 offset:0
    ds_read_b128 v[228:231], v1 offset:18432
    ds_read_b128 v[232:235], v2 offset:18432
    s_waitcnt lgkmcnt(2)
    v_smfmac_f32_16x16x64_bf16 v[124:127], a[0:3], v[196:203], v12
    s_add_u32 s43, s43, 4096
    buffer_load_dwordx4 a[48:51], v11, s[16:19], s43 offen offset:0 sc1
    s_waitcnt lgkmcnt(0)
    v_mov_b32 v82, s54
    v_smfmac_f32_16x16x64_bf16 v[160:163], a[0:3], v[228:235], v12
    ds_read_b128 v[204:207], v1 offset:1024
    ds_read_b128 v[208:211], v2 offset:1024
    v_or3_b32 v78, v56, v60, v64
    v_or_b32 v78, v78, v68
    v_cmp_gt_i32 s[32:33], 0, v78
    v_cmp_gt_u32 s[36:37], 2.0, v56
    s_nop 1
    v_mbcnt_lo_u32_b32 v74, s36, 0
    s_waitcnt vmcnt(12)
    v_mbcnt_hi_u32_b32 v74, s37, v74
    v_smfmac_f32_16x16x64_bf16 v[128:131], a[4:7], v[196:203], v12 abid:1
    buffer_load_dwordx4 a[52:55], v11, s[16:19], s43 offen offset:1024 sc1
    v_lshl_add_u32 v74, v74, 3, s38
    v_smfmac_f32_16x16x64_bf16 v[164:167], a[4:7], v[228:235], v12 abid:1
    ds_read_b128 v[220:223], v1 offset:19456
    ds_read_b128 v[224:227], v2 offset:19456
    v_min_u32 v74, s39, v74
    s_waitcnt vmcnt(12)
    v_cndmask_b32 v74, v82, v74, s[36:37]
    v_smfmac_f32_16x16x64_bf16 v[132:135], a[8:11], v[196:203], v13
    buffer_load_dwordx4 a[56:59], v11, s[16:19], s43 offen offset:2048 sc1
    ds_write_b64 v74, v[56:57]
    s_bcnt1_i32_b64 s30, s[36:37]
    s_lshl3_add_u32 s38, s30, s38
    v_cmp_gt_u32 s[44:45], 2.0, v58
    v_smfmac_f32_16x16x64_bf16 v[168:171], a[8:11], v[228:235], v13
    s_nop 0
    v_mbcnt_lo_u32_b32 v75, s44, 0
    v_mbcnt_hi_u32_b32 v75, s45, v75
    v_lshl_add_u32 v75, v75, 3, s38
    v_min_u32 v75, s39, v75
    s_waitcnt vmcnt(12)
    v_cndmask_b32 v75, v82, v75, s[44:45]
    v_smfmac_f32_16x16x64_bf16 v[136:139], a[12:15], v[196:203], v13 abid:1
    buffer_load_dwordx4 a[60:63], v11, s[16:19], s43 offen offset:3072 sc1
    ds_write_b64 v75, v[58:59]
    s_bcnt1_i32_b64 s30, s[44:45]
    s_lshl3_add_u32 s38, s30, s38
    v_cmp_gt_u32 s[36:37], 2.0, v60
    v_smfmac_f32_16x16x64_bf16 v[172:175], a[12:15], v[228:235], v13 abid:1
    s_nop 0
    v_mbcnt_lo_u32_b32 v74, s36, 0
    v_mbcnt_hi_u32_b32 v74, s37, v74
    v_lshl_add_u32 v74, v74, 3, s38
    s_waitcnt vmcnt(12)
    v_min_u32 v74, s39, v74
    v_smfmac_f32_16x16x64_bf16 v[140:143], a[16:19], v[196:203], v14
    s_add_u32 s43, s43, 4096
    buffer_load_dwordx4 a[64:67], v11, s[16:19], s43 offen offset:0 sc1
    v_cndmask_b32 v74, v82, v74, s[36:37]
    v_smfmac_f32_16x16x64_bf16 v[176:179], a[16:19], v[228:235], v14
    ds_write_b64 v74, v[60:61]
    s_bcnt1_i32_b64 s30, s[36:37]
    s_lshl3_add_u32 s38, s30, s38
    v_cmp_gt_u32 s[44:45], 2.0, v62
    s_nop 1
    v_mbcnt_lo_u32_b32 v75, s44, 0
    s_waitcnt vmcnt(12)
    v_mbcnt_hi_u32_b32 v75, s45, v75
    v_smfmac_f32_16x16x64_bf16 v[144:147], a[20:23], v[196:203], v14 abid:1
    buffer_load_dwordx4 a[68:71], v11, s[16:19], s43 offen offset:1024 sc1
    v_lshl_add_u32 v75, v75, 3, s38
    v_smfmac_f32_16x16x64_bf16 v[180:183], a[20:23], v[228:235], v14 abid:1
    v_min_u32 v75, s39, v75
    s_waitcnt vmcnt(12)
    v_cndmask_b32 v75, v82, v75, s[44:45]
    v_smfmac_f32_16x16x64_bf16 v[148:151], a[24:27], v[196:203], v15
    buffer_load_dwordx4 v[20:23], v11, s[16:19], s43 offen offset:2048 sc1
    buffer_load_dwordx4 a[72:75], v11, s[16:19], s43 offen offset:3072 sc1
    ds_write_b64 v75, v[62:63]
    s_bcnt1_i32_b64 s30, s[44:45]
    s_lshl3_add_u32 s38, s30, s38
    v_cmp_gt_u32 s[36:37], 2.0, v64
    v_smfmac_f32_16x16x64_bf16 v[184:187], a[24:27], v[228:235], v15
    s_nop 0
    v_mbcnt_lo_u32_b32 v74, s36, 0
    v_mbcnt_hi_u32_b32 v74, s37, v74
    v_lshl_add_u32 v74, v74, 3, s38
    v_min_u32 v74, s39, v74
    s_waitcnt vmcnt(13)
    v_cndmask_b32 v74, v82, v74, s[36:37]
    v_smfmac_f32_16x16x64_bf16 v[152:155], a[28:31], v[196:203], v15 abid:1
    s_add_u32 s43, s43, 4096
    buffer_load_dwordx4 a[76:79], v11, s[16:19], s43 offen offset:0 sc1
    ds_write_b64 v74, v[64:65]
    s_bcnt1_i32_b64 s30, s[36:37]
    s_lshl3_add_u32 s38, s30, s38
    v_cmp_gt_u32 s[44:45], 2.0, v66
    v_smfmac_f32_16x16x64_bf16 v[188:191], a[28:31], v[228:235], v15 abid:1
    s_nop 0
    v_mbcnt_lo_u32_b32 v75, s44, 0
    v_mbcnt_hi_u32_b32 v75, s45, v75
    v_lshl_add_u32 v75, v75, 3, s38
    s_waitcnt vmcnt(13)
    v_min_u32 v75, s39, v75
    v_smfmac_f32_16x16x64_bf16 v[156:159], a[32:35], v[196:203], v48
    buffer_load_dwordx4 a[80:83], v11, s[16:19], s43 offen offset:1024 sc1
    v_cndmask_b32 v75, v82, v75, s[44:45]
    v_smfmac_f32_16x16x64_bf16 v[192:195], a[32:35], v[228:235], v48
    ds_write_b64 v75, v[66:67]
    s_bcnt1_i32_b64 s30, s[44:45]
    s_lshl3_add_u32 s38, s30, s38
    v_cmp_gt_u32 s[36:37], 2.0, v68
    s_nop 1
    s_waitcnt vmcnt(12)
    s_waitcnt lgkmcnt(8)
    v_mbcnt_lo_u32_b32 v74, s36, 0
    v_smfmac_f32_16x16x64_bf16 v[124:127], a[36:39], v[204:211], v16
    buffer_load_dwordx4 a[84:87], v11, s[16:19], s43 offen offset:2048 sc1
    s_waitcnt lgkmcnt(6)
    v_mbcnt_hi_u32_b32 v74, s37, v74
    v_smfmac_f32_16x16x64_bf16 v[160:163], a[36:39], v[220:227], v16
    ds_read_b128 v[196:199], v1 offset:2048
    ds_read_b128 v[200:203], v2 offset:2048
    v_lshl_add_u32 v74, v74, 3, s38
    v_min_u32 v74, s39, v74
    s_waitcnt vmcnt(12)
    v_cndmask_b32 v74, v82, v74, s[36:37]
    v_smfmac_f32_16x16x64_bf16 v[128:131], a[40:43], v[204:211], v16 abid:1
    buffer_load_dwordx4 a[88:91], v11, s[16:19], s43 offen offset:3072 sc1
    ds_write_b64 v74, v[68:69]
    s_bcnt1_i32_b64 s30, s[36:37]
    s_lshl3_add_u32 s38, s30, s38
    v_cmp_gt_u32 s[44:45], 2.0, v70
    v_smfmac_f32_16x16x64_bf16 v[164:167], a[40:43], v[220:227], v16 abid:1
    ds_read_b128 v[228:231], v1 offset:20480
    ds_read_b128 v[232:235], v2 offset:20480
    v_mbcnt_lo_u32_b32 v75, s44, 0
    v_mbcnt_hi_u32_b32 v75, s45, v75
    v_lshl_add_u32 v75, v75, 3, s38
    v_min_u32 v75, s39, v75
    s_waitcnt vmcnt(12)
    v_cndmask_b32 v75, v82, v75, s[44:45]
    v_smfmac_f32_16x16x64_bf16 v[132:135], a[44:47], v[204:211], v17
    s_add_u32 s43, s43, 4096
    buffer_load_dwordx4 a[92:95], v11, s[16:19], s43 offen offset:0 sc1
    ds_write_b64 v75, v[70:71]
    s_bcnt1_i32_b64 s30, s[44:45]
    s_lshl3_add_u32 s38, s30, s38
    ds_read_b64 v[56:57], v55 offset:0
    ds_read_b64 v[58:59], v55 offset:512
    ds_read_b64 v[60:61], v55 offset:1024
    v_smfmac_f32_16x16x64_bf16 v[168:171], a[44:47], v[220:227], v17
    s_waitcnt vmcnt(12)
    v_smfmac_f32_16x16x64_bf16 v[136:139], a[48:51], v[204:211], v17 abid:1
    buffer_load_dwordx4 a[96:99], v11, s[16:19], s43 offen offset:1024 sc1
    v_smfmac_f32_16x16x64_bf16 v[172:175], a[48:51], v[220:227], v17 abid:1
    s_waitcnt vmcnt(12)
    v_smfmac_f32_16x16x64_bf16 v[140:143], a[52:55], v[204:211], v18
    buffer_load_dwordx4 a[100:103], v11, s[16:19], s43 offen offset:2048 sc1
    s_waitcnt lgkmcnt(2)
    v_bfe_u32 v74, v56, 24, 4
    v_smfmac_f32_16x16x64_bf16 v[176:179], a[52:55], v[220:227], v18
    v_lshlrev_b32 v75, 1, v56
    v_lshl_add_u32 v74, v74, 2, s49
    v_and_b32 v75, 16, v75
    s_waitcnt vmcnt(12)
    v_and_or_b32 v74, v56, 2.0, v74
    v_smfmac_f32_16x16x64_bf16 v[144:147], a[56:59], v[204:211], v18 abid:1
    buffer_load_dwordx4 a[104:107], v11, s[16:19], s43 offen offset:3072 sc1
    v_lshlrev_b32 v75, v75, 1
    v_smfmac_f32_16x16x64_bf16 v[180:183], a[56:59], v[220:227], v18 abid:1
    ds_add_rtn_u32 v62, v74, v75
    s_waitcnt lgkmcnt(2)
    v_bfe_u32 v76, v58, 24, 4
    v_lshlrev_b32 v77, 1, v58
    v_lshl_add_u32 v76, v76, 2, s49
    s_waitcnt vmcnt(12)
    v_and_b32 v77, 16, v77
    v_smfmac_f32_16x16x64_bf16 v[148:151], a[60:63], v[204:211], v19
    s_add_u32 s43, s43, 4096
    buffer_load_dwordx4 v[24:27], v11, s[16:19], s43 offen offset:0 sc1
    buffer_load_dwordx4 a[108:111], v11, s[16:19], s43 offen offset:1024 sc1
    v_and_or_b32 v76, v58, 2.0, v76
    v_smfmac_f32_16x16x64_bf16 v[184:187], a[60:63], v[220:227], v19
    s_waitcnt vmcnt(13)
    v_lshlrev_b32 v77, v77, 1
    v_smfmac_f32_16x16x64_bf16 v[152:155], a[64:67], v[204:211], v19 abid:1
    buffer_load_dwordx4 a[112:115], v11, s[16:19], s43 offen offset:2048 sc1
    ds_add_rtn_u32 v63, v76, v77
    s_waitcnt lgkmcnt(2)
    s_cmp_gt_u32 s38, s35
    s_cbranch_scc1 M_r3
M_r3r:
    ds_read_b32 v81, v84
    v_and_b32 v74, 8, v56
    v_smfmac_f32_16x16x64_bf16 v[188:191], a[64:67], v[220:227], v19 abid:1
    v_lshrrev_b32 v77, 14, v56
    v_cmp_ne_u32 s[44:45], 0, v74
    v_and_b32 v80, 0x3cf0, v77
    s_waitcnt lgkmcnt(2)
    v_lshrrev_b32 v75, 16, v62
    v_and_b32 v76, 0xffff, v62
    s_waitcnt vmcnt(13)
    v_sub_u32 v74, 15, v75
    v_smfmac_f32_16x16x64_bf16 v[156:159], a[68:71], v[204:211], v48 abid:1
    buffer_load_dwordx4 a[116:119], v11, s[16:19], s43 offen offset:3072 sc1
    v_and_b32 v62, 2.0, v56
    v_smfmac_f32_16x16x64_bf16 v[192:195], a[68:71], v[220:227], v48 abid:1
    v_add3_u32 v62, v76, v75, v62
    v_cndmask_b32 v74, v76, v74, s[44:45]
    v_cmp_gt_u32 s[44:45], 16, v62
    v_cmp_gt_u32 s[36:37], 2.0, v62
    v_lshlrev_b32 v74, 2, v74
    s_waitcnt vmcnt(12)
    v_lshrrev_b64 v[76:77], v74, s[50:51]
    v_smfmac_f32_16x16x64_bf16 v[124:127], a[72:75], v[196:203], v20
    s_add_u32 s43, s43, 4096
    buffer_load_dwordx4 a[120:123], v11, s[16:19], s43 offen offset:0 sc1
    s_andn2_b64 s[36:37], s[36:37], s[44:45]
    v_lshrrev_b64 v[78:79], v74, s[52:53]
    v_smfmac_f32_16x16x64_bf16 v[160:163], a[72:75], v[228:235], v20
    ds_read_b128 v[204:207], v1 offset:3072
    ds_read_b128 v[208:211], v2 offset:3072
    v_bfe_u32 v74, v56, 24, 4
    v_mbcnt_lo_u32_b32 v75, s36, 0
    v_and_b32 v76, 15, v76
    v_mbcnt_hi_u32_b32 v75, s37, v75
    v_and_b32 v78, 15, v78
    s_waitcnt vmcnt(12)
    v_lshl_add_u32 v75, v75, 3, s40
    v_smfmac_f32_16x16x64_bf16 v[128:131], a[76:79], v[196:203], v20 abid:1
    buffer_load_dwordx4 a[124:127], v11, s[16:19], s43 offen offset:1024 sc1
    v_lshl_add_u32 v76, v74, 4, v76
    v_smfmac_f32_16x16x64_bf16 v[164:167], a[76:79], v[228:235], v20 abid:1
    ds_read_b128 v[220:223], v1 offset:21504
    ds_read_b128 v[224:227], v2 offset:21504
    v_min_u32 v75, s41, v75
    v_mul_u32_u24 v78, 68, v78
    s_waitcnt vmcnt(12)
    v_cndmask_b32 v75, v82, v75, s[36:37]
    v_smfmac_f32_16x16x64_bf16 v[132:135], a[80:83], v[196:203], v21
    buffer_load_dwordx4 a[128:131], v11, s[16:19], s43 offen offset:2048 sc1
    ds_write_b64 v75, v[56:57]
    s_bcnt1_i32_b64 s30, s[36:37]
    s_lshl3_add_u32 s40, s30, s40
    v_lshl_add_u32 v76, v76, 2, s47
    v_smfmac_f32_16x16x64_bf16 v[168:171], a[80:83], v[228:235], v21
    v_and_b32 v78, 0x30c, v78
    v_cndmask_b32 v76, v82, v76, s[44:45]
    v_add3_u32 v77, v80, v78, s29
    v_and_b32 v78, 0x3fff, v56
    s_waitcnt vmcnt(12)
    v_cndmask_b32 v74, v82, v77, s[44:45]
    v_smfmac_f32_16x16x64_bf16 v[136:139], a[84:87], v[196:203], v21 abid:1
    buffer_load_dwordx4 a[132:135], v11, s[16:19], s43 offen offset:3072 sc1
    ds_write_b32 v76, v78
    ds_write_b32 v74, v57
    v_and_b32 v74, 8, v58
    v_smfmac_f32_16x16x64_bf16 v[172:175], a[84:87], v[228:235], v21 abid:1
    v_lshrrev_b32 v77, 14, v58
    v_cmp_ne_u32 s[44:45], 0, v74
    v_and_b32 v80, 0x3cf0, v77
    s_waitcnt lgkmcnt(8)
    s_waitcnt vmcnt(12)
    v_lshrrev_b32 v75, 16, v63
    v_smfmac_f32_16x16x64_bf16 v[140:143], a[88:91], v[196:203], v22
    s_add_u32 s43, s43, 4096
    buffer_load_dwordx4 a[136:139], v11, s[16:19], s43 offen offset:0 sc1
    v_and_b32 v76, 0xffff, v63
    v_smfmac_f32_16x16x64_bf16 v[176:179], a[88:91], v[228:235], v22
    v_sub_u32 v74, 15, v75
    v_and_b32 v63, 2.0, v58
    v_add3_u32 v63, v76, v75, v63
    v_cndmask_b32 v74, v76, v74, s[44:45]
    s_waitcnt vmcnt(12)
    v_cmp_gt_u32 s[44:45], 16, v63
    v_smfmac_f32_16x16x64_bf16 v[144:147], a[92:95], v[196:203], v22 abid:1
    buffer_load_dwordx4 a[140:143], v11, s[16:19], s43 offen offset:1024 sc1
    v_cmp_gt_u32 s[36:37], 2.0, v63
    v_smfmac_f32_16x16x64_bf16 v[180:183], a[92:95], v[228:235], v22 abid:1
    v_lshlrev_b32 v74, 2, v74
    s_waitcnt vmcnt(12)
    v_lshrrev_b64 v[76:77], v74, s[50:51]
    v_smfmac_f32_16x16x64_bf16 v[148:151], a[96:99], v[196:203], v23
    buffer_load_dwordx4 v[28:31], v11, s[16:19], s43 offen offset:2048 sc1
    buffer_load_dwordx4 a[144:147], v11, s[16:19], s43 offen offset:3072 sc1
    s_andn2_b64 s[36:37], s[36:37], s[44:45]
    v_lshrrev_b64 v[78:79], v74, s[52:53]
    v_smfmac_f32_16x16x64_bf16 v[184:187], a[96:99], v[228:235], v23
    v_bfe_u32 v74, v58, 24, 4
    v_mbcnt_lo_u32_b32 v75, s36, 0
    v_and_b32 v76, 15, v76
    v_mbcnt_hi_u32_b32 v75, s37, v75
    v_and_b32 v78, 15, v78
    s_waitcnt vmcnt(13)
    v_lshl_add_u32 v75, v75, 3, s40
    v_smfmac_f32_16x16x64_bf16 v[152:155], a[100:103], v[196:203], v23 abid:1
    s_add_u32 s43, s43, 4096
    buffer_load_dwordx4 a[148:151], v11, s[16:19], s43 offen offset:0 sc1
    v_lshl_add_u32 v76, v74, 4, v76
    v_smfmac_f32_16x16x64_bf16 v[188:191], a[100:103], v[228:235], v23 abid:1
    v_min_u32 v75, s41, v75
    v_mul_u32_u24 v78, 68, v78
    s_waitcnt vmcnt(13)
    v_cndmask_b32 v75, v82, v75, s[36:37]
    v_smfmac_f32_16x16x64_bf16 v[156:159], a[104:107], v[196:203], v49
    buffer_load_dwordx4 a[152:155], v11, s[16:19], s43 offen offset:1024 sc1
    ds_write_b64 v75, v[58:59]
    s_bcnt1_i32_b64 s30, s[36:37]
    s_lshl3_add_u32 s40, s30, s40
    v_lshl_add_u32 v76, v76, 2, s47
    v_smfmac_f32_16x16x64_bf16 v[192:195], a[104:107], v[228:235], v49
    v_and_b32 v78, 0x30c, v78
    v_cndmask_b32 v76, v82, v76, s[44:45]
    v_add3_u32 v77, v80, v78, s29
    v_and_b32 v78, 0x3fff, v58
    s_waitcnt vmcnt(12)
    s_waitcnt lgkmcnt(6)
    v_cndmask_b32 v74, v82, v77, s[44:45]
    v_smfmac_f32_16x16x64_bf16 v[124:127], a[108:111], v[204:211], v24
    buffer_load_dwordx4 a[156:159], v11, s[16:19], s43 offen offset:2048 sc1
    ds_write_b32 v76, v78
    ds_write_b32 v74, v59
    s_waitcnt lgkmcnt(6)
    v_lshrrev_b32 v74, 16, v81
    v_smfmac_f32_16x16x64_bf16 v[160:163], a[108:111], v[220:227], v24
    ds_read_b128 v[196:199], v1 offset:4096
    ds_read_b128 v[200:203], v2 offset:4096
    v_and_b32 v81, 0xffff, v81
    v_add_u32 v81, v81, v74
    s_waitcnt vmcnt(12)
    v_cmp_lt_u32 s[34:35], 16, v81
    v_smfmac_f32_16x16x64_bf16 v[128:131], a[112:115], v[204:211], v24 abid:1
    buffer_load_dwordx4 a[160:163], v11, s[16:19], s43 offen offset:3072 sc1
    s_sub_u32 s46, s40, s48
    s_add_u32 s46, s46, 56
    s_lshr_b32 s46, s46, 6
    s_mov_b32 s21, 0
    s_and_b32 s27, s34, 0x1ff
    s_cmp_gt_u32 s46, 4
    s_cselect_b32 s32, 1, s32
    s_or_b32 s32, s32, s33
    s_cbranch_scc1 M_dn
M_dnr:
    ds_read_b128 v[56:59], v9 offset:9792
    s_bcnt1_i32_b32 s30, s27
    s_cmp_gt_u32 s30, 3
    s_cselect_b32 s34, 0, s27
    s_cselect_b32 s80, 0, 1
    s_getpc_b64 s[36:37]
M_pc:
    v_bfe_u32 v74, v11, 4, 4
    v_smfmac_f32_16x16x64_bf16 v[164:167], a[112:115], v[220:227], v24 abid:1
    ds_read_b128 v[228:231], v1 offset:22528
    ds_read_b128 v[232:235], v2 offset:22528
    s_waitcnt vmcnt(12)
    v_smfmac_f32_16x16x64_bf16 v[132:135], a[116:119], v[204:211], v25
    s_add_u32 s43, s43, 4096
    buffer_load_dwordx4 a[164:167], v11, s[16:19], s43 offen offset:0 sc1
    s_ff1_i32_b32 s81, s34
    s_bitset0_b32 s34, s81
    s_mul_i32 s30, s81, 20
    s_add_u32 s31, s30, M_ovc0-M_pc
    s_add_u32 s30, s30, M_ovl0-M_pc
    s_cmp_lg_u32 s34, 0
    s_cselect_b32 s30, s31, s30
    s_cmp_lt_i32 s81, 0
    s_cselect_b32 s30, M_ovn-M_pc, s30
    s_add_u32 s72, s36, s30
    s_addc_u32 s73, s37, 0
    s_ff1_i32_b32 s82, s34
    s_bitset0_b32 s34, s82
    s_mul_i32 s30, s82, 20
    s_add_u32 s31, s30, M_ovc1-M_pc
    s_add_u32 s30, s30, M_ovl1-M_pc
    s_cmp_lg_u32 s34, 0
    s_cselect_b32 s30, s31, s30
    s_cmp_lt_i32 s82, 0
    s_cselect_b32 s30, M_ovn-M_pc, s30
    v_smfmac_f32_16x16x64_bf16 v[168:171], a[116:119], v[220:227], v25
    s_waitcnt vmcnt(12)
    v_smfmac_f32_16x16x64_bf16 v[136:139], a[120:123], v[204:211], v25 abid:1
    buffer_load_dwordx4 a[168:171], v11, s[16:19], s43 offen offset:1024 sc1
    s_add_u32 s74, s36, s30
    s_addc_u32 s75, s37, 0
    s_ff1_i32_b32 s83, s34
    s_bitset0_b32 s34, s83
    s_mul_i32 s30, s83, 20
    s_add_u32 s31, s30, M_ovc1-M_pc
    s_add_u32 s30, s30, M_ovl2-M_pc
    s_cmp_lg_u32 s34, 0
    s_cselect_b32 s30, s31, s30
    s_cmp_lt_i32 s83, 0
    s_cselect_b32 s30, M_ovn-M_pc, s30
    s_add_u32 s76, s36, s30
    s_addc_u32 s77, s37, 0
    s_waitcnt lgkmcnt(2)
    v_lshrrev_b32 v76, 18, v56
    v_smfmac_f32_16x16x64_bf16 v[172:175], a[120:123], v[220:227], v25 abid:1
    s_waitcnt vmcnt(12)
    v_lshrrev_b32 v77, 18, v58
    v_smfmac_f32_16x16x64_bf16 v[140:143], a[124:127], v[204:211], v26
    buffer_load_dwordx4 a[172:175], v11, s[16:19], s43 offen offset:2048 sc1
    v_and_b32 v78, 0x3fff, v56
    v_smfmac_f32_16x16x64_bf16 v[176:179], a[124:127], v[220:227], v26
    s_waitcnt vmcnt(12)
    v_and_b32 v79, 0x3fff, v58
    v_smfmac_f32_16x16x64_bf16 v[144:147], a[128:131], v[204:211], v26 abid:1
    buffer_load_dwordx4 a[176:179], v11, s[16:19], s43 offen offset:3072 sc1
    ds_write_b64 v9, v[78:79] offset:10056
    v_lshl_or_b32 v75, s81, 6, v74
    v_smfmac_f32_16x16x64_bf16 v[180:183], a[128:131], v[220:227], v26 abid:1
    v_cmp_eq_u32 s[44:45], v76, v75
    v_cmp_eq_u32 s[36:37], v77, v75
    s_nop 0
    v_cndmask_b32 v54, 0, v57, s[44:45]
    v_cndmask_b32 v55, 0, v59, s[36:37]
    v_lshl_or_b32 v75, s82, 6, v74
    s_waitcnt vmcnt(12)
    v_cmp_eq_u32 s[44:45], v76, v75
    v_smfmac_f32_16x16x64_bf16 v[148:151], a[132:135], v[204:211], v27
    s_add_u32 s43, s43, 4096
    buffer_load_dwordx4 v[32:35], v11, s[16:19], s43 offen offset:0 sc1
    buffer_load_dwordx4 a[180:183], v11, s[16:19], s43 offen offset:1024 sc1
    v_cmp_eq_u32 s[36:37], v77, v75
    v_smfmac_f32_16x16x64_bf16 v[184:187], a[132:135], v[220:227], v27
    v_cndmask_b32 v252, 0, v57, s[44:45]
    v_cndmask_b32 v253, 0, v59, s[36:37]
    v_lshl_or_b32 v75, s83, 6, v74
    v_cmp_eq_u32 s[44:45], v76, v75
    v_cmp_eq_u32 s[36:37], v77, v75
    s_nop 0
    s_waitcnt vmcnt(13)
    v_cndmask_b32 v254, 0, v57, s[44:45]
    v_smfmac_f32_16x16x64_bf16 v[152:155], a[136:139], v[204:211], v27 abid:1
    buffer_load_dwordx4 a[184:187], v11, s[16:19], s43 offen offset:2048 sc1
    v_cndmask_b32 v255, 0, v59, s[36:37]
    v_smfmac_f32_16x16x64_bf16 v[188:191], a[136:139], v[220:227], v27 abid:1
    ds_read_b128 v[236:239], v9 offset:9408
    ds_read_b64 v[216:217], v9 offset:10056
    s_waitcnt vmcnt(13)
    v_smfmac_f32_16x16x64_bf16 v[156:159], a[140:143], v[204:211], v49 abid:1
    buffer_load_dwordx4 a[188:191], v11, s[16:19], s43 offen offset:3072 sc1
    s_waitcnt lgkmcnt(1)
    v_xad_u32 v236, v236, v3, v4
    v_smfmac_f32_16x16x64_bf16 v[192:195], a[140:143], v[220:227], v49 abid:1
    s_waitcnt vmcnt(12)
    v_xad_u32 v237, v237, v3, v4
    v_smfmac_f32_16x16x64_bf16 v[124:127], a[144:147], v[196:203], v28
    s_add_u32 s43, s43, 4096
    buffer_load_dwordx4 a[192:195], v11, s[16:19], s43 offen offset:0 sc1
    ds_read2st64_b32 v[244:245], v236 offset0:0 offset1:72
    ds_read2st64_b32 v[246:247], v237 offset0:0 offset1:72
    v_xad_u32 v238, v238, v3, v4
    v_smfmac_f32_16x16x64_bf16 v[160:163], a[144:147], v[228:235], v28
    ds_read_b128 v[204:207], v1 offset:5120
    ds_read_b128 v[208:211], v2 offset:5120
    s_waitcnt vmcnt(12)
    v_xad_u32 v239, v239, v3, v4
    v_smfmac_f32_16x16x64_bf16 v[128:131], a[148:151], v[196:203], v28 abid:1
    buffer_load_dwordx4 a[196:199], v11, s[16:19], s43 offen offset:1024 sc1
    ds_read2st64_b32 v[248:249], v238 offset0:0 offset1:72
    ds_read2st64_b32 v[250:251], v239 offset0:0 offset1:72
    ds_read_b128 v[240:243], v8 offset:3072
    ds_read_b128 v[236:239], v9 offset:9280
    s_waitcnt lgkmcnt(8)
    v_xad_u32 v212, v216, v3, v4
    v_smfmac_f32_16x16x64_bf16 v[164:167], a[148:151], v[228:235], v28 abid:1
    ds_read_b128 v[220:223], v1 offset:23552
    ds_read_b128 v[224:227], v2 offset:23552
    ds_read2st64_b32 v[212:213], v212 offset0:0 offset1:72
    s_waitcnt vmcnt(12)
    v_xad_u32 v214, v217, v3, v4
    v_smfmac_f32_16x16x64_bf16 v[132:135], a[152:155], v[196:203], v29
    buffer_load_dwordx4 a[200:203], v11, s[16:19], s43 offen offset:2048 sc1
    ds_read2st64_b32 v[214:215], v214 offset0:0 offset1:72
    v_smfmac_f32_16x16x64_bf16 v[168:171], a[152:155], v[228:235], v29
    s_waitcnt vmcnt(12)
    v_smfmac_f32_16x16x64_bf16 v[136:139], a[156:159], v[196:203], v29 abid:1
    buffer_load_dwordx4 a[204:207], v11, s[16:19], s43 offen offset:3072 sc1
    v_smfmac_f32_16x16x64_bf16 v[172:175], a[156:159], v[228:235], v29 abid:1
    s_waitcnt vmcnt(12)
    v_smfmac_f32_16x16x64_bf16 v[140:143], a[160:163], v[196:203], v30
    s_add_u32 s43, s43, 4096
    buffer_load_dwordx4 a[208:211], v11, s[16:19], s43 offen offset:0 sc1
    s_waitcnt lgkmcnt(5)
    v_smfmac_f32_16x16x64_bf16 v[136:139], v[240:243], v[244:251], v10
    v_smfmac_f32_16x16x64_bf16 v[172:175], v[240:243], v[244:251], v10 abid:1
    s_waitcnt lgkmcnt(4)
    v_xad_u32 v236, v236, v3, v4
    v_smfmac_f32_16x16x64_bf16 v[176:179], a[160:163], v[228:235], v30
    s_waitcnt vmcnt(12)
    v_xad_u32 v237, v237, v3, v4
    v_smfmac_f32_16x16x64_bf16 v[144:147], a[164:167], v[196:203], v30 abid:1
    buffer_load_dwordx4 a[212:215], v11, s[16:19], s43 offen offset:1024 sc1
    ds_read2st64_b32 v[244:245], v236 offset0:0 offset1:72
    ds_read2st64_b32 v[246:247], v237 offset0:0 offset1:72
    v_xad_u32 v238, v238, v3, v4
    v_smfmac_f32_16x16x64_bf16 v[180:183], a[164:167], v[228:235], v30 abid:1
    s_waitcnt vmcnt(12)
    v_xad_u32 v239, v239, v3, v4
    v_smfmac_f32_16x16x64_bf16 v[148:151], a[168:171], v[196:203], v31
    buffer_load_dwordx4 v[36:39], v11, s[16:19], s43 offen offset:2048 sc1
    buffer_load_dwordx4 a[216:219], v11, s[16:19], s43 offen offset:3072 sc1
    ds_read2st64_b32 v[248:249], v238 offset0:0 offset1:72
    ds_read2st64_b32 v[250:251], v239 offset0:0 offset1:72
    ds_read_b128 v[240:243], v8 offset:1024
    ds_read_b128 v[236:239], v9 offset:9344
    v_smfmac_f32_16x16x64_bf16 v[184:187], a[168:171], v[228:235], v31
    s_waitcnt vmcnt(13)
    v_smfmac_f32_16x16x64_bf16 v[152:155], a[172:175], v[196:203], v31 abid:1
    s_add_u32 s43, s43, 4096
    buffer_load_dwordx4 a[220:223], v11, s[16:19], s43 offen offset:0 sc1
    s_waitcnt lgkmcnt(6)
    s_cmp_lt_i32 s81, 0
    s_cbranch_scc1 M_ovr0
    s_swappc_b64 s[78:79], s[72:73]
M_ovr0:
    v_smfmac_f32_16x16x64_bf16 v[188:191], a[172:175], v[228:235], v31 abid:1
    s_waitcnt vmcnt(13)
    v_smfmac_f32_16x16x64_bf16 v[156:159], a[176:179], v[196:203], v50
    buffer_load_dwordx4 a[224:227], v11, s[16:19], s43 offen offset:1024 sc1
    v_smfmac_f32_16x16x64_bf16 v[192:195], a[176:179], v[228:235], v50
    s_waitcnt vmcnt(12)
    v_smfmac_f32_16x16x64_bf16 v[124:127], a[180:183], v[204:211], v32
    buffer_load_dwordx4 a[228:231], v11, s[16:19], s43 offen offset:2048 sc1
    s_waitcnt lgkmcnt(1)
    v_smfmac_f32_16x16x64_bf16 v[128:131], v[240:243], v[244:251], v10
    v_smfmac_f32_16x16x64_bf16 v[164:167], v[240:243], v[244:251], v10 abid:1
    s_waitcnt lgkmcnt(0)
    v_xad_u32 v236, v236, v3, v4
    v_smfmac_f32_16x16x64_bf16 v[160:163], a[180:183], v[220:227], v32
    ds_read_b128 v[196:199], v1 offset:6144
    ds_read_b128 v[200:203], v2 offset:6144
    s_waitcnt vmcnt(12)
    v_xad_u32 v237, v237, v3, v4
    v_smfmac_f32_16x16x64_bf16 v[128:131], a[184:187], v[204:211], v32 abid:1
    buffer_load_dwordx4 a[232:235], v11, s[16:19], s43 offen offset:3072 sc1
    ds_read2st64_b32 v[244:245], v236 offset0:0 offset1:72
    ds_read2st64_b32 v[246:247], v237 offset0:0 offset1:72
    v_xad_u32 v238, v238, v3, v4
    v_smfmac_f32_16x16x64_bf16 v[164:167], a[184:187], v[220:227], v32 abid:1
    ds_read_b128 v[228:231], v1 offset:24576
    ds_read_b128 v[232:235], v2 offset:24576
    s_waitcnt vmcnt(12)
    v_xad_u32 v239, v239, v3, v4
    v_smfmac_f32_16x16x64_bf16 v[132:135], a[188:191], v[204:211], v33
    s_add_u32 s43, s43, 4096
    buffer_load_dwordx4 a[236:239], v11, s[16:19], s43 offen offset:0 sc1
    ds_read2st64_b32 v[248:249], v238 offset0:0 offset1:72
    ds_read2st64_b32 v[250:251], v239 offset0:0 offset1:72
    ds_read_b128 v[240:243], v8 offset:2048
    ds_read_b128 v[236:239], v9 offset:9216
    v_smfmac_f32_16x16x64_bf16 v[168:171], a[188:191], v[220:227], v33
    s_waitcnt vmcnt(12)
    v_smfmac_f32_16x16x64_bf16 v[136:139], a[192:195], v[204:211], v33 abid:1
    buffer_load_dwordx4 a[240:243], v11, s[16:19], s43 offen offset:1024 sc1
    v_smfmac_f32_16x16x64_bf16 v[172:175], a[192:195], v[220:227], v33 abid:1
    s_waitcnt vmcnt(12)
    v_smfmac_f32_16x16x64_bf16 v[140:143], a[196:199], v[204:211], v34
    buffer_load_dwordx4 a[244:247], v11, s[16:19], s43 offen offset:2048 sc1
    v_smfmac_f32_16x16x64_bf16 v[176:179], a[196:199], v[220:227], v34
    s_waitcnt vmcnt(12)
    v_smfmac_f32_16x16x64_bf16 v[144:147], a[200:203], v[204:211], v34 abid:1
    buffer_load_dwordx4 a[248:251], v11, s[16:19], s43 offen offset:3072 sc1
    s_waitcnt lgkmcnt(1)
    v_smfmac_f32_16x16x64_bf16 v[132:135], v[240:243], v[244:251], v10
    v_smfmac_f32_16x16x64_bf16 v[168:171], v[240:243], v[244:251], v10 abid:1
    s_waitcnt lgkmcnt(0)
    v_xad_u32 v236, v236, v3, v4
    v_smfmac_f32_16x16x64_bf16 v[180:183], a[200:203], v[220:227], v34 abid:1
    s_waitcnt vmcnt(12)
    v_xad_u32 v237, v237, v3, v4
    v_smfmac_f32_16x16x64_bf16 v[148:151], a[204:207], v[204:211], v35
    s_add_u32 s43, s43, 4096
    buffer_load_dwordx4 v[40:43], v11, s[16:19], s43 offen offset:0 sc1
    buffer_load_dwordx4 a[252:255], v11, s[16:19], s43 offen offset:1024 sc1
    ds_read2st64_b32 v[244:245], v236 offset0:0 offset1:72
    ds_read2st64_b32 v[246:247], v237 offset0:0 offset1:72
    v_xad_u32 v238, v238, v3, v4
    v_smfmac_f32_16x16x64_bf16 v[184:187], a[204:207], v[220:227], v35
    s_waitcnt vmcnt(13)
    v_xad_u32 v239, v239, v3, v4
    v_smfmac_f32_16x16x64_bf16 v[152:155], a[208:211], v[204:211], v35 abid:1
    buffer_load_dwordx4 v[56:59], v11, s[16:19], s43 offen offset:2048 sc1
    ds_read2st64_b32 v[248:249], v238 offset0:0 offset1:72
    ds_read2st64_b32 v[250:251], v239 offset0:0 offset1:72
    ds_read_b128 v[240:243], v8 offset:0
    ds_read_b128 v[236:239], v9 offset:9728
    v_smfmac_f32_16x16x64_bf16 v[188:191], a[208:211], v[220:227], v35 abid:1
    s_waitcnt vmcnt(13)
    v_smfmac_f32_16x16x64_bf16 v[156:159], a[212:215], v[204:211], v50 abid:1
    buffer_load_dwordx4 v[60:63], v11, s[16:19], s43 offen offset:3072 sc1
    v_smfmac_f32_16x16x64_bf16 v[192:195], a[212:215], v[220:227], v50 abid:1
    s_waitcnt vmcnt(12)
    v_smfmac_f32_16x16x64_bf16 v[124:127], a[216:219], v[196:203], v36
    s_add_u32 s43, s43, 4096
    buffer_load_dwordx4 v[64:67], v11, s[16:19], s43 offen offset:0 sc1
    v_smfmac_f32_16x16x64_bf16 v[160:163], a[216:219], v[228:235], v36
    ds_read_b128 v[204:207], v1 offset:7168
    ds_read_b128 v[208:211], v2 offset:7168
    s_waitcnt vmcnt(12)
    v_smfmac_f32_16x16x64_bf16 v[128:131], a[220:223], v[196:203], v36 abid:1
    buffer_load_dwordx4 v[68:71], v11, s[16:19], s43 offen offset:1024 sc1
    s_waitcnt lgkmcnt(3)
    v_smfmac_f32_16x16x64_bf16 v[124:127], v[240:243], v[244:251], v10
    v_smfmac_f32_16x16x64_bf16 v[160:163], v[240:243], v[244:251], v10 abid:1
    s_waitcnt lgkmcnt(2)
    v_xad_u32 v236, v236, v3, v4
    v_smfmac_f32_16x16x64_bf16 v[164:167], a[220:223], v[228:235], v36 abid:1
    ds_read_b128 v[220:223], v1 offset:25600
    ds_read_b128 v[224:227], v2 offset:25600
    s_waitcnt vmcnt(12)
    v_xad_u32 v237, v237, v3, v4
    v_smfmac_f32_16x16x64_bf16 v[132:135], a[224:227], v[196:203], v37
    buffer_load_dwordx4 v[72:75], v11, s[16:19], s43 offen offset:2048 sc1
    ds_read2st64_b32 v[244:245], v236 offset0:0 offset1:72
    ds_read2st64_b32 v[246:247], v237 offset0:0 offset1:72
    v_xad_u32 v238, v238, v3, v4
    v_smfmac_f32_16x16x64_bf16 v[168:171], a[224:227], v[228:235], v37
    s_waitcnt vmcnt(12)
    v_xad_u32 v239, v239, v3, v4
    v_smfmac_f32_16x16x64_bf16 v[136:139], a[228:231], v[196:203], v37 abid:1
    buffer_load_dwordx4 v[76:79], v11, s[16:19], s43 offen offset:3072 sc1
    ds_read2st64_b32 v[248:249], v238 offset0:0 offset1:72
    ds_read2st64_b32 v[250:251], v239 offset0:0 offset1:72
    ds_read_b128 v[240:243], v8 offset:8192
    ds_read_b128 v[236:239], v9 offset:9664
    v_smfmac_f32_16x16x64_bf16 v[172:175], a[228:231], v[228:235], v37 abid:1
    s_waitcnt vmcnt(12)
    v_smfmac_f32_16x16x64_bf16 v[140:143], a[232:235], v[196:203], v38
    s_add_u32 s43, s43, 4096
    buffer_load_dwordx4 v[80:83], v11, s[16:19], s43 offen offset:0 sc1
    v_smfmac_f32_16x16x64_bf16 v[176:179], a[232:235], v[228:235], v38
    s_waitcnt vmcnt(12)
    v_smfmac_f32_16x16x64_bf16 v[144:147], a[236:239], v[196:203], v38 abid:1
    buffer_load_dwordx4 v[84:87], v11, s[16:19], s43 offen offset:1024 sc1
    v_smfmac_f32_16x16x64_bf16 v[180:183], a[236:239], v[228:235], v38 abid:1
    s_waitcnt vmcnt(12)
    v_smfmac_f32_16x16x64_bf16 v[148:151], a[240:243], v[196:203], v39
    buffer_load_dwordx4 v[44:47], v11, s[16:19], s43 offen offset:2048 sc1
    buffer_load_dwordx4 v[88:91], v11, s[16:19], s43 offen offset:3072 sc1
    s_waitcnt lgkmcnt(1)
    v_smfmac_f32_16x16x64_bf16 v[156:159], v[240:243], v[244:251], v10
    v_smfmac_f32_16x16x64_bf16 v[192:195], v[240:243], v[244:251], v10 abid:1
    s_waitcnt lgkmcnt(0)
    v_xad_u32 v236, v236, v3, v4
    v_smfmac_f32_16x16x64_bf16 v[184:187], a[240:243], v[228:235], v39
    s_waitcnt vmcnt(13)
    v_xad_u32 v237, v237, v3, v4
    v_smfmac_f32_16x16x64_bf16 v[152:155], a[244:247], v[196:203], v39 abid:1
    s_add_u32 s43, s43, 4096
    buffer_load_dwordx4 v[92:95], v11, s[16:19], s43 offen offset:0 sc1
    ds_read2st64_b32 v[244:245], v236 offset0:0 offset1:72
    ds_read2st64_b32 v[246:247], v237 offset0:0 offset1:72
    v_xad_u32 v238, v238, v3, v4
    v_smfmac_f32_16x16x64_bf16 v[188:191], a[244:247], v[228:235], v39 abid:1
    s_waitcnt vmcnt(13)
    v_xad_u32 v239, v239, v3, v4
    v_smfmac_f32_16x16x64_bf16 v[156:159], a[248:251], v[196:203], v51
    buffer_load_dwordx4 v[96:99], v11, s[16:19], s43 offen offset:1024 sc1
    ds_read2st64_b32 v[248:249], v238 offset0:0 offset1:72
    ds_read2st64_b32 v[250:251], v239 offset0:0 offset1:72
    ds_read_b128 v[240:243], v8 offset:7168
    ds_read_b128 v[236:239], v9 offset:9536
    v_smfmac_f32_16x16x64_bf16 v[192:195], a[248:251], v[228:235], v51
    s_waitcnt vmcnt(12)
    v_smfmac_f32_16x16x64_bf16 v[124:127], a[252:255], v[204:211], v40
    buffer_load_dwordx4 v[100:103], v11, s[16:19], s43 offen offset:2048 sc1
    ds_read_b128 v[196:199], v1 offset:8192
    ds_read_b128 v[200:203], v2 offset:8192
    s_waitcnt vmcnt(12)
    v_smfmac_f32_16x16x64_bf16 v[128:131], v[56:59], v[204:211], v40 abid:1
    buffer_load_dwordx4 v[104:107], v11, s[16:19], s43 offen offset:3072 sc1
    ds_read_b128 v[228:231], v1 offset:26624
    ds_read_b128 v[232:235], v2 offset:26624
    s_waitcnt vmcnt(12)
    v_smfmac_f32_16x16x64_bf16 v[132:135], v[60:63], v[204:211], v41
    s_add_u32 s43, s43, 4096
    buffer_load_dwordx4 v[108:111], v11, s[16:19], s43 offen offset:0 sc1
    s_waitcnt lgkmcnt(5)
    v_smfmac_f32_16x16x64_bf16 v[152:155], v[240:243], v[244:251], v10
    v_smfmac_f32_16x16x64_bf16 v[188:191], v[240:243], v[244:251], v10 abid:1
    s_waitcnt lgkmcnt(4)
    v_xad_u32 v236, v236, v3, v4
    s_waitcnt vmcnt(12)
    v_xad_u32 v237, v237, v3, v4
    v_smfmac_f32_16x16x64_bf16 v[136:139], v[64:67], v[204:211], v41 abid:1
    buffer_load_dwordx4 v[112:115], v11, s[16:19], s43 offen offset:1024 sc1
    ds_read2st64_b32 v[244:245], v236 offset0:0 offset1:72
    ds_read2st64_b32 v[246:247], v237 offset0:0 offset1:72
    v_xad_u32 v238, v238, v3, v4
    s_waitcnt vmcnt(12)
    v_xad_u32 v239, v239, v3, v4
    v_smfmac_f32_16x16x64_bf16 v[140:143], v[68:71], v[204:211], v42
    buffer_load_dwordx4 v[116:119], v11, s[16:19], s43 offen offset:2048 sc1
    ds_read2st64_b32 v[248:249], v238 offset0:0 offset1:72
    ds_read2st64_b32 v[250:251], v239 offset0:0 offset1:72
    ds_read_b128 v[240:243], v8 offset:5120
    ds_read_b128 v[236:239], v9 offset:9600
    s_waitcnt vmcnt(12)
    v_smfmac_f32_16x16x64_bf16 v[144:147], v[72:75], v[204:211], v42 abid:1
    buffer_load_dwordx4 v[120:123], v11, s[16:19], s43 offen offset:3072 sc1
    s_waitcnt vmcnt(12)
    v_smfmac_f32_16x16x64_bf16 v[148:151], v[76:79], v[204:211], v43
    s_add_u32 m0, s29, 11840
    s_nop 0
    buffer_load_dword v0, s[8:11], 0 offen lds
    s_mov_b32 m0, s42
    s_nop 0
    buffer_load_dwordx4 v5, s[8:11], s22 offen offset:0 nt lds
    s_waitcnt vmcnt(13)
    v_smfmac_f32_16x16x64_bf16 v[152:155], v[80:83], v[204:211], v43 abid:1
    s_add_u32 m0, m0, 896
    s_nop 0
    buffer_load_dwordx4 v5, s[8:11], s22 offen offset:128 nt lds
    s_waitcnt lgkmcnt(1)
    v_smfmac_f32_16x16x64_bf16 v[144:147], v[240:243], v[244:251], v10
    v_smfmac_f32_16x16x64_bf16 v[180:183], v[240:243], v[244:251], v10 abid:1
    s_waitcnt lgkmcnt(0)
    v_xad_u32 v236, v236, v3, v4
    s_waitcnt vmcnt(13)
    v_xad_u32 v237, v237, v3, v4
    v_smfmac_f32_16x16x64_bf16 v[156:159], v[84:87], v[204:211], v51 abid:1
    s_add_u32 m0, m0, 896
    s_nop 0
    buffer_load_dwordx4 v5, s[8:11], s22 offen offset:256 nt lds
    ds_read2st64_b32 v[244:245], v236 offset0:0 offset1:72
    ds_read2st64_b32 v[246:247], v237 offset0:0 offset1:72
    v_xad_u32 v238, v238, v3, v4
    s_waitcnt vmcnt(12)
    v_xad_u32 v239, v239, v3, v4
    v_smfmac_f32_16x16x64_bf16 v[124:127], v[88:91], v[196:203], v44
    s_add_u32 m0, m0, 896
    s_nop 0
    buffer_load_dwordx4 v5, s[8:11], s22 offen offset:384 nt lds
    ds_read2st64_b32 v[248:249], v238 offset0:0 offset1:72
    ds_read2st64_b32 v[250:251], v239 offset0:0 offset1:72
    ds_read_b128 v[240:243], v8 offset:6144
    ds_read_b128 v[236:239], v9 offset:9472
    s_waitcnt vmcnt(12)
    v_smfmac_f32_16x16x64_bf16 v[128:131], v[92:95], v[196:203], v44 abid:1
    s_waitcnt vmcnt(11)
    v_smfmac_f32_16x16x64_bf16 v[132:135], v[96:99], v[196:203], v45
    s_waitcnt vmcnt(10)
    v_smfmac_f32_16x16x64_bf16 v[136:139], v[100:103], v[196:203], v45 abid:1
    s_waitcnt lgkmcnt(1)
    v_smfmac_f32_16x16x64_bf16 v[148:151], v[240:243], v[244:251], v10
    v_smfmac_f32_16x16x64_bf16 v[184:187], v[240:243], v[244:251], v10 abid:1
    s_waitcnt lgkmcnt(0)
    v_xad_u32 v236, v236, v3, v4
    s_waitcnt vmcnt(9)
    v_xad_u32 v237, v237, v3, v4
    v_smfmac_f32_16x16x64_bf16 v[140:143], v[104:107], v[196:203], v46
    ds_read2st64_b32 v[244:245], v236 offset0:0 offset1:72
    ds_read2st64_b32 v[246:247], v237 offset0:0 offset1:72
    v_xad_u32 v238, v238, v3, v4
    s_waitcnt vmcnt(8)
    v_xad_u32 v239, v239, v3, v4
    v_smfmac_f32_16x16x64_bf16 v[144:147], v[108:111], v[196:203], v46 abid:1
    ds_read2st64_b32 v[248:249], v238 offset0:0 offset1:72
    ds_read2st64_b32 v[250:251], v239 offset0:0 offset1:72
    ds_read_b128 v[240:243], v8 offset:4096
    s_waitcnt vmcnt(7)
    v_smfmac_f32_16x16x64_bf16 v[148:151], v[112:115], v[196:203], v47
    s_waitcnt vmcnt(6)
    v_smfmac_f32_16x16x64_bf16 v[152:155], v[116:119], v[196:203], v47 abid:1
    s_waitcnt vmcnt(5)
    v_smfmac_f32_16x16x64_bf16 v[156:159], v[120:123], v[196:203], v52
    s_waitcnt lgkmcnt(0)
    v_smfmac_f32_16x16x64_bf16 v[140:143], v[240:243], v[244:251], v10
    v_smfmac_f32_16x16x64_bf16 v[176:179], v[240:243], v[244:251], v10 abid:1
    s_cmp_gt_u32 s46, s80
    s_cbranch_scc1 M_slow
M_slowr0:
    s_cmp_eq_u32 s20, 0
    s_mov_b32 s31, 1073903880
    s_cselect_b32 s30, 162048, s31
    v_mov_b32 v11, s31
    v_writelane_b32 v11, s30, 0
    v_cvt_pk_bf16_f32 v124, v124, v125
    v_cvt_pk_bf16_f32 v125, v126, v127
    v_cvt_pk_bf16_f32 v126, v128, v129
    v_cvt_pk_bf16_f32 v127, v130, v131
    v_cvt_pk_bf16_f32 v132, v132, v133
    v_cvt_pk_bf16_f32 v133, v134, v135
    v_cvt_pk_bf16_f32 v134, v136, v137
    v_cvt_pk_bf16_f32 v135, v138, v139
    ds_read_b128 v[136:139], v9 offset:10432
    v_cndmask_b32_dpp v128, v124, v132, vcc row_ror:8 row_mask:0xf bank_mask:0xf
    v_cndmask_b32_dpp v129, v125, v133, vcc row_ror:8 row_mask:0xf bank_mask:0xf
    v_cndmask_b32_dpp v130, v126, v134, vcc row_ror:8 row_mask:0xf bank_mask:0xf
    v_cndmask_b32_dpp v131, v127, v135, vcc row_ror:8 row_mask:0xf bank_mask:0xf
    buffer_store_dwordx4 v[128:131], v6, s[12:15], s59 offen offset:0 sc1
    v_mov_b32_dpp v124, v132 row_ror:8 row_mask:0xf bank_mask:0xc
    v_mov_b32_dpp v125, v133 row_ror:8 row_mask:0xf bank_mask:0xc
    v_mov_b32_dpp v126, v134 row_ror:8 row_mask:0xf bank_mask:0xc
    v_mov_b32_dpp v127, v135 row_ror:8 row_mask:0xf bank_mask:0xc
    buffer_store_dwordx4 v[124:127], v6, s[12:15], s24 offen offset:0 sc1
    ds_read_b128 v[128:131], v9 offset:10304
    ds_read_b128 v[132:135], v9 offset:10368
    ds_read_b128 v[124:127], v9 offset:10240
    v_cvt_pk_bf16_f32 v140, v140, v141
    v_cvt_pk_bf16_f32 v141, v142, v143
    v_cvt_pk_bf16_f32 v142, v144, v145
    v_cvt_pk_bf16_f32 v143, v146, v147
    v_cvt_pk_bf16_f32 v148, v148, v149
    v_cvt_pk_bf16_f32 v149, v150, v151
    v_cvt_pk_bf16_f32 v150, v152, v153
    v_cvt_pk_bf16_f32 v151, v154, v155
    ds_read_b128 v[152:155], v9 offset:10688
    v_cndmask_b32_dpp v144, v140, v148, vcc row_ror:8 row_mask:0xf bank_mask:0xf
    v_cndmask_b32_dpp v145, v141, v149, vcc row_ror:8 row_mask:0xf bank_mask:0xf
    v_cndmask_b32_dpp v146, v142, v150, vcc row_ror:8 row_mask:0xf bank_mask:0xf
    v_cndmask_b32_dpp v147, v143, v151, vcc row_ror:8 row_mask:0xf bank_mask:0xf
    buffer_store_dwordx4 v[144:147], v6, s[12:15], s59 offen offset:128 sc1
    v_mov_b32_dpp v140, v148 row_ror:8 row_mask:0xf bank_mask:0xc
    v_mov_b32_dpp v141, v149 row_ror:8 row_mask:0xf bank_mask:0xc
    v_mov_b32_dpp v142, v150 row_ror:8 row_mask:0xf bank_mask:0xc
    v_mov_b32_dpp v143, v151 row_ror:8 row_mask:0xf bank_mask:0xc
    buffer_store_dwordx4 v[140:143], v6, s[12:15], s24 offen offset:128 sc1
    ds_read_b128 v[144:147], v9 offset:10560
    ds_read_b128 v[148:151], v9 offset:10624
    ds_read_b128 v[140:143], v9 offset:10496
    v_cvt_pk_bf16_f32 v156, v156, v157
    v_cvt_pk_bf16_f32 v157, v158, v159
    ds_write_b64 v53, v[156:157] offset:25728
    ds_read_b128 v[156:159], v9 offset:10752
    s_mov_b32 s89, 0
    s_mov_b32 s101, 34209792
    s_mov_b32 s91, 0
    s_mov_b32 s25, 36864
    s_add_u32 s90, s24, 9437184
    s_mov_b32 s28, s26
    s_add_u32 s23, s24, 18432
    s_cmp_lt_u32 s20, 2
    s_cselect_b32 s66, s23, s24
    s_add_u32 s66, s66, s95
    v_add_u32 v4, 36864, v4
    v_add_u32 v1, 36864, v1
    v_add_u32 v2, 36864, v2
M_top:
M_top1:
    s_add_u32 s23, s24, 18432
    s_add_u32 s58, s24, 27648
    s_mov_b32 s24, s90
    s_add_u32 s59, s90, 9216
    s_waitcnt lgkmcnt(0)
    s_barrier
    ds_read_b128 v[244:247], v8 offset:10816
    v_smfmac_f32_16x16x64_bf16 v[160:163], a[252:255], v[220:227], v40
    ds_read_b128 v[196:199], v1 offset:0
    v_smfmac_f32_16x16x64_bf16 v[160:163], v[88:91], v[228:235], v44
    ds_read_b128 v[200:203], v2 offset:0
    s_cmp_lt_u32 s22, 75497472
    s_cbranch_scc0 M_bF
    s_cmp_lt_u32 s91, 2
    s_cbranch_scc1 M_bE0
M_bL:
    v_smfmac_f32_16x16x64_bf16 v[164:167], v[56:59], v[220:227], v40 abid:1
    ds_read_b128 v[204:207], v1 offset:1024
    v_smfmac_f32_16x16x64_bf16 v[164:167], v[92:95], v[228:235], v44 abid:1
    ds_read_b128 v[208:211], v2 offset:1024
    v_mov_b32 v0, 1
    v_smfmac_f32_16x16x64_bf16 v[168:171], v[60:63], v[220:227], v41
    ds_read_b128 v[212:215], v1 offset:2048
    v_smfmac_f32_16x16x64_bf16 v[168:171], v[96:99], v[228:235], v45
    ds_read_b128 v[216:219], v2 offset:2048
    v_smfmac_f32_16x16x64_bf16 v[172:175], v[64:67], v[220:227], v41 abid:1
    s_waitcnt vmcnt(6)
    s_waitcnt lgkmcnt(6)
    buffer_store_dwordx4 v[244:247], v7, s[12:15], s66 offen sc1
    v_smfmac_f32_16x16x64_bf16 v[172:175], v[100:103], v[228:235], v45 abid:1
    ds_read_b128 v[236:239], v9 offset:9408
    v_smfmac_f32_16x16x64_bf16 v[176:179], v[68:71], v[220:227], v42
    s_waitcnt vmcnt(7)
    buffer_atomic_add v0, v11, s[16:19], s92 offen sc0 sc1
    s_mov_b32 s21, 1
    v_smfmac_f32_16x16x64_bf16 v[176:179], v[104:107], v[228:235], v46
    v_smfmac_f32_16x16x64_bf16 v[180:183], v[72:75], v[220:227], v42 abid:1
    v_cvt_pk_bf16_f32 v160, v160, v161
    v_smfmac_f32_16x16x64_bf16 v[180:183], v[108:111], v[228:235], v46 abid:1
    v_cvt_pk_bf16_f32 v161, v162, v163
    v_smfmac_f32_16x16x64_bf16 v[184:187], v[76:79], v[220:227], v43
    v_cvt_pk_bf16_f32 v162, v164, v165
    v_smfmac_f32_16x16x64_bf16 v[184:187], v[112:115], v[228:235], v47
    v_cvt_pk_bf16_f32 v163, v166, v167
    v_smfmac_f32_16x16x64_bf16 v[188:191], v[80:83], v[220:227], v43 abid:1
    s_add_u32 m0, m0, 896
    v_cvt_pk_bf16_f32 v168, v168, v169
    v_smfmac_f32_16x16x64_bf16 v[188:191], v[116:119], v[228:235], v47 abid:1
    s_waitcnt vmcnt(6)
    buffer_load_dwordx4 v5, s[8:11], s22 offen offset:512 nt lds
    v_cvt_pk_bf16_f32 v169, v170, v171
    v_smfmac_f32_16x16x64_bf16 v[192:195], v[84:87], v[220:227], v51 abid:1
    v_cvt_pk_bf16_f32 v170, v172, v173
    v_smfmac_f32_16x16x64_bf16 v[192:195], v[120:123], v[228:235], v52
    ds_read_b128 v[220:223], v1 offset:3072
    s_waitcnt lgkmcnt(6)
    v_cvt_pk_bf16_f32 v171, v174, v175
    v_smfmac_f32_16x16x64_bf16 v[124:127], a[0:3], v[196:203], v12
    ds_read_b128 v[224:227], v2 offset:3072
    ds_read_b128 v[172:175], v9 offset:10432
    s_waitcnt lgkmcnt(6)
    v_cndmask_b32_dpp v164, v160, v168, vcc row_ror:8 row_mask:0xf bank_mask:0xf
    v_smfmac_f32_16x16x64_bf16 v[124:127], a[36:39], v[204:211], v16
    ds_read_b128 v[228:231], v1 offset:4096
    s_waitcnt lgkmcnt(5)
    v_cndmask_b32_dpp v165, v161, v169, vcc row_ror:8 row_mask:0xf bank_mask:0xf
    v_smfmac_f32_16x16x64_bf16 v[124:127], a[72:75], v[212:219], v20
    ds_read_b128 v[232:235], v2 offset:4096
    v_cndmask_b32_dpp v166, v162, v170, vcc row_ror:8 row_mask:0xf bank_mask:0xf
    v_smfmac_f32_16x16x64_bf16 v[128:131], a[4:7], v[196:203], v12 abid:1
    s_barrier
    v_cndmask_b32_dpp v167, v163, v171, vcc row_ror:8 row_mask:0xf bank_mask:0xf
    v_smfmac_f32_16x16x64_bf16 v[128:131], a[40:43], v[204:211], v16 abid:1
    s_waitcnt vmcnt(7)
    buffer_store_dwordx4 v[164:167], v6, s[12:15], s58 offen offset:0 sc1
    s_waitcnt lgkmcnt(5)
    v_xad_u32 v236, v236, v3, v4
    v_smfmac_f32_16x16x64_bf16 v[128:131], a[76:79], v[212:219], v20 abid:1
    v_xad_u32 v237, v237, v3, v4
    v_smfmac_f32_16x16x64_bf16 v[132:135], a[8:11], v[196:203], v13
    ds_read2st64_b32 v[244:245], v236 offset0:0 offset1:72
    ds_read_b128 v[240:243], v8 offset:3072
    v_xad_u32 v238, v238, v3, v4
    v_smfmac_f32_16x16x64_bf16 v[132:135], a[44:47], v[204:211], v17
    ds_read2st64_b32 v[246:247], v237 offset0:0 offset1:72
    v_xad_u32 v239, v239, v3, v4
    v_smfmac_f32_16x16x64_bf16 v[132:135], a[80:83], v[212:219], v21
    ds_read2st64_b32 v[248:249], v238 offset0:0 offset1:72
    v_mov_b32_dpp v160, v168 row_ror:8 row_mask:0xf bank_mask:0xc
    v_smfmac_f32_16x16x64_bf16 v[144:147], a[20:23], v[196:203], v14 abid:1
    ds_read2st64_b32 v[250:251], v239 offset0:0 offset1:72
    ds_read_b128 v[236:239], v9 offset:9280
    v_mov_b32_dpp v161, v169 row_ror:8 row_mask:0xf bank_mask:0xc
    v_smfmac_f32_16x16x64_bf16 v[144:147], a[56:59], v[204:211], v18 abid:1
    v_mov_b32_dpp v162, v170 row_ror:8 row_mask:0xf bank_mask:0xc
    v_smfmac_f32_16x16x64_bf16 v[144:147], a[92:95], v[212:219], v22 abid:1
    v_mov_b32_dpp v163, v171 row_ror:8 row_mask:0xf bank_mask:0xc
    v_smfmac_f32_16x16x64_bf16 v[140:143], a[16:19], v[196:203], v14
    s_waitcnt vmcnt(6)
    buffer_store_dwordx4 v[160:163], v6, s[12:15], s23 offen offset:0 sc1
    ds_read_b128 v[164:167], v9 offset:10304
    v_smfmac_f32_16x16x64_bf16 v[140:143], a[52:55], v[204:211], v18
    ds_read_b128 v[168:171], v9 offset:10368
    ds_read_b128 v[160:163], v9 offset:10240
    v_smfmac_f32_16x16x64_bf16 v[140:143], a[88:91], v[212:219], v22
    v_smfmac_f32_16x16x64_bf16 v[136:139], a[12:15], v[196:203], v13 abid:1
    v_smfmac_f32_16x16x64_bf16 v[136:139], a[48:51], v[204:211], v17 abid:1
    v_smfmac_f32_16x16x64_bf16 v[136:139], a[84:87], v[212:219], v21 abid:1
    s_waitcnt lgkmcnt(3)
    v_xad_u32 v236, v236, v3, v4
    v_smfmac_f32_16x16x64_bf16 v[136:139], v[240:243], v[244:251], v10
    v_xad_u32 v237, v237, v3, v4
    v_smfmac_f32_16x16x64_bf16 v[172:175], v[240:243], v[244:251], v10 abid:1
    ds_read2st64_b32 v[244:245], v236 offset0:0 offset1:72
    ds_read_b128 v[240:243], v8 offset:1024
    v_xad_u32 v238, v238, v3, v4
    v_smfmac_f32_16x16x64_bf16 v[148:151], a[24:27], v[196:203], v15
    ds_read2st64_b32 v[246:247], v237 offset0:0 offset1:72
    v_xad_u32 v239, v239, v3, v4
    v_smfmac_f32_16x16x64_bf16 v[148:151], a[60:63], v[204:211], v19
    ds_read2st64_b32 v[248:249], v238 offset0:0 offset1:72
    v_cvt_pk_bf16_f32 v192, v192, v193
    v_smfmac_f32_16x16x64_bf16 v[148:151], a[96:99], v[212:219], v23
    ds_read2st64_b32 v[250:251], v239 offset0:0 offset1:72
    ds_read_b128 v[236:239], v9 offset:9344
    v_cvt_pk_bf16_f32 v193, v194, v195
    v_smfmac_f32_16x16x64_bf16 v[152:155], a[28:31], v[196:203], v15 abid:1
    ds_write_b64 v53, v[192:193] offset:0
    ds_read_b128 v[192:195], v9 offset:10752
    v_smfmac_f32_16x16x64_bf16 v[152:155], a[64:67], v[204:211], v19 abid:1
    s_add_u32 m0, m0, 896
    v_smfmac_f32_16x16x64_bf16 v[152:155], a[100:103], v[212:219], v23 abid:1
    s_waitcnt vmcnt(7)
    buffer_load_dwordx4 v5, s[8:11], s22 offen offset:640 nt lds
    v_smfmac_f32_16x16x64_bf16 v[156:159], a[32:35], v[196:203], v48
    v_smfmac_f32_16x16x64_bf16 v[156:159], a[68:71], v[204:211], v48 abid:1
    v_smfmac_f32_16x16x64_bf16 v[156:159], a[104:107], v[212:219], v49
    ds_read_b128 v[196:199], v1 offset:5120
    v_cvt_pk_bf16_f32 v176, v176, v177
    v_smfmac_f32_16x16x64_bf16 v[124:127], a[108:111], v[220:227], v24
    ds_read_b128 v[200:203], v2 offset:5120
    v_cvt_pk_bf16_f32 v177, v178, v179
    v_smfmac_f32_16x16x64_bf16 v[124:127], a[144:147], v[228:235], v28
    ds_read_b128 v[204:207], v1 offset:6144
    ds_read_b64 v[216:217], v9 offset:10056
    v_cvt_pk_bf16_f32 v178, v180, v181
    v_smfmac_f32_16x16x64_bf16 v[128:131], a[112:115], v[220:227], v24 abid:1
    ds_read_b128 v[208:211], v2 offset:6144
    v_cvt_pk_bf16_f32 v179, v182, v183
    v_smfmac_f32_16x16x64_bf16 v[128:131], a[148:151], v[228:235], v28 abid:1
    s_waitcnt lgkmcnt(7)
    v_xad_u32 v236, v236, v3, v4
    v_smfmac_f32_16x16x64_bf16 v[128:131], v[240:243], v[244:251], v10
    s_add_u32 m0, m0, 896
    v_xad_u32 v237, v237, v3, v4
    v_smfmac_f32_16x16x64_bf16 v[164:167], v[240:243], v[244:251], v10 abid:1
    ds_read2st64_b32 v[244:245], v236 offset0:0 offset1:72
    ds_read_b128 v[240:243], v8 offset:2048
    v_xad_u32 v238, v238, v3, v4
    v_smfmac_f32_16x16x64_bf16 v[152:155], a[136:139], v[220:227], v27 abid:1
    ds_read2st64_b32 v[246:247], v237 offset0:0 offset1:72
    s_waitcnt vmcnt(6)
    v_xad_u32 v239, v239, v3, v4
    v_smfmac_f32_16x16x64_bf16 v[152:155], a[172:175], v[228:235], v31 abid:1
    ds_read2st64_b32 v[248:249], v238 offset0:0 offset1:72
    buffer_load_dwordx4 v5, s[8:11], s22 offen offset:768 nt lds
    v_cvt_pk_bf16_f32 v184, v184, v185
    v_smfmac_f32_16x16x64_bf16 v[136:139], a[120:123], v[220:227], v25 abid:1
    ds_read2st64_b32 v[250:251], v239 offset0:0 offset1:72
    ds_read_b128 v[236:239], v9 offset:9216
    v_cvt_pk_bf16_f32 v185, v186, v187
    v_smfmac_f32_16x16x64_bf16 v[136:139], a[156:159], v[228:235], v29 abid:1
    v_cvt_pk_bf16_f32 v186, v188, v189
    v_smfmac_f32_16x16x64_bf16 v[140:143], a[124:127], v[220:227], v26
    v_cvt_pk_bf16_f32 v187, v190, v191
    v_smfmac_f32_16x16x64_bf16 v[140:143], a[160:163], v[228:235], v30
    ds_read_b128 v[188:191], v9 offset:10688
    v_cndmask_b32_dpp v180, v176, v184, vcc row_ror:8 row_mask:0xf bank_mask:0xf
    v_smfmac_f32_16x16x64_bf16 v[144:147], a[128:131], v[220:227], v26 abid:1
    v_cndmask_b32_dpp v181, v177, v185, vcc row_ror:8 row_mask:0xf bank_mask:0xf
    v_smfmac_f32_16x16x64_bf16 v[144:147], a[164:167], v[228:235], v30 abid:1
    v_cndmask_b32_dpp v182, v178, v186, vcc row_ror:8 row_mask:0xf bank_mask:0xf
    v_smfmac_f32_16x16x64_bf16 v[148:151], a[132:135], v[220:227], v27
    v_cndmask_b32_dpp v183, v179, v187, vcc row_ror:8 row_mask:0xf bank_mask:0xf
    v_smfmac_f32_16x16x64_bf16 v[148:151], a[168:171], v[228:235], v31
    s_waitcnt vmcnt(7)
    buffer_store_dwordx4 v[180:183], v6, s[12:15], s58 offen offset:128 sc1
    v_mov_b32_dpp v176, v184 row_ror:8 row_mask:0xf bank_mask:0xc
    v_smfmac_f32_16x16x64_bf16 v[132:135], a[116:119], v[220:227], v25
    v_mov_b32_dpp v177, v185 row_ror:8 row_mask:0xf bank_mask:0xc
    v_smfmac_f32_16x16x64_bf16 v[132:135], a[152:155], v[228:235], v29
    s_waitcnt lgkmcnt(1)
    v_xad_u32 v236, v236, v3, v4
    v_smfmac_f32_16x16x64_bf16 v[132:135], v[240:243], v[244:251], v10
    v_xad_u32 v237, v237, v3, v4
    v_smfmac_f32_16x16x64_bf16 v[168:171], v[240:243], v[244:251], v10 abid:1
    ds_read2st64_b32 v[244:245], v236 offset0:0 offset1:72
    ds_read_b128 v[240:243], v8 offset:0
    v_xad_u32 v238, v238, v3, v4
    v_smfmac_f32_16x16x64_bf16 v[156:159], a[140:143], v[220:227], v49 abid:1
    ds_read2st64_b32 v[246:247], v237 offset0:0 offset1:72
    v_xad_u32 v239, v239, v3, v4
    v_smfmac_f32_16x16x64_bf16 v[156:159], a[176:179], v[228:235], v50
    ds_read2st64_b32 v[248:249], v238 offset0:0 offset1:72
    ds_read_b128 v[220:223], v1 offset:7168
    v_mov_b32_dpp v178, v186 row_ror:8 row_mask:0xf bank_mask:0xc
    v_smfmac_f32_16x16x64_bf16 v[140:143], a[196:199], v[196:203], v34
    ds_read2st64_b32 v[250:251], v239 offset0:0 offset1:72
    ds_read_b128 v[236:239], v9 offset:9728
    v_mov_b32_dpp v179, v187 row_ror:8 row_mask:0xf bank_mask:0xc
    v_smfmac_f32_16x16x64_bf16 v[140:143], a[232:235], v[204:211], v38
    ds_read_b128 v[224:227], v2 offset:7168
    s_waitcnt vmcnt(6)
    buffer_store_dwordx4 v[176:179], v6, s[12:15], s23 offen offset:128 sc1
    v_smfmac_f32_16x16x64_bf16 v[128:131], a[184:187], v[196:203], v32 abid:1
    ds_read_b128 v[228:231], v1 offset:8192
    ds_read_b128 v[180:183], v9 offset:10560
    ds_read_b128 v[184:187], v9 offset:10624
    v_smfmac_f32_16x16x64_bf16 v[128:131], a[220:223], v[204:211], v36 abid:1
    ds_read_b128 v[232:235], v2 offset:8192
    ds_read_b128 v[176:179], v9 offset:10496
    v_xad_u32 v212, v216, v3, v4
    v_smfmac_f32_16x16x64_bf16 v[132:135], a[188:191], v[196:203], v33
    ds_read2st64_b32 v[212:213], v212 offset0:0 offset1:72
    v_xad_u32 v214, v217, v3, v4
    v_smfmac_f32_16x16x64_bf16 v[132:135], a[224:227], v[204:211], v37
    ds_read2st64_b32 v[214:215], v214 offset0:0 offset1:72
    v_smfmac_f32_16x16x64_bf16 v[136:139], a[192:195], v[196:203], v33 abid:1
    v_smfmac_f32_16x16x64_bf16 v[136:139], a[228:231], v[204:211], v37 abid:1
    v_smfmac_f32_16x16x64_bf16 v[124:127], a[180:183], v[196:203], v32
    v_smfmac_f32_16x16x64_bf16 v[124:127], a[216:219], v[204:211], v36
    s_waitcnt vmcnt(7)
    s_waitcnt lgkmcnt(8)
    v_xad_u32 v236, v236, v3, v4
    v_smfmac_f32_16x16x64_bf16 v[124:127], v[240:243], v[244:251], v10
    v_xad_u32 v237, v237, v3, v4
    v_smfmac_f32_16x16x64_bf16 v[160:163], v[240:243], v[244:251], v10 abid:1
    ds_read2st64_b32 v[244:245], v236 offset0:0 offset1:72
    ds_read_b128 v[240:243], v8 offset:8192
    v_xad_u32 v238, v238, v3, v4
    v_smfmac_f32_16x16x64_bf16 v[144:147], a[200:203], v[196:203], v34 abid:1
    ds_read2st64_b32 v[246:247], v237 offset0:0 offset1:72
    v_xad_u32 v239, v239, v3, v4
    v_smfmac_f32_16x16x64_bf16 v[144:147], a[236:239], v[204:211], v38 abid:1
    ds_read2st64_b32 v[248:249], v238 offset0:0 offset1:72
    v_mul_u32_u24 v0, s94, v0
    v_smfmac_f32_16x16x64_bf16 v[148:151], a[204:207], v[196:203], v35
    ds_read2st64_b32 v[250:251], v239 offset0:0 offset1:72
    ds_read_b128 v[236:239], v9 offset:9664
    v_add_u32 v0, s93, v0
    v_smfmac_f32_16x16x64_bf16 v[148:151], a[240:243], v[204:211], v39
    s_add_u32 m0, m0, 896
    v_min_u32 v0, 75497472, v0
    v_smfmac_f32_16x16x64_bf16 v[152:155], a[208:211], v[196:203], v35 abid:1
    ds_write_b32 v11, v0
    s_waitcnt vmcnt(7)
    v_mov_b32 v0, 162048
    v_smfmac_f32_16x16x64_bf16 v[152:155], a[244:247], v[204:211], v39 abid:1
    buffer_load_dwordx4 v5, s[8:11], s22 offen offset:896 nt lds
    v_smfmac_f32_16x16x64_bf16 v[156:159], a[212:215], v[196:203], v50 abid:1
    s_waitcnt lgkmcnt(7)
    s_cmp_lt_i32 s81, 0
    s_cbranch_scc1 M_ovrL
    s_swappc_b64 s[78:79], s[72:73]
M_ovrL:
    v_smfmac_f32_16x16x64_bf16 v[156:159], a[248:251], v[204:211], v51
    ds_read_b128 v[196:199], v1 offset:18432
    v_smfmac_f32_16x16x64_bf16 v[124:127], a[252:255], v[220:227], v40
    ds_read_b128 v[200:203], v2 offset:18432
    v_smfmac_f32_16x16x64_bf16 v[124:127], v[88:91], v[228:235], v44
    ds_read_b128 v[204:207], v1 offset:19456
    v_smfmac_f32_16x16x64_bf16 v[156:159], v[84:87], v[220:227], v51 abid:1
    ds_read_b128 v[208:211], v2 offset:19456
    v_smfmac_f32_16x16x64_bf16 v[156:159], v[120:123], v[228:235], v52
    s_waitcnt lgkmcnt(4)
    s_barrier
    v_xad_u32 v236, v236, v3, v4
    v_smfmac_f32_16x16x64_bf16 v[156:159], v[240:243], v[244:251], v10
    ds_read_b32 v0, v0
    v_xad_u32 v237, v237, v3, v4
    v_smfmac_f32_16x16x64_bf16 v[192:195], v[240:243], v[244:251], v10 abid:1
    ds_read2st64_b32 v[244:245], v236 offset0:0 offset1:72
    ds_read_b128 v[240:243], v8 offset:7168
    v_xad_u32 v238, v238, v3, v4
    v_smfmac_f32_16x16x64_bf16 v[132:135], v[60:63], v[220:227], v41
    ds_read2st64_b32 v[246:247], v237 offset0:0 offset1:72
    v_xad_u32 v239, v239, v3, v4
    v_smfmac_f32_16x16x64_bf16 v[132:135], v[96:99], v[228:235], v45
    ds_read2st64_b32 v[248:249], v238 offset0:0 offset1:72
    s_add_u32 m0, m0, 896
    v_smfmac_f32_16x16x64_bf16 v[136:139], v[64:67], v[220:227], v41 abid:1
    ds_read2st64_b32 v[250:251], v239 offset0:0 offset1:72
    ds_read_b128 v[236:239], v9 offset:9536
    s_waitcnt vmcnt(6)
    v_smfmac_f32_16x16x64_bf16 v[136:139], v[100:103], v[228:235], v45 abid:1
    buffer_load_dwordx4 v5, s[8:11], s22 offen offset:1024 nt lds
    s_waitcnt lgkmcnt(6)
    v_readfirstlane_b32 s88, v0
    v_smfmac_f32_16x16x64_bf16 v[140:143], v[68:71], v[220:227], v42
    s_cmp_lt_u32 s88, 75497472
    s_cselect_b32 s10, 75497472, 0
    v_smfmac_f32_16x16x64_bf16 v[140:143], v[104:107], v[228:235], v46
    v_smfmac_f32_16x16x64_bf16 v[144:147], v[72:75], v[220:227], v42 abid:1
    ds_read_b128 v[212:215], v1 offset:20480
    v_smfmac_f32_16x16x64_bf16 v[144:147], v[108:111], v[228:235], v46 abid:1
    ds_read_b128 v[216:219], v2 offset:20480
    v_smfmac_f32_16x16x64_bf16 v[148:151], v[76:79], v[220:227], v43
    v_smfmac_f32_16x16x64_bf16 v[148:151], v[112:115], v[228:235], v47
    v_smfmac_f32_16x16x64_bf16 v[152:155], v[80:83], v[220:227], v43 abid:1
    v_smfmac_f32_16x16x64_bf16 v[152:155], v[116:119], v[228:235], v47 abid:1
    s_waitcnt lgkmcnt(2)
    v_xad_u32 v236, v236, v3, v4
    v_smfmac_f32_16x16x64_bf16 v[152:155], v[240:243], v[244:251], v10
    v_xad_u32 v237, v237, v3, v4
    v_smfmac_f32_16x16x64_bf16 v[188:191], v[240:243], v[244:251], v10 abid:1
    s_cmp_gt_u32 s46, s80
    s_cbranch_scc1 M_slow
M_slowrL:
    v_xad_u32 v238, v238, v3, v4
    v_smfmac_f32_16x16x64_bf16 v[128:131], v[56:59], v[220:227], v40 abid:1
    ds_read2st64_b32 v[244:245], v236 offset0:0 offset1:72
    ds_read_b128 v[240:243], v8 offset:5120
    v_xad_u32 v239, v239, v3, v4
    v_smfmac_f32_16x16x64_bf16 v[128:131], v[92:95], v[228:235], v44 abid:1
    ds_read2st64_b32 v[246:247], v237 offset0:0 offset1:72
    ds_read_b128 v[220:223], v1 offset:21504
    v_smfmac_f32_16x16x64_bf16 v[160:163], a[0:3], v[196:203], v12
    ds_read2st64_b32 v[248:249], v238 offset0:0 offset1:72
    ds_read_b128 v[224:227], v2 offset:21504
    v_smfmac_f32_16x16x64_bf16 v[160:163], a[36:39], v[204:211], v16
    ds_read2st64_b32 v[250:251], v239 offset0:0 offset1:72
    ds_read_b128 v[236:239], v9 offset:9600
    s_waitcnt lgkmcnt(8)
    v_smfmac_f32_16x16x64_bf16 v[160:163], a[72:75], v[212:219], v20
    ds_read_b128 v[228:231], v1 offset:22528
    v_smfmac_f32_16x16x64_bf16 v[164:167], a[4:7], v[196:203], v12 abid:1
    ds_read_b128 v[232:235], v2 offset:22528
    v_cvt_pk_bf16_f32 v156, v156, v157
    v_smfmac_f32_16x16x64_bf16 v[164:167], a[40:43], v[204:211], v16 abid:1
    s_mov_b32 m0, s28
    v_cvt_pk_bf16_f32 v157, v158, v159
    v_smfmac_f32_16x16x64_bf16 v[164:167], a[76:79], v[212:219], v20 abid:1
    ds_write_b64 v53, v[156:157] offset:25728
    ds_read_b128 v[156:159], v9 offset:10752
    s_waitcnt vmcnt(7)
    v_smfmac_f32_16x16x64_bf16 v[180:183], a[20:23], v[196:203], v14 abid:1
    buffer_load_dwordx4 v5, s[8:11], s88 offen offset:0 nt lds
    v_smfmac_f32_16x16x64_bf16 v[180:183], a[56:59], v[204:211], v18 abid:1
    v_cvt_pk_bf16_f32 v124, v124, v125
    v_smfmac_f32_16x16x64_bf16 v[180:183], a[92:95], v[212:219], v22 abid:1
    s_waitcnt lgkmcnt(4)
    v_xad_u32 v236, v236, v3, v4
    v_smfmac_f32_16x16x64_bf16 v[180:183], v[240:243], v[244:251], v10 abid:1
    v_xad_u32 v237, v237, v3, v4
    v_smfmac_f32_16x16x64_bf16 v[144:147], v[240:243], v[244:251], v10
    ds_read2st64_b32 v[244:245], v236 offset0:0 offset1:72
    ds_read_b128 v[240:243], v8 offset:6144
    v_xad_u32 v238, v238, v3, v4
    v_smfmac_f32_16x16x64_bf16 v[172:175], a[12:15], v[196:203], v13 abid:1
    ds_read2st64_b32 v[246:247], v237 offset0:0 offset1:72
    v_xad_u32 v239, v239, v3, v4
    v_smfmac_f32_16x16x64_bf16 v[172:175], a[48:51], v[204:211], v17 abid:1
    ds_read2st64_b32 v[248:249], v238 offset0:0 offset1:72
    v_cvt_pk_bf16_f32 v125, v126, v127
    v_smfmac_f32_16x16x64_bf16 v[172:175], a[84:87], v[212:219], v21 abid:1
    ds_read2st64_b32 v[250:251], v239 offset0:0 offset1:72
    ds_read_b128 v[236:239], v9 offset:9472
    v_cvt_pk_bf16_f32 v126, v128, v129
    v_smfmac_f32_16x16x64_bf16 v[176:179], a[16:19], v[196:203], v14
    v_cvt_pk_bf16_f32 v127, v130, v131
    v_smfmac_f32_16x16x64_bf16 v[176:179], a[52:55], v[204:211], v18
    v_cvt_pk_bf16_f32 v132, v132, v133
    v_smfmac_f32_16x16x64_bf16 v[176:179], a[88:91], v[212:219], v22
    v_cvt_pk_bf16_f32 v133, v134, v135
    v_smfmac_f32_16x16x64_bf16 v[168:171], a[8:11], v[196:203], v13
    s_add_u32 m0, m0, 896
    v_cvt_pk_bf16_f32 v134, v136, v137
    v_smfmac_f32_16x16x64_bf16 v[168:171], a[44:47], v[204:211], v17
    s_waitcnt vmcnt(6)
    buffer_load_dwordx4 v5, s[8:11], s88 offen offset:128 nt lds
    v_cvt_pk_bf16_f32 v135, v138, v139
    v_smfmac_f32_16x16x64_bf16 v[168:171], a[80:83], v[212:219], v21
    ds_read_b128 v[136:139], v9 offset:10432
    v_cndmask_b32_dpp v128, v124, v132, vcc row_ror:8 row_mask:0xf bank_mask:0xf
    v_smfmac_f32_16x16x64_bf16 v[184:187], a[24:27], v[196:203], v15
    v_cndmask_b32_dpp v129, v125, v133, vcc row_ror:8 row_mask:0xf bank_mask:0xf
    v_smfmac_f32_16x16x64_bf16 v[184:187], a[60:63], v[204:211], v19
    v_cndmask_b32_dpp v130, v126, v134, vcc row_ror:8 row_mask:0xf bank_mask:0xf
    v_smfmac_f32_16x16x64_bf16 v[184:187], a[96:99], v[212:219], v23
    s_waitcnt lgkmcnt(1)
    v_xad_u32 v236, v236, v3, v4
    v_smfmac_f32_16x16x64_bf16 v[184:187], v[240:243], v[244:251], v10 abid:1
    v_xad_u32 v237, v237, v3, v4
    v_smfmac_f32_16x16x64_bf16 v[148:151], v[240:243], v[244:251], v10
    ds_read2st64_b32 v[244:245], v236 offset0:0 offset1:72
    ds_read_b128 v[240:243], v8 offset:4096
    v_xad_u32 v238, v238, v3, v4
    v_smfmac_f32_16x16x64_bf16 v[188:191], a[28:31], v[196:203], v15 abid:1
    ds_read2st64_b32 v[246:247], v237 offset0:0 offset1:72
    v_xad_u32 v239, v239, v3, v4
    v_smfmac_f32_16x16x64_bf16 v[188:191], a[64:67], v[204:211], v19 abid:1
    ds_read2st64_b32 v[248:249], v238 offset0:0 offset1:72
    v_cndmask_b32_dpp v131, v127, v135, vcc row_ror:8 row_mask:0xf bank_mask:0xf
    v_smfmac_f32_16x16x64_bf16 v[188:191], a[100:103], v[212:219], v23 abid:1
    ds_read2st64_b32 v[250:251], v239 offset0:0 offset1:72
    s_waitcnt vmcnt(7)
    buffer_store_dwordx4 v[128:131], v6, s[12:15], s59 offen offset:0 sc1
    v_smfmac_f32_16x16x64_bf16 v[192:195], a[32:35], v[196:203], v48
    v_mov_b32_dpp v124, v132 row_ror:8 row_mask:0xf bank_mask:0xc
    v_smfmac_f32_16x16x64_bf16 v[192:195], a[68:71], v[204:211], v48 abid:1
    v_mov_b32_dpp v125, v133 row_ror:8 row_mask:0xf bank_mask:0xc
    v_smfmac_f32_16x16x64_bf16 v[192:195], a[104:107], v[212:219], v49
    ds_read_b128 v[196:199], v1 offset:23552
    v_mov_b32_dpp v126, v134 row_ror:8 row_mask:0xf bank_mask:0xc
    v_smfmac_f32_16x16x64_bf16 v[160:163], a[108:111], v[220:227], v24
    ds_read_b128 v[200:203], v2 offset:23552
    v_mov_b32_dpp v127, v135 row_ror:8 row_mask:0xf bank_mask:0xc
    v_smfmac_f32_16x16x64_bf16 v[160:163], a[144:147], v[228:235], v28
    ds_read_b128 v[204:207], v1 offset:24576
    s_waitcnt vmcnt(6)
    buffer_store_dwordx4 v[124:127], v6, s[12:15], s24 offen offset:0 sc1
    v_smfmac_f32_16x16x64_bf16 v[164:167], a[112:115], v[220:227], v24 abid:1
    ds_read_b128 v[208:211], v2 offset:24576
    ds_read_b128 v[128:131], v9 offset:10304
    ds_read_b128 v[132:135], v9 offset:10368
    v_smfmac_f32_16x16x64_bf16 v[164:167], a[148:151], v[228:235], v28 abid:1
    ds_read_b128 v[124:127], v9 offset:10240
    v_smfmac_f32_16x16x64_bf16 v[176:179], a[124:127], v[220:227], v26
    v_smfmac_f32_16x16x64_bf16 v[176:179], a[160:163], v[228:235], v30
    s_waitcnt lgkmcnt(7)
    v_smfmac_f32_16x16x64_bf16 v[176:179], v[240:243], v[244:251], v10 abid:1
    v_smfmac_f32_16x16x64_bf16 v[140:143], v[240:243], v[244:251], v10
    v_smfmac_f32_16x16x64_bf16 v[172:175], a[120:123], v[220:227], v25 abid:1
    s_add_u32 s28, s28, 36864
    s_cmp_ge_u32 s28, 110592
    s_cselect_b32 s28, s26, s28
    v_smfmac_f32_16x16x64_bf16 v[172:175], a[156:159], v[228:235], v29 abid:1
    s_add_u32 s30, s25, 36864
    s_cmp_eq_u32 s30, 110592
    s_cselect_b32 s30, 0, s30
    v_smfmac_f32_16x16x64_bf16 v[168:171], a[116:119], v[220:227], v25
    s_sub_u32 s31, s30, s25
    s_mov_b32 s25, s30
    s_mov_b32 s90, s22
    v_smfmac_f32_16x16x64_bf16 v[168:171], a[152:155], v[228:235], v29
    s_mov_b32 s22, s88
    s_add_u32 s91, s91, 1
    s_cmp_lt_u32 s20, 2
    v_smfmac_f32_16x16x64_bf16 v[180:183], a[128:131], v[220:227], v26 abid:1
    s_cselect_b32 s66, s23, s24
    s_add_u32 s66, s66, s95
    v_smfmac_f32_16x16x64_bf16 v[180:183], a[164:167], v[228:235], v30 abid:1
    v_cvt_pk_bf16_f32 v140, v140, v141
    v_smfmac_f32_16x16x64_bf16 v[184:187], a[132:135], v[220:227], v27
    s_add_u32 m0, m0, 896
    v_cvt_pk_bf16_f32 v141, v142, v143
    v_smfmac_f32_16x16x64_bf16 v[184:187], a[168:171], v[228:235], v31
    s_waitcnt vmcnt(7)
    buffer_load_dwordx4 v5, s[8:11], s88 offen offset:256 nt lds
    v_cvt_pk_bf16_f32 v142, v144, v145
    v_smfmac_f32_16x16x64_bf16 v[188:191], a[136:139], v[220:227], v27 abid:1
    v_cvt_pk_bf16_f32 v143, v146, v147
    v_smfmac_f32_16x16x64_bf16 v[188:191], a[172:175], v[228:235], v31 abid:1
    v_cvt_pk_bf16_f32 v148, v148, v149
    v_smfmac_f32_16x16x64_bf16 v[192:195], a[140:143], v[220:227], v49 abid:1
    v_cvt_pk_bf16_f32 v149, v150, v151
    v_smfmac_f32_16x16x64_bf16 v[192:195], a[176:179], v[228:235], v50
    ds_read_b128 v[220:223], v1 offset:25600
    s_waitcnt lgkmcnt(6)
    v_cvt_pk_bf16_f32 v150, v152, v153
    v_smfmac_f32_16x16x64_bf16 v[160:163], a[180:183], v[196:203], v32
    ds_read_b128 v[224:227], v2 offset:25600
    s_waitcnt lgkmcnt(5)
    v_cvt_pk_bf16_f32 v151, v154, v155
    v_smfmac_f32_16x16x64_bf16 v[160:163], a[216:219], v[204:211], v36
    ds_read_b128 v[228:231], v1 offset:26624
    ds_read_b128 v[152:155], v9 offset:10688
    v_cndmask_b32_dpp v144, v140, v148, vcc row_ror:8 row_mask:0xf bank_mask:0xf
    v_smfmac_f32_16x16x64_bf16 v[164:167], a[184:187], v[196:203], v32 abid:1
    ds_read_b128 v[232:235], v2 offset:26624
    v_cndmask_b32_dpp v145, v141, v149, vcc row_ror:8 row_mask:0xf bank_mask:0xf
    v_smfmac_f32_16x16x64_bf16 v[164:167], a[220:223], v[204:211], v36 abid:1
    s_add_u32 m0, m0, 896
    v_cndmask_b32_dpp v146, v142, v150, vcc row_ror:8 row_mask:0xf bank_mask:0xf
    v_smfmac_f32_16x16x64_bf16 v[168:171], a[188:191], v[196:203], v33
    s_waitcnt vmcnt(6)
    buffer_load_dwordx4 v5, s[8:11], s88 offen offset:384 nt lds
    v_cndmask_b32_dpp v147, v143, v151, vcc row_ror:8 row_mask:0xf bank_mask:0xf
    v_smfmac_f32_16x16x64_bf16 v[168:171], a[224:227], v[204:211], v37
    s_waitcnt vmcnt(7)
    buffer_store_dwordx4 v[144:147], v6, s[12:15], s59 offen offset:128 sc1
    v_mov_b32_dpp v140, v148 row_ror:8 row_mask:0xf bank_mask:0xc
    v_smfmac_f32_16x16x64_bf16 v[172:175], a[192:195], v[196:203], v33 abid:1
    v_mov_b32_dpp v141, v149 row_ror:8 row_mask:0xf bank_mask:0xc
    v_smfmac_f32_16x16x64_bf16 v[172:175], a[228:231], v[204:211], v37 abid:1
    v_mov_b32_dpp v142, v150 row_ror:8 row_mask:0xf bank_mask:0xc
    v_smfmac_f32_16x16x64_bf16 v[176:179], a[196:199], v[196:203], v34
    v_mov_b32_dpp v143, v151 row_ror:8 row_mask:0xf bank_mask:0xc
    v_smfmac_f32_16x16x64_bf16 v[176:179], a[232:235], v[204:211], v38
    s_waitcnt vmcnt(6)
    buffer_store_dwordx4 v[140:143], v6, s[12:15], s24 offen offset:128 sc1
    ds_read_b128 v[144:147], v9 offset:10560
    v_smfmac_f32_16x16x64_bf16 v[180:183], a[200:203], v[196:203], v34 abid:1
    ds_read_b128 v[148:151], v9 offset:10624
    ds_read_b128 v[140:143], v9 offset:10496
    v_add_u32 v4, s31, v4
    v_smfmac_f32_16x16x64_bf16 v[180:183], a[236:239], v[204:211], v38 abid:1
    v_add_u32 v1, s31, v1
    v_smfmac_f32_16x16x64_bf16 v[184:187], a[204:207], v[196:203], v35
    v_add_u32 v2, s31, v2
    v_smfmac_f32_16x16x64_bf16 v[184:187], a[240:243], v[204:211], v39
    v_smfmac_f32_16x16x64_bf16 v[188:191], a[208:211], v[196:203], v35 abid:1
    v_smfmac_f32_16x16x64_bf16 v[188:191], a[244:247], v[204:211], v39 abid:1
    v_smfmac_f32_16x16x64_bf16 v[192:195], a[212:215], v[196:203], v50 abid:1
    v_smfmac_f32_16x16x64_bf16 v[192:195], a[248:251], v[204:211], v51
    s_waitcnt vmcnt(8)
    s_branch M_top1
M_bE0:
    v_smfmac_f32_16x16x64_bf16 v[164:167], v[56:59], v[220:227], v40 abid:1
    ds_read_b128 v[204:207], v1 offset:1024
    v_smfmac_f32_16x16x64_bf16 v[164:167], v[92:95], v[228:235], v44 abid:1
    ds_read_b128 v[208:211], v2 offset:1024
    v_mov_b32 v0, 1
    v_smfmac_f32_16x16x64_bf16 v[168:171], v[60:63], v[220:227], v41
    ds_read_b128 v[212:215], v1 offset:2048
    v_smfmac_f32_16x16x64_bf16 v[168:171], v[96:99], v[228:235], v45
    ds_read_b128 v[216:219], v2 offset:2048
    v_smfmac_f32_16x16x64_bf16 v[172:175], v[64:67], v[220:227], v41 abid:1
    s_waitcnt vmcnt(5)
    s_waitcnt lgkmcnt(6)
    buffer_store_dwordx4 v[244:247], v7, s[12:15], s66 offen sc1
    v_smfmac_f32_16x16x64_bf16 v[172:175], v[100:103], v[228:235], v45 abid:1
    ds_read_b128 v[236:239], v9 offset:9408
    v_smfmac_f32_16x16x64_bf16 v[176:179], v[68:71], v[220:227], v42
    s_waitcnt vmcnt(6)
    buffer_atomic_add v0, v11, s[16:19], s92 offen sc0 sc1
    s_mov_b32 s21, 2
    v_smfmac_f32_16x16x64_bf16 v[176:179], v[104:107], v[228:235], v46
    v_smfmac_f32_16x16x64_bf16 v[180:183], v[72:75], v[220:227], v42 abid:1
    v_cvt_pk_bf16_f32 v160, v160, v161
    v_smfmac_f32_16x16x64_bf16 v[180:183], v[108:111], v[228:235], v46 abid:1
    v_cvt_pk_bf16_f32 v161, v162, v163
    v_smfmac_f32_16x16x64_bf16 v[184:187], v[76:79], v[220:227], v43
    v_cvt_pk_bf16_f32 v162, v164, v165
    v_smfmac_f32_16x16x64_bf16 v[184:187], v[112:115], v[228:235], v47
    v_cvt_pk_bf16_f32 v163, v166, v167
    v_smfmac_f32_16x16x64_bf16 v[188:191], v[80:83], v[220:227], v43 abid:1
    s_add_u32 m0, m0, 896
    v_cvt_pk_bf16_f32 v168, v168, v169
    v_smfmac_f32_16x16x64_bf16 v[188:191], v[116:119], v[228:235], v47 abid:1
    s_waitcnt vmcnt(5)
    buffer_load_dwordx4 v5, s[8:11], s22 offen offset:512 nt lds
    v_cvt_pk_bf16_f32 v169, v170, v171
    v_smfmac_f32_16x16x64_bf16 v[192:195], v[84:87], v[220:227], v51 abid:1
    v_cvt_pk_bf16_f32 v170, v172, v173
    v_smfmac_f32_16x16x64_bf16 v[192:195], v[120:123], v[228:235], v52
    ds_read_b128 v[220:223], v1 offset:3072
    s_waitcnt lgkmcnt(6)
    v_cvt_pk_bf16_f32 v171, v174, v175
    v_smfmac_f32_16x16x64_bf16 v[124:127], a[0:3], v[196:203], v12
    ds_read_b128 v[224:227], v2 offset:3072
    ds_read_b128 v[172:175], v9 offset:10432
    s_waitcnt lgkmcnt(6)
    v_cndmask_b32_dpp v164, v160, v168, vcc row_ror:8 row_mask:0xf bank_mask:0xf
    v_smfmac_f32_16x16x64_bf16 v[124:127], a[36:39], v[204:211], v16
    ds_read_b128 v[228:231], v1 offset:4096
    s_waitcnt lgkmcnt(5)
    v_cndmask_b32_dpp v165, v161, v169, vcc row_ror:8 row_mask:0xf bank_mask:0xf
    v_smfmac_f32_16x16x64_bf16 v[124:127], a[72:75], v[212:219], v20
    ds_read_b128 v[232:235], v2 offset:4096
    v_cndmask_b32_dpp v166, v162, v170, vcc row_ror:8 row_mask:0xf bank_mask:0xf
    v_smfmac_f32_16x16x64_bf16 v[128:131], a[4:7], v[196:203], v12 abid:1
    s_barrier
    v_cndmask_b32_dpp v167, v163, v171, vcc row_ror:8 row_mask:0xf bank_mask:0xf
    v_smfmac_f32_16x16x64_bf16 v[128:131], a[40:43], v[204:211], v16 abid:1
    s_waitcnt vmcnt(6)
    buffer_store_dwordx4 v[164:167], v6, s[12:15], s58 offen offset:0 sc1
    s_waitcnt lgkmcnt(5)
    v_xad_u32 v236, v236, v3, v4
    v_smfmac_f32_16x16x64_bf16 v[128:131], a[76:79], v[212:219], v20 abid:1
    v_xad_u32 v237, v237, v3, v4
    v_smfmac_f32_16x16x64_bf16 v[132:135], a[8:11], v[196:203], v13
    ds_read2st64_b32 v[244:245], v236 offset0:0 offset1:72
    ds_read_b128 v[240:243], v8 offset:3072
    v_xad_u32 v238, v238, v3, v4
    v_smfmac_f32_16x16x64_bf16 v[132:135], a[44:47], v[204:211], v17
    ds_read2st64_b32 v[246:247], v237 offset0:0 offset1:72
    v_xad_u32 v239, v239, v3, v4
    v_smfmac_f32_16x16x64_bf16 v[132:135], a[80:83], v[212:219], v21
    ds_read2st64_b32 v[248:249], v238 offset0:0 offset1:72
    v_mov_b32_dpp v160, v168 row_ror:8 row_mask:0xf bank_mask:0xc
    v_smfmac_f32_16x16x64_bf16 v[144:147], a[20:23], v[196:203], v14 abid:1
    ds_read2st64_b32 v[250:251], v239 offset0:0 offset1:72
    ds_read_b128 v[236:239], v9 offset:9280
    v_mov_b32_dpp v161, v169 row_ror:8 row_mask:0xf bank_mask:0xc
    v_smfmac_f32_16x16x64_bf16 v[144:147], a[56:59], v[204:211], v18 abid:1
    v_mov_b32_dpp v162, v170 row_ror:8 row_mask:0xf bank_mask:0xc
    v_smfmac_f32_16x16x64_bf16 v[144:147], a[92:95], v[212:219], v22 abid:1
    v_mov_b32_dpp v163, v171 row_ror:8 row_mask:0xf bank_mask:0xc
    v_smfmac_f32_16x16x64_bf16 v[140:143], a[16:19], v[196:203], v14
    s_waitcnt vmcnt(5)
    buffer_store_dwordx4 v[160:163], v6, s[12:15], s23 offen offset:0 sc1
    ds_read_b128 v[164:167], v9 offset:10304
    v_smfmac_f32_16x16x64_bf16 v[140:143], a[52:55], v[204:211], v18
    ds_read_b128 v[168:171], v9 offset:10368
    ds_read_b128 v[160:163], v9 offset:10240
    v_smfmac_f32_16x16x64_bf16 v[140:143], a[88:91], v[212:219], v22
    v_smfmac_f32_16x16x64_bf16 v[136:139], a[12:15], v[196:203], v13 abid:1
    v_smfmac_f32_16x16x64_bf16 v[136:139], a[48:51], v[204:211], v17 abid:1
    v_smfmac_f32_16x16x64_bf16 v[136:139], a[84:87], v[212:219], v21 abid:1
    s_waitcnt lgkmcnt(3)
    v_xad_u32 v236, v236, v3, v4
    v_smfmac_f32_16x16x64_bf16 v[136:139], v[240:243], v[244:251], v10
    v_xad_u32 v237, v237, v3, v4
    v_smfmac_f32_16x16x64_bf16 v[172:175], v[240:243], v[244:251], v10 abid:1
    ds_read2st64_b32 v[244:245], v236 offset0:0 offset1:72
    ds_read_b128 v[240:243], v8 offset:1024
    v_xad_u32 v238, v238, v3, v4
    v_smfmac_f32_16x16x64_bf16 v[148:151], a[24:27], v[196:203], v15
    ds_read2st64_b32 v[246:247], v237 offset0:0 offset1:72
    v_xad_u32 v239, v239, v3, v4
    v_smfmac_f32_16x16x64_bf16 v[148:151], a[60:63], v[204:211], v19
    ds_read2st64_b32 v[248:249], v238 offset0:0 offset1:72
    v_cvt_pk_bf16_f32 v192, v192, v193
    v_smfmac_f32_16x16x64_bf16 v[148:151], a[96:99], v[212:219], v23
    ds_read2st64_b32 v[250:251], v239 offset0:0 offset1:72
    ds_read_b128 v[236:239], v9 offset:9344
    v_cvt_pk_bf16_f32 v193, v194, v195
    v_smfmac_f32_16x16x64_bf16 v[152:155], a[28:31], v[196:203], v15 abid:1
    ds_write_b64 v53, v[192:193] offset:0
    ds_read_b128 v[192:195], v9 offset:10752
    v_smfmac_f32_16x16x64_bf16 v[152:155], a[64:67], v[204:211], v19 abid:1
    s_add_u32 m0, m0, 896
    v_smfmac_f32_16x16x64_bf16 v[152:155], a[100:103], v[212:219], v23 abid:1
    s_waitcnt vmcnt(6)
    buffer_load_dwordx4 v5, s[8:11], s22 offen offset:640 nt lds
    v_smfmac_f32_16x16x64_bf16 v[156:159], a[32:35], v[196:203], v48
    v_smfmac_f32_16x16x64_bf16 v[156:159], a[68:71], v[204:211], v48 abid:1
    v_smfmac_f32_16x16x64_bf16 v[156:159], a[104:107], v[212:219], v49
    ds_read_b128 v[196:199], v1 offset:5120
    v_cvt_pk_bf16_f32 v176, v176, v177
    v_smfmac_f32_16x16x64_bf16 v[124:127], a[108:111], v[220:227], v24
    ds_read_b128 v[200:203], v2 offset:5120
    v_cvt_pk_bf16_f32 v177, v178, v179
    v_smfmac_f32_16x16x64_bf16 v[124:127], a[144:147], v[228:235], v28
    ds_read_b128 v[204:207], v1 offset:6144
    ds_read_b64 v[216:217], v9 offset:10056
    v_cvt_pk_bf16_f32 v178, v180, v181
    v_smfmac_f32_16x16x64_bf16 v[128:131], a[112:115], v[220:227], v24 abid:1
    ds_read_b128 v[208:211], v2 offset:6144
    v_cvt_pk_bf16_f32 v179, v182, v183
    v_smfmac_f32_16x16x64_bf16 v[128:131], a[148:151], v[228:235], v28 abid:1
    s_waitcnt lgkmcnt(7)
    v_xad_u32 v236, v236, v3, v4
    v_smfmac_f32_16x16x64_bf16 v[128:131], v[240:243], v[244:251], v10
    s_add_u32 m0, m0, 896
    v_xad_u32 v237, v237, v3, v4
    v_smfmac_f32_16x16x64_bf16 v[164:167], v[240:243], v[244:251], v10 abid:1
    ds_read2st64_b32 v[244:245], v236 offset0:0 offset1:72
    ds_read_b128 v[240:243], v8 offset:2048
    v_xad_u32 v238, v238, v3, v4
    v_smfmac_f32_16x16x64_bf16 v[152:155], a[136:139], v[220:227], v27 abid:1
    ds_read2st64_b32 v[246:247], v237 offset0:0 offset1:72
    s_waitcnt vmcnt(5)
    v_xad_u32 v239, v239, v3, v4
    v_smfmac_f32_16x16x64_bf16 v[152:155], a[172:175], v[228:235], v31 abid:1
    ds_read2st64_b32 v[248:249], v238 offset0:0 offset1:72
    buffer_load_dwordx4 v5, s[8:11], s22 offen offset:768 nt lds
    v_cvt_pk_bf16_f32 v184, v184, v185
    v_smfmac_f32_16x16x64_bf16 v[136:139], a[120:123], v[220:227], v25 abid:1
    ds_read2st64_b32 v[250:251], v239 offset0:0 offset1:72
    ds_read_b128 v[236:239], v9 offset:9216
    v_cvt_pk_bf16_f32 v185, v186, v187
    v_smfmac_f32_16x16x64_bf16 v[136:139], a[156:159], v[228:235], v29 abid:1
    v_cvt_pk_bf16_f32 v186, v188, v189
    v_smfmac_f32_16x16x64_bf16 v[140:143], a[124:127], v[220:227], v26
    v_cvt_pk_bf16_f32 v187, v190, v191
    v_smfmac_f32_16x16x64_bf16 v[140:143], a[160:163], v[228:235], v30
    ds_read_b128 v[188:191], v9 offset:10688
    v_cndmask_b32_dpp v180, v176, v184, vcc row_ror:8 row_mask:0xf bank_mask:0xf
    v_smfmac_f32_16x16x64_bf16 v[144:147], a[128:131], v[220:227], v26 abid:1
    v_cndmask_b32_dpp v181, v177, v185, vcc row_ror:8 row_mask:0xf bank_mask:0xf
    v_smfmac_f32_16x16x64_bf16 v[144:147], a[164:167], v[228:235], v30 abid:1
    v_cndmask_b32_dpp v182, v178, v186, vcc row_ror:8 row_mask:0xf bank_mask:0xf
    v_smfmac_f32_16x16x64_bf16 v[148:151], a[132:135], v[220:227], v27
    v_cndmask_b32_dpp v183, v179, v187, vcc row_ror:8 row_mask:0xf bank_mask:0xf
    v_smfmac_f32_16x16x64_bf16 v[148:151], a[168:171], v[228:235], v31
    s_waitcnt vmcnt(6)
    buffer_store_dwordx4 v[180:183], v6, s[12:15], s58 offen offset:128 sc1
    v_mov_b32_dpp v176, v184 row_ror:8 row_mask:0xf bank_mask:0xc
    v_smfmac_f32_16x16x64_bf16 v[132:135], a[116:119], v[220:227], v25
    v_mov_b32_dpp v177, v185 row_ror:8 row_mask:0xf bank_mask:0xc
    v_smfmac_f32_16x16x64_bf16 v[132:135], a[152:155], v[228:235], v29
    s_waitcnt lgkmcnt(1)
    v_xad_u32 v236, v236, v3, v4
    v_smfmac_f32_16x16x64_bf16 v[132:135], v[240:243], v[244:251], v10
    v_xad_u32 v237, v237, v3, v4
    v_smfmac_f32_16x16x64_bf16 v[168:171], v[240:243], v[244:251], v10 abid:1
    ds_read2st64_b32 v[244:245], v236 offset0:0 offset1:72
    ds_read_b128 v[240:243], v8 offset:0
    v_xad_u32 v238, v238, v3, v4
    v_smfmac_f32_16x16x64_bf16 v[156:159], a[140:143], v[220:227], v49 abid:1
    ds_read2st64_b32 v[246:247], v237 offset0:0 offset1:72
    v_xad_u32 v239, v239, v3, v4
    v_smfmac_f32_16x16x64_bf16 v[156:159], a[176:179], v[228:235], v50
    ds_read2st64_b32 v[248:249], v238 offset0:0 offset1:72
    ds_read_b128 v[220:223], v1 offset:7168
    v_mov_b32_dpp v178, v186 row_ror:8 row_mask:0xf bank_mask:0xc
    v_smfmac_f32_16x16x64_bf16 v[140:143], a[196:199], v[196:203], v34
    ds_read2st64_b32 v[250:251], v239 offset0:0 offset1:72
    ds_read_b128 v[236:239], v9 offset:9728
    v_mov_b32_dpp v179, v187 row_ror:8 row_mask:0xf bank_mask:0xc
    v_smfmac_f32_16x16x64_bf16 v[140:143], a[232:235], v[204:211], v38
    ds_read_b128 v[224:227], v2 offset:7168
    s_waitcnt vmcnt(5)
    buffer_store_dwordx4 v[176:179], v6, s[12:15], s23 offen offset:128 sc1
    v_smfmac_f32_16x16x64_bf16 v[128:131], a[184:187], v[196:203], v32 abid:1
    ds_read_b128 v[228:231], v1 offset:8192
    ds_read_b128 v[180:183], v9 offset:10560
    ds_read_b128 v[184:187], v9 offset:10624
    v_smfmac_f32_16x16x64_bf16 v[128:131], a[220:223], v[204:211], v36 abid:1
    ds_read_b128 v[232:235], v2 offset:8192
    ds_read_b128 v[176:179], v9 offset:10496
    v_xad_u32 v212, v216, v3, v4
    v_smfmac_f32_16x16x64_bf16 v[132:135], a[188:191], v[196:203], v33
    ds_read2st64_b32 v[212:213], v212 offset0:0 offset1:72
    v_xad_u32 v214, v217, v3, v4
    v_smfmac_f32_16x16x64_bf16 v[132:135], a[224:227], v[204:211], v37
    ds_read2st64_b32 v[214:215], v214 offset0:0 offset1:72
    v_smfmac_f32_16x16x64_bf16 v[136:139], a[192:195], v[196:203], v33 abid:1
    v_smfmac_f32_16x16x64_bf16 v[136:139], a[228:231], v[204:211], v37 abid:1
    v_smfmac_f32_16x16x64_bf16 v[124:127], a[180:183], v[196:203], v32
    v_smfmac_f32_16x16x64_bf16 v[124:127], a[216:219], v[204:211], v36
    s_waitcnt vmcnt(7)
    s_waitcnt lgkmcnt(8)
    v_xad_u32 v236, v236, v3, v4
    v_smfmac_f32_16x16x64_bf16 v[124:127], v[240:243], v[244:251], v10
    v_xad_u32 v237, v237, v3, v4
    v_smfmac_f32_16x16x64_bf16 v[160:163], v[240:243], v[244:251], v10 abid:1
    ds_read2st64_b32 v[244:245], v236 offset0:0 offset1:72
    ds_read_b128 v[240:243], v8 offset:8192
    v_xad_u32 v238, v238, v3, v4
    v_smfmac_f32_16x16x64_bf16 v[144:147], a[200:203], v[196:203], v34 abid:1
    ds_read2st64_b32 v[246:247], v237 offset0:0 offset1:72
    v_xad_u32 v239, v239, v3, v4
    v_smfmac_f32_16x16x64_bf16 v[144:147], a[236:239], v[204:211], v38 abid:1
    ds_read2st64_b32 v[248:249], v238 offset0:0 offset1:72
    v_mul_u32_u24 v0, s94, v0
    v_smfmac_f32_16x16x64_bf16 v[148:151], a[204:207], v[196:203], v35
    ds_read2st64_b32 v[250:251], v239 offset0:0 offset1:72
    ds_read_b128 v[236:239], v9 offset:9664
    v_add_u32 v0, s93, v0
    v_smfmac_f32_16x16x64_bf16 v[148:151], a[240:243], v[204:211], v39
    s_add_u32 m0, m0, 896
    v_min_u32 v0, 75497472, v0
    v_smfmac_f32_16x16x64_bf16 v[152:155], a[208:211], v[196:203], v35 abid:1
    ds_write_b32 v11, v0
    s_waitcnt vmcnt(6)
    v_mov_b32 v0, 162048
    v_smfmac_f32_16x16x64_bf16 v[152:155], a[244:247], v[204:211], v39 abid:1
    buffer_load_dwordx4 v5, s[8:11], s22 offen offset:896 nt lds
    v_smfmac_f32_16x16x64_bf16 v[156:159], a[212:215], v[196:203], v50 abid:1
    s_waitcnt lgkmcnt(7)
    s_cmp_lt_i32 s81, 0
    s_cbranch_scc1 M_ovrE0
    s_swappc_b64 s[78:79], s[72:73]
M_ovrE0:
    v_smfmac_f32_16x16x64_bf16 v[156:159], a[248:251], v[204:211], v51
    ds_read_b128 v[196:199], v1 offset:18432
    v_smfmac_f32_16x16x64_bf16 v[124:127], a[252:255], v[220:227], v40
    ds_read_b128 v[200:203], v2 offset:18432
    v_smfmac_f32_16x16x64_bf16 v[124:127], v[88:91], v[228:235], v44
    ds_read_b128 v[204:207], v1 offset:19456
    v_smfmac_f32_16x16x64_bf16 v[156:159], v[84:87], v[220:227], v51 abid:1
    ds_read_b128 v[208:211], v2 offset:19456
    v_smfmac_f32_16x16x64_bf16 v[156:159], v[120:123], v[228:235], v52
    s_waitcnt lgkmcnt(4)
    s_barrier
    v_xad_u32 v236, v236, v3, v4
    v_smfmac_f32_16x16x64_bf16 v[156:159], v[240:243], v[244:251], v10
    ds_read_b32 v0, v0
    v_xad_u32 v237, v237, v3, v4
    v_smfmac_f32_16x16x64_bf16 v[192:195], v[240:243], v[244:251], v10 abid:1
    ds_read2st64_b32 v[244:245], v236 offset0:0 offset1:72
    ds_read_b128 v[240:243], v8 offset:7168
    v_xad_u32 v238, v238, v3, v4
    v_smfmac_f32_16x16x64_bf16 v[132:135], v[60:63], v[220:227], v41
    ds_read2st64_b32 v[246:247], v237 offset0:0 offset1:72
    v_xad_u32 v239, v239, v3, v4
    v_smfmac_f32_16x16x64_bf16 v[132:135], v[96:99], v[228:235], v45
    ds_read2st64_b32 v[248:249], v238 offset0:0 offset1:72
    s_add_u32 m0, m0, 896
    v_smfmac_f32_16x16x64_bf16 v[136:139], v[64:67], v[220:227], v41 abid:1
    ds_read2st64_b32 v[250:251], v239 offset0:0 offset1:72
    ds_read_b128 v[236:239], v9 offset:9536
    s_waitcnt vmcnt(5)
    v_smfmac_f32_16x16x64_bf16 v[136:139], v[100:103], v[228:235], v45 abid:1
    buffer_load_dwordx4 v5, s[8:11], s22 offen offset:1024 nt lds
    s_waitcnt lgkmcnt(6)
    v_readfirstlane_b32 s88, v0
    v_smfmac_f32_16x16x64_bf16 v[140:143], v[68:71], v[220:227], v42
    s_cmp_lt_u32 s88, 75497472
    s_cselect_b32 s10, 75497472, 0
    v_smfmac_f32_16x16x64_bf16 v[140:143], v[104:107], v[228:235], v46
    v_smfmac_f32_16x16x64_bf16 v[144:147], v[72:75], v[220:227], v42 abid:1
    ds_read_b128 v[212:215], v1 offset:20480
    v_smfmac_f32_16x16x64_bf16 v[144:147], v[108:111], v[228:235], v46 abid:1
    ds_read_b128 v[216:219], v2 offset:20480
    v_smfmac_f32_16x16x64_bf16 v[148:151], v[76:79], v[220:227], v43
    v_smfmac_f32_16x16x64_bf16 v[148:151], v[112:115], v[228:235], v47
    v_smfmac_f32_16x16x64_bf16 v[152:155], v[80:83], v[220:227], v43 abid:1
    v_smfmac_f32_16x16x64_bf16 v[152:155], v[116:119], v[228:235], v47 abid:1
    s_waitcnt lgkmcnt(2)
    v_xad_u32 v236, v236, v3, v4
    v_smfmac_f32_16x16x64_bf16 v[152:155], v[240:243], v[244:251], v10
    v_xad_u32 v237, v237, v3, v4
    v_smfmac_f32_16x16x64_bf16 v[188:191], v[240:243], v[244:251], v10 abid:1
    s_cmp_gt_u32 s46, s80
    s_cbranch_scc1 M_slow
M_slowrE0:
    v_xad_u32 v238, v238, v3, v4
    v_smfmac_f32_16x16x64_bf16 v[128:131], v[56:59], v[220:227], v40 abid:1
    ds_read2st64_b32 v[244:245], v236 offset0:0 offset1:72
    ds_read_b128 v[240:243], v8 offset:5120
    v_xad_u32 v239, v239, v3, v4
    v_smfmac_f32_16x16x64_bf16 v[128:131], v[92:95], v[228:235], v44 abid:1
    ds_read2st64_b32 v[246:247], v237 offset0:0 offset1:72
    ds_read_b128 v[220:223], v1 offset:21504
    v_smfmac_f32_16x16x64_bf16 v[160:163], a[0:3], v[196:203], v12
    ds_read2st64_b32 v[248:249], v238 offset0:0 offset1:72
    ds_read_b128 v[224:227], v2 offset:21504
    v_smfmac_f32_16x16x64_bf16 v[160:163], a[36:39], v[204:211], v16
    ds_read2st64_b32 v[250:251], v239 offset0:0 offset1:72
    ds_read_b128 v[236:239], v9 offset:9600
    s_waitcnt lgkmcnt(8)
    v_smfmac_f32_16x16x64_bf16 v[160:163], a[72:75], v[212:219], v20
    ds_read_b128 v[228:231], v1 offset:22528
    v_smfmac_f32_16x16x64_bf16 v[164:167], a[4:7], v[196:203], v12 abid:1
    ds_read_b128 v[232:235], v2 offset:22528
    v_cvt_pk_bf16_f32 v156, v156, v157
    v_smfmac_f32_16x16x64_bf16 v[164:167], a[40:43], v[204:211], v16 abid:1
    s_mov_b32 m0, s28
    v_cvt_pk_bf16_f32 v157, v158, v159
    v_smfmac_f32_16x16x64_bf16 v[164:167], a[76:79], v[212:219], v20 abid:1
    ds_write_b64 v53, v[156:157] offset:25728
    ds_read_b128 v[156:159], v9 offset:10752
    s_waitcnt vmcnt(6)
    v_smfmac_f32_16x16x64_bf16 v[180:183], a[20:23], v[196:203], v14 abid:1
    buffer_load_dwordx4 v5, s[8:11], s88 offen offset:0 nt lds
    v_smfmac_f32_16x16x64_bf16 v[180:183], a[56:59], v[204:211], v18 abid:1
    v_cvt_pk_bf16_f32 v124, v124, v125
    v_smfmac_f32_16x16x64_bf16 v[180:183], a[92:95], v[212:219], v22 abid:1
    s_waitcnt lgkmcnt(4)
    v_xad_u32 v236, v236, v3, v4
    v_smfmac_f32_16x16x64_bf16 v[180:183], v[240:243], v[244:251], v10 abid:1
    v_xad_u32 v237, v237, v3, v4
    v_smfmac_f32_16x16x64_bf16 v[144:147], v[240:243], v[244:251], v10
    ds_read2st64_b32 v[244:245], v236 offset0:0 offset1:72
    ds_read_b128 v[240:243], v8 offset:6144
    v_xad_u32 v238, v238, v3, v4
    v_smfmac_f32_16x16x64_bf16 v[172:175], a[12:15], v[196:203], v13 abid:1
    ds_read2st64_b32 v[246:247], v237 offset0:0 offset1:72
    v_xad_u32 v239, v239, v3, v4
    v_smfmac_f32_16x16x64_bf16 v[172:175], a[48:51], v[204:211], v17 abid:1
    ds_read2st64_b32 v[248:249], v238 offset0:0 offset1:72
    v_cvt_pk_bf16_f32 v125, v126, v127
    v_smfmac_f32_16x16x64_bf16 v[172:175], a[84:87], v[212:219], v21 abid:1
    ds_read2st64_b32 v[250:251], v239 offset0:0 offset1:72
    ds_read_b128 v[236:239], v9 offset:9472
    v_cvt_pk_bf16_f32 v126, v128, v129
    v_smfmac_f32_16x16x64_bf16 v[176:179], a[16:19], v[196:203], v14
    v_cvt_pk_bf16_f32 v127, v130, v131
    v_smfmac_f32_16x16x64_bf16 v[176:179], a[52:55], v[204:211], v18
    v_cvt_pk_bf16_f32 v132, v132, v133
    v_smfmac_f32_16x16x64_bf16 v[176:179], a[88:91], v[212:219], v22
    v_cvt_pk_bf16_f32 v133, v134, v135
    v_smfmac_f32_16x16x64_bf16 v[168:171], a[8:11], v[196:203], v13
    s_add_u32 m0, m0, 896
    v_cvt_pk_bf16_f32 v134, v136, v137
    v_smfmac_f32_16x16x64_bf16 v[168:171], a[44:47], v[204:211], v17
    s_waitcnt vmcnt(5)
    buffer_load_dwordx4 v5, s[8:11], s88 offen offset:128 nt lds
    v_cvt_pk_bf16_f32 v135, v138, v139
    v_smfmac_f32_16x16x64_bf16 v[168:171], a[80:83], v[212:219], v21
    ds_read_b128 v[136:139], v9 offset:10432
    v_cndmask_b32_dpp v128, v124, v132, vcc row_ror:8 row_mask:0xf bank_mask:0xf
    v_smfmac_f32_16x16x64_bf16 v[184:187], a[24:27], v[196:203], v15
    v_cndmask_b32_dpp v129, v125, v133, vcc row_ror:8 row_mask:0xf bank_mask:0xf
    v_smfmac_f32_16x16x64_bf16 v[184:187], a[60:63], v[204:211], v19
    v_cndmask_b32_dpp v130, v126, v134, vcc row_ror:8 row_mask:0xf bank_mask:0xf
    v_smfmac_f32_16x16x64_bf16 v[184:187], a[96:99], v[212:219], v23
    s_waitcnt lgkmcnt(1)
    v_xad_u32 v236, v236, v3, v4
    v_smfmac_f32_16x16x64_bf16 v[184:187], v[240:243], v[244:251], v10 abid:1
    v_xad_u32 v237, v237, v3, v4
    v_smfmac_f32_16x16x64_bf16 v[148:151], v[240:243], v[244:251], v10
    ds_read2st64_b32 v[244:245], v236 offset0:0 offset1:72
    ds_read_b128 v[240:243], v8 offset:4096
    v_xad_u32 v238, v238, v3, v4
    v_smfmac_f32_16x16x64_bf16 v[188:191], a[28:31], v[196:203], v15 abid:1
    ds_read2st64_b32 v[246:247], v237 offset0:0 offset1:72
    v_xad_u32 v239, v239, v3, v4
    v_smfmac_f32_16x16x64_bf16 v[188:191], a[64:67], v[204:211], v19 abid:1
    ds_read2st64_b32 v[248:249], v238 offset0:0 offset1:72
    v_cndmask_b32_dpp v131, v127, v135, vcc row_ror:8 row_mask:0xf bank_mask:0xf
    v_smfmac_f32_16x16x64_bf16 v[188:191], a[100:103], v[212:219], v23 abid:1
    ds_read2st64_b32 v[250:251], v239 offset0:0 offset1:72
    s_waitcnt vmcnt(6)
    buffer_store_dwordx4 v[128:131], v6, s[12:15], s59 offen offset:0 sc1
    v_smfmac_f32_16x16x64_bf16 v[192:195], a[32:35], v[196:203], v48
    v_mov_b32_dpp v124, v132 row_ror:8 row_mask:0xf bank_mask:0xc
    v_smfmac_f32_16x16x64_bf16 v[192:195], a[68:71], v[204:211], v48 abid:1
    v_mov_b32_dpp v125, v133 row_ror:8 row_mask:0xf bank_mask:0xc
    v_smfmac_f32_16x16x64_bf16 v[192:195], a[104:107], v[212:219], v49
    ds_read_b128 v[196:199], v1 offset:23552
    v_mov_b32_dpp v126, v134 row_ror:8 row_mask:0xf bank_mask:0xc
    v_smfmac_f32_16x16x64_bf16 v[160:163], a[108:111], v[220:227], v24
    ds_read_b128 v[200:203], v2 offset:23552
    v_mov_b32_dpp v127, v135 row_ror:8 row_mask:0xf bank_mask:0xc
    v_smfmac_f32_16x16x64_bf16 v[160:163], a[144:147], v[228:235], v28
    ds_read_b128 v[204:207], v1 offset:24576
    s_waitcnt vmcnt(5)
    buffer_store_dwordx4 v[124:127], v6, s[12:15], s24 offen offset:0 sc1
    v_smfmac_f32_16x16x64_bf16 v[164:167], a[112:115], v[220:227], v24 abid:1
    ds_read_b128 v[208:211], v2 offset:24576
    ds_read_b128 v[128:131], v9 offset:10304
    ds_read_b128 v[132:135], v9 offset:10368
    v_smfmac_f32_16x16x64_bf16 v[164:167], a[148:151], v[228:235], v28 abid:1
    ds_read_b128 v[124:127], v9 offset:10240
    v_smfmac_f32_16x16x64_bf16 v[176:179], a[124:127], v[220:227], v26
    v_smfmac_f32_16x16x64_bf16 v[176:179], a[160:163], v[228:235], v30
    s_waitcnt lgkmcnt(7)
    v_smfmac_f32_16x16x64_bf16 v[176:179], v[240:243], v[244:251], v10 abid:1
    v_smfmac_f32_16x16x64_bf16 v[140:143], v[240:243], v[244:251], v10
    v_smfmac_f32_16x16x64_bf16 v[172:175], a[120:123], v[220:227], v25 abid:1
    s_add_u32 s28, s28, 36864
    s_cmp_ge_u32 s28, 110592
    s_cselect_b32 s28, s26, s28
    v_smfmac_f32_16x16x64_bf16 v[172:175], a[156:159], v[228:235], v29 abid:1
    s_add_u32 s30, s25, 36864
    s_cmp_eq_u32 s30, 110592
    s_cselect_b32 s30, 0, s30
    v_smfmac_f32_16x16x64_bf16 v[168:171], a[116:119], v[220:227], v25
    s_sub_u32 s31, s30, s25
    s_mov_b32 s25, s30
    s_mov_b32 s90, s22
    v_smfmac_f32_16x16x64_bf16 v[168:171], a[152:155], v[228:235], v29
    s_mov_b32 s22, s88
    s_add_u32 s91, s91, 1
    s_cmp_lt_u32 s20, 2
    v_smfmac_f32_16x16x64_bf16 v[180:183], a[128:131], v[220:227], v26 abid:1
    s_cselect_b32 s66, s23, s24
    s_add_u32 s66, s66, s95
    v_smfmac_f32_16x16x64_bf16 v[180:183], a[164:167], v[228:235], v30 abid:1
    v_cvt_pk_bf16_f32 v140, v140, v141
    v_smfmac_f32_16x16x64_bf16 v[184:187], a[132:135], v[220:227], v27
    s_add_u32 m0, m0, 896
    v_cvt_pk_bf16_f32 v141, v142, v143
    v_smfmac_f32_16x16x64_bf16 v[184:187], a[168:171], v[228:235], v31
    s_waitcnt vmcnt(6)
    buffer_load_dwordx4 v5, s[8:11], s88 offen offset:256 nt lds
    v_cvt_pk_bf16_f32 v142, v144, v145
    v_smfmac_f32_16x16x64_bf16 v[188:191], a[136:139], v[220:227], v27 abid:1
    v_cvt_pk_bf16_f32 v143, v146, v147
    v_smfmac_f32_16x16x64_bf16 v[188:191], a[172:175], v[228:235], v31 abid:1
    v_cvt_pk_bf16_f32 v148, v148, v149
    v_smfmac_f32_16x16x64_bf16 v[192:195], a[140:143], v[220:227], v49 abid:1
    v_cvt_pk_bf16_f32 v149, v150, v151
    v_smfmac_f32_16x16x64_bf16 v[192:195], a[176:179], v[228:235], v50
    ds_read_b128 v[220:223], v1 offset:25600
    s_waitcnt lgkmcnt(6)
    v_cvt_pk_bf16_f32 v150, v152, v153
    v_smfmac_f32_16x16x64_bf16 v[160:163], a[180:183], v[196:203], v32
    ds_read_b128 v[224:227], v2 offset:25600
    s_waitcnt lgkmcnt(5)
    v_cvt_pk_bf16_f32 v151, v154, v155
    v_smfmac_f32_16x16x64_bf16 v[160:163], a[216:219], v[204:211], v36
    ds_read_b128 v[228:231], v1 offset:26624
    ds_read_b128 v[152:155], v9 offset:10688
    v_cndmask_b32_dpp v144, v140, v148, vcc row_ror:8 row_mask:0xf bank_mask:0xf
    v_smfmac_f32_16x16x64_bf16 v[164:167], a[184:187], v[196:203], v32 abid:1
    ds_read_b128 v[232:235], v2 offset:26624
    v_cndmask_b32_dpp v145, v141, v149, vcc row_ror:8 row_mask:0xf bank_mask:0xf
    v_smfmac_f32_16x16x64_bf16 v[164:167], a[220:223], v[204:211], v36 abid:1
    s_add_u32 m0, m0, 896
    v_cndmask_b32_dpp v146, v142, v150, vcc row_ror:8 row_mask:0xf bank_mask:0xf
    v_smfmac_f32_16x16x64_bf16 v[168:171], a[188:191], v[196:203], v33
    s_waitcnt vmcnt(5)
    buffer_load_dwordx4 v5, s[8:11], s88 offen offset:384 nt lds
    v_cndmask_b32_dpp v147, v143, v151, vcc row_ror:8 row_mask:0xf bank_mask:0xf
    v_smfmac_f32_16x16x64_bf16 v[168:171], a[224:227], v[204:211], v37
    s_waitcnt vmcnt(6)
    buffer_store_dwordx4 v[144:147], v6, s[12:15], s59 offen offset:128 sc1
    v_mov_b32_dpp v140, v148 row_ror:8 row_mask:0xf bank_mask:0xc
    v_smfmac_f32_16x16x64_bf16 v[172:175], a[192:195], v[196:203], v33 abid:1
    v_mov_b32_dpp v141, v149 row_ror:8 row_mask:0xf bank_mask:0xc
    v_smfmac_f32_16x16x64_bf16 v[172:175], a[228:231], v[204:211], v37 abid:1
    v_mov_b32_dpp v142, v150 row_ror:8 row_mask:0xf bank_mask:0xc
    v_smfmac_f32_16x16x64_bf16 v[176:179], a[196:199], v[196:203], v34
    v_mov_b32_dpp v143, v151 row_ror:8 row_mask:0xf bank_mask:0xc
    v_smfmac_f32_16x16x64_bf16 v[176:179], a[232:235], v[204:211], v38
    s_waitcnt vmcnt(5)
    buffer_store_dwordx4 v[140:143], v6, s[12:15], s24 offen offset:128 sc1
    ds_read_b128 v[144:147], v9 offset:10560
    v_smfmac_f32_16x16x64_bf16 v[180:183], a[200:203], v[196:203], v34 abid:1
    ds_read_b128 v[148:151], v9 offset:10624
    ds_read_b128 v[140:143], v9 offset:10496
    v_add_u32 v4, s31, v4
    v_smfmac_f32_16x16x64_bf16 v[180:183], a[236:239], v[204:211], v38 abid:1
    v_add_u32 v1, s31, v1
    v_smfmac_f32_16x16x64_bf16 v[184:187], a[204:207], v[196:203], v35
    v_add_u32 v2, s31, v2
    v_smfmac_f32_16x16x64_bf16 v[184:187], a[240:243], v[204:211], v39
    v_smfmac_f32_16x16x64_bf16 v[188:191], a[208:211], v[196:203], v35 abid:1
    v_smfmac_f32_16x16x64_bf16 v[188:191], a[244:247], v[204:211], v39 abid:1
    v_smfmac_f32_16x16x64_bf16 v[192:195], a[212:215], v[196:203], v50 abid:1
    v_smfmac_f32_16x16x64_bf16 v[192:195], a[248:251], v[204:211], v51
    s_waitcnt vmcnt(8)
    s_branch M_top1
M_bF:
    v_smfmac_f32_16x16x64_bf16 v[164:167], v[56:59], v[220:227], v40 abid:1
    ds_read_b128 v[204:207], v1 offset:1024
    v_smfmac_f32_16x16x64_bf16 v[164:167], v[92:95], v[228:235], v44 abid:1
    ds_read_b128 v[208:211], v2 offset:1024
    v_smfmac_f32_16x16x64_bf16 v[168:171], v[60:63], v[220:227], v41
    ds_read_b128 v[212:215], v1 offset:2048
    v_smfmac_f32_16x16x64_bf16 v[168:171], v[96:99], v[228:235], v45
    ds_read_b128 v[216:219], v2 offset:2048
    v_smfmac_f32_16x16x64_bf16 v[172:175], v[64:67], v[220:227], v41 abid:1
    s_waitcnt lgkmcnt(6)
    buffer_store_dwordx4 v[244:247], v7, s[12:15], s66 offen sc1
    v_smfmac_f32_16x16x64_bf16 v[172:175], v[100:103], v[228:235], v45 abid:1
    ds_read_b128 v[236:239], v9 offset:9408
    v_smfmac_f32_16x16x64_bf16 v[176:179], v[68:71], v[220:227], v42
    s_mov_b32 s21, 3
    v_smfmac_f32_16x16x64_bf16 v[176:179], v[104:107], v[228:235], v46
    v_smfmac_f32_16x16x64_bf16 v[180:183], v[72:75], v[220:227], v42 abid:1
    v_cvt_pk_bf16_f32 v160, v160, v161
    v_smfmac_f32_16x16x64_bf16 v[180:183], v[108:111], v[228:235], v46 abid:1
    v_cvt_pk_bf16_f32 v161, v162, v163
    v_smfmac_f32_16x16x64_bf16 v[184:187], v[76:79], v[220:227], v43
    v_cvt_pk_bf16_f32 v162, v164, v165
    v_smfmac_f32_16x16x64_bf16 v[184:187], v[112:115], v[228:235], v47
    v_cvt_pk_bf16_f32 v163, v166, v167
    v_smfmac_f32_16x16x64_bf16 v[188:191], v[80:83], v[220:227], v43 abid:1
    v_cvt_pk_bf16_f32 v168, v168, v169
    v_smfmac_f32_16x16x64_bf16 v[188:191], v[116:119], v[228:235], v47 abid:1
    v_cvt_pk_bf16_f32 v169, v170, v171
    v_smfmac_f32_16x16x64_bf16 v[192:195], v[84:87], v[220:227], v51 abid:1
    v_cvt_pk_bf16_f32 v170, v172, v173
    v_smfmac_f32_16x16x64_bf16 v[192:195], v[120:123], v[228:235], v52
    ds_read_b128 v[220:223], v1 offset:3072
    s_waitcnt lgkmcnt(6)
    v_cvt_pk_bf16_f32 v171, v174, v175
    v_smfmac_f32_16x16x64_bf16 v[124:127], a[0:3], v[196:203], v12
    ds_read_b128 v[224:227], v2 offset:3072
    ds_read_b128 v[172:175], v9 offset:10432
    s_waitcnt lgkmcnt(6)
    v_cndmask_b32_dpp v164, v160, v168, vcc row_ror:8 row_mask:0xf bank_mask:0xf
    v_smfmac_f32_16x16x64_bf16 v[124:127], a[36:39], v[204:211], v16
    ds_read_b128 v[228:231], v1 offset:4096
    s_waitcnt lgkmcnt(5)
    v_cndmask_b32_dpp v165, v161, v169, vcc row_ror:8 row_mask:0xf bank_mask:0xf
    v_smfmac_f32_16x16x64_bf16 v[124:127], a[72:75], v[212:219], v20
    ds_read_b128 v[232:235], v2 offset:4096
    s_waitcnt lgkmcnt(5)
    v_xad_u32 v236, v236, v3, v4
    v_smfmac_f32_16x16x64_bf16 v[156:159], a[32:35], v[196:203], v48
    s_barrier
    v_xad_u32 v237, v237, v3, v4
    v_smfmac_f32_16x16x64_bf16 v[156:159], a[68:71], v[204:211], v48 abid:1
    ds_read2st64_b32 v[244:245], v236 offset0:0 offset1:72
    ds_read_b128 v[240:243], v8 offset:3072
    v_xad_u32 v238, v238, v3, v4
    v_smfmac_f32_16x16x64_bf16 v[156:159], a[104:107], v[212:219], v49
    ds_read2st64_b32 v[246:247], v237 offset0:0 offset1:72
    v_xad_u32 v239, v239, v3, v4
    v_smfmac_f32_16x16x64_bf16 v[132:135], a[8:11], v[196:203], v13
    ds_read2st64_b32 v[248:249], v238 offset0:0 offset1:72
    v_cndmask_b32_dpp v166, v162, v170, vcc row_ror:8 row_mask:0xf bank_mask:0xf
    v_smfmac_f32_16x16x64_bf16 v[132:135], a[44:47], v[204:211], v17
    ds_read2st64_b32 v[250:251], v239 offset0:0 offset1:72
    ds_read_b128 v[236:239], v9 offset:9280
    v_cndmask_b32_dpp v167, v163, v171, vcc row_ror:8 row_mask:0xf bank_mask:0xf
    v_smfmac_f32_16x16x64_bf16 v[132:135], a[80:83], v[212:219], v21
    buffer_store_dwordx4 v[164:167], v6, s[12:15], s58 offen offset:0 sc1
    v_mov_b32_dpp v160, v168 row_ror:8 row_mask:0xf bank_mask:0xc
    v_smfmac_f32_16x16x64_bf16 v[140:143], a[16:19], v[196:203], v14
    v_mov_b32_dpp v161, v169 row_ror:8 row_mask:0xf bank_mask:0xc
    v_smfmac_f32_16x16x64_bf16 v[140:143], a[52:55], v[204:211], v18
    v_mov_b32_dpp v162, v170 row_ror:8 row_mask:0xf bank_mask:0xc
    v_smfmac_f32_16x16x64_bf16 v[140:143], a[88:91], v[212:219], v22
    v_mov_b32_dpp v163, v171 row_ror:8 row_mask:0xf bank_mask:0xc
    v_smfmac_f32_16x16x64_bf16 v[136:139], a[12:15], v[196:203], v13 abid:1
    buffer_store_dwordx4 v[160:163], v6, s[12:15], s23 offen offset:0 sc1
    ds_read_b128 v[164:167], v9 offset:10304
    ds_read_b128 v[168:171], v9 offset:10368
    v_smfmac_f32_16x16x64_bf16 v[136:139], a[48:51], v[204:211], v17 abid:1
    ds_read_b128 v[160:163], v9 offset:10240
    v_smfmac_f32_16x16x64_bf16 v[136:139], a[84:87], v[212:219], v21 abid:1
    s_waitcnt lgkmcnt(3)
    v_xad_u32 v236, v236, v3, v4
    v_smfmac_f32_16x16x64_bf16 v[136:139], v[240:243], v[244:251], v10
    v_xad_u32 v237, v237, v3, v4
    v_smfmac_f32_16x16x64_bf16 v[172:175], v[240:243], v[244:251], v10 abid:1
    ds_read2st64_b32 v[244:245], v236 offset0:0 offset1:72
    ds_read_b128 v[240:243], v8 offset:1024
    v_xad_u32 v238, v238, v3, v4
    v_smfmac_f32_16x16x64_bf16 v[144:147], a[20:23], v[196:203], v14 abid:1
    ds_read2st64_b32 v[246:247], v237 offset0:0 offset1:72
    v_xad_u32 v239, v239, v3, v4
    v_smfmac_f32_16x16x64_bf16 v[144:147], a[56:59], v[204:211], v18 abid:1
    ds_read2st64_b32 v[248:249], v238 offset0:0 offset1:72
    v_smfmac_f32_16x16x64_bf16 v[144:147], a[92:95], v[212:219], v22 abid:1
    ds_read2st64_b32 v[250:251], v239 offset0:0 offset1:72
    ds_read_b128 v[236:239], v9 offset:9344
    v_smfmac_f32_16x16x64_bf16 v[148:151], a[24:27], v[196:203], v15
    v_cvt_pk_bf16_f32 v192, v192, v193
    v_smfmac_f32_16x16x64_bf16 v[148:151], a[60:63], v[204:211], v19
    v_cvt_pk_bf16_f32 v193, v194, v195
    v_smfmac_f32_16x16x64_bf16 v[148:151], a[96:99], v[212:219], v23
    ds_write_b64 v53, v[192:193] offset:0
    ds_read_b128 v[192:195], v9 offset:10752
    v_smfmac_f32_16x16x64_bf16 v[152:155], a[28:31], v[196:203], v15 abid:1
    v_smfmac_f32_16x16x64_bf16 v[152:155], a[64:67], v[204:211], v19 abid:1
    v_smfmac_f32_16x16x64_bf16 v[152:155], a[100:103], v[212:219], v23 abid:1
    v_smfmac_f32_16x16x64_bf16 v[128:131], a[4:7], v[196:203], v12 abid:1
    v_smfmac_f32_16x16x64_bf16 v[128:131], a[40:43], v[204:211], v16 abid:1
    v_smfmac_f32_16x16x64_bf16 v[128:131], a[76:79], v[212:219], v20 abid:1
    s_waitcnt lgkmcnt(2)
    v_xad_u32 v236, v236, v3, v4
    v_smfmac_f32_16x16x64_bf16 v[128:131], v[240:243], v[244:251], v10
    ds_read_b128 v[196:199], v1 offset:5120
    v_xad_u32 v237, v237, v3, v4
    v_smfmac_f32_16x16x64_bf16 v[164:167], v[240:243], v[244:251], v10 abid:1
    ds_read2st64_b32 v[244:245], v236 offset0:0 offset1:72
    ds_read_b128 v[240:243], v8 offset:2048
    v_xad_u32 v238, v238, v3, v4
    v_smfmac_f32_16x16x64_bf16 v[124:127], a[108:111], v[220:227], v24
    ds_read2st64_b32 v[246:247], v237 offset0:0 offset1:72
    v_xad_u32 v239, v239, v3, v4
    v_smfmac_f32_16x16x64_bf16 v[124:127], a[144:147], v[228:235], v28
    ds_read2st64_b32 v[248:249], v238 offset0:0 offset1:72
    ds_read_b128 v[200:203], v2 offset:5120
    v_cvt_pk_bf16_f32 v176, v176, v177
    v_smfmac_f32_16x16x64_bf16 v[128:131], a[112:115], v[220:227], v24 abid:1
    ds_read2st64_b32 v[250:251], v239 offset0:0 offset1:72
    ds_read_b128 v[236:239], v9 offset:9216
    v_cvt_pk_bf16_f32 v177, v178, v179
    v_smfmac_f32_16x16x64_bf16 v[128:131], a[148:151], v[228:235], v28 abid:1
    ds_read_b128 v[204:207], v1 offset:6144
    ds_read_b64 v[216:217], v9 offset:10056
    v_cvt_pk_bf16_f32 v178, v180, v181
    v_smfmac_f32_16x16x64_bf16 v[140:143], a[124:127], v[220:227], v26
    ds_read_b128 v[208:211], v2 offset:6144
    v_cvt_pk_bf16_f32 v179, v182, v183
    v_smfmac_f32_16x16x64_bf16 v[140:143], a[160:163], v[228:235], v30
    v_cvt_pk_bf16_f32 v184, v184, v185
    v_smfmac_f32_16x16x64_bf16 v[136:139], a[120:123], v[220:227], v25 abid:1
    v_cvt_pk_bf16_f32 v185, v186, v187
    v_smfmac_f32_16x16x64_bf16 v[136:139], a[156:159], v[228:235], v29 abid:1
    v_cvt_pk_bf16_f32 v186, v188, v189
    v_smfmac_f32_16x16x64_bf16 v[132:135], a[116:119], v[220:227], v25
    v_cvt_pk_bf16_f32 v187, v190, v191
    v_smfmac_f32_16x16x64_bf16 v[132:135], a[152:155], v[228:235], v29
    ds_read_b128 v[188:191], v9 offset:10688
    s_waitcnt lgkmcnt(4)
    v_xad_u32 v236, v236, v3, v4
    v_smfmac_f32_16x16x64_bf16 v[132:135], v[240:243], v[244:251], v10
    v_xad_u32 v237, v237, v3, v4
    v_smfmac_f32_16x16x64_bf16 v[168:171], v[240:243], v[244:251], v10 abid:1
    ds_read2st64_b32 v[244:245], v236 offset0:0 offset1:72
    ds_read_b128 v[240:243], v8 offset:0
    v_xad_u32 v238, v238, v3, v4
    v_smfmac_f32_16x16x64_bf16 v[144:147], a[128:131], v[220:227], v26 abid:1
    ds_read2st64_b32 v[246:247], v237 offset0:0 offset1:72
    v_xad_u32 v239, v239, v3, v4
    v_smfmac_f32_16x16x64_bf16 v[144:147], a[164:167], v[228:235], v30 abid:1
    ds_read2st64_b32 v[248:249], v238 offset0:0 offset1:72
    v_cndmask_b32_dpp v180, v176, v184, vcc row_ror:8 row_mask:0xf bank_mask:0xf
    v_smfmac_f32_16x16x64_bf16 v[148:151], a[132:135], v[220:227], v27
    ds_read2st64_b32 v[250:251], v239 offset0:0 offset1:72
    ds_read_b128 v[236:239], v9 offset:9728
    v_cndmask_b32_dpp v181, v177, v185, vcc row_ror:8 row_mask:0xf bank_mask:0xf
    v_smfmac_f32_16x16x64_bf16 v[148:151], a[168:171], v[228:235], v31
    v_cndmask_b32_dpp v182, v178, v186, vcc row_ror:8 row_mask:0xf bank_mask:0xf
    v_smfmac_f32_16x16x64_bf16 v[152:155], a[136:139], v[220:227], v27 abid:1
    v_cndmask_b32_dpp v183, v179, v187, vcc row_ror:8 row_mask:0xf bank_mask:0xf
    v_smfmac_f32_16x16x64_bf16 v[152:155], a[172:175], v[228:235], v31 abid:1
    buffer_store_dwordx4 v[180:183], v6, s[12:15], s58 offen offset:128 sc1
    v_mov_b32_dpp v176, v184 row_ror:8 row_mask:0xf bank_mask:0xc
    v_smfmac_f32_16x16x64_bf16 v[156:159], a[140:143], v[220:227], v49 abid:1
    v_mov_b32_dpp v177, v185 row_ror:8 row_mask:0xf bank_mask:0xc
    v_smfmac_f32_16x16x64_bf16 v[156:159], a[176:179], v[228:235], v50
    ds_read_b128 v[220:223], v1 offset:7168
    v_mov_b32_dpp v178, v186 row_ror:8 row_mask:0xf bank_mask:0xc
    v_smfmac_f32_16x16x64_bf16 v[128:131], a[184:187], v[196:203], v32 abid:1
    ds_read_b128 v[224:227], v2 offset:7168
    s_waitcnt lgkmcnt(9)
    v_mov_b32_dpp v179, v187 row_ror:8 row_mask:0xf bank_mask:0xc
    v_smfmac_f32_16x16x64_bf16 v[128:131], a[220:223], v[204:211], v36 abid:1
    ds_read_b128 v[228:231], v1 offset:8192
    buffer_store_dwordx4 v[176:179], v6, s[12:15], s23 offen offset:128 sc1
    ds_read_b128 v[180:183], v9 offset:10560
    v_smfmac_f32_16x16x64_bf16 v[124:127], a[180:183], v[196:203], v32
    ds_read_b128 v[232:235], v2 offset:8192
    ds_read_b128 v[184:187], v9 offset:10624
    ds_read_b128 v[176:179], v9 offset:10496
    v_smfmac_f32_16x16x64_bf16 v[124:127], a[216:219], v[204:211], v36
    s_waitcnt lgkmcnt(7)
    v_xad_u32 v236, v236, v3, v4
    v_smfmac_f32_16x16x64_bf16 v[124:127], v[240:243], v[244:251], v10
    v_xad_u32 v237, v237, v3, v4
    v_smfmac_f32_16x16x64_bf16 v[160:163], v[240:243], v[244:251], v10 abid:1
    ds_read2st64_b32 v[244:245], v236 offset0:0 offset1:72
    ds_read_b128 v[240:243], v8 offset:8192
    v_xad_u32 v238, v238, v3, v4
    v_smfmac_f32_16x16x64_bf16 v[132:135], a[188:191], v[196:203], v33
    ds_read2st64_b32 v[246:247], v237 offset0:0 offset1:72
    v_xad_u32 v239, v239, v3, v4
    v_smfmac_f32_16x16x64_bf16 v[132:135], a[224:227], v[204:211], v37
    ds_read2st64_b32 v[248:249], v238 offset0:0 offset1:72
    v_xad_u32 v212, v216, v3, v4
    v_smfmac_f32_16x16x64_bf16 v[136:139], a[192:195], v[196:203], v33 abid:1
    ds_read2st64_b32 v[250:251], v239 offset0:0 offset1:72
    ds_read_b128 v[236:239], v9 offset:9664
    ds_read2st64_b32 v[212:213], v212 offset0:0 offset1:72
    v_smfmac_f32_16x16x64_bf16 v[136:139], a[228:231], v[204:211], v37 abid:1
    v_xad_u32 v214, v217, v3, v4
    v_smfmac_f32_16x16x64_bf16 v[140:143], a[196:199], v[196:203], v34
    ds_read2st64_b32 v[214:215], v214 offset0:0 offset1:72
    v_smfmac_f32_16x16x64_bf16 v[140:143], a[232:235], v[204:211], v38
    v_smfmac_f32_16x16x64_bf16 v[144:147], a[200:203], v[196:203], v34 abid:1
    v_smfmac_f32_16x16x64_bf16 v[144:147], a[236:239], v[204:211], v38 abid:1
    v_smfmac_f32_16x16x64_bf16 v[156:159], a[212:215], v[196:203], v50 abid:1
    v_smfmac_f32_16x16x64_bf16 v[156:159], a[248:251], v[204:211], v51
    s_waitcnt lgkmcnt(2)
    v_xad_u32 v236, v236, v3, v4
    v_smfmac_f32_16x16x64_bf16 v[156:159], v[240:243], v[244:251], v10
    v_xad_u32 v237, v237, v3, v4
    v_smfmac_f32_16x16x64_bf16 v[192:195], v[240:243], v[244:251], v10 abid:1
    ds_read2st64_b32 v[244:245], v236 offset0:0 offset1:72
    ds_read_b128 v[240:243], v8 offset:7168
    v_xad_u32 v238, v238, v3, v4
    v_smfmac_f32_16x16x64_bf16 v[152:155], a[208:211], v[196:203], v35 abid:1
    ds_read2st64_b32 v[246:247], v237 offset0:0 offset1:72
    v_xad_u32 v239, v239, v3, v4
    v_smfmac_f32_16x16x64_bf16 v[152:155], a[244:247], v[204:211], v39 abid:1
    ds_read2st64_b32 v[248:249], v238 offset0:0 offset1:72
    v_smfmac_f32_16x16x64_bf16 v[148:151], a[204:207], v[196:203], v35
    ds_read2st64_b32 v[250:251], v239 offset0:0 offset1:72
    ds_read_b128 v[236:239], v9 offset:9536
    v_smfmac_f32_16x16x64_bf16 v[148:151], a[240:243], v[204:211], v39
    ds_read_b128 v[196:199], v1 offset:18432
    v_smfmac_f32_16x16x64_bf16 v[124:127], a[252:255], v[220:227], v40
    ds_read_b128 v[200:203], v2 offset:18432
    v_smfmac_f32_16x16x64_bf16 v[124:127], v[88:91], v[228:235], v44
    ds_read_b128 v[204:207], v1 offset:19456
    v_smfmac_f32_16x16x64_bf16 v[128:131], v[56:59], v[220:227], v40 abid:1
    ds_read_b128 v[208:211], v2 offset:19456
    v_smfmac_f32_16x16x64_bf16 v[128:131], v[92:95], v[228:235], v44 abid:1
    s_waitcnt lgkmcnt(10)
    s_cmp_lt_i32 s81, 0
    s_cbranch_scc1 M_ovrF
    s_swappc_b64 s[78:79], s[72:73]
M_ovrF:
    v_smfmac_f32_16x16x64_bf16 v[132:135], v[60:63], v[220:227], v41
    s_cmp_lt_u32 s20, 2
    s_cselect_b32 s66, s23, s24
    s_add_u32 s66, s66, s95
    v_smfmac_f32_16x16x64_bf16 v[132:135], v[96:99], v[228:235], v45
    s_add_u32 s23, s24, 18432
    s_add_u32 s58, s24, 27648
    s_add_u32 s67, s23, s95
    v_smfmac_f32_16x16x64_bf16 v[152:155], v[80:83], v[220:227], v43 abid:1
    v_smfmac_f32_16x16x64_bf16 v[152:155], v[116:119], v[228:235], v47 abid:1
    s_waitcnt lgkmcnt(4)
    v_xad_u32 v236, v236, v3, v4
    v_smfmac_f32_16x16x64_bf16 v[152:155], v[240:243], v[244:251], v10
    v_xad_u32 v237, v237, v3, v4
    v_smfmac_f32_16x16x64_bf16 v[188:191], v[240:243], v[244:251], v10 abid:1
    s_cmp_gt_u32 s46, s80
    s_cbranch_scc1 M_slow
M_slowrF:
    v_xad_u32 v238, v238, v3, v4
    v_smfmac_f32_16x16x64_bf16 v[140:143], v[68:71], v[220:227], v42
    ds_read2st64_b32 v[244:245], v236 offset0:0 offset1:72
    ds_read_b128 v[240:243], v8 offset:5120
    v_xad_u32 v239, v239, v3, v4
    v_smfmac_f32_16x16x64_bf16 v[140:143], v[104:107], v[228:235], v46
    ds_read2st64_b32 v[246:247], v237 offset0:0 offset1:72
    v_smfmac_f32_16x16x64_bf16 v[156:159], v[84:87], v[220:227], v51 abid:1
    ds_read2st64_b32 v[248:249], v238 offset0:0 offset1:72
    ds_read_b128 v[212:215], v1 offset:20480
    v_smfmac_f32_16x16x64_bf16 v[156:159], v[120:123], v[228:235], v52
    ds_read2st64_b32 v[250:251], v239 offset0:0 offset1:72
    ds_read_b128 v[236:239], v9 offset:9600
    v_smfmac_f32_16x16x64_bf16 v[148:151], v[76:79], v[220:227], v43
    ds_read_b128 v[216:219], v2 offset:20480
    v_smfmac_f32_16x16x64_bf16 v[148:151], v[112:115], v[228:235], v47
    v_smfmac_f32_16x16x64_bf16 v[136:139], v[64:67], v[220:227], v41 abid:1
    v_smfmac_f32_16x16x64_bf16 v[136:139], v[100:103], v[228:235], v45 abid:1
    v_smfmac_f32_16x16x64_bf16 v[144:147], v[72:75], v[220:227], v42 abid:1
    v_smfmac_f32_16x16x64_bf16 v[144:147], v[108:111], v[228:235], v46 abid:1
    ds_read_b128 v[220:223], v1 offset:21504
    s_waitcnt lgkmcnt(2)
    v_xad_u32 v236, v236, v3, v4
    v_smfmac_f32_16x16x64_bf16 v[144:147], v[240:243], v[244:251], v10
    ds_read_b128 v[224:227], v2 offset:21504
    v_xad_u32 v237, v237, v3, v4
    v_smfmac_f32_16x16x64_bf16 v[180:183], v[240:243], v[244:251], v10 abid:1
    ds_read2st64_b32 v[244:245], v236 offset0:0 offset1:72
    ds_read_b128 v[240:243], v8 offset:6144
    v_xad_u32 v238, v238, v3, v4
    v_smfmac_f32_16x16x64_bf16 v[192:195], a[32:35], v[196:203], v48
    ds_read2st64_b32 v[246:247], v237 offset0:0 offset1:72
    ds_read_b128 v[228:231], v1 offset:22528
    v_xad_u32 v239, v239, v3, v4
    v_smfmac_f32_16x16x64_bf16 v[192:195], a[68:71], v[204:211], v48 abid:1
    ds_read2st64_b32 v[248:249], v238 offset0:0 offset1:72
    ds_read_b128 v[232:235], v2 offset:22528
    s_waitcnt lgkmcnt(8)
    v_cvt_pk_bf16_f32 v124, v124, v125
    v_smfmac_f32_16x16x64_bf16 v[192:195], a[104:107], v[212:219], v49
    ds_read2st64_b32 v[250:251], v239 offset0:0 offset1:72
    ds_read_b128 v[236:239], v9 offset:9472
    v_cvt_pk_bf16_f32 v125, v126, v127
    v_smfmac_f32_16x16x64_bf16 v[160:163], a[0:3], v[196:203], v12
    v_cvt_pk_bf16_f32 v126, v128, v129
    v_smfmac_f32_16x16x64_bf16 v[160:163], a[36:39], v[204:211], v16
    v_cvt_pk_bf16_f32 v127, v130, v131
    v_smfmac_f32_16x16x64_bf16 v[160:163], a[72:75], v[212:219], v20
    v_cvt_pk_bf16_f32 v156, v156, v157
    v_smfmac_f32_16x16x64_bf16 v[164:167], a[4:7], v[196:203], v12 abid:1
    v_cvt_pk_bf16_f32 v157, v158, v159
    v_smfmac_f32_16x16x64_bf16 v[164:167], a[40:43], v[204:211], v16 abid:1
    ds_write_b64 v53, v[156:157] offset:25728
    v_cvt_pk_bf16_f32 v132, v132, v133
    v_smfmac_f32_16x16x64_bf16 v[164:167], a[76:79], v[212:219], v20 abid:1
    v_cvt_pk_bf16_f32 v133, v134, v135
    v_smfmac_f32_16x16x64_bf16 v[168:171], a[8:11], v[196:203], v13
    v_cvt_pk_bf16_f32 v134, v136, v137
    v_smfmac_f32_16x16x64_bf16 v[168:171], a[44:47], v[204:211], v17
    v_cvt_pk_bf16_f32 v135, v138, v139
    v_smfmac_f32_16x16x64_bf16 v[168:171], a[80:83], v[212:219], v21
    s_waitcnt lgkmcnt(1)
    v_xad_u32 v236, v236, v3, v4
    v_smfmac_f32_16x16x64_bf16 v[184:187], v[240:243], v[244:251], v10 abid:1
    v_xad_u32 v237, v237, v3, v4
    v_smfmac_f32_16x16x64_bf16 v[148:151], v[240:243], v[244:251], v10
    ds_read2st64_b32 v[244:245], v236 offset0:0 offset1:72
    ds_read_b128 v[240:243], v8 offset:4096
    v_xad_u32 v238, v238, v3, v4
    v_smfmac_f32_16x16x64_bf16 v[172:175], a[12:15], v[196:203], v13 abid:1
    ds_read2st64_b32 v[246:247], v237 offset0:0 offset1:72
    v_xad_u32 v239, v239, v3, v4
    v_smfmac_f32_16x16x64_bf16 v[172:175], a[48:51], v[204:211], v17 abid:1
    ds_read2st64_b32 v[248:249], v238 offset0:0 offset1:72
    v_cndmask_b32_dpp v128, v124, v132, vcc row_ror:8 row_mask:0xf bank_mask:0xf
    v_smfmac_f32_16x16x64_bf16 v[172:175], a[84:87], v[212:219], v21 abid:1
    ds_read2st64_b32 v[250:251], v239 offset0:0 offset1:72
    ds_read_b128 v[196:199], v1 offset:23552
    v_cndmask_b32_dpp v129, v125, v133, vcc row_ror:8 row_mask:0xf bank_mask:0xf
    v_smfmac_f32_16x16x64_bf16 v[192:195], a[140:143], v[220:227], v49 abid:1
    ds_read_b128 v[200:203], v2 offset:23552
    v_cndmask_b32_dpp v130, v126, v134, vcc row_ror:8 row_mask:0xf bank_mask:0xf
    v_smfmac_f32_16x16x64_bf16 v[192:195], a[176:179], v[228:235], v50
    ds_read_b128 v[204:207], v1 offset:24576
    v_cndmask_b32_dpp v131, v127, v135, vcc row_ror:8 row_mask:0xf bank_mask:0xf
    v_smfmac_f32_16x16x64_bf16 v[160:163], a[108:111], v[220:227], v24
    ds_read_b128 v[208:211], v2 offset:24576
    buffer_store_dwordx4 v[128:131], v6, s[12:15], s59 offen offset:0 sc1
    v_mov_b32_dpp v124, v132 row_ror:8 row_mask:0xf bank_mask:0xc
    v_smfmac_f32_16x16x64_bf16 v[160:163], a[144:147], v[228:235], v28
    s_waitcnt lgkmcnt(9)
    s_barrier
    ds_read_b128 v[236:239], v8 offset:10816
    v_mov_b32_dpp v125, v133 row_ror:8 row_mask:0xf bank_mask:0xc
    v_smfmac_f32_16x16x64_bf16 v[164:167], a[112:115], v[220:227], v24 abid:1
    ds_read_b128 v[212:215], v1 offset:20480
    v_mov_b32_dpp v126, v134 row_ror:8 row_mask:0xf bank_mask:0xc
    v_smfmac_f32_16x16x64_bf16 v[164:167], a[148:151], v[228:235], v28 abid:1
    ds_read_b128 v[216:219], v2 offset:20480
    v_mov_b32_dpp v127, v135 row_ror:8 row_mask:0xf bank_mask:0xc
    v_smfmac_f32_16x16x64_bf16 v[168:171], a[116:119], v[220:227], v25
    buffer_store_dwordx4 v[124:127], v6, s[12:15], s24 offen offset:0 sc1
    v_smfmac_f32_16x16x64_bf16 v[168:171], a[152:155], v[228:235], v29
    s_waitcnt lgkmcnt(7)
    v_smfmac_f32_16x16x64_bf16 v[176:179], v[240:243], v[244:251], v10 abid:1
    v_smfmac_f32_16x16x64_bf16 v[140:143], v[240:243], v[244:251], v10
    s_waitcnt lgkmcnt(2)
    buffer_store_dwordx4 v[236:239], v7, s[12:15], s66 offen sc1
    v_smfmac_f32_16x16x64_bf16 v[172:175], a[120:123], v[220:227], v25 abid:1
    v_smfmac_f32_16x16x64_bf16 v[172:175], a[156:159], v[228:235], v29 abid:1
    ds_read_b128 v[220:223], v1 offset:25600
    v_smfmac_f32_16x16x64_bf16 v[192:195], a[212:215], v[196:203], v50 abid:1
    ds_read_b128 v[224:227], v2 offset:25600
    s_nop 0
    v_cvt_pk_bf16_f32 v140, v140, v141
    v_smfmac_f32_16x16x64_bf16 v[192:195], a[248:251], v[204:211], v51
    ds_read_b128 v[228:231], v1 offset:26624
    v_cvt_pk_bf16_f32 v141, v142, v143
    v_smfmac_f32_16x16x64_bf16 v[160:163], a[180:183], v[196:203], v32
    ds_read_b128 v[232:235], v2 offset:26624
    v_cvt_pk_bf16_f32 v142, v144, v145
    v_smfmac_f32_16x16x64_bf16 v[160:163], a[216:219], v[204:211], v36
    v_cvt_pk_bf16_f32 v143, v146, v147
    v_smfmac_f32_16x16x64_bf16 v[164:167], a[184:187], v[196:203], v32 abid:1
    v_cvt_pk_bf16_f32 v148, v148, v149
    v_smfmac_f32_16x16x64_bf16 v[164:167], a[220:223], v[204:211], v36 abid:1
    v_cvt_pk_bf16_f32 v149, v150, v151
    v_smfmac_f32_16x16x64_bf16 v[168:171], a[188:191], v[196:203], v33
    v_cvt_pk_bf16_f32 v150, v152, v153
    v_smfmac_f32_16x16x64_bf16 v[168:171], a[224:227], v[204:211], v37
    v_cvt_pk_bf16_f32 v151, v154, v155
    v_smfmac_f32_16x16x64_bf16 v[172:175], a[192:195], v[196:203], v33 abid:1
    v_cndmask_b32_dpp v144, v140, v148, vcc row_ror:8 row_mask:0xf bank_mask:0xf
    v_smfmac_f32_16x16x64_bf16 v[172:175], a[228:231], v[204:211], v37 abid:1
    ds_read_b128 v[196:199], v1 offset:18432
    s_waitcnt lgkmcnt(3)
    v_cndmask_b32_dpp v145, v141, v149, vcc row_ror:8 row_mask:0xf bank_mask:0xf
    v_smfmac_f32_16x16x64_bf16 v[192:195], v[84:87], v[220:227], v51 abid:1
    ds_read_b128 v[200:203], v2 offset:18432
    s_waitcnt lgkmcnt(2)
    v_cndmask_b32_dpp v146, v142, v150, vcc row_ror:8 row_mask:0xf bank_mask:0xf
    v_smfmac_f32_16x16x64_bf16 v[192:195], v[120:123], v[228:235], v52
    ds_read_b128 v[204:207], v1 offset:19456
    v_cndmask_b32_dpp v147, v143, v151, vcc row_ror:8 row_mask:0xf bank_mask:0xf
    v_smfmac_f32_16x16x64_bf16 v[160:163], a[252:255], v[220:227], v40
    ds_read_b128 v[208:211], v2 offset:19456
    buffer_store_dwordx4 v[144:147], v6, s[12:15], s59 offen offset:128 sc1
    v_mov_b32_dpp v140, v148 row_ror:8 row_mask:0xf bank_mask:0xc
    v_smfmac_f32_16x16x64_bf16 v[160:163], v[88:91], v[228:235], v44
    v_mov_b32_dpp v141, v149 row_ror:8 row_mask:0xf bank_mask:0xc
    v_smfmac_f32_16x16x64_bf16 v[164:167], v[56:59], v[220:227], v40 abid:1
    v_mov_b32_dpp v142, v150 row_ror:8 row_mask:0xf bank_mask:0xc
    v_smfmac_f32_16x16x64_bf16 v[164:167], v[92:95], v[228:235], v44 abid:1
    v_mov_b32_dpp v143, v151 row_ror:8 row_mask:0xf bank_mask:0xc
    v_smfmac_f32_16x16x64_bf16 v[168:171], v[60:63], v[220:227], v41
    buffer_store_dwordx4 v[140:143], v6, s[12:15], s24 offen offset:128 sc1
    v_cvt_pk_bf16_f32 v192, v192, v193
    v_smfmac_f32_16x16x64_bf16 v[168:171], v[96:99], v[228:235], v45
    v_cvt_pk_bf16_f32 v193, v194, v195
    v_smfmac_f32_16x16x64_bf16 v[172:175], v[64:67], v[220:227], v41 abid:1
    ds_write_b64 v53, v[192:193] offset:1024
    v_smfmac_f32_16x16x64_bf16 v[172:175], v[100:103], v[228:235], v45 abid:1
    ds_read_b128 v[220:223], v1 offset:21504
    s_waitcnt lgkmcnt(4)
    v_smfmac_f32_16x16x64_bf16 v[176:179], a[16:19], v[196:203], v14
    ds_read_b128 v[224:227], v2 offset:21504
    s_waitcnt lgkmcnt(3)
    v_smfmac_f32_16x16x64_bf16 v[176:179], a[52:55], v[204:211], v18
    ds_read_b128 v[228:231], v1 offset:22528
    v_smfmac_f32_16x16x64_bf16 v[176:179], a[88:91], v[212:219], v22
    ds_read_b128 v[232:235], v2 offset:22528
    s_waitcnt lgkmcnt(4)
    s_barrier
    ds_read_b128 v[236:239], v8 offset:11840
    v_smfmac_f32_16x16x64_bf16 v[180:183], a[20:23], v[196:203], v14 abid:1
    v_cvt_pk_bf16_f32 v160, v160, v161
    v_smfmac_f32_16x16x64_bf16 v[180:183], a[56:59], v[204:211], v18 abid:1
    v_cvt_pk_bf16_f32 v161, v162, v163
    v_smfmac_f32_16x16x64_bf16 v[180:183], a[92:95], v[212:219], v22 abid:1
    v_cvt_pk_bf16_f32 v162, v164, v165
    v_smfmac_f32_16x16x64_bf16 v[184:187], a[24:27], v[196:203], v15
    v_cvt_pk_bf16_f32 v163, v166, v167
    v_smfmac_f32_16x16x64_bf16 v[184:187], a[60:63], v[204:211], v19
    v_cvt_pk_bf16_f32 v168, v168, v169
    v_smfmac_f32_16x16x64_bf16 v[184:187], a[96:99], v[212:219], v23
    s_cmp_lt_u32 s20, 2
    s_waitcnt lgkmcnt(0)
    s_cbranch_scc0 M_fx
    buffer_store_dwordx4 v[236:239], v7, s[12:15], s67 offen sc1
M_fx:
    v_smfmac_f32_16x16x64_bf16 v[188:191], a[28:31], v[196:203], v15 abid:1
    v_cvt_pk_bf16_f32 v169, v170, v171
    v_smfmac_f32_16x16x64_bf16 v[188:191], a[64:67], v[204:211], v19 abid:1
    v_cvt_pk_bf16_f32 v170, v172, v173
    v_smfmac_f32_16x16x64_bf16 v[188:191], a[100:103], v[212:219], v23 abid:1
    ds_read_b128 v[196:199], v1 offset:23552
    v_cvt_pk_bf16_f32 v171, v174, v175
    v_smfmac_f32_16x16x64_bf16 v[176:179], a[124:127], v[220:227], v26
    ds_read_b128 v[200:203], v2 offset:23552
    v_cndmask_b32_dpp v164, v160, v168, vcc row_ror:8 row_mask:0xf bank_mask:0xf
    v_smfmac_f32_16x16x64_bf16 v[176:179], a[160:163], v[228:235], v30
    ds_read_b128 v[204:207], v1 offset:24576
    v_cndmask_b32_dpp v165, v161, v169, vcc row_ror:8 row_mask:0xf bank_mask:0xf
    v_smfmac_f32_16x16x64_bf16 v[180:183], a[128:131], v[220:227], v26 abid:1
    ds_read_b128 v[208:211], v2 offset:24576
    v_cndmask_b32_dpp v166, v162, v170, vcc row_ror:8 row_mask:0xf bank_mask:0xf
    v_smfmac_f32_16x16x64_bf16 v[180:183], a[164:167], v[228:235], v30 abid:1
    v_cndmask_b32_dpp v167, v163, v171, vcc row_ror:8 row_mask:0xf bank_mask:0xf
    v_smfmac_f32_16x16x64_bf16 v[184:187], a[132:135], v[220:227], v27
    buffer_store_dwordx4 v[164:167], v6, s[12:15], s58 offen offset:0 sc1
    v_mov_b32_dpp v160, v168 row_ror:8 row_mask:0xf bank_mask:0xc
    v_smfmac_f32_16x16x64_bf16 v[184:187], a[168:171], v[228:235], v31
    v_mov_b32_dpp v161, v169 row_ror:8 row_mask:0xf bank_mask:0xc
    v_smfmac_f32_16x16x64_bf16 v[188:191], a[136:139], v[220:227], v27 abid:1
    v_mov_b32_dpp v162, v170 row_ror:8 row_mask:0xf bank_mask:0xc
    v_smfmac_f32_16x16x64_bf16 v[188:191], a[172:175], v[228:235], v31 abid:1
    ds_read_b128 v[220:223], v1 offset:25600
    s_waitcnt lgkmcnt(3)
    v_mov_b32_dpp v163, v171 row_ror:8 row_mask:0xf bank_mask:0xc
    v_smfmac_f32_16x16x64_bf16 v[176:179], a[196:199], v[196:203], v34
    ds_read_b128 v[224:227], v2 offset:25600
    buffer_store_dwordx4 v[160:163], v6, s[12:15], s23 offen offset:0 sc1
    s_waitcnt lgkmcnt(2)
    v_smfmac_f32_16x16x64_bf16 v[176:179], a[232:235], v[204:211], v38
    ds_read_b128 v[228:231], v1 offset:26624
    v_smfmac_f32_16x16x64_bf16 v[180:183], a[200:203], v[196:203], v34 abid:1
    ds_read_b128 v[232:235], v2 offset:26624
    v_smfmac_f32_16x16x64_bf16 v[180:183], a[236:239], v[204:211], v38 abid:1
    v_smfmac_f32_16x16x64_bf16 v[184:187], a[204:207], v[196:203], v35
    v_smfmac_f32_16x16x64_bf16 v[184:187], a[240:243], v[204:211], v39
    v_smfmac_f32_16x16x64_bf16 v[188:191], a[208:211], v[196:203], v35 abid:1
    v_smfmac_f32_16x16x64_bf16 v[188:191], a[244:247], v[204:211], v39 abid:1
    s_waitcnt lgkmcnt(2)
    v_smfmac_f32_16x16x64_bf16 v[176:179], v[68:71], v[220:227], v42
    s_waitcnt lgkmcnt(0)
    v_smfmac_f32_16x16x64_bf16 v[176:179], v[104:107], v[228:235], v46
    v_smfmac_f32_16x16x64_bf16 v[180:183], v[72:75], v[220:227], v42 abid:1
    v_smfmac_f32_16x16x64_bf16 v[180:183], v[108:111], v[228:235], v46 abid:1
    v_smfmac_f32_16x16x64_bf16 v[184:187], v[76:79], v[220:227], v43
    v_smfmac_f32_16x16x64_bf16 v[184:187], v[112:115], v[228:235], v47
    v_smfmac_f32_16x16x64_bf16 v[188:191], v[80:83], v[220:227], v43 abid:1
    v_smfmac_f32_16x16x64_bf16 v[188:191], v[116:119], v[228:235], v47 abid:1
    s_nop 1
    v_cvt_pk_bf16_f32 v176, v176, v177
    v_cvt_pk_bf16_f32 v177, v178, v179
    v_cvt_pk_bf16_f32 v178, v180, v181
    v_cvt_pk_bf16_f32 v179, v182, v183
    v_cvt_pk_bf16_f32 v184, v184, v185
    v_cvt_pk_bf16_f32 v185, v186, v187
    v_cvt_pk_bf16_f32 v186, v188, v189
    v_cvt_pk_bf16_f32 v187, v190, v191
    v_cndmask_b32_dpp v180, v176, v184, vcc row_ror:8 row_mask:0xf bank_mask:0xf
    v_cndmask_b32_dpp v181, v177, v185, vcc row_ror:8 row_mask:0xf bank_mask:0xf
    v_cndmask_b32_dpp v182, v178, v186, vcc row_ror:8 row_mask:0xf bank_mask:0xf
    v_cndmask_b32_dpp v183, v179, v187, vcc row_ror:8 row_mask:0xf bank_mask:0xf
    buffer_store_dwordx4 v[180:183], v6, s[12:15], s58 offen offset:128 sc1
    v_mov_b32_dpp v176, v184 row_ror:8 row_mask:0xf bank_mask:0xc
    v_mov_b32_dpp v177, v185 row_ror:8 row_mask:0xf bank_mask:0xc
    v_mov_b32_dpp v178, v186 row_ror:8 row_mask:0xf bank_mask:0xc
    v_mov_b32_dpp v179, v187 row_ror:8 row_mask:0xf bank_mask:0xc
    buffer_store_dwordx4 v[176:179], v6, s[12:15], s23 offen offset:128 sc1
M_end:
    s_endpgm
M_pf_spin:
    s_sleep 4
    v_mov_b32 v0, 0
    s_mov_b64 exec, 1
    buffer_atomic_add v0, off, s[16:19], s96 sc0 sc1
    s_mov_b64 exec, -1
    s_add_u32 s31, s31, 1
    s_waitcnt vmcnt(0)
    v_readfirstlane_b32 s30, v0
    s_nop 0
    s_sub_u32 s30, s30, s100
    s_cmp_eq_u32 s30, 27
    s_cbranch_scc1 M_pf_ok
    s_cmp_lt_u32 s31, 24
    s_cbranch_scc1 M_pf_spin
    s_cmp_eq_u32 s98, 0
    s_cbranch_scc1 M_pf_spin2
    s_mov_b32 s98, 0
    v_mov_b32 v250, 1
    s_mov_b64 exec, 1
    buffer_atomic_add v250, off, s[68:71], 0 offset:0 sc1
    s_mov_b64 exec, -1
    s_nop 3
M_pf_spin2:
    s_sleep 16
    buffer_load_dword v0, off, s[68:71], 0 offset:0 sc1
    s_add_u32 s31, s31, 1
    s_cmp_ge_u32 s31, 131072
    s_cbranch_scc1 M_end
    s_waitcnt vmcnt(0)
    v_readfirstlane_b32 s30, v0
    s_nop 0
    s_cmp_eq_u32 s30, 81
    s_cbranch_scc0 M_pf_spin2
    s_branch M_pf_ok
M_r3:
    v_bfe_u32 v74, v60, 24, 4
    v_lshlrev_b32 v75, 1, v60
    v_lshl_add_u32 v74, v74, 2, s49
    v_and_b32 v75, 16, v75
    v_and_or_b32 v74, v60, 2.0, v74
    v_lshlrev_b32 v75, v75, 1
    ds_add_rtn_u32 v64, v74, v75
    v_and_b32 v74, 8, v60
    v_lshrrev_b32 v77, 14, v60
    v_cmp_ne_u32 s[44:45], 0, v74
    v_and_b32 v80, 0x3cf0, v77
    s_waitcnt lgkmcnt(0)
    v_lshrrev_b32 v75, 16, v64
    v_and_b32 v76, 0xffff, v64
    v_sub_u32 v74, 15, v75
    v_and_b32 v64, 2.0, v60
    v_add3_u32 v64, v76, v75, v64
    v_cndmask_b32 v74, v76, v74, s[44:45]
    v_cmp_gt_u32 s[44:45], 16, v64
    v_cmp_gt_u32 s[36:37], 2.0, v64
    v_lshlrev_b32 v74, 2, v74
    v_lshrrev_b64 v[76:77], v74, s[50:51]
    s_andn2_b64 s[36:37], s[36:37], s[44:45]
    v_lshrrev_b64 v[78:79], v74, s[52:53]
    v_bfe_u32 v74, v60, 24, 4
    v_mbcnt_lo_u32_b32 v75, s36, 0
    v_and_b32 v76, 15, v76
    v_mbcnt_hi_u32_b32 v75, s37, v75
    v_and_b32 v78, 15, v78
    v_lshl_add_u32 v75, v75, 3, s40
    v_lshl_add_u32 v76, v74, 4, v76
    v_min_u32 v75, s41, v75
    v_mul_u32_u24 v78, 68, v78
    v_cndmask_b32 v75, v82, v75, s[36:37]
    ds_write_b64 v75, v[60:61]
    s_bcnt1_i32_b64 s30, s[36:37]
    s_lshl3_add_u32 s40, s30, s40
    v_lshl_add_u32 v76, v76, 2, s47
    v_and_b32 v78, 0x30c, v78
    v_cndmask_b32 v76, v82, v76, s[44:45]
    v_add3_u32 v77, v80, v78, s29
    v_and_b32 v78, 0x3fff, v60
    v_cndmask_b32 v74, v82, v77, s[44:45]
    ds_write_b32 v76, v78
    ds_write_b32 v74, v61
    s_cmp_gt_u32 s38, s39
    s_cselect_b32 s32, 1, s32
    s_branch M_r3r
M_dn:
    s_mov_b32 s27, 0
    s_mov_b32 s46, 0x80000000
    v_mov_b32 v244, 0
    v_mov_b32 v245, 0
    v_mov_b32 v246, 0
    v_mov_b32 v247, 0
    ds_write_b128 v8, v[244:247] offset:0
    ds_write_b128 v8, v[244:247] offset:1024
    ds_write_b128 v8, v[244:247] offset:2048
    ds_write_b128 v8, v[244:247] offset:3072
    ds_write_b128 v8, v[244:247] offset:4096
    ds_write_b128 v8, v[244:247] offset:5120
    ds_write_b128 v8, v[244:247] offset:6144
    ds_write_b128 v8, v[244:247] offset:7168
    ds_write_b128 v8, v[244:247] offset:8192
    s_waitcnt lgkmcnt(0)
    s_branch M_dnr
M_ovc0:
    v_smfmac_f32_16x16x32_bf16 v[124:127], v[54:55], v[212:215], v10
    v_smfmac_f32_16x16x32_bf16 v[160:163], v[54:55], v[212:215], v10 abid:2
    s_setpc_b64 s[74:75]
    v_smfmac_f32_16x16x32_bf16 v[128:131], v[54:55], v[212:215], v10
    v_smfmac_f32_16x16x32_bf16 v[164:167], v[54:55], v[212:215], v10 abid:2
    s_setpc_b64 s[74:75]
    v_smfmac_f32_16x16x32_bf16 v[132:135], v[54:55], v[212:215], v10
    v_smfmac_f32_16x16x32_bf16 v[168:171], v[54:55], v[212:215], v10 abid:2
    s_setpc_b64 s[74:75]
    v_smfmac_f32_16x16x32_bf16 v[136:139], v[54:55], v[212:215], v10
    v_smfmac_f32_16x16x32_bf16 v[172:175], v[54:55], v[212:215], v10 abid:2
    s_setpc_b64 s[74:75]
    v_smfmac_f32_16x16x32_bf16 v[140:143], v[54:55], v[212:215], v10
    v_smfmac_f32_16x16x32_bf16 v[176:179], v[54:55], v[212:215], v10 abid:2
    s_setpc_b64 s[74:75]
    v_smfmac_f32_16x16x32_bf16 v[144:147], v[54:55], v[212:215], v10
    v_smfmac_f32_16x16x32_bf16 v[180:183], v[54:55], v[212:215], v10 abid:2
    s_setpc_b64 s[74:75]
    v_smfmac_f32_16x16x32_bf16 v[148:151], v[54:55], v[212:215], v10
    v_smfmac_f32_16x16x32_bf16 v[184:187], v[54:55], v[212:215], v10 abid:2
    s_setpc_b64 s[74:75]
    v_smfmac_f32_16x16x32_bf16 v[152:155], v[54:55], v[212:215], v10
    v_smfmac_f32_16x16x32_bf16 v[188:191], v[54:55], v[212:215], v10 abid:2
    s_setpc_b64 s[74:75]
    v_smfmac_f32_16x16x32_bf16 v[156:159], v[54:55], v[212:215], v10
    v_smfmac_f32_16x16x32_bf16 v[192:195], v[54:55], v[212:215], v10 abid:2
    s_setpc_b64 s[74:75]
M_ovl0:
    v_smfmac_f32_16x16x32_bf16 v[124:127], v[54:55], v[212:215], v10
    v_smfmac_f32_16x16x32_bf16 v[160:163], v[54:55], v[212:215], v10 abid:2
    s_setpc_b64 s[78:79]
    v_smfmac_f32_16x16x32_bf16 v[128:131], v[54:55], v[212:215], v10
    v_smfmac_f32_16x16x32_bf16 v[164:167], v[54:55], v[212:215], v10 abid:2
    s_setpc_b64 s[78:79]
    v_smfmac_f32_16x16x32_bf16 v[132:135], v[54:55], v[212:215], v10
    v_smfmac_f32_16x16x32_bf16 v[168:171], v[54:55], v[212:215], v10 abid:2
    s_setpc_b64 s[78:79]
    v_smfmac_f32_16x16x32_bf16 v[136:139], v[54:55], v[212:215], v10
    v_smfmac_f32_16x16x32_bf16 v[172:175], v[54:55], v[212:215], v10 abid:2
    s_setpc_b64 s[78:79]
    v_smfmac_f32_16x16x32_bf16 v[140:143], v[54:55], v[212:215], v10
    v_smfmac_f32_16x16x32_bf16 v[176:179], v[54:55], v[212:215], v10 abid:2
    s_setpc_b64 s[78:79]
    v_smfmac_f32_16x16x32_bf16 v[144:147], v[54:55], v[212:215], v10
    v_smfmac_f32_16x16x32_bf16 v[180:183], v[54:55], v[212:215], v10 abid:2
    s_setpc_b64 s[78:79]
    v_smfmac_f32_16x16x32_bf16 v[148:151], v[54:55], v[212:215], v10
    v_smfmac_f32_16x16x32_bf16 v[184:187], v[54:55], v[212:215], v10 abid:2
    s_setpc_b64 s[78:79]
    v_smfmac_f32_16x16x32_bf16 v[152:155], v[54:55], v[212:215], v10
    v_smfmac_f32_16x16x32_bf16 v[188:191], v[54:55], v[212:215], v10 abid:2
    s_setpc_b64 s[78:79]
    v_smfmac_f32_16x16x32_bf16 v[156:159], v[54:55], v[212:215], v10
    v_smfmac_f32_16x16x32_bf16 v[192:195], v[54:55], v[212:215], v10 abid:2
    s_setpc_b64 s[78:79]
M_ovc1:
    v_smfmac_f32_16x16x32_bf16 v[124:127], v[252:253], v[212:215], v10
    v_smfmac_f32_16x16x32_bf16 v[160:163], v[252:253], v[212:215], v10 abid:2
    s_setpc_b64 s[76:77]
    v_smfmac_f32_16x16x32_bf16 v[128:131], v[252:253], v[212:215], v10
    v_smfmac_f32_16x16x32_bf16 v[164:167], v[252:253], v[212:215], v10 abid:2
    s_setpc_b64 s[76:77]
    v_smfmac_f32_16x16x32_bf16 v[132:135], v[252:253], v[212:215], v10
    v_smfmac_f32_16x16x32_bf16 v[168:171], v[252:253], v[212:215], v10 abid:2
    s_setpc_b64 s[76:77]
    v_smfmac_f32_16x16x32_bf16 v[136:139], v[252:253], v[212:215], v10
    v_smfmac_f32_16x16x32_bf16 v[172:175], v[252:253], v[212:215], v10 abid:2
    s_setpc_b64 s[76:77]
    v_smfmac_f32_16x16x32_bf16 v[140:143], v[252:253], v[212:215], v10
    v_smfmac_f32_16x16x32_bf16 v[176:179], v[252:253], v[212:215], v10 abid:2
    s_setpc_b64 s[76:77]
    v_smfmac_f32_16x16x32_bf16 v[144:147], v[252:253], v[212:215], v10
    v_smfmac_f32_16x16x32_bf16 v[180:183], v[252:253], v[212:215], v10 abid:2
    s_setpc_b64 s[76:77]
    v_smfmac_f32_16x16x32_bf16 v[148:151], v[252:253], v[212:215], v10
    v_smfmac_f32_16x16x32_bf16 v[184:187], v[252:253], v[212:215], v10 abid:2
    s_setpc_b64 s[76:77]
    v_smfmac_f32_16x16x32_bf16 v[152:155], v[252:253], v[212:215], v10
    v_smfmac_f32_16x16x32_bf16 v[188:191], v[252:253], v[212:215], v10 abid:2
    s_setpc_b64 s[76:77]
    v_smfmac_f32_16x16x32_bf16 v[156:159], v[252:253], v[212:215], v10
    v_smfmac_f32_16x16x32_bf16 v[192:195], v[252:253], v[212:215], v10 abid:2
    s_setpc_b64 s[76:77]
M_ovl1:
    v_smfmac_f32_16x16x32_bf16 v[124:127], v[252:253], v[212:215], v10
    v_smfmac_f32_16x16x32_bf16 v[160:163], v[252:253], v[212:215], v10 abid:2
    s_setpc_b64 s[78:79]
    v_smfmac_f32_16x16x32_bf16 v[128:131], v[252:253], v[212:215], v10
    v_smfmac_f32_16x16x32_bf16 v[164:167], v[252:253], v[212:215], v10 abid:2
    s_setpc_b64 s[78:79]
    v_smfmac_f32_16x16x32_bf16 v[132:135], v[252:253], v[212:215], v10
    v_smfmac_f32_16x16x32_bf16 v[168:171], v[252:253], v[212:215], v10 abid:2
    s_setpc_b64 s[78:79]
    v_smfmac_f32_16x16x32_bf16 v[136:139], v[252:253], v[212:215], v10
    v_smfmac_f32_16x16x32_bf16 v[172:175], v[252:253], v[212:215], v10 abid:2
    s_setpc_b64 s[78:79]
    v_smfmac_f32_16x16x32_bf16 v[140:143], v[252:253], v[212:215], v10
    v_smfmac_f32_16x16x32_bf16 v[176:179], v[252:253], v[212:215], v10 abid:2
    s_setpc_b64 s[78:79]
    v_smfmac_f32_16x16x32_bf16 v[144:147], v[252:253], v[212:215], v10
    v_smfmac_f32_16x16x32_bf16 v[180:183], v[252:253], v[212:215], v10 abid:2
    s_setpc_b64 s[78:79]
    v_smfmac_f32_16x16x32_bf16 v[148:151], v[252:253], v[212:215], v10
    v_smfmac_f32_16x16x32_bf16 v[184:187], v[252:253], v[212:215], v10 abid:2
    s_setpc_b64 s[78:79]
    v_smfmac_f32_16x16x32_bf16 v[152:155], v[252:253], v[212:215], v10
    v_smfmac_f32_16x16x32_bf16 v[188:191], v[252:253], v[212:215], v10 abid:2
    s_setpc_b64 s[78:79]
    v_smfmac_f32_16x16x32_bf16 v[156:159], v[252:253], v[212:215], v10
    v_smfmac_f32_16x16x32_bf16 v[192:195], v[252:253], v[212:215], v10 abid:2
    s_setpc_b64 s[78:79]
M_ovl2:
    v_smfmac_f32_16x16x32_bf16 v[124:127], v[254:255], v[212:215], v10
    v_smfmac_f32_16x16x32_bf16 v[160:163], v[254:255], v[212:215], v10 abid:2
    s_setpc_b64 s[78:79]
    v_smfmac_f32_16x16x32_bf16 v[128:131], v[254:255], v[212:215], v10
    v_smfmac_f32_16x16x32_bf16 v[164:167], v[254:255], v[212:215], v10 abid:2
    s_setpc_b64 s[78:79]
    v_smfmac_f32_16x16x32_bf16 v[132:135], v[254:255], v[212:215], v10
    v_smfmac_f32_16x16x32_bf16 v[168:171], v[254:255], v[212:215], v10 abid:2
    s_setpc_b64 s[78:79]
    v_smfmac_f32_16x16x32_bf16 v[136:139], v[254:255], v[212:215], v10
    v_smfmac_f32_16x16x32_bf16 v[172:175], v[254:255], v[212:215], v10 abid:2
    s_setpc_b64 s[78:79]
    v_smfmac_f32_16x16x32_bf16 v[140:143], v[254:255], v[212:215], v10
    v_smfmac_f32_16x16x32_bf16 v[176:179], v[254:255], v[212:215], v10 abid:2
    s_setpc_b64 s[78:79]
    v_smfmac_f32_16x16x32_bf16 v[144:147], v[254:255], v[212:215], v10
    v_smfmac_f32_16x16x32_bf16 v[180:183], v[254:255], v[212:215], v10 abid:2
    s_setpc_b64 s[78:79]
    v_smfmac_f32_16x16x32_bf16 v[148:151], v[254:255], v[212:215], v10
    v_smfmac_f32_16x16x32_bf16 v[184:187], v[254:255], v[212:215], v10 abid:2
    s_setpc_b64 s[78:79]
    v_smfmac_f32_16x16x32_bf16 v[152:155], v[254:255], v[212:215], v10
    v_smfmac_f32_16x16x32_bf16 v[188:191], v[254:255], v[212:215], v10 abid:2
    s_setpc_b64 s[78:79]
    v_smfmac_f32_16x16x32_bf16 v[156:159], v[254:255], v[212:215], v10
    v_smfmac_f32_16x16x32_bf16 v[192:195], v[254:255], v[212:215], v10 abid:2
    s_setpc_b64 s[78:79]
M_ovn:
    s_setpc_b64 s[78:79]
M_slow:
    s_bitcmp1_b32 s46, 31
    s_cbranch_scc1 M_dense
    s_mov_b32 s56, s80
M_sl:
    s_lshl_b32 s57, s56, 6
    v_add_u32 v240, s57, v9
    ds_read_b128 v[248:251], v240 offset:9792
    s_waitcnt lgkmcnt(0)
    v_and_b32 v240, 0x3fff, v248
    v_and_b32 v241, 0x3fff, v250
    v_xad_u32 v240, v240, v3, v4
    v_xad_u32 v241, v241, v3, v4
    ds_read2st64_b32 v[244:245], v240 offset0:0 offset1:72
    ds_read2st64_b32 v[246:247], v241 offset0:0 offset1:72
    v_subrev_u32 v240, s29, v8
    v_bfe_u32 v240, v240, 4, 4
    s_waitcnt lgkmcnt(0)
    s_bitcmp1_b32 s27, 0
    s_cbranch_scc0 M_sle0
    v_lshrrev_b32 v242, 18, v248
    v_lshrrev_b32 v243, 18, v250
    v_or_b32 v241, 0, v240
    v_cmp_eq_u32 s[44:45], v242, v241
    v_cmp_eq_u32 s[54:55], v243, v241
    s_nop 0
    v_cndmask_b32 v242, 0, v249, s[44:45]
    v_cndmask_b32 v243, 0, v251, s[54:55]
    s_nop 1
    v_smfmac_f32_16x16x32_bf16 v[124:127], v[242:243], v[244:247], v10
    v_smfmac_f32_16x16x32_bf16 v[160:163], v[242:243], v[244:247], v10 abid:2
M_sle0:
    s_bitcmp1_b32 s27, 1
    s_cbranch_scc0 M_sle1
    v_lshrrev_b32 v242, 18, v248
    v_lshrrev_b32 v243, 18, v250
    v_or_b32 v241, 64, v240
    v_cmp_eq_u32 s[44:45], v242, v241
    v_cmp_eq_u32 s[54:55], v243, v241
    s_nop 0
    v_cndmask_b32 v242, 0, v249, s[44:45]
    v_cndmask_b32 v243, 0, v251, s[54:55]
    s_nop 1
    v_smfmac_f32_16x16x32_bf16 v[128:131], v[242:243], v[244:247], v10
    v_smfmac_f32_16x16x32_bf16 v[164:167], v[242:243], v[244:247], v10 abid:2
M_sle1:
    s_bitcmp1_b32 s27, 2
    s_cbranch_scc0 M_sle2
    v_lshrrev_b32 v242, 18, v248
    v_lshrrev_b32 v243, 18, v250
    v_or_b32 v241, 128, v240
    v_cmp_eq_u32 s[44:45], v242, v241
    v_cmp_eq_u32 s[54:55], v243, v241
    s_nop 0
    v_cndmask_b32 v242, 0, v249, s[44:45]
    v_cndmask_b32 v243, 0, v251, s[54:55]
    s_nop 1
    v_smfmac_f32_16x16x32_bf16 v[132:135], v[242:243], v[244:247], v10
    v_smfmac_f32_16x16x32_bf16 v[168:171], v[242:243], v[244:247], v10 abid:2
M_sle2:
    s_bitcmp1_b32 s27, 3
    s_cbranch_scc0 M_sle3
    v_lshrrev_b32 v242, 18, v248
    v_lshrrev_b32 v243, 18, v250
    v_or_b32 v241, 192, v240
    v_cmp_eq_u32 s[44:45], v242, v241
    v_cmp_eq_u32 s[54:55], v243, v241
    s_nop 0
    v_cndmask_b32 v242, 0, v249, s[44:45]
    v_cndmask_b32 v243, 0, v251, s[54:55]
    s_nop 1
    v_smfmac_f32_16x16x32_bf16 v[136:139], v[242:243], v[244:247], v10
    v_smfmac_f32_16x16x32_bf16 v[172:175], v[242:243], v[244:247], v10 abid:2
M_sle3:
    s_bitcmp1_b32 s27, 4
    s_cbranch_scc0 M_sle4
    v_lshrrev_b32 v242, 18, v248
    v_lshrrev_b32 v243, 18, v250
    v_or_b32 v241, 256, v240
    v_cmp_eq_u32 s[44:45], v242, v241
    v_cmp_eq_u32 s[54:55], v243, v241
    s_nop 0
    v_cndmask_b32 v242, 0, v249, s[44:45]
    v_cndmask_b32 v243, 0, v251, s[54:55]
    s_nop 1
    v_smfmac_f32_16x16x32_bf16 v[140:143], v[242:243], v[244:247], v10
    v_smfmac_f32_16x16x32_bf16 v[176:179], v[242:243], v[244:247], v10 abid:2
M_sle4:
    s_bitcmp1_b32 s27, 5
    s_cbranch_scc0 M_sle5
    v_lshrrev_b32 v242, 18, v248
    v_lshrrev_b32 v243, 18, v250
    v_or_b32 v241, 320, v240
    v_cmp_eq_u32 s[44:45], v242, v241
    v_cmp_eq_u32 s[54:55], v243, v241
    s_nop 0
    v_cndmask_b32 v242, 0, v249, s[44:45]
    v_cndmask_b32 v243, 0, v251, s[54:55]
    s_nop 1
    v_smfmac_f32_16x16x32_bf16 v[144:147], v[242:243], v[244:247], v10
    v_smfmac_f32_16x16x32_bf16 v[180:183], v[242:243], v[244:247], v10 abid:2
M_sle5:
    s_bitcmp1_b32 s27, 6
    s_cbranch_scc0 M_sle6
    v_lshrrev_b32 v242, 18, v248
    v_lshrrev_b32 v243, 18, v250
    v_or_b32 v241, 384, v240
    v_cmp_eq_u32 s[44:45], v242, v241
    v_cmp_eq_u32 s[54:55], v243, v241
    s_nop 0
    v_cndmask_b32 v242, 0, v249, s[44:45]
    v_cndmask_b32 v243, 0, v251, s[54:55]
    s_nop 1
    v_smfmac_f32_16x16x32_bf16 v[148:151], v[242:243], v[244:247], v10
    v_smfmac_f32_16x16x32_bf16 v[184:187], v[242:243], v[244:247], v10 abid:2
M_sle6:
    s_bitcmp1_b32 s27, 7
    s_cbranch_scc0 M_sle7
    v_lshrrev_b32 v242, 18, v248
    v_lshrrev_b32 v243, 18, v250
    v_or_b32 v241, 448, v240
    v_cmp_eq_u32 s[44:45], v242, v241
    v_cmp_eq_u32 s[54:55], v243, v241
    s_nop 0
    v_cndmask_b32 v242, 0, v249, s[44:45]
    v_cndmask_b32 v243, 0, v251, s[54:55]
    s_nop 1
    v_smfmac_f32_16x16x32_bf16 v[152:155], v[242:243], v[244:247], v10
    v_smfmac_f32_16x16x32_bf16 v[188:191], v[242:243], v[244:247], v10 abid:2
M_sle7:
    s_bitcmp1_b32 s27, 8
    s_cbranch_scc0 M_sle8
    v_lshrrev_b32 v242, 18, v248
    v_lshrrev_b32 v243, 18, v250
    v_or_b32 v241, 512, v240
    v_cmp_eq_u32 s[44:45], v242, v241
    v_cmp_eq_u32 s[54:55], v243, v241
    s_nop 0
    v_cndmask_b32 v242, 0, v249, s[44:45]
    v_cndmask_b32 v243, 0, v251, s[54:55]
    s_nop 1
    v_smfmac_f32_16x16x32_bf16 v[156:159], v[242:243], v[244:247], v10
    v_smfmac_f32_16x16x32_bf16 v[192:195], v[242:243], v[244:247], v10 abid:2
M_sle8:
    s_add_u32 s56, s56, 1
    s_cmp_lt_u32 s56, s46
    s_cbranch_scc1 M_sl
M_slx:
    s_nop 7
    s_cmp_eq_u32 s21, 1
    s_cbranch_scc1 M_slowrL
    s_cmp_eq_u32 s21, 2
    s_cbranch_scc1 M_slowrE0
    s_cmp_eq_u32 s21, 3
    s_cbranch_scc1 M_slowrF
    s_branch M_slowr0
M_dense:
    s_mul_i32 s57, s20, 82944
    s_add_u32 s57, s57, 393216
    s_mov_b32 s56, 0
    v_mov_b32 v54, v1
    v_mov_b32 v55, v2
    v_subrev_u32 v252, s29, v8
M_dn0:
    ds_read_b128 v[244:247], v54 offset:0
    ds_read_b128 v[248:251], v55 offset:0
    v_add_u32 v54, 1024, v54
    v_add_u32 v55, 1024, v55
    buffer_load_dwordx4 v[240:243], v252, s[16:19], s57 offen sc1
    s_add_u32 s57, s57, 1024
    s_waitcnt vmcnt(0) lgkmcnt(0)
    v_smfmac_f32_16x16x64_bf16 v[124:127], v[240:243], v[244:251], v10
    buffer_load_dwordx4 v[240:243], v252, s[16:19], s57 offen sc1
    s_add_u32 s57, s57, 1024
    s_waitcnt vmcnt(0) lgkmcnt(0)
    v_smfmac_f32_16x16x64_bf16 v[128:131], v[240:243], v[244:251], v10
    buffer_load_dwordx4 v[240:243], v252, s[16:19], s57 offen sc1
    s_add_u32 s57, s57, 1024
    s_waitcnt vmcnt(0) lgkmcnt(0)
    v_smfmac_f32_16x16x64_bf16 v[132:135], v[240:243], v[244:251], v10
    buffer_load_dwordx4 v[240:243], v252, s[16:19], s57 offen sc1
    s_add_u32 s57, s57, 1024
    s_waitcnt vmcnt(0) lgkmcnt(0)
    v_smfmac_f32_16x16x64_bf16 v[136:139], v[240:243], v[244:251], v10
    buffer_load_dwordx4 v[240:243], v252, s[16:19], s57 offen sc1
    s_add_u32 s57, s57, 1024
    s_waitcnt vmcnt(0) lgkmcnt(0)
    v_smfmac_f32_16x16x64_bf16 v[140:143], v[240:243], v[244:251], v10
    buffer_load_dwordx4 v[240:243], v252, s[16:19], s57 offen sc1
    s_add_u32 s57, s57, 1024
    s_waitcnt vmcnt(0) lgkmcnt(0)
    v_smfmac_f32_16x16x64_bf16 v[144:147], v[240:243], v[244:251], v10
    buffer_load_dwordx4 v[240:243], v252, s[16:19], s57 offen sc1
    s_add_u32 s57, s57, 1024
    s_waitcnt vmcnt(0) lgkmcnt(0)
    v_smfmac_f32_16x16x64_bf16 v[148:151], v[240:243], v[244:251], v10
    buffer_load_dwordx4 v[240:243], v252, s[16:19], s57 offen sc1
    s_add_u32 s57, s57, 1024
    s_waitcnt vmcnt(0) lgkmcnt(0)
    v_smfmac_f32_16x16x64_bf16 v[152:155], v[240:243], v[244:251], v10
    buffer_load_dwordx4 v[240:243], v252, s[16:19], s57 offen sc1
    s_add_u32 s57, s57, 1024
    s_waitcnt vmcnt(0) lgkmcnt(0)
    v_smfmac_f32_16x16x64_bf16 v[156:159], v[240:243], v[244:251], v10
    s_add_u32 s56, s56, 1
    s_cmp_lt_u32 s56, 9
    s_cbranch_scc1 M_dn0
    s_mul_i32 s57, s20, 82944
    s_add_u32 s57, s57, 393216
    s_mov_b32 s56, 0
    v_mov_b32 v54, v1
    v_mov_b32 v55, v2
    v_subrev_u32 v252, s29, v8
M_dn1:
    ds_read_b128 v[244:247], v54 offset:18432
    ds_read_b128 v[248:251], v55 offset:18432
    v_add_u32 v54, 1024, v54
    v_add_u32 v55, 1024, v55
    buffer_load_dwordx4 v[240:243], v252, s[16:19], s57 offen sc1
    s_add_u32 s57, s57, 1024
    s_waitcnt vmcnt(0) lgkmcnt(0)
    v_smfmac_f32_16x16x64_bf16 v[160:163], v[240:243], v[244:251], v10
    buffer_load_dwordx4 v[240:243], v252, s[16:19], s57 offen sc1
    s_add_u32 s57, s57, 1024
    s_waitcnt vmcnt(0) lgkmcnt(0)
    v_smfmac_f32_16x16x64_bf16 v[164:167], v[240:243], v[244:251], v10
    buffer_load_dwordx4 v[240:243], v252, s[16:19], s57 offen sc1
    s_add_u32 s57, s57, 1024
    s_waitcnt vmcnt(0) lgkmcnt(0)
    v_smfmac_f32_16x16x64_bf16 v[168:171], v[240:243], v[244:251], v10
    buffer_load_dwordx4 v[240:243], v252, s[16:19], s57 offen sc1
    s_add_u32 s57, s57, 1024
    s_waitcnt vmcnt(0) lgkmcnt(0)
    v_smfmac_f32_16x16x64_bf16 v[172:175], v[240:243], v[244:251], v10
    buffer_load_dwordx4 v[240:243], v252, s[16:19], s57 offen sc1
    s_add_u32 s57, s57, 1024
    s_waitcnt vmcnt(0) lgkmcnt(0)
    v_smfmac_f32_16x16x64_bf16 v[176:179], v[240:243], v[244:251], v10
    buffer_load_dwordx4 v[240:243], v252, s[16:19], s57 offen sc1
    s_add_u32 s57, s57, 1024
    s_waitcnt vmcnt(0) lgkmcnt(0)
    v_smfmac_f32_16x16x64_bf16 v[180:183], v[240:243], v[244:251], v10
    buffer_load_dwordx4 v[240:243], v252, s[16:19], s57 offen sc1
    s_add_u32 s57, s57, 1024
    s_waitcnt vmcnt(0) lgkmcnt(0)
    v_smfmac_f32_16x16x64_bf16 v[184:187], v[240:243], v[244:251], v10
    buffer_load_dwordx4 v[240:243], v252, s[16:19], s57 offen sc1
    s_add_u32 s57, s57, 1024
    s_waitcnt vmcnt(0) lgkmcnt(0)
    v_smfmac_f32_16x16x64_bf16 v[188:191], v[240:243], v[244:251], v10
    buffer_load_dwordx4 v[240:243], v252, s[16:19], s57 offen sc1
    s_add_u32 s57, s57, 1024
    s_waitcnt vmcnt(0) lgkmcnt(0)
    v_smfmac_f32_16x16x64_bf16 v[192:195], v[240:243], v[244:251], v10
    s_add_u32 s56, s56, 1
    s_cmp_lt_u32 s56, 9
    s_cbranch_scc1 M_dn1
    s_branch M_slx
M_codeend:
.section .rodata,"a"
.p2align 6
.amdhsa_kernel standalone__structured_sparse_n_m__ragged_kernel
  .amdhsa_next_free_vgpr 512
  .amdhsa_next_free_sgpr 102
  .amdhsa_accum_offset 256
  .amdhsa_group_segment_fixed_size 0
  .amdhsa_kernarg_size 48
  .amdhsa_user_sgpr_count 2
  .amdhsa_user_sgpr_kernarg_segment_ptr 1
  .amdhsa_system_sgpr_workgroup_id_x 1
  .amdhsa_float_denorm_mode_32 3
.end_amdhsa_kernel
```

```asm
; @launch grid=(256,1,1) block=(256,1,1) lds=162064
.amdgcn_target "amdgcn-amd-amdhsa--gfx950"
.text
.globl standalone__structured_sparse_n_m__ragged_kernel
.p2align 8
.type standalone__structured_sparse_n_m__ragged_kernel,@function
standalone__structured_sparse_n_m__ragged_kernel:
    s_cmp_ge_u32 s2, 256
    s_cbranch_scc1 M_end
    s_load_dwordx8 s[72:79], s[0:1], 0
    s_load_dwordx4 s[80:83], s[0:1], 32
    s_getpc_b64 s[84:85]
    s_lshr_b32 s30, s2, 3
    s_and_b32 s30, s30, 15
    s_lshl_b32 s30, s30, 11
    s_and_b32 s84, s84, 0xffffff00
    s_cmp_ge_u32 s2, 88
    s_cselect_b32 s86, M_codeend-standalone__structured_sparse_n_m__ragged_kernel, 0
    s_mov_b32 s87, 0x20000
    v_lshlrev_b32 v254, 3, v0
    s_mov_b32 exec_lo, 0x00010001
    s_mov_b32 exec_hi, 0x00010001
    buffer_load_dword v254, v254, s[84:87], s30 offen
    s_mov_b64 exec, -1
    v_lshrrev_b32 v20, 6, v0
    v_and_b32 v12, 63, v0
    v_readfirstlane_b32 s20, v20
    v_lshrrev_b32 v22, 3, v0
    v_mul_u32_u24 v22, 1152, v22
    v_lshrrev_b32 v23, 4, v0
    v_xor_b32 v23, v23, v0
    v_and_b32 v23, 7, v23
    v_lshl_add_u32 v5, v23, 4, v22
    v_lshrrev_b32 v13, 4, v12
    v_and_b32 v14, 15, v12
    v_lshlrev_b32 v11, 4, v12
    v_lshlrev_b32 v54, 3, v12
    v_lshlrev_b32 v25, 4, v13
    v_lshlrev_b32 v26, 3, v13
    s_mov_b32 s6, 663552
    s_mov_b32 s7, 0x20000
    s_mov_b32 s10, 75497472
    s_mov_b32 s11, s7
    s_mov_b32 s18, 742400
    s_mov_b32 s19, s7
    s_movk_i32 s70, 256
    s_mov_b32 s71, s7
    s_movk_i32 s86, 1152
    s_mov_b32 s87, s7
    s_mov_b32 s98, 0
    s_mul_i32 s96, s20, 16
    s_and_b32 s97, s2, 15
    s_add_u32 s96, s96, s97
    s_lshl_b32 s96, s96, 8
    s_add_u32 s96, s96, 726016
    s_mul_i32 s22, s2, 36864
    s_mul_i32 s26, s20, 9216
    s_mov_b32 s24, s22
    s_mov_b32 s42, s26
    s_lshl_b32 s28, s20, 8
    s_lshl_b32 s29, s20, 5
    s_cmp_lt_u32 s2, 81
    s_cbranch_scc0 M_x1
    s_mul_i32 s32, s2, 57
    s_lshr_b32 s32, s32, 9
    s_mul_i32 s33, s32, 9
    s_sub_u32 s33, s2, s33
    s_mul_i32 s54, s32, 73728
    s_lshl_b32 s35, s33, 7
    s_add_u32 s54, s54, s35
    s_add_u32 s55, s54, 36864
    s_lshl_b32 s36, s20, 10
    s_add_u32 m0, s36, 73728
    s_lshr_b32 s30, s33, 1
    s_and_b32 s31, s33, 1
    s_lshl1_add_u32 s37, s32, s31
    s_mul_i32 s37, s37, 176
    s_mul_i32 s38, s32, 96
    s_add_u32 s38, s38, 3168
    s_cmp_lt_u32 s33, 8
    s_cselect_b32 s30, s30, s20
    s_cselect_b32 s37, s37, s38
    s_cselect_b32 s44, 2047, 63
    s_cselect_b32 s45, s20, 3
    s_cmp_eq_u32 s45, 3
    s_cselect_b32 s99, 742400, 0
    s_mul_i32 s48, s30, 98304
    s_add_u32 s37, s37, s48
    v_mov_b32 v44, 2.0
    v_mov_b32 v45, 0
    v_mov_b32 v46, 2.0
    v_mov_b32 v47, 0
    s_waitcnt lgkmcnt(0)
    s_mov_b64 s[4:5], s[74:75]
    buffer_load_dwordx4 v5, s[4:7], s54 offen lds
    s_add_u32 m0, m0, 4096
    s_mov_b32 s45, 0
    buffer_load_dwordx4 v5, s[4:7], s55 offen lds
    s_mov_b64 s[16:17], s[82:83]
    s_mov_b64 s[8:9], s[72:73]
    s_mov_b64 s[84:85], s[76:77]
    s_mov_b64 s[68:69], s[80:81]
    v_mov_b32 v10, 0
    s_mov_b64 exec, 1
    buffer_atomic_add v10, off, s[16:19], s96 sc0 sc1
    s_mov_b64 exec, -1
    s_mov_b64 exec, s[44:45]
    s_mov_b32 s18, s99
    buffer_store_dwordx4 v[44:47], v11, s[16:19], s37 offen sc1
    s_mov_b32 s18, 742400
    s_mov_b64 exec, -1
    buffer_load_dwordx4 v[196:199], v25, s[84:87], s28 offen offset:0
    buffer_load_dwordx4 v[200:203], v25, s[84:87], s28 offen offset:64
    buffer_load_dwordx4 v[204:207], v25, s[84:87], s28 offen offset:128
    buffer_load_dwordx4 v[208:211], v25, s[84:87], s28 offen offset:192
    buffer_load_dwordx2 v[212:213], v26, s[84:87], s29 offen offset:1024
    s_mov_b32 m0, s42
    s_nop 0
    buffer_load_dwordx4 v5, s[8:11], s22 offen offset:0 nt lds
    s_add_u32 m0, m0, 896
    s_nop 0
    buffer_load_dwordx4 v5, s[8:11], s22 offen offset:128 nt lds
    s_add_u32 m0, m0, 896
    s_nop 0
    buffer_load_dwordx4 v5, s[8:11], s22 offen offset:256 nt lds
    s_add_u32 m0, m0, 896
    s_nop 0
    buffer_load_dwordx4 v5, s[8:11], s22 offen offset:384 nt lds
    s_lshl_b32 s34, s31, 2
    s_add_u32 s34, s34, s20
    s_lshr_b32 s35, s20, 1
    s_lshl_b32 s35, s35, 6
    s_and_b32 s36, s20, 1
    s_lshl_b32 s36, s36, 3
    s_add_u32 s35, s35, s36
    s_lshl_b32 s36, s20, 5
    s_mul_i32 s39, s32, 10240
    s_add_u32 s39, s39, 6144
    s_lshl_b32 s40, s34, 1
    s_add_u32 s40, s40, s39
    s_lshl_b32 s38, s32, 1
    s_cmp_eq_u32 s32, 8
    s_cselect_b32 s38, 1024, s38
    s_add_u32 s38, s38, 4096
    s_cmp_lt_u32 s33, 8
    s_cselect_b32 s34, s34, 8
    s_cselect_b32 s35, s35, s36
    s_cselect_b32 s36, 4, 3
    s_cselect_b32 s40, s40, s38
    s_cselect_b32 s46, 0, s20
    s_cselect_b32 s47, 22, 12
    s_add_u32 s40, s40, s48
    s_lshl_b32 s38, s34, 10
    s_add_u32 s39, s39, s38
    s_add_u32 s39, s39, s48
    s_add_u32 s39, s39, 1024
    v_and_b32 v15, 3, v14
    v_lshlrev_b32 v15, s36, v15
    v_add_u32 v15, s35, v15
    v_lshrrev_b32 v16, 3, v14
    v_lshlrev_b32 v16, 4, v16
    v_xor_b32 v15, v15, v16
    v_lshrrev_b32 v16, 2, v14
    v_lshl_add_u32 v16, v13, 4, v16
    v_lshl_add_u32 v15, v16, 7, v15
    v_add_u32 v24, 73728, v15
    v_xor_b32 v27, 32, v24
    v_xor_b32 v28, 64, v24
    v_xor_b32 v29, 0x60, v24
    s_lshl_b32 s31, s46, 2
    s_add_u32 s31, s31, 81920
    v_mov_b32 v60, s31
    v_mov_b32 v61, 1
    ds_write_b32 v60, v61
    s_mul_i32 s49, s30, 81
    s_mul_i32 s31, s32, 9
    s_add_u32 s49, s49, s31
    s_add_u32 s49, s49, s34
    s_lshl_b32 s49, s49, 10
    s_add_u32 s49, s49, 393216
    s_lshl_b32 s31, s34, 24
    s_lshl_b32 s38, s32, 10
    s_add_u32 s31, s31, s38
    v_lshlrev_b32 v31, 18, v14
    v_lshl_add_u32 v31, v13, 5, v31
    v_add_u32 v31, s31, v31
    s_mov_b32 s50, 3437096686
    s_mov_b32 s51, 1150609561
    s_mov_b32 s52, 0x00010001
    s_mov_b32 s53, 0x00200010
    s_mov_b32 s38, 0x0202
    s_mul_i32 s57, s30, 4096
    s_add_u32 s57, s57, 726016
    s_cmp_eq_u32 s33, 8
    s_cselect_b32 s56, 0, s20
    s_cmp_eq_u32 s20, 0
    s_cselect_b32 s98, 1, 0
    v_add_u32 v74, 81984, v54
    v_lshl_add_u32 v73, s20, 1, v74
    v_mov_b32 v41, 0x01000100
    v_mov_b32 v40, 0
    v_mov_b32 v63, -2.0
    s_waitcnt vmcnt(11) lgkmcnt(0)
    s_barrier
    ds_read_b64_tr_b16 v[16:17], v24
    ds_read_b64_tr_b16 v[18:19], v27 offset:512
    ds_read_b64_tr_b16 v[20:21], v28 offset:1024
    ds_read_b64_tr_b16 v[22:23], v29 offset:1536
    s_waitcnt lgkmcnt(3)
    v_and_b32 v44, 0x7fff7fff, v16
    v_and_b32 v45, 0x7fff7fff, v17
    v_pk_max_u16 v46, v44, v45
    v_pk_min_u16 v47, v44, v45
    v_pk_min_u16 v46, v46, v46 op_sel:[0,1] op_sel_hi:[1,0]
    v_pk_max_u16 v47, v47, v47 op_sel:[0,1] op_sel_hi:[1,0]
    v_pk_max_u16 v46, v46, s52
    v_pk_max_u16 v46, v46, v47
    v_pk_sub_i16 v44, v44, v46
    v_pk_sub_i16 v45, v45, v46
    v_pk_ashrrev_i16 v44, 15, v44 op_sel_hi:[0,1]
    v_pk_ashrrev_i16 v45, 15, v45 op_sel_hi:[0,1]
    v_alignbit_b32 v47, -1, v44, 16
    v_alignbit_b32 v46, v45, v45, 16
    v_and_b32 v48, 0x00080004, v44
    v_bitop3_b32 v46, v45, v46, v47 bitop3:0xe8
    v_and_or_b32 v64, v45, s53, v48
    v_bitop3_b32 v36, v16, v44, v46 bitop3:0x10
    v_min_u32 v68, 1, v36
    s_waitcnt lgkmcnt(2)
    v_and_b32 v44, 0x7fff7fff, v18
    v_and_b32 v45, 0x7fff7fff, v19
    v_pk_max_u16 v46, v44, v45
    v_pk_min_u16 v47, v44, v45
    v_pk_min_u16 v46, v46, v46 op_sel:[0,1] op_sel_hi:[1,0]
    v_pk_max_u16 v47, v47, v47 op_sel:[0,1] op_sel_hi:[1,0]
    v_pk_max_u16 v46, v46, s52
    v_pk_max_u16 v46, v46, v47
    v_pk_sub_i16 v44, v44, v46
    v_pk_sub_i16 v45, v45, v46
    v_pk_ashrrev_i16 v44, 15, v44 op_sel_hi:[0,1]
    v_pk_ashrrev_i16 v45, 15, v45 op_sel_hi:[0,1]
    v_alignbit_b32 v47, -1, v44, 16
    v_alignbit_b32 v46, v45, v45, 16
    v_and_b32 v48, 0x00080004, v44
    v_bitop3_b32 v46, v45, v46, v47 bitop3:0xe8
    v_and_or_b32 v65, v45, s53, v48
    v_bitop3_b32 v37, v18, v44, v46 bitop3:0x10
    v_min_u32 v69, 1, v37
    s_waitcnt lgkmcnt(1)
    v_and_b32 v44, 0x7fff7fff, v20
    v_and_b32 v45, 0x7fff7fff, v21
    v_pk_max_u16 v46, v44, v45
    v_pk_min_u16 v47, v44, v45
    v_pk_min_u16 v46, v46, v46 op_sel:[0,1] op_sel_hi:[1,0]
    v_pk_max_u16 v47, v47, v47 op_sel:[0,1] op_sel_hi:[1,0]
    v_pk_max_u16 v46, v46, s52
    v_pk_max_u16 v46, v46, v47
    v_pk_sub_i16 v44, v44, v46
    v_pk_sub_i16 v45, v45, v46
    v_pk_ashrrev_i16 v44, 15, v44 op_sel_hi:[0,1]
    v_pk_ashrrev_i16 v45, 15, v45 op_sel_hi:[0,1]
    v_alignbit_b32 v47, -1, v44, 16
    v_alignbit_b32 v46, v45, v45, 16
    v_and_b32 v48, 0x00080004, v44
    v_bitop3_b32 v46, v45, v46, v47 bitop3:0xe8
    v_and_or_b32 v66, v45, s53, v48
    v_bitop3_b32 v38, v20, v44, v46 bitop3:0x10
    v_min_u32 v70, 1, v38
    s_waitcnt lgkmcnt(0)
    v_and_b32 v44, 0x7fff7fff, v22
    v_and_b32 v45, 0x7fff7fff, v23
    v_pk_max_u16 v46, v44, v45
    v_pk_min_u16 v47, v44, v45
    v_pk_min_u16 v46, v46, v46 op_sel:[0,1] op_sel_hi:[1,0]
    v_pk_max_u16 v47, v47, v47 op_sel:[0,1] op_sel_hi:[1,0]
    v_pk_max_u16 v46, v46, s52
    v_pk_max_u16 v46, v46, v47
    v_pk_sub_i16 v44, v44, v46
    v_pk_sub_i16 v45, v45, v46
    v_pk_ashrrev_i16 v44, 15, v44 op_sel_hi:[0,1]
    v_pk_ashrrev_i16 v45, 15, v45 op_sel_hi:[0,1]
    v_alignbit_b32 v47, -1, v44, 16
    v_alignbit_b32 v46, v45, v45, 16
    v_and_b32 v48, 0x00080004, v44
    v_bitop3_b32 v46, v45, v46, v47 bitop3:0xe8
    v_and_or_b32 v67, v45, s53, v48
    v_bitop3_b32 v39, v22, v44, v46 bitop3:0x10
    v_min_u32 v71, 1, v39
    v_add_u32 v72, v68, v69
    v_add3_u32 v72, v72, v70, v71
    buffer_store_dwordx4 v[36:39], v11, s[16:19], s49 offen sc1
    v_cmp_ne_u32 vcc, 0, v72
    s_and_saveexec_b64 s[44:45], vcc
    ds_add_rtn_u32 v62, v60, v72
    s_mov_b64 exec, -1
    v_lshrrev_b32 v48, 16, v64
    v_or_b32 v48, v48, v64
    v_lshrrev_b64 v[52:53], v48, s[50:51]
    v_and_b32 v64, 15, v52
    v_lshl_or_b32 v40, v64, 0, v40
    v_lshrrev_b32 v48, 16, v65
    v_or_b32 v48, v48, v65
    v_lshrrev_b64 v[52:53], v48, s[50:51]
    v_and_b32 v65, 15, v52
    v_lshl_or_b32 v40, v65, 4, v40
    v_lshrrev_b32 v48, 16, v66
    v_or_b32 v48, v48, v66
    v_lshrrev_b64 v[52:53], v48, s[50:51]
    v_and_b32 v66, 15, v52
    v_lshl_or_b32 v40, v66, 8, v40
    v_lshrrev_b32 v48, 16, v67
    v_or_b32 v48, v48, v67
    v_lshrrev_b64 v[52:53], v48, s[50:51]
    v_and_b32 v67, 15, v52
    v_lshl_or_b32 v40, v67, 12, v40
    v_lshrrev_b32 v44, 2, v40
    v_lshlrev_b32 v45, 2, v40
    s_movk_i32 s31, 0x3333
    v_not_b32 v47, v40
    v_bfi_b32 v44, s31, v44, v45
    s_movk_i32 s31, 0x1111
    s_nop 0
    v_mov_b32_dpp v47, v44 row_shr:4 row_mask:0xf bank_mask:0xf
    v_xor_b32 v47, v47, v40
    v_lshrrev_b32 v45, 1, v47
    v_or_b32 v47, v47, v45
    v_lshrrev_b32 v45, 2, v47
    v_bitop3_b32 v47, v47, v45, s31 bitop3:0x2a
    s_nop 1
    v_xor_b32_dpp v47, v47, v47 row_shr:4 row_mask:0xf bank_mask:0xe
    s_nop 1
    v_xor_b32_dpp v47, v47, v47 row_shr:8 row_mask:0xf bank_mask:0xc
    v_mul_u32_u24 v47, 15, v47
    v_bfi_b32 v40, v47, v44, v40
    ds_write_b16 v73, v40
    v_bfe_u32 v64, v40, 0, 4
    v_mul_u32_u24 v46, 0x4001, v64
    v_and_b32 v46, 0x30003, v46
    v_mad_u32_u24 v46, v46, s38, v41
    v_perm_b32 v32, v17, v16, v46
    v_bfe_u32 v65, v40, 4, 4
    v_mul_u32_u24 v46, 0x4001, v65
    v_and_b32 v46, 0x30003, v46
    v_mad_u32_u24 v46, v46, s38, v41
    v_perm_b32 v33, v19, v18, v46
    s_waitcnt vmcnt(10) lgkmcnt(0)
    s_barrier
    ds_read_b64 v[50:51], v74
    v_bfe_u32 v66, v40, 8, 4
    v_mul_u32_u24 v46, 0x4001, v66
    v_and_b32 v46, 0x30003, v46
    v_mad_u32_u24 v46, v46, s38, v41
    v_perm_b32 v34, v21, v20, v46
    v_bfe_u32 v67, v40, 12, 4
    v_mul_u32_u24 v46, 0x4001, v67
    v_and_b32 v46, 0x30003, v46
    v_mad_u32_u24 v46, v46, s38, v41
    v_perm_b32 v35, v23, v22, v46
    buffer_store_dwordx4 v[32:35], v11, s[16:19], s39 offen sc1
    s_cmp_eq_u32 s33, 8
    s_cbranch_scc0 F_i1
    buffer_store_short v40, v11, s[16:19], s40 offen sc1
    s_branch F_i2
F_i1:
    s_cmp_eq_u32 s20, 0
    s_cbranch_scc0 F_i2
    s_waitcnt lgkmcnt(0)
    buffer_store_dwordx2 v[50:51], v11, s[16:19], s40 offen sc1
F_i2:
    s_cbranch_vccz F_z
    v_cmp_ne_u32 vcc, 0, v36
    s_and_saveexec_b64 s[44:45], vcc
    s_cbranch_execz F_e0
    v_cmp_gt_u32 vcc, s47, v62
    v_add_u32 v42, 0, v31
    v_lshlrev_b32 v44, 3, v62
    v_add_u32 v62, 1, v62
    v_cndmask_b32 v42, v63, v42, vcc
    v_cndmask_b32 v43, 0, v36, vcc
    v_cndmask_b32 v44, 0, v44, vcc
    buffer_store_dwordx2 v[42:43], v44, s[16:19], s37 offen sc1
F_e0:
    s_mov_b64 exec, -1
    v_cmp_ne_u32 vcc, 0, v37
    s_and_saveexec_b64 s[44:45], vcc
    s_cbranch_execz F_e1
    v_cmp_gt_u32 vcc, s47, v62
    v_add_u32 v42, 8, v31
    v_lshlrev_b32 v44, 3, v62
    v_add_u32 v62, 1, v62
    v_cndmask_b32 v42, v63, v42, vcc
    v_cndmask_b32 v43, 0, v37, vcc
    v_cndmask_b32 v44, 0, v44, vcc
    buffer_store_dwordx2 v[42:43], v44, s[16:19], s37 offen sc1
F_e1:
    s_mov_b64 exec, -1
    v_cmp_ne_u32 vcc, 0, v38
    s_and_saveexec_b64 s[44:45], vcc
    s_cbranch_execz F_e2
    v_cmp_gt_u32 vcc, s47, v62
    v_add_u32 v42, 16, v31
    v_lshlrev_b32 v44, 3, v62
    v_add_u32 v62, 1, v62
    v_cndmask_b32 v42, v63, v42, vcc
    v_cndmask_b32 v43, 0, v38, vcc
    v_cndmask_b32 v44, 0, v44, vcc
    buffer_store_dwordx2 v[42:43], v44, s[16:19], s37 offen sc1
F_e2:
    s_mov_b64 exec, -1
    v_cmp_ne_u32 vcc, 0, v39
    s_and_saveexec_b64 s[44:45], vcc
    s_cbranch_execz F_e3
    v_cmp_gt_u32 vcc, s47, v62
    v_add_u32 v42, 24, v31
    v_lshlrev_b32 v44, 3, v62
    v_add_u32 v62, 1, v62
    v_cndmask_b32 v42, v63, v42, vcc
    v_cndmask_b32 v43, 0, v39, vcc
    v_cndmask_b32 v44, 0, v44, vcc
    buffer_store_dwordx2 v[42:43], v44, s[16:19], s37 offen sc1
F_e3:
    s_mov_b64 exec, -1
F_z:
    s_cmp_lg_u32 s2, 0
    s_cbranch_scc1 M_set
    v_mov_b32 v64, 0
    v_mov_b32 v65, 0
    v_mov_b32 v66, 0
    v_mov_b32 v67, 0
    s_mov_b32 s40, 724992
    buffer_store_dwordx4 v[64:67], v11, s[16:19], s40 offen sc1
    s_branch M_set
F_sig:
    v_lshlrev_b32 v30, 8, v12
    s_waitcnt vmcnt(0)
    s_barrier
    s_cmp_lg_u32 s56, 0
    s_cbranch_scc1 F_end
    s_mov_b64 exec, 65535
    buffer_atomic_add v61, v30, s[16:19], s57 offen sc1
    s_mov_b64 exec, -1
F_end:
    s_add_u32 m0, m0, 896
    s_nop 0
    buffer_load_dwordx4 v5, s[8:11], s22 offen offset:512 nt lds
    s_add_u32 m0, m0, 896
    s_nop 0
    buffer_load_dwordx4 v5, s[8:11], s22 offen offset:640 nt lds
    s_add_u32 m0, m0, 896
    s_nop 0
    buffer_load_dwordx4 v5, s[8:11], s22 offen offset:768 nt lds
    s_branch M_x2
M_x1:
    s_waitcnt lgkmcnt(0)
    s_mov_b64 s[4:5], s[74:75]
    s_mov_b64 s[16:17], s[82:83]
    s_mov_b64 s[8:9], s[72:73]
    s_mov_b64 s[84:85], s[76:77]
    s_mov_b64 s[68:69], s[80:81]
    v_mov_b32 v10, 0
    s_mov_b64 exec, 1
    buffer_atomic_add v10, off, s[16:19], s96 sc0 sc1
    s_mov_b64 exec, -1
    buffer_load_dwordx4 v[196:199], v25, s[84:87], s28 offen offset:0
    buffer_load_dwordx4 v[200:203], v25, s[84:87], s28 offen offset:64
    buffer_load_dwordx4 v[204:207], v25, s[84:87], s28 offen offset:128
    buffer_load_dwordx4 v[208:211], v25, s[84:87], s28 offen offset:192
    buffer_load_dwordx2 v[212:213], v26, s[84:87], s29 offen offset:1024
    s_mov_b32 m0, s42
    s_nop 0
    buffer_load_dwordx4 v5, s[8:11], s22 offen offset:0 nt lds
    s_add_u32 m0, m0, 896
    s_nop 0
    buffer_load_dwordx4 v5, s[8:11], s22 offen offset:128 nt lds
    s_add_u32 m0, m0, 896
    s_nop 0
    buffer_load_dwordx4 v5, s[8:11], s22 offen offset:256 nt lds
    s_add_u32 m0, m0, 896
    s_nop 0
    buffer_load_dwordx4 v5, s[8:11], s22 offen offset:384 nt lds
    s_add_u32 m0, m0, 896
    s_nop 0
    buffer_load_dwordx4 v5, s[8:11], s22 offen offset:512 nt lds
    s_add_u32 m0, m0, 896
    s_nop 0
    buffer_load_dwordx4 v5, s[8:11], s22 offen offset:640 nt lds
    s_add_u32 m0, m0, 896
    s_nop 0
    buffer_load_dwordx4 v5, s[8:11], s22 offen offset:768 nt lds
M_set:
    s_mov_b32 s12, s78
    s_mov_b32 s13, s79
    s_mov_b32 s14, 75497472
    s_mov_b32 s15, 0x20000
    s_mul_i32 s29, s20, 12864
    s_add_u32 s29, s29, 110592
    v_lshrrev_b32 v24, 1, v14
    v_and_b32 v27, 7, v14
    v_lshlrev_b32 v22, 7, v27
    v_lshl_or_b32 v3, v24, 4, v22
    v_lshrrev_b32 v23, 3, v14
    v_mul_u32_u24 v4, 9216, v23
    v_xad_u32 v1, v25, v3, v4
    v_xor_b32 v2, 64, v1
    v_add_u32 v9, s29, v25
    v_add_u32 v8, s29, v11
    v_mul_u32_u24 v24, 1152, v27
    v_lshl_add_u32 v24, v23, 6, v24
    v_add3_u32 v6, v24, v25, s28
    v_lshrrev_b32 v24, 3, v12
    v_xor_b32 v28, v24, v12
    v_and_b32 v28, 7, v28
    v_mul_u32_u24 v24, 1152, v24
    v_lshl_add_u32 v24, v28, 4, v24
    v_add_u32 v7, 1024, v24
    s_lshl_b32 s30, s20, 1
    v_lshrrev_b32 v24, 1, v13
    v_add_u32 v24, s30, v24
    v_xor_b32 v24, v24, v27
    v_lshl_add_u32 v24, v24, 4, v22
    v_and_b32 v28, 8, v26
    v_mul_u32_u24 v29, 12864, v23
    v_add3_u32 v24, v24, v28, v29
    v_add_u32 v53, 121408, v24
    s_lshr_b32 s30, s2, 3
    s_and_b32 s30, s30, 3
    s_mul_i32 s92, s30, 256
    s_add_u32 s92, s92, 562944
    s_add_u32 s30, s30, 768
    s_mul_i32 s93, s30, 36864
    s_mov_b32 s94, 147456
    s_and_b32 s95, s20, 1
    s_mul_i32 s95, s95, 9216
    s_add_u32 s59, s24, 9216
    s_mul_i32 s43, s20, 98304
    s_add_u32 s47, s29, 9216
    s_add_u32 s48, s29, 9792
    s_add_u32 s49, s29, 10112
    s_add_u32 s54, s29, 1073751872
    s_add_u32 s38, s26, 73728
    s_add_u32 s35, s38, 1024
    s_add_u32 s39, s38, 1536
    s_mov_b32 s40, s48
    s_add_u32 s41, s48, 256
    s_mov_b32 s50, 3130536464
    s_mov_b32 s51, 1164430831
    s_mov_b32 s52, 3696531472
    s_mov_b32 s53, 598435823
    v_mov_b32 v16, 0
    v_mov_b32 v17, 0
    v_mov_b32 v18, 0
    v_mov_b32 v19, 0
    v_cmp_gt_u32 s[44:45], 36, v12
    v_mov_b32 v20, 2.0
    s_nop 0
    v_cndmask_b32 v20, 0, v20, s[44:45]
    v_mov_b32 v21, v20
    v_mov_b32 v22, v20
    v_mov_b32 v23, v20
    v_mov_b32 v68, 1073741824
    v_mov_b32 v69, 0
    v_mov_b32 v70, 1073741824
    v_mov_b32 v71, 0
    v_lshl_add_u32 v84, v12, 2, s49
    v_add_u32 v55, s38, v54
    v_add_u32 v24, s38, v11
    ds_write_b128 v8, v[16:19] offset:0
    ds_write_b128 v8, v[16:19] offset:1024
    ds_write_b128 v8, v[16:19] offset:2048
    ds_write_b128 v8, v[16:19] offset:3072
    ds_write_b128 v8, v[16:19] offset:4096
    ds_write_b128 v8, v[16:19] offset:5120
    ds_write_b128 v8, v[16:19] offset:6144
    ds_write_b128 v8, v[16:19] offset:7168
    ds_write_b128 v8, v[16:19] offset:8192
    ds_write_b128 v24, v[68:71]
    ds_write_b128 v24, v[68:71] offset:1024
    ds_write_b128 v8, v[20:23] offset:9216
    s_cmp_lt_u32 s2, 81
    s_cbranch_scc1 F_sig
M_x2:
    s_add_u32 m0, m0, 896
    s_nop 0
    buffer_load_dwordx4 v5, s[8:11], s22 offen offset:896 nt lds
    s_add_u32 m0, m0, 896
    s_nop 0
    buffer_load_dwordx4 v5, s[8:11], s22 offen offset:1024 nt lds
    s_add_u32 s22, s22, 9437184
    s_add_u32 s42, s42, 36864
    s_mov_b32 m0, s42
    s_nop 0
    buffer_load_dwordx4 v5, s[8:11], s22 offen offset:0 nt lds
    s_add_u32 m0, m0, 896
    s_nop 0
    buffer_load_dwordx4 v5, s[8:11], s22 offen offset:128 nt lds
    s_add_u32 m0, m0, 896
    s_nop 0
    buffer_load_dwordx4 v5, s[8:11], s22 offen offset:256 nt lds
    s_add_u32 m0, m0, 896
    s_nop 0
    buffer_load_dwordx4 v5, s[8:11], s22 offen offset:384 nt lds
    s_add_u32 m0, m0, 896
    s_nop 0
    buffer_load_dwordx4 v5, s[8:11], s22 offen offset:512 nt lds
    s_add_u32 m0, m0, 896
    s_nop 0
    buffer_load_dwordx4 v5, s[8:11], s22 offen offset:640 nt lds
    s_add_u32 m0, m0, 896
    s_nop 0
    buffer_load_dwordx4 v5, s[8:11], s22 offen offset:768 nt lds
    s_add_u32 m0, m0, 896
    s_nop 0
    buffer_load_dwordx4 v5, s[8:11], s22 offen offset:896 nt lds
    s_add_u32 m0, m0, 896
    s_nop 0
    buffer_load_dwordx4 v5, s[8:11], s22 offen offset:1024 nt lds
    s_add_u32 s22, s22, 9437184
    s_add_u32 s42, s42, 36864
    s_waitcnt vmcnt(3)
    v_mov_b32 v0, 0
    s_mov_b64 exec, 1
    buffer_atomic_add v0, off, s[16:19], s96 sc0 sc1
    s_mov_b64 exec, -1
    v_readlane_b32 s100, v10, 0
    v_mov_b32 v10, 0xeeee4444
    v_lshlrev_b32 v124, 16, v196
    v_and_b32 v125, 0xffff0000, v196
    v_lshlrev_b32 v126, 16, v197
    v_and_b32 v127, 0xffff0000, v197
    v_lshlrev_b32 v128, 16, v198
    v_and_b32 v129, 0xffff0000, v198
    v_lshlrev_b32 v130, 16, v199
    v_and_b32 v131, 0xffff0000, v199
    v_lshlrev_b32 v132, 16, v200
    v_and_b32 v133, 0xffff0000, v200
    v_lshlrev_b32 v134, 16, v201
    v_and_b32 v135, 0xffff0000, v201
    v_lshlrev_b32 v136, 16, v202
    v_and_b32 v137, 0xffff0000, v202
    v_lshlrev_b32 v138, 16, v203
    v_and_b32 v139, 0xffff0000, v203
    v_lshlrev_b32 v140, 16, v204
    v_and_b32 v141, 0xffff0000, v204
    v_lshlrev_b32 v142, 16, v205
    v_and_b32 v143, 0xffff0000, v205
    v_lshlrev_b32 v144, 16, v206
    v_and_b32 v145, 0xffff0000, v206
    v_lshlrev_b32 v146, 16, v207
    v_and_b32 v147, 0xffff0000, v207
    v_lshlrev_b32 v148, 16, v208
    v_and_b32 v149, 0xffff0000, v208
    v_lshlrev_b32 v150, 16, v209
    v_and_b32 v151, 0xffff0000, v209
    v_lshlrev_b32 v152, 16, v210
    v_and_b32 v153, 0xffff0000, v210
    v_lshlrev_b32 v154, 16, v211
    v_and_b32 v155, 0xffff0000, v211
    v_lshlrev_b32 v156, 16, v212
    v_and_b32 v157, 0xffff0000, v212
    v_lshlrev_b32 v158, 16, v213
    v_and_b32 v159, 0xffff0000, v213
    s_mov_b32 exec_lo, 0x00010001
    s_mov_b32 exec_hi, 0x00010001
    ds_write_b128 v9, v[124:127] offset:10240
    ds_write_b128 v9, v[128:131] offset:10304
    ds_write_b128 v9, v[132:135] offset:10368
    ds_write_b128 v9, v[136:139] offset:10432
    ds_write_b128 v9, v[140:143] offset:10496
    ds_write_b128 v9, v[144:147] offset:10560
    ds_write_b128 v9, v[148:151] offset:10624
    ds_write_b128 v9, v[152:155] offset:10688
    ds_write_b128 v9, v[156:159] offset:10752
    s_mov_b64 exec, -1
    s_mul_i32 s30, s20, 256
    s_add_u32 s30, s30, s2
    s_sub_u32 s30, s30, 0
    s_cmp_lt_u32 s2, 0
    s_cselect_b32 s30, 1023, s30
    s_lshl_b32 s30, s30, 1
    v_lshrrev_b32 v244, 5, v12
    v_add_u32 v248, s30, v244
    v_mov_b32 v244, -1
    v_mov_b32 v245, 0
    v_subrev_u32 v246, 704, v248
    v_cmp_gt_u32 vcc, 16, v246
    v_mov_b32 v247, 0
    s_nop 0
    v_cndmask_b32 v244, v244, v246, vcc
    v_cndmask_b32 v245, v245, v247, vcc
    v_subrev_u32 v246, 672, v248
    v_cmp_gt_u32 vcc, 32, v246
    v_mov_b32 v247, 1
    s_nop 0
    v_cndmask_b32 v244, v244, v246, vcc
    v_cndmask_b32 v245, v245, v247, vcc
    v_subrev_u32 v246, 624, v248
    v_cmp_gt_u32 vcc, 48, v246
    v_mov_b32 v247, 2
    s_nop 0
    v_cndmask_b32 v244, v244, v246, vcc
    v_cndmask_b32 v245, v245, v247, vcc
    v_subrev_u32 v246, 560, v248
    v_cmp_gt_u32 vcc, 64, v246
    v_mov_b32 v247, 3
    s_nop 0
    v_cndmask_b32 v244, v244, v246, vcc
    v_cndmask_b32 v245, v245, v247, vcc
    v_subrev_u32 v246, 480, v248
    v_cmp_gt_u32 vcc, 80, v246
    v_mov_b32 v247, 4
    s_nop 0
    v_cndmask_b32 v244, v244, v246, vcc
    v_cndmask_b32 v245, v245, v247, vcc
    v_subrev_u32 v246, 384, v248
    v_cmp_gt_u32 vcc, 96, v246
    v_mov_b32 v247, 5
    s_nop 0
    v_cndmask_b32 v244, v244, v246, vcc
    v_cndmask_b32 v245, v245, v247, vcc
    v_subrev_u32 v246, 272, v248
    v_cmp_gt_u32 vcc, 112, v246
    v_mov_b32 v247, 6
    s_nop 0
    v_cndmask_b32 v244, v244, v246, vcc
    v_cndmask_b32 v245, v245, v247, vcc
    v_subrev_u32 v246, 144, v248
    v_cmp_gt_u32 vcc, 128, v246
    v_mov_b32 v247, 7
    s_nop 0
    v_cndmask_b32 v244, v244, v246, vcc
    v_cndmask_b32 v245, v245, v247, vcc
    v_subrev_u32 v246, 0, v248
    v_cmp_gt_u32 vcc, 144, v246
    v_mov_b32 v247, 8
    s_nop 0
    v_cndmask_b32 v244, v244, v246, vcc
    v_cndmask_b32 v245, v245, v247, vcc
    v_sub_u32 v244, 2047, v244
    v_mul_u32_u24 v244, 36864, v244
    v_lshl_add_u32 v244, v245, 7, v244
    v_and_b32 v245, 31, v12
    v_mul_u32_u24 v245, 1152, v245
    v_add_u32 v249, v244, v245
    s_mov_b32 vcc_lo, 0xff00ff00
    s_mov_b32 vcc_hi, 0xff00ff00
    s_waitcnt vmcnt(0)
    v_readfirstlane_b32 s30, v0
    s_mov_b32 s31, 0
    s_sub_u32 s30, s30, s100
    s_cmp_eq_u32 s30, 27
    s_cbranch_scc0 M_pf_spin
M_pf_ok:
    v_mov_b32 v0, v249
    buffer_load_dwordx4 v[56:59], v11, s[16:19], s43 offen offset:0 sc1
    buffer_load_dwordx4 v[60:63], v11, s[16:19], s43 offen offset:1024 sc1
    buffer_load_dwordx4 v[64:67], v11, s[16:19], s43 offen offset:2048 sc1
    s_mov_b32 exec_hi, 268435455
    buffer_load_dwordx4 v[68:71], v11, s[16:19], s43 offen offset:3072 sc1
    s_mov_b32 exec_hi, -1
    s_add_u32 s43, s43, 4096
    buffer_load_dwordx4 v[48:51], v11, s[16:19], s43 offen offset:0 sc1
    buffer_load_dword v52, v11, s[16:19], s43 offen offset:1024 sc1
    buffer_load_dwordx4 v[12:15], v11, s[16:19], s43 offen offset:2048 sc1
    buffer_load_dwordx4 a[0:3], v11, s[16:19], s43 offen offset:3072 sc1
    s_add_u32 s43, s43, 4096
    buffer_load_dwordx4 a[4:7], v11, s[16:19], s43 offen offset:0 sc1
    buffer_load_dwordx4 a[8:11], v11, s[16:19], s43 offen offset:1024 sc1
    buffer_load_dwordx4 a[12:15], v11, s[16:19], s43 offen offset:2048 sc1
    buffer_load_dwordx4 a[16:19], v11, s[16:19], s43 offen offset:3072 sc1
    s_add_u32 s43, s43, 4096
    buffer_load_dwordx4 a[20:23], v11, s[16:19], s43 offen offset:0 sc1
    buffer_load_dwordx4 a[24:27], v11, s[16:19], s43 offen offset:1024 sc1
    buffer_load_dwordx4 a[28:31], v11, s[16:19], s43 offen offset:2048 sc1
    buffer_load_dwordx4 a[32:35], v11, s[16:19], s43 offen offset:3072 sc1
    s_add_u32 s43, s43, 4096
    buffer_load_dwordx4 v[16:19], v11, s[16:19], s43 offen offset:0 sc1
    buffer_load_dwordx4 a[36:39], v11, s[16:19], s43 offen offset:1024 sc1
    buffer_load_dwordx4 a[40:43], v11, s[16:19], s43 offen offset:2048 sc1
    buffer_load_dwordx4 a[44:47], v11, s[16:19], s43 offen offset:3072 sc1
    ds_read_b128 v[160:163], v9 offset:10240
    ds_read_b128 v[164:167], v9 offset:10304
    ds_read_b128 v[168:171], v9 offset:10368
    ds_read_b128 v[172:175], v9 offset:10432
    ds_read_b128 v[176:179], v9 offset:10496
    ds_read_b128 v[180:183], v9 offset:10560
    ds_read_b128 v[184:187], v9 offset:10624
    ds_read_b128 v[188:191], v9 offset:10688
    ds_read_b128 v[192:195], v9 offset:10752
    s_cmp_eq_u32 s98, 0
    s_cbranch_scc1 M_cnt
    s_mov_b32 s98, 0
    v_mov_b32 v250, 1
    s_mov_b64 exec, 1
    buffer_atomic_add v250, off, s[68:71], 0 offset:0 sc1
    s_mov_b64 exec, -1
    s_nop 3
M_cnt:
    s_waitcnt vmcnt(12)
    s_barrier
    ds_read_b128 v[196:199], v1 offset:0
    ds_read_b128 v[200:203], v2 offset:0
    ds_read_b128 v[228:231], v1 offset:18432
    ds_read_b128 v[232:235], v2 offset:18432
    s_waitcnt lgkmcnt(2)
    v_smfmac_f32_16x16x64_bf16 v[124:127], a[0:3], v[196:203], v12
    s_add_u32 s43, s43, 4096
    buffer_load_dwordx4 a[48:51], v11, s[16:19], s43 offen offset:0 sc1
    s_waitcnt lgkmcnt(0)
    v_mov_b32 v82, s54
    v_smfmac_f32_16x16x64_bf16 v[160:163], a[0:3], v[228:235], v12
    ds_read_b128 v[204:207], v1 offset:1024
    ds_read_b128 v[208:211], v2 offset:1024
    v_or3_b32 v78, v56, v60, v64
    v_or_b32 v78, v78, v68
    v_cmp_gt_i32 s[32:33], 0, v78
    v_cmp_gt_u32 s[36:37], 2.0, v56
    s_nop 1
    v_mbcnt_lo_u32_b32 v74, s36, 0
    s_waitcnt vmcnt(12)
    v_mbcnt_hi_u32_b32 v74, s37, v74
    v_smfmac_f32_16x16x64_bf16 v[128:131], a[4:7], v[196:203], v12 abid:1
    buffer_load_dwordx4 a[52:55], v11, s[16:19], s43 offen offset:1024 sc1
    v_lshl_add_u32 v74, v74, 3, s38
    v_smfmac_f32_16x16x64_bf16 v[164:167], a[4:7], v[228:235], v12 abid:1
    ds_read_b128 v[220:223], v1 offset:19456
    ds_read_b128 v[224:227], v2 offset:19456
    v_min_u32 v74, s39, v74
    s_waitcnt vmcnt(12)
    v_cndmask_b32 v74, v82, v74, s[36:37]
    v_smfmac_f32_16x16x64_bf16 v[132:135], a[8:11], v[196:203], v13
    buffer_load_dwordx4 a[56:59], v11, s[16:19], s43 offen offset:2048 sc1
    ds_write_b64 v74, v[56:57]
    s_bcnt1_i32_b64 s30, s[36:37]
    s_lshl3_add_u32 s38, s30, s38
    v_cmp_gt_u32 s[44:45], 2.0, v58
    v_smfmac_f32_16x16x64_bf16 v[168:171], a[8:11], v[228:235], v13
    s_nop 0
    v_mbcnt_lo_u32_b32 v75, s44, 0
    v_mbcnt_hi_u32_b32 v75, s45, v75
    v_lshl_add_u32 v75, v75, 3, s38
    v_min_u32 v75, s39, v75
    s_waitcnt vmcnt(12)
    v_cndmask_b32 v75, v82, v75, s[44:45]
    v_smfmac_f32_16x16x64_bf16 v[136:139], a[12:15], v[196:203], v13 abid:1
    buffer_load_dwordx4 a[60:63], v11, s[16:19], s43 offen offset:3072 sc1
    ds_write_b64 v75, v[58:59]
    s_bcnt1_i32_b64 s30, s[44:45]
    s_lshl3_add_u32 s38, s30, s38
    v_cmp_gt_u32 s[36:37], 2.0, v60
    v_smfmac_f32_16x16x64_bf16 v[172:175], a[12:15], v[228:235], v13 abid:1
    s_nop 0
    v_mbcnt_lo_u32_b32 v74, s36, 0
    v_mbcnt_hi_u32_b32 v74, s37, v74
    v_lshl_add_u32 v74, v74, 3, s38
    s_waitcnt vmcnt(12)
    v_min_u32 v74, s39, v74
    v_smfmac_f32_16x16x64_bf16 v[140:143], a[16:19], v[196:203], v14
    s_add_u32 s43, s43, 4096
    buffer_load_dwordx4 a[64:67], v11, s[16:19], s43 offen offset:0 sc1
    v_cndmask_b32 v74, v82, v74, s[36:37]
    v_smfmac_f32_16x16x64_bf16 v[176:179], a[16:19], v[228:235], v14
    ds_write_b64 v74, v[60:61]
    s_bcnt1_i32_b64 s30, s[36:37]
    s_lshl3_add_u32 s38, s30, s38
    v_cmp_gt_u32 s[44:45], 2.0, v62
    s_nop 1
    v_mbcnt_lo_u32_b32 v75, s44, 0
    s_waitcnt vmcnt(12)
    v_mbcnt_hi_u32_b32 v75, s45, v75
    v_smfmac_f32_16x16x64_bf16 v[144:147], a[20:23], v[196:203], v14 abid:1
    buffer_load_dwordx4 a[68:71], v11, s[16:19], s43 offen offset:1024 sc1
    v_lshl_add_u32 v75, v75, 3, s38
    v_smfmac_f32_16x16x64_bf16 v[180:183], a[20:23], v[228:235], v14 abid:1
    v_min_u32 v75, s39, v75
    s_waitcnt vmcnt(12)
    v_cndmask_b32 v75, v82, v75, s[44:45]
    v_smfmac_f32_16x16x64_bf16 v[148:151], a[24:27], v[196:203], v15
    buffer_load_dwordx4 v[20:23], v11, s[16:19], s43 offen offset:2048 sc1
    buffer_load_dwordx4 a[72:75], v11, s[16:19], s43 offen offset:3072 sc1
    ds_write_b64 v75, v[62:63]
    s_bcnt1_i32_b64 s30, s[44:45]
    s_lshl3_add_u32 s38, s30, s38
    v_cmp_gt_u32 s[36:37], 2.0, v64
    v_smfmac_f32_16x16x64_bf16 v[184:187], a[24:27], v[228:235], v15
    s_nop 0
    v_mbcnt_lo_u32_b32 v74, s36, 0
    v_mbcnt_hi_u32_b32 v74, s37, v74
    v_lshl_add_u32 v74, v74, 3, s38
    v_min_u32 v74, s39, v74
    s_waitcnt vmcnt(13)
    v_cndmask_b32 v74, v82, v74, s[36:37]
    v_smfmac_f32_16x16x64_bf16 v[152:155], a[28:31], v[196:203], v15 abid:1
    s_add_u32 s43, s43, 4096
    buffer_load_dwordx4 a[76:79], v11, s[16:19], s43 offen offset:0 sc1
    ds_write_b64 v74, v[64:65]
    s_bcnt1_i32_b64 s30, s[36:37]
    s_lshl3_add_u32 s38, s30, s38
    v_cmp_gt_u32 s[44:45], 2.0, v66
    v_smfmac_f32_16x16x64_bf16 v[188:191], a[28:31], v[228:235], v15 abid:1
    s_nop 0
    v_mbcnt_lo_u32_b32 v75, s44, 0
    v_mbcnt_hi_u32_b32 v75, s45, v75
    v_lshl_add_u32 v75, v75, 3, s38
    s_waitcnt vmcnt(13)
    v_min_u32 v75, s39, v75
    v_smfmac_f32_16x16x64_bf16 v[156:159], a[32:35], v[196:203], v48
    buffer_load_dwordx4 a[80:83], v11, s[16:19], s43 offen offset:1024 sc1
    v_cndmask_b32 v75, v82, v75, s[44:45]
    v_smfmac_f32_16x16x64_bf16 v[192:195], a[32:35], v[228:235], v48
    ds_write_b64 v75, v[66:67]
    s_bcnt1_i32_b64 s30, s[44:45]
    s_lshl3_add_u32 s38, s30, s38
    v_cmp_gt_u32 s[36:37], 2.0, v68
    s_nop 1
    s_waitcnt vmcnt(12)
    s_waitcnt lgkmcnt(8)
    v_mbcnt_lo_u32_b32 v74, s36, 0
    v_smfmac_f32_16x16x64_bf16 v[124:127], a[36:39], v[204:211], v16
    buffer_load_dwordx4 a[84:87], v11, s[16:19], s43 offen offset:2048 sc1
    s_waitcnt lgkmcnt(6)
    v_mbcnt_hi_u32_b32 v74, s37, v74
    v_smfmac_f32_16x16x64_bf16 v[160:163], a[36:39], v[220:227], v16
    ds_read_b128 v[196:199], v1 offset:2048
    ds_read_b128 v[200:203], v2 offset:2048
    v_lshl_add_u32 v74, v74, 3, s38
    v_min_u32 v74, s39, v74
    s_waitcnt vmcnt(12)
    v_cndmask_b32 v74, v82, v74, s[36:37]
    v_smfmac_f32_16x16x64_bf16 v[128:131], a[40:43], v[204:211], v16 abid:1
    buffer_load_dwordx4 a[88:91], v11, s[16:19], s43 offen offset:3072 sc1
    ds_write_b64 v74, v[68:69]
    s_bcnt1_i32_b64 s30, s[36:37]
    s_lshl3_add_u32 s38, s30, s38
    v_cmp_gt_u32 s[44:45], 2.0, v70
    v_smfmac_f32_16x16x64_bf16 v[164:167], a[40:43], v[220:227], v16 abid:1
    ds_read_b128 v[228:231], v1 offset:20480
    ds_read_b128 v[232:235], v2 offset:20480
    v_mbcnt_lo_u32_b32 v75, s44, 0
    v_mbcnt_hi_u32_b32 v75, s45, v75
    v_lshl_add_u32 v75, v75, 3, s38
    v_min_u32 v75, s39, v75
    s_waitcnt vmcnt(12)
    v_cndmask_b32 v75, v82, v75, s[44:45]
    v_smfmac_f32_16x16x64_bf16 v[132:135], a[44:47], v[204:211], v17
    s_add_u32 s43, s43, 4096
    buffer_load_dwordx4 a[92:95], v11, s[16:19], s43 offen offset:0 sc1
    ds_write_b64 v75, v[70:71]
    s_bcnt1_i32_b64 s30, s[44:45]
    s_lshl3_add_u32 s38, s30, s38
    ds_read_b64 v[56:57], v55 offset:0
    ds_read_b64 v[58:59], v55 offset:512
    ds_read_b64 v[60:61], v55 offset:1024
    v_smfmac_f32_16x16x64_bf16 v[168:171], a[44:47], v[220:227], v17
    s_waitcnt vmcnt(12)
    v_smfmac_f32_16x16x64_bf16 v[136:139], a[48:51], v[204:211], v17 abid:1
    buffer_load_dwordx4 a[96:99], v11, s[16:19], s43 offen offset:1024 sc1
    v_smfmac_f32_16x16x64_bf16 v[172:175], a[48:51], v[220:227], v17 abid:1
    s_waitcnt vmcnt(12)
    v_smfmac_f32_16x16x64_bf16 v[140:143], a[52:55], v[204:211], v18
    buffer_load_dwordx4 a[100:103], v11, s[16:19], s43 offen offset:2048 sc1
    s_waitcnt lgkmcnt(2)
    v_bfe_u32 v74, v56, 24, 4
    v_smfmac_f32_16x16x64_bf16 v[176:179], a[52:55], v[220:227], v18
    v_lshlrev_b32 v75, 1, v56
    v_lshl_add_u32 v74, v74, 2, s49
    v_and_b32 v75, 16, v75
    s_waitcnt vmcnt(12)
    v_and_or_b32 v74, v56, 2.0, v74
    v_smfmac_f32_16x16x64_bf16 v[144:147], a[56:59], v[204:211], v18 abid:1
    buffer_load_dwordx4 a[104:107], v11, s[16:19], s43 offen offset:3072 sc1
    v_lshlrev_b32 v75, v75, 1
    v_smfmac_f32_16x16x64_bf16 v[180:183], a[56:59], v[220:227], v18 abid:1
    ds_add_rtn_u32 v62, v74, v75
    s_waitcnt lgkmcnt(2)
    v_bfe_u32 v76, v58, 24, 4
    v_lshlrev_b32 v77, 1, v58
    v_lshl_add_u32 v76, v76, 2, s49
    s_waitcnt vmcnt(12)
    v_and_b32 v77, 16, v77
    v_smfmac_f32_16x16x64_bf16 v[148:151], a[60:63], v[204:211], v19
    s_add_u32 s43, s43, 4096
    buffer_load_dwordx4 v[24:27], v11, s[16:19], s43 offen offset:0 sc1
    buffer_load_dwordx4 a[108:111], v11, s[16:19], s43 offen offset:1024 sc1
    v_and_or_b32 v76, v58, 2.0, v76
    v_smfmac_f32_16x16x64_bf16 v[184:187], a[60:63], v[220:227], v19
    s_waitcnt vmcnt(13)
    v_lshlrev_b32 v77, v77, 1
    v_smfmac_f32_16x16x64_bf16 v[152:155], a[64:67], v[204:211], v19 abid:1
    buffer_load_dwordx4 a[112:115], v11, s[16:19], s43 offen offset:2048 sc1
    ds_add_rtn_u32 v63, v76, v77
    s_waitcnt lgkmcnt(2)
    s_cmp_gt_u32 s38, s35
    s_cbranch_scc1 M_r3
M_r3r:
    ds_read_b32 v81, v84
    v_and_b32 v74, 8, v56
    v_smfmac_f32_16x16x64_bf16 v[188:191], a[64:67], v[220:227], v19 abid:1
    v_lshrrev_b32 v77, 14, v56
    v_cmp_ne_u32 s[44:45], 0, v74
    v_and_b32 v80, 0x3cf0, v77
    s_waitcnt lgkmcnt(2)
    v_lshrrev_b32 v75, 16, v62
    v_and_b32 v76, 0xffff, v62
    s_waitcnt vmcnt(13)
    v_sub_u32 v74, 15, v75
    v_smfmac_f32_16x16x64_bf16 v[156:159], a[68:71], v[204:211], v48 abid:1
    buffer_load_dwordx4 a[116:119], v11, s[16:19], s43 offen offset:3072 sc1
    v_and_b32 v62, 2.0, v56
    v_smfmac_f32_16x16x64_bf16 v[192:195], a[68:71], v[220:227], v48 abid:1
    v_add3_u32 v62, v76, v75, v62
    v_cndmask_b32 v74, v76, v74, s[44:45]
    v_cmp_gt_u32 s[44:45], 16, v62
    v_cmp_gt_u32 s[36:37], 2.0, v62
    v_lshlrev_b32 v74, 2, v74
    s_waitcnt vmcnt(12)
    v_lshrrev_b64 v[76:77], v74, s[50:51]
    v_smfmac_f32_16x16x64_bf16 v[124:127], a[72:75], v[196:203], v20
    s_add_u32 s43, s43, 4096
    buffer_load_dwordx4 a[120:123], v11, s[16:19], s43 offen offset:0 sc1
    s_andn2_b64 s[36:37], s[36:37], s[44:45]
    v_lshrrev_b64 v[78:79], v74, s[52:53]
    v_smfmac_f32_16x16x64_bf16 v[160:163], a[72:75], v[228:235], v20
    ds_read_b128 v[204:207], v1 offset:3072
    ds_read_b128 v[208:211], v2 offset:3072
    v_bfe_u32 v74, v56, 24, 4
    v_mbcnt_lo_u32_b32 v75, s36, 0
    v_and_b32 v76, 15, v76
    v_mbcnt_hi_u32_b32 v75, s37, v75
    v_and_b32 v78, 15, v78
    s_waitcnt vmcnt(12)
    v_lshl_add_u32 v75, v75, 3, s40
    v_smfmac_f32_16x16x64_bf16 v[128:131], a[76:79], v[196:203], v20 abid:1
    buffer_load_dwordx4 a[124:127], v11, s[16:19], s43 offen offset:1024 sc1
    v_lshl_add_u32 v76, v74, 4, v76
    v_smfmac_f32_16x16x64_bf16 v[164:167], a[76:79], v[228:235], v20 abid:1
    ds_read_b128 v[220:223], v1 offset:21504
    ds_read_b128 v[224:227], v2 offset:21504
    v_min_u32 v75, s41, v75
    v_mul_u32_u24 v78, 68, v78
    s_waitcnt vmcnt(12)
    v_cndmask_b32 v75, v82, v75, s[36:37]
    v_smfmac_f32_16x16x64_bf16 v[132:135], a[80:83], v[196:203], v21
    buffer_load_dwordx4 a[128:131], v11, s[16:19], s43 offen offset:2048 sc1
    ds_write_b64 v75, v[56:57]
    s_bcnt1_i32_b64 s30, s[36:37]
    s_lshl3_add_u32 s40, s30, s40
    v_lshl_add_u32 v76, v76, 2, s47
    v_smfmac_f32_16x16x64_bf16 v[168:171], a[80:83], v[228:235], v21
    v_and_b32 v78, 0x30c, v78
    v_cndmask_b32 v76, v82, v76, s[44:45]
    v_add3_u32 v77, v80, v78, s29
    v_and_b32 v78, 0x3fff, v56
    s_waitcnt vmcnt(12)
    v_cndmask_b32 v74, v82, v77, s[44:45]
    v_smfmac_f32_16x16x64_bf16 v[136:139], a[84:87], v[196:203], v21 abid:1
    buffer_load_dwordx4 a[132:135], v11, s[16:19], s43 offen offset:3072 sc1
    ds_write_b32 v76, v78
    ds_write_b32 v74, v57
    v_and_b32 v74, 8, v58
    v_smfmac_f32_16x16x64_bf16 v[172:175], a[84:87], v[228:235], v21 abid:1
    v_lshrrev_b32 v77, 14, v58
    v_cmp_ne_u32 s[44:45], 0, v74
    v_and_b32 v80, 0x3cf0, v77
    s_waitcnt lgkmcnt(8)
    s_waitcnt vmcnt(12)
    v_lshrrev_b32 v75, 16, v63
    v_smfmac_f32_16x16x64_bf16 v[140:143], a[88:91], v[196:203], v22
    s_add_u32 s43, s43, 4096
    buffer_load_dwordx4 a[136:139], v11, s[16:19], s43 offen offset:0 sc1
    v_and_b32 v76, 0xffff, v63
    v_smfmac_f32_16x16x64_bf16 v[176:179], a[88:91], v[228:235], v22
    v_sub_u32 v74, 15, v75
    v_and_b32 v63, 2.0, v58
    v_add3_u32 v63, v76, v75, v63
    v_cndmask_b32 v74, v76, v74, s[44:45]
    s_waitcnt vmcnt(12)
    v_cmp_gt_u32 s[44:45], 16, v63
    v_smfmac_f32_16x16x64_bf16 v[144:147], a[92:95], v[196:203], v22 abid:1
    buffer_load_dwordx4 a[140:143], v11, s[16:19], s43 offen offset:1024 sc1
    v_cmp_gt_u32 s[36:37], 2.0, v63
    v_smfmac_f32_16x16x64_bf16 v[180:183], a[92:95], v[228:235], v22 abid:1
    v_lshlrev_b32 v74, 2, v74
    s_waitcnt vmcnt(12)
    v_lshrrev_b64 v[76:77], v74, s[50:51]
    v_smfmac_f32_16x16x64_bf16 v[148:151], a[96:99], v[196:203], v23
    buffer_load_dwordx4 v[28:31], v11, s[16:19], s43 offen offset:2048 sc1
    buffer_load_dwordx4 a[144:147], v11, s[16:19], s43 offen offset:3072 sc1
    s_andn2_b64 s[36:37], s[36:37], s[44:45]
    v_lshrrev_b64 v[78:79], v74, s[52:53]
    v_smfmac_f32_16x16x64_bf16 v[184:187], a[96:99], v[228:235], v23
    v_bfe_u32 v74, v58, 24, 4
    v_mbcnt_lo_u32_b32 v75, s36, 0
    v_and_b32 v76, 15, v76
    v_mbcnt_hi_u32_b32 v75, s37, v75
    v_and_b32 v78, 15, v78
    s_waitcnt vmcnt(13)
    v_lshl_add_u32 v75, v75, 3, s40
    v_smfmac_f32_16x16x64_bf16 v[152:155], a[100:103], v[196:203], v23 abid:1
    s_add_u32 s43, s43, 4096
    buffer_load_dwordx4 a[148:151], v11, s[16:19], s43 offen offset:0 sc1
    v_lshl_add_u32 v76, v74, 4, v76
    v_smfmac_f32_16x16x64_bf16 v[188:191], a[100:103], v[228:235], v23 abid:1
    v_min_u32 v75, s41, v75
    v_mul_u32_u24 v78, 68, v78
    s_waitcnt vmcnt(13)
    v_cndmask_b32 v75, v82, v75, s[36:37]
    v_smfmac_f32_16x16x64_bf16 v[156:159], a[104:107], v[196:203], v49
    buffer_load_dwordx4 a[152:155], v11, s[16:19], s43 offen offset:1024 sc1
    ds_write_b64 v75, v[58:59]
    s_bcnt1_i32_b64 s30, s[36:37]
    s_lshl3_add_u32 s40, s30, s40
    v_lshl_add_u32 v76, v76, 2, s47
    v_smfmac_f32_16x16x64_bf16 v[192:195], a[104:107], v[228:235], v49
    v_and_b32 v78, 0x30c, v78
    v_cndmask_b32 v76, v82, v76, s[44:45]
    v_add3_u32 v77, v80, v78, s29
    v_and_b32 v78, 0x3fff, v58
    s_waitcnt vmcnt(12)
    s_waitcnt lgkmcnt(6)
    v_cndmask_b32 v74, v82, v77, s[44:45]
    v_smfmac_f32_16x16x64_bf16 v[124:127], a[108:111], v[204:211], v24
    buffer_load_dwordx4 a[156:159], v11, s[16:19], s43 offen offset:2048 sc1
    ds_write_b32 v76, v78
    ds_write_b32 v74, v59
    s_waitcnt lgkmcnt(6)
    v_lshrrev_b32 v74, 16, v81
    v_smfmac_f32_16x16x64_bf16 v[160:163], a[108:111], v[220:227], v24
    ds_read_b128 v[196:199], v1 offset:4096
    ds_read_b128 v[200:203], v2 offset:4096
    v_and_b32 v81, 0xffff, v81
    v_add_u32 v81, v81, v74
    s_waitcnt vmcnt(12)
    v_cmp_lt_u32 s[34:35], 16, v81
    v_smfmac_f32_16x16x64_bf16 v[128:131], a[112:115], v[204:211], v24 abid:1
    buffer_load_dwordx4 a[160:163], v11, s[16:19], s43 offen offset:3072 sc1
    s_sub_u32 s46, s40, s48
    s_add_u32 s46, s46, 56
    s_lshr_b32 s46, s46, 6
    s_mov_b32 s21, 0
    s_and_b32 s27, s34, 0x1ff
    s_cmp_gt_u32 s46, 4
    s_cselect_b32 s32, 1, s32
    s_or_b32 s32, s32, s33
    s_cbranch_scc1 M_dn
M_dnr:
    ds_read_b128 v[56:59], v9 offset:9792
    s_bcnt1_i32_b32 s30, s27
    s_cmp_gt_u32 s30, 3
    s_cselect_b32 s34, 0, s27
    s_cselect_b32 s80, 0, 1
    s_getpc_b64 s[36:37]
M_pc:
    v_bfe_u32 v74, v11, 4, 4
    v_smfmac_f32_16x16x64_bf16 v[164:167], a[112:115], v[220:227], v24 abid:1
    ds_read_b128 v[228:231], v1 offset:22528
    ds_read_b128 v[232:235], v2 offset:22528
    s_waitcnt vmcnt(12)
    v_smfmac_f32_16x16x64_bf16 v[132:135], a[116:119], v[204:211], v25
    s_add_u32 s43, s43, 4096
    buffer_load_dwordx4 a[164:167], v11, s[16:19], s43 offen offset:0 sc1
    s_ff1_i32_b32 s81, s34
    s_bitset0_b32 s34, s81
    s_mul_i32 s30, s81, 20
    s_add_u32 s31, s30, M_ovc0-M_pc
    s_add_u32 s30, s30, M_ovl0-M_pc
    s_cmp_lg_u32 s34, 0
    s_cselect_b32 s30, s31, s30
    s_cmp_lt_i32 s81, 0
    s_cselect_b32 s30, M_ovn-M_pc, s30
    s_add_u32 s72, s36, s30
    s_addc_u32 s73, s37, 0
    s_ff1_i32_b32 s82, s34
    s_bitset0_b32 s34, s82
    s_mul_i32 s30, s82, 20
    s_add_u32 s31, s30, M_ovc1-M_pc
    s_add_u32 s30, s30, M_ovl1-M_pc
    s_cmp_lg_u32 s34, 0
    s_cselect_b32 s30, s31, s30
    s_cmp_lt_i32 s82, 0
    s_cselect_b32 s30, M_ovn-M_pc, s30
    v_smfmac_f32_16x16x64_bf16 v[168:171], a[116:119], v[220:227], v25
    s_waitcnt vmcnt(12)
    v_smfmac_f32_16x16x64_bf16 v[136:139], a[120:123], v[204:211], v25 abid:1
    buffer_load_dwordx4 a[168:171], v11, s[16:19], s43 offen offset:1024 sc1
    s_add_u32 s74, s36, s30
    s_addc_u32 s75, s37, 0
    s_ff1_i32_b32 s83, s34
    s_bitset0_b32 s34, s83
    s_mul_i32 s30, s83, 20
    s_add_u32 s31, s30, M_ovc1-M_pc
    s_add_u32 s30, s30, M_ovl2-M_pc
    s_cmp_lg_u32 s34, 0
    s_cselect_b32 s30, s31, s30
    s_cmp_lt_i32 s83, 0
    s_cselect_b32 s30, M_ovn-M_pc, s30
    s_add_u32 s76, s36, s30
    s_addc_u32 s77, s37, 0
    s_waitcnt lgkmcnt(2)
    v_lshrrev_b32 v76, 18, v56
    v_smfmac_f32_16x16x64_bf16 v[172:175], a[120:123], v[220:227], v25 abid:1
    s_waitcnt vmcnt(12)
    v_lshrrev_b32 v77, 18, v58
    v_smfmac_f32_16x16x64_bf16 v[140:143], a[124:127], v[204:211], v26
    buffer_load_dwordx4 a[172:175], v11, s[16:19], s43 offen offset:2048 sc1
    v_and_b32 v78, 0x3fff, v56
    v_smfmac_f32_16x16x64_bf16 v[176:179], a[124:127], v[220:227], v26
    s_waitcnt vmcnt(12)
    v_and_b32 v79, 0x3fff, v58
    v_smfmac_f32_16x16x64_bf16 v[144:147], a[128:131], v[204:211], v26 abid:1
    buffer_load_dwordx4 a[176:179], v11, s[16:19], s43 offen offset:3072 sc1
    ds_write_b64 v9, v[78:79] offset:10056
    v_lshl_or_b32 v75, s81, 6, v74
    v_smfmac_f32_16x16x64_bf16 v[180:183], a[128:131], v[220:227], v26 abid:1
    v_cmp_eq_u32 s[44:45], v76, v75
    v_cmp_eq_u32 s[36:37], v77, v75
    s_nop 0
    v_cndmask_b32 v54, 0, v57, s[44:45]
    v_cndmask_b32 v55, 0, v59, s[36:37]
    v_lshl_or_b32 v75, s82, 6, v74
    s_waitcnt vmcnt(12)
    v_cmp_eq_u32 s[44:45], v76, v75
    v_smfmac_f32_16x16x64_bf16 v[148:151], a[132:135], v[204:211], v27
    s_add_u32 s43, s43, 4096
    buffer_load_dwordx4 v[32:35], v11, s[16:19], s43 offen offset:0 sc1
    buffer_load_dwordx4 a[180:183], v11, s[16:19], s43 offen offset:1024 sc1
    v_cmp_eq_u32 s[36:37], v77, v75
    v_smfmac_f32_16x16x64_bf16 v[184:187], a[132:135], v[220:227], v27
    v_cndmask_b32 v252, 0, v57, s[44:45]
    v_cndmask_b32 v253, 0, v59, s[36:37]
    v_lshl_or_b32 v75, s83, 6, v74
    v_cmp_eq_u32 s[44:45], v76, v75
    v_cmp_eq_u32 s[36:37], v77, v75
    s_nop 0
    s_waitcnt vmcnt(13)
    v_cndmask_b32 v254, 0, v57, s[44:45]
    v_smfmac_f32_16x16x64_bf16 v[152:155], a[136:139], v[204:211], v27 abid:1
    buffer_load_dwordx4 a[184:187], v11, s[16:19], s43 offen offset:2048 sc1
    v_cndmask_b32 v255, 0, v59, s[36:37]
    v_smfmac_f32_16x16x64_bf16 v[188:191], a[136:139], v[220:227], v27 abid:1
    ds_read_b128 v[236:239], v9 offset:9408
    ds_read_b64 v[216:217], v9 offset:10056
    s_waitcnt vmcnt(13)
    v_smfmac_f32_16x16x64_bf16 v[156:159], a[140:143], v[204:211], v49 abid:1
    buffer_load_dwordx4 a[188:191], v11, s[16:19], s43 offen offset:3072 sc1
    s_waitcnt lgkmcnt(1)
    v_xad_u32 v236, v236, v3, v4
    v_smfmac_f32_16x16x64_bf16 v[192:195], a[140:143], v[220:227], v49 abid:1
    s_waitcnt vmcnt(12)
    v_xad_u32 v237, v237, v3, v4
    v_smfmac_f32_16x16x64_bf16 v[124:127], a[144:147], v[196:203], v28
    s_add_u32 s43, s43, 4096
    buffer_load_dwordx4 a[192:195], v11, s[16:19], s43 offen offset:0 sc1
    ds_read2st64_b32 v[244:245], v236 offset0:0 offset1:72
    ds_read2st64_b32 v[246:247], v237 offset0:0 offset1:72
    v_xad_u32 v238, v238, v3, v4
    v_smfmac_f32_16x16x64_bf16 v[160:163], a[144:147], v[228:235], v28
    ds_read_b128 v[204:207], v1 offset:5120
    ds_read_b128 v[208:211], v2 offset:5120
    s_waitcnt vmcnt(12)
    v_xad_u32 v239, v239, v3, v4
    v_smfmac_f32_16x16x64_bf16 v[128:131], a[148:151], v[196:203], v28 abid:1
    buffer_load_dwordx4 a[196:199], v11, s[16:19], s43 offen offset:1024 sc1
    ds_read2st64_b32 v[248:249], v238 offset0:0 offset1:72
    ds_read2st64_b32 v[250:251], v239 offset0:0 offset1:72
    ds_read_b128 v[240:243], v8 offset:3072
    ds_read_b128 v[236:239], v9 offset:9280
    s_waitcnt lgkmcnt(8)
    v_xad_u32 v212, v216, v3, v4
    v_smfmac_f32_16x16x64_bf16 v[164:167], a[148:151], v[228:235], v28 abid:1
    ds_read_b128 v[220:223], v1 offset:23552
    ds_read_b128 v[224:227], v2 offset:23552
    ds_read2st64_b32 v[212:213], v212 offset0:0 offset1:72
    s_waitcnt vmcnt(12)
    v_xad_u32 v214, v217, v3, v4
    v_smfmac_f32_16x16x64_bf16 v[132:135], a[152:155], v[196:203], v29
    buffer_load_dwordx4 a[200:203], v11, s[16:19], s43 offen offset:2048 sc1
    ds_read2st64_b32 v[214:215], v214 offset0:0 offset1:72
    v_smfmac_f32_16x16x64_bf16 v[168:171], a[152:155], v[228:235], v29
    s_waitcnt vmcnt(12)
    v_smfmac_f32_16x16x64_bf16 v[136:139], a[156:159], v[196:203], v29 abid:1
    buffer_load_dwordx4 a[204:207], v11, s[16:19], s43 offen offset:3072 sc1
    v_smfmac_f32_16x16x64_bf16 v[172:175], a[156:159], v[228:235], v29 abid:1
    s_waitcnt vmcnt(12)
    v_smfmac_f32_16x16x64_bf16 v[140:143], a[160:163], v[196:203], v30
    s_add_u32 s43, s43, 4096
    buffer_load_dwordx4 a[208:211], v11, s[16:19], s43 offen offset:0 sc1
    s_waitcnt lgkmcnt(5)
    v_smfmac_f32_16x16x64_bf16 v[136:139], v[240:243], v[244:251], v10
    v_smfmac_f32_16x16x64_bf16 v[172:175], v[240:243], v[244:251], v10 abid:1
    s_waitcnt lgkmcnt(4)
    v_xad_u32 v236, v236, v3, v4
    v_smfmac_f32_16x16x64_bf16 v[176:179], a[160:163], v[228:235], v30
    s_waitcnt vmcnt(12)
    v_xad_u32 v237, v237, v3, v4
    v_smfmac_f32_16x16x64_bf16 v[144:147], a[164:167], v[196:203], v30 abid:1
    buffer_load_dwordx4 a[212:215], v11, s[16:19], s43 offen offset:1024 sc1
    ds_read2st64_b32 v[244:245], v236 offset0:0 offset1:72
    ds_read2st64_b32 v[246:247], v237 offset0:0 offset1:72
    v_xad_u32 v238, v238, v3, v4
    v_smfmac_f32_16x16x64_bf16 v[180:183], a[164:167], v[228:235], v30 abid:1
    s_waitcnt vmcnt(12)
    v_xad_u32 v239, v239, v3, v4
    v_smfmac_f32_16x16x64_bf16 v[148:151], a[168:171], v[196:203], v31
    buffer_load_dwordx4 v[36:39], v11, s[16:19], s43 offen offset:2048 sc1
    buffer_load_dwordx4 a[216:219], v11, s[16:19], s43 offen offset:3072 sc1
    ds_read2st64_b32 v[248:249], v238 offset0:0 offset1:72
    ds_read2st64_b32 v[250:251], v239 offset0:0 offset1:72
    ds_read_b128 v[240:243], v8 offset:1024
    ds_read_b128 v[236:239], v9 offset:9344
    v_smfmac_f32_16x16x64_bf16 v[184:187], a[168:171], v[228:235], v31
    s_waitcnt vmcnt(13)
    v_smfmac_f32_16x16x64_bf16 v[152:155], a[172:175], v[196:203], v31 abid:1
    s_add_u32 s43, s43, 4096
    buffer_load_dwordx4 a[220:223], v11, s[16:19], s43 offen offset:0 sc1
    s_waitcnt lgkmcnt(6)
    s_cmp_lt_i32 s81, 0
    s_cbranch_scc1 M_ovr0
    s_swappc_b64 s[78:79], s[72:73]
M_ovr0:
    v_smfmac_f32_16x16x64_bf16 v[188:191], a[172:175], v[228:235], v31 abid:1
    s_waitcnt vmcnt(13)
    v_smfmac_f32_16x16x64_bf16 v[156:159], a[176:179], v[196:203], v50
    buffer_load_dwordx4 a[224:227], v11, s[16:19], s43 offen offset:1024 sc1
    v_smfmac_f32_16x16x64_bf16 v[192:195], a[176:179], v[228:235], v50
    s_waitcnt vmcnt(12)
    v_smfmac_f32_16x16x64_bf16 v[124:127], a[180:183], v[204:211], v32
    buffer_load_dwordx4 a[228:231], v11, s[16:19], s43 offen offset:2048 sc1
    s_waitcnt lgkmcnt(1)
    v_smfmac_f32_16x16x64_bf16 v[128:131], v[240:243], v[244:251], v10
    v_smfmac_f32_16x16x64_bf16 v[164:167], v[240:243], v[244:251], v10 abid:1
    s_waitcnt lgkmcnt(0)
    v_xad_u32 v236, v236, v3, v4
    v_smfmac_f32_16x16x64_bf16 v[160:163], a[180:183], v[220:227], v32
    ds_read_b128 v[196:199], v1 offset:6144
    ds_read_b128 v[200:203], v2 offset:6144
    s_waitcnt vmcnt(12)
    v_xad_u32 v237, v237, v3, v4
    v_smfmac_f32_16x16x64_bf16 v[128:131], a[184:187], v[204:211], v32 abid:1
    buffer_load_dwordx4 a[232:235], v11, s[16:19], s43 offen offset:3072 sc1
    ds_read2st64_b32 v[244:245], v236 offset0:0 offset1:72
    ds_read2st64_b32 v[246:247], v237 offset0:0 offset1:72
    v_xad_u32 v238, v238, v3, v4
    v_smfmac_f32_16x16x64_bf16 v[164:167], a[184:187], v[220:227], v32 abid:1
    ds_read_b128 v[228:231], v1 offset:24576
    ds_read_b128 v[232:235], v2 offset:24576
    s_waitcnt vmcnt(12)
    v_xad_u32 v239, v239, v3, v4
    v_smfmac_f32_16x16x64_bf16 v[132:135], a[188:191], v[204:211], v33
    s_add_u32 s43, s43, 4096
    buffer_load_dwordx4 a[236:239], v11, s[16:19], s43 offen offset:0 sc1
    ds_read2st64_b32 v[248:249], v238 offset0:0 offset1:72
    ds_read2st64_b32 v[250:251], v239 offset0:0 offset1:72
    ds_read_b128 v[240:243], v8 offset:2048
    ds_read_b128 v[236:239], v9 offset:9216
    v_smfmac_f32_16x16x64_bf16 v[168:171], a[188:191], v[220:227], v33
    s_waitcnt vmcnt(12)
    v_smfmac_f32_16x16x64_bf16 v[136:139], a[192:195], v[204:211], v33 abid:1
    buffer_load_dwordx4 a[240:243], v11, s[16:19], s43 offen offset:1024 sc1
    v_smfmac_f32_16x16x64_bf16 v[172:175], a[192:195], v[220:227], v33 abid:1
    s_waitcnt vmcnt(12)
    v_smfmac_f32_16x16x64_bf16 v[140:143], a[196:199], v[204:211], v34
    buffer_load_dwordx4 a[244:247], v11, s[16:19], s43 offen offset:2048 sc1
    v_smfmac_f32_16x16x64_bf16 v[176:179], a[196:199], v[220:227], v34
    s_waitcnt vmcnt(12)
    v_smfmac_f32_16x16x64_bf16 v[144:147], a[200:203], v[204:211], v34 abid:1
    buffer_load_dwordx4 a[248:251], v11, s[16:19], s43 offen offset:3072 sc1
    s_waitcnt lgkmcnt(1)
    v_smfmac_f32_16x16x64_bf16 v[132:135], v[240:243], v[244:251], v10
    v_smfmac_f32_16x16x64_bf16 v[168:171], v[240:243], v[244:251], v10 abid:1
    s_waitcnt lgkmcnt(0)
    v_xad_u32 v236, v236, v3, v4
    v_smfmac_f32_16x16x64_bf16 v[180:183], a[200:203], v[220:227], v34 abid:1
    s_waitcnt vmcnt(12)
    v_xad_u32 v237, v237, v3, v4
    v_smfmac_f32_16x16x64_bf16 v[148:151], a[204:207], v[204:211], v35
    s_add_u32 s43, s43, 4096
    buffer_load_dwordx4 v[40:43], v11, s[16:19], s43 offen offset:0 sc1
    buffer_load_dwordx4 a[252:255], v11, s[16:19], s43 offen offset:1024 sc1
    ds_read2st64_b32 v[244:245], v236 offset0:0 offset1:72
    ds_read2st64_b32 v[246:247], v237 offset0:0 offset1:72
    v_xad_u32 v238, v238, v3, v4
    v_smfmac_f32_16x16x64_bf16 v[184:187], a[204:207], v[220:227], v35
    s_waitcnt vmcnt(13)
    v_xad_u32 v239, v239, v3, v4
    v_smfmac_f32_16x16x64_bf16 v[152:155], a[208:211], v[204:211], v35 abid:1
    buffer_load_dwordx4 v[56:59], v11, s[16:19], s43 offen offset:2048 sc1
    ds_read2st64_b32 v[248:249], v238 offset0:0 offset1:72
    ds_read2st64_b32 v[250:251], v239 offset0:0 offset1:72
    ds_read_b128 v[240:243], v8 offset:0
    ds_read_b128 v[236:239], v9 offset:9728
    v_smfmac_f32_16x16x64_bf16 v[188:191], a[208:211], v[220:227], v35 abid:1
    s_waitcnt vmcnt(13)
    v_smfmac_f32_16x16x64_bf16 v[156:159], a[212:215], v[204:211], v50 abid:1
    buffer_load_dwordx4 v[60:63], v11, s[16:19], s43 offen offset:3072 sc1
    v_smfmac_f32_16x16x64_bf16 v[192:195], a[212:215], v[220:227], v50 abid:1
    s_waitcnt vmcnt(12)
    v_smfmac_f32_16x16x64_bf16 v[124:127], a[216:219], v[196:203], v36
    s_add_u32 s43, s43, 4096
    buffer_load_dwordx4 v[64:67], v11, s[16:19], s43 offen offset:0 sc1
    v_smfmac_f32_16x16x64_bf16 v[160:163], a[216:219], v[228:235], v36
    ds_read_b128 v[204:207], v1 offset:7168
    ds_read_b128 v[208:211], v2 offset:7168
    s_waitcnt vmcnt(12)
    v_smfmac_f32_16x16x64_bf16 v[128:131], a[220:223], v[196:203], v36 abid:1
    buffer_load_dwordx4 v[68:71], v11, s[16:19], s43 offen offset:1024 sc1
    s_waitcnt lgkmcnt(3)
    v_smfmac_f32_16x16x64_bf16 v[124:127], v[240:243], v[244:251], v10
    v_smfmac_f32_16x16x64_bf16 v[160:163], v[240:243], v[244:251], v10 abid:1
    s_waitcnt lgkmcnt(2)
    v_xad_u32 v236, v236, v3, v4
    v_smfmac_f32_16x16x64_bf16 v[164:167], a[220:223], v[228:235], v36 abid:1
    ds_read_b128 v[220:223], v1 offset:25600
    ds_read_b128 v[224:227], v2 offset:25600
    s_waitcnt vmcnt(12)
    v_xad_u32 v237, v237, v3, v4
    v_smfmac_f32_16x16x64_bf16 v[132:135], a[224:227], v[196:203], v37
    buffer_load_dwordx4 v[72:75], v11, s[16:19], s43 offen offset:2048 sc1
    ds_read2st64_b32 v[244:245], v236 offset0:0 offset1:72
    ds_read2st64_b32 v[246:247], v237 offset0:0 offset1:72
    v_xad_u32 v238, v238, v3, v4
    v_smfmac_f32_16x16x64_bf16 v[168:171], a[224:227], v[228:235], v37
    s_waitcnt vmcnt(12)
    v_xad_u32 v239, v239, v3, v4
    v_smfmac_f32_16x16x64_bf16 v[136:139], a[228:231], v[196:203], v37 abid:1
    buffer_load_dwordx4 v[76:79], v11, s[16:19], s43 offen offset:3072 sc1
    ds_read2st64_b32 v[248:249], v238 offset0:0 offset1:72
    ds_read2st64_b32 v[250:251], v239 offset0:0 offset1:72
    ds_read_b128 v[240:243], v8 offset:8192
    ds_read_b128 v[236:239], v9 offset:9664
    v_smfmac_f32_16x16x64_bf16 v[172:175], a[228:231], v[228:235], v37 abid:1
    s_waitcnt vmcnt(12)
    v_smfmac_f32_16x16x64_bf16 v[140:143], a[232:235], v[196:203], v38
    s_add_u32 s43, s43, 4096
    buffer_load_dwordx4 v[80:83], v11, s[16:19], s43 offen offset:0 sc1
    v_smfmac_f32_16x16x64_bf16 v[176:179], a[232:235], v[228:235], v38
    s_waitcnt vmcnt(12)
    v_smfmac_f32_16x16x64_bf16 v[144:147], a[236:239], v[196:203], v38 abid:1
    buffer_load_dwordx4 v[84:87], v11, s[16:19], s43 offen offset:1024 sc1
    v_smfmac_f32_16x16x64_bf16 v[180:183], a[236:239], v[228:235], v38 abid:1
    s_waitcnt vmcnt(12)
    v_smfmac_f32_16x16x64_bf16 v[148:151], a[240:243], v[196:203], v39
    buffer_load_dwordx4 v[44:47], v11, s[16:19], s43 offen offset:2048 sc1
    buffer_load_dwordx4 v[88:91], v11, s[16:19], s43 offen offset:3072 sc1
    s_waitcnt lgkmcnt(1)
    v_smfmac_f32_16x16x64_bf16 v[156:159], v[240:243], v[244:251], v10
    v_smfmac_f32_16x16x64_bf16 v[192:195], v[240:243], v[244:251], v10 abid:1
    s_waitcnt lgkmcnt(0)
    v_xad_u32 v236, v236, v3, v4
    v_smfmac_f32_16x16x64_bf16 v[184:187], a[240:243], v[228:235], v39
    s_waitcnt vmcnt(13)
    v_xad_u32 v237, v237, v3, v4
    v_smfmac_f32_16x16x64_bf16 v[152:155], a[244:247], v[196:203], v39 abid:1
    s_add_u32 s43, s43, 4096
    buffer_load_dwordx4 v[92:95], v11, s[16:19], s43 offen offset:0 sc1
    ds_read2st64_b32 v[244:245], v236 offset0:0 offset1:72
    ds_read2st64_b32 v[246:247], v237 offset0:0 offset1:72
    v_xad_u32 v238, v238, v3, v4
    v_smfmac_f32_16x16x64_bf16 v[188:191], a[244:247], v[228:235], v39 abid:1
    s_waitcnt vmcnt(13)
    v_xad_u32 v239, v239, v3, v4
    v_smfmac_f32_16x16x64_bf16 v[156:159], a[248:251], v[196:203], v51
    buffer_load_dwordx4 v[96:99], v11, s[16:19], s43 offen offset:1024 sc1
    ds_read2st64_b32 v[248:249], v238 offset0:0 offset1:72
    ds_read2st64_b32 v[250:251], v239 offset0:0 offset1:72
    ds_read_b128 v[240:243], v8 offset:7168
    ds_read_b128 v[236:239], v9 offset:9536
    v_smfmac_f32_16x16x64_bf16 v[192:195], a[248:251], v[228:235], v51
    s_waitcnt vmcnt(12)
    v_smfmac_f32_16x16x64_bf16 v[124:127], a[252:255], v[204:211], v40
    buffer_load_dwordx4 v[100:103], v11, s[16:19], s43 offen offset:2048 sc1
    ds_read_b128 v[196:199], v1 offset:8192
    ds_read_b128 v[200:203], v2 offset:8192
    s_waitcnt vmcnt(12)
    v_smfmac_f32_16x16x64_bf16 v[128:131], v[56:59], v[204:211], v40 abid:1
    buffer_load_dwordx4 v[104:107], v11, s[16:19], s43 offen offset:3072 sc1
    ds_read_b128 v[228:231], v1 offset:26624
    ds_read_b128 v[232:235], v2 offset:26624
    s_waitcnt vmcnt(12)
    v_smfmac_f32_16x16x64_bf16 v[132:135], v[60:63], v[204:211], v41
    s_add_u32 s43, s43, 4096
    buffer_load_dwordx4 v[108:111], v11, s[16:19], s43 offen offset:0 sc1
    s_waitcnt lgkmcnt(5)
    v_smfmac_f32_16x16x64_bf16 v[152:155], v[240:243], v[244:251], v10
    v_smfmac_f32_16x16x64_bf16 v[188:191], v[240:243], v[244:251], v10 abid:1
    s_waitcnt lgkmcnt(4)
    v_xad_u32 v236, v236, v3, v4
    s_waitcnt vmcnt(12)
    v_xad_u32 v237, v237, v3, v4
    v_smfmac_f32_16x16x64_bf16 v[136:139], v[64:67], v[204:211], v41 abid:1
    buffer_load_dwordx4 v[112:115], v11, s[16:19], s43 offen offset:1024 sc1
    ds_read2st64_b32 v[244:245], v236 offset0:0 offset1:72
    ds_read2st64_b32 v[246:247], v237 offset0:0 offset1:72
    v_xad_u32 v238, v238, v3, v4
    s_waitcnt vmcnt(12)
    v_xad_u32 v239, v239, v3, v4
    v_smfmac_f32_16x16x64_bf16 v[140:143], v[68:71], v[204:211], v42
    buffer_load_dwordx4 v[116:119], v11, s[16:19], s43 offen offset:2048 sc1
    ds_read2st64_b32 v[248:249], v238 offset0:0 offset1:72
    ds_read2st64_b32 v[250:251], v239 offset0:0 offset1:72
    ds_read_b128 v[240:243], v8 offset:5120
    ds_read_b128 v[236:239], v9 offset:9600
    s_waitcnt vmcnt(12)
    v_smfmac_f32_16x16x64_bf16 v[144:147], v[72:75], v[204:211], v42 abid:1
    buffer_load_dwordx4 v[120:123], v11, s[16:19], s43 offen offset:3072 sc1
    s_waitcnt vmcnt(12)
    v_smfmac_f32_16x16x64_bf16 v[148:151], v[76:79], v[204:211], v43
    s_add_u32 m0, s29, 11840
    s_nop 0
    buffer_load_dword v0, s[8:11], 0 offen lds
    s_mov_b32 m0, s42
    s_nop 0
    buffer_load_dwordx4 v5, s[8:11], s22 offen offset:0 nt lds
    s_waitcnt vmcnt(13)
    v_smfmac_f32_16x16x64_bf16 v[152:155], v[80:83], v[204:211], v43 abid:1
    s_add_u32 m0, m0, 896
    s_nop 0
    buffer_load_dwordx4 v5, s[8:11], s22 offen offset:128 nt lds
    s_waitcnt lgkmcnt(1)
    v_smfmac_f32_16x16x64_bf16 v[144:147], v[240:243], v[244:251], v10
    v_smfmac_f32_16x16x64_bf16 v[180:183], v[240:243], v[244:251], v10 abid:1
    s_waitcnt lgkmcnt(0)
    v_xad_u32 v236, v236, v3, v4
    s_waitcnt vmcnt(13)
    v_xad_u32 v237, v237, v3, v4
    v_smfmac_f32_16x16x64_bf16 v[156:159], v[84:87], v[204:211], v51 abid:1
    s_add_u32 m0, m0, 896
    s_nop 0
    buffer_load_dwordx4 v5, s[8:11], s22 offen offset:256 nt lds
    ds_read2st64_b32 v[244:245], v236 offset0:0 offset1:72
    ds_read2st64_b32 v[246:247], v237 offset0:0 offset1:72
    v_xad_u32 v238, v238, v3, v4
    s_waitcnt vmcnt(12)
    v_xad_u32 v239, v239, v3, v4
    v_smfmac_f32_16x16x64_bf16 v[124:127], v[88:91], v[196:203], v44
    s_add_u32 m0, m0, 896
    s_nop 0
    buffer_load_dwordx4 v5, s[8:11], s22 offen offset:384 nt lds
    ds_read2st64_b32 v[248:249], v238 offset0:0 offset1:72
    ds_read2st64_b32 v[250:251], v239 offset0:0 offset1:72
    ds_read_b128 v[240:243], v8 offset:6144
    ds_read_b128 v[236:239], v9 offset:9472
    s_waitcnt vmcnt(12)
    v_smfmac_f32_16x16x64_bf16 v[128:131], v[92:95], v[196:203], v44 abid:1
    s_waitcnt vmcnt(11)
    v_smfmac_f32_16x16x64_bf16 v[132:135], v[96:99], v[196:203], v45
    s_waitcnt vmcnt(10)
    v_smfmac_f32_16x16x64_bf16 v[136:139], v[100:103], v[196:203], v45 abid:1
    s_waitcnt lgkmcnt(1)
    v_smfmac_f32_16x16x64_bf16 v[148:151], v[240:243], v[244:251], v10
    v_smfmac_f32_16x16x64_bf16 v[184:187], v[240:243], v[244:251], v10 abid:1
    s_waitcnt lgkmcnt(0)
    v_xad_u32 v236, v236, v3, v4
    s_waitcnt vmcnt(9)
    v_xad_u32 v237, v237, v3, v4
    v_smfmac_f32_16x16x64_bf16 v[140:143], v[104:107], v[196:203], v46
    ds_read2st64_b32 v[244:245], v236 offset0:0 offset1:72
    ds_read2st64_b32 v[246:247], v237 offset0:0 offset1:72
    v_xad_u32 v238, v238, v3, v4
    s_waitcnt vmcnt(8)
    v_xad_u32 v239, v239, v3, v4
    v_smfmac_f32_16x16x64_bf16 v[144:147], v[108:111], v[196:203], v46 abid:1
    ds_read2st64_b32 v[248:249], v238 offset0:0 offset1:72
    ds_read2st64_b32 v[250:251], v239 offset0:0 offset1:72
    ds_read_b128 v[240:243], v8 offset:4096
    s_waitcnt vmcnt(7)
    v_smfmac_f32_16x16x64_bf16 v[148:151], v[112:115], v[196:203], v47
    s_waitcnt vmcnt(6)
    v_smfmac_f32_16x16x64_bf16 v[152:155], v[116:119], v[196:203], v47 abid:1
    s_waitcnt vmcnt(5)
    v_smfmac_f32_16x16x64_bf16 v[156:159], v[120:123], v[196:203], v52
    s_waitcnt lgkmcnt(0)
    v_smfmac_f32_16x16x64_bf16 v[140:143], v[240:243], v[244:251], v10
    v_smfmac_f32_16x16x64_bf16 v[176:179], v[240:243], v[244:251], v10 abid:1
    s_cmp_gt_u32 s46, s80
    s_cbranch_scc1 M_slow
M_slowr0:
    s_cmp_eq_u32 s20, 0
    s_mov_b32 s31, 1073903880
    s_cselect_b32 s30, 162048, s31
    v_mov_b32 v11, s31
    v_writelane_b32 v11, s30, 0
    v_cvt_pk_bf16_f32 v124, v124, v125
    v_cvt_pk_bf16_f32 v125, v126, v127
    v_cvt_pk_bf16_f32 v126, v128, v129
    v_cvt_pk_bf16_f32 v127, v130, v131
    v_cvt_pk_bf16_f32 v132, v132, v133
    v_cvt_pk_bf16_f32 v133, v134, v135
    v_cvt_pk_bf16_f32 v134, v136, v137
    v_cvt_pk_bf16_f32 v135, v138, v139
    ds_read_b128 v[136:139], v9 offset:10432
    v_cndmask_b32_dpp v128, v124, v132, vcc row_ror:8 row_mask:0xf bank_mask:0xf
    v_cndmask_b32_dpp v129, v125, v133, vcc row_ror:8 row_mask:0xf bank_mask:0xf
    v_cndmask_b32_dpp v130, v126, v134, vcc row_ror:8 row_mask:0xf bank_mask:0xf
    v_cndmask_b32_dpp v131, v127, v135, vcc row_ror:8 row_mask:0xf bank_mask:0xf
    buffer_store_dwordx4 v[128:131], v6, s[12:15], s59 offen offset:0 sc1
    v_mov_b32_dpp v124, v132 row_ror:8 row_mask:0xf bank_mask:0xc
    v_mov_b32_dpp v125, v133 row_ror:8 row_mask:0xf bank_mask:0xc
    v_mov_b32_dpp v126, v134 row_ror:8 row_mask:0xf bank_mask:0xc
    v_mov_b32_dpp v127, v135 row_ror:8 row_mask:0xf bank_mask:0xc
    buffer_store_dwordx4 v[124:127], v6, s[12:15], s24 offen offset:0 sc1
    ds_read_b128 v[128:131], v9 offset:10304
    ds_read_b128 v[132:135], v9 offset:10368
    ds_read_b128 v[124:127], v9 offset:10240
    v_cvt_pk_bf16_f32 v140, v140, v141
    v_cvt_pk_bf16_f32 v141, v142, v143
    v_cvt_pk_bf16_f32 v142, v144, v145
    v_cvt_pk_bf16_f32 v143, v146, v147
    v_cvt_pk_bf16_f32 v148, v148, v149
    v_cvt_pk_bf16_f32 v149, v150, v151
    v_cvt_pk_bf16_f32 v150, v152, v153
    v_cvt_pk_bf16_f32 v151, v154, v155
    ds_read_b128 v[152:155], v9 offset:10688
    v_cndmask_b32_dpp v144, v140, v148, vcc row_ror:8 row_mask:0xf bank_mask:0xf
    v_cndmask_b32_dpp v145, v141, v149, vcc row_ror:8 row_mask:0xf bank_mask:0xf
    v_cndmask_b32_dpp v146, v142, v150, vcc row_ror:8 row_mask:0xf bank_mask:0xf
    v_cndmask_b32_dpp v147, v143, v151, vcc row_ror:8 row_mask:0xf bank_mask:0xf
    buffer_store_dwordx4 v[144:147], v6, s[12:15], s59 offen offset:128 sc1
    v_mov_b32_dpp v140, v148 row_ror:8 row_mask:0xf bank_mask:0xc
    v_mov_b32_dpp v141, v149 row_ror:8 row_mask:0xf bank_mask:0xc
    v_mov_b32_dpp v142, v150 row_ror:8 row_mask:0xf bank_mask:0xc
    v_mov_b32_dpp v143, v151 row_ror:8 row_mask:0xf bank_mask:0xc
    buffer_store_dwordx4 v[140:143], v6, s[12:15], s24 offen offset:128 sc1
    ds_read_b128 v[144:147], v9 offset:10560
    ds_read_b128 v[148:151], v9 offset:10624
    ds_read_b128 v[140:143], v9 offset:10496
    v_cvt_pk_bf16_f32 v156, v156, v157
    v_cvt_pk_bf16_f32 v157, v158, v159
    ds_write_b64 v53, v[156:157] offset:25728
    ds_read_b128 v[156:159], v9 offset:10752
    s_mov_b32 s89, 0
    s_mov_b32 s101, 34209792
    s_mov_b32 s91, 0
    s_mov_b32 s25, 36864
    s_add_u32 s90, s24, 9437184
    s_mov_b32 s28, s26
    s_add_u32 s23, s24, 18432
    s_cmp_lt_u32 s20, 2
    s_cselect_b32 s66, s23, s24
    s_cselect_b32 s99, s14, 75497472
    s_add_u32 s66, s66, s95
    v_add_u32 v4, 36864, v4
    v_add_u32 v1, 36864, v1
    v_add_u32 v2, 36864, v2
M_top:
M_top1:
    s_add_u32 s23, s24, 18432
    s_add_u32 s58, s24, 27648
    s_mov_b32 s24, s90
    s_add_u32 s59, s90, 9216
    s_waitcnt lgkmcnt(0)
    s_barrier
    ds_read_b128 v[244:247], v8 offset:10816
    v_smfmac_f32_16x16x64_bf16 v[160:163], a[252:255], v[220:227], v40
    ds_read_b128 v[196:199], v1 offset:0
    v_smfmac_f32_16x16x64_bf16 v[160:163], v[88:91], v[228:235], v44
    ds_read_b128 v[200:203], v2 offset:0
    s_cmp_lt_u32 s22, 75497472
    s_cbranch_scc0 M_bF
    s_cmp_lt_u32 s91, 2
    s_cbranch_scc1 M_bE0
M_bL:
    v_smfmac_f32_16x16x64_bf16 v[164:167], v[56:59], v[220:227], v40 abid:1
    ds_read_b128 v[204:207], v1 offset:1024
    v_smfmac_f32_16x16x64_bf16 v[164:167], v[92:95], v[228:235], v44 abid:1
    ds_read_b128 v[208:211], v2 offset:1024
    v_mov_b32 v0, 1
    v_smfmac_f32_16x16x64_bf16 v[168:171], v[60:63], v[220:227], v41
    ds_read_b128 v[212:215], v1 offset:2048
    v_smfmac_f32_16x16x64_bf16 v[168:171], v[96:99], v[228:235], v45
    ds_read_b128 v[216:219], v2 offset:2048
    v_smfmac_f32_16x16x64_bf16 v[172:175], v[64:67], v[220:227], v41 abid:1
    s_waitcnt vmcnt(6)
    s_waitcnt lgkmcnt(6)
    buffer_store_dwordx4 v[244:247], v7, s[12:15], s66 offen sc1
    v_smfmac_f32_16x16x64_bf16 v[172:175], v[100:103], v[228:235], v45 abid:1
    ds_read_b128 v[236:239], v9 offset:9408
    v_smfmac_f32_16x16x64_bf16 v[176:179], v[68:71], v[220:227], v42
    s_waitcnt vmcnt(7)
    buffer_atomic_add v0, v11, s[16:19], s92 offen sc0 sc1
    s_mov_b32 s21, 1
    v_smfmac_f32_16x16x64_bf16 v[176:179], v[104:107], v[228:235], v46
    v_smfmac_f32_16x16x64_bf16 v[180:183], v[72:75], v[220:227], v42 abid:1
    v_cvt_pk_bf16_f32 v160, v160, v161
    v_smfmac_f32_16x16x64_bf16 v[180:183], v[108:111], v[228:235], v46 abid:1
    v_cvt_pk_bf16_f32 v161, v162, v163
    v_smfmac_f32_16x16x64_bf16 v[184:187], v[76:79], v[220:227], v43
    v_cvt_pk_bf16_f32 v162, v164, v165
    v_smfmac_f32_16x16x64_bf16 v[184:187], v[112:115], v[228:235], v47
    v_cvt_pk_bf16_f32 v163, v166, v167
    v_smfmac_f32_16x16x64_bf16 v[188:191], v[80:83], v[220:227], v43 abid:1
    s_add_u32 m0, m0, 896
    v_cvt_pk_bf16_f32 v168, v168, v169
    v_smfmac_f32_16x16x64_bf16 v[188:191], v[116:119], v[228:235], v47 abid:1
    s_waitcnt vmcnt(6)
    buffer_load_dwordx4 v5, s[8:11], s22 offen offset:512 nt lds
    v_cvt_pk_bf16_f32 v169, v170, v171
    v_smfmac_f32_16x16x64_bf16 v[192:195], v[84:87], v[220:227], v51 abid:1
    v_cvt_pk_bf16_f32 v170, v172, v173
    v_smfmac_f32_16x16x64_bf16 v[192:195], v[120:123], v[228:235], v52
    ds_read_b128 v[220:223], v1 offset:3072
    s_waitcnt lgkmcnt(6)
    v_cvt_pk_bf16_f32 v171, v174, v175
    v_smfmac_f32_16x16x64_bf16 v[124:127], a[0:3], v[196:203], v12
    ds_read_b128 v[224:227], v2 offset:3072
    ds_read_b128 v[172:175], v9 offset:10432
    s_waitcnt lgkmcnt(6)
    v_cndmask_b32_dpp v164, v160, v168, vcc row_ror:8 row_mask:0xf bank_mask:0xf
    v_smfmac_f32_16x16x64_bf16 v[124:127], a[36:39], v[204:211], v16
    ds_read_b128 v[228:231], v1 offset:4096
    s_waitcnt lgkmcnt(5)
    v_cndmask_b32_dpp v165, v161, v169, vcc row_ror:8 row_mask:0xf bank_mask:0xf
    v_smfmac_f32_16x16x64_bf16 v[124:127], a[72:75], v[212:219], v20
    ds_read_b128 v[232:235], v2 offset:4096
    v_cndmask_b32_dpp v166, v162, v170, vcc row_ror:8 row_mask:0xf bank_mask:0xf
    v_smfmac_f32_16x16x64_bf16 v[128:131], a[4:7], v[196:203], v12 abid:1
    s_barrier
    v_cndmask_b32_dpp v167, v163, v171, vcc row_ror:8 row_mask:0xf bank_mask:0xf
    v_smfmac_f32_16x16x64_bf16 v[128:131], a[40:43], v[204:211], v16 abid:1
    s_waitcnt vmcnt(7)
    buffer_store_dwordx4 v[164:167], v6, s[12:15], s58 offen offset:0 sc1
    s_waitcnt lgkmcnt(5)
    v_xad_u32 v236, v236, v3, v4
    v_smfmac_f32_16x16x64_bf16 v[128:131], a[76:79], v[212:219], v20 abid:1
    v_xad_u32 v237, v237, v3, v4
    v_smfmac_f32_16x16x64_bf16 v[132:135], a[8:11], v[196:203], v13
    ds_read2st64_b32 v[244:245], v236 offset0:0 offset1:72
    ds_read_b128 v[240:243], v8 offset:3072
    v_xad_u32 v238, v238, v3, v4
    v_smfmac_f32_16x16x64_bf16 v[132:135], a[44:47], v[204:211], v17
    ds_read2st64_b32 v[246:247], v237 offset0:0 offset1:72
    v_xad_u32 v239, v239, v3, v4
    v_smfmac_f32_16x16x64_bf16 v[132:135], a[80:83], v[212:219], v21
    ds_read2st64_b32 v[248:249], v238 offset0:0 offset1:72
    v_mov_b32_dpp v160, v168 row_ror:8 row_mask:0xf bank_mask:0xc
    v_smfmac_f32_16x16x64_bf16 v[144:147], a[20:23], v[196:203], v14 abid:1
    ds_read2st64_b32 v[250:251], v239 offset0:0 offset1:72
    ds_read_b128 v[236:239], v9 offset:9280
    v_mov_b32_dpp v161, v169 row_ror:8 row_mask:0xf bank_mask:0xc
    v_smfmac_f32_16x16x64_bf16 v[144:147], a[56:59], v[204:211], v18 abid:1
    v_mov_b32_dpp v162, v170 row_ror:8 row_mask:0xf bank_mask:0xc
    v_smfmac_f32_16x16x64_bf16 v[144:147], a[92:95], v[212:219], v22 abid:1
    v_mov_b32_dpp v163, v171 row_ror:8 row_mask:0xf bank_mask:0xc
    v_smfmac_f32_16x16x64_bf16 v[140:143], a[16:19], v[196:203], v14
    s_waitcnt vmcnt(6)
    buffer_store_dwordx4 v[160:163], v6, s[12:15], s23 offen offset:0 sc1
    ds_read_b128 v[164:167], v9 offset:10304
    v_smfmac_f32_16x16x64_bf16 v[140:143], a[52:55], v[204:211], v18
    ds_read_b128 v[168:171], v9 offset:10368
    ds_read_b128 v[160:163], v9 offset:10240
    v_smfmac_f32_16x16x64_bf16 v[140:143], a[88:91], v[212:219], v22
    v_smfmac_f32_16x16x64_bf16 v[136:139], a[12:15], v[196:203], v13 abid:1
    v_smfmac_f32_16x16x64_bf16 v[136:139], a[48:51], v[204:211], v17 abid:1
    v_smfmac_f32_16x16x64_bf16 v[136:139], a[84:87], v[212:219], v21 abid:1
    s_waitcnt lgkmcnt(3)
    v_xad_u32 v236, v236, v3, v4
    v_smfmac_f32_16x16x64_bf16 v[136:139], v[240:243], v[244:251], v10
    v_xad_u32 v237, v237, v3, v4
    v_smfmac_f32_16x16x64_bf16 v[172:175], v[240:243], v[244:251], v10 abid:1
    ds_read2st64_b32 v[244:245], v236 offset0:0 offset1:72
    ds_read_b128 v[240:243], v8 offset:1024
    v_xad_u32 v238, v238, v3, v4
    v_smfmac_f32_16x16x64_bf16 v[148:151], a[24:27], v[196:203], v15
    ds_read2st64_b32 v[246:247], v237 offset0:0 offset1:72
    v_xad_u32 v239, v239, v3, v4
    v_smfmac_f32_16x16x64_bf16 v[148:151], a[60:63], v[204:211], v19
    ds_read2st64_b32 v[248:249], v238 offset0:0 offset1:72
    v_cvt_pk_bf16_f32 v192, v192, v193
    v_smfmac_f32_16x16x64_bf16 v[148:151], a[96:99], v[212:219], v23
    ds_read2st64_b32 v[250:251], v239 offset0:0 offset1:72
    ds_read_b128 v[236:239], v9 offset:9344
    v_cvt_pk_bf16_f32 v193, v194, v195
    v_smfmac_f32_16x16x64_bf16 v[152:155], a[28:31], v[196:203], v15 abid:1
    ds_write_b64 v53, v[192:193] offset:0
    ds_read_b128 v[192:195], v9 offset:10752
    v_smfmac_f32_16x16x64_bf16 v[152:155], a[64:67], v[204:211], v19 abid:1
    s_add_u32 m0, m0, 896
    v_smfmac_f32_16x16x64_bf16 v[152:155], a[100:103], v[212:219], v23 abid:1
    s_waitcnt vmcnt(7)
    buffer_load_dwordx4 v5, s[8:11], s22 offen offset:640 nt lds
    v_smfmac_f32_16x16x64_bf16 v[156:159], a[32:35], v[196:203], v48
    v_smfmac_f32_16x16x64_bf16 v[156:159], a[68:71], v[204:211], v48 abid:1
    v_smfmac_f32_16x16x64_bf16 v[156:159], a[104:107], v[212:219], v49
    ds_read_b128 v[196:199], v1 offset:5120
    v_cvt_pk_bf16_f32 v176, v176, v177
    v_smfmac_f32_16x16x64_bf16 v[124:127], a[108:111], v[220:227], v24
    ds_read_b128 v[200:203], v2 offset:5120
    v_cvt_pk_bf16_f32 v177, v178, v179
    v_smfmac_f32_16x16x64_bf16 v[124:127], a[144:147], v[228:235], v28
    ds_read_b128 v[204:207], v1 offset:6144
    ds_read_b64 v[216:217], v9 offset:10056
    v_cvt_pk_bf16_f32 v178, v180, v181
    v_smfmac_f32_16x16x64_bf16 v[128:131], a[112:115], v[220:227], v24 abid:1
    ds_read_b128 v[208:211], v2 offset:6144
    v_cvt_pk_bf16_f32 v179, v182, v183
    v_smfmac_f32_16x16x64_bf16 v[128:131], a[148:151], v[228:235], v28 abid:1
    s_waitcnt lgkmcnt(7)
    v_xad_u32 v236, v236, v3, v4
    v_smfmac_f32_16x16x64_bf16 v[128:131], v[240:243], v[244:251], v10
    s_add_u32 m0, m0, 896
    v_xad_u32 v237, v237, v3, v4
    v_smfmac_f32_16x16x64_bf16 v[164:167], v[240:243], v[244:251], v10 abid:1
    ds_read2st64_b32 v[244:245], v236 offset0:0 offset1:72
    ds_read_b128 v[240:243], v8 offset:2048
    v_xad_u32 v238, v238, v3, v4
    v_smfmac_f32_16x16x64_bf16 v[152:155], a[136:139], v[220:227], v27 abid:1
    ds_read2st64_b32 v[246:247], v237 offset0:0 offset1:72
    s_waitcnt vmcnt(6)
    v_xad_u32 v239, v239, v3, v4
    v_smfmac_f32_16x16x64_bf16 v[152:155], a[172:175], v[228:235], v31 abid:1
    ds_read2st64_b32 v[248:249], v238 offset0:0 offset1:72
    buffer_load_dwordx4 v5, s[8:11], s22 offen offset:768 nt lds
    v_cvt_pk_bf16_f32 v184, v184, v185
    v_smfmac_f32_16x16x64_bf16 v[136:139], a[120:123], v[220:227], v25 abid:1
    ds_read2st64_b32 v[250:251], v239 offset0:0 offset1:72
    ds_read_b128 v[236:239], v9 offset:9216
    v_cvt_pk_bf16_f32 v185, v186, v187
    v_smfmac_f32_16x16x64_bf16 v[136:139], a[156:159], v[228:235], v29 abid:1
    v_cvt_pk_bf16_f32 v186, v188, v189
    v_smfmac_f32_16x16x64_bf16 v[140:143], a[124:127], v[220:227], v26
    v_cvt_pk_bf16_f32 v187, v190, v191
    v_smfmac_f32_16x16x64_bf16 v[140:143], a[160:163], v[228:235], v30
    ds_read_b128 v[188:191], v9 offset:10688
    v_cndmask_b32_dpp v180, v176, v184, vcc row_ror:8 row_mask:0xf bank_mask:0xf
    v_smfmac_f32_16x16x64_bf16 v[144:147], a[128:131], v[220:227], v26 abid:1
    v_cndmask_b32_dpp v181, v177, v185, vcc row_ror:8 row_mask:0xf bank_mask:0xf
    v_smfmac_f32_16x16x64_bf16 v[144:147], a[164:167], v[228:235], v30 abid:1
    v_cndmask_b32_dpp v182, v178, v186, vcc row_ror:8 row_mask:0xf bank_mask:0xf
    v_smfmac_f32_16x16x64_bf16 v[148:151], a[132:135], v[220:227], v27
    v_cndmask_b32_dpp v183, v179, v187, vcc row_ror:8 row_mask:0xf bank_mask:0xf
    v_smfmac_f32_16x16x64_bf16 v[148:151], a[168:171], v[228:235], v31
    s_waitcnt vmcnt(7)
    buffer_store_dwordx4 v[180:183], v6, s[12:15], s58 offen offset:128 sc1
    s_waitcnt lgkmcnt(8)
    v_xad_u32 v212, v216, v3, v4
    v_smfmac_f32_16x16x64_bf16 v[132:135], a[116:119], v[220:227], v25
    ds_read2st64_b32 v[212:213], v212 offset0:0 offset1:72
    v_xad_u32 v214, v217, v3, v4
    v_smfmac_f32_16x16x64_bf16 v[132:135], a[152:155], v[228:235], v29
    ds_read2st64_b32 v[214:215], v214 offset0:0 offset1:72
    s_waitcnt lgkmcnt(3)
    v_xad_u32 v236, v236, v3, v4
    v_smfmac_f32_16x16x64_bf16 v[132:135], v[240:243], v[244:251], v10
    v_xad_u32 v237, v237, v3, v4
    v_smfmac_f32_16x16x64_bf16 v[168:171], v[240:243], v[244:251], v10 abid:1
    ds_read2st64_b32 v[244:245], v236 offset0:0 offset1:72
    ds_read_b128 v[240:243], v8 offset:0
    v_xad_u32 v238, v238, v3, v4
    v_smfmac_f32_16x16x64_bf16 v[156:159], a[140:143], v[220:227], v49 abid:1
    ds_read2st64_b32 v[246:247], v237 offset0:0 offset1:72
    v_xad_u32 v239, v239, v3, v4
    v_smfmac_f32_16x16x64_bf16 v[156:159], a[176:179], v[228:235], v50
    ds_read2st64_b32 v[248:249], v238 offset0:0 offset1:72
    ds_read_b128 v[220:223], v1 offset:7168
    v_mov_b32_dpp v176, v184 row_ror:8 row_mask:0xf bank_mask:0xc
    v_smfmac_f32_16x16x64_bf16 v[140:143], a[196:199], v[196:203], v34
    ds_read2st64_b32 v[250:251], v239 offset0:0 offset1:72
    ds_read_b128 v[236:239], v9 offset:9728
    v_mov_b32_dpp v177, v185 row_ror:8 row_mask:0xf bank_mask:0xc
    v_smfmac_f32_16x16x64_bf16 v[140:143], a[232:235], v[204:211], v38
    ds_read_b128 v[224:227], v2 offset:7168
    v_mov_b32_dpp v178, v186 row_ror:8 row_mask:0xf bank_mask:0xc
    v_smfmac_f32_16x16x64_bf16 v[128:131], a[184:187], v[196:203], v32 abid:1
    ds_read_b128 v[228:231], v1 offset:8192
    v_mov_b32_dpp v179, v187 row_ror:8 row_mask:0xf bank_mask:0xc
    v_smfmac_f32_16x16x64_bf16 v[128:131], a[220:223], v[204:211], v36 abid:1
    ds_read_b128 v[232:235], v2 offset:8192
    s_waitcnt vmcnt(6)
    buffer_store_dwordx4 v[176:179], v6, s[12:15], s23 offen offset:128 sc1
    v_smfmac_f32_16x16x64_bf16 v[132:135], a[188:191], v[196:203], v33
    ds_read_b128 v[180:183], v9 offset:10560
    ds_read_b128 v[184:187], v9 offset:10624
    ds_read_b128 v[176:179], v9 offset:10496
    v_smfmac_f32_16x16x64_bf16 v[132:135], a[224:227], v[204:211], v37
    v_smfmac_f32_16x16x64_bf16 v[136:139], a[192:195], v[196:203], v33 abid:1
    v_smfmac_f32_16x16x64_bf16 v[136:139], a[228:231], v[204:211], v37 abid:1
    v_smfmac_f32_16x16x64_bf16 v[124:127], a[180:183], v[196:203], v32
    v_smfmac_f32_16x16x64_bf16 v[124:127], a[216:219], v[204:211], v36
    s_waitcnt vmcnt(7)
    s_waitcnt lgkmcnt(6)
    v_xad_u32 v236, v236, v3, v4
    v_smfmac_f32_16x16x64_bf16 v[124:127], v[240:243], v[244:251], v10
    v_xad_u32 v237, v237, v3, v4
    v_smfmac_f32_16x16x64_bf16 v[160:163], v[240:243], v[244:251], v10 abid:1
    ds_read2st64_b32 v[244:245], v236 offset0:0 offset1:72
    ds_read_b128 v[240:243], v8 offset:8192
    v_xad_u32 v238, v238, v3, v4
    v_smfmac_f32_16x16x64_bf16 v[144:147], a[200:203], v[196:203], v34 abid:1
    ds_read2st64_b32 v[246:247], v237 offset0:0 offset1:72
    v_xad_u32 v239, v239, v3, v4
    v_smfmac_f32_16x16x64_bf16 v[144:147], a[236:239], v[204:211], v38 abid:1
    ds_read2st64_b32 v[248:249], v238 offset0:0 offset1:72
    v_mul_u32_u24 v0, s94, v0
    v_smfmac_f32_16x16x64_bf16 v[148:151], a[204:207], v[196:203], v35
    ds_read2st64_b32 v[250:251], v239 offset0:0 offset1:72
    ds_read_b128 v[236:239], v9 offset:9664
    v_add_u32 v0, s93, v0
    v_smfmac_f32_16x16x64_bf16 v[148:151], a[240:243], v[204:211], v39
    s_waitcnt lgkmcnt(6)
    s_cmp_lt_i32 s81, 0
    s_cbranch_scc1 M_ovrL
    s_swappc_b64 s[78:79], s[72:73]
M_ovrL:
    v_smfmac_f32_16x16x64_bf16 v[152:155], a[208:211], v[196:203], v35 abid:1
    s_add_u32 m0, m0, 896
    v_min_u32 v0, 75497472, v0
    v_smfmac_f32_16x16x64_bf16 v[152:155], a[244:247], v[204:211], v39 abid:1
    ds_write_b32 v11, v0
    s_waitcnt vmcnt(7)
    v_mov_b32 v0, 162048
    v_smfmac_f32_16x16x64_bf16 v[156:159], a[212:215], v[196:203], v50 abid:1
    buffer_load_dwordx4 v5, s[8:11], s22 offen offset:896 nt lds
    v_smfmac_f32_16x16x64_bf16 v[156:159], a[248:251], v[204:211], v51
    ds_read_b128 v[196:199], v1 offset:18432
    v_smfmac_f32_16x16x64_bf16 v[124:127], a[252:255], v[220:227], v40
    ds_read_b128 v[200:203], v2 offset:18432
    v_smfmac_f32_16x16x64_bf16 v[124:127], v[88:91], v[228:235], v44
    ds_read_b128 v[204:207], v1 offset:19456
    v_smfmac_f32_16x16x64_bf16 v[156:159], v[84:87], v[220:227], v51 abid:1
    ds_read_b128 v[208:211], v2 offset:19456
    v_smfmac_f32_16x16x64_bf16 v[156:159], v[120:123], v[228:235], v52
    s_waitcnt lgkmcnt(4)
    s_barrier
    v_xad_u32 v236, v236, v3, v4
    v_smfmac_f32_16x16x64_bf16 v[156:159], v[240:243], v[244:251], v10
    ds_read_b32 v0, v0
    v_xad_u32 v237, v237, v3, v4
    v_smfmac_f32_16x16x64_bf16 v[192:195], v[240:243], v[244:251], v10 abid:1
    ds_read2st64_b32 v[244:245], v236 offset0:0 offset1:72
    ds_read_b128 v[240:243], v8 offset:7168
    v_xad_u32 v238, v238, v3, v4
    v_smfmac_f32_16x16x64_bf16 v[132:135], v[60:63], v[220:227], v41
    ds_read2st64_b32 v[246:247], v237 offset0:0 offset1:72
    v_xad_u32 v239, v239, v3, v4
    v_smfmac_f32_16x16x64_bf16 v[132:135], v[96:99], v[228:235], v45
    ds_read2st64_b32 v[248:249], v238 offset0:0 offset1:72
    s_add_u32 m0, m0, 896
    v_smfmac_f32_16x16x64_bf16 v[136:139], v[64:67], v[220:227], v41 abid:1
    ds_read2st64_b32 v[250:251], v239 offset0:0 offset1:72
    ds_read_b128 v[236:239], v9 offset:9536
    s_waitcnt vmcnt(6)
    v_smfmac_f32_16x16x64_bf16 v[136:139], v[100:103], v[228:235], v45 abid:1
    buffer_load_dwordx4 v5, s[8:11], s22 offen offset:1024 nt lds
    s_waitcnt lgkmcnt(6)
    v_readfirstlane_b32 s88, v0
    v_smfmac_f32_16x16x64_bf16 v[140:143], v[68:71], v[220:227], v42
    s_cmp_lt_u32 s88, s99
    s_cselect_b32 s10, 75497472, 0
    v_smfmac_f32_16x16x64_bf16 v[140:143], v[104:107], v[228:235], v46
    v_smfmac_f32_16x16x64_bf16 v[144:147], v[72:75], v[220:227], v42 abid:1
    ds_read_b128 v[212:215], v1 offset:20480
    v_smfmac_f32_16x16x64_bf16 v[144:147], v[108:111], v[228:235], v46 abid:1
    ds_read_b128 v[216:219], v2 offset:20480
    v_smfmac_f32_16x16x64_bf16 v[148:151], v[76:79], v[220:227], v43
    v_smfmac_f32_16x16x64_bf16 v[148:151], v[112:115], v[228:235], v47
    v_smfmac_f32_16x16x64_bf16 v[152:155], v[80:83], v[220:227], v43 abid:1
    v_smfmac_f32_16x16x64_bf16 v[152:155], v[116:119], v[228:235], v47 abid:1
    s_waitcnt lgkmcnt(2)
    v_xad_u32 v236, v236, v3, v4
    v_smfmac_f32_16x16x64_bf16 v[152:155], v[240:243], v[244:251], v10
    v_xad_u32 v237, v237, v3, v4
    v_smfmac_f32_16x16x64_bf16 v[188:191], v[240:243], v[244:251], v10 abid:1
    s_cmp_gt_u32 s46, s80
    s_cbranch_scc1 M_slow
M_slowrL:
    v_xad_u32 v238, v238, v3, v4
    v_smfmac_f32_16x16x64_bf16 v[128:131], v[56:59], v[220:227], v40 abid:1
    ds_read2st64_b32 v[244:245], v236 offset0:0 offset1:72
    ds_read_b128 v[240:243], v8 offset:5120
    v_xad_u32 v239, v239, v3, v4
    v_smfmac_f32_16x16x64_bf16 v[128:131], v[92:95], v[228:235], v44 abid:1
    ds_read2st64_b32 v[246:247], v237 offset0:0 offset1:72
    ds_read_b128 v[220:223], v1 offset:21504
    v_smfmac_f32_16x16x64_bf16 v[160:163], a[0:3], v[196:203], v12
    ds_read2st64_b32 v[248:249], v238 offset0:0 offset1:72
    ds_read_b128 v[224:227], v2 offset:21504
    v_smfmac_f32_16x16x64_bf16 v[160:163], a[36:39], v[204:211], v16
    ds_read2st64_b32 v[250:251], v239 offset0:0 offset1:72
    ds_read_b128 v[236:239], v9 offset:9600
    s_waitcnt lgkmcnt(8)
    v_smfmac_f32_16x16x64_bf16 v[160:163], a[72:75], v[212:219], v20
    ds_read_b128 v[228:231], v1 offset:22528
    v_smfmac_f32_16x16x64_bf16 v[164:167], a[4:7], v[196:203], v12 abid:1
    ds_read_b128 v[232:235], v2 offset:22528
    v_cvt_pk_bf16_f32 v156, v156, v157
    v_smfmac_f32_16x16x64_bf16 v[164:167], a[40:43], v[204:211], v16 abid:1
    s_mov_b32 m0, s28
    v_cvt_pk_bf16_f32 v157, v158, v159
    v_smfmac_f32_16x16x64_bf16 v[164:167], a[76:79], v[212:219], v20 abid:1
    ds_write_b64 v53, v[156:157] offset:25728
    ds_read_b128 v[156:159], v9 offset:10752
    s_waitcnt vmcnt(7)
    v_smfmac_f32_16x16x64_bf16 v[180:183], a[20:23], v[196:203], v14 abid:1
    buffer_load_dwordx4 v5, s[8:11], s88 offen offset:0 nt lds
    v_smfmac_f32_16x16x64_bf16 v[180:183], a[56:59], v[204:211], v18 abid:1
    v_cvt_pk_bf16_f32 v124, v124, v125
    v_smfmac_f32_16x16x64_bf16 v[180:183], a[92:95], v[212:219], v22 abid:1
    s_waitcnt lgkmcnt(4)
    v_xad_u32 v236, v236, v3, v4
    v_smfmac_f32_16x16x64_bf16 v[180:183], v[240:243], v[244:251], v10 abid:1
    v_xad_u32 v237, v237, v3, v4
    v_smfmac_f32_16x16x64_bf16 v[144:147], v[240:243], v[244:251], v10
    ds_read2st64_b32 v[244:245], v236 offset0:0 offset1:72
    ds_read_b128 v[240:243], v8 offset:6144
    v_xad_u32 v238, v238, v3, v4
    v_smfmac_f32_16x16x64_bf16 v[172:175], a[12:15], v[196:203], v13 abid:1
    ds_read2st64_b32 v[246:247], v237 offset0:0 offset1:72
    v_xad_u32 v239, v239, v3, v4
    v_smfmac_f32_16x16x64_bf16 v[172:175], a[48:51], v[204:211], v17 abid:1
    ds_read2st64_b32 v[248:249], v238 offset0:0 offset1:72
    v_cvt_pk_bf16_f32 v125, v126, v127
    v_smfmac_f32_16x16x64_bf16 v[172:175], a[84:87], v[212:219], v21 abid:1
    ds_read2st64_b32 v[250:251], v239 offset0:0 offset1:72
    ds_read_b128 v[236:239], v9 offset:9472
    v_cvt_pk_bf16_f32 v126, v128, v129
    v_smfmac_f32_16x16x64_bf16 v[176:179], a[16:19], v[196:203], v14
    v_cvt_pk_bf16_f32 v127, v130, v131
    v_smfmac_f32_16x16x64_bf16 v[176:179], a[52:55], v[204:211], v18
    v_cvt_pk_bf16_f32 v132, v132, v133
    v_smfmac_f32_16x16x64_bf16 v[176:179], a[88:91], v[212:219], v22
    v_cvt_pk_bf16_f32 v133, v134, v135
    v_smfmac_f32_16x16x64_bf16 v[168:171], a[8:11], v[196:203], v13
    s_add_u32 m0, m0, 896
    v_cvt_pk_bf16_f32 v134, v136, v137
    v_smfmac_f32_16x16x64_bf16 v[168:171], a[44:47], v[204:211], v17
    s_waitcnt vmcnt(6)
    buffer_load_dwordx4 v5, s[8:11], s88 offen offset:128 nt lds
    v_cvt_pk_bf16_f32 v135, v138, v139
    v_smfmac_f32_16x16x64_bf16 v[168:171], a[80:83], v[212:219], v21
    ds_read_b128 v[136:139], v9 offset:10432
    v_cndmask_b32_dpp v128, v124, v132, vcc row_ror:8 row_mask:0xf bank_mask:0xf
    v_smfmac_f32_16x16x64_bf16 v[184:187], a[24:27], v[196:203], v15
    v_cndmask_b32_dpp v129, v125, v133, vcc row_ror:8 row_mask:0xf bank_mask:0xf
    v_smfmac_f32_16x16x64_bf16 v[184:187], a[60:63], v[204:211], v19
    v_cndmask_b32_dpp v130, v126, v134, vcc row_ror:8 row_mask:0xf bank_mask:0xf
    v_smfmac_f32_16x16x64_bf16 v[184:187], a[96:99], v[212:219], v23
    s_waitcnt lgkmcnt(1)
    v_xad_u32 v236, v236, v3, v4
    v_smfmac_f32_16x16x64_bf16 v[184:187], v[240:243], v[244:251], v10 abid:1
    v_xad_u32 v237, v237, v3, v4
    v_smfmac_f32_16x16x64_bf16 v[148:151], v[240:243], v[244:251], v10
    ds_read2st64_b32 v[244:245], v236 offset0:0 offset1:72
    ds_read_b128 v[240:243], v8 offset:4096
    v_xad_u32 v238, v238, v3, v4
    v_smfmac_f32_16x16x64_bf16 v[188:191], a[28:31], v[196:203], v15 abid:1
    ds_read2st64_b32 v[246:247], v237 offset0:0 offset1:72
    v_xad_u32 v239, v239, v3, v4
    v_smfmac_f32_16x16x64_bf16 v[188:191], a[64:67], v[204:211], v19 abid:1
    ds_read2st64_b32 v[248:249], v238 offset0:0 offset1:72
    v_cndmask_b32_dpp v131, v127, v135, vcc row_ror:8 row_mask:0xf bank_mask:0xf
    v_smfmac_f32_16x16x64_bf16 v[188:191], a[100:103], v[212:219], v23 abid:1
    ds_read2st64_b32 v[250:251], v239 offset0:0 offset1:72
    s_waitcnt vmcnt(7)
    buffer_store_dwordx4 v[128:131], v6, s[12:15], s59 offen offset:0 sc1
    v_smfmac_f32_16x16x64_bf16 v[192:195], a[32:35], v[196:203], v48
    v_mov_b32_dpp v124, v132 row_ror:8 row_mask:0xf bank_mask:0xc
    v_smfmac_f32_16x16x64_bf16 v[192:195], a[68:71], v[204:211], v48 abid:1
    v_mov_b32_dpp v125, v133 row_ror:8 row_mask:0xf bank_mask:0xc
    v_smfmac_f32_16x16x64_bf16 v[192:195], a[104:107], v[212:219], v49
    ds_read_b128 v[196:199], v1 offset:23552
    v_mov_b32_dpp v126, v134 row_ror:8 row_mask:0xf bank_mask:0xc
    v_smfmac_f32_16x16x64_bf16 v[160:163], a[108:111], v[220:227], v24
    ds_read_b128 v[200:203], v2 offset:23552
    v_mov_b32_dpp v127, v135 row_ror:8 row_mask:0xf bank_mask:0xc
    v_smfmac_f32_16x16x64_bf16 v[160:163], a[144:147], v[228:235], v28
    ds_read_b128 v[204:207], v1 offset:24576
    s_waitcnt vmcnt(6)
    buffer_store_dwordx4 v[124:127], v6, s[12:15], s24 offen offset:0 sc1
    v_smfmac_f32_16x16x64_bf16 v[164:167], a[112:115], v[220:227], v24 abid:1
    ds_read_b128 v[208:211], v2 offset:24576
    ds_read_b128 v[128:131], v9 offset:10304
    ds_read_b128 v[132:135], v9 offset:10368
    v_smfmac_f32_16x16x64_bf16 v[164:167], a[148:151], v[228:235], v28 abid:1
    ds_read_b128 v[124:127], v9 offset:10240
    v_smfmac_f32_16x16x64_bf16 v[176:179], a[124:127], v[220:227], v26
    v_smfmac_f32_16x16x64_bf16 v[176:179], a[160:163], v[228:235], v30
    s_waitcnt lgkmcnt(7)
    v_smfmac_f32_16x16x64_bf16 v[176:179], v[240:243], v[244:251], v10 abid:1
    v_smfmac_f32_16x16x64_bf16 v[140:143], v[240:243], v[244:251], v10
    v_smfmac_f32_16x16x64_bf16 v[172:175], a[120:123], v[220:227], v25 abid:1
    s_add_u32 s28, s28, 36864
    s_cmp_ge_u32 s28, 110592
    s_cselect_b32 s28, s26, s28
    v_smfmac_f32_16x16x64_bf16 v[172:175], a[156:159], v[228:235], v29 abid:1
    s_add_u32 s30, s25, 36864
    s_cmp_eq_u32 s30, 110592
    s_cselect_b32 s30, 0, s30
    v_smfmac_f32_16x16x64_bf16 v[168:171], a[116:119], v[220:227], v25
    s_sub_u32 s31, s30, s25
    s_mov_b32 s25, s30
    s_mov_b32 s90, s22
    v_smfmac_f32_16x16x64_bf16 v[168:171], a[152:155], v[228:235], v29
    s_mov_b32 s22, s88
    s_add_u32 s91, s91, 1
    s_cmp_lt_u32 s20, 2
    v_smfmac_f32_16x16x64_bf16 v[180:183], a[128:131], v[220:227], v26 abid:1
    s_cselect_b32 s66, s23, s24
    s_add_u32 s66, s66, s95
    v_smfmac_f32_16x16x64_bf16 v[180:183], a[164:167], v[228:235], v30 abid:1
    v_cvt_pk_bf16_f32 v140, v140, v141
    v_smfmac_f32_16x16x64_bf16 v[184:187], a[132:135], v[220:227], v27
    s_add_u32 m0, m0, 896
    v_cvt_pk_bf16_f32 v141, v142, v143
    v_smfmac_f32_16x16x64_bf16 v[184:187], a[168:171], v[228:235], v31
    s_waitcnt vmcnt(7)
    buffer_load_dwordx4 v5, s[8:11], s88 offen offset:256 nt lds
    v_cvt_pk_bf16_f32 v142, v144, v145
    v_smfmac_f32_16x16x64_bf16 v[188:191], a[136:139], v[220:227], v27 abid:1
    v_cvt_pk_bf16_f32 v143, v146, v147
    v_smfmac_f32_16x16x64_bf16 v[188:191], a[172:175], v[228:235], v31 abid:1
    v_cvt_pk_bf16_f32 v148, v148, v149
    v_smfmac_f32_16x16x64_bf16 v[192:195], a[140:143], v[220:227], v49 abid:1
    v_cvt_pk_bf16_f32 v149, v150, v151
    v_smfmac_f32_16x16x64_bf16 v[192:195], a[176:179], v[228:235], v50
    ds_read_b128 v[220:223], v1 offset:25600
    s_waitcnt lgkmcnt(6)
    v_cvt_pk_bf16_f32 v150, v152, v153
    v_smfmac_f32_16x16x64_bf16 v[160:163], a[180:183], v[196:203], v32
    ds_read_b128 v[224:227], v2 offset:25600
    s_waitcnt lgkmcnt(5)
    v_cvt_pk_bf16_f32 v151, v154, v155
    v_smfmac_f32_16x16x64_bf16 v[160:163], a[216:219], v[204:211], v36
    ds_read_b128 v[228:231], v1 offset:26624
    ds_read_b128 v[152:155], v9 offset:10688
    v_cndmask_b32_dpp v144, v140, v148, vcc row_ror:8 row_mask:0xf bank_mask:0xf
    v_smfmac_f32_16x16x64_bf16 v[164:167], a[184:187], v[196:203], v32 abid:1
    ds_read_b128 v[232:235], v2 offset:26624
    v_cndmask_b32_dpp v145, v141, v149, vcc row_ror:8 row_mask:0xf bank_mask:0xf
    v_smfmac_f32_16x16x64_bf16 v[164:167], a[220:223], v[204:211], v36 abid:1
    s_add_u32 m0, m0, 896
    v_cndmask_b32_dpp v146, v142, v150, vcc row_ror:8 row_mask:0xf bank_mask:0xf
    v_smfmac_f32_16x16x64_bf16 v[168:171], a[188:191], v[196:203], v33
    s_waitcnt vmcnt(6)
    buffer_load_dwordx4 v5, s[8:11], s88 offen offset:384 nt lds
    v_cndmask_b32_dpp v147, v143, v151, vcc row_ror:8 row_mask:0xf bank_mask:0xf
    v_smfmac_f32_16x16x64_bf16 v[168:171], a[224:227], v[204:211], v37
    s_waitcnt vmcnt(7)
    buffer_store_dwordx4 v[144:147], v6, s[12:15], s59 offen offset:128 sc1
    v_mov_b32_dpp v140, v148 row_ror:8 row_mask:0xf bank_mask:0xc
    v_smfmac_f32_16x16x64_bf16 v[172:175], a[192:195], v[196:203], v33 abid:1
    v_mov_b32_dpp v141, v149 row_ror:8 row_mask:0xf bank_mask:0xc
    v_smfmac_f32_16x16x64_bf16 v[172:175], a[228:231], v[204:211], v37 abid:1
    v_mov_b32_dpp v142, v150 row_ror:8 row_mask:0xf bank_mask:0xc
    v_smfmac_f32_16x16x64_bf16 v[176:179], a[196:199], v[196:203], v34
    v_mov_b32_dpp v143, v151 row_ror:8 row_mask:0xf bank_mask:0xc
    v_smfmac_f32_16x16x64_bf16 v[176:179], a[232:235], v[204:211], v38
    s_waitcnt vmcnt(6)
    buffer_store_dwordx4 v[140:143], v6, s[12:15], s24 offen offset:128 sc1
    ds_read_b128 v[144:147], v9 offset:10560
    v_smfmac_f32_16x16x64_bf16 v[180:183], a[200:203], v[196:203], v34 abid:1
    ds_read_b128 v[148:151], v9 offset:10624
    ds_read_b128 v[140:143], v9 offset:10496
    v_add_u32 v4, s31, v4
    v_smfmac_f32_16x16x64_bf16 v[180:183], a[236:239], v[204:211], v38 abid:1
    v_add_u32 v1, s31, v1
    v_smfmac_f32_16x16x64_bf16 v[184:187], a[204:207], v[196:203], v35
    v_add_u32 v2, s31, v2
    v_smfmac_f32_16x16x64_bf16 v[184:187], a[240:243], v[204:211], v39
    v_smfmac_f32_16x16x64_bf16 v[188:191], a[208:211], v[196:203], v35 abid:1
    v_smfmac_f32_16x16x64_bf16 v[188:191], a[244:247], v[204:211], v39 abid:1
    v_smfmac_f32_16x16x64_bf16 v[192:195], a[212:215], v[196:203], v50 abid:1
    v_smfmac_f32_16x16x64_bf16 v[192:195], a[248:251], v[204:211], v51
    s_waitcnt vmcnt(8)
    s_branch M_top1
M_bE0:
    v_smfmac_f32_16x16x64_bf16 v[164:167], v[56:59], v[220:227], v40 abid:1
    ds_read_b128 v[204:207], v1 offset:1024
    v_smfmac_f32_16x16x64_bf16 v[164:167], v[92:95], v[228:235], v44 abid:1
    ds_read_b128 v[208:211], v2 offset:1024
    v_mov_b32 v0, 1
    v_smfmac_f32_16x16x64_bf16 v[168:171], v[60:63], v[220:227], v41
    ds_read_b128 v[212:215], v1 offset:2048
    v_smfmac_f32_16x16x64_bf16 v[168:171], v[96:99], v[228:235], v45
    ds_read_b128 v[216:219], v2 offset:2048
    v_smfmac_f32_16x16x64_bf16 v[172:175], v[64:67], v[220:227], v41 abid:1
    s_waitcnt vmcnt(5)
    s_waitcnt lgkmcnt(6)
    buffer_store_dwordx4 v[244:247], v7, s[12:15], s66 offen sc1
    v_smfmac_f32_16x16x64_bf16 v[172:175], v[100:103], v[228:235], v45 abid:1
    ds_read_b128 v[236:239], v9 offset:9408
    v_smfmac_f32_16x16x64_bf16 v[176:179], v[68:71], v[220:227], v42
    s_waitcnt vmcnt(6)
    buffer_atomic_add v0, v11, s[16:19], s92 offen sc0 sc1
    s_mov_b32 s21, 2
    v_smfmac_f32_16x16x64_bf16 v[176:179], v[104:107], v[228:235], v46
    v_smfmac_f32_16x16x64_bf16 v[180:183], v[72:75], v[220:227], v42 abid:1
    v_cvt_pk_bf16_f32 v160, v160, v161
    v_smfmac_f32_16x16x64_bf16 v[180:183], v[108:111], v[228:235], v46 abid:1
    v_cvt_pk_bf16_f32 v161, v162, v163
    v_smfmac_f32_16x16x64_bf16 v[184:187], v[76:79], v[220:227], v43
    v_cvt_pk_bf16_f32 v162, v164, v165
    v_smfmac_f32_16x16x64_bf16 v[184:187], v[112:115], v[228:235], v47
    v_cvt_pk_bf16_f32 v163, v166, v167
    v_smfmac_f32_16x16x64_bf16 v[188:191], v[80:83], v[220:227], v43 abid:1
    s_add_u32 m0, m0, 896
    v_cvt_pk_bf16_f32 v168, v168, v169
    v_smfmac_f32_16x16x64_bf16 v[188:191], v[116:119], v[228:235], v47 abid:1
    s_waitcnt vmcnt(5)
    buffer_load_dwordx4 v5, s[8:11], s22 offen offset:512 nt lds
    v_cvt_pk_bf16_f32 v169, v170, v171
    v_smfmac_f32_16x16x64_bf16 v[192:195], v[84:87], v[220:227], v51 abid:1
    v_cvt_pk_bf16_f32 v170, v172, v173
    v_smfmac_f32_16x16x64_bf16 v[192:195], v[120:123], v[228:235], v52
    ds_read_b128 v[220:223], v1 offset:3072
    s_waitcnt lgkmcnt(6)
    v_cvt_pk_bf16_f32 v171, v174, v175
    v_smfmac_f32_16x16x64_bf16 v[124:127], a[0:3], v[196:203], v12
    ds_read_b128 v[224:227], v2 offset:3072
    ds_read_b128 v[172:175], v9 offset:10432
    s_waitcnt lgkmcnt(6)
    v_cndmask_b32_dpp v164, v160, v168, vcc row_ror:8 row_mask:0xf bank_mask:0xf
    v_smfmac_f32_16x16x64_bf16 v[124:127], a[36:39], v[204:211], v16
    ds_read_b128 v[228:231], v1 offset:4096
    s_waitcnt lgkmcnt(5)
    v_cndmask_b32_dpp v165, v161, v169, vcc row_ror:8 row_mask:0xf bank_mask:0xf
    v_smfmac_f32_16x16x64_bf16 v[124:127], a[72:75], v[212:219], v20
    ds_read_b128 v[232:235], v2 offset:4096
    v_cndmask_b32_dpp v166, v162, v170, vcc row_ror:8 row_mask:0xf bank_mask:0xf
    v_smfmac_f32_16x16x64_bf16 v[128:131], a[4:7], v[196:203], v12 abid:1
    s_barrier
    v_cndmask_b32_dpp v167, v163, v171, vcc row_ror:8 row_mask:0xf bank_mask:0xf
    v_smfmac_f32_16x16x64_bf16 v[128:131], a[40:43], v[204:211], v16 abid:1
    s_waitcnt vmcnt(6)
    buffer_store_dwordx4 v[164:167], v6, s[12:15], s58 offen offset:0 sc1
    s_waitcnt lgkmcnt(5)
    v_xad_u32 v236, v236, v3, v4
    v_smfmac_f32_16x16x64_bf16 v[128:131], a[76:79], v[212:219], v20 abid:1
    v_xad_u32 v237, v237, v3, v4
    v_smfmac_f32_16x16x64_bf16 v[132:135], a[8:11], v[196:203], v13
    ds_read2st64_b32 v[244:245], v236 offset0:0 offset1:72
    ds_read_b128 v[240:243], v8 offset:3072
    v_xad_u32 v238, v238, v3, v4
    v_smfmac_f32_16x16x64_bf16 v[132:135], a[44:47], v[204:211], v17
    ds_read2st64_b32 v[246:247], v237 offset0:0 offset1:72
    v_xad_u32 v239, v239, v3, v4
    v_smfmac_f32_16x16x64_bf16 v[132:135], a[80:83], v[212:219], v21
    ds_read2st64_b32 v[248:249], v238 offset0:0 offset1:72
    v_mov_b32_dpp v160, v168 row_ror:8 row_mask:0xf bank_mask:0xc
    v_smfmac_f32_16x16x64_bf16 v[144:147], a[20:23], v[196:203], v14 abid:1
    ds_read2st64_b32 v[250:251], v239 offset0:0 offset1:72
    ds_read_b128 v[236:239], v9 offset:9280
    v_mov_b32_dpp v161, v169 row_ror:8 row_mask:0xf bank_mask:0xc
    v_smfmac_f32_16x16x64_bf16 v[144:147], a[56:59], v[204:211], v18 abid:1
    v_mov_b32_dpp v162, v170 row_ror:8 row_mask:0xf bank_mask:0xc
    v_smfmac_f32_16x16x64_bf16 v[144:147], a[92:95], v[212:219], v22 abid:1
    v_mov_b32_dpp v163, v171 row_ror:8 row_mask:0xf bank_mask:0xc
    v_smfmac_f32_16x16x64_bf16 v[140:143], a[16:19], v[196:203], v14
    s_waitcnt vmcnt(5)
    buffer_store_dwordx4 v[160:163], v6, s[12:15], s23 offen offset:0 sc1
    ds_read_b128 v[164:167], v9 offset:10304
    v_smfmac_f32_16x16x64_bf16 v[140:143], a[52:55], v[204:211], v18
    ds_read_b128 v[168:171], v9 offset:10368
    ds_read_b128 v[160:163], v9 offset:10240
    v_smfmac_f32_16x16x64_bf16 v[140:143], a[88:91], v[212:219], v22
    v_smfmac_f32_16x16x64_bf16 v[136:139], a[12:15], v[196:203], v13 abid:1
    v_smfmac_f32_16x16x64_bf16 v[136:139], a[48:51], v[204:211], v17 abid:1
    v_smfmac_f32_16x16x64_bf16 v[136:139], a[84:87], v[212:219], v21 abid:1
    s_waitcnt lgkmcnt(3)
    v_xad_u32 v236, v236, v3, v4
    v_smfmac_f32_16x16x64_bf16 v[136:139], v[240:243], v[244:251], v10
    v_xad_u32 v237, v237, v3, v4
    v_smfmac_f32_16x16x64_bf16 v[172:175], v[240:243], v[244:251], v10 abid:1
    ds_read2st64_b32 v[244:245], v236 offset0:0 offset1:72
    ds_read_b128 v[240:243], v8 offset:1024
    v_xad_u32 v238, v238, v3, v4
    v_smfmac_f32_16x16x64_bf16 v[148:151], a[24:27], v[196:203], v15
    ds_read2st64_b32 v[246:247], v237 offset0:0 offset1:72
    v_xad_u32 v239, v239, v3, v4
    v_smfmac_f32_16x16x64_bf16 v[148:151], a[60:63], v[204:211], v19
    ds_read2st64_b32 v[248:249], v238 offset0:0 offset1:72
    v_cvt_pk_bf16_f32 v192, v192, v193
    v_smfmac_f32_16x16x64_bf16 v[148:151], a[96:99], v[212:219], v23
    ds_read2st64_b32 v[250:251], v239 offset0:0 offset1:72
    ds_read_b128 v[236:239], v9 offset:9344
    v_cvt_pk_bf16_f32 v193, v194, v195
    v_smfmac_f32_16x16x64_bf16 v[152:155], a[28:31], v[196:203], v15 abid:1
    ds_write_b64 v53, v[192:193] offset:0
    ds_read_b128 v[192:195], v9 offset:10752
    v_smfmac_f32_16x16x64_bf16 v[152:155], a[64:67], v[204:211], v19 abid:1
    s_add_u32 m0, m0, 896
    v_smfmac_f32_16x16x64_bf16 v[152:155], a[100:103], v[212:219], v23 abid:1
    s_waitcnt vmcnt(6)
    buffer_load_dwordx4 v5, s[8:11], s22 offen offset:640 nt lds
    v_smfmac_f32_16x16x64_bf16 v[156:159], a[32:35], v[196:203], v48
    v_smfmac_f32_16x16x64_bf16 v[156:159], a[68:71], v[204:211], v48 abid:1
    v_smfmac_f32_16x16x64_bf16 v[156:159], a[104:107], v[212:219], v49
    ds_read_b128 v[196:199], v1 offset:5120
    v_cvt_pk_bf16_f32 v176, v176, v177
    v_smfmac_f32_16x16x64_bf16 v[124:127], a[108:111], v[220:227], v24
    ds_read_b128 v[200:203], v2 offset:5120
    v_cvt_pk_bf16_f32 v177, v178, v179
    v_smfmac_f32_16x16x64_bf16 v[124:127], a[144:147], v[228:235], v28
    ds_read_b128 v[204:207], v1 offset:6144
    ds_read_b64 v[216:217], v9 offset:10056
    v_cvt_pk_bf16_f32 v178, v180, v181
    v_smfmac_f32_16x16x64_bf16 v[128:131], a[112:115], v[220:227], v24 abid:1
    ds_read_b128 v[208:211], v2 offset:6144
    v_cvt_pk_bf16_f32 v179, v182, v183
    v_smfmac_f32_16x16x64_bf16 v[128:131], a[148:151], v[228:235], v28 abid:1
    s_waitcnt lgkmcnt(7)
    v_xad_u32 v236, v236, v3, v4
    v_smfmac_f32_16x16x64_bf16 v[128:131], v[240:243], v[244:251], v10
    s_add_u32 m0, m0, 896
    v_xad_u32 v237, v237, v3, v4
    v_smfmac_f32_16x16x64_bf16 v[164:167], v[240:243], v[244:251], v10 abid:1
    ds_read2st64_b32 v[244:245], v236 offset0:0 offset1:72
    ds_read_b128 v[240:243], v8 offset:2048
    v_xad_u32 v238, v238, v3, v4
    v_smfmac_f32_16x16x64_bf16 v[152:155], a[136:139], v[220:227], v27 abid:1
    ds_read2st64_b32 v[246:247], v237 offset0:0 offset1:72
    s_waitcnt vmcnt(5)
    v_xad_u32 v239, v239, v3, v4
    v_smfmac_f32_16x16x64_bf16 v[152:155], a[172:175], v[228:235], v31 abid:1
    ds_read2st64_b32 v[248:249], v238 offset0:0 offset1:72
    buffer_load_dwordx4 v5, s[8:11], s22 offen offset:768 nt lds
    v_cvt_pk_bf16_f32 v184, v184, v185
    v_smfmac_f32_16x16x64_bf16 v[136:139], a[120:123], v[220:227], v25 abid:1
    ds_read2st64_b32 v[250:251], v239 offset0:0 offset1:72
    ds_read_b128 v[236:239], v9 offset:9216
    v_cvt_pk_bf16_f32 v185, v186, v187
    v_smfmac_f32_16x16x64_bf16 v[136:139], a[156:159], v[228:235], v29 abid:1
    v_cvt_pk_bf16_f32 v186, v188, v189
    v_smfmac_f32_16x16x64_bf16 v[140:143], a[124:127], v[220:227], v26
    v_cvt_pk_bf16_f32 v187, v190, v191
    v_smfmac_f32_16x16x64_bf16 v[140:143], a[160:163], v[228:235], v30
    ds_read_b128 v[188:191], v9 offset:10688
    v_cndmask_b32_dpp v180, v176, v184, vcc row_ror:8 row_mask:0xf bank_mask:0xf
    v_smfmac_f32_16x16x64_bf16 v[144:147], a[128:131], v[220:227], v26 abid:1
    v_cndmask_b32_dpp v181, v177, v185, vcc row_ror:8 row_mask:0xf bank_mask:0xf
    v_smfmac_f32_16x16x64_bf16 v[144:147], a[164:167], v[228:235], v30 abid:1
    v_cndmask_b32_dpp v182, v178, v186, vcc row_ror:8 row_mask:0xf bank_mask:0xf
    v_smfmac_f32_16x16x64_bf16 v[148:151], a[132:135], v[220:227], v27
    v_cndmask_b32_dpp v183, v179, v187, vcc row_ror:8 row_mask:0xf bank_mask:0xf
    v_smfmac_f32_16x16x64_bf16 v[148:151], a[168:171], v[228:235], v31
    s_waitcnt vmcnt(6)
    buffer_store_dwordx4 v[180:183], v6, s[12:15], s58 offen offset:128 sc1
    s_waitcnt lgkmcnt(8)
    v_xad_u32 v212, v216, v3, v4
    v_smfmac_f32_16x16x64_bf16 v[132:135], a[116:119], v[220:227], v25
    ds_read2st64_b32 v[212:213], v212 offset0:0 offset1:72
    v_xad_u32 v214, v217, v3, v4
    v_smfmac_f32_16x16x64_bf16 v[132:135], a[152:155], v[228:235], v29
    ds_read2st64_b32 v[214:215], v214 offset0:0 offset1:72
    s_waitcnt lgkmcnt(3)
    v_xad_u32 v236, v236, v3, v4
    v_smfmac_f32_16x16x64_bf16 v[132:135], v[240:243], v[244:251], v10
    v_xad_u32 v237, v237, v3, v4
    v_smfmac_f32_16x16x64_bf16 v[168:171], v[240:243], v[244:251], v10 abid:1
    ds_read2st64_b32 v[244:245], v236 offset0:0 offset1:72
    ds_read_b128 v[240:243], v8 offset:0
    v_xad_u32 v238, v238, v3, v4
    v_smfmac_f32_16x16x64_bf16 v[156:159], a[140:143], v[220:227], v49 abid:1
    ds_read2st64_b32 v[246:247], v237 offset0:0 offset1:72
    v_xad_u32 v239, v239, v3, v4
    v_smfmac_f32_16x16x64_bf16 v[156:159], a[176:179], v[228:235], v50
    ds_read2st64_b32 v[248:249], v238 offset0:0 offset1:72
    ds_read_b128 v[220:223], v1 offset:7168
    v_mov_b32_dpp v176, v184 row_ror:8 row_mask:0xf bank_mask:0xc
    v_smfmac_f32_16x16x64_bf16 v[140:143], a[196:199], v[196:203], v34
    ds_read2st64_b32 v[250:251], v239 offset0:0 offset1:72
    ds_read_b128 v[236:239], v9 offset:9728
    v_mov_b32_dpp v177, v185 row_ror:8 row_mask:0xf bank_mask:0xc
    v_smfmac_f32_16x16x64_bf16 v[140:143], a[232:235], v[204:211], v38
    ds_read_b128 v[224:227], v2 offset:7168
    v_mov_b32_dpp v178, v186 row_ror:8 row_mask:0xf bank_mask:0xc
    v_smfmac_f32_16x16x64_bf16 v[128:131], a[184:187], v[196:203], v32 abid:1
    ds_read_b128 v[228:231], v1 offset:8192
    v_mov_b32_dpp v179, v187 row_ror:8 row_mask:0xf bank_mask:0xc
    v_smfmac_f32_16x16x64_bf16 v[128:131], a[220:223], v[204:211], v36 abid:1
    ds_read_b128 v[232:235], v2 offset:8192
    s_waitcnt vmcnt(5)
    buffer_store_dwordx4 v[176:179], v6, s[12:15], s23 offen offset:128 sc1
    v_smfmac_f32_16x16x64_bf16 v[132:135], a[188:191], v[196:203], v33
    ds_read_b128 v[180:183], v9 offset:10560
    ds_read_b128 v[184:187], v9 offset:10624
    ds_read_b128 v[176:179], v9 offset:10496
    v_smfmac_f32_16x16x64_bf16 v[132:135], a[224:227], v[204:211], v37
    v_smfmac_f32_16x16x64_bf16 v[136:139], a[192:195], v[196:203], v33 abid:1
    v_smfmac_f32_16x16x64_bf16 v[136:139], a[228:231], v[204:211], v37 abid:1
    v_smfmac_f32_16x16x64_bf16 v[124:127], a[180:183], v[196:203], v32
    v_smfmac_f32_16x16x64_bf16 v[124:127], a[216:219], v[204:211], v36
    s_waitcnt vmcnt(7)
    s_waitcnt lgkmcnt(6)
    v_xad_u32 v236, v236, v3, v4
    v_smfmac_f32_16x16x64_bf16 v[124:127], v[240:243], v[244:251], v10
    v_xad_u32 v237, v237, v3, v4
    v_smfmac_f32_16x16x64_bf16 v[160:163], v[240:243], v[244:251], v10 abid:1
    ds_read2st64_b32 v[244:245], v236 offset0:0 offset1:72
    ds_read_b128 v[240:243], v8 offset:8192
    v_xad_u32 v238, v238, v3, v4
    v_smfmac_f32_16x16x64_bf16 v[144:147], a[200:203], v[196:203], v34 abid:1
    ds_read2st64_b32 v[246:247], v237 offset0:0 offset1:72
    v_xad_u32 v239, v239, v3, v4
    v_smfmac_f32_16x16x64_bf16 v[144:147], a[236:239], v[204:211], v38 abid:1
    ds_read2st64_b32 v[248:249], v238 offset0:0 offset1:72
    v_mul_u32_u24 v0, s94, v0
    v_smfmac_f32_16x16x64_bf16 v[148:151], a[204:207], v[196:203], v35
    ds_read2st64_b32 v[250:251], v239 offset0:0 offset1:72
    ds_read_b128 v[236:239], v9 offset:9664
    v_add_u32 v0, s93, v0
    v_smfmac_f32_16x16x64_bf16 v[148:151], a[240:243], v[204:211], v39
    s_waitcnt lgkmcnt(6)
    s_cmp_lt_i32 s81, 0
    s_cbranch_scc1 M_ovrE0
    s_swappc_b64 s[78:79], s[72:73]
M_ovrE0:
    v_smfmac_f32_16x16x64_bf16 v[152:155], a[208:211], v[196:203], v35 abid:1
    s_add_u32 m0, m0, 896
    v_min_u32 v0, 75497472, v0
    v_smfmac_f32_16x16x64_bf16 v[152:155], a[244:247], v[204:211], v39 abid:1
    ds_write_b32 v11, v0
    s_waitcnt vmcnt(6)
    v_mov_b32 v0, 162048
    v_smfmac_f32_16x16x64_bf16 v[156:159], a[212:215], v[196:203], v50 abid:1
    buffer_load_dwordx4 v5, s[8:11], s22 offen offset:896 nt lds
    v_smfmac_f32_16x16x64_bf16 v[156:159], a[248:251], v[204:211], v51
    ds_read_b128 v[196:199], v1 offset:18432
    v_smfmac_f32_16x16x64_bf16 v[124:127], a[252:255], v[220:227], v40
    ds_read_b128 v[200:203], v2 offset:18432
    v_smfmac_f32_16x16x64_bf16 v[124:127], v[88:91], v[228:235], v44
    ds_read_b128 v[204:207], v1 offset:19456
    v_smfmac_f32_16x16x64_bf16 v[156:159], v[84:87], v[220:227], v51 abid:1
    ds_read_b128 v[208:211], v2 offset:19456
    v_smfmac_f32_16x16x64_bf16 v[156:159], v[120:123], v[228:235], v52
    s_waitcnt lgkmcnt(4)
    s_barrier
    v_xad_u32 v236, v236, v3, v4
    v_smfmac_f32_16x16x64_bf16 v[156:159], v[240:243], v[244:251], v10
    ds_read_b32 v0, v0
    v_xad_u32 v237, v237, v3, v4
    v_smfmac_f32_16x16x64_bf16 v[192:195], v[240:243], v[244:251], v10 abid:1
    ds_read2st64_b32 v[244:245], v236 offset0:0 offset1:72
    ds_read_b128 v[240:243], v8 offset:7168
    v_xad_u32 v238, v238, v3, v4
    v_smfmac_f32_16x16x64_bf16 v[132:135], v[60:63], v[220:227], v41
    ds_read2st64_b32 v[246:247], v237 offset0:0 offset1:72
    v_xad_u32 v239, v239, v3, v4
    v_smfmac_f32_16x16x64_bf16 v[132:135], v[96:99], v[228:235], v45
    ds_read2st64_b32 v[248:249], v238 offset0:0 offset1:72
    s_add_u32 m0, m0, 896
    v_smfmac_f32_16x16x64_bf16 v[136:139], v[64:67], v[220:227], v41 abid:1
    ds_read2st64_b32 v[250:251], v239 offset0:0 offset1:72
    ds_read_b128 v[236:239], v9 offset:9536
    s_waitcnt vmcnt(5)
    v_smfmac_f32_16x16x64_bf16 v[136:139], v[100:103], v[228:235], v45 abid:1
    buffer_load_dwordx4 v5, s[8:11], s22 offen offset:1024 nt lds
    s_waitcnt lgkmcnt(6)
    v_readfirstlane_b32 s88, v0
    v_smfmac_f32_16x16x64_bf16 v[140:143], v[68:71], v[220:227], v42
    s_cmp_lt_u32 s88, s99
    s_cselect_b32 s10, 75497472, 0
    v_smfmac_f32_16x16x64_bf16 v[140:143], v[104:107], v[228:235], v46
    v_smfmac_f32_16x16x64_bf16 v[144:147], v[72:75], v[220:227], v42 abid:1
    ds_read_b128 v[212:215], v1 offset:20480
    v_smfmac_f32_16x16x64_bf16 v[144:147], v[108:111], v[228:235], v46 abid:1
    ds_read_b128 v[216:219], v2 offset:20480
    v_smfmac_f32_16x16x64_bf16 v[148:151], v[76:79], v[220:227], v43
    v_smfmac_f32_16x16x64_bf16 v[148:151], v[112:115], v[228:235], v47
    v_smfmac_f32_16x16x64_bf16 v[152:155], v[80:83], v[220:227], v43 abid:1
    v_smfmac_f32_16x16x64_bf16 v[152:155], v[116:119], v[228:235], v47 abid:1
    s_waitcnt lgkmcnt(2)
    v_xad_u32 v236, v236, v3, v4
    v_smfmac_f32_16x16x64_bf16 v[152:155], v[240:243], v[244:251], v10
    v_xad_u32 v237, v237, v3, v4
    v_smfmac_f32_16x16x64_bf16 v[188:191], v[240:243], v[244:251], v10 abid:1
    s_cmp_gt_u32 s46, s80
    s_cbranch_scc1 M_slow
M_slowrE0:
    v_xad_u32 v238, v238, v3, v4
    v_smfmac_f32_16x16x64_bf16 v[128:131], v[56:59], v[220:227], v40 abid:1
    ds_read2st64_b32 v[244:245], v236 offset0:0 offset1:72
    ds_read_b128 v[240:243], v8 offset:5120
    v_xad_u32 v239, v239, v3, v4
    v_smfmac_f32_16x16x64_bf16 v[128:131], v[92:95], v[228:235], v44 abid:1
    ds_read2st64_b32 v[246:247], v237 offset0:0 offset1:72
    ds_read_b128 v[220:223], v1 offset:21504
    v_smfmac_f32_16x16x64_bf16 v[160:163], a[0:3], v[196:203], v12
    ds_read2st64_b32 v[248:249], v238 offset0:0 offset1:72
    ds_read_b128 v[224:227], v2 offset:21504
    v_smfmac_f32_16x16x64_bf16 v[160:163], a[36:39], v[204:211], v16
    ds_read2st64_b32 v[250:251], v239 offset0:0 offset1:72
    ds_read_b128 v[236:239], v9 offset:9600
    s_waitcnt lgkmcnt(8)
    v_smfmac_f32_16x16x64_bf16 v[160:163], a[72:75], v[212:219], v20
    ds_read_b128 v[228:231], v1 offset:22528
    v_smfmac_f32_16x16x64_bf16 v[164:167], a[4:7], v[196:203], v12 abid:1
    ds_read_b128 v[232:235], v2 offset:22528
    v_cvt_pk_bf16_f32 v156, v156, v157
    v_smfmac_f32_16x16x64_bf16 v[164:167], a[40:43], v[204:211], v16 abid:1
    s_mov_b32 m0, s28
    v_cvt_pk_bf16_f32 v157, v158, v159
    v_smfmac_f32_16x16x64_bf16 v[164:167], a[76:79], v[212:219], v20 abid:1
    ds_write_b64 v53, v[156:157] offset:25728
    ds_read_b128 v[156:159], v9 offset:10752
    s_waitcnt vmcnt(6)
    v_smfmac_f32_16x16x64_bf16 v[180:183], a[20:23], v[196:203], v14 abid:1
    buffer_load_dwordx4 v5, s[8:11], s88 offen offset:0 nt lds
    v_smfmac_f32_16x16x64_bf16 v[180:183], a[56:59], v[204:211], v18 abid:1
    v_cvt_pk_bf16_f32 v124, v124, v125
    v_smfmac_f32_16x16x64_bf16 v[180:183], a[92:95], v[212:219], v22 abid:1
    s_waitcnt lgkmcnt(4)
    v_xad_u32 v236, v236, v3, v4
    v_smfmac_f32_16x16x64_bf16 v[180:183], v[240:243], v[244:251], v10 abid:1
    v_xad_u32 v237, v237, v3, v4
    v_smfmac_f32_16x16x64_bf16 v[144:147], v[240:243], v[244:251], v10
    ds_read2st64_b32 v[244:245], v236 offset0:0 offset1:72
    ds_read_b128 v[240:243], v8 offset:6144
    v_xad_u32 v238, v238, v3, v4
    v_smfmac_f32_16x16x64_bf16 v[172:175], a[12:15], v[196:203], v13 abid:1
    ds_read2st64_b32 v[246:247], v237 offset0:0 offset1:72
    v_xad_u32 v239, v239, v3, v4
    v_smfmac_f32_16x16x64_bf16 v[172:175], a[48:51], v[204:211], v17 abid:1
    ds_read2st64_b32 v[248:249], v238 offset0:0 offset1:72
    v_cvt_pk_bf16_f32 v125, v126, v127
    v_smfmac_f32_16x16x64_bf16 v[172:175], a[84:87], v[212:219], v21 abid:1
    ds_read2st64_b32 v[250:251], v239 offset0:0 offset1:72
    ds_read_b128 v[236:239], v9 offset:9472
    v_cvt_pk_bf16_f32 v126, v128, v129
    v_smfmac_f32_16x16x64_bf16 v[176:179], a[16:19], v[196:203], v14
    v_cvt_pk_bf16_f32 v127, v130, v131
    v_smfmac_f32_16x16x64_bf16 v[176:179], a[52:55], v[204:211], v18
    v_cvt_pk_bf16_f32 v132, v132, v133
    v_smfmac_f32_16x16x64_bf16 v[176:179], a[88:91], v[212:219], v22
    v_cvt_pk_bf16_f32 v133, v134, v135
    v_smfmac_f32_16x16x64_bf16 v[168:171], a[8:11], v[196:203], v13
    s_add_u32 m0, m0, 896
    v_cvt_pk_bf16_f32 v134, v136, v137
    v_smfmac_f32_16x16x64_bf16 v[168:171], a[44:47], v[204:211], v17
    s_waitcnt vmcnt(5)
    buffer_load_dwordx4 v5, s[8:11], s88 offen offset:128 nt lds
    v_cvt_pk_bf16_f32 v135, v138, v139
    v_smfmac_f32_16x16x64_bf16 v[168:171], a[80:83], v[212:219], v21
    ds_read_b128 v[136:139], v9 offset:10432
    v_cndmask_b32_dpp v128, v124, v132, vcc row_ror:8 row_mask:0xf bank_mask:0xf
    v_smfmac_f32_16x16x64_bf16 v[184:187], a[24:27], v[196:203], v15
    v_cndmask_b32_dpp v129, v125, v133, vcc row_ror:8 row_mask:0xf bank_mask:0xf
    v_smfmac_f32_16x16x64_bf16 v[184:187], a[60:63], v[204:211], v19
    v_cndmask_b32_dpp v130, v126, v134, vcc row_ror:8 row_mask:0xf bank_mask:0xf
    v_smfmac_f32_16x16x64_bf16 v[184:187], a[96:99], v[212:219], v23
    s_waitcnt lgkmcnt(1)
    v_xad_u32 v236, v236, v3, v4
    v_smfmac_f32_16x16x64_bf16 v[184:187], v[240:243], v[244:251], v10 abid:1
    v_xad_u32 v237, v237, v3, v4
    v_smfmac_f32_16x16x64_bf16 v[148:151], v[240:243], v[244:251], v10
    ds_read2st64_b32 v[244:245], v236 offset0:0 offset1:72
    ds_read_b128 v[240:243], v8 offset:4096
    v_xad_u32 v238, v238, v3, v4
    v_smfmac_f32_16x16x64_bf16 v[188:191], a[28:31], v[196:203], v15 abid:1
    ds_read2st64_b32 v[246:247], v237 offset0:0 offset1:72
    v_xad_u32 v239, v239, v3, v4
    v_smfmac_f32_16x16x64_bf16 v[188:191], a[64:67], v[204:211], v19 abid:1
    ds_read2st64_b32 v[248:249], v238 offset0:0 offset1:72
    v_cndmask_b32_dpp v131, v127, v135, vcc row_ror:8 row_mask:0xf bank_mask:0xf
    v_smfmac_f32_16x16x64_bf16 v[188:191], a[100:103], v[212:219], v23 abid:1
    ds_read2st64_b32 v[250:251], v239 offset0:0 offset1:72
    s_waitcnt vmcnt(6)
    buffer_store_dwordx4 v[128:131], v6, s[12:15], s59 offen offset:0 sc1
    v_smfmac_f32_16x16x64_bf16 v[192:195], a[32:35], v[196:203], v48
    v_mov_b32_dpp v124, v132 row_ror:8 row_mask:0xf bank_mask:0xc
    v_smfmac_f32_16x16x64_bf16 v[192:195], a[68:71], v[204:211], v48 abid:1
    v_mov_b32_dpp v125, v133 row_ror:8 row_mask:0xf bank_mask:0xc
    v_smfmac_f32_16x16x64_bf16 v[192:195], a[104:107], v[212:219], v49
    ds_read_b128 v[196:199], v1 offset:23552
    v_mov_b32_dpp v126, v134 row_ror:8 row_mask:0xf bank_mask:0xc
    v_smfmac_f32_16x16x64_bf16 v[160:163], a[108:111], v[220:227], v24
    ds_read_b128 v[200:203], v2 offset:23552
    v_mov_b32_dpp v127, v135 row_ror:8 row_mask:0xf bank_mask:0xc
    v_smfmac_f32_16x16x64_bf16 v[160:163], a[144:147], v[228:235], v28
    ds_read_b128 v[204:207], v1 offset:24576
    s_waitcnt vmcnt(5)
    buffer_store_dwordx4 v[124:127], v6, s[12:15], s24 offen offset:0 sc1
    v_smfmac_f32_16x16x64_bf16 v[164:167], a[112:115], v[220:227], v24 abid:1
    ds_read_b128 v[208:211], v2 offset:24576
    ds_read_b128 v[128:131], v9 offset:10304
    ds_read_b128 v[132:135], v9 offset:10368
    v_smfmac_f32_16x16x64_bf16 v[164:167], a[148:151], v[228:235], v28 abid:1
    ds_read_b128 v[124:127], v9 offset:10240
    v_smfmac_f32_16x16x64_bf16 v[176:179], a[124:127], v[220:227], v26
    v_smfmac_f32_16x16x64_bf16 v[176:179], a[160:163], v[228:235], v30
    s_waitcnt lgkmcnt(7)
    v_smfmac_f32_16x16x64_bf16 v[176:179], v[240:243], v[244:251], v10 abid:1
    v_smfmac_f32_16x16x64_bf16 v[140:143], v[240:243], v[244:251], v10
    v_smfmac_f32_16x16x64_bf16 v[172:175], a[120:123], v[220:227], v25 abid:1
    s_add_u32 s28, s28, 36864
    s_cmp_ge_u32 s28, 110592
    s_cselect_b32 s28, s26, s28
    v_smfmac_f32_16x16x64_bf16 v[172:175], a[156:159], v[228:235], v29 abid:1
    s_add_u32 s30, s25, 36864
    s_cmp_eq_u32 s30, 110592
    s_cselect_b32 s30, 0, s30
    v_smfmac_f32_16x16x64_bf16 v[168:171], a[116:119], v[220:227], v25
    s_sub_u32 s31, s30, s25
    s_mov_b32 s25, s30
    s_mov_b32 s90, s22
    v_smfmac_f32_16x16x64_bf16 v[168:171], a[152:155], v[228:235], v29
    s_mov_b32 s22, s88
    s_add_u32 s91, s91, 1
    s_cmp_lt_u32 s20, 2
    v_smfmac_f32_16x16x64_bf16 v[180:183], a[128:131], v[220:227], v26 abid:1
    s_cselect_b32 s66, s23, s24
    s_add_u32 s66, s66, s95
    v_smfmac_f32_16x16x64_bf16 v[180:183], a[164:167], v[228:235], v30 abid:1
    v_cvt_pk_bf16_f32 v140, v140, v141
    v_smfmac_f32_16x16x64_bf16 v[184:187], a[132:135], v[220:227], v27
    s_add_u32 m0, m0, 896
    v_cvt_pk_bf16_f32 v141, v142, v143
    v_smfmac_f32_16x16x64_bf16 v[184:187], a[168:171], v[228:235], v31
    s_waitcnt vmcnt(6)
    buffer_load_dwordx4 v5, s[8:11], s88 offen offset:256 nt lds
    v_cvt_pk_bf16_f32 v142, v144, v145
    v_smfmac_f32_16x16x64_bf16 v[188:191], a[136:139], v[220:227], v27 abid:1
    v_cvt_pk_bf16_f32 v143, v146, v147
    v_smfmac_f32_16x16x64_bf16 v[188:191], a[172:175], v[228:235], v31 abid:1
    v_cvt_pk_bf16_f32 v148, v148, v149
    v_smfmac_f32_16x16x64_bf16 v[192:195], a[140:143], v[220:227], v49 abid:1
    v_cvt_pk_bf16_f32 v149, v150, v151
    v_smfmac_f32_16x16x64_bf16 v[192:195], a[176:179], v[228:235], v50
    ds_read_b128 v[220:223], v1 offset:25600
    s_waitcnt lgkmcnt(6)
    v_cvt_pk_bf16_f32 v150, v152, v153
    v_smfmac_f32_16x16x64_bf16 v[160:163], a[180:183], v[196:203], v32
    ds_read_b128 v[224:227], v2 offset:25600
    s_waitcnt lgkmcnt(5)
    v_cvt_pk_bf16_f32 v151, v154, v155
    v_smfmac_f32_16x16x64_bf16 v[160:163], a[216:219], v[204:211], v36
    ds_read_b128 v[228:231], v1 offset:26624
    ds_read_b128 v[152:155], v9 offset:10688
    v_cndmask_b32_dpp v144, v140, v148, vcc row_ror:8 row_mask:0xf bank_mask:0xf
    v_smfmac_f32_16x16x64_bf16 v[164:167], a[184:187], v[196:203], v32 abid:1
    ds_read_b128 v[232:235], v2 offset:26624
    v_cndmask_b32_dpp v145, v141, v149, vcc row_ror:8 row_mask:0xf bank_mask:0xf
    v_smfmac_f32_16x16x64_bf16 v[164:167], a[220:223], v[204:211], v36 abid:1
    s_add_u32 m0, m0, 896
    v_cndmask_b32_dpp v146, v142, v150, vcc row_ror:8 row_mask:0xf bank_mask:0xf
    v_smfmac_f32_16x16x64_bf16 v[168:171], a[188:191], v[196:203], v33
    s_waitcnt vmcnt(5)
    buffer_load_dwordx4 v5, s[8:11], s88 offen offset:384 nt lds
    v_cndmask_b32_dpp v147, v143, v151, vcc row_ror:8 row_mask:0xf bank_mask:0xf
    v_smfmac_f32_16x16x64_bf16 v[168:171], a[224:227], v[204:211], v37
    s_waitcnt vmcnt(6)
    buffer_store_dwordx4 v[144:147], v6, s[12:15], s59 offen offset:128 sc1
    v_mov_b32_dpp v140, v148 row_ror:8 row_mask:0xf bank_mask:0xc
    v_smfmac_f32_16x16x64_bf16 v[172:175], a[192:195], v[196:203], v33 abid:1
    v_mov_b32_dpp v141, v149 row_ror:8 row_mask:0xf bank_mask:0xc
    v_smfmac_f32_16x16x64_bf16 v[172:175], a[228:231], v[204:211], v37 abid:1
    v_mov_b32_dpp v142, v150 row_ror:8 row_mask:0xf bank_mask:0xc
    v_smfmac_f32_16x16x64_bf16 v[176:179], a[196:199], v[196:203], v34
    v_mov_b32_dpp v143, v151 row_ror:8 row_mask:0xf bank_mask:0xc
    v_smfmac_f32_16x16x64_bf16 v[176:179], a[232:235], v[204:211], v38
    s_waitcnt vmcnt(5)
    buffer_store_dwordx4 v[140:143], v6, s[12:15], s24 offen offset:128 sc1
    ds_read_b128 v[144:147], v9 offset:10560
    v_smfmac_f32_16x16x64_bf16 v[180:183], a[200:203], v[196:203], v34 abid:1
    ds_read_b128 v[148:151], v9 offset:10624
    ds_read_b128 v[140:143], v9 offset:10496
    v_add_u32 v4, s31, v4
    v_smfmac_f32_16x16x64_bf16 v[180:183], a[236:239], v[204:211], v38 abid:1
    v_add_u32 v1, s31, v1
    v_smfmac_f32_16x16x64_bf16 v[184:187], a[204:207], v[196:203], v35
    v_add_u32 v2, s31, v2
    v_smfmac_f32_16x16x64_bf16 v[184:187], a[240:243], v[204:211], v39
    v_smfmac_f32_16x16x64_bf16 v[188:191], a[208:211], v[196:203], v35 abid:1
    v_smfmac_f32_16x16x64_bf16 v[188:191], a[244:247], v[204:211], v39 abid:1
    v_smfmac_f32_16x16x64_bf16 v[192:195], a[212:215], v[196:203], v50 abid:1
    v_smfmac_f32_16x16x64_bf16 v[192:195], a[248:251], v[204:211], v51
    s_waitcnt vmcnt(8)
    s_branch M_top1
M_bF:
    v_smfmac_f32_16x16x64_bf16 v[164:167], v[56:59], v[220:227], v40 abid:1
    ds_read_b128 v[204:207], v1 offset:1024
    v_smfmac_f32_16x16x64_bf16 v[164:167], v[92:95], v[228:235], v44 abid:1
    ds_read_b128 v[208:211], v2 offset:1024
    v_smfmac_f32_16x16x64_bf16 v[168:171], v[60:63], v[220:227], v41
    ds_read_b128 v[212:215], v1 offset:2048
    v_smfmac_f32_16x16x64_bf16 v[168:171], v[96:99], v[228:235], v45
    ds_read_b128 v[216:219], v2 offset:2048
    v_smfmac_f32_16x16x64_bf16 v[172:175], v[64:67], v[220:227], v41 abid:1
    s_waitcnt lgkmcnt(6)
    buffer_store_dwordx4 v[244:247], v7, s[12:15], s66 offen sc1
    v_smfmac_f32_16x16x64_bf16 v[172:175], v[100:103], v[228:235], v45 abid:1
    ds_read_b128 v[236:239], v9 offset:9408
    v_smfmac_f32_16x16x64_bf16 v[176:179], v[68:71], v[220:227], v42
    s_mov_b32 s21, 3
    v_smfmac_f32_16x16x64_bf16 v[176:179], v[104:107], v[228:235], v46
    v_smfmac_f32_16x16x64_bf16 v[180:183], v[72:75], v[220:227], v42 abid:1
    v_cvt_pk_bf16_f32 v160, v160, v161
    v_smfmac_f32_16x16x64_bf16 v[180:183], v[108:111], v[228:235], v46 abid:1
    v_cvt_pk_bf16_f32 v161, v162, v163
    v_smfmac_f32_16x16x64_bf16 v[184:187], v[76:79], v[220:227], v43
    v_cvt_pk_bf16_f32 v162, v164, v165
    v_smfmac_f32_16x16x64_bf16 v[184:187], v[112:115], v[228:235], v47
    v_cvt_pk_bf16_f32 v163, v166, v167
    v_smfmac_f32_16x16x64_bf16 v[188:191], v[80:83], v[220:227], v43 abid:1
    v_cvt_pk_bf16_f32 v168, v168, v169
    v_smfmac_f32_16x16x64_bf16 v[188:191], v[116:119], v[228:235], v47 abid:1
    v_cvt_pk_bf16_f32 v169, v170, v171
    v_smfmac_f32_16x16x64_bf16 v[192:195], v[84:87], v[220:227], v51 abid:1
    v_cvt_pk_bf16_f32 v170, v172, v173
    v_smfmac_f32_16x16x64_bf16 v[192:195], v[120:123], v[228:235], v52
    ds_read_b128 v[220:223], v1 offset:3072
    s_waitcnt lgkmcnt(6)
    v_cvt_pk_bf16_f32 v171, v174, v175
    v_smfmac_f32_16x16x64_bf16 v[124:127], a[0:3], v[196:203], v12
    ds_read_b128 v[224:227], v2 offset:3072
    ds_read_b128 v[172:175], v9 offset:10432
    s_waitcnt lgkmcnt(6)
    v_cndmask_b32_dpp v164, v160, v168, vcc row_ror:8 row_mask:0xf bank_mask:0xf
    v_smfmac_f32_16x16x64_bf16 v[124:127], a[36:39], v[204:211], v16
    ds_read_b128 v[228:231], v1 offset:4096
    s_waitcnt lgkmcnt(5)
    v_cndmask_b32_dpp v165, v161, v169, vcc row_ror:8 row_mask:0xf bank_mask:0xf
    v_smfmac_f32_16x16x64_bf16 v[124:127], a[72:75], v[212:219], v20
    ds_read_b128 v[232:235], v2 offset:4096
    s_waitcnt lgkmcnt(5)
    v_xad_u32 v236, v236, v3, v4
    v_smfmac_f32_16x16x64_bf16 v[156:159], a[32:35], v[196:203], v48
    s_barrier
    v_xad_u32 v237, v237, v3, v4
    v_smfmac_f32_16x16x64_bf16 v[156:159], a[68:71], v[204:211], v48 abid:1
    ds_read2st64_b32 v[244:245], v236 offset0:0 offset1:72
    ds_read_b128 v[240:243], v8 offset:3072
    v_xad_u32 v238, v238, v3, v4
    v_smfmac_f32_16x16x64_bf16 v[156:159], a[104:107], v[212:219], v49
    ds_read2st64_b32 v[246:247], v237 offset0:0 offset1:72
    v_xad_u32 v239, v239, v3, v4
    v_smfmac_f32_16x16x64_bf16 v[132:135], a[8:11], v[196:203], v13
    ds_read2st64_b32 v[248:249], v238 offset0:0 offset1:72
    v_cndmask_b32_dpp v166, v162, v170, vcc row_ror:8 row_mask:0xf bank_mask:0xf
    v_smfmac_f32_16x16x64_bf16 v[132:135], a[44:47], v[204:211], v17
    ds_read2st64_b32 v[250:251], v239 offset0:0 offset1:72
    ds_read_b128 v[236:239], v9 offset:9280
    v_cndmask_b32_dpp v167, v163, v171, vcc row_ror:8 row_mask:0xf bank_mask:0xf
    v_smfmac_f32_16x16x64_bf16 v[132:135], a[80:83], v[212:219], v21
    buffer_store_dwordx4 v[164:167], v6, s[12:15], s58 offen offset:0 sc1
    v_mov_b32_dpp v160, v168 row_ror:8 row_mask:0xf bank_mask:0xc
    v_smfmac_f32_16x16x64_bf16 v[140:143], a[16:19], v[196:203], v14
    v_mov_b32_dpp v161, v169 row_ror:8 row_mask:0xf bank_mask:0xc
    v_smfmac_f32_16x16x64_bf16 v[140:143], a[52:55], v[204:211], v18
    v_mov_b32_dpp v162, v170 row_ror:8 row_mask:0xf bank_mask:0xc
    v_smfmac_f32_16x16x64_bf16 v[140:143], a[88:91], v[212:219], v22
    v_mov_b32_dpp v163, v171 row_ror:8 row_mask:0xf bank_mask:0xc
    v_smfmac_f32_16x16x64_bf16 v[136:139], a[12:15], v[196:203], v13 abid:1
    buffer_store_dwordx4 v[160:163], v6, s[12:15], s23 offen offset:0 sc1
    ds_read_b128 v[164:167], v9 offset:10304
    ds_read_b128 v[168:171], v9 offset:10368
    v_smfmac_f32_16x16x64_bf16 v[136:139], a[48:51], v[204:211], v17 abid:1
    ds_read_b128 v[160:163], v9 offset:10240
    v_smfmac_f32_16x16x64_bf16 v[136:139], a[84:87], v[212:219], v21 abid:1
    s_waitcnt lgkmcnt(3)
    v_xad_u32 v236, v236, v3, v4
    v_smfmac_f32_16x16x64_bf16 v[136:139], v[240:243], v[244:251], v10
    v_xad_u32 v237, v237, v3, v4
    v_smfmac_f32_16x16x64_bf16 v[172:175], v[240:243], v[244:251], v10 abid:1
    ds_read2st64_b32 v[244:245], v236 offset0:0 offset1:72
    ds_read_b128 v[240:243], v8 offset:1024
    v_xad_u32 v238, v238, v3, v4
    v_smfmac_f32_16x16x64_bf16 v[144:147], a[20:23], v[196:203], v14 abid:1
    ds_read2st64_b32 v[246:247], v237 offset0:0 offset1:72
    v_xad_u32 v239, v239, v3, v4
    v_smfmac_f32_16x16x64_bf16 v[144:147], a[56:59], v[204:211], v18 abid:1
    ds_read2st64_b32 v[248:249], v238 offset0:0 offset1:72
    v_smfmac_f32_16x16x64_bf16 v[144:147], a[92:95], v[212:219], v22 abid:1
    ds_read2st64_b32 v[250:251], v239 offset0:0 offset1:72
    ds_read_b128 v[236:239], v9 offset:9344
    v_smfmac_f32_16x16x64_bf16 v[148:151], a[24:27], v[196:203], v15
    v_cvt_pk_bf16_f32 v192, v192, v193
    v_smfmac_f32_16x16x64_bf16 v[148:151], a[60:63], v[204:211], v19
    v_cvt_pk_bf16_f32 v193, v194, v195
    v_smfmac_f32_16x16x64_bf16 v[148:151], a[96:99], v[212:219], v23
    ds_write_b64 v53, v[192:193] offset:0
    ds_read_b128 v[192:195], v9 offset:10752
    v_smfmac_f32_16x16x64_bf16 v[152:155], a[28:31], v[196:203], v15 abid:1
    v_smfmac_f32_16x16x64_bf16 v[152:155], a[64:67], v[204:211], v19 abid:1
    v_smfmac_f32_16x16x64_bf16 v[152:155], a[100:103], v[212:219], v23 abid:1
    v_smfmac_f32_16x16x64_bf16 v[128:131], a[4:7], v[196:203], v12 abid:1
    v_smfmac_f32_16x16x64_bf16 v[128:131], a[40:43], v[204:211], v16 abid:1
    v_smfmac_f32_16x16x64_bf16 v[128:131], a[76:79], v[212:219], v20 abid:1
    s_waitcnt lgkmcnt(2)
    v_xad_u32 v236, v236, v3, v4
    v_smfmac_f32_16x16x64_bf16 v[128:131], v[240:243], v[244:251], v10
    ds_read_b128 v[196:199], v1 offset:5120
    v_xad_u32 v237, v237, v3, v4
    v_smfmac_f32_16x16x64_bf16 v[164:167], v[240:243], v[244:251], v10 abid:1
    ds_read2st64_b32 v[244:245], v236 offset0:0 offset1:72
    ds_read_b128 v[240:243], v8 offset:2048
    v_xad_u32 v238, v238, v3, v4
    v_smfmac_f32_16x16x64_bf16 v[124:127], a[108:111], v[220:227], v24
    ds_read2st64_b32 v[246:247], v237 offset0:0 offset1:72
    v_xad_u32 v239, v239, v3, v4
    v_smfmac_f32_16x16x64_bf16 v[124:127], a[144:147], v[228:235], v28
    ds_read2st64_b32 v[248:249], v238 offset0:0 offset1:72
    ds_read_b128 v[200:203], v2 offset:5120
    ds_read_b64 v[216:217], v9 offset:10056
    v_smfmac_f32_16x16x64_bf16 v[128:131], a[112:115], v[220:227], v24 abid:1
    ds_read2st64_b32 v[250:251], v239 offset0:0 offset1:72
    ds_read_b128 v[236:239], v9 offset:9216
    v_cvt_pk_bf16_f32 v176, v176, v177
    v_smfmac_f32_16x16x64_bf16 v[128:131], a[148:151], v[228:235], v28 abid:1
    ds_read_b128 v[204:207], v1 offset:6144
    v_cvt_pk_bf16_f32 v177, v178, v179
    v_smfmac_f32_16x16x64_bf16 v[140:143], a[124:127], v[220:227], v26
    ds_read_b128 v[208:211], v2 offset:6144
    v_cvt_pk_bf16_f32 v178, v180, v181
    v_smfmac_f32_16x16x64_bf16 v[140:143], a[160:163], v[228:235], v30
    v_cvt_pk_bf16_f32 v179, v182, v183
    v_smfmac_f32_16x16x64_bf16 v[136:139], a[120:123], v[220:227], v25 abid:1
    v_cvt_pk_bf16_f32 v184, v184, v185
    v_smfmac_f32_16x16x64_bf16 v[136:139], a[156:159], v[228:235], v29 abid:1
    v_cvt_pk_bf16_f32 v185, v186, v187
    v_smfmac_f32_16x16x64_bf16 v[132:135], a[116:119], v[220:227], v25
    v_cvt_pk_bf16_f32 v186, v188, v189
    v_smfmac_f32_16x16x64_bf16 v[132:135], a[152:155], v[228:235], v29
    s_waitcnt lgkmcnt(2)
    v_xad_u32 v236, v236, v3, v4
    v_smfmac_f32_16x16x64_bf16 v[132:135], v[240:243], v[244:251], v10
    v_xad_u32 v237, v237, v3, v4
    v_smfmac_f32_16x16x64_bf16 v[168:171], v[240:243], v[244:251], v10 abid:1
    ds_read2st64_b32 v[244:245], v236 offset0:0 offset1:72
    ds_read_b128 v[240:243], v8 offset:0
    v_xad_u32 v238, v238, v3, v4
    v_smfmac_f32_16x16x64_bf16 v[144:147], a[128:131], v[220:227], v26 abid:1
    ds_read2st64_b32 v[246:247], v237 offset0:0 offset1:72
    v_xad_u32 v239, v239, v3, v4
    v_smfmac_f32_16x16x64_bf16 v[144:147], a[164:167], v[228:235], v30 abid:1
    ds_read2st64_b32 v[248:249], v238 offset0:0 offset1:72
    v_cvt_pk_bf16_f32 v187, v190, v191
    v_smfmac_f32_16x16x64_bf16 v[148:151], a[132:135], v[220:227], v27
    ds_read2st64_b32 v[250:251], v239 offset0:0 offset1:72
    ds_read_b128 v[236:239], v9 offset:9728
    ds_read_b128 v[188:191], v9 offset:10688
    v_smfmac_f32_16x16x64_bf16 v[148:151], a[168:171], v[228:235], v31
    v_xad_u32 v212, v216, v3, v4
    v_smfmac_f32_16x16x64_bf16 v[152:155], a[136:139], v[220:227], v27 abid:1
    ds_read2st64_b32 v[212:213], v212 offset0:0 offset1:72
    v_xad_u32 v214, v217, v3, v4
    v_smfmac_f32_16x16x64_bf16 v[152:155], a[172:175], v[228:235], v31 abid:1
    ds_read2st64_b32 v[214:215], v214 offset0:0 offset1:72
    v_cndmask_b32_dpp v180, v176, v184, vcc row_ror:8 row_mask:0xf bank_mask:0xf
    v_smfmac_f32_16x16x64_bf16 v[156:159], a[140:143], v[220:227], v49 abid:1
    v_cndmask_b32_dpp v181, v177, v185, vcc row_ror:8 row_mask:0xf bank_mask:0xf
    v_smfmac_f32_16x16x64_bf16 v[156:159], a[176:179], v[228:235], v50
    ds_read_b128 v[220:223], v1 offset:7168
    v_cndmask_b32_dpp v182, v178, v186, vcc row_ror:8 row_mask:0xf bank_mask:0xf
    v_smfmac_f32_16x16x64_bf16 v[128:131], a[184:187], v[196:203], v32 abid:1
    ds_read_b128 v[224:227], v2 offset:7168
    s_waitcnt lgkmcnt(11)
    v_cndmask_b32_dpp v183, v179, v187, vcc row_ror:8 row_mask:0xf bank_mask:0xf
    v_smfmac_f32_16x16x64_bf16 v[128:131], a[220:223], v[204:211], v36 abid:1
    ds_read_b128 v[228:231], v1 offset:8192
    buffer_store_dwordx4 v[180:183], v6, s[12:15], s58 offen offset:128 sc1
    v_mov_b32_dpp v176, v184 row_ror:8 row_mask:0xf bank_mask:0xc
    v_smfmac_f32_16x16x64_bf16 v[124:127], a[180:183], v[196:203], v32
    ds_read_b128 v[232:235], v2 offset:8192
    v_mov_b32_dpp v177, v185 row_ror:8 row_mask:0xf bank_mask:0xc
    v_smfmac_f32_16x16x64_bf16 v[124:127], a[216:219], v[204:211], v36
    s_waitcnt lgkmcnt(7)
    v_xad_u32 v236, v236, v3, v4
    v_smfmac_f32_16x16x64_bf16 v[124:127], v[240:243], v[244:251], v10
    v_xad_u32 v237, v237, v3, v4
    v_smfmac_f32_16x16x64_bf16 v[160:163], v[240:243], v[244:251], v10 abid:1
    ds_read2st64_b32 v[244:245], v236 offset0:0 offset1:72
    ds_read_b128 v[240:243], v8 offset:8192
    v_xad_u32 v238, v238, v3, v4
    v_smfmac_f32_16x16x64_bf16 v[132:135], a[188:191], v[196:203], v33
    ds_read2st64_b32 v[246:247], v237 offset0:0 offset1:72
    v_xad_u32 v239, v239, v3, v4
    v_smfmac_f32_16x16x64_bf16 v[132:135], a[224:227], v[204:211], v37
    ds_read2st64_b32 v[248:249], v238 offset0:0 offset1:72
    v_mov_b32_dpp v178, v186 row_ror:8 row_mask:0xf bank_mask:0xc
    v_smfmac_f32_16x16x64_bf16 v[136:139], a[192:195], v[196:203], v33 abid:1
    ds_read2st64_b32 v[250:251], v239 offset0:0 offset1:72
    ds_read_b128 v[236:239], v9 offset:9664
    v_mov_b32_dpp v179, v187 row_ror:8 row_mask:0xf bank_mask:0xc
    v_smfmac_f32_16x16x64_bf16 v[136:139], a[228:231], v[204:211], v37 abid:1
    buffer_store_dwordx4 v[176:179], v6, s[12:15], s23 offen offset:128 sc1
    ds_read_b128 v[180:183], v9 offset:10560
    ds_read_b128 v[184:187], v9 offset:10624
    v_smfmac_f32_16x16x64_bf16 v[140:143], a[196:199], v[196:203], v34
    ds_read_b128 v[176:179], v9 offset:10496
    v_smfmac_f32_16x16x64_bf16 v[140:143], a[232:235], v[204:211], v38
    v_smfmac_f32_16x16x64_bf16 v[144:147], a[200:203], v[196:203], v34 abid:1
    v_smfmac_f32_16x16x64_bf16 v[144:147], a[236:239], v[204:211], v38 abid:1
    v_smfmac_f32_16x16x64_bf16 v[156:159], a[212:215], v[196:203], v50 abid:1
    v_smfmac_f32_16x16x64_bf16 v[156:159], a[248:251], v[204:211], v51
    s_waitcnt lgkmcnt(3)
    v_xad_u32 v236, v236, v3, v4
    v_smfmac_f32_16x16x64_bf16 v[156:159], v[240:243], v[244:251], v10
    v_xad_u32 v237, v237, v3, v4
    v_smfmac_f32_16x16x64_bf16 v[192:195], v[240:243], v[244:251], v10 abid:1
    ds_read2st64_b32 v[244:245], v236 offset0:0 offset1:72
    ds_read_b128 v[240:243], v8 offset:7168
    v_xad_u32 v238, v238, v3, v4
    v_smfmac_f32_16x16x64_bf16 v[152:155], a[208:211], v[196:203], v35 abid:1
    ds_read2st64_b32 v[246:247], v237 offset0:0 offset1:72
    v_xad_u32 v239, v239, v3, v4
    v_smfmac_f32_16x16x64_bf16 v[152:155], a[244:247], v[204:211], v39 abid:1
    ds_read2st64_b32 v[248:249], v238 offset0:0 offset1:72
    v_smfmac_f32_16x16x64_bf16 v[148:151], a[204:207], v[196:203], v35
    ds_read2st64_b32 v[250:251], v239 offset0:0 offset1:72
    ds_read_b128 v[236:239], v9 offset:9536
    v_smfmac_f32_16x16x64_bf16 v[148:151], a[240:243], v[204:211], v39
    ds_read_b128 v[196:199], v1 offset:18432
    v_smfmac_f32_16x16x64_bf16 v[124:127], a[252:255], v[220:227], v40
    ds_read_b128 v[200:203], v2 offset:18432
    v_smfmac_f32_16x16x64_bf16 v[124:127], v[88:91], v[228:235], v44
    ds_read_b128 v[204:207], v1 offset:19456
    v_smfmac_f32_16x16x64_bf16 v[128:131], v[56:59], v[220:227], v40 abid:1
    ds_read_b128 v[208:211], v2 offset:19456
    v_smfmac_f32_16x16x64_bf16 v[128:131], v[92:95], v[228:235], v44 abid:1
    s_waitcnt lgkmcnt(10)
    s_cmp_lt_i32 s81, 0
    s_cbranch_scc1 M_ovrF
    s_swappc_b64 s[78:79], s[72:73]
M_ovrF:
    v_smfmac_f32_16x16x64_bf16 v[132:135], v[60:63], v[220:227], v41
    s_cmp_lt_u32 s20, 2
    s_cselect_b32 s66, s23, s24
    s_add_u32 s66, s66, s95
    v_smfmac_f32_16x16x64_bf16 v[132:135], v[96:99], v[228:235], v45
    s_add_u32 s23, s24, 18432
    s_add_u32 s58, s24, 27648
    s_add_u32 s67, s23, s95
    v_smfmac_f32_16x16x64_bf16 v[152:155], v[80:83], v[220:227], v43 abid:1
    v_smfmac_f32_16x16x64_bf16 v[152:155], v[116:119], v[228:235], v47 abid:1
    s_waitcnt lgkmcnt(4)
    v_xad_u32 v236, v236, v3, v4
    v_smfmac_f32_16x16x64_bf16 v[152:155], v[240:243], v[244:251], v10
    v_xad_u32 v237, v237, v3, v4
    v_smfmac_f32_16x16x64_bf16 v[188:191], v[240:243], v[244:251], v10 abid:1
    s_cmp_gt_u32 s46, s80
    s_cbranch_scc1 M_slow
M_slowrF:
    v_xad_u32 v238, v238, v3, v4
    v_smfmac_f32_16x16x64_bf16 v[140:143], v[68:71], v[220:227], v42
    ds_read2st64_b32 v[244:245], v236 offset0:0 offset1:72
    ds_read_b128 v[240:243], v8 offset:5120
    v_xad_u32 v239, v239, v3, v4
    v_smfmac_f32_16x16x64_bf16 v[140:143], v[104:107], v[228:235], v46
    ds_read2st64_b32 v[246:247], v237 offset0:0 offset1:72
    v_smfmac_f32_16x16x64_bf16 v[156:159], v[84:87], v[220:227], v51 abid:1
    ds_read2st64_b32 v[248:249], v238 offset0:0 offset1:72
    ds_read_b128 v[212:215], v1 offset:20480
    v_smfmac_f32_16x16x64_bf16 v[156:159], v[120:123], v[228:235], v52
    ds_read2st64_b32 v[250:251], v239 offset0:0 offset1:72
    ds_read_b128 v[236:239], v9 offset:9600
    v_smfmac_f32_16x16x64_bf16 v[148:151], v[76:79], v[220:227], v43
    ds_read_b128 v[216:219], v2 offset:20480
    v_smfmac_f32_16x16x64_bf16 v[148:151], v[112:115], v[228:235], v47
    v_smfmac_f32_16x16x64_bf16 v[136:139], v[64:67], v[220:227], v41 abid:1
    v_smfmac_f32_16x16x64_bf16 v[136:139], v[100:103], v[228:235], v45 abid:1
    v_smfmac_f32_16x16x64_bf16 v[144:147], v[72:75], v[220:227], v42 abid:1
    v_smfmac_f32_16x16x64_bf16 v[144:147], v[108:111], v[228:235], v46 abid:1
    ds_read_b128 v[220:223], v1 offset:21504
    s_waitcnt lgkmcnt(2)
    v_xad_u32 v236, v236, v3, v4
    v_smfmac_f32_16x16x64_bf16 v[144:147], v[240:243], v[244:251], v10
    ds_read_b128 v[224:227], v2 offset:21504
    v_xad_u32 v237, v237, v3, v4
    v_smfmac_f32_16x16x64_bf16 v[180:183], v[240:243], v[244:251], v10 abid:1
    ds_read2st64_b32 v[244:245], v236 offset0:0 offset1:72
    ds_read_b128 v[240:243], v8 offset:6144
    v_xad_u32 v238, v238, v3, v4
    v_smfmac_f32_16x16x64_bf16 v[192:195], a[32:35], v[196:203], v48
    ds_read2st64_b32 v[246:247], v237 offset0:0 offset1:72
    ds_read_b128 v[228:231], v1 offset:22528
    v_xad_u32 v239, v239, v3, v4
    v_smfmac_f32_16x16x64_bf16 v[192:195], a[68:71], v[204:211], v48 abid:1
    ds_read2st64_b32 v[248:249], v238 offset0:0 offset1:72
    ds_read_b128 v[232:235], v2 offset:22528
    s_waitcnt lgkmcnt(8)
    v_cvt_pk_bf16_f32 v124, v124, v125
    v_smfmac_f32_16x16x64_bf16 v[192:195], a[104:107], v[212:219], v49
    ds_read2st64_b32 v[250:251], v239 offset0:0 offset1:72
    ds_read_b128 v[236:239], v9 offset:9472
    v_cvt_pk_bf16_f32 v125, v126, v127
    v_smfmac_f32_16x16x64_bf16 v[160:163], a[0:3], v[196:203], v12
    v_cvt_pk_bf16_f32 v126, v128, v129
    v_smfmac_f32_16x16x64_bf16 v[160:163], a[36:39], v[204:211], v16
    v_cvt_pk_bf16_f32 v127, v130, v131
    v_smfmac_f32_16x16x64_bf16 v[160:163], a[72:75], v[212:219], v20
    v_cvt_pk_bf16_f32 v156, v156, v157
    v_smfmac_f32_16x16x64_bf16 v[164:167], a[4:7], v[196:203], v12 abid:1
    v_cvt_pk_bf16_f32 v157, v158, v159
    v_smfmac_f32_16x16x64_bf16 v[164:167], a[40:43], v[204:211], v16 abid:1
    ds_write_b64 v53, v[156:157] offset:25728
    v_cvt_pk_bf16_f32 v132, v132, v133
    v_smfmac_f32_16x16x64_bf16 v[164:167], a[76:79], v[212:219], v20 abid:1
    v_cvt_pk_bf16_f32 v133, v134, v135
    v_smfmac_f32_16x16x64_bf16 v[168:171], a[8:11], v[196:203], v13
    v_cvt_pk_bf16_f32 v134, v136, v137
    v_smfmac_f32_16x16x64_bf16 v[168:171], a[44:47], v[204:211], v17
    v_cvt_pk_bf16_f32 v135, v138, v139
    v_smfmac_f32_16x16x64_bf16 v[168:171], a[80:83], v[212:219], v21
    s_waitcnt lgkmcnt(1)
    v_xad_u32 v236, v236, v3, v4
    v_smfmac_f32_16x16x64_bf16 v[184:187], v[240:243], v[244:251], v10 abid:1
    v_xad_u32 v237, v237, v3, v4
    v_smfmac_f32_16x16x64_bf16 v[148:151], v[240:243], v[244:251], v10
    ds_read2st64_b32 v[244:245], v236 offset0:0 offset1:72
    ds_read_b128 v[240:243], v8 offset:4096
    v_xad_u32 v238, v238, v3, v4
    v_smfmac_f32_16x16x64_bf16 v[172:175], a[12:15], v[196:203], v13 abid:1
    ds_read2st64_b32 v[246:247], v237 offset0:0 offset1:72
    v_xad_u32 v239, v239, v3, v4
    v_smfmac_f32_16x16x64_bf16 v[172:175], a[48:51], v[204:211], v17 abid:1
    ds_read2st64_b32 v[248:249], v238 offset0:0 offset1:72
    v_cndmask_b32_dpp v128, v124, v132, vcc row_ror:8 row_mask:0xf bank_mask:0xf
    v_smfmac_f32_16x16x64_bf16 v[172:175], a[84:87], v[212:219], v21 abid:1
    ds_read2st64_b32 v[250:251], v239 offset0:0 offset1:72
    ds_read_b128 v[196:199], v1 offset:23552
    v_cndmask_b32_dpp v129, v125, v133, vcc row_ror:8 row_mask:0xf bank_mask:0xf
    v_smfmac_f32_16x16x64_bf16 v[192:195], a[140:143], v[220:227], v49 abid:1
    ds_read_b128 v[200:203], v2 offset:23552
    v_cndmask_b32_dpp v130, v126, v134, vcc row_ror:8 row_mask:0xf bank_mask:0xf
    v_smfmac_f32_16x16x64_bf16 v[192:195], a[176:179], v[228:235], v50
    ds_read_b128 v[204:207], v1 offset:24576
    v_cndmask_b32_dpp v131, v127, v135, vcc row_ror:8 row_mask:0xf bank_mask:0xf
    v_smfmac_f32_16x16x64_bf16 v[160:163], a[108:111], v[220:227], v24
    ds_read_b128 v[208:211], v2 offset:24576
    buffer_store_dwordx4 v[128:131], v6, s[12:15], s59 offen offset:0 sc1
    v_mov_b32_dpp v124, v132 row_ror:8 row_mask:0xf bank_mask:0xc
    v_smfmac_f32_16x16x64_bf16 v[160:163], a[144:147], v[228:235], v28
    s_waitcnt lgkmcnt(9)
    s_barrier
    ds_read_b128 v[236:239], v8 offset:10816
    v_mov_b32_dpp v125, v133 row_ror:8 row_mask:0xf bank_mask:0xc
    v_smfmac_f32_16x16x64_bf16 v[164:167], a[112:115], v[220:227], v24 abid:1
    ds_read_b128 v[212:215], v1 offset:20480
    v_mov_b32_dpp v126, v134 row_ror:8 row_mask:0xf bank_mask:0xc
    v_smfmac_f32_16x16x64_bf16 v[164:167], a[148:151], v[228:235], v28 abid:1
    ds_read_b128 v[216:219], v2 offset:20480
    v_mov_b32_dpp v127, v135 row_ror:8 row_mask:0xf bank_mask:0xc
    v_smfmac_f32_16x16x64_bf16 v[168:171], a[116:119], v[220:227], v25
    buffer_store_dwordx4 v[124:127], v6, s[12:15], s24 offen offset:0 sc1
    v_smfmac_f32_16x16x64_bf16 v[168:171], a[152:155], v[228:235], v29
    s_waitcnt lgkmcnt(7)
    v_smfmac_f32_16x16x64_bf16 v[176:179], v[240:243], v[244:251], v10 abid:1
    v_smfmac_f32_16x16x64_bf16 v[140:143], v[240:243], v[244:251], v10
    s_waitcnt lgkmcnt(2)
    buffer_store_dwordx4 v[236:239], v7, s[12:15], s66 offen sc1
    v_smfmac_f32_16x16x64_bf16 v[172:175], a[120:123], v[220:227], v25 abid:1
    v_smfmac_f32_16x16x64_bf16 v[172:175], a[156:159], v[228:235], v29 abid:1
    ds_read_b128 v[220:223], v1 offset:25600
    v_smfmac_f32_16x16x64_bf16 v[192:195], a[212:215], v[196:203], v50 abid:1
    ds_read_b128 v[224:227], v2 offset:25600
    s_nop 0
    v_cvt_pk_bf16_f32 v140, v140, v141
    v_smfmac_f32_16x16x64_bf16 v[192:195], a[248:251], v[204:211], v51
    ds_read_b128 v[228:231], v1 offset:26624
    v_cvt_pk_bf16_f32 v141, v142, v143
    v_smfmac_f32_16x16x64_bf16 v[160:163], a[180:183], v[196:203], v32
    ds_read_b128 v[232:235], v2 offset:26624
    v_cvt_pk_bf16_f32 v142, v144, v145
    v_smfmac_f32_16x16x64_bf16 v[160:163], a[216:219], v[204:211], v36
    v_cvt_pk_bf16_f32 v143, v146, v147
    v_smfmac_f32_16x16x64_bf16 v[164:167], a[184:187], v[196:203], v32 abid:1
    v_cvt_pk_bf16_f32 v148, v148, v149
    v_smfmac_f32_16x16x64_bf16 v[164:167], a[220:223], v[204:211], v36 abid:1
    v_cvt_pk_bf16_f32 v149, v150, v151
    v_smfmac_f32_16x16x64_bf16 v[168:171], a[188:191], v[196:203], v33
    v_cvt_pk_bf16_f32 v150, v152, v153
    v_smfmac_f32_16x16x64_bf16 v[168:171], a[224:227], v[204:211], v37
    v_cvt_pk_bf16_f32 v151, v154, v155
    v_smfmac_f32_16x16x64_bf16 v[172:175], a[192:195], v[196:203], v33 abid:1
    v_cndmask_b32_dpp v144, v140, v148, vcc row_ror:8 row_mask:0xf bank_mask:0xf
    v_smfmac_f32_16x16x64_bf16 v[172:175], a[228:231], v[204:211], v37 abid:1
    ds_read_b128 v[196:199], v1 offset:18432
    s_waitcnt lgkmcnt(3)
    v_cndmask_b32_dpp v145, v141, v149, vcc row_ror:8 row_mask:0xf bank_mask:0xf
    v_smfmac_f32_16x16x64_bf16 v[192:195], v[84:87], v[220:227], v51 abid:1
    ds_read_b128 v[200:203], v2 offset:18432
    s_waitcnt lgkmcnt(2)
    v_cndmask_b32_dpp v146, v142, v150, vcc row_ror:8 row_mask:0xf bank_mask:0xf
    v_smfmac_f32_16x16x64_bf16 v[192:195], v[120:123], v[228:235], v52
    ds_read_b128 v[204:207], v1 offset:19456
    v_cndmask_b32_dpp v147, v143, v151, vcc row_ror:8 row_mask:0xf bank_mask:0xf
    v_smfmac_f32_16x16x64_bf16 v[160:163], a[252:255], v[220:227], v40
    ds_read_b128 v[208:211], v2 offset:19456
    buffer_store_dwordx4 v[144:147], v6, s[12:15], s59 offen offset:128 sc1
    v_mov_b32_dpp v140, v148 row_ror:8 row_mask:0xf bank_mask:0xc
    v_smfmac_f32_16x16x64_bf16 v[160:163], v[88:91], v[228:235], v44
    v_mov_b32_dpp v141, v149 row_ror:8 row_mask:0xf bank_mask:0xc
    v_smfmac_f32_16x16x64_bf16 v[164:167], v[56:59], v[220:227], v40 abid:1
    v_mov_b32_dpp v142, v150 row_ror:8 row_mask:0xf bank_mask:0xc
    v_smfmac_f32_16x16x64_bf16 v[164:167], v[92:95], v[228:235], v44 abid:1
    v_mov_b32_dpp v143, v151 row_ror:8 row_mask:0xf bank_mask:0xc
    v_smfmac_f32_16x16x64_bf16 v[168:171], v[60:63], v[220:227], v41
    buffer_store_dwordx4 v[140:143], v6, s[12:15], s24 offen offset:128 sc1
    v_cvt_pk_bf16_f32 v192, v192, v193
    v_smfmac_f32_16x16x64_bf16 v[168:171], v[96:99], v[228:235], v45
    v_cvt_pk_bf16_f32 v193, v194, v195
    v_smfmac_f32_16x16x64_bf16 v[172:175], v[64:67], v[220:227], v41 abid:1
    ds_write_b64 v53, v[192:193] offset:1024
    v_smfmac_f32_16x16x64_bf16 v[172:175], v[100:103], v[228:235], v45 abid:1
    ds_read_b128 v[220:223], v1 offset:21504
    s_waitcnt lgkmcnt(4)
    v_smfmac_f32_16x16x64_bf16 v[176:179], a[16:19], v[196:203], v14
    ds_read_b128 v[224:227], v2 offset:21504
    s_waitcnt lgkmcnt(3)
    v_smfmac_f32_16x16x64_bf16 v[176:179], a[52:55], v[204:211], v18
    ds_read_b128 v[228:231], v1 offset:22528
    v_smfmac_f32_16x16x64_bf16 v[176:179], a[88:91], v[212:219], v22
    ds_read_b128 v[232:235], v2 offset:22528
    s_waitcnt lgkmcnt(4)
    s_barrier
    ds_read_b128 v[236:239], v8 offset:11840
    v_smfmac_f32_16x16x64_bf16 v[180:183], a[20:23], v[196:203], v14 abid:1
    v_cvt_pk_bf16_f32 v160, v160, v161
    v_smfmac_f32_16x16x64_bf16 v[180:183], a[56:59], v[204:211], v18 abid:1
    v_cvt_pk_bf16_f32 v161, v162, v163
    v_smfmac_f32_16x16x64_bf16 v[180:183], a[92:95], v[212:219], v22 abid:1
    v_cvt_pk_bf16_f32 v162, v164, v165
    v_smfmac_f32_16x16x64_bf16 v[184:187], a[24:27], v[196:203], v15
    v_cvt_pk_bf16_f32 v163, v166, v167
    v_smfmac_f32_16x16x64_bf16 v[184:187], a[60:63], v[204:211], v19
    v_cvt_pk_bf16_f32 v168, v168, v169
    v_smfmac_f32_16x16x64_bf16 v[184:187], a[96:99], v[212:219], v23
    s_cmp_lt_u32 s20, 2
    s_waitcnt lgkmcnt(0)
    s_cbranch_scc0 M_fx
    buffer_store_dwordx4 v[236:239], v7, s[12:15], s67 offen sc1
M_fx:
    v_smfmac_f32_16x16x64_bf16 v[188:191], a[28:31], v[196:203], v15 abid:1
    v_cvt_pk_bf16_f32 v169, v170, v171
    v_smfmac_f32_16x16x64_bf16 v[188:191], a[64:67], v[204:211], v19 abid:1
    v_cvt_pk_bf16_f32 v170, v172, v173
    v_smfmac_f32_16x16x64_bf16 v[188:191], a[100:103], v[212:219], v23 abid:1
    ds_read_b128 v[196:199], v1 offset:23552
    v_cvt_pk_bf16_f32 v171, v174, v175
    v_smfmac_f32_16x16x64_bf16 v[176:179], a[124:127], v[220:227], v26
    ds_read_b128 v[200:203], v2 offset:23552
    v_cndmask_b32_dpp v164, v160, v168, vcc row_ror:8 row_mask:0xf bank_mask:0xf
    v_smfmac_f32_16x16x64_bf16 v[176:179], a[160:163], v[228:235], v30
    ds_read_b128 v[204:207], v1 offset:24576
    v_cndmask_b32_dpp v165, v161, v169, vcc row_ror:8 row_mask:0xf bank_mask:0xf
    v_smfmac_f32_16x16x64_bf16 v[180:183], a[128:131], v[220:227], v26 abid:1
    ds_read_b128 v[208:211], v2 offset:24576
    v_cndmask_b32_dpp v166, v162, v170, vcc row_ror:8 row_mask:0xf bank_mask:0xf
    v_smfmac_f32_16x16x64_bf16 v[180:183], a[164:167], v[228:235], v30 abid:1
    v_cndmask_b32_dpp v167, v163, v171, vcc row_ror:8 row_mask:0xf bank_mask:0xf
    v_smfmac_f32_16x16x64_bf16 v[184:187], a[132:135], v[220:227], v27
    buffer_store_dwordx4 v[164:167], v6, s[12:15], s58 offen offset:0 sc1
    v_mov_b32_dpp v160, v168 row_ror:8 row_mask:0xf bank_mask:0xc
    v_smfmac_f32_16x16x64_bf16 v[184:187], a[168:171], v[228:235], v31
    v_mov_b32_dpp v161, v169 row_ror:8 row_mask:0xf bank_mask:0xc
    v_smfmac_f32_16x16x64_bf16 v[188:191], a[136:139], v[220:227], v27 abid:1
    v_mov_b32_dpp v162, v170 row_ror:8 row_mask:0xf bank_mask:0xc
    v_smfmac_f32_16x16x64_bf16 v[188:191], a[172:175], v[228:235], v31 abid:1
    ds_read_b128 v[220:223], v1 offset:25600
    s_waitcnt lgkmcnt(3)
    v_mov_b32_dpp v163, v171 row_ror:8 row_mask:0xf bank_mask:0xc
    v_smfmac_f32_16x16x64_bf16 v[176:179], a[196:199], v[196:203], v34
    ds_read_b128 v[224:227], v2 offset:25600
    buffer_store_dwordx4 v[160:163], v6, s[12:15], s23 offen offset:0 sc1
    s_waitcnt lgkmcnt(2)
    v_smfmac_f32_16x16x64_bf16 v[176:179], a[232:235], v[204:211], v38
    ds_read_b128 v[228:231], v1 offset:26624
    v_smfmac_f32_16x16x64_bf16 v[180:183], a[200:203], v[196:203], v34 abid:1
    ds_read_b128 v[232:235], v2 offset:26624
    v_smfmac_f32_16x16x64_bf16 v[180:183], a[236:239], v[204:211], v38 abid:1
    v_smfmac_f32_16x16x64_bf16 v[184:187], a[204:207], v[196:203], v35
    v_smfmac_f32_16x16x64_bf16 v[184:187], a[240:243], v[204:211], v39
    v_smfmac_f32_16x16x64_bf16 v[188:191], a[208:211], v[196:203], v35 abid:1
    v_smfmac_f32_16x16x64_bf16 v[188:191], a[244:247], v[204:211], v39 abid:1
    s_waitcnt lgkmcnt(2)
    v_smfmac_f32_16x16x64_bf16 v[176:179], v[68:71], v[220:227], v42
    s_waitcnt lgkmcnt(0)
    v_smfmac_f32_16x16x64_bf16 v[176:179], v[104:107], v[228:235], v46
    v_smfmac_f32_16x16x64_bf16 v[180:183], v[72:75], v[220:227], v42 abid:1
    v_smfmac_f32_16x16x64_bf16 v[180:183], v[108:111], v[228:235], v46 abid:1
    v_smfmac_f32_16x16x64_bf16 v[184:187], v[76:79], v[220:227], v43
    v_smfmac_f32_16x16x64_bf16 v[184:187], v[112:115], v[228:235], v47
    v_smfmac_f32_16x16x64_bf16 v[188:191], v[80:83], v[220:227], v43 abid:1
    v_smfmac_f32_16x16x64_bf16 v[188:191], v[116:119], v[228:235], v47 abid:1
    s_nop 1
    v_cvt_pk_bf16_f32 v176, v176, v177
    v_cvt_pk_bf16_f32 v177, v178, v179
    v_cvt_pk_bf16_f32 v178, v180, v181
    v_cvt_pk_bf16_f32 v179, v182, v183
    v_cvt_pk_bf16_f32 v184, v184, v185
    v_cvt_pk_bf16_f32 v185, v186, v187
    v_cvt_pk_bf16_f32 v186, v188, v189
    v_cvt_pk_bf16_f32 v187, v190, v191
    v_cndmask_b32_dpp v180, v176, v184, vcc row_ror:8 row_mask:0xf bank_mask:0xf
    v_cndmask_b32_dpp v181, v177, v185, vcc row_ror:8 row_mask:0xf bank_mask:0xf
    v_cndmask_b32_dpp v182, v178, v186, vcc row_ror:8 row_mask:0xf bank_mask:0xf
    v_cndmask_b32_dpp v183, v179, v187, vcc row_ror:8 row_mask:0xf bank_mask:0xf
    buffer_store_dwordx4 v[180:183], v6, s[12:15], s58 offen offset:128 sc1
    v_mov_b32_dpp v176, v184 row_ror:8 row_mask:0xf bank_mask:0xc
    v_mov_b32_dpp v177, v185 row_ror:8 row_mask:0xf bank_mask:0xc
    v_mov_b32_dpp v178, v186 row_ror:8 row_mask:0xf bank_mask:0xc
    v_mov_b32_dpp v179, v187 row_ror:8 row_mask:0xf bank_mask:0xc
    buffer_store_dwordx4 v[176:179], v6, s[12:15], s23 offen offset:128 sc1
M_done:
M_end:
    s_endpgm
M_pf_spin:
    s_sleep 4
    v_mov_b32 v0, 0
    s_mov_b64 exec, 1
    buffer_atomic_add v0, off, s[16:19], s96 sc0 sc1
    s_mov_b64 exec, -1
    s_add_u32 s31, s31, 1
    s_waitcnt vmcnt(0)
    v_readfirstlane_b32 s30, v0
    s_nop 0
    s_sub_u32 s30, s30, s100
    s_cmp_eq_u32 s30, 27
    s_cbranch_scc1 M_pf_ok
    s_cmp_lt_u32 s31, 24
    s_cbranch_scc1 M_pf_spin
    s_cmp_eq_u32 s98, 0
    s_cbranch_scc1 M_pf_spin2
    s_mov_b32 s98, 0
    v_mov_b32 v250, 1
    s_mov_b64 exec, 1
    buffer_atomic_add v250, off, s[68:71], 0 offset:0 sc1
    s_mov_b64 exec, -1
    s_nop 3
M_pf_spin2:
    s_sleep 16
    buffer_load_dword v0, off, s[68:71], 0 offset:0 sc1
    s_add_u32 s31, s31, 1
    s_cmp_ge_u32 s31, 131072
    s_cbranch_scc1 M_end
    s_waitcnt vmcnt(0)
    v_readfirstlane_b32 s30, v0
    s_nop 0
    s_cmp_eq_u32 s30, 81
    s_cbranch_scc0 M_pf_spin2
    s_branch M_pf_ok
M_r3:
    v_bfe_u32 v74, v60, 24, 4
    v_lshlrev_b32 v75, 1, v60
    v_lshl_add_u32 v74, v74, 2, s49
    v_and_b32 v75, 16, v75
    v_and_or_b32 v74, v60, 2.0, v74
    v_lshlrev_b32 v75, v75, 1
    ds_add_rtn_u32 v64, v74, v75
    v_and_b32 v74, 8, v60
    v_lshrrev_b32 v77, 14, v60
    v_cmp_ne_u32 s[44:45], 0, v74
    v_and_b32 v80, 0x3cf0, v77
    s_waitcnt lgkmcnt(0)
    v_lshrrev_b32 v75, 16, v64
    v_and_b32 v76, 0xffff, v64
    v_sub_u32 v74, 15, v75
    v_and_b32 v64, 2.0, v60
    v_add3_u32 v64, v76, v75, v64
    v_cndmask_b32 v74, v76, v74, s[44:45]
    v_cmp_gt_u32 s[44:45], 16, v64
    v_cmp_gt_u32 s[36:37], 2.0, v64
    v_lshlrev_b32 v74, 2, v74
    v_lshrrev_b64 v[76:77], v74, s[50:51]
    s_andn2_b64 s[36:37], s[36:37], s[44:45]
    v_lshrrev_b64 v[78:79], v74, s[52:53]
    v_bfe_u32 v74, v60, 24, 4
    v_mbcnt_lo_u32_b32 v75, s36, 0
    v_and_b32 v76, 15, v76
    v_mbcnt_hi_u32_b32 v75, s37, v75
    v_and_b32 v78, 15, v78
    v_lshl_add_u32 v75, v75, 3, s40
    v_lshl_add_u32 v76, v74, 4, v76
    v_min_u32 v75, s41, v75
    v_mul_u32_u24 v78, 68, v78
    v_cndmask_b32 v75, v82, v75, s[36:37]
    ds_write_b64 v75, v[60:61]
    s_bcnt1_i32_b64 s30, s[36:37]
    s_lshl3_add_u32 s40, s30, s40
    v_lshl_add_u32 v76, v76, 2, s47
    v_and_b32 v78, 0x30c, v78
    v_cndmask_b32 v76, v82, v76, s[44:45]
    v_add3_u32 v77, v80, v78, s29
    v_and_b32 v78, 0x3fff, v60
    v_cndmask_b32 v74, v82, v77, s[44:45]
    ds_write_b32 v76, v78
    ds_write_b32 v74, v61
    s_cmp_gt_u32 s38, s39
    s_cselect_b32 s32, 1, s32
    s_branch M_r3r
M_dn:
    s_mov_b32 s27, 0
    s_mov_b32 s46, 0x80000000
    v_mov_b32 v244, 0
    v_mov_b32 v245, 0
    v_mov_b32 v246, 0
    v_mov_b32 v247, 0
    ds_write_b128 v8, v[244:247] offset:0
    ds_write_b128 v8, v[244:247] offset:1024
    ds_write_b128 v8, v[244:247] offset:2048
    ds_write_b128 v8, v[244:247] offset:3072
    ds_write_b128 v8, v[244:247] offset:4096
    ds_write_b128 v8, v[244:247] offset:5120
    ds_write_b128 v8, v[244:247] offset:6144
    ds_write_b128 v8, v[244:247] offset:7168
    ds_write_b128 v8, v[244:247] offset:8192
    s_waitcnt lgkmcnt(0)
    s_branch M_dnr
M_ovc0:
    v_smfmac_f32_16x16x32_bf16 v[124:127], v[54:55], v[212:215], v10
    v_smfmac_f32_16x16x32_bf16 v[160:163], v[54:55], v[212:215], v10 abid:2
    s_setpc_b64 s[74:75]
    v_smfmac_f32_16x16x32_bf16 v[128:131], v[54:55], v[212:215], v10
    v_smfmac_f32_16x16x32_bf16 v[164:167], v[54:55], v[212:215], v10 abid:2
    s_setpc_b64 s[74:75]
    v_smfmac_f32_16x16x32_bf16 v[132:135], v[54:55], v[212:215], v10
    v_smfmac_f32_16x16x32_bf16 v[168:171], v[54:55], v[212:215], v10 abid:2
    s_setpc_b64 s[74:75]
    v_smfmac_f32_16x16x32_bf16 v[136:139], v[54:55], v[212:215], v10
    v_smfmac_f32_16x16x32_bf16 v[172:175], v[54:55], v[212:215], v10 abid:2
    s_setpc_b64 s[74:75]
    v_smfmac_f32_16x16x32_bf16 v[140:143], v[54:55], v[212:215], v10
    v_smfmac_f32_16x16x32_bf16 v[176:179], v[54:55], v[212:215], v10 abid:2
    s_setpc_b64 s[74:75]
    v_smfmac_f32_16x16x32_bf16 v[144:147], v[54:55], v[212:215], v10
    v_smfmac_f32_16x16x32_bf16 v[180:183], v[54:55], v[212:215], v10 abid:2
    s_setpc_b64 s[74:75]
    v_smfmac_f32_16x16x32_bf16 v[148:151], v[54:55], v[212:215], v10
    v_smfmac_f32_16x16x32_bf16 v[184:187], v[54:55], v[212:215], v10 abid:2
    s_setpc_b64 s[74:75]
    v_smfmac_f32_16x16x32_bf16 v[152:155], v[54:55], v[212:215], v10
    v_smfmac_f32_16x16x32_bf16 v[188:191], v[54:55], v[212:215], v10 abid:2
    s_setpc_b64 s[74:75]
    v_smfmac_f32_16x16x32_bf16 v[156:159], v[54:55], v[212:215], v10
    v_smfmac_f32_16x16x32_bf16 v[192:195], v[54:55], v[212:215], v10 abid:2
    s_setpc_b64 s[74:75]
M_ovl0:
    v_smfmac_f32_16x16x32_bf16 v[124:127], v[54:55], v[212:215], v10
    v_smfmac_f32_16x16x32_bf16 v[160:163], v[54:55], v[212:215], v10 abid:2
    s_setpc_b64 s[78:79]
    v_smfmac_f32_16x16x32_bf16 v[128:131], v[54:55], v[212:215], v10
    v_smfmac_f32_16x16x32_bf16 v[164:167], v[54:55], v[212:215], v10 abid:2
    s_setpc_b64 s[78:79]
    v_smfmac_f32_16x16x32_bf16 v[132:135], v[54:55], v[212:215], v10
    v_smfmac_f32_16x16x32_bf16 v[168:171], v[54:55], v[212:215], v10 abid:2
    s_setpc_b64 s[78:79]
    v_smfmac_f32_16x16x32_bf16 v[136:139], v[54:55], v[212:215], v10
    v_smfmac_f32_16x16x32_bf16 v[172:175], v[54:55], v[212:215], v10 abid:2
    s_setpc_b64 s[78:79]
    v_smfmac_f32_16x16x32_bf16 v[140:143], v[54:55], v[212:215], v10
    v_smfmac_f32_16x16x32_bf16 v[176:179], v[54:55], v[212:215], v10 abid:2
    s_setpc_b64 s[78:79]
    v_smfmac_f32_16x16x32_bf16 v[144:147], v[54:55], v[212:215], v10
    v_smfmac_f32_16x16x32_bf16 v[180:183], v[54:55], v[212:215], v10 abid:2
    s_setpc_b64 s[78:79]
    v_smfmac_f32_16x16x32_bf16 v[148:151], v[54:55], v[212:215], v10
    v_smfmac_f32_16x16x32_bf16 v[184:187], v[54:55], v[212:215], v10 abid:2
    s_setpc_b64 s[78:79]
    v_smfmac_f32_16x16x32_bf16 v[152:155], v[54:55], v[212:215], v10
    v_smfmac_f32_16x16x32_bf16 v[188:191], v[54:55], v[212:215], v10 abid:2
    s_setpc_b64 s[78:79]
    v_smfmac_f32_16x16x32_bf16 v[156:159], v[54:55], v[212:215], v10
    v_smfmac_f32_16x16x32_bf16 v[192:195], v[54:55], v[212:215], v10 abid:2
    s_setpc_b64 s[78:79]
M_ovc1:
    v_smfmac_f32_16x16x32_bf16 v[124:127], v[252:253], v[212:215], v10
    v_smfmac_f32_16x16x32_bf16 v[160:163], v[252:253], v[212:215], v10 abid:2
    s_setpc_b64 s[76:77]
    v_smfmac_f32_16x16x32_bf16 v[128:131], v[252:253], v[212:215], v10
    v_smfmac_f32_16x16x32_bf16 v[164:167], v[252:253], v[212:215], v10 abid:2
    s_setpc_b64 s[76:77]
    v_smfmac_f32_16x16x32_bf16 v[132:135], v[252:253], v[212:215], v10
    v_smfmac_f32_16x16x32_bf16 v[168:171], v[252:253], v[212:215], v10 abid:2
    s_setpc_b64 s[76:77]
    v_smfmac_f32_16x16x32_bf16 v[136:139], v[252:253], v[212:215], v10
    v_smfmac_f32_16x16x32_bf16 v[172:175], v[252:253], v[212:215], v10 abid:2
    s_setpc_b64 s[76:77]
    v_smfmac_f32_16x16x32_bf16 v[140:143], v[252:253], v[212:215], v10
    v_smfmac_f32_16x16x32_bf16 v[176:179], v[252:253], v[212:215], v10 abid:2
    s_setpc_b64 s[76:77]
    v_smfmac_f32_16x16x32_bf16 v[144:147], v[252:253], v[212:215], v10
    v_smfmac_f32_16x16x32_bf16 v[180:183], v[252:253], v[212:215], v10 abid:2
    s_setpc_b64 s[76:77]
    v_smfmac_f32_16x16x32_bf16 v[148:151], v[252:253], v[212:215], v10
    v_smfmac_f32_16x16x32_bf16 v[184:187], v[252:253], v[212:215], v10 abid:2
    s_setpc_b64 s[76:77]
    v_smfmac_f32_16x16x32_bf16 v[152:155], v[252:253], v[212:215], v10
    v_smfmac_f32_16x16x32_bf16 v[188:191], v[252:253], v[212:215], v10 abid:2
    s_setpc_b64 s[76:77]
    v_smfmac_f32_16x16x32_bf16 v[156:159], v[252:253], v[212:215], v10
    v_smfmac_f32_16x16x32_bf16 v[192:195], v[252:253], v[212:215], v10 abid:2
    s_setpc_b64 s[76:77]
M_ovl1:
    v_smfmac_f32_16x16x32_bf16 v[124:127], v[252:253], v[212:215], v10
    v_smfmac_f32_16x16x32_bf16 v[160:163], v[252:253], v[212:215], v10 abid:2
    s_setpc_b64 s[78:79]
    v_smfmac_f32_16x16x32_bf16 v[128:131], v[252:253], v[212:215], v10
    v_smfmac_f32_16x16x32_bf16 v[164:167], v[252:253], v[212:215], v10 abid:2
    s_setpc_b64 s[78:79]
    v_smfmac_f32_16x16x32_bf16 v[132:135], v[252:253], v[212:215], v10
    v_smfmac_f32_16x16x32_bf16 v[168:171], v[252:253], v[212:215], v10 abid:2
    s_setpc_b64 s[78:79]
    v_smfmac_f32_16x16x32_bf16 v[136:139], v[252:253], v[212:215], v10
    v_smfmac_f32_16x16x32_bf16 v[172:175], v[252:253], v[212:215], v10 abid:2
    s_setpc_b64 s[78:79]
    v_smfmac_f32_16x16x32_bf16 v[140:143], v[252:253], v[212:215], v10
    v_smfmac_f32_16x16x32_bf16 v[176:179], v[252:253], v[212:215], v10 abid:2
    s_setpc_b64 s[78:79]
    v_smfmac_f32_16x16x32_bf16 v[144:147], v[252:253], v[212:215], v10
    v_smfmac_f32_16x16x32_bf16 v[180:183], v[252:253], v[212:215], v10 abid:2
    s_setpc_b64 s[78:79]
    v_smfmac_f32_16x16x32_bf16 v[148:151], v[252:253], v[212:215], v10
    v_smfmac_f32_16x16x32_bf16 v[184:187], v[252:253], v[212:215], v10 abid:2
    s_setpc_b64 s[78:79]
    v_smfmac_f32_16x16x32_bf16 v[152:155], v[252:253], v[212:215], v10
    v_smfmac_f32_16x16x32_bf16 v[188:191], v[252:253], v[212:215], v10 abid:2
    s_setpc_b64 s[78:79]
    v_smfmac_f32_16x16x32_bf16 v[156:159], v[252:253], v[212:215], v10
    v_smfmac_f32_16x16x32_bf16 v[192:195], v[252:253], v[212:215], v10 abid:2
    s_setpc_b64 s[78:79]
M_ovl2:
    v_smfmac_f32_16x16x32_bf16 v[124:127], v[254:255], v[212:215], v10
    v_smfmac_f32_16x16x32_bf16 v[160:163], v[254:255], v[212:215], v10 abid:2
    s_setpc_b64 s[78:79]
    v_smfmac_f32_16x16x32_bf16 v[128:131], v[254:255], v[212:215], v10
    v_smfmac_f32_16x16x32_bf16 v[164:167], v[254:255], v[212:215], v10 abid:2
    s_setpc_b64 s[78:79]
    v_smfmac_f32_16x16x32_bf16 v[132:135], v[254:255], v[212:215], v10
    v_smfmac_f32_16x16x32_bf16 v[168:171], v[254:255], v[212:215], v10 abid:2
    s_setpc_b64 s[78:79]
    v_smfmac_f32_16x16x32_bf16 v[136:139], v[254:255], v[212:215], v10
    v_smfmac_f32_16x16x32_bf16 v[172:175], v[254:255], v[212:215], v10 abid:2
    s_setpc_b64 s[78:79]
    v_smfmac_f32_16x16x32_bf16 v[140:143], v[254:255], v[212:215], v10
    v_smfmac_f32_16x16x32_bf16 v[176:179], v[254:255], v[212:215], v10 abid:2
    s_setpc_b64 s[78:79]
    v_smfmac_f32_16x16x32_bf16 v[144:147], v[254:255], v[212:215], v10
    v_smfmac_f32_16x16x32_bf16 v[180:183], v[254:255], v[212:215], v10 abid:2
    s_setpc_b64 s[78:79]
    v_smfmac_f32_16x16x32_bf16 v[148:151], v[254:255], v[212:215], v10
    v_smfmac_f32_16x16x32_bf16 v[184:187], v[254:255], v[212:215], v10 abid:2
    s_setpc_b64 s[78:79]
    v_smfmac_f32_16x16x32_bf16 v[152:155], v[254:255], v[212:215], v10
    v_smfmac_f32_16x16x32_bf16 v[188:191], v[254:255], v[212:215], v10 abid:2
    s_setpc_b64 s[78:79]
    v_smfmac_f32_16x16x32_bf16 v[156:159], v[254:255], v[212:215], v10
    v_smfmac_f32_16x16x32_bf16 v[192:195], v[254:255], v[212:215], v10 abid:2
    s_setpc_b64 s[78:79]
M_ovn:
    s_setpc_b64 s[78:79]
M_slow:
    s_bitcmp1_b32 s46, 31
    s_cbranch_scc1 M_dense
    s_mov_b32 s56, s80
M_sl:
    s_lshl_b32 s57, s56, 6
    v_add_u32 v240, s57, v9
    ds_read_b128 v[248:251], v240 offset:9792
    s_waitcnt lgkmcnt(0)
    v_and_b32 v240, 0x3fff, v248
    v_and_b32 v241, 0x3fff, v250
    v_xad_u32 v240, v240, v3, v4
    v_xad_u32 v241, v241, v3, v4
    ds_read2st64_b32 v[244:245], v240 offset0:0 offset1:72
    ds_read2st64_b32 v[246:247], v241 offset0:0 offset1:72
    v_subrev_u32 v240, s29, v8
    v_bfe_u32 v240, v240, 4, 4
    s_waitcnt lgkmcnt(0)
    s_bitcmp1_b32 s27, 0
    s_cbranch_scc0 M_sle0
    v_lshrrev_b32 v242, 18, v248
    v_lshrrev_b32 v243, 18, v250
    v_or_b32 v241, 0, v240
    v_cmp_eq_u32 s[44:45], v242, v241
    v_cmp_eq_u32 s[54:55], v243, v241
    s_nop 0
    v_cndmask_b32 v242, 0, v249, s[44:45]
    v_cndmask_b32 v243, 0, v251, s[54:55]
    s_nop 1
    v_smfmac_f32_16x16x32_bf16 v[124:127], v[242:243], v[244:247], v10
    v_smfmac_f32_16x16x32_bf16 v[160:163], v[242:243], v[244:247], v10 abid:2
M_sle0:
    s_bitcmp1_b32 s27, 1
    s_cbranch_scc0 M_sle1
    v_lshrrev_b32 v242, 18, v248
    v_lshrrev_b32 v243, 18, v250
    v_or_b32 v241, 64, v240
    v_cmp_eq_u32 s[44:45], v242, v241
    v_cmp_eq_u32 s[54:55], v243, v241
    s_nop 0
    v_cndmask_b32 v242, 0, v249, s[44:45]
    v_cndmask_b32 v243, 0, v251, s[54:55]
    s_nop 1
    v_smfmac_f32_16x16x32_bf16 v[128:131], v[242:243], v[244:247], v10
    v_smfmac_f32_16x16x32_bf16 v[164:167], v[242:243], v[244:247], v10 abid:2
M_sle1:
    s_bitcmp1_b32 s27, 2
    s_cbranch_scc0 M_sle2
    v_lshrrev_b32 v242, 18, v248
    v_lshrrev_b32 v243, 18, v250
    v_or_b32 v241, 128, v240
    v_cmp_eq_u32 s[44:45], v242, v241
    v_cmp_eq_u32 s[54:55], v243, v241
    s_nop 0
    v_cndmask_b32 v242, 0, v249, s[44:45]
    v_cndmask_b32 v243, 0, v251, s[54:55]
    s_nop 1
    v_smfmac_f32_16x16x32_bf16 v[132:135], v[242:243], v[244:247], v10
    v_smfmac_f32_16x16x32_bf16 v[168:171], v[242:243], v[244:247], v10 abid:2
M_sle2:
    s_bitcmp1_b32 s27, 3
    s_cbranch_scc0 M_sle3
    v_lshrrev_b32 v242, 18, v248
    v_lshrrev_b32 v243, 18, v250
    v_or_b32 v241, 192, v240
    v_cmp_eq_u32 s[44:45], v242, v241
    v_cmp_eq_u32 s[54:55], v243, v241
    s_nop 0
    v_cndmask_b32 v242, 0, v249, s[44:45]
    v_cndmask_b32 v243, 0, v251, s[54:55]
    s_nop 1
    v_smfmac_f32_16x16x32_bf16 v[136:139], v[242:243], v[244:247], v10
    v_smfmac_f32_16x16x32_bf16 v[172:175], v[242:243], v[244:247], v10 abid:2
M_sle3:
    s_bitcmp1_b32 s27, 4
    s_cbranch_scc0 M_sle4
    v_lshrrev_b32 v242, 18, v248
    v_lshrrev_b32 v243, 18, v250
    v_or_b32 v241, 256, v240
    v_cmp_eq_u32 s[44:45], v242, v241
    v_cmp_eq_u32 s[54:55], v243, v241
    s_nop 0
    v_cndmask_b32 v242, 0, v249, s[44:45]
    v_cndmask_b32 v243, 0, v251, s[54:55]
    s_nop 1
    v_smfmac_f32_16x16x32_bf16 v[140:143], v[242:243], v[244:247], v10
    v_smfmac_f32_16x16x32_bf16 v[176:179], v[242:243], v[244:247], v10 abid:2
M_sle4:
    s_bitcmp1_b32 s27, 5
    s_cbranch_scc0 M_sle5
    v_lshrrev_b32 v242, 18, v248
    v_lshrrev_b32 v243, 18, v250
    v_or_b32 v241, 320, v240
    v_cmp_eq_u32 s[44:45], v242, v241
    v_cmp_eq_u32 s[54:55], v243, v241
    s_nop 0
    v_cndmask_b32 v242, 0, v249, s[44:45]
    v_cndmask_b32 v243, 0, v251, s[54:55]
    s_nop 1
    v_smfmac_f32_16x16x32_bf16 v[144:147], v[242:243], v[244:247], v10
    v_smfmac_f32_16x16x32_bf16 v[180:183], v[242:243], v[244:247], v10 abid:2
M_sle5:
    s_bitcmp1_b32 s27, 6
    s_cbranch_scc0 M_sle6
    v_lshrrev_b32 v242, 18, v248
    v_lshrrev_b32 v243, 18, v250
    v_or_b32 v241, 384, v240
    v_cmp_eq_u32 s[44:45], v242, v241
    v_cmp_eq_u32 s[54:55], v243, v241
    s_nop 0
    v_cndmask_b32 v242, 0, v249, s[44:45]
    v_cndmask_b32 v243, 0, v251, s[54:55]
    s_nop 1
    v_smfmac_f32_16x16x32_bf16 v[148:151], v[242:243], v[244:247], v10
    v_smfmac_f32_16x16x32_bf16 v[184:187], v[242:243], v[244:247], v10 abid:2
M_sle6:
    s_bitcmp1_b32 s27, 7
    s_cbranch_scc0 M_sle7
    v_lshrrev_b32 v242, 18, v248
    v_lshrrev_b32 v243, 18, v250
    v_or_b32 v241, 448, v240
    v_cmp_eq_u32 s[44:45], v242, v241
    v_cmp_eq_u32 s[54:55], v243, v241
    s_nop 0
    v_cndmask_b32 v242, 0, v249, s[44:45]
    v_cndmask_b32 v243, 0, v251, s[54:55]
    s_nop 1
    v_smfmac_f32_16x16x32_bf16 v[152:155], v[242:243], v[244:247], v10
    v_smfmac_f32_16x16x32_bf16 v[188:191], v[242:243], v[244:247], v10 abid:2
M_sle7:
    s_bitcmp1_b32 s27, 8
    s_cbranch_scc0 M_sle8
    v_lshrrev_b32 v242, 18, v248
    v_lshrrev_b32 v243, 18, v250
    v_or_b32 v241, 512, v240
    v_cmp_eq_u32 s[44:45], v242, v241
    v_cmp_eq_u32 s[54:55], v243, v241
    s_nop 0
    v_cndmask_b32 v242, 0, v249, s[44:45]
    v_cndmask_b32 v243, 0, v251, s[54:55]
    s_nop 1
    v_smfmac_f32_16x16x32_bf16 v[156:159], v[242:243], v[244:247], v10
    v_smfmac_f32_16x16x32_bf16 v[192:195], v[242:243], v[244:247], v10 abid:2
M_sle8:
    s_add_u32 s56, s56, 1
    s_cmp_lt_u32 s56, s46
    s_cbranch_scc1 M_sl
M_slx:
    s_nop 7
    s_cmp_eq_u32 s21, 1
    s_cbranch_scc1 M_slowrL
    s_cmp_eq_u32 s21, 2
    s_cbranch_scc1 M_slowrE0
    s_cmp_eq_u32 s21, 3
    s_cbranch_scc1 M_slowrF
    s_branch M_slowr0
M_dense:
    s_mul_i32 s57, s20, 82944
    s_add_u32 s57, s57, 393216
    s_mov_b32 s56, 0
    v_mov_b32 v54, v1
    v_mov_b32 v55, v2
    v_subrev_u32 v252, s29, v8
M_dn0:
    ds_read_b128 v[244:247], v54 offset:0
    ds_read_b128 v[248:251], v55 offset:0
    v_add_u32 v54, 1024, v54
    v_add_u32 v55, 1024, v55
    buffer_load_dwordx4 v[240:243], v252, s[16:19], s57 offen sc1
    s_add_u32 s57, s57, 1024
    s_waitcnt vmcnt(0) lgkmcnt(0)
    v_smfmac_f32_16x16x64_bf16 v[124:127], v[240:243], v[244:251], v10
    buffer_load_dwordx4 v[240:243], v252, s[16:19], s57 offen sc1
    s_add_u32 s57, s57, 1024
    s_waitcnt vmcnt(0) lgkmcnt(0)
    v_smfmac_f32_16x16x64_bf16 v[128:131], v[240:243], v[244:251], v10
    buffer_load_dwordx4 v[240:243], v252, s[16:19], s57 offen sc1
    s_add_u32 s57, s57, 1024
    s_waitcnt vmcnt(0) lgkmcnt(0)
    v_smfmac_f32_16x16x64_bf16 v[132:135], v[240:243], v[244:251], v10
    buffer_load_dwordx4 v[240:243], v252, s[16:19], s57 offen sc1
    s_add_u32 s57, s57, 1024
    s_waitcnt vmcnt(0) lgkmcnt(0)
    v_smfmac_f32_16x16x64_bf16 v[136:139], v[240:243], v[244:251], v10
    buffer_load_dwordx4 v[240:243], v252, s[16:19], s57 offen sc1
    s_add_u32 s57, s57, 1024
    s_waitcnt vmcnt(0) lgkmcnt(0)
    v_smfmac_f32_16x16x64_bf16 v[140:143], v[240:243], v[244:251], v10
    buffer_load_dwordx4 v[240:243], v252, s[16:19], s57 offen sc1
    s_add_u32 s57, s57, 1024
    s_waitcnt vmcnt(0) lgkmcnt(0)
    v_smfmac_f32_16x16x64_bf16 v[144:147], v[240:243], v[244:251], v10
    buffer_load_dwordx4 v[240:243], v252, s[16:19], s57 offen sc1
    s_add_u32 s57, s57, 1024
    s_waitcnt vmcnt(0) lgkmcnt(0)
    v_smfmac_f32_16x16x64_bf16 v[148:151], v[240:243], v[244:251], v10
    buffer_load_dwordx4 v[240:243], v252, s[16:19], s57 offen sc1
    s_add_u32 s57, s57, 1024
    s_waitcnt vmcnt(0) lgkmcnt(0)
    v_smfmac_f32_16x16x64_bf16 v[152:155], v[240:243], v[244:251], v10
    buffer_load_dwordx4 v[240:243], v252, s[16:19], s57 offen sc1
    s_add_u32 s57, s57, 1024
    s_waitcnt vmcnt(0) lgkmcnt(0)
    v_smfmac_f32_16x16x64_bf16 v[156:159], v[240:243], v[244:251], v10
    s_add_u32 s56, s56, 1
    s_cmp_lt_u32 s56, 9
    s_cbranch_scc1 M_dn0
    s_mul_i32 s57, s20, 82944
    s_add_u32 s57, s57, 393216
    s_mov_b32 s56, 0
    v_mov_b32 v54, v1
    v_mov_b32 v55, v2
    v_subrev_u32 v252, s29, v8
M_dn1:
    ds_read_b128 v[244:247], v54 offset:18432
    ds_read_b128 v[248:251], v55 offset:18432
    v_add_u32 v54, 1024, v54
    v_add_u32 v55, 1024, v55
    buffer_load_dwordx4 v[240:243], v252, s[16:19], s57 offen sc1
    s_add_u32 s57, s57, 1024
    s_waitcnt vmcnt(0) lgkmcnt(0)
    v_smfmac_f32_16x16x64_bf16 v[160:163], v[240:243], v[244:251], v10
    buffer_load_dwordx4 v[240:243], v252, s[16:19], s57 offen sc1
    s_add_u32 s57, s57, 1024
    s_waitcnt vmcnt(0) lgkmcnt(0)
    v_smfmac_f32_16x16x64_bf16 v[164:167], v[240:243], v[244:251], v10
    buffer_load_dwordx4 v[240:243], v252, s[16:19], s57 offen sc1
    s_add_u32 s57, s57, 1024
    s_waitcnt vmcnt(0) lgkmcnt(0)
    v_smfmac_f32_16x16x64_bf16 v[168:171], v[240:243], v[244:251], v10
    buffer_load_dwordx4 v[240:243], v252, s[16:19], s57 offen sc1
    s_add_u32 s57, s57, 1024
    s_waitcnt vmcnt(0) lgkmcnt(0)
    v_smfmac_f32_16x16x64_bf16 v[172:175], v[240:243], v[244:251], v10
    buffer_load_dwordx4 v[240:243], v252, s[16:19], s57 offen sc1
    s_add_u32 s57, s57, 1024
    s_waitcnt vmcnt(0) lgkmcnt(0)
    v_smfmac_f32_16x16x64_bf16 v[176:179], v[240:243], v[244:251], v10
    buffer_load_dwordx4 v[240:243], v252, s[16:19], s57 offen sc1
    s_add_u32 s57, s57, 1024
    s_waitcnt vmcnt(0) lgkmcnt(0)
    v_smfmac_f32_16x16x64_bf16 v[180:183], v[240:243], v[244:251], v10
    buffer_load_dwordx4 v[240:243], v252, s[16:19], s57 offen sc1
    s_add_u32 s57, s57, 1024
    s_waitcnt vmcnt(0) lgkmcnt(0)
    v_smfmac_f32_16x16x64_bf16 v[184:187], v[240:243], v[244:251], v10
    buffer_load_dwordx4 v[240:243], v252, s[16:19], s57 offen sc1
    s_add_u32 s57, s57, 1024
    s_waitcnt vmcnt(0) lgkmcnt(0)
    v_smfmac_f32_16x16x64_bf16 v[188:191], v[240:243], v[244:251], v10
    buffer_load_dwordx4 v[240:243], v252, s[16:19], s57 offen sc1
    s_add_u32 s57, s57, 1024
    s_waitcnt vmcnt(0) lgkmcnt(0)
    v_smfmac_f32_16x16x64_bf16 v[192:195], v[240:243], v[244:251], v10
    s_add_u32 s56, s56, 1
    s_cmp_lt_u32 s56, 9
    s_cbranch_scc1 M_dn1
    s_branch M_slx
M_codeend:
.section .rodata,"a"
.p2align 6
.amdhsa_kernel standalone__structured_sparse_n_m__ragged_kernel
  .amdhsa_next_free_vgpr 512
  .amdhsa_next_free_sgpr 102
  .amdhsa_accum_offset 256
  .amdhsa_group_segment_fixed_size 0
  .amdhsa_kernarg_size 48
  .amdhsa_user_sgpr_count 2
  .amdhsa_user_sgpr_kernarg_segment_ptr 1
  .amdhsa_system_sgpr_workgroup_id_x 1
  .amdhsa_float_denorm_mode_32 3
.end_amdhsa_kernel
```

```asm
; @launch grid=(256,1,1) block=(256,1,1) lds=162064
.amdgcn_target "amdgcn-amd-amdhsa--gfx950"
.text
.globl standalone__structured_sparse_n_m__ragged_kernel
.p2align 8
.type standalone__structured_sparse_n_m__ragged_kernel,@function
standalone__structured_sparse_n_m__ragged_kernel:
    s_cmp_ge_u32 s2, 256
    s_cbranch_scc1 M_end
    s_load_dwordx8 s[72:79], s[0:1], 0
    s_load_dwordx4 s[80:83], s[0:1], 32
    s_getpc_b64 s[84:85]
    s_lshr_b32 s30, s2, 3
    s_and_b32 s30, s30, 15
    s_lshl_b32 s30, s30, 11
    s_and_b32 s84, s84, 0xffffff00
    s_cmp_ge_u32 s2, 88
    s_cselect_b32 s86, M_codeend-standalone__structured_sparse_n_m__ragged_kernel, 0
    s_mov_b32 s87, 0x20000
    v_lshlrev_b32 v254, 3, v0
    s_mov_b32 exec_lo, 0x00010001
    s_mov_b32 exec_hi, 0x00010001
    buffer_load_dword v254, v254, s[84:87], s30 offen
    s_mov_b64 exec, -1
    v_lshrrev_b32 v20, 6, v0
    v_and_b32 v12, 63, v0
    v_readfirstlane_b32 s20, v20
    v_lshrrev_b32 v22, 3, v0
    v_mul_u32_u24 v22, 1152, v22
    v_lshrrev_b32 v23, 4, v0
    v_xor_b32 v23, v23, v0
    v_and_b32 v23, 7, v23
    v_lshl_add_u32 v5, v23, 4, v22
    v_lshrrev_b32 v13, 4, v12
    v_and_b32 v14, 15, v12
    v_lshlrev_b32 v11, 4, v12
    v_lshlrev_b32 v54, 3, v12
    v_lshlrev_b32 v25, 4, v13
    v_lshlrev_b32 v26, 3, v13
    s_mov_b32 s6, 663552
    s_mov_b32 s7, 0x20000
    s_mov_b32 s10, 75497472
    s_mov_b32 s11, s7
    s_mov_b32 s18, 742400
    s_mov_b32 s19, s7
    s_movk_i32 s70, 256
    s_mov_b32 s71, s7
    s_movk_i32 s86, 1152
    s_mov_b32 s87, s7
    s_mov_b32 s98, 0
    s_mul_i32 s96, s20, 16
    s_and_b32 s97, s2, 15
    s_add_u32 s96, s96, s97
    s_lshl_b32 s96, s96, 8
    s_add_u32 s96, s96, 726016
    s_mul_i32 s22, s2, 36864
    s_mul_i32 s26, s20, 9216
    s_mov_b32 s24, s22
    s_mov_b32 s42, s26
    s_lshl_b32 s28, s20, 8
    s_lshl_b32 s29, s20, 5
    s_cmp_lt_u32 s2, 81
    s_cbranch_scc0 M_x1
    s_mul_i32 s32, s2, 57
    s_lshr_b32 s32, s32, 9
    s_mul_i32 s33, s32, 9
    s_sub_u32 s33, s2, s33
    s_mul_i32 s54, s32, 73728
    s_lshl_b32 s35, s33, 7
    s_add_u32 s54, s54, s35
    s_add_u32 s55, s54, 36864
    s_lshl_b32 s36, s20, 10
    s_add_u32 m0, s36, 73728
    s_lshr_b32 s30, s33, 1
    s_and_b32 s31, s33, 1
    s_lshl1_add_u32 s37, s32, s31
    s_mul_i32 s37, s37, 176
    s_mul_i32 s38, s32, 96
    s_add_u32 s38, s38, 3168
    s_cmp_lt_u32 s33, 8
    s_cselect_b32 s30, s30, s20
    s_cselect_b32 s37, s37, s38
    s_cselect_b32 s44, 2047, 63
    s_cselect_b32 s45, s20, 3
    s_cmp_eq_u32 s45, 3
    s_cselect_b32 s99, 742400, 0
    s_mul_i32 s48, s30, 98304
    s_add_u32 s37, s37, s48
    v_mov_b32 v44, 2.0
    v_mov_b32 v45, 0
    v_mov_b32 v46, 2.0
    v_mov_b32 v47, 0
    s_waitcnt lgkmcnt(0)
    s_mov_b64 s[4:5], s[74:75]
    buffer_load_dwordx4 v5, s[4:7], s54 offen lds
    s_add_u32 m0, m0, 4096
    s_mov_b32 s45, 0
    buffer_load_dwordx4 v5, s[4:7], s55 offen lds
    s_mov_b64 s[16:17], s[82:83]
    s_mov_b64 s[8:9], s[72:73]
    s_mov_b64 s[84:85], s[76:77]
    s_mov_b64 s[68:69], s[80:81]
    v_mov_b32 v10, 0
    s_mov_b64 exec, 1
    buffer_atomic_add v10, off, s[16:19], s96 sc0 sc1
    s_mov_b64 exec, -1
    s_mov_b64 exec, s[44:45]
    s_mov_b32 s18, s99
    buffer_store_dwordx4 v[44:47], v11, s[16:19], s37 offen sc1
    s_mov_b32 s18, 742400
    s_mov_b64 exec, -1
    buffer_load_dwordx4 v[196:199], v25, s[84:87], s28 offen offset:0
    buffer_load_dwordx4 v[200:203], v25, s[84:87], s28 offen offset:64
    buffer_load_dwordx4 v[204:207], v25, s[84:87], s28 offen offset:128
    buffer_load_dwordx4 v[208:211], v25, s[84:87], s28 offen offset:192
    buffer_load_dwordx2 v[212:213], v26, s[84:87], s29 offen offset:1024
    s_mov_b32 m0, s42
    s_nop 0
    buffer_load_dwordx4 v5, s[8:11], s22 offen offset:0 nt lds
    s_add_u32 m0, m0, 896
    s_nop 0
    buffer_load_dwordx4 v5, s[8:11], s22 offen offset:128 nt lds
    s_add_u32 m0, m0, 896
    s_nop 0
    buffer_load_dwordx4 v5, s[8:11], s22 offen offset:256 nt lds
    s_add_u32 m0, m0, 896
    s_nop 0
    buffer_load_dwordx4 v5, s[8:11], s22 offen offset:384 nt lds
    s_lshl_b32 s34, s31, 2
    s_add_u32 s34, s34, s20
    s_lshr_b32 s35, s20, 1
    s_lshl_b32 s35, s35, 6
    s_and_b32 s36, s20, 1
    s_lshl_b32 s36, s36, 3
    s_add_u32 s35, s35, s36
    s_lshl_b32 s36, s20, 5
    s_mul_i32 s39, s32, 10240
    s_add_u32 s39, s39, 6144
    s_lshl_b32 s40, s34, 1
    s_add_u32 s40, s40, s39
    s_lshl_b32 s38, s32, 1
    s_cmp_eq_u32 s32, 8
    s_cselect_b32 s38, 1024, s38
    s_add_u32 s38, s38, 4096
    s_cmp_lt_u32 s33, 8
    s_cselect_b32 s34, s34, 8
    s_cselect_b32 s35, s35, s36
    s_cselect_b32 s36, 4, 3
    s_cselect_b32 s40, s40, s38
    s_cselect_b32 s46, 0, s20
    s_cselect_b32 s47, 22, 12
    s_add_u32 s40, s40, s48
    s_lshl_b32 s38, s34, 10
    s_add_u32 s39, s39, s38
    s_add_u32 s39, s39, s48
    s_add_u32 s39, s39, 1024
    v_and_b32 v15, 3, v14
    v_lshlrev_b32 v15, s36, v15
    v_add_u32 v15, s35, v15
    v_lshrrev_b32 v16, 3, v14
    v_lshlrev_b32 v16, 4, v16
    v_xor_b32 v15, v15, v16
    v_lshrrev_b32 v16, 2, v14
    v_lshl_add_u32 v16, v13, 4, v16
    v_lshl_add_u32 v15, v16, 7, v15
    v_add_u32 v24, 73728, v15
    v_xor_b32 v27, 32, v24
    v_xor_b32 v28, 64, v24
    v_xor_b32 v29, 0x60, v24
    s_lshl_b32 s31, s46, 2
    s_add_u32 s31, s31, 81920
    v_mov_b32 v60, s31
    v_mov_b32 v61, 1
    ds_write_b32 v60, v61
    s_mul_i32 s49, s30, 81
    s_mul_i32 s31, s32, 9
    s_add_u32 s49, s49, s31
    s_add_u32 s49, s49, s34
    s_lshl_b32 s49, s49, 10
    s_add_u32 s49, s49, 393216
    s_lshl_b32 s31, s34, 24
    s_lshl_b32 s38, s32, 10
    s_add_u32 s31, s31, s38
    v_lshlrev_b32 v31, 18, v14
    v_lshl_add_u32 v31, v13, 5, v31
    v_add_u32 v31, s31, v31
    s_mov_b32 s50, 3437096686
    s_mov_b32 s51, 1150609561
    s_mov_b32 s52, 0x00010001
    s_mov_b32 s53, 0x00200010
    s_mov_b32 s38, 0x0202
    s_mul_i32 s57, s30, 4096
    s_add_u32 s57, s57, 726016
    s_cmp_eq_u32 s33, 8
    s_cselect_b32 s56, 0, s20
    s_cmp_eq_u32 s20, 0
    s_cselect_b32 s98, 1, 0
    v_add_u32 v74, 81984, v54
    v_lshl_add_u32 v73, s20, 1, v74
    v_mov_b32 v41, 0x01000100
    v_mov_b32 v40, 0
    v_mov_b32 v63, -2.0
    s_waitcnt vmcnt(11) lgkmcnt(0)
    s_barrier
    ds_read_b64_tr_b16 v[16:17], v24
    ds_read_b64_tr_b16 v[18:19], v27 offset:512
    ds_read_b64_tr_b16 v[20:21], v28 offset:1024
    ds_read_b64_tr_b16 v[22:23], v29 offset:1536
    s_waitcnt lgkmcnt(3)
    v_and_b32 v44, 0x7fff7fff, v16
    v_and_b32 v45, 0x7fff7fff, v17
    v_pk_max_u16 v46, v44, v45
    v_pk_min_u16 v47, v44, v45
    v_pk_min_u16 v46, v46, v46 op_sel:[0,1] op_sel_hi:[1,0]
    v_pk_max_u16 v47, v47, v47 op_sel:[0,1] op_sel_hi:[1,0]
    v_pk_max_u16 v46, v46, s52
    v_pk_max_u16 v46, v46, v47
    v_pk_sub_i16 v44, v44, v46
    v_pk_sub_i16 v45, v45, v46
    v_pk_ashrrev_i16 v44, 15, v44 op_sel_hi:[0,1]
    v_pk_ashrrev_i16 v45, 15, v45 op_sel_hi:[0,1]
    v_alignbit_b32 v47, -1, v44, 16
    v_alignbit_b32 v46, v45, v45, 16
    v_and_b32 v48, 0x00080004, v44
    v_bitop3_b32 v46, v45, v46, v47 bitop3:0xe8
    v_and_or_b32 v64, v45, s53, v48
    v_bitop3_b32 v36, v16, v44, v46 bitop3:0x10
    v_min_u32 v68, 1, v36
    s_waitcnt lgkmcnt(2)
    v_and_b32 v44, 0x7fff7fff, v18
    v_and_b32 v45, 0x7fff7fff, v19
    v_pk_max_u16 v46, v44, v45
    v_pk_min_u16 v47, v44, v45
    v_pk_min_u16 v46, v46, v46 op_sel:[0,1] op_sel_hi:[1,0]
    v_pk_max_u16 v47, v47, v47 op_sel:[0,1] op_sel_hi:[1,0]
    v_pk_max_u16 v46, v46, s52
    v_pk_max_u16 v46, v46, v47
    v_pk_sub_i16 v44, v44, v46
    v_pk_sub_i16 v45, v45, v46
    v_pk_ashrrev_i16 v44, 15, v44 op_sel_hi:[0,1]
    v_pk_ashrrev_i16 v45, 15, v45 op_sel_hi:[0,1]
    v_alignbit_b32 v47, -1, v44, 16
    v_alignbit_b32 v46, v45, v45, 16
    v_and_b32 v48, 0x00080004, v44
    v_bitop3_b32 v46, v45, v46, v47 bitop3:0xe8
    v_and_or_b32 v65, v45, s53, v48
    v_bitop3_b32 v37, v18, v44, v46 bitop3:0x10
    v_min_u32 v69, 1, v37
    s_waitcnt lgkmcnt(1)
    v_and_b32 v44, 0x7fff7fff, v20
    v_and_b32 v45, 0x7fff7fff, v21
    v_pk_max_u16 v46, v44, v45
    v_pk_min_u16 v47, v44, v45
    v_pk_min_u16 v46, v46, v46 op_sel:[0,1] op_sel_hi:[1,0]
    v_pk_max_u16 v47, v47, v47 op_sel:[0,1] op_sel_hi:[1,0]
    v_pk_max_u16 v46, v46, s52
    v_pk_max_u16 v46, v46, v47
    v_pk_sub_i16 v44, v44, v46
    v_pk_sub_i16 v45, v45, v46
    v_pk_ashrrev_i16 v44, 15, v44 op_sel_hi:[0,1]
    v_pk_ashrrev_i16 v45, 15, v45 op_sel_hi:[0,1]
    v_alignbit_b32 v47, -1, v44, 16
    v_alignbit_b32 v46, v45, v45, 16
    v_and_b32 v48, 0x00080004, v44
    v_bitop3_b32 v46, v45, v46, v47 bitop3:0xe8
    v_and_or_b32 v66, v45, s53, v48
    v_bitop3_b32 v38, v20, v44, v46 bitop3:0x10
    v_min_u32 v70, 1, v38
    s_waitcnt lgkmcnt(0)
    v_and_b32 v44, 0x7fff7fff, v22
    v_and_b32 v45, 0x7fff7fff, v23
    v_pk_max_u16 v46, v44, v45
    v_pk_min_u16 v47, v44, v45
    v_pk_min_u16 v46, v46, v46 op_sel:[0,1] op_sel_hi:[1,0]
    v_pk_max_u16 v47, v47, v47 op_sel:[0,1] op_sel_hi:[1,0]
    v_pk_max_u16 v46, v46, s52
    v_pk_max_u16 v46, v46, v47
    v_pk_sub_i16 v44, v44, v46
    v_pk_sub_i16 v45, v45, v46
    v_pk_ashrrev_i16 v44, 15, v44 op_sel_hi:[0,1]
    v_pk_ashrrev_i16 v45, 15, v45 op_sel_hi:[0,1]
    v_alignbit_b32 v47, -1, v44, 16
    v_alignbit_b32 v46, v45, v45, 16
    v_and_b32 v48, 0x00080004, v44
    v_bitop3_b32 v46, v45, v46, v47 bitop3:0xe8
    v_and_or_b32 v67, v45, s53, v48
    v_bitop3_b32 v39, v22, v44, v46 bitop3:0x10
    v_min_u32 v71, 1, v39
    v_add_u32 v72, v68, v69
    v_add3_u32 v72, v72, v70, v71
    buffer_store_dwordx4 v[36:39], v11, s[16:19], s49 offen sc1
    v_cmp_ne_u32 vcc, 0, v72
    s_and_saveexec_b64 s[44:45], vcc
    ds_add_rtn_u32 v62, v60, v72
    s_mov_b64 exec, -1
    v_lshrrev_b32 v48, 16, v64
    v_or_b32 v48, v48, v64
    v_lshrrev_b64 v[52:53], v48, s[50:51]
    v_and_b32 v64, 15, v52
    v_lshl_or_b32 v40, v64, 0, v40
    v_lshrrev_b32 v48, 16, v65
    v_or_b32 v48, v48, v65
    v_lshrrev_b64 v[52:53], v48, s[50:51]
    v_and_b32 v65, 15, v52
    v_lshl_or_b32 v40, v65, 4, v40
    v_lshrrev_b32 v48, 16, v66
    v_or_b32 v48, v48, v66
    v_lshrrev_b64 v[52:53], v48, s[50:51]
    v_and_b32 v66, 15, v52
    v_lshl_or_b32 v40, v66, 8, v40
    v_lshrrev_b32 v48, 16, v67
    v_or_b32 v48, v48, v67
    v_lshrrev_b64 v[52:53], v48, s[50:51]
    v_and_b32 v67, 15, v52
    v_lshl_or_b32 v40, v67, 12, v40
    v_lshrrev_b32 v44, 2, v40
    v_lshlrev_b32 v45, 2, v40
    s_movk_i32 s31, 0x3333
    v_not_b32 v47, v40
    v_bfi_b32 v44, s31, v44, v45
    s_movk_i32 s31, 0x1111
    s_nop 0
    v_mov_b32_dpp v47, v44 row_shr:4 row_mask:0xf bank_mask:0xf
    v_xor_b32 v47, v47, v40
    v_lshrrev_b32 v45, 1, v47
    v_or_b32 v47, v47, v45
    v_lshrrev_b32 v45, 2, v47
    v_bitop3_b32 v47, v47, v45, s31 bitop3:0x2a
    s_nop 1
    v_xor_b32_dpp v47, v47, v47 row_shr:4 row_mask:0xf bank_mask:0xe
    s_nop 1
    v_xor_b32_dpp v47, v47, v47 row_shr:8 row_mask:0xf bank_mask:0xc
    v_mul_u32_u24 v47, 15, v47
    v_bfi_b32 v40, v47, v44, v40
    ds_write_b16 v73, v40
    v_bfe_u32 v64, v40, 0, 4
    v_mul_u32_u24 v46, 0x4001, v64
    v_and_b32 v46, 0x30003, v46
    v_mad_u32_u24 v46, v46, s38, v41
    v_perm_b32 v32, v17, v16, v46
    v_bfe_u32 v65, v40, 4, 4
    v_mul_u32_u24 v46, 0x4001, v65
    v_and_b32 v46, 0x30003, v46
    v_mad_u32_u24 v46, v46, s38, v41
    v_perm_b32 v33, v19, v18, v46
    s_waitcnt vmcnt(10) lgkmcnt(0)
    s_barrier
    ds_read_b64 v[50:51], v74
    v_bfe_u32 v66, v40, 8, 4
    v_mul_u32_u24 v46, 0x4001, v66
    v_and_b32 v46, 0x30003, v46
    v_mad_u32_u24 v46, v46, s38, v41
    v_perm_b32 v34, v21, v20, v46
    v_bfe_u32 v67, v40, 12, 4
    v_mul_u32_u24 v46, 0x4001, v67
    v_and_b32 v46, 0x30003, v46
    v_mad_u32_u24 v46, v46, s38, v41
    v_perm_b32 v35, v23, v22, v46
    buffer_store_dwordx4 v[32:35], v11, s[16:19], s39 offen sc1
    s_cmp_eq_u32 s33, 8
    s_cbranch_scc0 F_i1
    buffer_store_short v40, v11, s[16:19], s40 offen sc1
    s_branch F_i2
F_i1:
    s_cmp_eq_u32 s20, 0
    s_cbranch_scc0 F_i2
    s_waitcnt lgkmcnt(0)
    buffer_store_dwordx2 v[50:51], v11, s[16:19], s40 offen sc1
F_i2:
    s_cbranch_vccz F_z
    v_cmp_ne_u32 vcc, 0, v36
    s_and_saveexec_b64 s[44:45], vcc
    s_cbranch_execz F_e0
    v_cmp_gt_u32 vcc, s47, v62
    v_add_u32 v42, 0, v31
    v_lshlrev_b32 v44, 3, v62
    v_add_u32 v62, 1, v62
    v_cndmask_b32 v42, v63, v42, vcc
    v_cndmask_b32 v43, 0, v36, vcc
    v_cndmask_b32 v44, 0, v44, vcc
    buffer_store_dwordx2 v[42:43], v44, s[16:19], s37 offen sc1
F_e0:
    s_mov_b64 exec, -1
    v_cmp_ne_u32 vcc, 0, v37
    s_and_saveexec_b64 s[44:45], vcc
    s_cbranch_execz F_e1
    v_cmp_gt_u32 vcc, s47, v62
    v_add_u32 v42, 8, v31
    v_lshlrev_b32 v44, 3, v62
    v_add_u32 v62, 1, v62
    v_cndmask_b32 v42, v63, v42, vcc
    v_cndmask_b32 v43, 0, v37, vcc
    v_cndmask_b32 v44, 0, v44, vcc
    buffer_store_dwordx2 v[42:43], v44, s[16:19], s37 offen sc1
F_e1:
    s_mov_b64 exec, -1
    v_cmp_ne_u32 vcc, 0, v38
    s_and_saveexec_b64 s[44:45], vcc
    s_cbranch_execz F_e2
    v_cmp_gt_u32 vcc, s47, v62
    v_add_u32 v42, 16, v31
    v_lshlrev_b32 v44, 3, v62
    v_add_u32 v62, 1, v62
    v_cndmask_b32 v42, v63, v42, vcc
    v_cndmask_b32 v43, 0, v38, vcc
    v_cndmask_b32 v44, 0, v44, vcc
    buffer_store_dwordx2 v[42:43], v44, s[16:19], s37 offen sc1
F_e2:
    s_mov_b64 exec, -1
    v_cmp_ne_u32 vcc, 0, v39
    s_and_saveexec_b64 s[44:45], vcc
    s_cbranch_execz F_e3
    v_cmp_gt_u32 vcc, s47, v62
    v_add_u32 v42, 24, v31
    v_lshlrev_b32 v44, 3, v62
    v_add_u32 v62, 1, v62
    v_cndmask_b32 v42, v63, v42, vcc
    v_cndmask_b32 v43, 0, v39, vcc
    v_cndmask_b32 v44, 0, v44, vcc
    buffer_store_dwordx2 v[42:43], v44, s[16:19], s37 offen sc1
F_e3:
    s_mov_b64 exec, -1
F_z:
    s_cmp_lg_u32 s2, 0
    s_cbranch_scc1 M_set
    v_mov_b32 v64, 0
    v_mov_b32 v65, 0
    v_mov_b32 v66, 0
    v_mov_b32 v67, 0
    s_mov_b32 s40, 724992
    buffer_store_dwordx4 v[64:67], v11, s[16:19], s40 offen sc1
    s_branch M_set
F_sig:
    v_lshlrev_b32 v30, 8, v12
    s_waitcnt vmcnt(0)
    s_barrier
    s_cmp_lg_u32 s56, 0
    s_cbranch_scc1 F_end
    s_mov_b64 exec, 65535
    buffer_atomic_add v61, v30, s[16:19], s57 offen sc1
    s_mov_b64 exec, -1
F_end:
    s_add_u32 m0, m0, 896
    s_nop 0
    buffer_load_dwordx4 v5, s[8:11], s22 offen offset:512 nt lds
    s_add_u32 m0, m0, 896
    s_nop 0
    buffer_load_dwordx4 v5, s[8:11], s22 offen offset:640 nt lds
    s_add_u32 m0, m0, 896
    s_nop 0
    buffer_load_dwordx4 v5, s[8:11], s22 offen offset:768 nt lds
    s_branch M_x2
M_x1:
    s_waitcnt lgkmcnt(0)
    s_mov_b64 s[4:5], s[74:75]
    s_mov_b64 s[16:17], s[82:83]
    s_mov_b64 s[8:9], s[72:73]
    s_mov_b64 s[84:85], s[76:77]
    s_mov_b64 s[68:69], s[80:81]
    v_mov_b32 v10, 0
    s_mov_b64 exec, 1
    buffer_atomic_add v10, off, s[16:19], s96 sc0 sc1
    s_mov_b64 exec, -1
    buffer_load_dwordx4 v[196:199], v25, s[84:87], s28 offen offset:0
    buffer_load_dwordx4 v[200:203], v25, s[84:87], s28 offen offset:64
    buffer_load_dwordx4 v[204:207], v25, s[84:87], s28 offen offset:128
    buffer_load_dwordx4 v[208:211], v25, s[84:87], s28 offen offset:192
    buffer_load_dwordx2 v[212:213], v26, s[84:87], s29 offen offset:1024
    s_mov_b32 m0, s42
    s_nop 0
    buffer_load_dwordx4 v5, s[8:11], s22 offen offset:0 nt lds
    s_add_u32 m0, m0, 896
    s_nop 0
    buffer_load_dwordx4 v5, s[8:11], s22 offen offset:128 nt lds
    s_add_u32 m0, m0, 896
    s_nop 0
    buffer_load_dwordx4 v5, s[8:11], s22 offen offset:256 nt lds
    s_add_u32 m0, m0, 896
    s_nop 0
    buffer_load_dwordx4 v5, s[8:11], s22 offen offset:384 nt lds
    s_add_u32 m0, m0, 896
    s_nop 0
    buffer_load_dwordx4 v5, s[8:11], s22 offen offset:512 nt lds
    s_add_u32 m0, m0, 896
    s_nop 0
    buffer_load_dwordx4 v5, s[8:11], s22 offen offset:640 nt lds
    s_add_u32 m0, m0, 896
    s_nop 0
    buffer_load_dwordx4 v5, s[8:11], s22 offen offset:768 nt lds
M_set:
    s_mov_b32 s12, s78
    s_mov_b32 s13, s79
    s_mov_b32 s14, 75497472
    s_mov_b32 s15, 0x20000
    s_mul_i32 s29, s20, 12864
    s_add_u32 s29, s29, 110592
    v_lshrrev_b32 v24, 1, v14
    v_and_b32 v27, 7, v14
    v_lshlrev_b32 v22, 7, v27
    v_lshl_or_b32 v3, v24, 4, v22
    v_lshrrev_b32 v23, 3, v14
    v_mul_u32_u24 v4, 9216, v23
    v_xad_u32 v1, v25, v3, v4
    v_xor_b32 v2, 64, v1
    v_add_u32 v9, s29, v25
    v_add_u32 v8, s29, v11
    v_mul_u32_u24 v24, 1152, v27
    v_lshl_add_u32 v24, v23, 6, v24
    v_add3_u32 v6, v24, v25, s28
    v_lshrrev_b32 v24, 3, v12
    v_xor_b32 v28, v24, v12
    v_and_b32 v28, 7, v28
    v_mul_u32_u24 v24, 1152, v24
    v_lshl_add_u32 v24, v28, 4, v24
    v_add_u32 v7, 1024, v24
    s_lshl_b32 s30, s20, 1
    v_lshrrev_b32 v24, 1, v13
    v_add_u32 v24, s30, v24
    v_xor_b32 v24, v24, v27
    v_lshl_add_u32 v24, v24, 4, v22
    v_and_b32 v28, 8, v26
    v_mul_u32_u24 v29, 12864, v23
    v_add3_u32 v24, v24, v28, v29
    v_add_u32 v53, 121408, v24
    s_lshr_b32 s30, s2, 3
    s_and_b32 s30, s30, 3
    s_mul_i32 s92, s30, 256
    s_add_u32 s92, s92, 562944
    s_add_u32 s30, s30, 768
    s_mul_i32 s93, s30, 36864
    s_mov_b32 s94, 147456
    s_and_b32 s95, s20, 1
    s_mul_i32 s95, s95, 9216
    s_add_u32 s59, s24, 9216
    s_mul_i32 s43, s20, 98304
    s_add_u32 s47, s29, 9216
    s_add_u32 s48, s29, 9792
    s_add_u32 s49, s29, 10112
    s_add_u32 s54, s29, 1073751872
    s_add_u32 s38, s26, 73728
    s_add_u32 s35, s38, 1024
    s_add_u32 s39, s38, 1536
    s_mov_b32 s40, s48
    s_add_u32 s41, s48, 256
    s_mov_b32 s50, 3130536464
    s_mov_b32 s51, 1164430831
    s_mov_b32 s52, 3696531472
    s_mov_b32 s53, 598435823
    v_mov_b32 v16, 0
    v_mov_b32 v17, 0
    v_mov_b32 v18, 0
    v_mov_b32 v19, 0
    v_cmp_gt_u32 s[44:45], 36, v12
    v_mov_b32 v20, 2.0
    s_nop 0
    v_cndmask_b32 v20, 0, v20, s[44:45]
    v_mov_b32 v21, v20
    v_mov_b32 v22, v20
    v_mov_b32 v23, v20
    v_mov_b32 v68, 1073741824
    v_mov_b32 v69, 0
    v_mov_b32 v70, 1073741824
    v_mov_b32 v71, 0
    v_lshl_add_u32 v84, v12, 2, s49
    v_add_u32 v55, s38, v54
    v_add_u32 v24, s38, v11
    ds_write_b128 v8, v[16:19] offset:0
    ds_write_b128 v8, v[16:19] offset:1024
    ds_write_b128 v8, v[16:19] offset:2048
    ds_write_b128 v8, v[16:19] offset:3072
    ds_write_b128 v8, v[16:19] offset:4096
    ds_write_b128 v8, v[16:19] offset:5120
    ds_write_b128 v8, v[16:19] offset:6144
    ds_write_b128 v8, v[16:19] offset:7168
    ds_write_b128 v8, v[16:19] offset:8192
    ds_write_b128 v24, v[68:71]
    ds_write_b128 v24, v[68:71] offset:1024
    ds_write_b128 v8, v[20:23] offset:9216
    s_cmp_lt_u32 s2, 81
    s_cbranch_scc1 F_sig
M_x2:
    s_add_u32 m0, m0, 896
    s_nop 0
    buffer_load_dwordx4 v5, s[8:11], s22 offen offset:896 nt lds
    s_add_u32 m0, m0, 896
    s_nop 0
    buffer_load_dwordx4 v5, s[8:11], s22 offen offset:1024 nt lds
    s_add_u32 s22, s22, 9437184
    s_add_u32 s42, s42, 36864
    s_mov_b32 m0, s42
    s_nop 0
    buffer_load_dwordx4 v5, s[8:11], s22 offen offset:0 nt lds
    s_add_u32 m0, m0, 896
    s_nop 0
    buffer_load_dwordx4 v5, s[8:11], s22 offen offset:128 nt lds
    s_add_u32 m0, m0, 896
    s_nop 0
    buffer_load_dwordx4 v5, s[8:11], s22 offen offset:256 nt lds
    s_add_u32 m0, m0, 896
    s_nop 0
    buffer_load_dwordx4 v5, s[8:11], s22 offen offset:384 nt lds
    s_add_u32 m0, m0, 896
    s_nop 0
    buffer_load_dwordx4 v5, s[8:11], s22 offen offset:512 nt lds
    s_add_u32 m0, m0, 896
    s_nop 0
    buffer_load_dwordx4 v5, s[8:11], s22 offen offset:640 nt lds
    s_add_u32 m0, m0, 896
    s_nop 0
    buffer_load_dwordx4 v5, s[8:11], s22 offen offset:768 nt lds
    s_add_u32 m0, m0, 896
    s_nop 0
    buffer_load_dwordx4 v5, s[8:11], s22 offen offset:896 nt lds
    s_add_u32 m0, m0, 896
    s_nop 0
    buffer_load_dwordx4 v5, s[8:11], s22 offen offset:1024 nt lds
    s_add_u32 s22, s22, 9437184
    s_add_u32 s42, s42, 36864
    s_waitcnt vmcnt(3)
    v_mov_b32 v0, 0
    s_mov_b64 exec, 1
    buffer_atomic_add v0, off, s[16:19], s96 sc0 sc1
    s_mov_b64 exec, -1
    v_readlane_b32 s100, v10, 0
    v_mov_b32 v10, 0xeeee4444
    v_lshlrev_b32 v124, 16, v196
    v_and_b32 v125, 0xffff0000, v196
    v_lshlrev_b32 v126, 16, v197
    v_and_b32 v127, 0xffff0000, v197
    v_lshlrev_b32 v128, 16, v198
    v_and_b32 v129, 0xffff0000, v198
    v_lshlrev_b32 v130, 16, v199
    v_and_b32 v131, 0xffff0000, v199
    v_lshlrev_b32 v132, 16, v200
    v_and_b32 v133, 0xffff0000, v200
    v_lshlrev_b32 v134, 16, v201
    v_and_b32 v135, 0xffff0000, v201
    v_lshlrev_b32 v136, 16, v202
    v_and_b32 v137, 0xffff0000, v202
    v_lshlrev_b32 v138, 16, v203
    v_and_b32 v139, 0xffff0000, v203
    v_lshlrev_b32 v140, 16, v204
    v_and_b32 v141, 0xffff0000, v204
    v_lshlrev_b32 v142, 16, v205
    v_and_b32 v143, 0xffff0000, v205
    v_lshlrev_b32 v144, 16, v206
    v_and_b32 v145, 0xffff0000, v206
    v_lshlrev_b32 v146, 16, v207
    v_and_b32 v147, 0xffff0000, v207
    v_lshlrev_b32 v148, 16, v208
    v_and_b32 v149, 0xffff0000, v208
    v_lshlrev_b32 v150, 16, v209
    v_and_b32 v151, 0xffff0000, v209
    v_lshlrev_b32 v152, 16, v210
    v_and_b32 v153, 0xffff0000, v210
    v_lshlrev_b32 v154, 16, v211
    v_and_b32 v155, 0xffff0000, v211
    v_lshlrev_b32 v156, 16, v212
    v_and_b32 v157, 0xffff0000, v212
    v_lshlrev_b32 v158, 16, v213
    v_and_b32 v159, 0xffff0000, v213
    s_mov_b32 exec_lo, 0x00010001
    s_mov_b32 exec_hi, 0x00010001
    ds_write_b128 v9, v[124:127] offset:10240
    ds_write_b128 v9, v[128:131] offset:10304
    ds_write_b128 v9, v[132:135] offset:10368
    ds_write_b128 v9, v[136:139] offset:10432
    ds_write_b128 v9, v[140:143] offset:10496
    ds_write_b128 v9, v[144:147] offset:10560
    ds_write_b128 v9, v[148:151] offset:10624
    ds_write_b128 v9, v[152:155] offset:10688
    ds_write_b128 v9, v[156:159] offset:10752
    s_mov_b64 exec, -1
    s_mul_i32 s30, s20, 256
    s_add_u32 s30, s30, s2
    s_sub_u32 s30, s30, 0
    s_cmp_lt_u32 s2, 0
    s_cselect_b32 s30, 1023, s30
    s_lshl_b32 s30, s30, 1
    v_lshrrev_b32 v244, 5, v12
    v_add_u32 v248, s30, v244
    v_mov_b32 v244, -1
    v_mov_b32 v245, 0
    v_subrev_u32 v246, 704, v248
    v_cmp_gt_u32 vcc, 16, v246
    v_mov_b32 v247, 0
    s_nop 0
    v_cndmask_b32 v244, v244, v246, vcc
    v_cndmask_b32 v245, v245, v247, vcc
    v_subrev_u32 v246, 672, v248
    v_cmp_gt_u32 vcc, 32, v246
    v_mov_b32 v247, 1
    s_nop 0
    v_cndmask_b32 v244, v244, v246, vcc
    v_cndmask_b32 v245, v245, v247, vcc
    v_subrev_u32 v246, 624, v248
    v_cmp_gt_u32 vcc, 48, v246
    v_mov_b32 v247, 2
    s_nop 0
    v_cndmask_b32 v244, v244, v246, vcc
    v_cndmask_b32 v245, v245, v247, vcc
    v_subrev_u32 v246, 560, v248
    v_cmp_gt_u32 vcc, 64, v246
    v_mov_b32 v247, 3
    s_nop 0
    v_cndmask_b32 v244, v244, v246, vcc
    v_cndmask_b32 v245, v245, v247, vcc
    v_subrev_u32 v246, 480, v248
    v_cmp_gt_u32 vcc, 80, v246
    v_mov_b32 v247, 4
    s_nop 0
    v_cndmask_b32 v244, v244, v246, vcc
    v_cndmask_b32 v245, v245, v247, vcc
    v_subrev_u32 v246, 384, v248
    v_cmp_gt_u32 vcc, 96, v246
    v_mov_b32 v247, 5
    s_nop 0
    v_cndmask_b32 v244, v244, v246, vcc
    v_cndmask_b32 v245, v245, v247, vcc
    v_subrev_u32 v246, 272, v248
    v_cmp_gt_u32 vcc, 112, v246
    v_mov_b32 v247, 6
    s_nop 0
    v_cndmask_b32 v244, v244, v246, vcc
    v_cndmask_b32 v245, v245, v247, vcc
    v_subrev_u32 v246, 144, v248
    v_cmp_gt_u32 vcc, 128, v246
    v_mov_b32 v247, 7
    s_nop 0
    v_cndmask_b32 v244, v244, v246, vcc
    v_cndmask_b32 v245, v245, v247, vcc
    v_subrev_u32 v246, 0, v248
    v_cmp_gt_u32 vcc, 144, v246
    v_mov_b32 v247, 8
    s_nop 0
    v_cndmask_b32 v244, v244, v246, vcc
    v_cndmask_b32 v245, v245, v247, vcc
    v_sub_u32 v244, 2047, v244
    v_mul_u32_u24 v244, 36864, v244
    v_lshl_add_u32 v244, v245, 7, v244
    v_and_b32 v245, 31, v12
    v_mul_u32_u24 v245, 1152, v245
    v_add_u32 v249, v244, v245
    s_mov_b32 vcc_lo, 0xff00ff00
    s_mov_b32 vcc_hi, 0xff00ff00
    s_waitcnt vmcnt(0)
    v_readfirstlane_b32 s30, v0
    s_mov_b32 s31, 0
    s_sub_u32 s30, s30, s100
    s_cmp_eq_u32 s30, 27
    s_cbranch_scc0 M_pf_spin
M_pf_ok:
    v_mov_b32 v0, v249
    buffer_load_dwordx4 v[56:59], v11, s[16:19], s43 offen offset:0 sc1
    buffer_load_dwordx4 v[60:63], v11, s[16:19], s43 offen offset:1024 sc1
    buffer_load_dwordx4 v[64:67], v11, s[16:19], s43 offen offset:2048 sc1
    s_mov_b32 exec_hi, 268435455
    buffer_load_dwordx4 v[68:71], v11, s[16:19], s43 offen offset:3072 sc1
    s_mov_b32 exec_hi, -1
    s_add_u32 s43, s43, 4096
    buffer_load_dwordx4 v[48:51], v11, s[16:19], s43 offen offset:0 sc1
    buffer_load_dword v52, v11, s[16:19], s43 offen offset:1024 sc1
    buffer_load_dwordx4 v[12:15], v11, s[16:19], s43 offen offset:2048 sc1
    buffer_load_dwordx4 a[0:3], v11, s[16:19], s43 offen offset:3072 sc1
    s_add_u32 s43, s43, 4096
    buffer_load_dwordx4 a[4:7], v11, s[16:19], s43 offen offset:0 sc1
    buffer_load_dwordx4 a[8:11], v11, s[16:19], s43 offen offset:1024 sc1
    buffer_load_dwordx4 a[12:15], v11, s[16:19], s43 offen offset:2048 sc1
    buffer_load_dwordx4 a[16:19], v11, s[16:19], s43 offen offset:3072 sc1
    s_add_u32 s43, s43, 4096
    buffer_load_dwordx4 a[20:23], v11, s[16:19], s43 offen offset:0 sc1
    buffer_load_dwordx4 a[24:27], v11, s[16:19], s43 offen offset:1024 sc1
    buffer_load_dwordx4 a[28:31], v11, s[16:19], s43 offen offset:2048 sc1
    buffer_load_dwordx4 a[32:35], v11, s[16:19], s43 offen offset:3072 sc1
    s_add_u32 s43, s43, 4096
    buffer_load_dwordx4 v[16:19], v11, s[16:19], s43 offen offset:0 sc1
    buffer_load_dwordx4 a[36:39], v11, s[16:19], s43 offen offset:1024 sc1
    buffer_load_dwordx4 a[40:43], v11, s[16:19], s43 offen offset:2048 sc1
    buffer_load_dwordx4 a[44:47], v11, s[16:19], s43 offen offset:3072 sc1
    ds_read_b128 v[160:163], v9 offset:10240
    ds_read_b128 v[164:167], v9 offset:10304
    ds_read_b128 v[168:171], v9 offset:10368
    ds_read_b128 v[172:175], v9 offset:10432
    ds_read_b128 v[176:179], v9 offset:10496
    ds_read_b128 v[180:183], v9 offset:10560
    ds_read_b128 v[184:187], v9 offset:10624
    ds_read_b128 v[188:191], v9 offset:10688
    ds_read_b128 v[192:195], v9 offset:10752
    s_cmp_eq_u32 s98, 0
    s_cbranch_scc1 M_cnt
    s_mov_b32 s98, 0
    v_mov_b32 v250, 1
    s_mov_b64 exec, 1
    buffer_atomic_add v250, off, s[68:71], 0 offset:0 sc1
    s_mov_b64 exec, -1
    s_nop 3
M_cnt:
    s_waitcnt vmcnt(12)
    s_barrier
    ds_read_b128 v[196:199], v1 offset:0
    ds_read_b128 v[200:203], v2 offset:0
    ds_read_b128 v[228:231], v1 offset:18432
    ds_read_b128 v[232:235], v2 offset:18432
    s_waitcnt lgkmcnt(2)
    v_smfmac_f32_16x16x64_bf16 v[124:127], a[0:3], v[196:203], v12
    s_add_u32 s43, s43, 4096
    buffer_load_dwordx4 a[48:51], v11, s[16:19], s43 offen offset:0 sc1
    s_waitcnt lgkmcnt(0)
    v_mov_b32 v82, s54
    v_smfmac_f32_16x16x64_bf16 v[160:163], a[0:3], v[228:235], v12
    ds_read_b128 v[204:207], v1 offset:1024
    ds_read_b128 v[208:211], v2 offset:1024
    v_or3_b32 v78, v56, v60, v64
    v_or_b32 v78, v78, v68
    v_cmp_gt_i32 s[32:33], 0, v78
    v_cmp_gt_u32 s[36:37], 2.0, v56
    s_nop 1
    v_mbcnt_lo_u32_b32 v74, s36, 0
    s_waitcnt vmcnt(12)
    v_mbcnt_hi_u32_b32 v74, s37, v74
    v_smfmac_f32_16x16x64_bf16 v[128:131], a[4:7], v[196:203], v12 abid:1
    buffer_load_dwordx4 a[52:55], v11, s[16:19], s43 offen offset:1024 sc1
    v_lshl_add_u32 v74, v74, 3, s38
    v_smfmac_f32_16x16x64_bf16 v[164:167], a[4:7], v[228:235], v12 abid:1
    ds_read_b128 v[220:223], v1 offset:19456
    ds_read_b128 v[224:227], v2 offset:19456
    v_min_u32 v74, s39, v74
    s_waitcnt vmcnt(12)
    v_cndmask_b32 v74, v82, v74, s[36:37]
    v_smfmac_f32_16x16x64_bf16 v[132:135], a[8:11], v[196:203], v13
    buffer_load_dwordx4 a[56:59], v11, s[16:19], s43 offen offset:2048 sc1
    ds_write_b64 v74, v[56:57]
    s_bcnt1_i32_b64 s30, s[36:37]
    s_lshl3_add_u32 s38, s30, s38
    v_cmp_gt_u32 s[44:45], 2.0, v58
    v_smfmac_f32_16x16x64_bf16 v[168:171], a[8:11], v[228:235], v13
    s_nop 0
    v_mbcnt_lo_u32_b32 v75, s44, 0
    v_mbcnt_hi_u32_b32 v75, s45, v75
    v_lshl_add_u32 v75, v75, 3, s38
    v_min_u32 v75, s39, v75
    s_waitcnt vmcnt(12)
    v_cndmask_b32 v75, v82, v75, s[44:45]
    v_smfmac_f32_16x16x64_bf16 v[136:139], a[12:15], v[196:203], v13 abid:1
    buffer_load_dwordx4 a[60:63], v11, s[16:19], s43 offen offset:3072 sc1
    ds_write_b64 v75, v[58:59]
    s_bcnt1_i32_b64 s30, s[44:45]
    s_lshl3_add_u32 s38, s30, s38
    v_cmp_gt_u32 s[36:37], 2.0, v60
    v_smfmac_f32_16x16x64_bf16 v[172:175], a[12:15], v[228:235], v13 abid:1
    s_nop 0
    v_mbcnt_lo_u32_b32 v74, s36, 0
    v_mbcnt_hi_u32_b32 v74, s37, v74
    v_lshl_add_u32 v74, v74, 3, s38
    s_waitcnt vmcnt(12)
    v_min_u32 v74, s39, v74
    v_smfmac_f32_16x16x64_bf16 v[140:143], a[16:19], v[196:203], v14
    s_add_u32 s43, s43, 4096
    buffer_load_dwordx4 a[64:67], v11, s[16:19], s43 offen offset:0 sc1
    v_cndmask_b32 v74, v82, v74, s[36:37]
    v_smfmac_f32_16x16x64_bf16 v[176:179], a[16:19], v[228:235], v14
    ds_write_b64 v74, v[60:61]
    s_bcnt1_i32_b64 s30, s[36:37]
    s_lshl3_add_u32 s38, s30, s38
    v_cmp_gt_u32 s[44:45], 2.0, v62
    s_nop 1
    v_mbcnt_lo_u32_b32 v75, s44, 0
    s_waitcnt vmcnt(12)
    v_mbcnt_hi_u32_b32 v75, s45, v75
    v_smfmac_f32_16x16x64_bf16 v[144:147], a[20:23], v[196:203], v14 abid:1
    buffer_load_dwordx4 a[68:71], v11, s[16:19], s43 offen offset:1024 sc1
    v_lshl_add_u32 v75, v75, 3, s38
    v_smfmac_f32_16x16x64_bf16 v[180:183], a[20:23], v[228:235], v14 abid:1
    v_min_u32 v75, s39, v75
    s_waitcnt vmcnt(12)
    v_cndmask_b32 v75, v82, v75, s[44:45]
    v_smfmac_f32_16x16x64_bf16 v[148:151], a[24:27], v[196:203], v15
    buffer_load_dwordx4 v[20:23], v11, s[16:19], s43 offen offset:2048 sc1
    buffer_load_dwordx4 a[72:75], v11, s[16:19], s43 offen offset:3072 sc1
    ds_write_b64 v75, v[62:63]
    s_bcnt1_i32_b64 s30, s[44:45]
    s_lshl3_add_u32 s38, s30, s38
    v_cmp_gt_u32 s[36:37], 2.0, v64
    v_smfmac_f32_16x16x64_bf16 v[184:187], a[24:27], v[228:235], v15
    s_nop 0
    v_mbcnt_lo_u32_b32 v74, s36, 0
    v_mbcnt_hi_u32_b32 v74, s37, v74
    v_lshl_add_u32 v74, v74, 3, s38
    v_min_u32 v74, s39, v74
    s_waitcnt vmcnt(13)
    v_cndmask_b32 v74, v82, v74, s[36:37]
    v_smfmac_f32_16x16x64_bf16 v[152:155], a[28:31], v[196:203], v15 abid:1
    s_add_u32 s43, s43, 4096
    buffer_load_dwordx4 a[76:79], v11, s[16:19], s43 offen offset:0 sc1
    ds_write_b64 v74, v[64:65]
    s_bcnt1_i32_b64 s30, s[36:37]
    s_lshl3_add_u32 s38, s30, s38
    v_cmp_gt_u32 s[44:45], 2.0, v66
    v_smfmac_f32_16x16x64_bf16 v[188:191], a[28:31], v[228:235], v15 abid:1
    s_nop 0
    v_mbcnt_lo_u32_b32 v75, s44, 0
    v_mbcnt_hi_u32_b32 v75, s45, v75
    v_lshl_add_u32 v75, v75, 3, s38
    s_waitcnt vmcnt(13)
    v_min_u32 v75, s39, v75
    v_smfmac_f32_16x16x64_bf16 v[156:159], a[32:35], v[196:203], v48
    buffer_load_dwordx4 a[80:83], v11, s[16:19], s43 offen offset:1024 sc1
    v_cndmask_b32 v75, v82, v75, s[44:45]
    v_smfmac_f32_16x16x64_bf16 v[192:195], a[32:35], v[228:235], v48
    ds_write_b64 v75, v[66:67]
    s_bcnt1_i32_b64 s30, s[44:45]
    s_lshl3_add_u32 s38, s30, s38
    v_cmp_gt_u32 s[36:37], 2.0, v68
    s_nop 1
    s_waitcnt vmcnt(12)
    s_waitcnt lgkmcnt(8)
    v_mbcnt_lo_u32_b32 v74, s36, 0
    v_smfmac_f32_16x16x64_bf16 v[124:127], a[36:39], v[204:211], v16
    buffer_load_dwordx4 a[84:87], v11, s[16:19], s43 offen offset:2048 sc1
    s_waitcnt lgkmcnt(6)
    v_mbcnt_hi_u32_b32 v74, s37, v74
    v_smfmac_f32_16x16x64_bf16 v[160:163], a[36:39], v[220:227], v16
    ds_read_b128 v[196:199], v1 offset:2048
    ds_read_b128 v[200:203], v2 offset:2048
    v_lshl_add_u32 v74, v74, 3, s38
    v_min_u32 v74, s39, v74
    s_waitcnt vmcnt(12)
    v_cndmask_b32 v74, v82, v74, s[36:37]
    v_smfmac_f32_16x16x64_bf16 v[128:131], a[40:43], v[204:211], v16 abid:1
    buffer_load_dwordx4 a[88:91], v11, s[16:19], s43 offen offset:3072 sc1
    ds_write_b64 v74, v[68:69]
    s_bcnt1_i32_b64 s30, s[36:37]
    s_lshl3_add_u32 s38, s30, s38
    v_cmp_gt_u32 s[44:45], 2.0, v70
    v_smfmac_f32_16x16x64_bf16 v[164:167], a[40:43], v[220:227], v16 abid:1
    ds_read_b128 v[228:231], v1 offset:20480
    ds_read_b128 v[232:235], v2 offset:20480
    v_mbcnt_lo_u32_b32 v75, s44, 0
    v_mbcnt_hi_u32_b32 v75, s45, v75
    v_lshl_add_u32 v75, v75, 3, s38
    v_min_u32 v75, s39, v75
    s_waitcnt vmcnt(12)
    v_cndmask_b32 v75, v82, v75, s[44:45]
    v_smfmac_f32_16x16x64_bf16 v[132:135], a[44:47], v[204:211], v17
    s_add_u32 s43, s43, 4096
    buffer_load_dwordx4 a[92:95], v11, s[16:19], s43 offen offset:0 sc1
    ds_write_b64 v75, v[70:71]
    s_bcnt1_i32_b64 s30, s[44:45]
    s_lshl3_add_u32 s38, s30, s38
    ds_read_b64 v[56:57], v55 offset:0
    ds_read_b64 v[58:59], v55 offset:512
    ds_read_b64 v[60:61], v55 offset:1024
    v_smfmac_f32_16x16x64_bf16 v[168:171], a[44:47], v[220:227], v17
    s_waitcnt vmcnt(12)
    v_smfmac_f32_16x16x64_bf16 v[136:139], a[48:51], v[204:211], v17 abid:1
    buffer_load_dwordx4 a[96:99], v11, s[16:19], s43 offen offset:1024 sc1
    v_smfmac_f32_16x16x64_bf16 v[172:175], a[48:51], v[220:227], v17 abid:1
    s_waitcnt vmcnt(12)
    v_smfmac_f32_16x16x64_bf16 v[140:143], a[52:55], v[204:211], v18
    buffer_load_dwordx4 a[100:103], v11, s[16:19], s43 offen offset:2048 sc1
    s_waitcnt lgkmcnt(2)
    v_bfe_u32 v74, v56, 24, 4
    v_smfmac_f32_16x16x64_bf16 v[176:179], a[52:55], v[220:227], v18
    v_lshlrev_b32 v75, 1, v56
    v_lshl_add_u32 v74, v74, 2, s49
    v_and_b32 v75, 16, v75
    s_waitcnt vmcnt(12)
    v_and_or_b32 v74, v56, 2.0, v74
    v_smfmac_f32_16x16x64_bf16 v[144:147], a[56:59], v[204:211], v18 abid:1
    buffer_load_dwordx4 a[104:107], v11, s[16:19], s43 offen offset:3072 sc1
    v_lshlrev_b32 v75, v75, 1
    v_smfmac_f32_16x16x64_bf16 v[180:183], a[56:59], v[220:227], v18 abid:1
    ds_add_rtn_u32 v62, v74, v75
    s_waitcnt lgkmcnt(2)
    v_bfe_u32 v76, v58, 24, 4
    v_lshlrev_b32 v77, 1, v58
    v_lshl_add_u32 v76, v76, 2, s49
    s_waitcnt vmcnt(12)
    v_and_b32 v77, 16, v77
    v_smfmac_f32_16x16x64_bf16 v[148:151], a[60:63], v[204:211], v19
    s_add_u32 s43, s43, 4096
    buffer_load_dwordx4 v[24:27], v11, s[16:19], s43 offen offset:0 sc1
    buffer_load_dwordx4 a[108:111], v11, s[16:19], s43 offen offset:1024 sc1
    v_and_or_b32 v76, v58, 2.0, v76
    v_smfmac_f32_16x16x64_bf16 v[184:187], a[60:63], v[220:227], v19
    s_waitcnt vmcnt(13)
    v_lshlrev_b32 v77, v77, 1
    v_smfmac_f32_16x16x64_bf16 v[152:155], a[64:67], v[204:211], v19 abid:1
    buffer_load_dwordx4 a[112:115], v11, s[16:19], s43 offen offset:2048 sc1
    ds_add_rtn_u32 v63, v76, v77
    s_waitcnt lgkmcnt(2)
    s_cmp_gt_u32 s38, s35
    s_cbranch_scc1 M_r3
M_r3r:
    ds_read_b32 v81, v84
    v_and_b32 v74, 8, v56
    v_smfmac_f32_16x16x64_bf16 v[188:191], a[64:67], v[220:227], v19 abid:1
    v_lshrrev_b32 v77, 14, v56
    v_cmp_ne_u32 s[44:45], 0, v74
    v_and_b32 v80, 0x3cf0, v77
    s_waitcnt lgkmcnt(2)
    v_lshrrev_b32 v75, 16, v62
    v_and_b32 v76, 0xffff, v62
    s_waitcnt vmcnt(13)
    v_sub_u32 v74, 15, v75
    v_smfmac_f32_16x16x64_bf16 v[156:159], a[68:71], v[204:211], v48 abid:1
    buffer_load_dwordx4 a[116:119], v11, s[16:19], s43 offen offset:3072 sc1
    v_and_b32 v62, 2.0, v56
    v_smfmac_f32_16x16x64_bf16 v[192:195], a[68:71], v[220:227], v48 abid:1
    v_add3_u32 v62, v76, v75, v62
    v_cndmask_b32 v74, v76, v74, s[44:45]
    v_cmp_gt_u32 s[44:45], 16, v62
    v_cmp_gt_u32 s[36:37], 2.0, v62
    v_lshlrev_b32 v74, 2, v74
    s_waitcnt vmcnt(12)
    v_lshrrev_b64 v[76:77], v74, s[50:51]
    v_smfmac_f32_16x16x64_bf16 v[124:127], a[72:75], v[196:203], v20
    s_add_u32 s43, s43, 4096
    buffer_load_dwordx4 a[120:123], v11, s[16:19], s43 offen offset:0 sc1
    s_andn2_b64 s[36:37], s[36:37], s[44:45]
    v_lshrrev_b64 v[78:79], v74, s[52:53]
    v_smfmac_f32_16x16x64_bf16 v[160:163], a[72:75], v[228:235], v20
    ds_read_b128 v[204:207], v1 offset:3072
    ds_read_b128 v[208:211], v2 offset:3072
    v_bfe_u32 v74, v56, 24, 4
    v_mbcnt_lo_u32_b32 v75, s36, 0
    v_and_b32 v76, 15, v76
    v_mbcnt_hi_u32_b32 v75, s37, v75
    v_and_b32 v78, 15, v78
    s_waitcnt vmcnt(12)
    v_lshl_add_u32 v75, v75, 3, s40
    v_smfmac_f32_16x16x64_bf16 v[128:131], a[76:79], v[196:203], v20 abid:1
    buffer_load_dwordx4 a[124:127], v11, s[16:19], s43 offen offset:1024 sc1
    v_lshl_add_u32 v76, v74, 4, v76
    v_smfmac_f32_16x16x64_bf16 v[164:167], a[76:79], v[228:235], v20 abid:1
    ds_read_b128 v[220:223], v1 offset:21504
    ds_read_b128 v[224:227], v2 offset:21504
    v_min_u32 v75, s41, v75
    v_mul_u32_u24 v78, 68, v78
    s_waitcnt vmcnt(12)
    v_cndmask_b32 v75, v82, v75, s[36:37]
    v_smfmac_f32_16x16x64_bf16 v[132:135], a[80:83], v[196:203], v21
    buffer_load_dwordx4 a[128:131], v11, s[16:19], s43 offen offset:2048 sc1
    ds_write_b64 v75, v[56:57]
    s_bcnt1_i32_b64 s30, s[36:37]
    s_lshl3_add_u32 s40, s30, s40
    v_lshl_add_u32 v76, v76, 2, s47
    v_smfmac_f32_16x16x64_bf16 v[168:171], a[80:83], v[228:235], v21
    v_and_b32 v78, 0x30c, v78
    v_cndmask_b32 v76, v82, v76, s[44:45]
    v_add3_u32 v77, v80, v78, s29
    v_and_b32 v78, 0x3fff, v56
    s_waitcnt vmcnt(12)
    v_cndmask_b32 v74, v82, v77, s[44:45]
    v_smfmac_f32_16x16x64_bf16 v[136:139], a[84:87], v[196:203], v21 abid:1
    buffer_load_dwordx4 a[132:135], v11, s[16:19], s43 offen offset:3072 sc1
    ds_write_b32 v76, v78
    ds_write_b32 v74, v57
    v_and_b32 v74, 8, v58
    v_smfmac_f32_16x16x64_bf16 v[172:175], a[84:87], v[228:235], v21 abid:1
    v_lshrrev_b32 v77, 14, v58
    v_cmp_ne_u32 s[44:45], 0, v74
    v_and_b32 v80, 0x3cf0, v77
    s_waitcnt lgkmcnt(8)
    s_waitcnt vmcnt(12)
    v_lshrrev_b32 v75, 16, v63
    v_smfmac_f32_16x16x64_bf16 v[140:143], a[88:91], v[196:203], v22
    s_add_u32 s43, s43, 4096
    buffer_load_dwordx4 a[136:139], v11, s[16:19], s43 offen offset:0 sc1
    v_and_b32 v76, 0xffff, v63
    v_smfmac_f32_16x16x64_bf16 v[176:179], a[88:91], v[228:235], v22
    v_sub_u32 v74, 15, v75
    v_and_b32 v63, 2.0, v58
    v_add3_u32 v63, v76, v75, v63
    v_cndmask_b32 v74, v76, v74, s[44:45]
    s_waitcnt vmcnt(12)
    v_cmp_gt_u32 s[44:45], 16, v63
    v_smfmac_f32_16x16x64_bf16 v[144:147], a[92:95], v[196:203], v22 abid:1
    buffer_load_dwordx4 a[140:143], v11, s[16:19], s43 offen offset:1024 sc1
    v_cmp_gt_u32 s[36:37], 2.0, v63
    v_smfmac_f32_16x16x64_bf16 v[180:183], a[92:95], v[228:235], v22 abid:1
    v_lshlrev_b32 v74, 2, v74
    s_waitcnt vmcnt(12)
    v_lshrrev_b64 v[76:77], v74, s[50:51]
    v_smfmac_f32_16x16x64_bf16 v[148:151], a[96:99], v[196:203], v23
    buffer_load_dwordx4 v[28:31], v11, s[16:19], s43 offen offset:2048 sc1
    buffer_load_dwordx4 a[144:147], v11, s[16:19], s43 offen offset:3072 sc1
    s_andn2_b64 s[36:37], s[36:37], s[44:45]
    v_lshrrev_b64 v[78:79], v74, s[52:53]
    v_smfmac_f32_16x16x64_bf16 v[184:187], a[96:99], v[228:235], v23
    v_bfe_u32 v74, v58, 24, 4
    v_mbcnt_lo_u32_b32 v75, s36, 0
    v_and_b32 v76, 15, v76
    v_mbcnt_hi_u32_b32 v75, s37, v75
    v_and_b32 v78, 15, v78
    s_waitcnt vmcnt(13)
    v_lshl_add_u32 v75, v75, 3, s40
    v_smfmac_f32_16x16x64_bf16 v[152:155], a[100:103], v[196:203], v23 abid:1
    s_add_u32 s43, s43, 4096
    buffer_load_dwordx4 a[148:151], v11, s[16:19], s43 offen offset:0 sc1
    v_lshl_add_u32 v76, v74, 4, v76
    v_smfmac_f32_16x16x64_bf16 v[188:191], a[100:103], v[228:235], v23 abid:1
    v_min_u32 v75, s41, v75
    v_mul_u32_u24 v78, 68, v78
    s_waitcnt vmcnt(13)
    v_cndmask_b32 v75, v82, v75, s[36:37]
    v_smfmac_f32_16x16x64_bf16 v[156:159], a[104:107], v[196:203], v49
    buffer_load_dwordx4 a[152:155], v11, s[16:19], s43 offen offset:1024 sc1
    ds_write_b64 v75, v[58:59]
    s_bcnt1_i32_b64 s30, s[36:37]
    s_lshl3_add_u32 s40, s30, s40
    v_lshl_add_u32 v76, v76, 2, s47
    v_smfmac_f32_16x16x64_bf16 v[192:195], a[104:107], v[228:235], v49
    v_and_b32 v78, 0x30c, v78
    v_cndmask_b32 v76, v82, v76, s[44:45]
    v_add3_u32 v77, v80, v78, s29
    v_and_b32 v78, 0x3fff, v58
    s_waitcnt vmcnt(12)
    s_waitcnt lgkmcnt(6)
    v_cndmask_b32 v74, v82, v77, s[44:45]
    v_smfmac_f32_16x16x64_bf16 v[124:127], a[108:111], v[204:211], v24
    buffer_load_dwordx4 a[156:159], v11, s[16:19], s43 offen offset:2048 sc1
    ds_write_b32 v76, v78
    ds_write_b32 v74, v59
    s_waitcnt lgkmcnt(6)
    v_lshrrev_b32 v74, 16, v81
    v_smfmac_f32_16x16x64_bf16 v[160:163], a[108:111], v[220:227], v24
    ds_read_b128 v[196:199], v1 offset:4096
    ds_read_b128 v[200:203], v2 offset:4096
    v_and_b32 v81, 0xffff, v81
    v_add_u32 v81, v81, v74
    s_waitcnt vmcnt(12)
    v_cmp_lt_u32 s[34:35], 16, v81
    v_smfmac_f32_16x16x64_bf16 v[128:131], a[112:115], v[204:211], v24 abid:1
    buffer_load_dwordx4 a[160:163], v11, s[16:19], s43 offen offset:3072 sc1
    s_sub_u32 s46, s40, s48
    s_add_u32 s46, s46, 56
    s_lshr_b32 s46, s46, 6
    s_mov_b32 s21, 0
    s_and_b32 s27, s34, 0x1ff
    s_cmp_gt_u32 s46, 4
    s_cselect_b32 s32, 1, s32
    s_or_b32 s32, s32, s33
    s_cbranch_scc1 M_dn
M_dnr:
    ds_read_b128 v[56:59], v9 offset:9792
    s_bcnt1_i32_b32 s30, s27
    s_cmp_gt_u32 s30, 3
    s_cselect_b32 s34, 0, s27
    s_cselect_b32 s80, 0, 1
    s_getpc_b64 s[36:37]
M_pc:
    v_bfe_u32 v74, v11, 4, 4
    v_smfmac_f32_16x16x64_bf16 v[164:167], a[112:115], v[220:227], v24 abid:1
    ds_read_b128 v[228:231], v1 offset:22528
    ds_read_b128 v[232:235], v2 offset:22528
    s_waitcnt vmcnt(12)
    v_smfmac_f32_16x16x64_bf16 v[132:135], a[116:119], v[204:211], v25
    s_add_u32 s43, s43, 4096
    buffer_load_dwordx4 a[164:167], v11, s[16:19], s43 offen offset:0 sc1
    s_ff1_i32_b32 s81, s34
    s_bitset0_b32 s34, s81
    s_mul_i32 s30, s81, 20
    s_add_u32 s31, s30, M_ovc0-M_pc
    s_add_u32 s30, s30, M_ovl0-M_pc
    s_cmp_lg_u32 s34, 0
    s_cselect_b32 s30, s31, s30
    s_cmp_lt_i32 s81, 0
    s_cselect_b32 s30, M_ovn-M_pc, s30
    s_add_u32 s72, s36, s30
    s_addc_u32 s73, s37, 0
    s_ff1_i32_b32 s82, s34
    s_bitset0_b32 s34, s82
    s_mul_i32 s30, s82, 20
    s_add_u32 s31, s30, M_ovc1-M_pc
    s_add_u32 s30, s30, M_ovl1-M_pc
    s_cmp_lg_u32 s34, 0
    s_cselect_b32 s30, s31, s30
    s_cmp_lt_i32 s82, 0
    s_cselect_b32 s30, M_ovn-M_pc, s30
    v_smfmac_f32_16x16x64_bf16 v[168:171], a[116:119], v[220:227], v25
    s_waitcnt vmcnt(12)
    v_smfmac_f32_16x16x64_bf16 v[136:139], a[120:123], v[204:211], v25 abid:1
    buffer_load_dwordx4 a[168:171], v11, s[16:19], s43 offen offset:1024 sc1
    s_add_u32 s74, s36, s30
    s_addc_u32 s75, s37, 0
    s_ff1_i32_b32 s83, s34
    s_bitset0_b32 s34, s83
    s_mul_i32 s30, s83, 20
    s_add_u32 s31, s30, M_ovc1-M_pc
    s_add_u32 s30, s30, M_ovl2-M_pc
    s_cmp_lg_u32 s34, 0
    s_cselect_b32 s30, s31, s30
    s_cmp_lt_i32 s83, 0
    s_cselect_b32 s30, M_ovn-M_pc, s30
    s_add_u32 s76, s36, s30
    s_addc_u32 s77, s37, 0
    s_waitcnt lgkmcnt(2)
    v_lshrrev_b32 v76, 18, v56
    v_smfmac_f32_16x16x64_bf16 v[172:175], a[120:123], v[220:227], v25 abid:1
    s_waitcnt vmcnt(12)
    v_lshrrev_b32 v77, 18, v58
    v_smfmac_f32_16x16x64_bf16 v[140:143], a[124:127], v[204:211], v26
    buffer_load_dwordx4 a[172:175], v11, s[16:19], s43 offen offset:2048 sc1
    v_and_b32 v78, 0x3fff, v56
    v_smfmac_f32_16x16x64_bf16 v[176:179], a[124:127], v[220:227], v26
    s_waitcnt vmcnt(12)
    v_and_b32 v79, 0x3fff, v58
    v_smfmac_f32_16x16x64_bf16 v[144:147], a[128:131], v[204:211], v26 abid:1
    buffer_load_dwordx4 a[176:179], v11, s[16:19], s43 offen offset:3072 sc1
    ds_write_b64 v9, v[78:79] offset:10056
    v_lshl_or_b32 v75, s81, 6, v74
    v_smfmac_f32_16x16x64_bf16 v[180:183], a[128:131], v[220:227], v26 abid:1
    v_cmp_eq_u32 s[44:45], v76, v75
    v_cmp_eq_u32 s[36:37], v77, v75
    s_nop 0
    v_cndmask_b32 v54, 0, v57, s[44:45]
    v_cndmask_b32 v55, 0, v59, s[36:37]
    v_lshl_or_b32 v75, s82, 6, v74
    s_waitcnt vmcnt(12)
    v_cmp_eq_u32 s[44:45], v76, v75
    v_smfmac_f32_16x16x64_bf16 v[148:151], a[132:135], v[204:211], v27
    s_add_u32 s43, s43, 4096
    buffer_load_dwordx4 v[32:35], v11, s[16:19], s43 offen offset:0 sc1
    buffer_load_dwordx4 a[180:183], v11, s[16:19], s43 offen offset:1024 sc1
    v_cmp_eq_u32 s[36:37], v77, v75
    v_smfmac_f32_16x16x64_bf16 v[184:187], a[132:135], v[220:227], v27
    v_cndmask_b32 v252, 0, v57, s[44:45]
    v_cndmask_b32 v253, 0, v59, s[36:37]
    v_lshl_or_b32 v75, s83, 6, v74
    v_cmp_eq_u32 s[44:45], v76, v75
    v_cmp_eq_u32 s[36:37], v77, v75
    s_nop 0
    s_waitcnt vmcnt(13)
    v_cndmask_b32 v254, 0, v57, s[44:45]
    v_smfmac_f32_16x16x64_bf16 v[152:155], a[136:139], v[204:211], v27 abid:1
    buffer_load_dwordx4 a[184:187], v11, s[16:19], s43 offen offset:2048 sc1
    v_cndmask_b32 v255, 0, v59, s[36:37]
    v_smfmac_f32_16x16x64_bf16 v[188:191], a[136:139], v[220:227], v27 abid:1
    ds_read_b128 v[236:239], v9 offset:9408
    ds_read_b64 v[216:217], v9 offset:10056
    s_waitcnt vmcnt(13)
    v_smfmac_f32_16x16x64_bf16 v[156:159], a[140:143], v[204:211], v49 abid:1
    buffer_load_dwordx4 a[188:191], v11, s[16:19], s43 offen offset:3072 sc1
    s_waitcnt lgkmcnt(1)
    v_xad_u32 v236, v236, v3, v4
    v_smfmac_f32_16x16x64_bf16 v[192:195], a[140:143], v[220:227], v49 abid:1
    s_waitcnt vmcnt(12)
    v_xad_u32 v237, v237, v3, v4
    v_smfmac_f32_16x16x64_bf16 v[124:127], a[144:147], v[196:203], v28
    s_add_u32 s43, s43, 4096
    buffer_load_dwordx4 a[192:195], v11, s[16:19], s43 offen offset:0 sc1
    ds_read2st64_b32 v[244:245], v236 offset0:0 offset1:72
    ds_read2st64_b32 v[246:247], v237 offset0:0 offset1:72
    v_xad_u32 v238, v238, v3, v4
    v_smfmac_f32_16x16x64_bf16 v[160:163], a[144:147], v[228:235], v28
    ds_read_b128 v[204:207], v1 offset:5120
    ds_read_b128 v[208:211], v2 offset:5120
    s_waitcnt vmcnt(12)
    v_xad_u32 v239, v239, v3, v4
    v_smfmac_f32_16x16x64_bf16 v[128:131], a[148:151], v[196:203], v28 abid:1
    buffer_load_dwordx4 a[196:199], v11, s[16:19], s43 offen offset:1024 sc1
    ds_read2st64_b32 v[248:249], v238 offset0:0 offset1:72
    ds_read2st64_b32 v[250:251], v239 offset0:0 offset1:72
    ds_read_b128 v[240:243], v8 offset:3072
    ds_read_b128 v[236:239], v9 offset:9280
    s_waitcnt lgkmcnt(8)
    v_xad_u32 v212, v216, v3, v4
    v_smfmac_f32_16x16x64_bf16 v[164:167], a[148:151], v[228:235], v28 abid:1
    ds_read_b128 v[220:223], v1 offset:23552
    ds_read_b128 v[224:227], v2 offset:23552
    ds_read2st64_b32 v[212:213], v212 offset0:0 offset1:72
    s_waitcnt vmcnt(12)
    v_xad_u32 v214, v217, v3, v4
    v_smfmac_f32_16x16x64_bf16 v[132:135], a[152:155], v[196:203], v29
    buffer_load_dwordx4 a[200:203], v11, s[16:19], s43 offen offset:2048 sc1
    ds_read2st64_b32 v[214:215], v214 offset0:0 offset1:72
    v_smfmac_f32_16x16x64_bf16 v[168:171], a[152:155], v[228:235], v29
    s_waitcnt vmcnt(12)
    v_smfmac_f32_16x16x64_bf16 v[136:139], a[156:159], v[196:203], v29 abid:1
    buffer_load_dwordx4 a[204:207], v11, s[16:19], s43 offen offset:3072 sc1
    v_smfmac_f32_16x16x64_bf16 v[172:175], a[156:159], v[228:235], v29 abid:1
    s_waitcnt vmcnt(12)
    v_smfmac_f32_16x16x64_bf16 v[140:143], a[160:163], v[196:203], v30
    s_add_u32 s43, s43, 4096
    buffer_load_dwordx4 a[208:211], v11, s[16:19], s43 offen offset:0 sc1
    s_waitcnt lgkmcnt(5)
    v_smfmac_f32_16x16x64_bf16 v[136:139], v[240:243], v[244:251], v10
    v_smfmac_f32_16x16x64_bf16 v[172:175], v[240:243], v[244:251], v10 abid:1
    s_waitcnt lgkmcnt(4)
    v_xad_u32 v236, v236, v3, v4
    v_smfmac_f32_16x16x64_bf16 v[176:179], a[160:163], v[228:235], v30
    s_waitcnt vmcnt(12)
    v_xad_u32 v237, v237, v3, v4
    v_smfmac_f32_16x16x64_bf16 v[144:147], a[164:167], v[196:203], v30 abid:1
    buffer_load_dwordx4 a[212:215], v11, s[16:19], s43 offen offset:1024 sc1
    ds_read2st64_b32 v[244:245], v236 offset0:0 offset1:72
    ds_read2st64_b32 v[246:247], v237 offset0:0 offset1:72
    v_xad_u32 v238, v238, v3, v4
    v_smfmac_f32_16x16x64_bf16 v[180:183], a[164:167], v[228:235], v30 abid:1
    s_waitcnt vmcnt(12)
    v_xad_u32 v239, v239, v3, v4
    v_smfmac_f32_16x16x64_bf16 v[148:151], a[168:171], v[196:203], v31
    buffer_load_dwordx4 v[36:39], v11, s[16:19], s43 offen offset:2048 sc1
    buffer_load_dwordx4 a[216:219], v11, s[16:19], s43 offen offset:3072 sc1
    ds_read2st64_b32 v[248:249], v238 offset0:0 offset1:72
    ds_read2st64_b32 v[250:251], v239 offset0:0 offset1:72
    ds_read_b128 v[240:243], v8 offset:1024
    ds_read_b128 v[236:239], v9 offset:9344
    v_smfmac_f32_16x16x64_bf16 v[184:187], a[168:171], v[228:235], v31
    s_waitcnt vmcnt(13)
    v_smfmac_f32_16x16x64_bf16 v[152:155], a[172:175], v[196:203], v31 abid:1
    s_add_u32 s43, s43, 4096
    buffer_load_dwordx4 a[220:223], v11, s[16:19], s43 offen offset:0 sc1
    s_waitcnt lgkmcnt(6)
    s_cmp_lt_i32 s81, 0
    s_cbranch_scc1 M_ovr0
    s_swappc_b64 s[78:79], s[72:73]
M_ovr0:
    v_smfmac_f32_16x16x64_bf16 v[188:191], a[172:175], v[228:235], v31 abid:1
    s_waitcnt vmcnt(13)
    v_smfmac_f32_16x16x64_bf16 v[156:159], a[176:179], v[196:203], v50
    buffer_load_dwordx4 a[224:227], v11, s[16:19], s43 offen offset:1024 sc1
    v_smfmac_f32_16x16x64_bf16 v[192:195], a[176:179], v[228:235], v50
    s_waitcnt vmcnt(12)
    v_smfmac_f32_16x16x64_bf16 v[124:127], a[180:183], v[204:211], v32
    buffer_load_dwordx4 a[228:231], v11, s[16:19], s43 offen offset:2048 sc1
    s_waitcnt lgkmcnt(1)
    v_smfmac_f32_16x16x64_bf16 v[128:131], v[240:243], v[244:251], v10
    v_smfmac_f32_16x16x64_bf16 v[164:167], v[240:243], v[244:251], v10 abid:1
    s_waitcnt lgkmcnt(0)
    v_xad_u32 v236, v236, v3, v4
    v_smfmac_f32_16x16x64_bf16 v[160:163], a[180:183], v[220:227], v32
    ds_read_b128 v[196:199], v1 offset:6144
    ds_read_b128 v[200:203], v2 offset:6144
    s_waitcnt vmcnt(12)
    v_xad_u32 v237, v237, v3, v4
    v_smfmac_f32_16x16x64_bf16 v[128:131], a[184:187], v[204:211], v32 abid:1
    buffer_load_dwordx4 a[232:235], v11, s[16:19], s43 offen offset:3072 sc1
    ds_read2st64_b32 v[244:245], v236 offset0:0 offset1:72
    ds_read2st64_b32 v[246:247], v237 offset0:0 offset1:72
    v_xad_u32 v238, v238, v3, v4
    v_smfmac_f32_16x16x64_bf16 v[164:167], a[184:187], v[220:227], v32 abid:1
    ds_read_b128 v[228:231], v1 offset:24576
    ds_read_b128 v[232:235], v2 offset:24576
    s_waitcnt vmcnt(12)
    v_xad_u32 v239, v239, v3, v4
    v_smfmac_f32_16x16x64_bf16 v[132:135], a[188:191], v[204:211], v33
    s_add_u32 s43, s43, 4096
    buffer_load_dwordx4 a[236:239], v11, s[16:19], s43 offen offset:0 sc1
    ds_read2st64_b32 v[248:249], v238 offset0:0 offset1:72
    ds_read2st64_b32 v[250:251], v239 offset0:0 offset1:72
    ds_read_b128 v[240:243], v8 offset:2048
    ds_read_b128 v[236:239], v9 offset:9216
    v_smfmac_f32_16x16x64_bf16 v[168:171], a[188:191], v[220:227], v33
    s_waitcnt vmcnt(12)
    v_smfmac_f32_16x16x64_bf16 v[136:139], a[192:195], v[204:211], v33 abid:1
    buffer_load_dwordx4 a[240:243], v11, s[16:19], s43 offen offset:1024 sc1
    v_smfmac_f32_16x16x64_bf16 v[172:175], a[192:195], v[220:227], v33 abid:1
    s_waitcnt vmcnt(12)
    v_smfmac_f32_16x16x64_bf16 v[140:143], a[196:199], v[204:211], v34
    buffer_load_dwordx4 a[244:247], v11, s[16:19], s43 offen offset:2048 sc1
    v_smfmac_f32_16x16x64_bf16 v[176:179], a[196:199], v[220:227], v34
    s_waitcnt vmcnt(12)
    v_smfmac_f32_16x16x64_bf16 v[144:147], a[200:203], v[204:211], v34 abid:1
    buffer_load_dwordx4 a[248:251], v11, s[16:19], s43 offen offset:3072 sc1
    s_waitcnt lgkmcnt(1)
    v_smfmac_f32_16x16x64_bf16 v[132:135], v[240:243], v[244:251], v10
    v_smfmac_f32_16x16x64_bf16 v[168:171], v[240:243], v[244:251], v10 abid:1
    s_waitcnt lgkmcnt(0)
    v_xad_u32 v236, v236, v3, v4
    v_smfmac_f32_16x16x64_bf16 v[180:183], a[200:203], v[220:227], v34 abid:1
    s_waitcnt vmcnt(12)
    v_xad_u32 v237, v237, v3, v4
    v_smfmac_f32_16x16x64_bf16 v[148:151], a[204:207], v[204:211], v35
    s_add_u32 s43, s43, 4096
    buffer_load_dwordx4 v[40:43], v11, s[16:19], s43 offen offset:0 sc1
    buffer_load_dwordx4 a[252:255], v11, s[16:19], s43 offen offset:1024 sc1
    ds_read2st64_b32 v[244:245], v236 offset0:0 offset1:72
    ds_read2st64_b32 v[246:247], v237 offset0:0 offset1:72
    v_xad_u32 v238, v238, v3, v4
    v_smfmac_f32_16x16x64_bf16 v[184:187], a[204:207], v[220:227], v35
    s_waitcnt vmcnt(13)
    v_xad_u32 v239, v239, v3, v4
    v_smfmac_f32_16x16x64_bf16 v[152:155], a[208:211], v[204:211], v35 abid:1
    buffer_load_dwordx4 v[56:59], v11, s[16:19], s43 offen offset:2048 sc1
    ds_read2st64_b32 v[248:249], v238 offset0:0 offset1:72
    ds_read2st64_b32 v[250:251], v239 offset0:0 offset1:72
    ds_read_b128 v[240:243], v8 offset:0
    ds_read_b128 v[236:239], v9 offset:9728
    v_smfmac_f32_16x16x64_bf16 v[188:191], a[208:211], v[220:227], v35 abid:1
    s_waitcnt vmcnt(13)
    v_smfmac_f32_16x16x64_bf16 v[156:159], a[212:215], v[204:211], v50 abid:1
    buffer_load_dwordx4 v[60:63], v11, s[16:19], s43 offen offset:3072 sc1
    v_smfmac_f32_16x16x64_bf16 v[192:195], a[212:215], v[220:227], v50 abid:1
    s_waitcnt vmcnt(12)
    v_smfmac_f32_16x16x64_bf16 v[124:127], a[216:219], v[196:203], v36
    s_add_u32 s43, s43, 4096
    buffer_load_dwordx4 v[64:67], v11, s[16:19], s43 offen offset:0 sc1
    v_smfmac_f32_16x16x64_bf16 v[160:163], a[216:219], v[228:235], v36
    ds_read_b128 v[204:207], v1 offset:7168
    ds_read_b128 v[208:211], v2 offset:7168
    s_waitcnt vmcnt(12)
    v_smfmac_f32_16x16x64_bf16 v[128:131], a[220:223], v[196:203], v36 abid:1
    buffer_load_dwordx4 v[68:71], v11, s[16:19], s43 offen offset:1024 sc1
    s_waitcnt lgkmcnt(3)
    v_smfmac_f32_16x16x64_bf16 v[124:127], v[240:243], v[244:251], v10
    v_smfmac_f32_16x16x64_bf16 v[160:163], v[240:243], v[244:251], v10 abid:1
    s_waitcnt lgkmcnt(2)
    v_xad_u32 v236, v236, v3, v4
    v_smfmac_f32_16x16x64_bf16 v[164:167], a[220:223], v[228:235], v36 abid:1
    ds_read_b128 v[220:223], v1 offset:25600
    ds_read_b128 v[224:227], v2 offset:25600
    s_waitcnt vmcnt(12)
    v_xad_u32 v237, v237, v3, v4
    v_smfmac_f32_16x16x64_bf16 v[132:135], a[224:227], v[196:203], v37
    buffer_load_dwordx4 v[72:75], v11, s[16:19], s43 offen offset:2048 sc1
    ds_read2st64_b32 v[244:245], v236 offset0:0 offset1:72
    ds_read2st64_b32 v[246:247], v237 offset0:0 offset1:72
    v_xad_u32 v238, v238, v3, v4
    v_smfmac_f32_16x16x64_bf16 v[168:171], a[224:227], v[228:235], v37
    s_waitcnt vmcnt(12)
    v_xad_u32 v239, v239, v3, v4
    v_smfmac_f32_16x16x64_bf16 v[136:139], a[228:231], v[196:203], v37 abid:1
    buffer_load_dwordx4 v[76:79], v11, s[16:19], s43 offen offset:3072 sc1
    ds_read2st64_b32 v[248:249], v238 offset0:0 offset1:72
    ds_read2st64_b32 v[250:251], v239 offset0:0 offset1:72
    ds_read_b128 v[240:243], v8 offset:8192
    ds_read_b128 v[236:239], v9 offset:9664
    v_smfmac_f32_16x16x64_bf16 v[172:175], a[228:231], v[228:235], v37 abid:1
    s_waitcnt vmcnt(12)
    v_smfmac_f32_16x16x64_bf16 v[140:143], a[232:235], v[196:203], v38
    s_add_u32 s43, s43, 4096
    buffer_load_dwordx4 v[80:83], v11, s[16:19], s43 offen offset:0 sc1
    v_smfmac_f32_16x16x64_bf16 v[176:179], a[232:235], v[228:235], v38
    s_waitcnt vmcnt(12)
    v_smfmac_f32_16x16x64_bf16 v[144:147], a[236:239], v[196:203], v38 abid:1
    buffer_load_dwordx4 v[84:87], v11, s[16:19], s43 offen offset:1024 sc1
    v_smfmac_f32_16x16x64_bf16 v[180:183], a[236:239], v[228:235], v38 abid:1
    s_waitcnt vmcnt(12)
    v_smfmac_f32_16x16x64_bf16 v[148:151], a[240:243], v[196:203], v39
    buffer_load_dwordx4 v[44:47], v11, s[16:19], s43 offen offset:2048 sc1
    buffer_load_dwordx4 v[88:91], v11, s[16:19], s43 offen offset:3072 sc1
    s_waitcnt lgkmcnt(1)
    v_smfmac_f32_16x16x64_bf16 v[156:159], v[240:243], v[244:251], v10
    v_smfmac_f32_16x16x64_bf16 v[192:195], v[240:243], v[244:251], v10 abid:1
    s_waitcnt lgkmcnt(0)
    v_xad_u32 v236, v236, v3, v4
    v_smfmac_f32_16x16x64_bf16 v[184:187], a[240:243], v[228:235], v39
    s_waitcnt vmcnt(13)
    v_xad_u32 v237, v237, v3, v4
    v_smfmac_f32_16x16x64_bf16 v[152:155], a[244:247], v[196:203], v39 abid:1
    s_add_u32 s43, s43, 4096
    buffer_load_dwordx4 v[92:95], v11, s[16:19], s43 offen offset:0 sc1
    ds_read2st64_b32 v[244:245], v236 offset0:0 offset1:72
    ds_read2st64_b32 v[246:247], v237 offset0:0 offset1:72
    v_xad_u32 v238, v238, v3, v4
    v_smfmac_f32_16x16x64_bf16 v[188:191], a[244:247], v[228:235], v39 abid:1
    s_waitcnt vmcnt(13)
    v_xad_u32 v239, v239, v3, v4
    v_smfmac_f32_16x16x64_bf16 v[156:159], a[248:251], v[196:203], v51
    buffer_load_dwordx4 v[96:99], v11, s[16:19], s43 offen offset:1024 sc1
    ds_read2st64_b32 v[248:249], v238 offset0:0 offset1:72
    ds_read2st64_b32 v[250:251], v239 offset0:0 offset1:72
    ds_read_b128 v[240:243], v8 offset:7168
    ds_read_b128 v[236:239], v9 offset:9536
    v_smfmac_f32_16x16x64_bf16 v[192:195], a[248:251], v[228:235], v51
    s_waitcnt vmcnt(12)
    v_smfmac_f32_16x16x64_bf16 v[124:127], a[252:255], v[204:211], v40
    buffer_load_dwordx4 v[100:103], v11, s[16:19], s43 offen offset:2048 sc1
    ds_read_b128 v[196:199], v1 offset:8192
    ds_read_b128 v[200:203], v2 offset:8192
    s_waitcnt vmcnt(12)
    v_smfmac_f32_16x16x64_bf16 v[128:131], v[56:59], v[204:211], v40 abid:1
    buffer_load_dwordx4 v[104:107], v11, s[16:19], s43 offen offset:3072 sc1
    ds_read_b128 v[228:231], v1 offset:26624
    ds_read_b128 v[232:235], v2 offset:26624
    s_waitcnt vmcnt(12)
    v_smfmac_f32_16x16x64_bf16 v[132:135], v[60:63], v[204:211], v41
    s_add_u32 s43, s43, 4096
    buffer_load_dwordx4 v[108:111], v11, s[16:19], s43 offen offset:0 sc1
    s_waitcnt lgkmcnt(5)
    v_smfmac_f32_16x16x64_bf16 v[152:155], v[240:243], v[244:251], v10
    v_smfmac_f32_16x16x64_bf16 v[188:191], v[240:243], v[244:251], v10 abid:1
    s_waitcnt lgkmcnt(4)
    v_xad_u32 v236, v236, v3, v4
    s_waitcnt vmcnt(12)
    v_xad_u32 v237, v237, v3, v4
    v_smfmac_f32_16x16x64_bf16 v[136:139], v[64:67], v[204:211], v41 abid:1
    buffer_load_dwordx4 v[112:115], v11, s[16:19], s43 offen offset:1024 sc1
    ds_read2st64_b32 v[244:245], v236 offset0:0 offset1:72
    ds_read2st64_b32 v[246:247], v237 offset0:0 offset1:72
    v_xad_u32 v238, v238, v3, v4
    s_waitcnt vmcnt(12)
    v_xad_u32 v239, v239, v3, v4
    v_smfmac_f32_16x16x64_bf16 v[140:143], v[68:71], v[204:211], v42
    buffer_load_dwordx4 v[116:119], v11, s[16:19], s43 offen offset:2048 sc1
    ds_read2st64_b32 v[248:249], v238 offset0:0 offset1:72
    ds_read2st64_b32 v[250:251], v239 offset0:0 offset1:72
    ds_read_b128 v[240:243], v8 offset:5120
    ds_read_b128 v[236:239], v9 offset:9600
    s_waitcnt vmcnt(12)
    v_smfmac_f32_16x16x64_bf16 v[144:147], v[72:75], v[204:211], v42 abid:1
    buffer_load_dwordx4 v[120:123], v11, s[16:19], s43 offen offset:3072 sc1
    s_waitcnt vmcnt(12)
    v_smfmac_f32_16x16x64_bf16 v[148:151], v[76:79], v[204:211], v43
    s_add_u32 m0, s29, 11840
    s_nop 0
    buffer_load_dword v0, s[8:11], 0 offen lds
    s_mov_b32 m0, s42
    s_nop 0
    buffer_load_dwordx4 v5, s[8:11], s22 offen offset:0 nt lds
    s_waitcnt vmcnt(13)
    v_smfmac_f32_16x16x64_bf16 v[152:155], v[80:83], v[204:211], v43 abid:1
    s_add_u32 m0, m0, 896
    s_nop 0
    buffer_load_dwordx4 v5, s[8:11], s22 offen offset:128 nt lds
    s_waitcnt lgkmcnt(1)
    v_smfmac_f32_16x16x64_bf16 v[144:147], v[240:243], v[244:251], v10
    v_smfmac_f32_16x16x64_bf16 v[180:183], v[240:243], v[244:251], v10 abid:1
    s_waitcnt lgkmcnt(0)
    v_xad_u32 v236, v236, v3, v4
    s_waitcnt vmcnt(13)
    v_xad_u32 v237, v237, v3, v4
    v_smfmac_f32_16x16x64_bf16 v[156:159], v[84:87], v[204:211], v51 abid:1
    s_add_u32 m0, m0, 896
    s_nop 0
    buffer_load_dwordx4 v5, s[8:11], s22 offen offset:256 nt lds
    ds_read2st64_b32 v[244:245], v236 offset0:0 offset1:72
    ds_read2st64_b32 v[246:247], v237 offset0:0 offset1:72
    v_xad_u32 v238, v238, v3, v4
    s_waitcnt vmcnt(12)
    v_xad_u32 v239, v239, v3, v4
    v_smfmac_f32_16x16x64_bf16 v[124:127], v[88:91], v[196:203], v44
    s_add_u32 m0, m0, 896
    s_nop 0
    buffer_load_dwordx4 v5, s[8:11], s22 offen offset:384 nt lds
    ds_read2st64_b32 v[248:249], v238 offset0:0 offset1:72
    ds_read2st64_b32 v[250:251], v239 offset0:0 offset1:72
    ds_read_b128 v[240:243], v8 offset:6144
    ds_read_b128 v[236:239], v9 offset:9472
    s_waitcnt vmcnt(12)
    v_smfmac_f32_16x16x64_bf16 v[128:131], v[92:95], v[196:203], v44 abid:1
    s_waitcnt vmcnt(11)
    v_smfmac_f32_16x16x64_bf16 v[132:135], v[96:99], v[196:203], v45
    s_waitcnt vmcnt(10)
    v_smfmac_f32_16x16x64_bf16 v[136:139], v[100:103], v[196:203], v45 abid:1
    s_waitcnt lgkmcnt(1)
    v_smfmac_f32_16x16x64_bf16 v[148:151], v[240:243], v[244:251], v10
    v_smfmac_f32_16x16x64_bf16 v[184:187], v[240:243], v[244:251], v10 abid:1
    s_waitcnt lgkmcnt(0)
    v_xad_u32 v236, v236, v3, v4
    s_waitcnt vmcnt(9)
    v_xad_u32 v237, v237, v3, v4
    v_smfmac_f32_16x16x64_bf16 v[140:143], v[104:107], v[196:203], v46
    ds_read2st64_b32 v[244:245], v236 offset0:0 offset1:72
    ds_read2st64_b32 v[246:247], v237 offset0:0 offset1:72
    v_xad_u32 v238, v238, v3, v4
    s_waitcnt vmcnt(8)
    v_xad_u32 v239, v239, v3, v4
    v_smfmac_f32_16x16x64_bf16 v[144:147], v[108:111], v[196:203], v46 abid:1
    ds_read2st64_b32 v[248:249], v238 offset0:0 offset1:72
    ds_read2st64_b32 v[250:251], v239 offset0:0 offset1:72
    ds_read_b128 v[240:243], v8 offset:4096
    s_waitcnt vmcnt(7)
    v_smfmac_f32_16x16x64_bf16 v[148:151], v[112:115], v[196:203], v47
    s_waitcnt vmcnt(6)
    v_smfmac_f32_16x16x64_bf16 v[152:155], v[116:119], v[196:203], v47 abid:1
    s_waitcnt vmcnt(5)
    v_smfmac_f32_16x16x64_bf16 v[156:159], v[120:123], v[196:203], v52
    s_waitcnt lgkmcnt(0)
    v_smfmac_f32_16x16x64_bf16 v[140:143], v[240:243], v[244:251], v10
    v_smfmac_f32_16x16x64_bf16 v[176:179], v[240:243], v[244:251], v10 abid:1
    s_cmp_gt_u32 s46, s80
    s_cbranch_scc1 M_slow
M_slowr0:
    s_cmp_eq_u32 s20, 0
    s_mov_b32 s31, 1073903880
    s_cselect_b32 s30, 162048, s31
    v_mov_b32 v11, s31
    v_writelane_b32 v11, s30, 0
    v_cvt_pk_bf16_f32 v124, v124, v125
    v_cvt_pk_bf16_f32 v125, v126, v127
    v_cvt_pk_bf16_f32 v126, v128, v129
    v_cvt_pk_bf16_f32 v127, v130, v131
    v_cvt_pk_bf16_f32 v132, v132, v133
    v_cvt_pk_bf16_f32 v133, v134, v135
    v_cvt_pk_bf16_f32 v134, v136, v137
    v_cvt_pk_bf16_f32 v135, v138, v139
    ds_read_b128 v[136:139], v9 offset:10432
    v_cndmask_b32_dpp v128, v124, v132, vcc row_ror:8 row_mask:0xf bank_mask:0xf
    v_cndmask_b32_dpp v129, v125, v133, vcc row_ror:8 row_mask:0xf bank_mask:0xf
    v_cndmask_b32_dpp v130, v126, v134, vcc row_ror:8 row_mask:0xf bank_mask:0xf
    v_cndmask_b32_dpp v131, v127, v135, vcc row_ror:8 row_mask:0xf bank_mask:0xf
    buffer_store_dwordx4 v[128:131], v6, s[12:15], s59 offen offset:0 sc1
    v_mov_b32_dpp v124, v132 row_ror:8 row_mask:0xf bank_mask:0xc
    v_mov_b32_dpp v125, v133 row_ror:8 row_mask:0xf bank_mask:0xc
    v_mov_b32_dpp v126, v134 row_ror:8 row_mask:0xf bank_mask:0xc
    v_mov_b32_dpp v127, v135 row_ror:8 row_mask:0xf bank_mask:0xc
    buffer_store_dwordx4 v[124:127], v6, s[12:15], s24 offen offset:0 sc1
    ds_read_b128 v[128:131], v9 offset:10304
    ds_read_b128 v[132:135], v9 offset:10368
    ds_read_b128 v[124:127], v9 offset:10240
    v_cvt_pk_bf16_f32 v140, v140, v141
    v_cvt_pk_bf16_f32 v141, v142, v143
    v_cvt_pk_bf16_f32 v142, v144, v145
    v_cvt_pk_bf16_f32 v143, v146, v147
    v_cvt_pk_bf16_f32 v148, v148, v149
    v_cvt_pk_bf16_f32 v149, v150, v151
    v_cvt_pk_bf16_f32 v150, v152, v153
    v_cvt_pk_bf16_f32 v151, v154, v155
    ds_read_b128 v[152:155], v9 offset:10688
    v_cndmask_b32_dpp v144, v140, v148, vcc row_ror:8 row_mask:0xf bank_mask:0xf
    v_cndmask_b32_dpp v145, v141, v149, vcc row_ror:8 row_mask:0xf bank_mask:0xf
    v_cndmask_b32_dpp v146, v142, v150, vcc row_ror:8 row_mask:0xf bank_mask:0xf
    v_cndmask_b32_dpp v147, v143, v151, vcc row_ror:8 row_mask:0xf bank_mask:0xf
    buffer_store_dwordx4 v[144:147], v6, s[12:15], s59 offen offset:128 sc1
    v_mov_b32_dpp v140, v148 row_ror:8 row_mask:0xf bank_mask:0xc
    v_mov_b32_dpp v141, v149 row_ror:8 row_mask:0xf bank_mask:0xc
    v_mov_b32_dpp v142, v150 row_ror:8 row_mask:0xf bank_mask:0xc
    v_mov_b32_dpp v143, v151 row_ror:8 row_mask:0xf bank_mask:0xc
    buffer_store_dwordx4 v[140:143], v6, s[12:15], s24 offen offset:128 sc1
    ds_read_b128 v[144:147], v9 offset:10560
    ds_read_b128 v[148:151], v9 offset:10624
    ds_read_b128 v[140:143], v9 offset:10496
    v_cvt_pk_bf16_f32 v156, v156, v157
    v_cvt_pk_bf16_f32 v157, v158, v159
    ds_write_b64 v53, v[156:157] offset:25728
    ds_read_b128 v[156:159], v9 offset:10752
    s_mov_b32 s89, 0
    s_mov_b32 s101, 34209792
    s_mov_b32 s91, 0
    s_mov_b32 s25, 36864
    s_add_u32 s90, s24, 9437184
    s_mov_b32 s28, s26
    s_add_u32 s23, s24, 18432
    s_cmp_lt_u32 s20, 2
    s_cselect_b32 s66, s23, s24
    s_cselect_b32 s99, s14, 75497472
    s_add_u32 s66, s66, s95
    v_add_u32 v4, 36864, v4
    v_add_u32 v1, 36864, v1
    v_add_u32 v2, 36864, v2
M_top:
M_top1:
    s_add_u32 s23, s24, 18432
    s_add_u32 s58, s24, 27648
    s_mov_b32 s24, s90
    s_add_u32 s59, s90, 9216
    s_waitcnt lgkmcnt(0)
    s_barrier
    ds_read_b128 v[244:247], v8 offset:10816
    v_smfmac_f32_16x16x64_bf16 v[160:163], a[252:255], v[220:227], v40
    ds_read_b128 v[196:199], v1 offset:0
    v_smfmac_f32_16x16x64_bf16 v[160:163], v[88:91], v[228:235], v44
    ds_read_b128 v[200:203], v2 offset:0
    s_cmp_lt_u32 s22, 75497472
    s_cbranch_scc0 M_bF
    s_cmp_lt_u32 s91, 2
    s_cbranch_scc1 M_bE0
M_bL:
    v_smfmac_f32_16x16x64_bf16 v[164:167], v[56:59], v[220:227], v40 abid:1
    ds_read_b128 v[204:207], v1 offset:1024
    v_smfmac_f32_16x16x64_bf16 v[164:167], v[92:95], v[228:235], v44 abid:1
    ds_read_b128 v[208:211], v2 offset:1024
    v_mov_b32 v0, 1
    v_smfmac_f32_16x16x64_bf16 v[168:171], v[60:63], v[220:227], v41
    ds_read_b128 v[212:215], v1 offset:2048
    v_smfmac_f32_16x16x64_bf16 v[168:171], v[96:99], v[228:235], v45
    ds_read_b128 v[216:219], v2 offset:2048
    v_smfmac_f32_16x16x64_bf16 v[172:175], v[64:67], v[220:227], v41 abid:1
    s_waitcnt vmcnt(6)
    s_waitcnt lgkmcnt(6)
    buffer_store_dwordx4 v[244:247], v7, s[12:15], s66 offen sc1
    v_smfmac_f32_16x16x64_bf16 v[172:175], v[100:103], v[228:235], v45 abid:1
    ds_read_b128 v[236:239], v9 offset:9408
    v_smfmac_f32_16x16x64_bf16 v[176:179], v[68:71], v[220:227], v42
    s_waitcnt vmcnt(7)
    buffer_atomic_add v0, v11, s[16:19], s92 offen sc0 sc1
    s_mov_b32 s21, 1
    v_smfmac_f32_16x16x64_bf16 v[176:179], v[104:107], v[228:235], v46
    v_smfmac_f32_16x16x64_bf16 v[180:183], v[72:75], v[220:227], v42 abid:1
    v_cvt_pk_bf16_f32 v160, v160, v161
    v_smfmac_f32_16x16x64_bf16 v[180:183], v[108:111], v[228:235], v46 abid:1
    v_cvt_pk_bf16_f32 v161, v162, v163
    v_smfmac_f32_16x16x64_bf16 v[184:187], v[76:79], v[220:227], v43
    v_cvt_pk_bf16_f32 v162, v164, v165
    v_smfmac_f32_16x16x64_bf16 v[184:187], v[112:115], v[228:235], v47
    v_cvt_pk_bf16_f32 v163, v166, v167
    v_smfmac_f32_16x16x64_bf16 v[188:191], v[80:83], v[220:227], v43 abid:1
    s_add_u32 m0, m0, 896
    v_cvt_pk_bf16_f32 v168, v168, v169
    v_smfmac_f32_16x16x64_bf16 v[188:191], v[116:119], v[228:235], v47 abid:1
    s_waitcnt vmcnt(6)
    buffer_load_dwordx4 v5, s[8:11], s22 offen offset:512 nt lds
    v_cvt_pk_bf16_f32 v169, v170, v171
    v_smfmac_f32_16x16x64_bf16 v[192:195], v[84:87], v[220:227], v51 abid:1
    v_cvt_pk_bf16_f32 v170, v172, v173
    v_smfmac_f32_16x16x64_bf16 v[192:195], v[120:123], v[228:235], v52
    ds_read_b128 v[220:223], v1 offset:3072
    s_waitcnt lgkmcnt(6)
    v_cvt_pk_bf16_f32 v171, v174, v175
    v_smfmac_f32_16x16x64_bf16 v[124:127], a[0:3], v[196:203], v12
    ds_read_b128 v[224:227], v2 offset:3072
    ds_read_b128 v[172:175], v9 offset:10432
    s_waitcnt lgkmcnt(6)
    v_cndmask_b32_dpp v164, v160, v168, vcc row_ror:8 row_mask:0xf bank_mask:0xf
    v_smfmac_f32_16x16x64_bf16 v[124:127], a[36:39], v[204:211], v16
    ds_read_b128 v[228:231], v1 offset:4096
    s_waitcnt lgkmcnt(5)
    v_cndmask_b32_dpp v165, v161, v169, vcc row_ror:8 row_mask:0xf bank_mask:0xf
    v_smfmac_f32_16x16x64_bf16 v[124:127], a[72:75], v[212:219], v20
    ds_read_b128 v[232:235], v2 offset:4096
    v_cndmask_b32_dpp v166, v162, v170, vcc row_ror:8 row_mask:0xf bank_mask:0xf
    v_smfmac_f32_16x16x64_bf16 v[128:131], a[4:7], v[196:203], v12 abid:1
    s_barrier
    v_cndmask_b32_dpp v167, v163, v171, vcc row_ror:8 row_mask:0xf bank_mask:0xf
    v_smfmac_f32_16x16x64_bf16 v[128:131], a[40:43], v[204:211], v16 abid:1
    s_waitcnt vmcnt(7)
    buffer_store_dwordx4 v[164:167], v6, s[12:15], s58 offen offset:0 sc1
    s_waitcnt lgkmcnt(5)
    v_xad_u32 v236, v236, v3, v4
    v_smfmac_f32_16x16x64_bf16 v[128:131], a[76:79], v[212:219], v20 abid:1
    v_xad_u32 v237, v237, v3, v4
    v_smfmac_f32_16x16x64_bf16 v[132:135], a[8:11], v[196:203], v13
    ds_read2st64_b32 v[244:245], v236 offset0:0 offset1:72
    ds_read_b128 v[240:243], v8 offset:3072
    v_xad_u32 v238, v238, v3, v4
    v_smfmac_f32_16x16x64_bf16 v[132:135], a[44:47], v[204:211], v17
    ds_read2st64_b32 v[246:247], v237 offset0:0 offset1:72
    v_xad_u32 v239, v239, v3, v4
    v_smfmac_f32_16x16x64_bf16 v[132:135], a[80:83], v[212:219], v21
    ds_read2st64_b32 v[248:249], v238 offset0:0 offset1:72
    v_mov_b32_dpp v160, v168 row_ror:8 row_mask:0xf bank_mask:0xc
    v_smfmac_f32_16x16x64_bf16 v[144:147], a[20:23], v[196:203], v14 abid:1
    ds_read2st64_b32 v[250:251], v239 offset0:0 offset1:72
    ds_read_b128 v[236:239], v9 offset:9280
    v_mov_b32_dpp v161, v169 row_ror:8 row_mask:0xf bank_mask:0xc
    v_smfmac_f32_16x16x64_bf16 v[144:147], a[56:59], v[204:211], v18 abid:1
    v_mov_b32_dpp v162, v170 row_ror:8 row_mask:0xf bank_mask:0xc
    v_smfmac_f32_16x16x64_bf16 v[144:147], a[92:95], v[212:219], v22 abid:1
    v_mov_b32_dpp v163, v171 row_ror:8 row_mask:0xf bank_mask:0xc
    v_smfmac_f32_16x16x64_bf16 v[140:143], a[16:19], v[196:203], v14
    s_waitcnt vmcnt(6)
    buffer_store_dwordx4 v[160:163], v6, s[12:15], s23 offen offset:0 sc1
    ds_read_b128 v[164:167], v9 offset:10304
    v_smfmac_f32_16x16x64_bf16 v[140:143], a[52:55], v[204:211], v18
    ds_read_b128 v[168:171], v9 offset:10368
    ds_read_b128 v[160:163], v9 offset:10240
    v_smfmac_f32_16x16x64_bf16 v[140:143], a[88:91], v[212:219], v22
    v_smfmac_f32_16x16x64_bf16 v[136:139], a[12:15], v[196:203], v13 abid:1
    v_smfmac_f32_16x16x64_bf16 v[136:139], a[48:51], v[204:211], v17 abid:1
    v_smfmac_f32_16x16x64_bf16 v[136:139], a[84:87], v[212:219], v21 abid:1
    s_waitcnt lgkmcnt(3)
    v_xad_u32 v236, v236, v3, v4
    v_smfmac_f32_16x16x64_bf16 v[136:139], v[240:243], v[244:251], v10
    v_xad_u32 v237, v237, v3, v4
    v_smfmac_f32_16x16x64_bf16 v[172:175], v[240:243], v[244:251], v10 abid:1
    ds_read2st64_b32 v[244:245], v236 offset0:0 offset1:72
    ds_read_b128 v[240:243], v8 offset:1024
    v_xad_u32 v238, v238, v3, v4
    v_smfmac_f32_16x16x64_bf16 v[148:151], a[24:27], v[196:203], v15
    ds_read2st64_b32 v[246:247], v237 offset0:0 offset1:72
    v_xad_u32 v239, v239, v3, v4
    v_smfmac_f32_16x16x64_bf16 v[148:151], a[60:63], v[204:211], v19
    ds_read2st64_b32 v[248:249], v238 offset0:0 offset1:72
    v_cvt_pk_bf16_f32 v192, v192, v193
    v_smfmac_f32_16x16x64_bf16 v[148:151], a[96:99], v[212:219], v23
    ds_read2st64_b32 v[250:251], v239 offset0:0 offset1:72
    ds_read_b128 v[236:239], v9 offset:9344
    v_cvt_pk_bf16_f32 v193, v194, v195
    v_smfmac_f32_16x16x64_bf16 v[152:155], a[28:31], v[196:203], v15 abid:1
    ds_write_b64 v53, v[192:193] offset:0
    ds_read_b128 v[192:195], v9 offset:10752
    v_smfmac_f32_16x16x64_bf16 v[152:155], a[64:67], v[204:211], v19 abid:1
    s_add_u32 m0, m0, 896
    v_smfmac_f32_16x16x64_bf16 v[152:155], a[100:103], v[212:219], v23 abid:1
    s_waitcnt vmcnt(7)
    buffer_load_dwordx4 v5, s[8:11], s22 offen offset:640 nt lds
    v_smfmac_f32_16x16x64_bf16 v[156:159], a[32:35], v[196:203], v48
    v_smfmac_f32_16x16x64_bf16 v[156:159], a[68:71], v[204:211], v48 abid:1
    v_smfmac_f32_16x16x64_bf16 v[156:159], a[104:107], v[212:219], v49
    ds_read_b128 v[196:199], v1 offset:5120
    v_cvt_pk_bf16_f32 v176, v176, v177
    v_smfmac_f32_16x16x64_bf16 v[124:127], a[108:111], v[220:227], v24
    ds_read_b128 v[200:203], v2 offset:5120
    v_cvt_pk_bf16_f32 v177, v178, v179
    v_smfmac_f32_16x16x64_bf16 v[124:127], a[144:147], v[228:235], v28
    ds_read_b128 v[204:207], v1 offset:6144
    ds_read_b64 v[216:217], v9 offset:10056
    v_cvt_pk_bf16_f32 v178, v180, v181
    v_smfmac_f32_16x16x64_bf16 v[128:131], a[112:115], v[220:227], v24 abid:1
    ds_read_b128 v[208:211], v2 offset:6144
    v_cvt_pk_bf16_f32 v179, v182, v183
    v_smfmac_f32_16x16x64_bf16 v[128:131], a[148:151], v[228:235], v28 abid:1
    s_waitcnt lgkmcnt(7)
    v_xad_u32 v236, v236, v3, v4
    v_smfmac_f32_16x16x64_bf16 v[128:131], v[240:243], v[244:251], v10
    s_add_u32 m0, m0, 896
    v_xad_u32 v237, v237, v3, v4
    v_smfmac_f32_16x16x64_bf16 v[164:167], v[240:243], v[244:251], v10 abid:1
    ds_read2st64_b32 v[244:245], v236 offset0:0 offset1:72
    ds_read_b128 v[240:243], v8 offset:2048
    v_xad_u32 v238, v238, v3, v4
    v_smfmac_f32_16x16x64_bf16 v[152:155], a[136:139], v[220:227], v27 abid:1
    ds_read2st64_b32 v[246:247], v237 offset0:0 offset1:72
    s_waitcnt vmcnt(6)
    v_xad_u32 v239, v239, v3, v4
    v_smfmac_f32_16x16x64_bf16 v[152:155], a[172:175], v[228:235], v31 abid:1
    ds_read2st64_b32 v[248:249], v238 offset0:0 offset1:72
    buffer_load_dwordx4 v5, s[8:11], s22 offen offset:768 nt lds
    v_cvt_pk_bf16_f32 v184, v184, v185
    v_smfmac_f32_16x16x64_bf16 v[136:139], a[120:123], v[220:227], v25 abid:1
    ds_read2st64_b32 v[250:251], v239 offset0:0 offset1:72
    ds_read_b128 v[236:239], v9 offset:9216
    v_cvt_pk_bf16_f32 v185, v186, v187
    v_smfmac_f32_16x16x64_bf16 v[136:139], a[156:159], v[228:235], v29 abid:1
    v_cvt_pk_bf16_f32 v186, v188, v189
    v_smfmac_f32_16x16x64_bf16 v[140:143], a[124:127], v[220:227], v26
    v_cvt_pk_bf16_f32 v187, v190, v191
    v_smfmac_f32_16x16x64_bf16 v[140:143], a[160:163], v[228:235], v30
    ds_read_b128 v[188:191], v9 offset:10688
    v_cndmask_b32_dpp v180, v176, v184, vcc row_ror:8 row_mask:0xf bank_mask:0xf
    v_smfmac_f32_16x16x64_bf16 v[144:147], a[128:131], v[220:227], v26 abid:1
    v_cndmask_b32_dpp v181, v177, v185, vcc row_ror:8 row_mask:0xf bank_mask:0xf
    v_smfmac_f32_16x16x64_bf16 v[144:147], a[164:167], v[228:235], v30 abid:1
    v_cndmask_b32_dpp v182, v178, v186, vcc row_ror:8 row_mask:0xf bank_mask:0xf
    v_smfmac_f32_16x16x64_bf16 v[148:151], a[132:135], v[220:227], v27
    v_cndmask_b32_dpp v183, v179, v187, vcc row_ror:8 row_mask:0xf bank_mask:0xf
    v_smfmac_f32_16x16x64_bf16 v[148:151], a[168:171], v[228:235], v31
    s_waitcnt vmcnt(7)
    buffer_store_dwordx4 v[180:183], v6, s[12:15], s58 offen offset:128 sc1
    s_waitcnt lgkmcnt(8)
    v_xad_u32 v212, v216, v3, v4
    v_smfmac_f32_16x16x64_bf16 v[132:135], a[116:119], v[220:227], v25
    ds_read2st64_b32 v[212:213], v212 offset0:0 offset1:72
    v_xad_u32 v214, v217, v3, v4
    v_smfmac_f32_16x16x64_bf16 v[132:135], a[152:155], v[228:235], v29
    ds_read2st64_b32 v[214:215], v214 offset0:0 offset1:72
    s_waitcnt lgkmcnt(3)
    v_xad_u32 v236, v236, v3, v4
    v_smfmac_f32_16x16x64_bf16 v[132:135], v[240:243], v[244:251], v10
    v_xad_u32 v237, v237, v3, v4
    v_smfmac_f32_16x16x64_bf16 v[168:171], v[240:243], v[244:251], v10 abid:1
    ds_read2st64_b32 v[244:245], v236 offset0:0 offset1:72
    ds_read_b128 v[240:243], v8 offset:0
    v_xad_u32 v238, v238, v3, v4
    v_smfmac_f32_16x16x64_bf16 v[156:159], a[140:143], v[220:227], v49 abid:1
    ds_read2st64_b32 v[246:247], v237 offset0:0 offset1:72
    v_xad_u32 v239, v239, v3, v4
    v_smfmac_f32_16x16x64_bf16 v[156:159], a[176:179], v[228:235], v50
    ds_read2st64_b32 v[248:249], v238 offset0:0 offset1:72
    ds_read_b128 v[220:223], v1 offset:7168
    v_mov_b32_dpp v176, v184 row_ror:8 row_mask:0xf bank_mask:0xc
    v_smfmac_f32_16x16x64_bf16 v[140:143], a[196:199], v[196:203], v34
    ds_read2st64_b32 v[250:251], v239 offset0:0 offset1:72
    ds_read_b128 v[236:239], v9 offset:9728
    v_mov_b32_dpp v177, v185 row_ror:8 row_mask:0xf bank_mask:0xc
    v_smfmac_f32_16x16x64_bf16 v[140:143], a[232:235], v[204:211], v38
    ds_read_b128 v[224:227], v2 offset:7168
    v_mov_b32_dpp v178, v186 row_ror:8 row_mask:0xf bank_mask:0xc
    v_smfmac_f32_16x16x64_bf16 v[128:131], a[184:187], v[196:203], v32 abid:1
    ds_read_b128 v[228:231], v1 offset:8192
    v_mov_b32_dpp v179, v187 row_ror:8 row_mask:0xf bank_mask:0xc
    v_smfmac_f32_16x16x64_bf16 v[128:131], a[220:223], v[204:211], v36 abid:1
    ds_read_b128 v[232:235], v2 offset:8192
    s_waitcnt vmcnt(6)
    buffer_store_dwordx4 v[176:179], v6, s[12:15], s23 offen offset:128 sc1
    v_smfmac_f32_16x16x64_bf16 v[132:135], a[188:191], v[196:203], v33
    ds_read_b128 v[180:183], v9 offset:10560
    ds_read_b128 v[184:187], v9 offset:10624
    ds_read_b128 v[176:179], v9 offset:10496
    v_smfmac_f32_16x16x64_bf16 v[132:135], a[224:227], v[204:211], v37
    v_smfmac_f32_16x16x64_bf16 v[136:139], a[192:195], v[196:203], v33 abid:1
    v_smfmac_f32_16x16x64_bf16 v[136:139], a[228:231], v[204:211], v37 abid:1
    v_smfmac_f32_16x16x64_bf16 v[124:127], a[180:183], v[196:203], v32
    v_smfmac_f32_16x16x64_bf16 v[124:127], a[216:219], v[204:211], v36
    s_waitcnt vmcnt(7)
    s_waitcnt lgkmcnt(6)
    v_xad_u32 v236, v236, v3, v4
    v_smfmac_f32_16x16x64_bf16 v[124:127], v[240:243], v[244:251], v10
    v_xad_u32 v237, v237, v3, v4
    v_smfmac_f32_16x16x64_bf16 v[160:163], v[240:243], v[244:251], v10 abid:1
    ds_read2st64_b32 v[244:245], v236 offset0:0 offset1:72
    ds_read_b128 v[240:243], v8 offset:8192
    v_xad_u32 v238, v238, v3, v4
    v_smfmac_f32_16x16x64_bf16 v[144:147], a[200:203], v[196:203], v34 abid:1
    ds_read2st64_b32 v[246:247], v237 offset0:0 offset1:72
    v_xad_u32 v239, v239, v3, v4
    v_smfmac_f32_16x16x64_bf16 v[144:147], a[236:239], v[204:211], v38 abid:1
    ds_read2st64_b32 v[248:249], v238 offset0:0 offset1:72
    v_mul_u32_u24 v0, s94, v0
    v_smfmac_f32_16x16x64_bf16 v[148:151], a[204:207], v[196:203], v35
    ds_read2st64_b32 v[250:251], v239 offset0:0 offset1:72
    ds_read_b128 v[236:239], v9 offset:9664
    v_add_u32 v0, s93, v0
    v_smfmac_f32_16x16x64_bf16 v[148:151], a[240:243], v[204:211], v39
    s_waitcnt lgkmcnt(6)
    s_cmp_lt_i32 s81, 0
    s_cbranch_scc1 M_ovrL
    s_swappc_b64 s[78:79], s[72:73]
M_ovrL:
    v_smfmac_f32_16x16x64_bf16 v[152:155], a[208:211], v[196:203], v35 abid:1
    s_add_u32 m0, m0, 896
    v_min_u32 v0, 75497472, v0
    v_smfmac_f32_16x16x64_bf16 v[152:155], a[244:247], v[204:211], v39 abid:1
    ds_write_b32 v11, v0
    s_waitcnt vmcnt(7)
    v_mov_b32 v0, 162048
    v_smfmac_f32_16x16x64_bf16 v[156:159], a[212:215], v[196:203], v50 abid:1
    buffer_load_dwordx4 v5, s[8:11], s22 offen offset:896 nt lds
    v_smfmac_f32_16x16x64_bf16 v[156:159], a[248:251], v[204:211], v51
    ds_read_b128 v[196:199], v1 offset:18432
    v_smfmac_f32_16x16x64_bf16 v[124:127], a[252:255], v[220:227], v40
    ds_read_b128 v[200:203], v2 offset:18432
    v_smfmac_f32_16x16x64_bf16 v[124:127], v[88:91], v[228:235], v44
    ds_read_b128 v[204:207], v1 offset:19456
    v_smfmac_f32_16x16x64_bf16 v[156:159], v[84:87], v[220:227], v51 abid:1
    ds_read_b128 v[208:211], v2 offset:19456
    v_smfmac_f32_16x16x64_bf16 v[156:159], v[120:123], v[228:235], v52
    s_waitcnt lgkmcnt(4)
    s_barrier
    v_xad_u32 v236, v236, v3, v4
    v_smfmac_f32_16x16x64_bf16 v[156:159], v[240:243], v[244:251], v10
    ds_read_b32 v0, v0
    v_xad_u32 v237, v237, v3, v4
    v_smfmac_f32_16x16x64_bf16 v[192:195], v[240:243], v[244:251], v10 abid:1
    ds_read2st64_b32 v[244:245], v236 offset0:0 offset1:72
    ds_read_b128 v[240:243], v8 offset:7168
    v_xad_u32 v238, v238, v3, v4
    v_smfmac_f32_16x16x64_bf16 v[132:135], v[60:63], v[220:227], v41
    ds_read2st64_b32 v[246:247], v237 offset0:0 offset1:72
    v_xad_u32 v239, v239, v3, v4
    v_smfmac_f32_16x16x64_bf16 v[132:135], v[96:99], v[228:235], v45
    ds_read2st64_b32 v[248:249], v238 offset0:0 offset1:72
    s_add_u32 m0, m0, 896
    v_smfmac_f32_16x16x64_bf16 v[136:139], v[64:67], v[220:227], v41 abid:1
    ds_read2st64_b32 v[250:251], v239 offset0:0 offset1:72
    ds_read_b128 v[236:239], v9 offset:9536
    s_waitcnt vmcnt(6)
    v_smfmac_f32_16x16x64_bf16 v[136:139], v[100:103], v[228:235], v45 abid:1
    buffer_load_dwordx4 v5, s[8:11], s22 offen offset:1024 nt lds
    s_waitcnt lgkmcnt(6)
    v_readfirstlane_b32 s88, v0
    v_smfmac_f32_16x16x64_bf16 v[140:143], v[68:71], v[220:227], v42
    s_cmp_lt_u32 s88, s99
    s_cselect_b32 s10, 75497472, 0
    v_smfmac_f32_16x16x64_bf16 v[140:143], v[104:107], v[228:235], v46
    v_smfmac_f32_16x16x64_bf16 v[144:147], v[72:75], v[220:227], v42 abid:1
    ds_read_b128 v[212:215], v1 offset:20480
    v_smfmac_f32_16x16x64_bf16 v[144:147], v[108:111], v[228:235], v46 abid:1
    ds_read_b128 v[216:219], v2 offset:20480
    v_smfmac_f32_16x16x64_bf16 v[148:151], v[76:79], v[220:227], v43
    v_smfmac_f32_16x16x64_bf16 v[148:151], v[112:115], v[228:235], v47
    v_smfmac_f32_16x16x64_bf16 v[152:155], v[80:83], v[220:227], v43 abid:1
    v_smfmac_f32_16x16x64_bf16 v[152:155], v[116:119], v[228:235], v47 abid:1
    s_waitcnt lgkmcnt(2)
    v_xad_u32 v236, v236, v3, v4
    v_smfmac_f32_16x16x64_bf16 v[152:155], v[240:243], v[244:251], v10
    v_xad_u32 v237, v237, v3, v4
    v_smfmac_f32_16x16x64_bf16 v[188:191], v[240:243], v[244:251], v10 abid:1
    s_cmp_gt_u32 s46, s80
    s_cbranch_scc1 M_slow
M_slowrL:
    v_xad_u32 v238, v238, v3, v4
    v_smfmac_f32_16x16x64_bf16 v[128:131], v[56:59], v[220:227], v40 abid:1
    ds_read2st64_b32 v[244:245], v236 offset0:0 offset1:72
    ds_read_b128 v[240:243], v8 offset:5120
    v_xad_u32 v239, v239, v3, v4
    v_smfmac_f32_16x16x64_bf16 v[128:131], v[92:95], v[228:235], v44 abid:1
    ds_read2st64_b32 v[246:247], v237 offset0:0 offset1:72
    ds_read_b128 v[220:223], v1 offset:21504
    v_smfmac_f32_16x16x64_bf16 v[160:163], a[0:3], v[196:203], v12
    ds_read2st64_b32 v[248:249], v238 offset0:0 offset1:72
    ds_read_b128 v[224:227], v2 offset:21504
    v_smfmac_f32_16x16x64_bf16 v[160:163], a[36:39], v[204:211], v16
    ds_read2st64_b32 v[250:251], v239 offset0:0 offset1:72
    ds_read_b128 v[236:239], v9 offset:9600
    s_waitcnt lgkmcnt(8)
    v_smfmac_f32_16x16x64_bf16 v[160:163], a[72:75], v[212:219], v20
    ds_read_b128 v[228:231], v1 offset:22528
    v_smfmac_f32_16x16x64_bf16 v[164:167], a[4:7], v[196:203], v12 abid:1
    ds_read_b128 v[232:235], v2 offset:22528
    v_cvt_pk_bf16_f32 v156, v156, v157
    v_smfmac_f32_16x16x64_bf16 v[164:167], a[40:43], v[204:211], v16 abid:1
    s_mov_b32 m0, s28
    v_cvt_pk_bf16_f32 v157, v158, v159
    v_smfmac_f32_16x16x64_bf16 v[164:167], a[76:79], v[212:219], v20 abid:1
    ds_write_b64 v53, v[156:157] offset:25728
    ds_read_b128 v[156:159], v9 offset:10752
    s_waitcnt vmcnt(7)
    v_smfmac_f32_16x16x64_bf16 v[180:183], a[20:23], v[196:203], v14 abid:1
    buffer_load_dwordx4 v5, s[8:11], s88 offen offset:0 nt lds
    v_smfmac_f32_16x16x64_bf16 v[180:183], a[56:59], v[204:211], v18 abid:1
    v_cvt_pk_bf16_f32 v124, v124, v125
    v_smfmac_f32_16x16x64_bf16 v[180:183], a[92:95], v[212:219], v22 abid:1
    s_waitcnt lgkmcnt(4)
    v_xad_u32 v236, v236, v3, v4
    v_smfmac_f32_16x16x64_bf16 v[180:183], v[240:243], v[244:251], v10 abid:1
    v_xad_u32 v237, v237, v3, v4
    v_smfmac_f32_16x16x64_bf16 v[144:147], v[240:243], v[244:251], v10
    ds_read2st64_b32 v[244:245], v236 offset0:0 offset1:72
    ds_read_b128 v[240:243], v8 offset:6144
    v_xad_u32 v238, v238, v3, v4
    v_smfmac_f32_16x16x64_bf16 v[172:175], a[12:15], v[196:203], v13 abid:1
    ds_read2st64_b32 v[246:247], v237 offset0:0 offset1:72
    v_xad_u32 v239, v239, v3, v4
    v_smfmac_f32_16x16x64_bf16 v[172:175], a[48:51], v[204:211], v17 abid:1
    ds_read2st64_b32 v[248:249], v238 offset0:0 offset1:72
    v_cvt_pk_bf16_f32 v125, v126, v127
    v_smfmac_f32_16x16x64_bf16 v[172:175], a[84:87], v[212:219], v21 abid:1
    ds_read2st64_b32 v[250:251], v239 offset0:0 offset1:72
    ds_read_b128 v[236:239], v9 offset:9472
    v_cvt_pk_bf16_f32 v126, v128, v129
    v_smfmac_f32_16x16x64_bf16 v[176:179], a[16:19], v[196:203], v14
    v_cvt_pk_bf16_f32 v127, v130, v131
    v_smfmac_f32_16x16x64_bf16 v[176:179], a[52:55], v[204:211], v18
    v_cvt_pk_bf16_f32 v132, v132, v133
    v_smfmac_f32_16x16x64_bf16 v[176:179], a[88:91], v[212:219], v22
    v_cvt_pk_bf16_f32 v133, v134, v135
    v_smfmac_f32_16x16x64_bf16 v[168:171], a[8:11], v[196:203], v13
    s_add_u32 m0, m0, 896
    v_cvt_pk_bf16_f32 v134, v136, v137
    v_smfmac_f32_16x16x64_bf16 v[168:171], a[44:47], v[204:211], v17
    s_waitcnt vmcnt(6)
    buffer_load_dwordx4 v5, s[8:11], s88 offen offset:128 nt lds
    v_cvt_pk_bf16_f32 v135, v138, v139
    v_smfmac_f32_16x16x64_bf16 v[168:171], a[80:83], v[212:219], v21
    ds_read_b128 v[136:139], v9 offset:10432
    v_cndmask_b32_dpp v128, v124, v132, vcc row_ror:8 row_mask:0xf bank_mask:0xf
    v_smfmac_f32_16x16x64_bf16 v[184:187], a[24:27], v[196:203], v15
    v_cndmask_b32_dpp v129, v125, v133, vcc row_ror:8 row_mask:0xf bank_mask:0xf
    v_smfmac_f32_16x16x64_bf16 v[184:187], a[60:63], v[204:211], v19
    v_cndmask_b32_dpp v130, v126, v134, vcc row_ror:8 row_mask:0xf bank_mask:0xf
    v_smfmac_f32_16x16x64_bf16 v[184:187], a[96:99], v[212:219], v23
    s_waitcnt lgkmcnt(1)
    v_xad_u32 v236, v236, v3, v4
    v_smfmac_f32_16x16x64_bf16 v[184:187], v[240:243], v[244:251], v10 abid:1
    v_xad_u32 v237, v237, v3, v4
    v_smfmac_f32_16x16x64_bf16 v[148:151], v[240:243], v[244:251], v10
    ds_read2st64_b32 v[244:245], v236 offset0:0 offset1:72
    ds_read_b128 v[240:243], v8 offset:4096
    v_xad_u32 v238, v238, v3, v4
    v_smfmac_f32_16x16x64_bf16 v[188:191], a[28:31], v[196:203], v15 abid:1
    ds_read2st64_b32 v[246:247], v237 offset0:0 offset1:72
    v_xad_u32 v239, v239, v3, v4
    v_smfmac_f32_16x16x64_bf16 v[188:191], a[64:67], v[204:211], v19 abid:1
    ds_read2st64_b32 v[248:249], v238 offset0:0 offset1:72
    v_cndmask_b32_dpp v131, v127, v135, vcc row_ror:8 row_mask:0xf bank_mask:0xf
    v_smfmac_f32_16x16x64_bf16 v[188:191], a[100:103], v[212:219], v23 abid:1
    ds_read2st64_b32 v[250:251], v239 offset0:0 offset1:72
    s_waitcnt vmcnt(7)
    buffer_store_dwordx4 v[128:131], v6, s[12:15], s59 offen offset:0 sc1
    v_smfmac_f32_16x16x64_bf16 v[192:195], a[32:35], v[196:203], v48
    v_mov_b32_dpp v124, v132 row_ror:8 row_mask:0xf bank_mask:0xc
    v_smfmac_f32_16x16x64_bf16 v[192:195], a[68:71], v[204:211], v48 abid:1
    v_mov_b32_dpp v125, v133 row_ror:8 row_mask:0xf bank_mask:0xc
    v_smfmac_f32_16x16x64_bf16 v[192:195], a[104:107], v[212:219], v49
    ds_read_b128 v[196:199], v1 offset:23552
    v_mov_b32_dpp v126, v134 row_ror:8 row_mask:0xf bank_mask:0xc
    v_smfmac_f32_16x16x64_bf16 v[160:163], a[108:111], v[220:227], v24
    ds_read_b128 v[200:203], v2 offset:23552
    v_mov_b32_dpp v127, v135 row_ror:8 row_mask:0xf bank_mask:0xc
    v_smfmac_f32_16x16x64_bf16 v[160:163], a[144:147], v[228:235], v28
    ds_read_b128 v[204:207], v1 offset:24576
    s_waitcnt vmcnt(6)
    buffer_store_dwordx4 v[124:127], v6, s[12:15], s24 offen offset:0 sc1
    v_smfmac_f32_16x16x64_bf16 v[164:167], a[112:115], v[220:227], v24 abid:1
    ds_read_b128 v[208:211], v2 offset:24576
    ds_read_b128 v[128:131], v9 offset:10304
    ds_read_b128 v[132:135], v9 offset:10368
    v_smfmac_f32_16x16x64_bf16 v[164:167], a[148:151], v[228:235], v28 abid:1
    ds_read_b128 v[124:127], v9 offset:10240
    v_smfmac_f32_16x16x64_bf16 v[176:179], a[124:127], v[220:227], v26
    v_smfmac_f32_16x16x64_bf16 v[176:179], a[160:163], v[228:235], v30
    s_waitcnt lgkmcnt(7)
    v_smfmac_f32_16x16x64_bf16 v[176:179], v[240:243], v[244:251], v10 abid:1
    v_smfmac_f32_16x16x64_bf16 v[140:143], v[240:243], v[244:251], v10
    v_smfmac_f32_16x16x64_bf16 v[172:175], a[120:123], v[220:227], v25 abid:1
    s_add_u32 s28, s28, 36864
    s_cmp_ge_u32 s28, 110592
    s_cselect_b32 s28, s26, s28
    v_smfmac_f32_16x16x64_bf16 v[172:175], a[156:159], v[228:235], v29 abid:1
    s_add_u32 s30, s25, 36864
    s_cmp_eq_u32 s30, 110592
    s_cselect_b32 s30, 0, s30
    v_smfmac_f32_16x16x64_bf16 v[168:171], a[116:119], v[220:227], v25
    s_sub_u32 s31, s30, s25
    s_mov_b32 s25, s30
    s_mov_b32 s90, s22
    v_smfmac_f32_16x16x64_bf16 v[168:171], a[152:155], v[228:235], v29
    s_mov_b32 s22, s88
    s_add_u32 s91, s91, 1
    s_cmp_lt_u32 s20, 2
    v_smfmac_f32_16x16x64_bf16 v[180:183], a[128:131], v[220:227], v26 abid:1
    s_cselect_b32 s66, s23, s24
    s_add_u32 s66, s66, s95
    v_smfmac_f32_16x16x64_bf16 v[180:183], a[164:167], v[228:235], v30 abid:1
    v_cvt_pk_bf16_f32 v140, v140, v141
    v_smfmac_f32_16x16x64_bf16 v[184:187], a[132:135], v[220:227], v27
    s_add_u32 m0, m0, 896
    v_cvt_pk_bf16_f32 v141, v142, v143
    v_smfmac_f32_16x16x64_bf16 v[184:187], a[168:171], v[228:235], v31
    s_waitcnt vmcnt(7)
    buffer_load_dwordx4 v5, s[8:11], s88 offen offset:256 nt lds
    v_cvt_pk_bf16_f32 v142, v144, v145
    v_smfmac_f32_16x16x64_bf16 v[188:191], a[136:139], v[220:227], v27 abid:1
    v_cvt_pk_bf16_f32 v143, v146, v147
    v_smfmac_f32_16x16x64_bf16 v[188:191], a[172:175], v[228:235], v31 abid:1
    v_cvt_pk_bf16_f32 v148, v148, v149
    v_smfmac_f32_16x16x64_bf16 v[192:195], a[140:143], v[220:227], v49 abid:1
    v_cvt_pk_bf16_f32 v149, v150, v151
    v_smfmac_f32_16x16x64_bf16 v[192:195], a[176:179], v[228:235], v50
    ds_read_b128 v[220:223], v1 offset:25600
    s_waitcnt lgkmcnt(6)
    v_cvt_pk_bf16_f32 v150, v152, v153
    v_smfmac_f32_16x16x64_bf16 v[160:163], a[180:183], v[196:203], v32
    ds_read_b128 v[224:227], v2 offset:25600
    s_waitcnt lgkmcnt(5)
    v_cvt_pk_bf16_f32 v151, v154, v155
    v_smfmac_f32_16x16x64_bf16 v[160:163], a[216:219], v[204:211], v36
    ds_read_b128 v[228:231], v1 offset:26624
    ds_read_b128 v[152:155], v9 offset:10688
    v_cndmask_b32_dpp v144, v140, v148, vcc row_ror:8 row_mask:0xf bank_mask:0xf
    v_smfmac_f32_16x16x64_bf16 v[164:167], a[184:187], v[196:203], v32 abid:1
    ds_read_b128 v[232:235], v2 offset:26624
    v_cndmask_b32_dpp v145, v141, v149, vcc row_ror:8 row_mask:0xf bank_mask:0xf
    v_smfmac_f32_16x16x64_bf16 v[164:167], a[220:223], v[204:211], v36 abid:1
    s_add_u32 m0, m0, 896
    v_cndmask_b32_dpp v146, v142, v150, vcc row_ror:8 row_mask:0xf bank_mask:0xf
    v_smfmac_f32_16x16x64_bf16 v[168:171], a[188:191], v[196:203], v33
    s_waitcnt vmcnt(6)
    buffer_load_dwordx4 v5, s[8:11], s88 offen offset:384 nt lds
    v_cndmask_b32_dpp v147, v143, v151, vcc row_ror:8 row_mask:0xf bank_mask:0xf
    v_smfmac_f32_16x16x64_bf16 v[168:171], a[224:227], v[204:211], v37
    s_waitcnt vmcnt(7)
    buffer_store_dwordx4 v[144:147], v6, s[12:15], s59 offen offset:128 sc1
    v_mov_b32_dpp v140, v148 row_ror:8 row_mask:0xf bank_mask:0xc
    v_smfmac_f32_16x16x64_bf16 v[172:175], a[192:195], v[196:203], v33 abid:1
    v_mov_b32_dpp v141, v149 row_ror:8 row_mask:0xf bank_mask:0xc
    v_smfmac_f32_16x16x64_bf16 v[172:175], a[228:231], v[204:211], v37 abid:1
    v_mov_b32_dpp v142, v150 row_ror:8 row_mask:0xf bank_mask:0xc
    v_smfmac_f32_16x16x64_bf16 v[176:179], a[196:199], v[196:203], v34
    v_mov_b32_dpp v143, v151 row_ror:8 row_mask:0xf bank_mask:0xc
    v_smfmac_f32_16x16x64_bf16 v[176:179], a[232:235], v[204:211], v38
    s_waitcnt vmcnt(6)
    buffer_store_dwordx4 v[140:143], v6, s[12:15], s24 offen offset:128 sc1
    ds_read_b128 v[144:147], v9 offset:10560
    v_smfmac_f32_16x16x64_bf16 v[180:183], a[200:203], v[196:203], v34 abid:1
    ds_read_b128 v[148:151], v9 offset:10624
    ds_read_b128 v[140:143], v9 offset:10496
    v_add_u32 v4, s31, v4
    v_smfmac_f32_16x16x64_bf16 v[180:183], a[236:239], v[204:211], v38 abid:1
    v_add_u32 v1, s31, v1
    v_smfmac_f32_16x16x64_bf16 v[184:187], a[204:207], v[196:203], v35
    v_add_u32 v2, s31, v2
    v_smfmac_f32_16x16x64_bf16 v[184:187], a[240:243], v[204:211], v39
    v_smfmac_f32_16x16x64_bf16 v[188:191], a[208:211], v[196:203], v35 abid:1
    v_smfmac_f32_16x16x64_bf16 v[188:191], a[244:247], v[204:211], v39 abid:1
    v_smfmac_f32_16x16x64_bf16 v[192:195], a[212:215], v[196:203], v50 abid:1
    v_smfmac_f32_16x16x64_bf16 v[192:195], a[248:251], v[204:211], v51
    s_waitcnt vmcnt(8)
    s_branch M_top1
M_bE0:
    v_smfmac_f32_16x16x64_bf16 v[164:167], v[56:59], v[220:227], v40 abid:1
    ds_read_b128 v[204:207], v1 offset:1024
    v_smfmac_f32_16x16x64_bf16 v[164:167], v[92:95], v[228:235], v44 abid:1
    ds_read_b128 v[208:211], v2 offset:1024
    v_mov_b32 v0, 1
    v_smfmac_f32_16x16x64_bf16 v[168:171], v[60:63], v[220:227], v41
    ds_read_b128 v[212:215], v1 offset:2048
    v_smfmac_f32_16x16x64_bf16 v[168:171], v[96:99], v[228:235], v45
    ds_read_b128 v[216:219], v2 offset:2048
    v_smfmac_f32_16x16x64_bf16 v[172:175], v[64:67], v[220:227], v41 abid:1
    s_waitcnt vmcnt(5)
    s_waitcnt lgkmcnt(6)
    buffer_store_dwordx4 v[244:247], v7, s[12:15], s66 offen sc1
    v_smfmac_f32_16x16x64_bf16 v[172:175], v[100:103], v[228:235], v45 abid:1
    ds_read_b128 v[236:239], v9 offset:9408
    v_smfmac_f32_16x16x64_bf16 v[176:179], v[68:71], v[220:227], v42
    s_waitcnt vmcnt(6)
    buffer_atomic_add v0, v11, s[16:19], s92 offen sc0 sc1
    s_mov_b32 s21, 2
    v_smfmac_f32_16x16x64_bf16 v[176:179], v[104:107], v[228:235], v46
    v_smfmac_f32_16x16x64_bf16 v[180:183], v[72:75], v[220:227], v42 abid:1
    v_cvt_pk_bf16_f32 v160, v160, v161
    v_smfmac_f32_16x16x64_bf16 v[180:183], v[108:111], v[228:235], v46 abid:1
    v_cvt_pk_bf16_f32 v161, v162, v163
    v_smfmac_f32_16x16x64_bf16 v[184:187], v[76:79], v[220:227], v43
    v_cvt_pk_bf16_f32 v162, v164, v165
    v_smfmac_f32_16x16x64_bf16 v[184:187], v[112:115], v[228:235], v47
    v_cvt_pk_bf16_f32 v163, v166, v167
    v_smfmac_f32_16x16x64_bf16 v[188:191], v[80:83], v[220:227], v43 abid:1
    s_add_u32 m0, m0, 896
    v_cvt_pk_bf16_f32 v168, v168, v169
    v_smfmac_f32_16x16x64_bf16 v[188:191], v[116:119], v[228:235], v47 abid:1
    s_waitcnt vmcnt(5)
    buffer_load_dwordx4 v5, s[8:11], s22 offen offset:512 nt lds
    v_cvt_pk_bf16_f32 v169, v170, v171
    v_smfmac_f32_16x16x64_bf16 v[192:195], v[84:87], v[220:227], v51 abid:1
    v_cvt_pk_bf16_f32 v170, v172, v173
    v_smfmac_f32_16x16x64_bf16 v[192:195], v[120:123], v[228:235], v52
    ds_read_b128 v[220:223], v1 offset:3072
    s_waitcnt lgkmcnt(6)
    v_cvt_pk_bf16_f32 v171, v174, v175
    v_smfmac_f32_16x16x64_bf16 v[124:127], a[0:3], v[196:203], v12
    ds_read_b128 v[224:227], v2 offset:3072
    ds_read_b128 v[172:175], v9 offset:10432
    s_waitcnt lgkmcnt(6)
    v_cndmask_b32_dpp v164, v160, v168, vcc row_ror:8 row_mask:0xf bank_mask:0xf
    v_smfmac_f32_16x16x64_bf16 v[124:127], a[36:39], v[204:211], v16
    ds_read_b128 v[228:231], v1 offset:4096
    s_waitcnt lgkmcnt(5)
    v_cndmask_b32_dpp v165, v161, v169, vcc row_ror:8 row_mask:0xf bank_mask:0xf
    v_smfmac_f32_16x16x64_bf16 v[124:127], a[72:75], v[212:219], v20
    ds_read_b128 v[232:235], v2 offset:4096
    v_cndmask_b32_dpp v166, v162, v170, vcc row_ror:8 row_mask:0xf bank_mask:0xf
    v_smfmac_f32_16x16x64_bf16 v[128:131], a[4:7], v[196:203], v12 abid:1
    s_barrier
    v_cndmask_b32_dpp v167, v163, v171, vcc row_ror:8 row_mask:0xf bank_mask:0xf
    v_smfmac_f32_16x16x64_bf16 v[128:131], a[40:43], v[204:211], v16 abid:1
    s_waitcnt vmcnt(6)
    buffer_store_dwordx4 v[164:167], v6, s[12:15], s58 offen offset:0 sc1
    s_waitcnt lgkmcnt(5)
    v_xad_u32 v236, v236, v3, v4
    v_smfmac_f32_16x16x64_bf16 v[128:131], a[76:79], v[212:219], v20 abid:1
    v_xad_u32 v237, v237, v3, v4
    v_smfmac_f32_16x16x64_bf16 v[132:135], a[8:11], v[196:203], v13
    ds_read2st64_b32 v[244:245], v236 offset0:0 offset1:72
    ds_read_b128 v[240:243], v8 offset:3072
    v_xad_u32 v238, v238, v3, v4
    v_smfmac_f32_16x16x64_bf16 v[132:135], a[44:47], v[204:211], v17
    ds_read2st64_b32 v[246:247], v237 offset0:0 offset1:72
    v_xad_u32 v239, v239, v3, v4
    v_smfmac_f32_16x16x64_bf16 v[132:135], a[80:83], v[212:219], v21
    ds_read2st64_b32 v[248:249], v238 offset0:0 offset1:72
    v_mov_b32_dpp v160, v168 row_ror:8 row_mask:0xf bank_mask:0xc
    v_smfmac_f32_16x16x64_bf16 v[144:147], a[20:23], v[196:203], v14 abid:1
    ds_read2st64_b32 v[250:251], v239 offset0:0 offset1:72
    ds_read_b128 v[236:239], v9 offset:9280
    v_mov_b32_dpp v161, v169 row_ror:8 row_mask:0xf bank_mask:0xc
    v_smfmac_f32_16x16x64_bf16 v[144:147], a[56:59], v[204:211], v18 abid:1
    v_mov_b32_dpp v162, v170 row_ror:8 row_mask:0xf bank_mask:0xc
    v_smfmac_f32_16x16x64_bf16 v[144:147], a[92:95], v[212:219], v22 abid:1
    v_mov_b32_dpp v163, v171 row_ror:8 row_mask:0xf bank_mask:0xc
    v_smfmac_f32_16x16x64_bf16 v[140:143], a[16:19], v[196:203], v14
    s_waitcnt vmcnt(5)
    buffer_store_dwordx4 v[160:163], v6, s[12:15], s23 offen offset:0 sc1
    ds_read_b128 v[164:167], v9 offset:10304
    v_smfmac_f32_16x16x64_bf16 v[140:143], a[52:55], v[204:211], v18
    ds_read_b128 v[168:171], v9 offset:10368
    ds_read_b128 v[160:163], v9 offset:10240
    v_smfmac_f32_16x16x64_bf16 v[140:143], a[88:91], v[212:219], v22
    v_smfmac_f32_16x16x64_bf16 v[136:139], a[12:15], v[196:203], v13 abid:1
    v_smfmac_f32_16x16x64_bf16 v[136:139], a[48:51], v[204:211], v17 abid:1
    v_smfmac_f32_16x16x64_bf16 v[136:139], a[84:87], v[212:219], v21 abid:1
    s_waitcnt lgkmcnt(3)
    v_xad_u32 v236, v236, v3, v4
    v_smfmac_f32_16x16x64_bf16 v[136:139], v[240:243], v[244:251], v10
    v_xad_u32 v237, v237, v3, v4
    v_smfmac_f32_16x16x64_bf16 v[172:175], v[240:243], v[244:251], v10 abid:1
    ds_read2st64_b32 v[244:245], v236 offset0:0 offset1:72
    ds_read_b128 v[240:243], v8 offset:1024
    v_xad_u32 v238, v238, v3, v4
    v_smfmac_f32_16x16x64_bf16 v[148:151], a[24:27], v[196:203], v15
    ds_read2st64_b32 v[246:247], v237 offset0:0 offset1:72
    v_xad_u32 v239, v239, v3, v4
    v_smfmac_f32_16x16x64_bf16 v[148:151], a[60:63], v[204:211], v19
    ds_read2st64_b32 v[248:249], v238 offset0:0 offset1:72
    v_cvt_pk_bf16_f32 v192, v192, v193
    v_smfmac_f32_16x16x64_bf16 v[148:151], a[96:99], v[212:219], v23
    ds_read2st64_b32 v[250:251], v239 offset0:0 offset1:72
    ds_read_b128 v[236:239], v9 offset:9344
    v_cvt_pk_bf16_f32 v193, v194, v195
    v_smfmac_f32_16x16x64_bf16 v[152:155], a[28:31], v[196:203], v15 abid:1
    ds_write_b64 v53, v[192:193] offset:0
    ds_read_b128 v[192:195], v9 offset:10752
    v_smfmac_f32_16x16x64_bf16 v[152:155], a[64:67], v[204:211], v19 abid:1
    s_add_u32 m0, m0, 896
    v_smfmac_f32_16x16x64_bf16 v[152:155], a[100:103], v[212:219], v23 abid:1
    s_waitcnt vmcnt(6)
    buffer_load_dwordx4 v5, s[8:11], s22 offen offset:640 nt lds
    v_smfmac_f32_16x16x64_bf16 v[156:159], a[32:35], v[196:203], v48
    v_smfmac_f32_16x16x64_bf16 v[156:159], a[68:71], v[204:211], v48 abid:1
    v_smfmac_f32_16x16x64_bf16 v[156:159], a[104:107], v[212:219], v49
    ds_read_b128 v[196:199], v1 offset:5120
    v_cvt_pk_bf16_f32 v176, v176, v177
    v_smfmac_f32_16x16x64_bf16 v[124:127], a[108:111], v[220:227], v24
    ds_read_b128 v[200:203], v2 offset:5120
    v_cvt_pk_bf16_f32 v177, v178, v179
    v_smfmac_f32_16x16x64_bf16 v[124:127], a[144:147], v[228:235], v28
    ds_read_b128 v[204:207], v1 offset:6144
    ds_read_b64 v[216:217], v9 offset:10056
    v_cvt_pk_bf16_f32 v178, v180, v181
    v_smfmac_f32_16x16x64_bf16 v[128:131], a[112:115], v[220:227], v24 abid:1
    ds_read_b128 v[208:211], v2 offset:6144
    v_cvt_pk_bf16_f32 v179, v182, v183
    v_smfmac_f32_16x16x64_bf16 v[128:131], a[148:151], v[228:235], v28 abid:1
    s_waitcnt lgkmcnt(7)
    v_xad_u32 v236, v236, v3, v4
    v_smfmac_f32_16x16x64_bf16 v[128:131], v[240:243], v[244:251], v10
    s_add_u32 m0, m0, 896
    v_xad_u32 v237, v237, v3, v4
    v_smfmac_f32_16x16x64_bf16 v[164:167], v[240:243], v[244:251], v10 abid:1
    ds_read2st64_b32 v[244:245], v236 offset0:0 offset1:72
    ds_read_b128 v[240:243], v8 offset:2048
    v_xad_u32 v238, v238, v3, v4
    v_smfmac_f32_16x16x64_bf16 v[152:155], a[136:139], v[220:227], v27 abid:1
    ds_read2st64_b32 v[246:247], v237 offset0:0 offset1:72
    s_waitcnt vmcnt(5)
    v_xad_u32 v239, v239, v3, v4
    v_smfmac_f32_16x16x64_bf16 v[152:155], a[172:175], v[228:235], v31 abid:1
    ds_read2st64_b32 v[248:249], v238 offset0:0 offset1:72
    buffer_load_dwordx4 v5, s[8:11], s22 offen offset:768 nt lds
    v_cvt_pk_bf16_f32 v184, v184, v185
    v_smfmac_f32_16x16x64_bf16 v[136:139], a[120:123], v[220:227], v25 abid:1
    ds_read2st64_b32 v[250:251], v239 offset0:0 offset1:72
    ds_read_b128 v[236:239], v9 offset:9216
    v_cvt_pk_bf16_f32 v185, v186, v187
    v_smfmac_f32_16x16x64_bf16 v[136:139], a[156:159], v[228:235], v29 abid:1
    v_cvt_pk_bf16_f32 v186, v188, v189
    v_smfmac_f32_16x16x64_bf16 v[140:143], a[124:127], v[220:227], v26
    v_cvt_pk_bf16_f32 v187, v190, v191
    v_smfmac_f32_16x16x64_bf16 v[140:143], a[160:163], v[228:235], v30
    ds_read_b128 v[188:191], v9 offset:10688
    v_cndmask_b32_dpp v180, v176, v184, vcc row_ror:8 row_mask:0xf bank_mask:0xf
    v_smfmac_f32_16x16x64_bf16 v[144:147], a[128:131], v[220:227], v26 abid:1
    v_cndmask_b32_dpp v181, v177, v185, vcc row_ror:8 row_mask:0xf bank_mask:0xf
    v_smfmac_f32_16x16x64_bf16 v[144:147], a[164:167], v[228:235], v30 abid:1
    v_cndmask_b32_dpp v182, v178, v186, vcc row_ror:8 row_mask:0xf bank_mask:0xf
    v_smfmac_f32_16x16x64_bf16 v[148:151], a[132:135], v[220:227], v27
    v_cndmask_b32_dpp v183, v179, v187, vcc row_ror:8 row_mask:0xf bank_mask:0xf
    v_smfmac_f32_16x16x64_bf16 v[148:151], a[168:171], v[228:235], v31
    s_waitcnt vmcnt(6)
    buffer_store_dwordx4 v[180:183], v6, s[12:15], s58 offen offset:128 sc1
    s_waitcnt lgkmcnt(8)
    v_xad_u32 v212, v216, v3, v4
    v_smfmac_f32_16x16x64_bf16 v[132:135], a[116:119], v[220:227], v25
    ds_read2st64_b32 v[212:213], v212 offset0:0 offset1:72
    v_xad_u32 v214, v217, v3, v4
    v_smfmac_f32_16x16x64_bf16 v[132:135], a[152:155], v[228:235], v29
    ds_read2st64_b32 v[214:215], v214 offset0:0 offset1:72
    s_waitcnt lgkmcnt(3)
    v_xad_u32 v236, v236, v3, v4
    v_smfmac_f32_16x16x64_bf16 v[132:135], v[240:243], v[244:251], v10
    v_xad_u32 v237, v237, v3, v4
    v_smfmac_f32_16x16x64_bf16 v[168:171], v[240:243], v[244:251], v10 abid:1
    ds_read2st64_b32 v[244:245], v236 offset0:0 offset1:72
    ds_read_b128 v[240:243], v8 offset:0
    v_xad_u32 v238, v238, v3, v4
    v_smfmac_f32_16x16x64_bf16 v[156:159], a[140:143], v[220:227], v49 abid:1
    ds_read2st64_b32 v[246:247], v237 offset0:0 offset1:72
    v_xad_u32 v239, v239, v3, v4
    v_smfmac_f32_16x16x64_bf16 v[156:159], a[176:179], v[228:235], v50
    ds_read2st64_b32 v[248:249], v238 offset0:0 offset1:72
    ds_read_b128 v[220:223], v1 offset:7168
    v_mov_b32_dpp v176, v184 row_ror:8 row_mask:0xf bank_mask:0xc
    v_smfmac_f32_16x16x64_bf16 v[140:143], a[196:199], v[196:203], v34
    ds_read2st64_b32 v[250:251], v239 offset0:0 offset1:72
    ds_read_b128 v[236:239], v9 offset:9728
    v_mov_b32_dpp v177, v185 row_ror:8 row_mask:0xf bank_mask:0xc
    v_smfmac_f32_16x16x64_bf16 v[140:143], a[232:235], v[204:211], v38
    ds_read_b128 v[224:227], v2 offset:7168
    v_mov_b32_dpp v178, v186 row_ror:8 row_mask:0xf bank_mask:0xc
    v_smfmac_f32_16x16x64_bf16 v[128:131], a[184:187], v[196:203], v32 abid:1
    ds_read_b128 v[228:231], v1 offset:8192
    v_mov_b32_dpp v179, v187 row_ror:8 row_mask:0xf bank_mask:0xc
    v_smfmac_f32_16x16x64_bf16 v[128:131], a[220:223], v[204:211], v36 abid:1
    ds_read_b128 v[232:235], v2 offset:8192
    s_waitcnt vmcnt(5)
    buffer_store_dwordx4 v[176:179], v6, s[12:15], s23 offen offset:128 sc1
    v_smfmac_f32_16x16x64_bf16 v[132:135], a[188:191], v[196:203], v33
    ds_read_b128 v[180:183], v9 offset:10560
    ds_read_b128 v[184:187], v9 offset:10624
    ds_read_b128 v[176:179], v9 offset:10496
    v_smfmac_f32_16x16x64_bf16 v[132:135], a[224:227], v[204:211], v37
    v_smfmac_f32_16x16x64_bf16 v[136:139], a[192:195], v[196:203], v33 abid:1
    v_smfmac_f32_16x16x64_bf16 v[136:139], a[228:231], v[204:211], v37 abid:1
    v_smfmac_f32_16x16x64_bf16 v[124:127], a[180:183], v[196:203], v32
    v_smfmac_f32_16x16x64_bf16 v[124:127], a[216:219], v[204:211], v36
    s_waitcnt vmcnt(7)
    s_waitcnt lgkmcnt(6)
    v_xad_u32 v236, v236, v3, v4
    v_smfmac_f32_16x16x64_bf16 v[124:127], v[240:243], v[244:251], v10
    v_xad_u32 v237, v237, v3, v4
    v_smfmac_f32_16x16x64_bf16 v[160:163], v[240:243], v[244:251], v10 abid:1
    ds_read2st64_b32 v[244:245], v236 offset0:0 offset1:72
    ds_read_b128 v[240:243], v8 offset:8192
    v_xad_u32 v238, v238, v3, v4
    v_smfmac_f32_16x16x64_bf16 v[144:147], a[200:203], v[196:203], v34 abid:1
    ds_read2st64_b32 v[246:247], v237 offset0:0 offset1:72
    v_xad_u32 v239, v239, v3, v4
    v_smfmac_f32_16x16x64_bf16 v[144:147], a[236:239], v[204:211], v38 abid:1
    ds_read2st64_b32 v[248:249], v238 offset0:0 offset1:72
    v_mul_u32_u24 v0, s94, v0
    v_smfmac_f32_16x16x64_bf16 v[148:151], a[204:207], v[196:203], v35
    ds_read2st64_b32 v[250:251], v239 offset0:0 offset1:72
    ds_read_b128 v[236:239], v9 offset:9664
    v_add_u32 v0, s93, v0
    v_smfmac_f32_16x16x64_bf16 v[148:151], a[240:243], v[204:211], v39
    s_waitcnt lgkmcnt(6)
    s_cmp_lt_i32 s81, 0
    s_cbranch_scc1 M_ovrE0
    s_swappc_b64 s[78:79], s[72:73]
M_ovrE0:
    v_smfmac_f32_16x16x64_bf16 v[152:155], a[208:211], v[196:203], v35 abid:1
    s_add_u32 m0, m0, 896
    v_min_u32 v0, 75497472, v0
    v_smfmac_f32_16x16x64_bf16 v[152:155], a[244:247], v[204:211], v39 abid:1
    ds_write_b32 v11, v0
    s_waitcnt vmcnt(6)
    v_mov_b32 v0, 162048
    v_smfmac_f32_16x16x64_bf16 v[156:159], a[212:215], v[196:203], v50 abid:1
    buffer_load_dwordx4 v5, s[8:11], s22 offen offset:896 nt lds
    v_smfmac_f32_16x16x64_bf16 v[156:159], a[248:251], v[204:211], v51
    ds_read_b128 v[196:199], v1 offset:18432
    v_smfmac_f32_16x16x64_bf16 v[124:127], a[252:255], v[220:227], v40
    ds_read_b128 v[200:203], v2 offset:18432
    v_smfmac_f32_16x16x64_bf16 v[124:127], v[88:91], v[228:235], v44
    ds_read_b128 v[204:207], v1 offset:19456
    v_smfmac_f32_16x16x64_bf16 v[156:159], v[84:87], v[220:227], v51 abid:1
    ds_read_b128 v[208:211], v2 offset:19456
    v_smfmac_f32_16x16x64_bf16 v[156:159], v[120:123], v[228:235], v52
    s_waitcnt lgkmcnt(4)
    s_barrier
    v_xad_u32 v236, v236, v3, v4
    v_smfmac_f32_16x16x64_bf16 v[156:159], v[240:243], v[244:251], v10
    ds_read_b32 v0, v0
    v_xad_u32 v237, v237, v3, v4
    v_smfmac_f32_16x16x64_bf16 v[192:195], v[240:243], v[244:251], v10 abid:1
    ds_read2st64_b32 v[244:245], v236 offset0:0 offset1:72
    ds_read_b128 v[240:243], v8 offset:7168
    v_xad_u32 v238, v238, v3, v4
    v_smfmac_f32_16x16x64_bf16 v[132:135], v[60:63], v[220:227], v41
    ds_read2st64_b32 v[246:247], v237 offset0:0 offset1:72
    v_xad_u32 v239, v239, v3, v4
    v_smfmac_f32_16x16x64_bf16 v[132:135], v[96:99], v[228:235], v45
    ds_read2st64_b32 v[248:249], v238 offset0:0 offset1:72
    s_add_u32 m0, m0, 896
    v_smfmac_f32_16x16x64_bf16 v[136:139], v[64:67], v[220:227], v41 abid:1
    ds_read2st64_b32 v[250:251], v239 offset0:0 offset1:72
    ds_read_b128 v[236:239], v9 offset:9536
    s_waitcnt vmcnt(5)
    v_smfmac_f32_16x16x64_bf16 v[136:139], v[100:103], v[228:235], v45 abid:1
    buffer_load_dwordx4 v5, s[8:11], s22 offen offset:1024 nt lds
    s_waitcnt lgkmcnt(6)
    v_readfirstlane_b32 s88, v0
    v_smfmac_f32_16x16x64_bf16 v[140:143], v[68:71], v[220:227], v42
    s_cmp_lt_u32 s88, s99
    s_cselect_b32 s10, 75497472, 0
    v_smfmac_f32_16x16x64_bf16 v[140:143], v[104:107], v[228:235], v46
    v_smfmac_f32_16x16x64_bf16 v[144:147], v[72:75], v[220:227], v42 abid:1
    ds_read_b128 v[212:215], v1 offset:20480
    v_smfmac_f32_16x16x64_bf16 v[144:147], v[108:111], v[228:235], v46 abid:1
    ds_read_b128 v[216:219], v2 offset:20480
    v_smfmac_f32_16x16x64_bf16 v[148:151], v[76:79], v[220:227], v43
    v_smfmac_f32_16x16x64_bf16 v[148:151], v[112:115], v[228:235], v47
    v_smfmac_f32_16x16x64_bf16 v[152:155], v[80:83], v[220:227], v43 abid:1
    v_smfmac_f32_16x16x64_bf16 v[152:155], v[116:119], v[228:235], v47 abid:1
    s_waitcnt lgkmcnt(2)
    v_xad_u32 v236, v236, v3, v4
    v_smfmac_f32_16x16x64_bf16 v[152:155], v[240:243], v[244:251], v10
    v_xad_u32 v237, v237, v3, v4
    v_smfmac_f32_16x16x64_bf16 v[188:191], v[240:243], v[244:251], v10 abid:1
    s_cmp_gt_u32 s46, s80
    s_cbranch_scc1 M_slow
M_slowrE0:
    v_xad_u32 v238, v238, v3, v4
    v_smfmac_f32_16x16x64_bf16 v[128:131], v[56:59], v[220:227], v40 abid:1
    ds_read2st64_b32 v[244:245], v236 offset0:0 offset1:72
    ds_read_b128 v[240:243], v8 offset:5120
    v_xad_u32 v239, v239, v3, v4
    v_smfmac_f32_16x16x64_bf16 v[128:131], v[92:95], v[228:235], v44 abid:1
    ds_read2st64_b32 v[246:247], v237 offset0:0 offset1:72
    ds_read_b128 v[220:223], v1 offset:21504
    v_smfmac_f32_16x16x64_bf16 v[160:163], a[0:3], v[196:203], v12
    ds_read2st64_b32 v[248:249], v238 offset0:0 offset1:72
    ds_read_b128 v[224:227], v2 offset:21504
    v_smfmac_f32_16x16x64_bf16 v[160:163], a[36:39], v[204:211], v16
    ds_read2st64_b32 v[250:251], v239 offset0:0 offset1:72
    ds_read_b128 v[236:239], v9 offset:9600
    s_waitcnt lgkmcnt(8)
    v_smfmac_f32_16x16x64_bf16 v[160:163], a[72:75], v[212:219], v20
    ds_read_b128 v[228:231], v1 offset:22528
    v_smfmac_f32_16x16x64_bf16 v[164:167], a[4:7], v[196:203], v12 abid:1
    ds_read_b128 v[232:235], v2 offset:22528
    v_cvt_pk_bf16_f32 v156, v156, v157
    v_smfmac_f32_16x16x64_bf16 v[164:167], a[40:43], v[204:211], v16 abid:1
    s_mov_b32 m0, s28
    v_cvt_pk_bf16_f32 v157, v158, v159
    v_smfmac_f32_16x16x64_bf16 v[164:167], a[76:79], v[212:219], v20 abid:1
    ds_write_b64 v53, v[156:157] offset:25728
    ds_read_b128 v[156:159], v9 offset:10752
    s_waitcnt vmcnt(6)
    v_smfmac_f32_16x16x64_bf16 v[180:183], a[20:23], v[196:203], v14 abid:1
    buffer_load_dwordx4 v5, s[8:11], s88 offen offset:0 nt lds
    v_smfmac_f32_16x16x64_bf16 v[180:183], a[56:59], v[204:211], v18 abid:1
    v_cvt_pk_bf16_f32 v124, v124, v125
    v_smfmac_f32_16x16x64_bf16 v[180:183], a[92:95], v[212:219], v22 abid:1
    s_waitcnt lgkmcnt(4)
    v_xad_u32 v236, v236, v3, v4
    v_smfmac_f32_16x16x64_bf16 v[180:183], v[240:243], v[244:251], v10 abid:1
    v_xad_u32 v237, v237, v3, v4
    v_smfmac_f32_16x16x64_bf16 v[144:147], v[240:243], v[244:251], v10
    ds_read2st64_b32 v[244:245], v236 offset0:0 offset1:72
    ds_read_b128 v[240:243], v8 offset:6144
    v_xad_u32 v238, v238, v3, v4
    v_smfmac_f32_16x16x64_bf16 v[172:175], a[12:15], v[196:203], v13 abid:1
    ds_read2st64_b32 v[246:247], v237 offset0:0 offset1:72
    v_xad_u32 v239, v239, v3, v4
    v_smfmac_f32_16x16x64_bf16 v[172:175], a[48:51], v[204:211], v17 abid:1
    ds_read2st64_b32 v[248:249], v238 offset0:0 offset1:72
    v_cvt_pk_bf16_f32 v125, v126, v127
    v_smfmac_f32_16x16x64_bf16 v[172:175], a[84:87], v[212:219], v21 abid:1
    ds_read2st64_b32 v[250:251], v239 offset0:0 offset1:72
    ds_read_b128 v[236:239], v9 offset:9472
    v_cvt_pk_bf16_f32 v126, v128, v129
    v_smfmac_f32_16x16x64_bf16 v[176:179], a[16:19], v[196:203], v14
    v_cvt_pk_bf16_f32 v127, v130, v131
    v_smfmac_f32_16x16x64_bf16 v[176:179], a[52:55], v[204:211], v18
    v_cvt_pk_bf16_f32 v132, v132, v133
    v_smfmac_f32_16x16x64_bf16 v[176:179], a[88:91], v[212:219], v22
    v_cvt_pk_bf16_f32 v133, v134, v135
    v_smfmac_f32_16x16x64_bf16 v[168:171], a[8:11], v[196:203], v13
    s_add_u32 m0, m0, 896
    v_cvt_pk_bf16_f32 v134, v136, v137
    v_smfmac_f32_16x16x64_bf16 v[168:171], a[44:47], v[204:211], v17
    s_waitcnt vmcnt(5)
    buffer_load_dwordx4 v5, s[8:11], s88 offen offset:128 nt lds
    v_cvt_pk_bf16_f32 v135, v138, v139
    v_smfmac_f32_16x16x64_bf16 v[168:171], a[80:83], v[212:219], v21
    ds_read_b128 v[136:139], v9 offset:10432
    v_cndmask_b32_dpp v128, v124, v132, vcc row_ror:8 row_mask:0xf bank_mask:0xf
    v_smfmac_f32_16x16x64_bf16 v[184:187], a[24:27], v[196:203], v15
    v_cndmask_b32_dpp v129, v125, v133, vcc row_ror:8 row_mask:0xf bank_mask:0xf
    v_smfmac_f32_16x16x64_bf16 v[184:187], a[60:63], v[204:211], v19
    v_cndmask_b32_dpp v130, v126, v134, vcc row_ror:8 row_mask:0xf bank_mask:0xf
    v_smfmac_f32_16x16x64_bf16 v[184:187], a[96:99], v[212:219], v23
    s_waitcnt lgkmcnt(1)
    v_xad_u32 v236, v236, v3, v4
    v_smfmac_f32_16x16x64_bf16 v[184:187], v[240:243], v[244:251], v10 abid:1
    v_xad_u32 v237, v237, v3, v4
    v_smfmac_f32_16x16x64_bf16 v[148:151], v[240:243], v[244:251], v10
    ds_read2st64_b32 v[244:245], v236 offset0:0 offset1:72
    ds_read_b128 v[240:243], v8 offset:4096
    v_xad_u32 v238, v238, v3, v4
    v_smfmac_f32_16x16x64_bf16 v[188:191], a[28:31], v[196:203], v15 abid:1
    ds_read2st64_b32 v[246:247], v237 offset0:0 offset1:72
    v_xad_u32 v239, v239, v3, v4
    v_smfmac_f32_16x16x64_bf16 v[188:191], a[64:67], v[204:211], v19 abid:1
    ds_read2st64_b32 v[248:249], v238 offset0:0 offset1:72
    v_cndmask_b32_dpp v131, v127, v135, vcc row_ror:8 row_mask:0xf bank_mask:0xf
    v_smfmac_f32_16x16x64_bf16 v[188:191], a[100:103], v[212:219], v23 abid:1
    ds_read2st64_b32 v[250:251], v239 offset0:0 offset1:72
    s_waitcnt vmcnt(6)
    buffer_store_dwordx4 v[128:131], v6, s[12:15], s59 offen offset:0 sc1
    v_smfmac_f32_16x16x64_bf16 v[192:195], a[32:35], v[196:203], v48
    v_mov_b32_dpp v124, v132 row_ror:8 row_mask:0xf bank_mask:0xc
    v_smfmac_f32_16x16x64_bf16 v[192:195], a[68:71], v[204:211], v48 abid:1
    v_mov_b32_dpp v125, v133 row_ror:8 row_mask:0xf bank_mask:0xc
    v_smfmac_f32_16x16x64_bf16 v[192:195], a[104:107], v[212:219], v49
    ds_read_b128 v[196:199], v1 offset:23552
    v_mov_b32_dpp v126, v134 row_ror:8 row_mask:0xf bank_mask:0xc
    v_smfmac_f32_16x16x64_bf16 v[160:163], a[108:111], v[220:227], v24
    ds_read_b128 v[200:203], v2 offset:23552
    v_mov_b32_dpp v127, v135 row_ror:8 row_mask:0xf bank_mask:0xc
    v_smfmac_f32_16x16x64_bf16 v[160:163], a[144:147], v[228:235], v28
    ds_read_b128 v[204:207], v1 offset:24576
    s_waitcnt vmcnt(5)
    buffer_store_dwordx4 v[124:127], v6, s[12:15], s24 offen offset:0 sc1
    v_smfmac_f32_16x16x64_bf16 v[164:167], a[112:115], v[220:227], v24 abid:1
    ds_read_b128 v[208:211], v2 offset:24576
    ds_read_b128 v[128:131], v9 offset:10304
    ds_read_b128 v[132:135], v9 offset:10368
    v_smfmac_f32_16x16x64_bf16 v[164:167], a[148:151], v[228:235], v28 abid:1
    ds_read_b128 v[124:127], v9 offset:10240
    v_smfmac_f32_16x16x64_bf16 v[176:179], a[124:127], v[220:227], v26
    v_smfmac_f32_16x16x64_bf16 v[176:179], a[160:163], v[228:235], v30
    s_waitcnt lgkmcnt(7)
    v_smfmac_f32_16x16x64_bf16 v[176:179], v[240:243], v[244:251], v10 abid:1
    v_smfmac_f32_16x16x64_bf16 v[140:143], v[240:243], v[244:251], v10
    v_smfmac_f32_16x16x64_bf16 v[172:175], a[120:123], v[220:227], v25 abid:1
    s_add_u32 s28, s28, 36864
    s_cmp_ge_u32 s28, 110592
    s_cselect_b32 s28, s26, s28
    v_smfmac_f32_16x16x64_bf16 v[172:175], a[156:159], v[228:235], v29 abid:1
    s_add_u32 s30, s25, 36864
    s_cmp_eq_u32 s30, 110592
    s_cselect_b32 s30, 0, s30
    v_smfmac_f32_16x16x64_bf16 v[168:171], a[116:119], v[220:227], v25
    s_sub_u32 s31, s30, s25
    s_mov_b32 s25, s30
    s_mov_b32 s90, s22
    v_smfmac_f32_16x16x64_bf16 v[168:171], a[152:155], v[228:235], v29
    s_mov_b32 s22, s88
    s_add_u32 s91, s91, 1
    s_cmp_lt_u32 s20, 2
    v_smfmac_f32_16x16x64_bf16 v[180:183], a[128:131], v[220:227], v26 abid:1
    s_cselect_b32 s66, s23, s24
    s_add_u32 s66, s66, s95
    v_smfmac_f32_16x16x64_bf16 v[180:183], a[164:167], v[228:235], v30 abid:1
    v_cvt_pk_bf16_f32 v140, v140, v141
    v_smfmac_f32_16x16x64_bf16 v[184:187], a[132:135], v[220:227], v27
    s_add_u32 m0, m0, 896
    v_cvt_pk_bf16_f32 v141, v142, v143
    v_smfmac_f32_16x16x64_bf16 v[184:187], a[168:171], v[228:235], v31
    s_waitcnt vmcnt(6)
    buffer_load_dwordx4 v5, s[8:11], s88 offen offset:256 nt lds
    v_cvt_pk_bf16_f32 v142, v144, v145
    v_smfmac_f32_16x16x64_bf16 v[188:191], a[136:139], v[220:227], v27 abid:1
    v_cvt_pk_bf16_f32 v143, v146, v147
    v_smfmac_f32_16x16x64_bf16 v[188:191], a[172:175], v[228:235], v31 abid:1
    v_cvt_pk_bf16_f32 v148, v148, v149
    v_smfmac_f32_16x16x64_bf16 v[192:195], a[140:143], v[220:227], v49 abid:1
    v_cvt_pk_bf16_f32 v149, v150, v151
    v_smfmac_f32_16x16x64_bf16 v[192:195], a[176:179], v[228:235], v50
    ds_read_b128 v[220:223], v1 offset:25600
    s_waitcnt lgkmcnt(6)
    v_cvt_pk_bf16_f32 v150, v152, v153
    v_smfmac_f32_16x16x64_bf16 v[160:163], a[180:183], v[196:203], v32
    ds_read_b128 v[224:227], v2 offset:25600
    s_waitcnt lgkmcnt(5)
    v_cvt_pk_bf16_f32 v151, v154, v155
    v_smfmac_f32_16x16x64_bf16 v[160:163], a[216:219], v[204:211], v36
    ds_read_b128 v[228:231], v1 offset:26624
    ds_read_b128 v[152:155], v9 offset:10688
    v_cndmask_b32_dpp v144, v140, v148, vcc row_ror:8 row_mask:0xf bank_mask:0xf
    v_smfmac_f32_16x16x64_bf16 v[164:167], a[184:187], v[196:203], v32 abid:1
    ds_read_b128 v[232:235], v2 offset:26624
    v_cndmask_b32_dpp v145, v141, v149, vcc row_ror:8 row_mask:0xf bank_mask:0xf
    v_smfmac_f32_16x16x64_bf16 v[164:167], a[220:223], v[204:211], v36 abid:1
    s_add_u32 m0, m0, 896
    v_cndmask_b32_dpp v146, v142, v150, vcc row_ror:8 row_mask:0xf bank_mask:0xf
    v_smfmac_f32_16x16x64_bf16 v[168:171], a[188:191], v[196:203], v33
    s_waitcnt vmcnt(5)
    buffer_load_dwordx4 v5, s[8:11], s88 offen offset:384 nt lds
    v_cndmask_b32_dpp v147, v143, v151, vcc row_ror:8 row_mask:0xf bank_mask:0xf
    v_smfmac_f32_16x16x64_bf16 v[168:171], a[224:227], v[204:211], v37
    s_waitcnt vmcnt(6)
    buffer_store_dwordx4 v[144:147], v6, s[12:15], s59 offen offset:128 sc1
    v_mov_b32_dpp v140, v148 row_ror:8 row_mask:0xf bank_mask:0xc
    v_smfmac_f32_16x16x64_bf16 v[172:175], a[192:195], v[196:203], v33 abid:1
    v_mov_b32_dpp v141, v149 row_ror:8 row_mask:0xf bank_mask:0xc
    v_smfmac_f32_16x16x64_bf16 v[172:175], a[228:231], v[204:211], v37 abid:1
    v_mov_b32_dpp v142, v150 row_ror:8 row_mask:0xf bank_mask:0xc
    v_smfmac_f32_16x16x64_bf16 v[176:179], a[196:199], v[196:203], v34
    v_mov_b32_dpp v143, v151 row_ror:8 row_mask:0xf bank_mask:0xc
    v_smfmac_f32_16x16x64_bf16 v[176:179], a[232:235], v[204:211], v38
    s_waitcnt vmcnt(5)
    buffer_store_dwordx4 v[140:143], v6, s[12:15], s24 offen offset:128 sc1
    ds_read_b128 v[144:147], v9 offset:10560
    v_smfmac_f32_16x16x64_bf16 v[180:183], a[200:203], v[196:203], v34 abid:1
    ds_read_b128 v[148:151], v9 offset:10624
    ds_read_b128 v[140:143], v9 offset:10496
    v_add_u32 v4, s31, v4
    v_smfmac_f32_16x16x64_bf16 v[180:183], a[236:239], v[204:211], v38 abid:1
    v_add_u32 v1, s31, v1
    v_smfmac_f32_16x16x64_bf16 v[184:187], a[204:207], v[196:203], v35
    v_add_u32 v2, s31, v2
    v_smfmac_f32_16x16x64_bf16 v[184:187], a[240:243], v[204:211], v39
    v_smfmac_f32_16x16x64_bf16 v[188:191], a[208:211], v[196:203], v35 abid:1
    v_smfmac_f32_16x16x64_bf16 v[188:191], a[244:247], v[204:211], v39 abid:1
    v_smfmac_f32_16x16x64_bf16 v[192:195], a[212:215], v[196:203], v50 abid:1
    v_smfmac_f32_16x16x64_bf16 v[192:195], a[248:251], v[204:211], v51
    s_waitcnt vmcnt(8)
    s_branch M_top1
M_bF:
    v_smfmac_f32_16x16x64_bf16 v[164:167], v[56:59], v[220:227], v40 abid:1
    ds_read_b128 v[204:207], v1 offset:1024
    v_smfmac_f32_16x16x64_bf16 v[164:167], v[92:95], v[228:235], v44 abid:1
    ds_read_b128 v[208:211], v2 offset:1024
    v_smfmac_f32_16x16x64_bf16 v[168:171], v[60:63], v[220:227], v41
    ds_read_b128 v[212:215], v1 offset:2048
    v_smfmac_f32_16x16x64_bf16 v[168:171], v[96:99], v[228:235], v45
    ds_read_b128 v[216:219], v2 offset:2048
    v_smfmac_f32_16x16x64_bf16 v[172:175], v[64:67], v[220:227], v41 abid:1
    s_waitcnt lgkmcnt(6)
    buffer_store_dwordx4 v[244:247], v7, s[12:15], s66 offen sc1
    v_smfmac_f32_16x16x64_bf16 v[172:175], v[100:103], v[228:235], v45 abid:1
    ds_read_b128 v[236:239], v9 offset:9408
    v_smfmac_f32_16x16x64_bf16 v[176:179], v[68:71], v[220:227], v42
    s_mov_b32 s21, 3
    v_smfmac_f32_16x16x64_bf16 v[176:179], v[104:107], v[228:235], v46
    v_smfmac_f32_16x16x64_bf16 v[180:183], v[72:75], v[220:227], v42 abid:1
    v_cvt_pk_bf16_f32 v160, v160, v161
    v_smfmac_f32_16x16x64_bf16 v[180:183], v[108:111], v[228:235], v46 abid:1
    v_cvt_pk_bf16_f32 v161, v162, v163
    v_smfmac_f32_16x16x64_bf16 v[184:187], v[76:79], v[220:227], v43
    v_cvt_pk_bf16_f32 v162, v164, v165
    v_smfmac_f32_16x16x64_bf16 v[184:187], v[112:115], v[228:235], v47
    v_cvt_pk_bf16_f32 v163, v166, v167
    v_smfmac_f32_16x16x64_bf16 v[188:191], v[80:83], v[220:227], v43 abid:1
    v_cvt_pk_bf16_f32 v168, v168, v169
    v_smfmac_f32_16x16x64_bf16 v[188:191], v[116:119], v[228:235], v47 abid:1
    v_cvt_pk_bf16_f32 v169, v170, v171
    v_smfmac_f32_16x16x64_bf16 v[192:195], v[84:87], v[220:227], v51 abid:1
    v_cvt_pk_bf16_f32 v170, v172, v173
    v_smfmac_f32_16x16x64_bf16 v[192:195], v[120:123], v[228:235], v52
    ds_read_b128 v[220:223], v1 offset:3072
    s_waitcnt lgkmcnt(6)
    v_cvt_pk_bf16_f32 v171, v174, v175
    v_smfmac_f32_16x16x64_bf16 v[124:127], a[0:3], v[196:203], v12
    ds_read_b128 v[224:227], v2 offset:3072
    ds_read_b128 v[172:175], v9 offset:10432
    s_waitcnt lgkmcnt(6)
    v_cndmask_b32_dpp v164, v160, v168, vcc row_ror:8 row_mask:0xf bank_mask:0xf
    v_smfmac_f32_16x16x64_bf16 v[124:127], a[36:39], v[204:211], v16
    ds_read_b128 v[228:231], v1 offset:4096
    s_waitcnt lgkmcnt(5)
    v_cndmask_b32_dpp v165, v161, v169, vcc row_ror:8 row_mask:0xf bank_mask:0xf
    v_smfmac_f32_16x16x64_bf16 v[124:127], a[72:75], v[212:219], v20
    ds_read_b128 v[232:235], v2 offset:4096
    s_waitcnt lgkmcnt(5)
    v_xad_u32 v236, v236, v3, v4
    v_smfmac_f32_16x16x64_bf16 v[156:159], a[32:35], v[196:203], v48
    s_barrier
    v_xad_u32 v237, v237, v3, v4
    v_smfmac_f32_16x16x64_bf16 v[156:159], a[68:71], v[204:211], v48 abid:1
    ds_read2st64_b32 v[244:245], v236 offset0:0 offset1:72
    ds_read_b128 v[240:243], v8 offset:3072
    v_xad_u32 v238, v238, v3, v4
    v_smfmac_f32_16x16x64_bf16 v[156:159], a[104:107], v[212:219], v49
    ds_read2st64_b32 v[246:247], v237 offset0:0 offset1:72
    v_xad_u32 v239, v239, v3, v4
    v_smfmac_f32_16x16x64_bf16 v[132:135], a[8:11], v[196:203], v13
    ds_read2st64_b32 v[248:249], v238 offset0:0 offset1:72
    v_cndmask_b32_dpp v166, v162, v170, vcc row_ror:8 row_mask:0xf bank_mask:0xf
    v_smfmac_f32_16x16x64_bf16 v[132:135], a[44:47], v[204:211], v17
    ds_read2st64_b32 v[250:251], v239 offset0:0 offset1:72
    ds_read_b128 v[236:239], v9 offset:9280
    v_cndmask_b32_dpp v167, v163, v171, vcc row_ror:8 row_mask:0xf bank_mask:0xf
    v_smfmac_f32_16x16x64_bf16 v[132:135], a[80:83], v[212:219], v21
    buffer_store_dwordx4 v[164:167], v6, s[12:15], s58 offen offset:0 sc1
    v_mov_b32_dpp v160, v168 row_ror:8 row_mask:0xf bank_mask:0xc
    v_smfmac_f32_16x16x64_bf16 v[140:143], a[16:19], v[196:203], v14
    v_mov_b32_dpp v161, v169 row_ror:8 row_mask:0xf bank_mask:0xc
    v_smfmac_f32_16x16x64_bf16 v[140:143], a[52:55], v[204:211], v18
    v_mov_b32_dpp v162, v170 row_ror:8 row_mask:0xf bank_mask:0xc
    v_smfmac_f32_16x16x64_bf16 v[140:143], a[88:91], v[212:219], v22
    v_mov_b32_dpp v163, v171 row_ror:8 row_mask:0xf bank_mask:0xc
    v_smfmac_f32_16x16x64_bf16 v[136:139], a[12:15], v[196:203], v13 abid:1
    buffer_store_dwordx4 v[160:163], v6, s[12:15], s23 offen offset:0 sc1
    ds_read_b128 v[164:167], v9 offset:10304
    ds_read_b128 v[168:171], v9 offset:10368
    v_smfmac_f32_16x16x64_bf16 v[136:139], a[48:51], v[204:211], v17 abid:1
    ds_read_b128 v[160:163], v9 offset:10240
    v_smfmac_f32_16x16x64_bf16 v[136:139], a[84:87], v[212:219], v21 abid:1
    s_waitcnt lgkmcnt(3)
    v_xad_u32 v236, v236, v3, v4
    v_smfmac_f32_16x16x64_bf16 v[136:139], v[240:243], v[244:251], v10
    v_xad_u32 v237, v237, v3, v4
    v_smfmac_f32_16x16x64_bf16 v[172:175], v[240:243], v[244:251], v10 abid:1
    ds_read2st64_b32 v[244:245], v236 offset0:0 offset1:72
    ds_read_b128 v[240:243], v8 offset:1024
    v_xad_u32 v238, v238, v3, v4
    v_smfmac_f32_16x16x64_bf16 v[144:147], a[20:23], v[196:203], v14 abid:1
    ds_read2st64_b32 v[246:247], v237 offset0:0 offset1:72
    v_xad_u32 v239, v239, v3, v4
    v_smfmac_f32_16x16x64_bf16 v[144:147], a[56:59], v[204:211], v18 abid:1
    ds_read2st64_b32 v[248:249], v238 offset0:0 offset1:72
    v_smfmac_f32_16x16x64_bf16 v[144:147], a[92:95], v[212:219], v22 abid:1
    ds_read2st64_b32 v[250:251], v239 offset0:0 offset1:72
    ds_read_b128 v[236:239], v9 offset:9344
    v_smfmac_f32_16x16x64_bf16 v[148:151], a[24:27], v[196:203], v15
    v_cvt_pk_bf16_f32 v192, v192, v193
    v_smfmac_f32_16x16x64_bf16 v[148:151], a[60:63], v[204:211], v19
    v_cvt_pk_bf16_f32 v193, v194, v195
    v_smfmac_f32_16x16x64_bf16 v[148:151], a[96:99], v[212:219], v23
    ds_write_b64 v53, v[192:193] offset:0
    ds_read_b128 v[192:195], v9 offset:10752
    v_smfmac_f32_16x16x64_bf16 v[152:155], a[28:31], v[196:203], v15 abid:1
    v_smfmac_f32_16x16x64_bf16 v[152:155], a[64:67], v[204:211], v19 abid:1
    v_smfmac_f32_16x16x64_bf16 v[152:155], a[100:103], v[212:219], v23 abid:1
    v_smfmac_f32_16x16x64_bf16 v[128:131], a[4:7], v[196:203], v12 abid:1
    v_smfmac_f32_16x16x64_bf16 v[128:131], a[40:43], v[204:211], v16 abid:1
    v_smfmac_f32_16x16x64_bf16 v[128:131], a[76:79], v[212:219], v20 abid:1
    s_waitcnt lgkmcnt(2)
    v_xad_u32 v236, v236, v3, v4
    v_smfmac_f32_16x16x64_bf16 v[128:131], v[240:243], v[244:251], v10
    ds_read_b128 v[196:199], v1 offset:5120
    v_xad_u32 v237, v237, v3, v4
    v_smfmac_f32_16x16x64_bf16 v[164:167], v[240:243], v[244:251], v10 abid:1
    ds_read2st64_b32 v[244:245], v236 offset0:0 offset1:72
    ds_read_b128 v[240:243], v8 offset:2048
    v_xad_u32 v238, v238, v3, v4
    v_smfmac_f32_16x16x64_bf16 v[124:127], a[108:111], v[220:227], v24
    ds_read2st64_b32 v[246:247], v237 offset0:0 offset1:72
    v_xad_u32 v239, v239, v3, v4
    v_smfmac_f32_16x16x64_bf16 v[124:127], a[144:147], v[228:235], v28
    ds_read2st64_b32 v[248:249], v238 offset0:0 offset1:72
    ds_read_b128 v[200:203], v2 offset:5120
    ds_read_b64 v[216:217], v9 offset:10056
    v_smfmac_f32_16x16x64_bf16 v[128:131], a[112:115], v[220:227], v24 abid:1
    ds_read2st64_b32 v[250:251], v239 offset0:0 offset1:72
    ds_read_b128 v[236:239], v9 offset:9216
    v_cvt_pk_bf16_f32 v176, v176, v177
    v_smfmac_f32_16x16x64_bf16 v[128:131], a[148:151], v[228:235], v28 abid:1
    ds_read_b128 v[204:207], v1 offset:6144
    v_cvt_pk_bf16_f32 v177, v178, v179
    v_smfmac_f32_16x16x64_bf16 v[140:143], a[124:127], v[220:227], v26
    ds_read_b128 v[208:211], v2 offset:6144
    v_cvt_pk_bf16_f32 v178, v180, v181
    v_smfmac_f32_16x16x64_bf16 v[140:143], a[160:163], v[228:235], v30
    v_cvt_pk_bf16_f32 v179, v182, v183
    v_smfmac_f32_16x16x64_bf16 v[136:139], a[120:123], v[220:227], v25 abid:1
    v_cvt_pk_bf16_f32 v184, v184, v185
    v_smfmac_f32_16x16x64_bf16 v[136:139], a[156:159], v[228:235], v29 abid:1
    v_cvt_pk_bf16_f32 v185, v186, v187
    v_smfmac_f32_16x16x64_bf16 v[132:135], a[116:119], v[220:227], v25
    v_cvt_pk_bf16_f32 v186, v188, v189
    v_smfmac_f32_16x16x64_bf16 v[132:135], a[152:155], v[228:235], v29
    s_waitcnt lgkmcnt(2)
    v_xad_u32 v236, v236, v3, v4
    v_smfmac_f32_16x16x64_bf16 v[132:135], v[240:243], v[244:251], v10
    v_xad_u32 v237, v237, v3, v4
    v_smfmac_f32_16x16x64_bf16 v[168:171], v[240:243], v[244:251], v10 abid:1
    ds_read2st64_b32 v[244:245], v236 offset0:0 offset1:72
    ds_read_b128 v[240:243], v8 offset:0
    v_xad_u32 v238, v238, v3, v4
    v_smfmac_f32_16x16x64_bf16 v[144:147], a[128:131], v[220:227], v26 abid:1
    ds_read2st64_b32 v[246:247], v237 offset0:0 offset1:72
    v_xad_u32 v239, v239, v3, v4
    v_smfmac_f32_16x16x64_bf16 v[144:147], a[164:167], v[228:235], v30 abid:1
    ds_read2st64_b32 v[248:249], v238 offset0:0 offset1:72
    v_cvt_pk_bf16_f32 v187, v190, v191
    v_smfmac_f32_16x16x64_bf16 v[148:151], a[132:135], v[220:227], v27
    ds_read2st64_b32 v[250:251], v239 offset0:0 offset1:72
    ds_read_b128 v[236:239], v9 offset:9728
    ds_read_b128 v[188:191], v9 offset:10688
    v_smfmac_f32_16x16x64_bf16 v[148:151], a[168:171], v[228:235], v31
    v_xad_u32 v212, v216, v3, v4
    v_smfmac_f32_16x16x64_bf16 v[152:155], a[136:139], v[220:227], v27 abid:1
    ds_read2st64_b32 v[212:213], v212 offset0:0 offset1:72
    v_xad_u32 v214, v217, v3, v4
    v_smfmac_f32_16x16x64_bf16 v[152:155], a[172:175], v[228:235], v31 abid:1
    ds_read2st64_b32 v[214:215], v214 offset0:0 offset1:72
    v_cndmask_b32_dpp v180, v176, v184, vcc row_ror:8 row_mask:0xf bank_mask:0xf
    v_smfmac_f32_16x16x64_bf16 v[156:159], a[140:143], v[220:227], v49 abid:1
    v_cndmask_b32_dpp v181, v177, v185, vcc row_ror:8 row_mask:0xf bank_mask:0xf
    v_smfmac_f32_16x16x64_bf16 v[156:159], a[176:179], v[228:235], v50
    ds_read_b128 v[220:223], v1 offset:7168
    v_cndmask_b32_dpp v182, v178, v186, vcc row_ror:8 row_mask:0xf bank_mask:0xf
    v_smfmac_f32_16x16x64_bf16 v[128:131], a[184:187], v[196:203], v32 abid:1
    ds_read_b128 v[224:227], v2 offset:7168
    s_waitcnt lgkmcnt(11)
    v_cndmask_b32_dpp v183, v179, v187, vcc row_ror:8 row_mask:0xf bank_mask:0xf
    v_smfmac_f32_16x16x64_bf16 v[128:131], a[220:223], v[204:211], v36 abid:1
    ds_read_b128 v[228:231], v1 offset:8192
    buffer_store_dwordx4 v[180:183], v6, s[12:15], s58 offen offset:128 sc1
    v_mov_b32_dpp v176, v184 row_ror:8 row_mask:0xf bank_mask:0xc
    v_smfmac_f32_16x16x64_bf16 v[124:127], a[180:183], v[196:203], v32
    ds_read_b128 v[232:235], v2 offset:8192
    v_mov_b32_dpp v177, v185 row_ror:8 row_mask:0xf bank_mask:0xc
    v_smfmac_f32_16x16x64_bf16 v[124:127], a[216:219], v[204:211], v36
    s_waitcnt lgkmcnt(7)
    v_xad_u32 v236, v236, v3, v4
    v_smfmac_f32_16x16x64_bf16 v[124:127], v[240:243], v[244:251], v10
    v_xad_u32 v237, v237, v3, v4
    v_smfmac_f32_16x16x64_bf16 v[160:163], v[240:243], v[244:251], v10 abid:1
    ds_read2st64_b32 v[244:245], v236 offset0:0 offset1:72
    ds_read_b128 v[240:243], v8 offset:8192
    v_xad_u32 v238, v238, v3, v4
    v_smfmac_f32_16x16x64_bf16 v[132:135], a[188:191], v[196:203], v33
    ds_read2st64_b32 v[246:247], v237 offset0:0 offset1:72
    v_xad_u32 v239, v239, v3, v4
    v_smfmac_f32_16x16x64_bf16 v[132:135], a[224:227], v[204:211], v37
    ds_read2st64_b32 v[248:249], v238 offset0:0 offset1:72
    v_mov_b32_dpp v178, v186 row_ror:8 row_mask:0xf bank_mask:0xc
    v_smfmac_f32_16x16x64_bf16 v[136:139], a[192:195], v[196:203], v33 abid:1
    ds_read2st64_b32 v[250:251], v239 offset0:0 offset1:72
    ds_read_b128 v[236:239], v9 offset:9664
    v_mov_b32_dpp v179, v187 row_ror:8 row_mask:0xf bank_mask:0xc
    v_smfmac_f32_16x16x64_bf16 v[136:139], a[228:231], v[204:211], v37 abid:1
    buffer_store_dwordx4 v[176:179], v6, s[12:15], s23 offen offset:128 sc1
    ds_read_b128 v[180:183], v9 offset:10560
    ds_read_b128 v[184:187], v9 offset:10624
    v_smfmac_f32_16x16x64_bf16 v[140:143], a[196:199], v[196:203], v34
    ds_read_b128 v[176:179], v9 offset:10496
    v_smfmac_f32_16x16x64_bf16 v[140:143], a[232:235], v[204:211], v38
    v_smfmac_f32_16x16x64_bf16 v[144:147], a[200:203], v[196:203], v34 abid:1
    v_smfmac_f32_16x16x64_bf16 v[144:147], a[236:239], v[204:211], v38 abid:1
    v_smfmac_f32_16x16x64_bf16 v[156:159], a[212:215], v[196:203], v50 abid:1
    v_smfmac_f32_16x16x64_bf16 v[156:159], a[248:251], v[204:211], v51
    s_waitcnt lgkmcnt(3)
    v_xad_u32 v236, v236, v3, v4
    v_smfmac_f32_16x16x64_bf16 v[156:159], v[240:243], v[244:251], v10
    v_xad_u32 v237, v237, v3, v4
    v_smfmac_f32_16x16x64_bf16 v[192:195], v[240:243], v[244:251], v10 abid:1
    ds_read2st64_b32 v[244:245], v236 offset0:0 offset1:72
    ds_read_b128 v[240:243], v8 offset:7168
    v_xad_u32 v238, v238, v3, v4
    v_smfmac_f32_16x16x64_bf16 v[152:155], a[208:211], v[196:203], v35 abid:1
    ds_read2st64_b32 v[246:247], v237 offset0:0 offset1:72
    v_xad_u32 v239, v239, v3, v4
    v_smfmac_f32_16x16x64_bf16 v[152:155], a[244:247], v[204:211], v39 abid:1
    ds_read2st64_b32 v[248:249], v238 offset0:0 offset1:72
    v_smfmac_f32_16x16x64_bf16 v[148:151], a[204:207], v[196:203], v35
    ds_read2st64_b32 v[250:251], v239 offset0:0 offset1:72
    ds_read_b128 v[236:239], v9 offset:9536
    v_smfmac_f32_16x16x64_bf16 v[148:151], a[240:243], v[204:211], v39
    ds_read_b128 v[196:199], v1 offset:18432
    v_smfmac_f32_16x16x64_bf16 v[124:127], a[252:255], v[220:227], v40
    ds_read_b128 v[200:203], v2 offset:18432
    v_smfmac_f32_16x16x64_bf16 v[124:127], v[88:91], v[228:235], v44
    ds_read_b128 v[204:207], v1 offset:19456
    v_smfmac_f32_16x16x64_bf16 v[128:131], v[56:59], v[220:227], v40 abid:1
    ds_read_b128 v[208:211], v2 offset:19456
    v_smfmac_f32_16x16x64_bf16 v[128:131], v[92:95], v[228:235], v44 abid:1
    s_waitcnt lgkmcnt(10)
    s_cmp_lt_i32 s81, 0
    s_cbranch_scc1 M_ovrF
    s_swappc_b64 s[78:79], s[72:73]
M_ovrF:
    v_smfmac_f32_16x16x64_bf16 v[132:135], v[60:63], v[220:227], v41
    s_cmp_lt_u32 s20, 2
    s_cselect_b32 s66, s23, s24
    s_add_u32 s66, s66, s95
    v_smfmac_f32_16x16x64_bf16 v[132:135], v[96:99], v[228:235], v45
    s_add_u32 s23, s24, 18432
    s_add_u32 s58, s24, 27648
    s_add_u32 s67, s23, s95
    v_smfmac_f32_16x16x64_bf16 v[152:155], v[80:83], v[220:227], v43 abid:1
    v_smfmac_f32_16x16x64_bf16 v[152:155], v[116:119], v[228:235], v47 abid:1
    s_waitcnt lgkmcnt(4)
    v_xad_u32 v236, v236, v3, v4
    v_smfmac_f32_16x16x64_bf16 v[152:155], v[240:243], v[244:251], v10
    v_xad_u32 v237, v237, v3, v4
    v_smfmac_f32_16x16x64_bf16 v[188:191], v[240:243], v[244:251], v10 abid:1
    s_cmp_gt_u32 s46, s80
    s_cbranch_scc1 M_slow
M_slowrF:
    v_xad_u32 v238, v238, v3, v4
    v_smfmac_f32_16x16x64_bf16 v[140:143], v[68:71], v[220:227], v42
    ds_read2st64_b32 v[244:245], v236 offset0:0 offset1:72
    ds_read_b128 v[240:243], v8 offset:5120
    v_xad_u32 v239, v239, v3, v4
    v_smfmac_f32_16x16x64_bf16 v[140:143], v[104:107], v[228:235], v46
    ds_read2st64_b32 v[246:247], v237 offset0:0 offset1:72
    v_smfmac_f32_16x16x64_bf16 v[156:159], v[84:87], v[220:227], v51 abid:1
    ds_read2st64_b32 v[248:249], v238 offset0:0 offset1:72
    ds_read_b128 v[212:215], v1 offset:20480
    v_smfmac_f32_16x16x64_bf16 v[156:159], v[120:123], v[228:235], v52
    ds_read2st64_b32 v[250:251], v239 offset0:0 offset1:72
    ds_read_b128 v[236:239], v9 offset:9600
    v_smfmac_f32_16x16x64_bf16 v[148:151], v[76:79], v[220:227], v43
    ds_read_b128 v[216:219], v2 offset:20480
    v_smfmac_f32_16x16x64_bf16 v[148:151], v[112:115], v[228:235], v47
    v_smfmac_f32_16x16x64_bf16 v[136:139], v[64:67], v[220:227], v41 abid:1
    v_smfmac_f32_16x16x64_bf16 v[136:139], v[100:103], v[228:235], v45 abid:1
    v_smfmac_f32_16x16x64_bf16 v[144:147], v[72:75], v[220:227], v42 abid:1
    v_smfmac_f32_16x16x64_bf16 v[144:147], v[108:111], v[228:235], v46 abid:1
    ds_read_b128 v[220:223], v1 offset:21504
    s_waitcnt lgkmcnt(2)
    v_xad_u32 v236, v236, v3, v4
    v_smfmac_f32_16x16x64_bf16 v[144:147], v[240:243], v[244:251], v10
    ds_read_b128 v[224:227], v2 offset:21504
    v_xad_u32 v237, v237, v3, v4
    v_smfmac_f32_16x16x64_bf16 v[180:183], v[240:243], v[244:251], v10 abid:1
    ds_read2st64_b32 v[244:245], v236 offset0:0 offset1:72
    ds_read_b128 v[240:243], v8 offset:6144
    v_xad_u32 v238, v238, v3, v4
    v_smfmac_f32_16x16x64_bf16 v[192:195], a[32:35], v[196:203], v48
    ds_read2st64_b32 v[246:247], v237 offset0:0 offset1:72
    ds_read_b128 v[228:231], v1 offset:22528
    v_xad_u32 v239, v239, v3, v4
    v_smfmac_f32_16x16x64_bf16 v[192:195], a[68:71], v[204:211], v48 abid:1
    ds_read2st64_b32 v[248:249], v238 offset0:0 offset1:72
    ds_read_b128 v[232:235], v2 offset:22528
    s_waitcnt lgkmcnt(8)
    v_cvt_pk_bf16_f32 v124, v124, v125
    v_smfmac_f32_16x16x64_bf16 v[192:195], a[104:107], v[212:219], v49
    ds_read2st64_b32 v[250:251], v239 offset0:0 offset1:72
    ds_read_b128 v[236:239], v9 offset:9472
    v_cvt_pk_bf16_f32 v125, v126, v127
    v_smfmac_f32_16x16x64_bf16 v[160:163], a[0:3], v[196:203], v12
    v_cvt_pk_bf16_f32 v126, v128, v129
    v_smfmac_f32_16x16x64_bf16 v[160:163], a[36:39], v[204:211], v16
    v_cvt_pk_bf16_f32 v127, v130, v131
    v_smfmac_f32_16x16x64_bf16 v[160:163], a[72:75], v[212:219], v20
    v_cvt_pk_bf16_f32 v156, v156, v157
    v_smfmac_f32_16x16x64_bf16 v[164:167], a[4:7], v[196:203], v12 abid:1
    v_cvt_pk_bf16_f32 v157, v158, v159
    v_smfmac_f32_16x16x64_bf16 v[164:167], a[40:43], v[204:211], v16 abid:1
    ds_write_b64 v53, v[156:157] offset:25728
    v_cvt_pk_bf16_f32 v132, v132, v133
    v_smfmac_f32_16x16x64_bf16 v[164:167], a[76:79], v[212:219], v20 abid:1
    v_cvt_pk_bf16_f32 v133, v134, v135
    v_smfmac_f32_16x16x64_bf16 v[168:171], a[8:11], v[196:203], v13
    v_cvt_pk_bf16_f32 v134, v136, v137
    v_smfmac_f32_16x16x64_bf16 v[168:171], a[44:47], v[204:211], v17
    v_cvt_pk_bf16_f32 v135, v138, v139
    v_smfmac_f32_16x16x64_bf16 v[168:171], a[80:83], v[212:219], v21
    s_waitcnt lgkmcnt(1)
    v_xad_u32 v236, v236, v3, v4
    v_smfmac_f32_16x16x64_bf16 v[184:187], v[240:243], v[244:251], v10 abid:1
    v_xad_u32 v237, v237, v3, v4
    v_smfmac_f32_16x16x64_bf16 v[148:151], v[240:243], v[244:251], v10
    ds_read2st64_b32 v[244:245], v236 offset0:0 offset1:72
    ds_read_b128 v[240:243], v8 offset:4096
    v_xad_u32 v238, v238, v3, v4
    v_smfmac_f32_16x16x64_bf16 v[172:175], a[12:15], v[196:203], v13 abid:1
    ds_read2st64_b32 v[246:247], v237 offset0:0 offset1:72
    v_xad_u32 v239, v239, v3, v4
    v_smfmac_f32_16x16x64_bf16 v[172:175], a[48:51], v[204:211], v17 abid:1
    ds_read2st64_b32 v[248:249], v238 offset0:0 offset1:72
    v_cndmask_b32_dpp v128, v124, v132, vcc row_ror:8 row_mask:0xf bank_mask:0xf
    v_smfmac_f32_16x16x64_bf16 v[172:175], a[84:87], v[212:219], v21 abid:1
    ds_read2st64_b32 v[250:251], v239 offset0:0 offset1:72
    ds_read_b128 v[196:199], v1 offset:23552
    v_cndmask_b32_dpp v129, v125, v133, vcc row_ror:8 row_mask:0xf bank_mask:0xf
    v_smfmac_f32_16x16x64_bf16 v[192:195], a[140:143], v[220:227], v49 abid:1
    ds_read_b128 v[200:203], v2 offset:23552
    v_cndmask_b32_dpp v130, v126, v134, vcc row_ror:8 row_mask:0xf bank_mask:0xf
    v_smfmac_f32_16x16x64_bf16 v[192:195], a[176:179], v[228:235], v50
    ds_read_b128 v[204:207], v1 offset:24576
    v_cndmask_b32_dpp v131, v127, v135, vcc row_ror:8 row_mask:0xf bank_mask:0xf
    v_smfmac_f32_16x16x64_bf16 v[160:163], a[108:111], v[220:227], v24
    ds_read_b128 v[208:211], v2 offset:24576
    buffer_store_dwordx4 v[128:131], v6, s[12:15], s59 offen offset:0 sc1
    v_mov_b32_dpp v124, v132 row_ror:8 row_mask:0xf bank_mask:0xc
    v_smfmac_f32_16x16x64_bf16 v[160:163], a[144:147], v[228:235], v28
    s_waitcnt lgkmcnt(9)
    s_barrier
    ds_read_b128 v[236:239], v8 offset:10816
    v_mov_b32_dpp v125, v133 row_ror:8 row_mask:0xf bank_mask:0xc
    v_smfmac_f32_16x16x64_bf16 v[164:167], a[112:115], v[220:227], v24 abid:1
    ds_read_b128 v[212:215], v1 offset:20480
    v_mov_b32_dpp v126, v134 row_ror:8 row_mask:0xf bank_mask:0xc
    v_smfmac_f32_16x16x64_bf16 v[164:167], a[148:151], v[228:235], v28 abid:1
    ds_read_b128 v[216:219], v2 offset:20480
    v_mov_b32_dpp v127, v135 row_ror:8 row_mask:0xf bank_mask:0xc
    v_smfmac_f32_16x16x64_bf16 v[168:171], a[116:119], v[220:227], v25
    buffer_store_dwordx4 v[124:127], v6, s[12:15], s24 offen offset:0 sc1
    v_smfmac_f32_16x16x64_bf16 v[168:171], a[152:155], v[228:235], v29
    s_waitcnt lgkmcnt(7)
    v_smfmac_f32_16x16x64_bf16 v[176:179], v[240:243], v[244:251], v10 abid:1
    v_smfmac_f32_16x16x64_bf16 v[140:143], v[240:243], v[244:251], v10
    s_waitcnt lgkmcnt(2)
    buffer_store_dwordx4 v[236:239], v7, s[12:15], s66 offen sc1
    v_smfmac_f32_16x16x64_bf16 v[172:175], a[120:123], v[220:227], v25 abid:1
    v_smfmac_f32_16x16x64_bf16 v[172:175], a[156:159], v[228:235], v29 abid:1
    ds_read_b128 v[220:223], v1 offset:25600
    v_smfmac_f32_16x16x64_bf16 v[192:195], a[212:215], v[196:203], v50 abid:1
    ds_read_b128 v[224:227], v2 offset:25600
    s_nop 0
    v_cvt_pk_bf16_f32 v140, v140, v141
    v_smfmac_f32_16x16x64_bf16 v[192:195], a[248:251], v[204:211], v51
    ds_read_b128 v[228:231], v1 offset:26624
    v_cvt_pk_bf16_f32 v141, v142, v143
    v_smfmac_f32_16x16x64_bf16 v[160:163], a[180:183], v[196:203], v32
    ds_read_b128 v[232:235], v2 offset:26624
    v_cvt_pk_bf16_f32 v142, v144, v145
    v_smfmac_f32_16x16x64_bf16 v[160:163], a[216:219], v[204:211], v36
    v_cvt_pk_bf16_f32 v143, v146, v147
    v_smfmac_f32_16x16x64_bf16 v[164:167], a[184:187], v[196:203], v32 abid:1
    v_cvt_pk_bf16_f32 v148, v148, v149
    v_smfmac_f32_16x16x64_bf16 v[164:167], a[220:223], v[204:211], v36 abid:1
    v_cvt_pk_bf16_f32 v149, v150, v151
    v_smfmac_f32_16x16x64_bf16 v[168:171], a[188:191], v[196:203], v33
    v_cvt_pk_bf16_f32 v150, v152, v153
    v_smfmac_f32_16x16x64_bf16 v[168:171], a[224:227], v[204:211], v37
    v_cvt_pk_bf16_f32 v151, v154, v155
    v_smfmac_f32_16x16x64_bf16 v[172:175], a[192:195], v[196:203], v33 abid:1
    v_cndmask_b32_dpp v144, v140, v148, vcc row_ror:8 row_mask:0xf bank_mask:0xf
    v_smfmac_f32_16x16x64_bf16 v[172:175], a[228:231], v[204:211], v37 abid:1
    ds_read_b128 v[196:199], v1 offset:18432
    s_waitcnt lgkmcnt(3)
    v_cndmask_b32_dpp v145, v141, v149, vcc row_ror:8 row_mask:0xf bank_mask:0xf
    v_smfmac_f32_16x16x64_bf16 v[192:195], v[84:87], v[220:227], v51 abid:1
    ds_read_b128 v[200:203], v2 offset:18432
    s_waitcnt lgkmcnt(2)
    v_cndmask_b32_dpp v146, v142, v150, vcc row_ror:8 row_mask:0xf bank_mask:0xf
    v_smfmac_f32_16x16x64_bf16 v[192:195], v[120:123], v[228:235], v52
    ds_read_b128 v[204:207], v1 offset:19456
    v_cndmask_b32_dpp v147, v143, v151, vcc row_ror:8 row_mask:0xf bank_mask:0xf
    v_smfmac_f32_16x16x64_bf16 v[160:163], a[252:255], v[220:227], v40
    ds_read_b128 v[208:211], v2 offset:19456
    buffer_store_dwordx4 v[144:147], v6, s[12:15], s59 offen offset:128 sc1
    v_mov_b32_dpp v140, v148 row_ror:8 row_mask:0xf bank_mask:0xc
    v_smfmac_f32_16x16x64_bf16 v[160:163], v[88:91], v[228:235], v44
    v_mov_b32_dpp v141, v149 row_ror:8 row_mask:0xf bank_mask:0xc
    v_smfmac_f32_16x16x64_bf16 v[164:167], v[56:59], v[220:227], v40 abid:1
    v_mov_b32_dpp v142, v150 row_ror:8 row_mask:0xf bank_mask:0xc
    v_smfmac_f32_16x16x64_bf16 v[164:167], v[92:95], v[228:235], v44 abid:1
    v_mov_b32_dpp v143, v151 row_ror:8 row_mask:0xf bank_mask:0xc
    v_smfmac_f32_16x16x64_bf16 v[168:171], v[60:63], v[220:227], v41
    buffer_store_dwordx4 v[140:143], v6, s[12:15], s24 offen offset:128 sc1
    v_cvt_pk_bf16_f32 v192, v192, v193
    v_smfmac_f32_16x16x64_bf16 v[168:171], v[96:99], v[228:235], v45
    v_cvt_pk_bf16_f32 v193, v194, v195
    v_smfmac_f32_16x16x64_bf16 v[172:175], v[64:67], v[220:227], v41 abid:1
    ds_write_b64 v53, v[192:193] offset:1024
    v_smfmac_f32_16x16x64_bf16 v[172:175], v[100:103], v[228:235], v45 abid:1
    ds_read_b128 v[220:223], v1 offset:21504
    s_waitcnt lgkmcnt(4)
    v_smfmac_f32_16x16x64_bf16 v[176:179], a[16:19], v[196:203], v14
    ds_read_b128 v[224:227], v2 offset:21504
    s_waitcnt lgkmcnt(3)
    v_smfmac_f32_16x16x64_bf16 v[176:179], a[52:55], v[204:211], v18
    ds_read_b128 v[228:231], v1 offset:22528
    v_smfmac_f32_16x16x64_bf16 v[176:179], a[88:91], v[212:219], v22
    ds_read_b128 v[232:235], v2 offset:22528
    s_waitcnt lgkmcnt(4)
    s_barrier
    ds_read_b128 v[236:239], v8 offset:11840
    v_smfmac_f32_16x16x64_bf16 v[180:183], a[20:23], v[196:203], v14 abid:1
    v_cvt_pk_bf16_f32 v160, v160, v161
    v_smfmac_f32_16x16x64_bf16 v[180:183], a[56:59], v[204:211], v18 abid:1
    v_cvt_pk_bf16_f32 v161, v162, v163
    v_smfmac_f32_16x16x64_bf16 v[180:183], a[92:95], v[212:219], v22 abid:1
    v_cvt_pk_bf16_f32 v162, v164, v165
    v_smfmac_f32_16x16x64_bf16 v[184:187], a[24:27], v[196:203], v15
    v_cvt_pk_bf16_f32 v163, v166, v167
    v_smfmac_f32_16x16x64_bf16 v[184:187], a[60:63], v[204:211], v19
    v_cvt_pk_bf16_f32 v168, v168, v169
    v_smfmac_f32_16x16x64_bf16 v[184:187], a[96:99], v[212:219], v23
    s_cmp_lt_u32 s20, 2
    s_waitcnt lgkmcnt(0)
    s_cbranch_scc0 M_fx
    buffer_store_dwordx4 v[236:239], v7, s[12:15], s67 offen sc1
M_fx:
    v_smfmac_f32_16x16x64_bf16 v[188:191], a[28:31], v[196:203], v15 abid:1
    v_cvt_pk_bf16_f32 v169, v170, v171
    v_smfmac_f32_16x16x64_bf16 v[188:191], a[64:67], v[204:211], v19 abid:1
    v_cvt_pk_bf16_f32 v170, v172, v173
    v_smfmac_f32_16x16x64_bf16 v[188:191], a[100:103], v[212:219], v23 abid:1
    ds_read_b128 v[196:199], v1 offset:23552
    v_cvt_pk_bf16_f32 v171, v174, v175
    v_smfmac_f32_16x16x64_bf16 v[176:179], a[124:127], v[220:227], v26
    ds_read_b128 v[200:203], v2 offset:23552
    v_cndmask_b32_dpp v164, v160, v168, vcc row_ror:8 row_mask:0xf bank_mask:0xf
    v_smfmac_f32_16x16x64_bf16 v[176:179], a[160:163], v[228:235], v30
    ds_read_b128 v[204:207], v1 offset:24576
    v_cndmask_b32_dpp v165, v161, v169, vcc row_ror:8 row_mask:0xf bank_mask:0xf
    v_smfmac_f32_16x16x64_bf16 v[180:183], a[128:131], v[220:227], v26 abid:1
    ds_read_b128 v[208:211], v2 offset:24576
    v_cndmask_b32_dpp v166, v162, v170, vcc row_ror:8 row_mask:0xf bank_mask:0xf
    v_smfmac_f32_16x16x64_bf16 v[180:183], a[164:167], v[228:235], v30 abid:1
    v_cndmask_b32_dpp v167, v163, v171, vcc row_ror:8 row_mask:0xf bank_mask:0xf
    v_smfmac_f32_16x16x64_bf16 v[184:187], a[132:135], v[220:227], v27
    buffer_store_dwordx4 v[164:167], v6, s[12:15], s58 offen offset:0 sc1
    v_mov_b32_dpp v160, v168 row_ror:8 row_mask:0xf bank_mask:0xc
    v_smfmac_f32_16x16x64_bf16 v[184:187], a[168:171], v[228:235], v31
    v_mov_b32_dpp v161, v169 row_ror:8 row_mask:0xf bank_mask:0xc
    v_smfmac_f32_16x16x64_bf16 v[188:191], a[136:139], v[220:227], v27 abid:1
    v_mov_b32_dpp v162, v170 row_ror:8 row_mask:0xf bank_mask:0xc
    v_smfmac_f32_16x16x64_bf16 v[188:191], a[172:175], v[228:235], v31 abid:1
    ds_read_b128 v[220:223], v1 offset:25600
    s_waitcnt lgkmcnt(3)
    v_mov_b32_dpp v163, v171 row_ror:8 row_mask:0xf bank_mask:0xc
    v_smfmac_f32_16x16x64_bf16 v[176:179], a[196:199], v[196:203], v34
    ds_read_b128 v[224:227], v2 offset:25600
    buffer_store_dwordx4 v[160:163], v6, s[12:15], s23 offen offset:0 sc1
    s_waitcnt lgkmcnt(2)
    v_smfmac_f32_16x16x64_bf16 v[176:179], a[232:235], v[204:211], v38
    ds_read_b128 v[228:231], v1 offset:26624
    v_smfmac_f32_16x16x64_bf16 v[180:183], a[200:203], v[196:203], v34 abid:1
    ds_read_b128 v[232:235], v2 offset:26624
    v_smfmac_f32_16x16x64_bf16 v[180:183], a[236:239], v[204:211], v38 abid:1
    v_smfmac_f32_16x16x64_bf16 v[184:187], a[204:207], v[196:203], v35
    v_smfmac_f32_16x16x64_bf16 v[184:187], a[240:243], v[204:211], v39
    v_smfmac_f32_16x16x64_bf16 v[188:191], a[208:211], v[196:203], v35 abid:1
    v_smfmac_f32_16x16x64_bf16 v[188:191], a[244:247], v[204:211], v39 abid:1
    s_waitcnt lgkmcnt(2)
    v_smfmac_f32_16x16x64_bf16 v[176:179], v[68:71], v[220:227], v42
    s_waitcnt lgkmcnt(0)
    v_smfmac_f32_16x16x64_bf16 v[176:179], v[104:107], v[228:235], v46
    v_smfmac_f32_16x16x64_bf16 v[180:183], v[72:75], v[220:227], v42 abid:1
    v_smfmac_f32_16x16x64_bf16 v[180:183], v[108:111], v[228:235], v46 abid:1
    v_smfmac_f32_16x16x64_bf16 v[184:187], v[76:79], v[220:227], v43
    v_smfmac_f32_16x16x64_bf16 v[184:187], v[112:115], v[228:235], v47
    v_smfmac_f32_16x16x64_bf16 v[188:191], v[80:83], v[220:227], v43 abid:1
    v_smfmac_f32_16x16x64_bf16 v[188:191], v[116:119], v[228:235], v47 abid:1
    s_nop 1
    v_cvt_pk_bf16_f32 v176, v176, v177
    v_cvt_pk_bf16_f32 v177, v178, v179
    v_cvt_pk_bf16_f32 v178, v180, v181
    v_cvt_pk_bf16_f32 v179, v182, v183
    v_cvt_pk_bf16_f32 v184, v184, v185
    v_cvt_pk_bf16_f32 v185, v186, v187
    v_cvt_pk_bf16_f32 v186, v188, v189
    v_cvt_pk_bf16_f32 v187, v190, v191
    v_cndmask_b32_dpp v180, v176, v184, vcc row_ror:8 row_mask:0xf bank_mask:0xf
    v_cndmask_b32_dpp v181, v177, v185, vcc row_ror:8 row_mask:0xf bank_mask:0xf
    v_cndmask_b32_dpp v182, v178, v186, vcc row_ror:8 row_mask:0xf bank_mask:0xf
    v_cndmask_b32_dpp v183, v179, v187, vcc row_ror:8 row_mask:0xf bank_mask:0xf
    buffer_store_dwordx4 v[180:183], v6, s[12:15], s58 offen offset:128 sc1
    v_mov_b32_dpp v176, v184 row_ror:8 row_mask:0xf bank_mask:0xc
    v_mov_b32_dpp v177, v185 row_ror:8 row_mask:0xf bank_mask:0xc
    v_mov_b32_dpp v178, v186 row_ror:8 row_mask:0xf bank_mask:0xc
    v_mov_b32_dpp v179, v187 row_ror:8 row_mask:0xf bank_mask:0xc
    buffer_store_dwordx4 v[176:179], v6, s[12:15], s23 offen offset:128 sc1
M_done:
M_end:
    s_endpgm
M_pf_spin:
    s_sleep 4
    v_mov_b32 v0, 0
    s_mov_b64 exec, 1
    buffer_atomic_add v0, off, s[16:19], s96 sc0 sc1
    s_mov_b64 exec, -1
    s_add_u32 s31, s31, 1
    s_waitcnt vmcnt(0)
    v_readfirstlane_b32 s30, v0
    s_nop 0
    s_sub_u32 s30, s30, s100
    s_cmp_eq_u32 s30, 27
    s_cbranch_scc1 M_pf_ok
    s_cmp_lt_u32 s31, 6
    s_cbranch_scc1 M_pf_spin
    s_cmp_eq_u32 s98, 0
    s_cbranch_scc1 M_pf_spin2
    s_mov_b32 s98, 0
    v_mov_b32 v250, 1
    s_mov_b64 exec, 1
    buffer_atomic_add v250, off, s[68:71], 0 offset:0 sc1
    s_mov_b64 exec, -1
    s_nop 3
M_pf_spin2:
    buffer_load_dword v0, off, s[68:71], 0 offset:0 sc1
    s_cmp_ge_u32 s31, 131072
    s_cbranch_scc1 M_end
    s_waitcnt vmcnt(0)
    v_readfirstlane_b32 s30, v0
    s_nop 0
    s_cmp_eq_u32 s30, 81
    s_cbranch_scc0 M_pf_spin
    s_branch M_pf_ok
M_r3:
    v_bfe_u32 v74, v60, 24, 4
    v_lshlrev_b32 v75, 1, v60
    v_lshl_add_u32 v74, v74, 2, s49
    v_and_b32 v75, 16, v75
    v_and_or_b32 v74, v60, 2.0, v74
    v_lshlrev_b32 v75, v75, 1
    ds_add_rtn_u32 v64, v74, v75
    v_and_b32 v74, 8, v60
    v_lshrrev_b32 v77, 14, v60
    v_cmp_ne_u32 s[44:45], 0, v74
    v_and_b32 v80, 0x3cf0, v77
    s_waitcnt lgkmcnt(0)
    v_lshrrev_b32 v75, 16, v64
    v_and_b32 v76, 0xffff, v64
    v_sub_u32 v74, 15, v75
    v_and_b32 v64, 2.0, v60
    v_add3_u32 v64, v76, v75, v64
    v_cndmask_b32 v74, v76, v74, s[44:45]
    v_cmp_gt_u32 s[44:45], 16, v64
    v_cmp_gt_u32 s[36:37], 2.0, v64
    v_lshlrev_b32 v74, 2, v74
    v_lshrrev_b64 v[76:77], v74, s[50:51]
    s_andn2_b64 s[36:37], s[36:37], s[44:45]
    v_lshrrev_b64 v[78:79], v74, s[52:53]
    v_bfe_u32 v74, v60, 24, 4
    v_mbcnt_lo_u32_b32 v75, s36, 0
    v_and_b32 v76, 15, v76
    v_mbcnt_hi_u32_b32 v75, s37, v75
    v_and_b32 v78, 15, v78
    v_lshl_add_u32 v75, v75, 3, s40
    v_lshl_add_u32 v76, v74, 4, v76
    v_min_u32 v75, s41, v75
    v_mul_u32_u24 v78, 68, v78
    v_cndmask_b32 v75, v82, v75, s[36:37]
    ds_write_b64 v75, v[60:61]
    s_bcnt1_i32_b64 s30, s[36:37]
    s_lshl3_add_u32 s40, s30, s40
    v_lshl_add_u32 v76, v76, 2, s47
    v_and_b32 v78, 0x30c, v78
    v_cndmask_b32 v76, v82, v76, s[44:45]
    v_add3_u32 v77, v80, v78, s29
    v_and_b32 v78, 0x3fff, v60
    v_cndmask_b32 v74, v82, v77, s[44:45]
    ds_write_b32 v76, v78
    ds_write_b32 v74, v61
    s_cmp_gt_u32 s38, s39
    s_cselect_b32 s32, 1, s32
    s_branch M_r3r
M_dn:
    s_mov_b32 s27, 0
    s_mov_b32 s46, 0x80000000
    v_mov_b32 v244, 0
    v_mov_b32 v245, 0
    v_mov_b32 v246, 0
    v_mov_b32 v247, 0
    ds_write_b128 v8, v[244:247] offset:0
    ds_write_b128 v8, v[244:247] offset:1024
    ds_write_b128 v8, v[244:247] offset:2048
    ds_write_b128 v8, v[244:247] offset:3072
    ds_write_b128 v8, v[244:247] offset:4096
    ds_write_b128 v8, v[244:247] offset:5120
    ds_write_b128 v8, v[244:247] offset:6144
    ds_write_b128 v8, v[244:247] offset:7168
    ds_write_b128 v8, v[244:247] offset:8192
    s_waitcnt lgkmcnt(0)
    s_branch M_dnr
M_ovc0:
    v_smfmac_f32_16x16x32_bf16 v[124:127], v[54:55], v[212:215], v10
    v_smfmac_f32_16x16x32_bf16 v[160:163], v[54:55], v[212:215], v10 abid:2
    s_setpc_b64 s[74:75]
    v_smfmac_f32_16x16x32_bf16 v[128:131], v[54:55], v[212:215], v10
    v_smfmac_f32_16x16x32_bf16 v[164:167], v[54:55], v[212:215], v10 abid:2
    s_setpc_b64 s[74:75]
    v_smfmac_f32_16x16x32_bf16 v[132:135], v[54:55], v[212:215], v10
    v_smfmac_f32_16x16x32_bf16 v[168:171], v[54:55], v[212:215], v10 abid:2
    s_setpc_b64 s[74:75]
    v_smfmac_f32_16x16x32_bf16 v[136:139], v[54:55], v[212:215], v10
    v_smfmac_f32_16x16x32_bf16 v[172:175], v[54:55], v[212:215], v10 abid:2
    s_setpc_b64 s[74:75]
    v_smfmac_f32_16x16x32_bf16 v[140:143], v[54:55], v[212:215], v10
    v_smfmac_f32_16x16x32_bf16 v[176:179], v[54:55], v[212:215], v10 abid:2
    s_setpc_b64 s[74:75]
    v_smfmac_f32_16x16x32_bf16 v[144:147], v[54:55], v[212:215], v10
    v_smfmac_f32_16x16x32_bf16 v[180:183], v[54:55], v[212:215], v10 abid:2
    s_setpc_b64 s[74:75]
    v_smfmac_f32_16x16x32_bf16 v[148:151], v[54:55], v[212:215], v10
    v_smfmac_f32_16x16x32_bf16 v[184:187], v[54:55], v[212:215], v10 abid:2
    s_setpc_b64 s[74:75]
    v_smfmac_f32_16x16x32_bf16 v[152:155], v[54:55], v[212:215], v10
    v_smfmac_f32_16x16x32_bf16 v[188:191], v[54:55], v[212:215], v10 abid:2
    s_setpc_b64 s[74:75]
    v_smfmac_f32_16x16x32_bf16 v[156:159], v[54:55], v[212:215], v10
    v_smfmac_f32_16x16x32_bf16 v[192:195], v[54:55], v[212:215], v10 abid:2
    s_setpc_b64 s[74:75]
M_ovl0:
    v_smfmac_f32_16x16x32_bf16 v[124:127], v[54:55], v[212:215], v10
    v_smfmac_f32_16x16x32_bf16 v[160:163], v[54:55], v[212:215], v10 abid:2
    s_setpc_b64 s[78:79]
    v_smfmac_f32_16x16x32_bf16 v[128:131], v[54:55], v[212:215], v10
    v_smfmac_f32_16x16x32_bf16 v[164:167], v[54:55], v[212:215], v10 abid:2
    s_setpc_b64 s[78:79]
    v_smfmac_f32_16x16x32_bf16 v[132:135], v[54:55], v[212:215], v10
    v_smfmac_f32_16x16x32_bf16 v[168:171], v[54:55], v[212:215], v10 abid:2
    s_setpc_b64 s[78:79]
    v_smfmac_f32_16x16x32_bf16 v[136:139], v[54:55], v[212:215], v10
    v_smfmac_f32_16x16x32_bf16 v[172:175], v[54:55], v[212:215], v10 abid:2
    s_setpc_b64 s[78:79]
    v_smfmac_f32_16x16x32_bf16 v[140:143], v[54:55], v[212:215], v10
    v_smfmac_f32_16x16x32_bf16 v[176:179], v[54:55], v[212:215], v10 abid:2
    s_setpc_b64 s[78:79]
    v_smfmac_f32_16x16x32_bf16 v[144:147], v[54:55], v[212:215], v10
    v_smfmac_f32_16x16x32_bf16 v[180:183], v[54:55], v[212:215], v10 abid:2
    s_setpc_b64 s[78:79]
    v_smfmac_f32_16x16x32_bf16 v[148:151], v[54:55], v[212:215], v10
    v_smfmac_f32_16x16x32_bf16 v[184:187], v[54:55], v[212:215], v10 abid:2
    s_setpc_b64 s[78:79]
    v_smfmac_f32_16x16x32_bf16 v[152:155], v[54:55], v[212:215], v10
    v_smfmac_f32_16x16x32_bf16 v[188:191], v[54:55], v[212:215], v10 abid:2
    s_setpc_b64 s[78:79]
    v_smfmac_f32_16x16x32_bf16 v[156:159], v[54:55], v[212:215], v10
    v_smfmac_f32_16x16x32_bf16 v[192:195], v[54:55], v[212:215], v10 abid:2
    s_setpc_b64 s[78:79]
M_ovc1:
    v_smfmac_f32_16x16x32_bf16 v[124:127], v[252:253], v[212:215], v10
    v_smfmac_f32_16x16x32_bf16 v[160:163], v[252:253], v[212:215], v10 abid:2
    s_setpc_b64 s[76:77]
    v_smfmac_f32_16x16x32_bf16 v[128:131], v[252:253], v[212:215], v10
    v_smfmac_f32_16x16x32_bf16 v[164:167], v[252:253], v[212:215], v10 abid:2
    s_setpc_b64 s[76:77]
    v_smfmac_f32_16x16x32_bf16 v[132:135], v[252:253], v[212:215], v10
    v_smfmac_f32_16x16x32_bf16 v[168:171], v[252:253], v[212:215], v10 abid:2
    s_setpc_b64 s[76:77]
    v_smfmac_f32_16x16x32_bf16 v[136:139], v[252:253], v[212:215], v10
    v_smfmac_f32_16x16x32_bf16 v[172:175], v[252:253], v[212:215], v10 abid:2
    s_setpc_b64 s[76:77]
    v_smfmac_f32_16x16x32_bf16 v[140:143], v[252:253], v[212:215], v10
    v_smfmac_f32_16x16x32_bf16 v[176:179], v[252:253], v[212:215], v10 abid:2
    s_setpc_b64 s[76:77]
    v_smfmac_f32_16x16x32_bf16 v[144:147], v[252:253], v[212:215], v10
    v_smfmac_f32_16x16x32_bf16 v[180:183], v[252:253], v[212:215], v10 abid:2
    s_setpc_b64 s[76:77]
    v_smfmac_f32_16x16x32_bf16 v[148:151], v[252:253], v[212:215], v10
    v_smfmac_f32_16x16x32_bf16 v[184:187], v[252:253], v[212:215], v10 abid:2
    s_setpc_b64 s[76:77]
    v_smfmac_f32_16x16x32_bf16 v[152:155], v[252:253], v[212:215], v10
    v_smfmac_f32_16x16x32_bf16 v[188:191], v[252:253], v[212:215], v10 abid:2
    s_setpc_b64 s[76:77]
    v_smfmac_f32_16x16x32_bf16 v[156:159], v[252:253], v[212:215], v10
    v_smfmac_f32_16x16x32_bf16 v[192:195], v[252:253], v[212:215], v10 abid:2
    s_setpc_b64 s[76:77]
M_ovl1:
    v_smfmac_f32_16x16x32_bf16 v[124:127], v[252:253], v[212:215], v10
    v_smfmac_f32_16x16x32_bf16 v[160:163], v[252:253], v[212:215], v10 abid:2
    s_setpc_b64 s[78:79]
    v_smfmac_f32_16x16x32_bf16 v[128:131], v[252:253], v[212:215], v10
    v_smfmac_f32_16x16x32_bf16 v[164:167], v[252:253], v[212:215], v10 abid:2
    s_setpc_b64 s[78:79]
    v_smfmac_f32_16x16x32_bf16 v[132:135], v[252:253], v[212:215], v10
    v_smfmac_f32_16x16x32_bf16 v[168:171], v[252:253], v[212:215], v10 abid:2
    s_setpc_b64 s[78:79]
    v_smfmac_f32_16x16x32_bf16 v[136:139], v[252:253], v[212:215], v10
    v_smfmac_f32_16x16x32_bf16 v[172:175], v[252:253], v[212:215], v10 abid:2
    s_setpc_b64 s[78:79]
    v_smfmac_f32_16x16x32_bf16 v[140:143], v[252:253], v[212:215], v10
    v_smfmac_f32_16x16x32_bf16 v[176:179], v[252:253], v[212:215], v10 abid:2
    s_setpc_b64 s[78:79]
    v_smfmac_f32_16x16x32_bf16 v[144:147], v[252:253], v[212:215], v10
    v_smfmac_f32_16x16x32_bf16 v[180:183], v[252:253], v[212:215], v10 abid:2
    s_setpc_b64 s[78:79]
    v_smfmac_f32_16x16x32_bf16 v[148:151], v[252:253], v[212:215], v10
    v_smfmac_f32_16x16x32_bf16 v[184:187], v[252:253], v[212:215], v10 abid:2
    s_setpc_b64 s[78:79]
    v_smfmac_f32_16x16x32_bf16 v[152:155], v[252:253], v[212:215], v10
    v_smfmac_f32_16x16x32_bf16 v[188:191], v[252:253], v[212:215], v10 abid:2
    s_setpc_b64 s[78:79]
    v_smfmac_f32_16x16x32_bf16 v[156:159], v[252:253], v[212:215], v10
    v_smfmac_f32_16x16x32_bf16 v[192:195], v[252:253], v[212:215], v10 abid:2
    s_setpc_b64 s[78:79]
M_ovl2:
    v_smfmac_f32_16x16x32_bf16 v[124:127], v[254:255], v[212:215], v10
    v_smfmac_f32_16x16x32_bf16 v[160:163], v[254:255], v[212:215], v10 abid:2
    s_setpc_b64 s[78:79]
    v_smfmac_f32_16x16x32_bf16 v[128:131], v[254:255], v[212:215], v10
    v_smfmac_f32_16x16x32_bf16 v[164:167], v[254:255], v[212:215], v10 abid:2
    s_setpc_b64 s[78:79]
    v_smfmac_f32_16x16x32_bf16 v[132:135], v[254:255], v[212:215], v10
    v_smfmac_f32_16x16x32_bf16 v[168:171], v[254:255], v[212:215], v10 abid:2
    s_setpc_b64 s[78:79]
    v_smfmac_f32_16x16x32_bf16 v[136:139], v[254:255], v[212:215], v10
    v_smfmac_f32_16x16x32_bf16 v[172:175], v[254:255], v[212:215], v10 abid:2
    s_setpc_b64 s[78:79]
    v_smfmac_f32_16x16x32_bf16 v[140:143], v[254:255], v[212:215], v10
    v_smfmac_f32_16x16x32_bf16 v[176:179], v[254:255], v[212:215], v10 abid:2
    s_setpc_b64 s[78:79]
    v_smfmac_f32_16x16x32_bf16 v[144:147], v[254:255], v[212:215], v10
    v_smfmac_f32_16x16x32_bf16 v[180:183], v[254:255], v[212:215], v10 abid:2
    s_setpc_b64 s[78:79]
    v_smfmac_f32_16x16x32_bf16 v[148:151], v[254:255], v[212:215], v10
    v_smfmac_f32_16x16x32_bf16 v[184:187], v[254:255], v[212:215], v10 abid:2
    s_setpc_b64 s[78:79]
    v_smfmac_f32_16x16x32_bf16 v[152:155], v[254:255], v[212:215], v10
    v_smfmac_f32_16x16x32_bf16 v[188:191], v[254:255], v[212:215], v10 abid:2
    s_setpc_b64 s[78:79]
    v_smfmac_f32_16x16x32_bf16 v[156:159], v[254:255], v[212:215], v10
    v_smfmac_f32_16x16x32_bf16 v[192:195], v[254:255], v[212:215], v10 abid:2
    s_setpc_b64 s[78:79]
M_ovn:
    s_setpc_b64 s[78:79]
M_slow:
    s_bitcmp1_b32 s46, 31
    s_cbranch_scc1 M_dense
    s_mov_b32 s56, s80
M_sl:
    s_lshl_b32 s57, s56, 6
    v_add_u32 v240, s57, v9
    ds_read_b128 v[248:251], v240 offset:9792
    s_waitcnt lgkmcnt(0)
    v_and_b32 v240, 0x3fff, v248
    v_and_b32 v241, 0x3fff, v250
    v_xad_u32 v240, v240, v3, v4
    v_xad_u32 v241, v241, v3, v4
    ds_read2st64_b32 v[244:245], v240 offset0:0 offset1:72
    ds_read2st64_b32 v[246:247], v241 offset0:0 offset1:72
    v_subrev_u32 v240, s29, v8
    v_bfe_u32 v240, v240, 4, 4
    s_waitcnt lgkmcnt(0)
    s_bitcmp1_b32 s27, 0
    s_cbranch_scc0 M_sle0
    v_lshrrev_b32 v242, 18, v248
    v_lshrrev_b32 v243, 18, v250
    v_or_b32 v241, 0, v240
    v_cmp_eq_u32 s[44:45], v242, v241
    v_cmp_eq_u32 s[54:55], v243, v241
    s_nop 0
    v_cndmask_b32 v242, 0, v249, s[44:45]
    v_cndmask_b32 v243, 0, v251, s[54:55]
    s_nop 1
    v_smfmac_f32_16x16x32_bf16 v[124:127], v[242:243], v[244:247], v10
    v_smfmac_f32_16x16x32_bf16 v[160:163], v[242:243], v[244:247], v10 abid:2
M_sle0:
    s_bitcmp1_b32 s27, 1
    s_cbranch_scc0 M_sle1
    v_lshrrev_b32 v242, 18, v248
    v_lshrrev_b32 v243, 18, v250
    v_or_b32 v241, 64, v240
    v_cmp_eq_u32 s[44:45], v242, v241
    v_cmp_eq_u32 s[54:55], v243, v241
    s_nop 0
    v_cndmask_b32 v242, 0, v249, s[44:45]
    v_cndmask_b32 v243, 0, v251, s[54:55]
    s_nop 1
    v_smfmac_f32_16x16x32_bf16 v[128:131], v[242:243], v[244:247], v10
    v_smfmac_f32_16x16x32_bf16 v[164:167], v[242:243], v[244:247], v10 abid:2
M_sle1:
    s_bitcmp1_b32 s27, 2
    s_cbranch_scc0 M_sle2
    v_lshrrev_b32 v242, 18, v248
    v_lshrrev_b32 v243, 18, v250
    v_or_b32 v241, 128, v240
    v_cmp_eq_u32 s[44:45], v242, v241
    v_cmp_eq_u32 s[54:55], v243, v241
    s_nop 0
    v_cndmask_b32 v242, 0, v249, s[44:45]
    v_cndmask_b32 v243, 0, v251, s[54:55]
    s_nop 1
    v_smfmac_f32_16x16x32_bf16 v[132:135], v[242:243], v[244:247], v10
    v_smfmac_f32_16x16x32_bf16 v[168:171], v[242:243], v[244:247], v10 abid:2
M_sle2:
    s_bitcmp1_b32 s27, 3
    s_cbranch_scc0 M_sle3
    v_lshrrev_b32 v242, 18, v248
    v_lshrrev_b32 v243, 18, v250
    v_or_b32 v241, 192, v240
    v_cmp_eq_u32 s[44:45], v242, v241
    v_cmp_eq_u32 s[54:55], v243, v241
    s_nop 0
    v_cndmask_b32 v242, 0, v249, s[44:45]
    v_cndmask_b32 v243, 0, v251, s[54:55]
    s_nop 1
    v_smfmac_f32_16x16x32_bf16 v[136:139], v[242:243], v[244:247], v10
    v_smfmac_f32_16x16x32_bf16 v[172:175], v[242:243], v[244:247], v10 abid:2
M_sle3:
    s_bitcmp1_b32 s27, 4
    s_cbranch_scc0 M_sle4
    v_lshrrev_b32 v242, 18, v248
    v_lshrrev_b32 v243, 18, v250
    v_or_b32 v241, 256, v240
    v_cmp_eq_u32 s[44:45], v242, v241
    v_cmp_eq_u32 s[54:55], v243, v241
    s_nop 0
    v_cndmask_b32 v242, 0, v249, s[44:45]
    v_cndmask_b32 v243, 0, v251, s[54:55]
    s_nop 1
    v_smfmac_f32_16x16x32_bf16 v[140:143], v[242:243], v[244:247], v10
    v_smfmac_f32_16x16x32_bf16 v[176:179], v[242:243], v[244:247], v10 abid:2
M_sle4:
    s_bitcmp1_b32 s27, 5
    s_cbranch_scc0 M_sle5
    v_lshrrev_b32 v242, 18, v248
    v_lshrrev_b32 v243, 18, v250
    v_or_b32 v241, 320, v240
    v_cmp_eq_u32 s[44:45], v242, v241
    v_cmp_eq_u32 s[54:55], v243, v241
    s_nop 0
    v_cndmask_b32 v242, 0, v249, s[44:45]
    v_cndmask_b32 v243, 0, v251, s[54:55]
    s_nop 1
    v_smfmac_f32_16x16x32_bf16 v[144:147], v[242:243], v[244:247], v10
    v_smfmac_f32_16x16x32_bf16 v[180:183], v[242:243], v[244:247], v10 abid:2
M_sle5:
    s_bitcmp1_b32 s27, 6
    s_cbranch_scc0 M_sle6
    v_lshrrev_b32 v242, 18, v248
    v_lshrrev_b32 v243, 18, v250
    v_or_b32 v241, 384, v240
    v_cmp_eq_u32 s[44:45], v242, v241
    v_cmp_eq_u32 s[54:55], v243, v241
    s_nop 0
    v_cndmask_b32 v242, 0, v249, s[44:45]
    v_cndmask_b32 v243, 0, v251, s[54:55]
    s_nop 1
    v_smfmac_f32_16x16x32_bf16 v[148:151], v[242:243], v[244:247], v10
    v_smfmac_f32_16x16x32_bf16 v[184:187], v[242:243], v[244:247], v10 abid:2
M_sle6:
    s_bitcmp1_b32 s27, 7
    s_cbranch_scc0 M_sle7
    v_lshrrev_b32 v242, 18, v248
    v_lshrrev_b32 v243, 18, v250
    v_or_b32 v241, 448, v240
    v_cmp_eq_u32 s[44:45], v242, v241
    v_cmp_eq_u32 s[54:55], v243, v241
    s_nop 0
    v_cndmask_b32 v242, 0, v249, s[44:45]
    v_cndmask_b32 v243, 0, v251, s[54:55]
    s_nop 1
    v_smfmac_f32_16x16x32_bf16 v[152:155], v[242:243], v[244:247], v10
    v_smfmac_f32_16x16x32_bf16 v[188:191], v[242:243], v[244:247], v10 abid:2
M_sle7:
    s_bitcmp1_b32 s27, 8
    s_cbranch_scc0 M_sle8
    v_lshrrev_b32 v242, 18, v248
    v_lshrrev_b32 v243, 18, v250
    v_or_b32 v241, 512, v240
    v_cmp_eq_u32 s[44:45], v242, v241
    v_cmp_eq_u32 s[54:55], v243, v241
    s_nop 0
    v_cndmask_b32 v242, 0, v249, s[44:45]
    v_cndmask_b32 v243, 0, v251, s[54:55]
    s_nop 1
    v_smfmac_f32_16x16x32_bf16 v[156:159], v[242:243], v[244:247], v10
    v_smfmac_f32_16x16x32_bf16 v[192:195], v[242:243], v[244:247], v10 abid:2
M_sle8:
    s_add_u32 s56, s56, 1
    s_cmp_lt_u32 s56, s46
    s_cbranch_scc1 M_sl
M_slx:
    s_nop 7
    s_cmp_eq_u32 s21, 1
    s_cbranch_scc1 M_slowrL
    s_cmp_eq_u32 s21, 2
    s_cbranch_scc1 M_slowrE0
    s_cmp_eq_u32 s21, 3
    s_cbranch_scc1 M_slowrF
    s_branch M_slowr0
M_dense:
    s_mul_i32 s57, s20, 82944
    s_add_u32 s57, s57, 393216
    s_mov_b32 s56, 0
    v_mov_b32 v54, v1
    v_mov_b32 v55, v2
    v_subrev_u32 v252, s29, v8
M_dn0:
    ds_read_b128 v[244:247], v54 offset:0
    ds_read_b128 v[248:251], v55 offset:0
    v_add_u32 v54, 1024, v54
    v_add_u32 v55, 1024, v55
    buffer_load_dwordx4 v[240:243], v252, s[16:19], s57 offen sc1
    s_add_u32 s57, s57, 1024
    s_waitcnt vmcnt(0) lgkmcnt(0)
    v_smfmac_f32_16x16x64_bf16 v[124:127], v[240:243], v[244:251], v10
    buffer_load_dwordx4 v[240:243], v252, s[16:19], s57 offen sc1
    s_add_u32 s57, s57, 1024
    s_waitcnt vmcnt(0) lgkmcnt(0)
    v_smfmac_f32_16x16x64_bf16 v[128:131], v[240:243], v[244:251], v10
    buffer_load_dwordx4 v[240:243], v252, s[16:19], s57 offen sc1
    s_add_u32 s57, s57, 1024
    s_waitcnt vmcnt(0) lgkmcnt(0)
    v_smfmac_f32_16x16x64_bf16 v[132:135], v[240:243], v[244:251], v10
    buffer_load_dwordx4 v[240:243], v252, s[16:19], s57 offen sc1
    s_add_u32 s57, s57, 1024
    s_waitcnt vmcnt(0) lgkmcnt(0)
    v_smfmac_f32_16x16x64_bf16 v[136:139], v[240:243], v[244:251], v10
    buffer_load_dwordx4 v[240:243], v252, s[16:19], s57 offen sc1
    s_add_u32 s57, s57, 1024
    s_waitcnt vmcnt(0) lgkmcnt(0)
    v_smfmac_f32_16x16x64_bf16 v[140:143], v[240:243], v[244:251], v10
    buffer_load_dwordx4 v[240:243], v252, s[16:19], s57 offen sc1
    s_add_u32 s57, s57, 1024
    s_waitcnt vmcnt(0) lgkmcnt(0)
    v_smfmac_f32_16x16x64_bf16 v[144:147], v[240:243], v[244:251], v10
    buffer_load_dwordx4 v[240:243], v252, s[16:19], s57 offen sc1
    s_add_u32 s57, s57, 1024
    s_waitcnt vmcnt(0) lgkmcnt(0)
    v_smfmac_f32_16x16x64_bf16 v[148:151], v[240:243], v[244:251], v10
    buffer_load_dwordx4 v[240:243], v252, s[16:19], s57 offen sc1
    s_add_u32 s57, s57, 1024
    s_waitcnt vmcnt(0) lgkmcnt(0)
    v_smfmac_f32_16x16x64_bf16 v[152:155], v[240:243], v[244:251], v10
    buffer_load_dwordx4 v[240:243], v252, s[16:19], s57 offen sc1
    s_add_u32 s57, s57, 1024
    s_waitcnt vmcnt(0) lgkmcnt(0)
    v_smfmac_f32_16x16x64_bf16 v[156:159], v[240:243], v[244:251], v10
    s_add_u32 s56, s56, 1
    s_cmp_lt_u32 s56, 9
    s_cbranch_scc1 M_dn0
    s_mul_i32 s57, s20, 82944
    s_add_u32 s57, s57, 393216
    s_mov_b32 s56, 0
    v_mov_b32 v54, v1
    v_mov_b32 v55, v2
    v_subrev_u32 v252, s29, v8
M_dn1:
    ds_read_b128 v[244:247], v54 offset:18432
    ds_read_b128 v[248:251], v55 offset:18432
    v_add_u32 v54, 1024, v54
    v_add_u32 v55, 1024, v55
    buffer_load_dwordx4 v[240:243], v252, s[16:19], s57 offen sc1
    s_add_u32 s57, s57, 1024
    s_waitcnt vmcnt(0) lgkmcnt(0)
    v_smfmac_f32_16x16x64_bf16 v[160:163], v[240:243], v[244:251], v10
    buffer_load_dwordx4 v[240:243], v252, s[16:19], s57 offen sc1
    s_add_u32 s57, s57, 1024
    s_waitcnt vmcnt(0) lgkmcnt(0)
    v_smfmac_f32_16x16x64_bf16 v[164:167], v[240:243], v[244:251], v10
    buffer_load_dwordx4 v[240:243], v252, s[16:19], s57 offen sc1
    s_add_u32 s57, s57, 1024
    s_waitcnt vmcnt(0) lgkmcnt(0)
    v_smfmac_f32_16x16x64_bf16 v[168:171], v[240:243], v[244:251], v10
    buffer_load_dwordx4 v[240:243], v252, s[16:19], s57 offen sc1
    s_add_u32 s57, s57, 1024
    s_waitcnt vmcnt(0) lgkmcnt(0)
    v_smfmac_f32_16x16x64_bf16 v[172:175], v[240:243], v[244:251], v10
    buffer_load_dwordx4 v[240:243], v252, s[16:19], s57 offen sc1
    s_add_u32 s57, s57, 1024
    s_waitcnt vmcnt(0) lgkmcnt(0)
    v_smfmac_f32_16x16x64_bf16 v[176:179], v[240:243], v[244:251], v10
    buffer_load_dwordx4 v[240:243], v252, s[16:19], s57 offen sc1
    s_add_u32 s57, s57, 1024
    s_waitcnt vmcnt(0) lgkmcnt(0)
    v_smfmac_f32_16x16x64_bf16 v[180:183], v[240:243], v[244:251], v10
    buffer_load_dwordx4 v[240:243], v252, s[16:19], s57 offen sc1
    s_add_u32 s57, s57, 1024
    s_waitcnt vmcnt(0) lgkmcnt(0)
    v_smfmac_f32_16x16x64_bf16 v[184:187], v[240:243], v[244:251], v10
    buffer_load_dwordx4 v[240:243], v252, s[16:19], s57 offen sc1
    s_add_u32 s57, s57, 1024
    s_waitcnt vmcnt(0) lgkmcnt(0)
    v_smfmac_f32_16x16x64_bf16 v[188:191], v[240:243], v[244:251], v10
    buffer_load_dwordx4 v[240:243], v252, s[16:19], s57 offen sc1
    s_add_u32 s57, s57, 1024
    s_waitcnt vmcnt(0) lgkmcnt(0)
    v_smfmac_f32_16x16x64_bf16 v[192:195], v[240:243], v[244:251], v10
    s_add_u32 s56, s56, 1
    s_cmp_lt_u32 s56, 9
    s_cbranch_scc1 M_dn1
    s_branch M_slx
M_codeend:
.section .rodata,"a"
.p2align 6
.amdhsa_kernel standalone__structured_sparse_n_m__ragged_kernel
  .amdhsa_next_free_vgpr 512
  .amdhsa_next_free_sgpr 102
  .amdhsa_accum_offset 256
  .amdhsa_group_segment_fixed_size 0
  .amdhsa_kernarg_size 48
  .amdhsa_user_sgpr_count 2
  .amdhsa_user_sgpr_kernarg_segment_ptr 1
  .amdhsa_system_sgpr_workgroup_id_x 1
  .amdhsa_float_denorm_mode_32 3
.end_amdhsa_kernel
```

```asm
; @launch grid=(256,1,1) block=(256,1,1) lds=162064
.amdgcn_target "amdgcn-amd-amdhsa--gfx950"
.text
.globl standalone__structured_sparse_n_m__ragged_kernel
.p2align 8
.type standalone__structured_sparse_n_m__ragged_kernel,@function
standalone__structured_sparse_n_m__ragged_kernel:
    s_cmp_ge_u32 s2, 256
    s_cbranch_scc1 M_end
    s_load_dwordx8 s[72:79], s[0:1], 0
    s_load_dwordx4 s[80:83], s[0:1], 32
    s_getpc_b64 s[84:85]
    s_lshr_b32 s30, s2, 3
    s_and_b32 s30, s30, 15
    s_lshl_b32 s30, s30, 11
    s_and_b32 s84, s84, 0xffffff00
    s_cmp_ge_u32 s2, 88
    s_cselect_b32 s86, M_codeend-standalone__structured_sparse_n_m__ragged_kernel, 0
    s_mov_b32 s87, 0x20000
    v_lshlrev_b32 v254, 3, v0
    s_mov_b32 exec_lo, 0x00010001
    s_mov_b32 exec_hi, 0x00010001
    buffer_load_dword v254, v254, s[84:87], s30 offen
    s_mov_b64 exec, -1
    v_lshrrev_b32 v20, 6, v0
    v_and_b32 v12, 63, v0
    v_readfirstlane_b32 s20, v20
    v_lshrrev_b32 v22, 3, v0
    v_mul_u32_u24 v22, 1152, v22
    v_lshrrev_b32 v23, 4, v0
    v_xor_b32 v23, v23, v0
    v_and_b32 v23, 7, v23
    v_lshl_add_u32 v5, v23, 4, v22
    v_lshrrev_b32 v13, 4, v12
    v_and_b32 v14, 15, v12
    v_lshlrev_b32 v11, 4, v12
    v_lshlrev_b32 v54, 3, v12
    v_lshlrev_b32 v25, 4, v13
    v_lshlrev_b32 v26, 3, v13
    s_mov_b32 s6, 663552
    s_mov_b32 s7, 0x20000
    s_mov_b32 s10, 75497472
    s_mov_b32 s11, s7
    s_mov_b32 s18, 742400
    s_mov_b32 s19, s7
    s_movk_i32 s70, 256
    s_mov_b32 s71, s7
    s_movk_i32 s86, 1152
    s_mov_b32 s87, s7
    s_mov_b32 s98, 0
    s_mul_i32 s96, s20, 16
    s_and_b32 s97, s2, 15
    s_add_u32 s96, s96, s97
    s_lshl_b32 s96, s96, 8
    s_add_u32 s96, s96, 726016
    s_mul_i32 s22, s2, 36864
    s_mul_i32 s26, s20, 9216
    s_mov_b32 s24, s22
    s_mov_b32 s42, s26
    s_lshl_b32 s28, s20, 8
    s_lshl_b32 s29, s20, 5
    s_cmp_lt_u32 s2, 81
    s_cbranch_scc0 M_x1
    s_mul_i32 s32, s2, 57
    s_lshr_b32 s32, s32, 9
    s_mul_i32 s33, s32, 9
    s_sub_u32 s33, s2, s33
    s_mul_i32 s54, s32, 73728
    s_lshl_b32 s35, s33, 7
    s_add_u32 s54, s54, s35
    s_add_u32 s55, s54, 36864
    s_lshl_b32 s36, s20, 10
    s_add_u32 m0, s36, 73728
    s_lshr_b32 s30, s33, 1
    s_and_b32 s31, s33, 1
    s_lshl1_add_u32 s37, s32, s31
    s_mul_i32 s37, s37, 176
    s_mul_i32 s38, s32, 96
    s_add_u32 s38, s38, 3168
    s_cmp_lt_u32 s33, 8
    s_cselect_b32 s30, s30, s20
    s_cselect_b32 s37, s37, s38
    s_cselect_b32 s44, 2047, 63
    s_cselect_b32 s45, s20, 3
    s_cmp_eq_u32 s45, 3
    s_cselect_b32 s99, 742400, 0
    s_mul_i32 s48, s30, 98304
    s_add_u32 s37, s37, s48
    v_mov_b32 v44, 2.0
    v_mov_b32 v45, 0
    v_mov_b32 v46, 2.0
    v_mov_b32 v47, 0
    s_waitcnt lgkmcnt(0)
    s_mov_b64 s[4:5], s[74:75]
    buffer_load_dwordx4 v5, s[4:7], s54 offen lds
    s_add_u32 m0, m0, 4096
    s_mov_b32 s45, 0
    buffer_load_dwordx4 v5, s[4:7], s55 offen lds
    s_mov_b64 s[16:17], s[82:83]
    s_mov_b64 s[8:9], s[72:73]
    s_mov_b64 s[84:85], s[76:77]
    s_mov_b64 s[68:69], s[80:81]
    v_mov_b32 v10, 0
    s_mov_b64 exec, 1
    buffer_atomic_add v10, off, s[16:19], s96 sc0 sc1
    s_mov_b64 exec, -1
    s_mov_b64 exec, s[44:45]
    s_mov_b32 s18, s99
    buffer_store_dwordx4 v[44:47], v11, s[16:19], s37 offen sc1
    s_mov_b32 s18, 742400
    s_mov_b64 exec, -1
    buffer_load_dwordx4 v[196:199], v25, s[84:87], s28 offen offset:0
    buffer_load_dwordx4 v[200:203], v25, s[84:87], s28 offen offset:64
    buffer_load_dwordx4 v[204:207], v25, s[84:87], s28 offen offset:128
    buffer_load_dwordx4 v[208:211], v25, s[84:87], s28 offen offset:192
    buffer_load_dwordx2 v[212:213], v26, s[84:87], s29 offen offset:1024
    s_mov_b32 m0, s42
    s_nop 0
    buffer_load_dwordx4 v5, s[8:11], s22 offen offset:0 nt lds
    s_add_u32 m0, m0, 896
    s_nop 0
    buffer_load_dwordx4 v5, s[8:11], s22 offen offset:128 nt lds
    s_lshl_b32 s34, s31, 2
    s_add_u32 s34, s34, s20
    s_lshr_b32 s35, s20, 1
    s_lshl_b32 s35, s35, 6
    s_and_b32 s36, s20, 1
    s_lshl_b32 s36, s36, 3
    s_add_u32 s35, s35, s36
    s_lshl_b32 s36, s20, 5
    s_mul_i32 s39, s32, 10240
    s_add_u32 s39, s39, 6144
    s_lshl_b32 s40, s34, 1
    s_add_u32 s40, s40, s39
    s_lshl_b32 s38, s32, 1
    s_cmp_eq_u32 s32, 8
    s_cselect_b32 s38, 1024, s38
    s_add_u32 s38, s38, 4096
    s_cmp_lt_u32 s33, 8
    s_cselect_b32 s34, s34, 8
    s_cselect_b32 s35, s35, s36
    s_cselect_b32 s36, 4, 3
    s_cselect_b32 s40, s40, s38
    s_cselect_b32 s46, 0, s20
    s_cselect_b32 s47, 22, 12
    s_add_u32 s40, s40, s48
    s_lshl_b32 s38, s34, 10
    s_add_u32 s39, s39, s38
    s_add_u32 s39, s39, s48
    s_add_u32 s39, s39, 1024
    v_and_b32 v15, 3, v14
    v_lshlrev_b32 v15, s36, v15
    v_add_u32 v15, s35, v15
    v_lshrrev_b32 v16, 3, v14
    v_lshlrev_b32 v16, 4, v16
    v_xor_b32 v15, v15, v16
    v_lshrrev_b32 v16, 2, v14
    v_lshl_add_u32 v16, v13, 4, v16
    v_lshl_add_u32 v15, v16, 7, v15
    v_add_u32 v24, 73728, v15
    v_xor_b32 v27, 32, v24
    v_xor_b32 v28, 64, v24
    v_xor_b32 v29, 0x60, v24
    s_lshl_b32 s31, s46, 2
    s_add_u32 s31, s31, 81920
    v_mov_b32 v60, s31
    v_mov_b32 v61, 1
    ds_write_b32 v60, v61
    s_mul_i32 s49, s30, 81
    s_mul_i32 s31, s32, 9
    s_add_u32 s49, s49, s31
    s_add_u32 s49, s49, s34
    s_lshl_b32 s49, s49, 10
    s_add_u32 s49, s49, 393216
    s_lshl_b32 s31, s34, 24
    s_lshl_b32 s38, s32, 10
    s_add_u32 s31, s31, s38
    v_lshlrev_b32 v31, 18, v14
    v_lshl_add_u32 v31, v13, 5, v31
    v_add_u32 v31, s31, v31
    s_mov_b32 s50, 3437096686
    s_mov_b32 s51, 1150609561
    s_mov_b32 s52, 0x00010001
    s_mov_b32 s53, 0x00200010
    s_mov_b32 s38, 0x0202
    s_mul_i32 s57, s30, 4096
    s_add_u32 s57, s57, 726016
    s_cmp_eq_u32 s33, 8
    s_cselect_b32 s56, 0, s20
    s_cmp_eq_u32 s20, 0
    s_cselect_b32 s98, 1, 0
    v_add_u32 v74, 81984, v54
    v_lshl_add_u32 v73, s20, 1, v74
    v_mov_b32 v41, 0x01000100
    v_mov_b32 v40, 0
    v_mov_b32 v63, -2.0
    s_waitcnt vmcnt(9) lgkmcnt(0)
    s_barrier
    ds_read_b64_tr_b16 v[16:17], v24
    ds_read_b64_tr_b16 v[18:19], v27 offset:512
    ds_read_b64_tr_b16 v[20:21], v28 offset:1024
    ds_read_b64_tr_b16 v[22:23], v29 offset:1536
    s_waitcnt lgkmcnt(3)
    v_and_b32 v44, 0x7fff7fff, v16
    v_and_b32 v45, 0x7fff7fff, v17
    v_pk_max_u16 v46, v44, v45
    v_pk_min_u16 v47, v44, v45
    v_pk_min_u16 v46, v46, v46 op_sel:[0,1] op_sel_hi:[1,0]
    v_pk_max_u16 v47, v47, v47 op_sel:[0,1] op_sel_hi:[1,0]
    v_pk_max_u16 v46, v46, s52
    v_pk_max_u16 v46, v46, v47
    v_pk_sub_i16 v44, v44, v46
    v_pk_sub_i16 v45, v45, v46
    v_pk_ashrrev_i16 v44, 15, v44 op_sel_hi:[0,1]
    v_pk_ashrrev_i16 v45, 15, v45 op_sel_hi:[0,1]
    v_alignbit_b32 v47, -1, v44, 16
    v_alignbit_b32 v46, v45, v45, 16
    v_and_b32 v48, 0x00080004, v44
    v_bitop3_b32 v46, v45, v46, v47 bitop3:0xe8
    v_and_or_b32 v64, v45, s53, v48
    v_bitop3_b32 v36, v16, v44, v46 bitop3:0x10
    v_min_u32 v68, 1, v36
    s_waitcnt lgkmcnt(2)
    v_and_b32 v44, 0x7fff7fff, v18
    v_and_b32 v45, 0x7fff7fff, v19
    v_pk_max_u16 v46, v44, v45
    v_pk_min_u16 v47, v44, v45
    v_pk_min_u16 v46, v46, v46 op_sel:[0,1] op_sel_hi:[1,0]
    v_pk_max_u16 v47, v47, v47 op_sel:[0,1] op_sel_hi:[1,0]
    v_pk_max_u16 v46, v46, s52
    v_pk_max_u16 v46, v46, v47
    v_pk_sub_i16 v44, v44, v46
    v_pk_sub_i16 v45, v45, v46
    v_pk_ashrrev_i16 v44, 15, v44 op_sel_hi:[0,1]
    v_pk_ashrrev_i16 v45, 15, v45 op_sel_hi:[0,1]
    v_alignbit_b32 v47, -1, v44, 16
    v_alignbit_b32 v46, v45, v45, 16
    v_and_b32 v48, 0x00080004, v44
    v_bitop3_b32 v46, v45, v46, v47 bitop3:0xe8
    v_and_or_b32 v65, v45, s53, v48
    v_bitop3_b32 v37, v18, v44, v46 bitop3:0x10
    v_min_u32 v69, 1, v37
    s_waitcnt lgkmcnt(1)
    v_and_b32 v44, 0x7fff7fff, v20
    v_and_b32 v45, 0x7fff7fff, v21
    v_pk_max_u16 v46, v44, v45
    v_pk_min_u16 v47, v44, v45
    v_pk_min_u16 v46, v46, v46 op_sel:[0,1] op_sel_hi:[1,0]
    v_pk_max_u16 v47, v47, v47 op_sel:[0,1] op_sel_hi:[1,0]
    v_pk_max_u16 v46, v46, s52
    v_pk_max_u16 v46, v46, v47
    v_pk_sub_i16 v44, v44, v46
    v_pk_sub_i16 v45, v45, v46
    v_pk_ashrrev_i16 v44, 15, v44 op_sel_hi:[0,1]
    v_pk_ashrrev_i16 v45, 15, v45 op_sel_hi:[0,1]
    v_alignbit_b32 v47, -1, v44, 16
    v_alignbit_b32 v46, v45, v45, 16
    v_and_b32 v48, 0x00080004, v44
    v_bitop3_b32 v46, v45, v46, v47 bitop3:0xe8
    v_and_or_b32 v66, v45, s53, v48
    v_bitop3_b32 v38, v20, v44, v46 bitop3:0x10
    v_min_u32 v70, 1, v38
    s_waitcnt lgkmcnt(0)
    v_and_b32 v44, 0x7fff7fff, v22
    v_and_b32 v45, 0x7fff7fff, v23
    v_pk_max_u16 v46, v44, v45
    v_pk_min_u16 v47, v44, v45
    v_pk_min_u16 v46, v46, v46 op_sel:[0,1] op_sel_hi:[1,0]
    v_pk_max_u16 v47, v47, v47 op_sel:[0,1] op_sel_hi:[1,0]
    v_pk_max_u16 v46, v46, s52
    v_pk_max_u16 v46, v46, v47
    v_pk_sub_i16 v44, v44, v46
    v_pk_sub_i16 v45, v45, v46
    v_pk_ashrrev_i16 v44, 15, v44 op_sel_hi:[0,1]
    v_pk_ashrrev_i16 v45, 15, v45 op_sel_hi:[0,1]
    v_alignbit_b32 v47, -1, v44, 16
    v_alignbit_b32 v46, v45, v45, 16
    v_and_b32 v48, 0x00080004, v44
    v_bitop3_b32 v46, v45, v46, v47 bitop3:0xe8
    v_and_or_b32 v67, v45, s53, v48
    v_bitop3_b32 v39, v22, v44, v46 bitop3:0x10
    v_min_u32 v71, 1, v39
    v_add_u32 v72, v68, v69
    v_add3_u32 v72, v72, v70, v71
    buffer_store_dwordx4 v[36:39], v11, s[16:19], s49 offen sc1
    v_cmp_ne_u32 vcc, 0, v72
    s_and_saveexec_b64 s[44:45], vcc
    ds_add_rtn_u32 v62, v60, v72
    s_mov_b64 exec, -1
    v_lshrrev_b32 v48, 16, v64
    v_or_b32 v48, v48, v64
    v_lshrrev_b64 v[52:53], v48, s[50:51]
    v_and_b32 v64, 15, v52
    v_lshl_or_b32 v40, v64, 0, v40
    v_lshrrev_b32 v48, 16, v65
    v_or_b32 v48, v48, v65
    v_lshrrev_b64 v[52:53], v48, s[50:51]
    v_and_b32 v65, 15, v52
    v_lshl_or_b32 v40, v65, 4, v40
    v_lshrrev_b32 v48, 16, v66
    v_or_b32 v48, v48, v66
    v_lshrrev_b64 v[52:53], v48, s[50:51]
    v_and_b32 v66, 15, v52
    v_lshl_or_b32 v40, v66, 8, v40
    v_lshrrev_b32 v48, 16, v67
    v_or_b32 v48, v48, v67
    v_lshrrev_b64 v[52:53], v48, s[50:51]
    v_and_b32 v67, 15, v52
    v_lshl_or_b32 v40, v67, 12, v40
    v_lshrrev_b32 v44, 2, v40
    v_lshlrev_b32 v45, 2, v40
    s_movk_i32 s31, 0x3333
    v_not_b32 v47, v40
    v_bfi_b32 v44, s31, v44, v45
    s_movk_i32 s31, 0x1111
    s_nop 0
    v_mov_b32_dpp v47, v44 row_shr:4 row_mask:0xf bank_mask:0xf
    v_xor_b32 v47, v47, v40
    v_lshrrev_b32 v45, 1, v47
    v_or_b32 v47, v47, v45
    v_lshrrev_b32 v45, 2, v47
    v_bitop3_b32 v47, v47, v45, s31 bitop3:0x2a
    s_nop 1
    v_xor_b32_dpp v47, v47, v47 row_shr:4 row_mask:0xf bank_mask:0xe
    s_nop 1
    v_xor_b32_dpp v47, v47, v47 row_shr:8 row_mask:0xf bank_mask:0xc
    v_mul_u32_u24 v47, 15, v47
    v_bfi_b32 v40, v47, v44, v40
    ds_write_b16 v73, v40
    v_bfe_u32 v64, v40, 0, 4
    v_mul_u32_u24 v46, 0x4001, v64
    v_and_b32 v46, 0x30003, v46
    v_mad_u32_u24 v46, v46, s38, v41
    v_perm_b32 v32, v17, v16, v46
    v_bfe_u32 v65, v40, 4, 4
    v_mul_u32_u24 v46, 0x4001, v65
    v_and_b32 v46, 0x30003, v46
    v_mad_u32_u24 v46, v46, s38, v41
    v_perm_b32 v33, v19, v18, v46
    s_waitcnt vmcnt(8) lgkmcnt(0)
    s_barrier
    ds_read_b64 v[50:51], v74
    v_bfe_u32 v66, v40, 8, 4
    v_mul_u32_u24 v46, 0x4001, v66
    v_and_b32 v46, 0x30003, v46
    v_mad_u32_u24 v46, v46, s38, v41
    v_perm_b32 v34, v21, v20, v46
    v_bfe_u32 v67, v40, 12, 4
    v_mul_u32_u24 v46, 0x4001, v67
    v_and_b32 v46, 0x30003, v46
    v_mad_u32_u24 v46, v46, s38, v41
    v_perm_b32 v35, v23, v22, v46
    buffer_store_dwordx4 v[32:35], v11, s[16:19], s39 offen sc1
    s_cmp_eq_u32 s33, 8
    s_cbranch_scc0 F_i1
    buffer_store_short v40, v11, s[16:19], s40 offen sc1
    s_branch F_i2
F_i1:
    s_cmp_eq_u32 s20, 0
    s_cbranch_scc0 F_i2
    s_waitcnt lgkmcnt(0)
    buffer_store_dwordx2 v[50:51], v11, s[16:19], s40 offen sc1
F_i2:
    s_cbranch_vccz F_z
    v_cmp_ne_u32 vcc, 0, v36
    s_and_saveexec_b64 s[44:45], vcc
    s_cbranch_execz F_e0
    v_cmp_gt_u32 vcc, s47, v62
    v_add_u32 v42, 0, v31
    v_lshlrev_b32 v44, 3, v62
    v_add_u32 v62, 1, v62
    v_cndmask_b32 v42, v63, v42, vcc
    v_cndmask_b32 v43, 0, v36, vcc
    v_cndmask_b32 v44, 0, v44, vcc
    buffer_store_dwordx2 v[42:43], v44, s[16:19], s37 offen sc1
F_e0:
    s_mov_b64 exec, -1
    v_cmp_ne_u32 vcc, 0, v37
    s_and_saveexec_b64 s[44:45], vcc
    s_cbranch_execz F_e1
    v_cmp_gt_u32 vcc, s47, v62
    v_add_u32 v42, 8, v31
    v_lshlrev_b32 v44, 3, v62
    v_add_u32 v62, 1, v62
    v_cndmask_b32 v42, v63, v42, vcc
    v_cndmask_b32 v43, 0, v37, vcc
    v_cndmask_b32 v44, 0, v44, vcc
    buffer_store_dwordx2 v[42:43], v44, s[16:19], s37 offen sc1
F_e1:
    s_mov_b64 exec, -1
    v_cmp_ne_u32 vcc, 0, v38
    s_and_saveexec_b64 s[44:45], vcc
    s_cbranch_execz F_e2
    v_cmp_gt_u32 vcc, s47, v62
    v_add_u32 v42, 16, v31
    v_lshlrev_b32 v44, 3, v62
    v_add_u32 v62, 1, v62
    v_cndmask_b32 v42, v63, v42, vcc
    v_cndmask_b32 v43, 0, v38, vcc
    v_cndmask_b32 v44, 0, v44, vcc
    buffer_store_dwordx2 v[42:43], v44, s[16:19], s37 offen sc1
F_e2:
    s_mov_b64 exec, -1
    v_cmp_ne_u32 vcc, 0, v39
    s_and_saveexec_b64 s[44:45], vcc
    s_cbranch_execz F_e3
    v_cmp_gt_u32 vcc, s47, v62
    v_add_u32 v42, 24, v31
    v_lshlrev_b32 v44, 3, v62
    v_add_u32 v62, 1, v62
    v_cndmask_b32 v42, v63, v42, vcc
    v_cndmask_b32 v43, 0, v39, vcc
    v_cndmask_b32 v44, 0, v44, vcc
    buffer_store_dwordx2 v[42:43], v44, s[16:19], s37 offen sc1
F_e3:
    s_mov_b64 exec, -1
F_z:
    s_cmp_lg_u32 s2, 0
    s_cbranch_scc1 M_set
    v_mov_b32 v64, 0
    v_mov_b32 v65, 0
    v_mov_b32 v66, 0
    v_mov_b32 v67, 0
    s_mov_b32 s40, 724992
    buffer_store_dwordx4 v[64:67], v11, s[16:19], s40 offen sc1
    s_branch M_set
F_sig:
    v_lshlrev_b32 v30, 8, v12
    s_waitcnt vmcnt(0)
    s_barrier
    s_cmp_lg_u32 s56, 0
    s_cbranch_scc1 F_end
    s_mov_b64 exec, 65535
    buffer_atomic_add v61, v30, s[16:19], s57 offen sc1
    s_mov_b64 exec, -1
F_end:
    s_add_u32 m0, m0, 896
    s_nop 0
    buffer_load_dwordx4 v5, s[8:11], s22 offen offset:256 nt lds
    s_branch M_x2
M_x1:
    s_waitcnt lgkmcnt(0)
    s_mov_b64 s[4:5], s[74:75]
    s_mov_b64 s[16:17], s[82:83]
    s_mov_b64 s[8:9], s[72:73]
    s_mov_b64 s[84:85], s[76:77]
    s_mov_b64 s[68:69], s[80:81]
    v_mov_b32 v10, 0
    s_mov_b64 exec, 1
    buffer_atomic_add v10, off, s[16:19], s96 sc0 sc1
    s_mov_b64 exec, -1
    buffer_load_dwordx4 v[196:199], v25, s[84:87], s28 offen offset:0
    buffer_load_dwordx4 v[200:203], v25, s[84:87], s28 offen offset:64
    buffer_load_dwordx4 v[204:207], v25, s[84:87], s28 offen offset:128
    buffer_load_dwordx4 v[208:211], v25, s[84:87], s28 offen offset:192
    buffer_load_dwordx2 v[212:213], v26, s[84:87], s29 offen offset:1024
    s_mov_b32 m0, s42
    s_nop 0
    buffer_load_dwordx4 v5, s[8:11], s22 offen offset:0 nt lds
    s_add_u32 m0, m0, 896
    s_nop 0
    buffer_load_dwordx4 v5, s[8:11], s22 offen offset:128 nt lds
    s_add_u32 m0, m0, 896
    s_nop 0
    buffer_load_dwordx4 v5, s[8:11], s22 offen offset:256 nt lds
M_set:
    s_mov_b32 s12, s78
    s_mov_b32 s13, s79
    s_mov_b32 s14, 75497472
    s_mov_b32 s15, 0x20000
    s_mul_i32 s29, s20, 12864
    s_add_u32 s29, s29, 110592
    v_lshrrev_b32 v24, 1, v14
    v_and_b32 v27, 7, v14
    v_lshlrev_b32 v22, 7, v27
    v_lshl_or_b32 v3, v24, 4, v22
    v_lshrrev_b32 v23, 3, v14
    v_mul_u32_u24 v4, 9216, v23
    v_xad_u32 v1, v25, v3, v4
    v_xor_b32 v2, 64, v1
    v_add_u32 v9, s29, v25
    v_add_u32 v8, s29, v11
    v_mul_u32_u24 v24, 1152, v27
    v_lshl_add_u32 v24, v23, 6, v24
    v_add3_u32 v6, v24, v25, s28
    v_lshrrev_b32 v24, 3, v12
    v_xor_b32 v28, v24, v12
    v_and_b32 v28, 7, v28
    v_mul_u32_u24 v24, 1152, v24
    v_lshl_add_u32 v24, v28, 4, v24
    v_add_u32 v7, 1024, v24
    s_lshl_b32 s30, s20, 1
    v_lshrrev_b32 v24, 1, v13
    v_add_u32 v24, s30, v24
    v_xor_b32 v24, v24, v27
    v_lshl_add_u32 v24, v24, 4, v22
    v_and_b32 v28, 8, v26
    v_mul_u32_u24 v29, 12864, v23
    v_add3_u32 v24, v24, v28, v29
    v_add_u32 v53, 121408, v24
    s_lshr_b32 s30, s2, 3
    s_and_b32 s30, s30, 3
    s_mul_i32 s92, s30, 256
    s_add_u32 s92, s92, 562944
    s_add_u32 s30, s30, 768
    s_mul_i32 s93, s30, 36864
    s_mov_b32 s94, 147456
    s_and_b32 s95, s20, 1
    s_mul_i32 s95, s95, 9216
    s_add_u32 s59, s24, 9216
    s_mul_i32 s43, s20, 98304
    s_add_u32 s47, s29, 9216
    s_add_u32 s48, s29, 9792
    s_add_u32 s49, s29, 10112
    s_add_u32 s54, s29, 1073751872
    s_add_u32 s38, s26, 73728
    s_add_u32 s35, s38, 1024
    s_add_u32 s39, s38, 1536
    s_mov_b32 s40, s48
    s_add_u32 s41, s48, 256
    s_mov_b32 s50, 3130536464
    s_mov_b32 s51, 1164430831
    s_mov_b32 s52, 3696531472
    s_mov_b32 s53, 598435823
    v_mov_b32 v16, 0
    v_mov_b32 v17, 0
    v_mov_b32 v18, 0
    v_mov_b32 v19, 0
    v_cmp_gt_u32 s[44:45], 36, v12
    v_mov_b32 v20, 2.0
    s_nop 0
    v_cndmask_b32 v20, 0, v20, s[44:45]
    v_mov_b32 v21, v20
    v_mov_b32 v22, v20
    v_mov_b32 v23, v20
    v_mov_b32 v68, 1073741824
    v_mov_b32 v69, 0
    v_mov_b32 v70, 1073741824
    v_mov_b32 v71, 0
    v_lshl_add_u32 v84, v12, 2, s49
    v_add_u32 v55, s38, v54
    v_add_u32 v24, s38, v11
    ds_write_b128 v8, v[16:19] offset:0
    ds_write_b128 v8, v[16:19] offset:1024
    ds_write_b128 v8, v[16:19] offset:2048
    ds_write_b128 v8, v[16:19] offset:3072
    ds_write_b128 v8, v[16:19] offset:4096
    ds_write_b128 v8, v[16:19] offset:5120
    ds_write_b128 v8, v[16:19] offset:6144
    ds_write_b128 v8, v[16:19] offset:7168
    ds_write_b128 v8, v[16:19] offset:8192
    ds_write_b128 v24, v[68:71]
    ds_write_b128 v24, v[68:71] offset:1024
    ds_write_b128 v8, v[20:23] offset:9216
    s_cmp_lt_u32 s2, 81
    s_cbranch_scc1 F_sig
M_x2:
    s_add_u32 m0, m0, 896
    s_nop 0
    buffer_load_dwordx4 v5, s[8:11], s22 offen offset:384 nt lds
    s_add_u32 m0, m0, 896
    s_nop 0
    buffer_load_dwordx4 v5, s[8:11], s22 offen offset:512 nt lds
    s_add_u32 m0, m0, 896
    s_nop 0
    buffer_load_dwordx4 v5, s[8:11], s22 offen offset:640 nt lds
    s_add_u32 m0, m0, 896
    s_nop 0
    buffer_load_dwordx4 v5, s[8:11], s22 offen offset:768 nt lds
    s_add_u32 m0, m0, 896
    s_nop 0
    buffer_load_dwordx4 v5, s[8:11], s22 offen offset:896 nt lds
    s_add_u32 m0, m0, 896
    s_nop 0
    buffer_load_dwordx4 v5, s[8:11], s22 offen offset:1024 nt lds
    s_add_u32 s22, s22, 9437184
    s_add_u32 s42, s42, 36864
    s_mov_b32 m0, s42
    s_nop 0
    buffer_load_dwordx4 v5, s[8:11], s22 offen offset:0 nt lds
    s_add_u32 m0, m0, 896
    s_nop 0
    buffer_load_dwordx4 v5, s[8:11], s22 offen offset:128 nt lds
    s_add_u32 m0, m0, 896
    s_nop 0
    buffer_load_dwordx4 v5, s[8:11], s22 offen offset:256 nt lds
    s_add_u32 m0, m0, 896
    s_nop 0
    buffer_load_dwordx4 v5, s[8:11], s22 offen offset:384 nt lds
    s_add_u32 m0, m0, 896
    s_nop 0
    buffer_load_dwordx4 v5, s[8:11], s22 offen offset:512 nt lds
    s_add_u32 m0, m0, 896
    s_nop 0
    buffer_load_dwordx4 v5, s[8:11], s22 offen offset:640 nt lds
    s_add_u32 m0, m0, 896
    s_nop 0
    buffer_load_dwordx4 v5, s[8:11], s22 offen offset:768 nt lds
    s_add_u32 m0, m0, 896
    s_nop 0
    buffer_load_dwordx4 v5, s[8:11], s22 offen offset:896 nt lds
    s_add_u32 m0, m0, 896
    s_nop 0
    buffer_load_dwordx4 v5, s[8:11], s22 offen offset:1024 nt lds
    s_add_u32 s22, s22, 9437184
    s_add_u32 s42, s42, 36864
    s_waitcnt vmcnt(3)
    v_mov_b32 v0, 0
    s_mov_b64 exec, 1
    buffer_atomic_add v0, off, s[16:19], s96 sc0 sc1
    s_mov_b64 exec, -1
    v_readlane_b32 s100, v10, 0
    v_mov_b32 v10, 0xeeee4444
    v_lshlrev_b32 v124, 16, v196
    v_and_b32 v125, 0xffff0000, v196
    v_lshlrev_b32 v126, 16, v197
    v_and_b32 v127, 0xffff0000, v197
    v_lshlrev_b32 v128, 16, v198
    v_and_b32 v129, 0xffff0000, v198
    v_lshlrev_b32 v130, 16, v199
    v_and_b32 v131, 0xffff0000, v199
    v_lshlrev_b32 v132, 16, v200
    v_and_b32 v133, 0xffff0000, v200
    v_lshlrev_b32 v134, 16, v201
    v_and_b32 v135, 0xffff0000, v201
    v_lshlrev_b32 v136, 16, v202
    v_and_b32 v137, 0xffff0000, v202
    v_lshlrev_b32 v138, 16, v203
    v_and_b32 v139, 0xffff0000, v203
    v_lshlrev_b32 v140, 16, v204
    v_and_b32 v141, 0xffff0000, v204
    v_lshlrev_b32 v142, 16, v205
    v_and_b32 v143, 0xffff0000, v205
    v_lshlrev_b32 v144, 16, v206
    v_and_b32 v145, 0xffff0000, v206
    v_lshlrev_b32 v146, 16, v207
    v_and_b32 v147, 0xffff0000, v207
    v_lshlrev_b32 v148, 16, v208
    v_and_b32 v149, 0xffff0000, v208
    v_lshlrev_b32 v150, 16, v209
    v_and_b32 v151, 0xffff0000, v209
    v_lshlrev_b32 v152, 16, v210
    v_and_b32 v153, 0xffff0000, v210
    v_lshlrev_b32 v154, 16, v211
    v_and_b32 v155, 0xffff0000, v211
    v_lshlrev_b32 v156, 16, v212
    v_and_b32 v157, 0xffff0000, v212
    v_lshlrev_b32 v158, 16, v213
    v_and_b32 v159, 0xffff0000, v213
    s_mov_b32 exec_lo, 0x00010001
    s_mov_b32 exec_hi, 0x00010001
    ds_write_b128 v9, v[124:127] offset:10240
    ds_write_b128 v9, v[128:131] offset:10304
    ds_write_b128 v9, v[132:135] offset:10368
    ds_write_b128 v9, v[136:139] offset:10432
    ds_write_b128 v9, v[140:143] offset:10496
    ds_write_b128 v9, v[144:147] offset:10560
    ds_write_b128 v9, v[148:151] offset:10624
    ds_write_b128 v9, v[152:155] offset:10688
    ds_write_b128 v9, v[156:159] offset:10752
    s_mov_b64 exec, -1
    s_mul_i32 s30, s20, 256
    s_add_u32 s30, s30, s2
    s_sub_u32 s30, s30, 0
    s_cmp_lt_u32 s2, 0
    s_cselect_b32 s30, 1023, s30
    s_lshl_b32 s30, s30, 1
    v_lshrrev_b32 v244, 5, v12
    v_add_u32 v248, s30, v244
    v_mov_b32 v244, -1
    v_mov_b32 v245, 0
    v_subrev_u32 v246, 704, v248
    v_cmp_gt_u32 vcc, 16, v246
    v_mov_b32 v247, 0
    s_nop 0
    v_cndmask_b32 v244, v244, v246, vcc
    v_cndmask_b32 v245, v245, v247, vcc
    v_subrev_u32 v246, 672, v248
    v_cmp_gt_u32 vcc, 32, v246
    v_mov_b32 v247, 1
    s_nop 0
    v_cndmask_b32 v244, v244, v246, vcc
    v_cndmask_b32 v245, v245, v247, vcc
    v_subrev_u32 v246, 624, v248
    v_cmp_gt_u32 vcc, 48, v246
    v_mov_b32 v247, 2
    s_nop 0
    v_cndmask_b32 v244, v244, v246, vcc
    v_cndmask_b32 v245, v245, v247, vcc
    v_subrev_u32 v246, 560, v248
    v_cmp_gt_u32 vcc, 64, v246
    v_mov_b32 v247, 3
    s_nop 0
    v_cndmask_b32 v244, v244, v246, vcc
    v_cndmask_b32 v245, v245, v247, vcc
    v_subrev_u32 v246, 480, v248
    v_cmp_gt_u32 vcc, 80, v246
    v_mov_b32 v247, 4
    s_nop 0
    v_cndmask_b32 v244, v244, v246, vcc
    v_cndmask_b32 v245, v245, v247, vcc
    v_subrev_u32 v246, 384, v248
    v_cmp_gt_u32 vcc, 96, v246
    v_mov_b32 v247, 5
    s_nop 0
    v_cndmask_b32 v244, v244, v246, vcc
    v_cndmask_b32 v245, v245, v247, vcc
    v_subrev_u32 v246, 272, v248
    v_cmp_gt_u32 vcc, 112, v246
    v_mov_b32 v247, 6
    s_nop 0
    v_cndmask_b32 v244, v244, v246, vcc
    v_cndmask_b32 v245, v245, v247, vcc
    v_subrev_u32 v246, 144, v248
    v_cmp_gt_u32 vcc, 128, v246
    v_mov_b32 v247, 7
    s_nop 0
    v_cndmask_b32 v244, v244, v246, vcc
    v_cndmask_b32 v245, v245, v247, vcc
    v_subrev_u32 v246, 0, v248
    v_cmp_gt_u32 vcc, 144, v246
    v_mov_b32 v247, 8
    s_nop 0
    v_cndmask_b32 v244, v244, v246, vcc
    v_cndmask_b32 v245, v245, v247, vcc
    v_sub_u32 v244, 2047, v244
    v_mul_u32_u24 v244, 36864, v244
    v_lshl_add_u32 v244, v245, 7, v244
    v_and_b32 v245, 31, v12
    v_mul_u32_u24 v245, 1152, v245
    v_add_u32 v249, v244, v245
    s_mov_b32 vcc_lo, 0xff00ff00
    s_mov_b32 vcc_hi, 0xff00ff00
    s_waitcnt vmcnt(0)
    v_readfirstlane_b32 s30, v0
    s_mov_b32 s31, 0
    s_sub_u32 s30, s30, s100
    s_cmp_eq_u32 s30, 27
    s_cbranch_scc0 M_pf_spin
M_pf_ok:
    s_lshr_b32 s30, s2, 3
    s_sub_u32 s31, s30, 11
    s_cselect_b32 s30, s30, s31
    s_mul_i32 s30, s30, 3072
    s_add_u32 s30, s30, s43
    s_add_u32 s30, s30, 33792
    v_lshlrev_b32 v244, 3, v11
    v_mov_b32 v0, v249
    buffer_load_dwordx4 v[56:59], v11, s[16:19], s43 offen offset:0 sc1
    buffer_load_dwordx4 v[60:63], v11, s[16:19], s43 offen offset:1024 sc1
    buffer_load_dwordx4 v[64:67], v11, s[16:19], s43 offen offset:2048 sc1
    s_mov_b32 exec_hi, 268435455
    buffer_load_dwordx4 v[68:71], v11, s[16:19], s43 offen offset:3072 sc1
    s_mov_b32 exec_hi, -1
    s_add_u32 s43, s43, 4096
    buffer_load_dwordx4 v[48:51], v11, s[16:19], s43 offen offset:0 sc1
    buffer_load_dword v52, v11, s[16:19], s43 offen offset:1024 sc1
    buffer_load_dwordx4 v[12:15], v11, s[16:19], s43 offen offset:2048 sc1
    buffer_load_dwordx4 a[0:3], v11, s[16:19], s43 offen offset:3072 sc1
    s_add_u32 s43, s43, 4096
    buffer_load_dwordx4 a[4:7], v11, s[16:19], s43 offen offset:0 sc1
    buffer_load_dwordx4 a[8:11], v11, s[16:19], s43 offen offset:1024 sc1
    buffer_load_dwordx4 a[12:15], v11, s[16:19], s43 offen offset:2048 sc1
    buffer_load_dwordx4 a[16:19], v11, s[16:19], s43 offen offset:3072 sc1
    s_add_u32 s43, s43, 4096
    s_bfm_b64 exec, 24, 0
    buffer_load_dword v244, v244, s[16:19], s30 offen sc1
    s_mov_b64 exec, -1
    buffer_load_dwordx4 a[20:23], v11, s[16:19], s43 offen offset:0 sc1
    buffer_load_dwordx4 a[24:27], v11, s[16:19], s43 offen offset:1024 sc1
    buffer_load_dwordx4 a[28:31], v11, s[16:19], s43 offen offset:2048 sc1
    buffer_load_dwordx4 a[32:35], v11, s[16:19], s43 offen offset:3072 sc1
    s_add_u32 s43, s43, 4096
    buffer_load_dwordx4 v[16:19], v11, s[16:19], s43 offen offset:0 sc1
    buffer_load_dwordx4 a[36:39], v11, s[16:19], s43 offen offset:1024 sc1
    buffer_load_dwordx4 a[40:43], v11, s[16:19], s43 offen offset:2048 sc1
    buffer_load_dwordx4 a[44:47], v11, s[16:19], s43 offen offset:3072 sc1
    ds_read_b128 v[160:163], v9 offset:10240
    ds_read_b128 v[164:167], v9 offset:10304
    ds_read_b128 v[168:171], v9 offset:10368
    ds_read_b128 v[172:175], v9 offset:10432
    ds_read_b128 v[176:179], v9 offset:10496
    ds_read_b128 v[180:183], v9 offset:10560
    ds_read_b128 v[184:187], v9 offset:10624
    ds_read_b128 v[188:191], v9 offset:10688
    ds_read_b128 v[192:195], v9 offset:10752
    s_cmp_eq_u32 s98, 0
    s_cbranch_scc1 M_cnt
    s_mov_b32 s98, 0
    v_mov_b32 v250, 1
    s_mov_b64 exec, 1
    buffer_atomic_add v250, off, s[68:71], 0 offset:0 sc1
    s_mov_b64 exec, -1
    s_nop 3
M_cnt:
    s_waitcnt vmcnt(13)
    s_barrier
    ds_read_b128 v[196:199], v1 offset:0
    ds_read_b128 v[200:203], v2 offset:0
    ds_read_b128 v[228:231], v1 offset:18432
    ds_read_b128 v[232:235], v2 offset:18432
    s_waitcnt lgkmcnt(2)
    v_smfmac_f32_16x16x64_bf16 v[124:127], a[0:3], v[196:203], v12
    s_add_u32 s43, s43, 4096
    buffer_load_dwordx4 a[48:51], v11, s[16:19], s43 offen offset:0 sc1
    s_waitcnt lgkmcnt(0)
    v_mov_b32 v82, s54
    v_smfmac_f32_16x16x64_bf16 v[160:163], a[0:3], v[228:235], v12
    ds_read_b128 v[204:207], v1 offset:1024
    ds_read_b128 v[208:211], v2 offset:1024
    v_or3_b32 v78, v56, v60, v64
    v_or_b32 v78, v78, v68
    v_cmp_gt_i32 s[32:33], 0, v78
    v_cmp_gt_u32 s[36:37], 2.0, v56
    s_nop 1
    v_mbcnt_lo_u32_b32 v74, s36, 0
    s_waitcnt vmcnt(13)
    v_mbcnt_hi_u32_b32 v74, s37, v74
    v_smfmac_f32_16x16x64_bf16 v[128:131], a[4:7], v[196:203], v12 abid:1
    buffer_load_dwordx4 a[52:55], v11, s[16:19], s43 offen offset:1024 sc1
    v_lshl_add_u32 v74, v74, 3, s38
    v_smfmac_f32_16x16x64_bf16 v[164:167], a[4:7], v[228:235], v12 abid:1
    ds_read_b128 v[220:223], v1 offset:19456
    ds_read_b128 v[224:227], v2 offset:19456
    v_min_u32 v74, s39, v74
    s_waitcnt vmcnt(13)
    v_cndmask_b32 v74, v82, v74, s[36:37]
    v_smfmac_f32_16x16x64_bf16 v[132:135], a[8:11], v[196:203], v13
    buffer_load_dwordx4 a[56:59], v11, s[16:19], s43 offen offset:2048 sc1
    ds_write_b64 v74, v[56:57]
    s_bcnt1_i32_b64 s30, s[36:37]
    s_lshl3_add_u32 s38, s30, s38
    v_cmp_gt_u32 s[44:45], 2.0, v58
    v_smfmac_f32_16x16x64_bf16 v[168:171], a[8:11], v[228:235], v13
    s_nop 0
    v_mbcnt_lo_u32_b32 v75, s44, 0
    v_mbcnt_hi_u32_b32 v75, s45, v75
    v_lshl_add_u32 v75, v75, 3, s38
    v_min_u32 v75, s39, v75
    s_waitcnt vmcnt(13)
    v_cndmask_b32 v75, v82, v75, s[44:45]
    v_smfmac_f32_16x16x64_bf16 v[136:139], a[12:15], v[196:203], v13 abid:1
    buffer_load_dwordx4 a[60:63], v11, s[16:19], s43 offen offset:3072 sc1
    ds_write_b64 v75, v[58:59]
    s_bcnt1_i32_b64 s30, s[44:45]
    s_lshl3_add_u32 s38, s30, s38
    v_cmp_gt_u32 s[36:37], 2.0, v60
    v_smfmac_f32_16x16x64_bf16 v[172:175], a[12:15], v[228:235], v13 abid:1
    s_nop 0
    v_mbcnt_lo_u32_b32 v74, s36, 0
    v_mbcnt_hi_u32_b32 v74, s37, v74
    v_lshl_add_u32 v74, v74, 3, s38
    s_waitcnt vmcnt(13)
    v_min_u32 v74, s39, v74
    v_smfmac_f32_16x16x64_bf16 v[140:143], a[16:19], v[196:203], v14
    s_add_u32 s43, s43, 4096
    buffer_load_dwordx4 a[64:67], v11, s[16:19], s43 offen offset:0 sc1
    v_cndmask_b32 v74, v82, v74, s[36:37]
    v_smfmac_f32_16x16x64_bf16 v[176:179], a[16:19], v[228:235], v14
    ds_write_b64 v74, v[60:61]
    s_bcnt1_i32_b64 s30, s[36:37]
    s_lshl3_add_u32 s38, s30, s38
    v_cmp_gt_u32 s[44:45], 2.0, v62
    s_nop 1
    v_mbcnt_lo_u32_b32 v75, s44, 0
    s_waitcnt vmcnt(12)
    v_mbcnt_hi_u32_b32 v75, s45, v75
    v_smfmac_f32_16x16x64_bf16 v[144:147], a[20:23], v[196:203], v14 abid:1
    buffer_load_dwordx4 a[68:71], v11, s[16:19], s43 offen offset:1024 sc1
    v_lshl_add_u32 v75, v75, 3, s38
    v_smfmac_f32_16x16x64_bf16 v[180:183], a[20:23], v[228:235], v14 abid:1
    v_min_u32 v75, s39, v75
    s_waitcnt vmcnt(12)
    v_cndmask_b32 v75, v82, v75, s[44:45]
    v_smfmac_f32_16x16x64_bf16 v[148:151], a[24:27], v[196:203], v15
    buffer_load_dwordx4 v[20:23], v11, s[16:19], s43 offen offset:2048 sc1
    buffer_load_dwordx4 a[72:75], v11, s[16:19], s43 offen offset:3072 sc1
    ds_write_b64 v75, v[62:63]
    s_bcnt1_i32_b64 s30, s[44:45]
    s_lshl3_add_u32 s38, s30, s38
    v_cmp_gt_u32 s[36:37], 2.0, v64
    v_smfmac_f32_16x16x64_bf16 v[184:187], a[24:27], v[228:235], v15
    s_nop 0
    v_mbcnt_lo_u32_b32 v74, s36, 0
    v_mbcnt_hi_u32_b32 v74, s37, v74
    v_lshl_add_u32 v74, v74, 3, s38
    v_min_u32 v74, s39, v74
    s_waitcnt vmcnt(13)
    v_cndmask_b32 v74, v82, v74, s[36:37]
    v_smfmac_f32_16x16x64_bf16 v[152:155], a[28:31], v[196:203], v15 abid:1
    s_add_u32 s43, s43, 4096
    buffer_load_dwordx4 a[76:79], v11, s[16:19], s43 offen offset:0 sc1
    ds_write_b64 v74, v[64:65]
    s_bcnt1_i32_b64 s30, s[36:37]
    s_lshl3_add_u32 s38, s30, s38
    v_cmp_gt_u32 s[44:45], 2.0, v66
    v_smfmac_f32_16x16x64_bf16 v[188:191], a[28:31], v[228:235], v15 abid:1
    s_nop 0
    v_mbcnt_lo_u32_b32 v75, s44, 0
    v_mbcnt_hi_u32_b32 v75, s45, v75
    v_lshl_add_u32 v75, v75, 3, s38
    s_waitcnt vmcnt(13)
    v_min_u32 v75, s39, v75
    v_smfmac_f32_16x16x64_bf16 v[156:159], a[32:35], v[196:203], v48
    buffer_load_dwordx4 a[80:83], v11, s[16:19], s43 offen offset:1024 sc1
    v_cndmask_b32 v75, v82, v75, s[44:45]
    v_smfmac_f32_16x16x64_bf16 v[192:195], a[32:35], v[228:235], v48
    ds_write_b64 v75, v[66:67]
    s_bcnt1_i32_b64 s30, s[44:45]
    s_lshl3_add_u32 s38, s30, s38
    v_cmp_gt_u32 s[36:37], 2.0, v68
    s_nop 1
    s_waitcnt vmcnt(12)
    s_waitcnt lgkmcnt(8)
    v_mbcnt_lo_u32_b32 v74, s36, 0
    v_smfmac_f32_16x16x64_bf16 v[124:127], a[36:39], v[204:211], v16
    buffer_load_dwordx4 a[84:87], v11, s[16:19], s43 offen offset:2048 sc1
    s_waitcnt lgkmcnt(6)
    v_mbcnt_hi_u32_b32 v74, s37, v74
    v_smfmac_f32_16x16x64_bf16 v[160:163], a[36:39], v[220:227], v16
    ds_read_b128 v[196:199], v1 offset:2048
    ds_read_b128 v[200:203], v2 offset:2048
    v_lshl_add_u32 v74, v74, 3, s38
    v_min_u32 v74, s39, v74
    s_waitcnt vmcnt(12)
    v_cndmask_b32 v74, v82, v74, s[36:37]
    v_smfmac_f32_16x16x64_bf16 v[128:131], a[40:43], v[204:211], v16 abid:1
    buffer_load_dwordx4 a[88:91], v11, s[16:19], s43 offen offset:3072 sc1
    ds_write_b64 v74, v[68:69]
    s_bcnt1_i32_b64 s30, s[36:37]
    s_lshl3_add_u32 s38, s30, s38
    v_cmp_gt_u32 s[44:45], 2.0, v70
    v_smfmac_f32_16x16x64_bf16 v[164:167], a[40:43], v[220:227], v16 abid:1
    ds_read_b128 v[228:231], v1 offset:20480
    ds_read_b128 v[232:235], v2 offset:20480
    v_mbcnt_lo_u32_b32 v75, s44, 0
    v_mbcnt_hi_u32_b32 v75, s45, v75
    v_lshl_add_u32 v75, v75, 3, s38
    v_min_u32 v75, s39, v75
    s_waitcnt vmcnt(12)
    v_cndmask_b32 v75, v82, v75, s[44:45]
    v_smfmac_f32_16x16x64_bf16 v[132:135], a[44:47], v[204:211], v17
    s_add_u32 s43, s43, 4096
    buffer_load_dwordx4 a[92:95], v11, s[16:19], s43 offen offset:0 sc1
    ds_write_b64 v75, v[70:71]
    s_bcnt1_i32_b64 s30, s[44:45]
    s_lshl3_add_u32 s38, s30, s38
    ds_read_b64 v[56:57], v55 offset:0
    ds_read_b64 v[58:59], v55 offset:512
    ds_read_b64 v[60:61], v55 offset:1024
    v_smfmac_f32_16x16x64_bf16 v[168:171], a[44:47], v[220:227], v17
    s_waitcnt vmcnt(12)
    v_smfmac_f32_16x16x64_bf16 v[136:139], a[48:51], v[204:211], v17 abid:1
    buffer_load_dwordx4 a[96:99], v11, s[16:19], s43 offen offset:1024 sc1
    v_smfmac_f32_16x16x64_bf16 v[172:175], a[48:51], v[220:227], v17 abid:1
    s_waitcnt vmcnt(12)
    v_smfmac_f32_16x16x64_bf16 v[140:143], a[52:55], v[204:211], v18
    buffer_load_dwordx4 a[100:103], v11, s[16:19], s43 offen offset:2048 sc1
    s_waitcnt lgkmcnt(2)
    v_bfe_u32 v74, v56, 24, 4
    v_smfmac_f32_16x16x64_bf16 v[176:179], a[52:55], v[220:227], v18
    v_lshlrev_b32 v75, 1, v56
    v_lshl_add_u32 v74, v74, 2, s49
    v_and_b32 v75, 16, v75
    s_waitcnt vmcnt(12)
    v_and_or_b32 v74, v56, 2.0, v74
    v_smfmac_f32_16x16x64_bf16 v[144:147], a[56:59], v[204:211], v18 abid:1
    buffer_load_dwordx4 a[104:107], v11, s[16:19], s43 offen offset:3072 sc1
    v_lshlrev_b32 v75, v75, 1
    v_smfmac_f32_16x16x64_bf16 v[180:183], a[56:59], v[220:227], v18 abid:1
    ds_add_rtn_u32 v62, v74, v75
    s_waitcnt lgkmcnt(2)
    v_bfe_u32 v76, v58, 24, 4
    v_lshlrev_b32 v77, 1, v58
    v_lshl_add_u32 v76, v76, 2, s49
    s_waitcnt vmcnt(12)
    v_and_b32 v77, 16, v77
    v_smfmac_f32_16x16x64_bf16 v[148:151], a[60:63], v[204:211], v19
    s_add_u32 s43, s43, 4096
    buffer_load_dwordx4 v[24:27], v11, s[16:19], s43 offen offset:0 sc1
    buffer_load_dwordx4 a[108:111], v11, s[16:19], s43 offen offset:1024 sc1
    v_and_or_b32 v76, v58, 2.0, v76
    v_smfmac_f32_16x16x64_bf16 v[184:187], a[60:63], v[220:227], v19
    s_waitcnt vmcnt(13)
    v_lshlrev_b32 v77, v77, 1
    v_smfmac_f32_16x16x64_bf16 v[152:155], a[64:67], v[204:211], v19 abid:1
    buffer_load_dwordx4 a[112:115], v11, s[16:19], s43 offen offset:2048 sc1
    ds_add_rtn_u32 v63, v76, v77
    s_waitcnt lgkmcnt(2)
    s_cmp_gt_u32 s38, s35
    s_cbranch_scc1 M_r3
M_r3r:
    ds_read_b32 v81, v84
    v_and_b32 v74, 8, v56
    v_smfmac_f32_16x16x64_bf16 v[188:191], a[64:67], v[220:227], v19 abid:1
    v_lshrrev_b32 v77, 14, v56
    v_cmp_ne_u32 s[44:45], 0, v74
    v_and_b32 v80, 0x3cf0, v77
    s_waitcnt lgkmcnt(2)
    v_lshrrev_b32 v75, 16, v62
    v_and_b32 v76, 0xffff, v62
    s_waitcnt vmcnt(13)
    v_sub_u32 v74, 15, v75
    v_smfmac_f32_16x16x64_bf16 v[156:159], a[68:71], v[204:211], v48 abid:1
    buffer_load_dwordx4 a[116:119], v11, s[16:19], s43 offen offset:3072 sc1
    v_and_b32 v62, 2.0, v56
    v_smfmac_f32_16x16x64_bf16 v[192:195], a[68:71], v[220:227], v48 abid:1
    v_add3_u32 v62, v76, v75, v62
    v_cndmask_b32 v74, v76, v74, s[44:45]
    v_cmp_gt_u32 s[44:45], 16, v62
    v_cmp_gt_u32 s[36:37], 2.0, v62
    v_lshlrev_b32 v74, 2, v74
    s_waitcnt vmcnt(12)
    v_lshrrev_b64 v[76:77], v74, s[50:51]
    v_smfmac_f32_16x16x64_bf16 v[124:127], a[72:75], v[196:203], v20
    s_add_u32 s43, s43, 4096
    buffer_load_dwordx4 a[120:123], v11, s[16:19], s43 offen offset:0 sc1
    s_andn2_b64 s[36:37], s[36:37], s[44:45]
    v_lshrrev_b64 v[78:79], v74, s[52:53]
    v_smfmac_f32_16x16x64_bf16 v[160:163], a[72:75], v[228:235], v20
    ds_read_b128 v[204:207], v1 offset:3072
    ds_read_b128 v[208:211], v2 offset:3072
    v_bfe_u32 v74, v56, 24, 4
    v_mbcnt_lo_u32_b32 v75, s36, 0
    v_and_b32 v76, 15, v76
    v_mbcnt_hi_u32_b32 v75, s37, v75
    v_and_b32 v78, 15, v78
    s_waitcnt vmcnt(12)
    v_lshl_add_u32 v75, v75, 3, s40
    v_smfmac_f32_16x16x64_bf16 v[128:131], a[76:79], v[196:203], v20 abid:1
    buffer_load_dwordx4 a[124:127], v11, s[16:19], s43 offen offset:1024 sc1
    v_lshl_add_u32 v76, v74, 4, v76
    v_smfmac_f32_16x16x64_bf16 v[164:167], a[76:79], v[228:235], v20 abid:1
    ds_read_b128 v[220:223], v1 offset:21504
    ds_read_b128 v[224:227], v2 offset:21504
    v_min_u32 v75, s41, v75
    v_mul_u32_u24 v78, 68, v78
    s_waitcnt vmcnt(12)
    v_cndmask_b32 v75, v82, v75, s[36:37]
    v_smfmac_f32_16x16x64_bf16 v[132:135], a[80:83], v[196:203], v21
    buffer_load_dwordx4 a[128:131], v11, s[16:19], s43 offen offset:2048 sc1
    ds_write_b64 v75, v[56:57]
    s_bcnt1_i32_b64 s30, s[36:37]
    s_lshl3_add_u32 s40, s30, s40
    v_lshl_add_u32 v76, v76, 2, s47
    v_smfmac_f32_16x16x64_bf16 v[168:171], a[80:83], v[228:235], v21
    v_and_b32 v78, 0x30c, v78
    v_cndmask_b32 v76, v82, v76, s[44:45]
    v_add3_u32 v77, v80, v78, s29
    v_and_b32 v78, 0x3fff, v56
    s_waitcnt vmcnt(12)
    v_cndmask_b32 v74, v82, v77, s[44:45]
    v_smfmac_f32_16x16x64_bf16 v[136:139], a[84:87], v[196:203], v21 abid:1
    buffer_load_dwordx4 a[132:135], v11, s[16:19], s43 offen offset:3072 sc1
    ds_write_b32 v76, v78
    ds_write_b32 v74, v57
    v_and_b32 v74, 8, v58
    v_smfmac_f32_16x16x64_bf16 v[172:175], a[84:87], v[228:235], v21 abid:1
    v_lshrrev_b32 v77, 14, v58
    v_cmp_ne_u32 s[44:45], 0, v74
    v_and_b32 v80, 0x3cf0, v77
    s_waitcnt lgkmcnt(8)
    s_waitcnt vmcnt(12)
    v_lshrrev_b32 v75, 16, v63
    v_smfmac_f32_16x16x64_bf16 v[140:143], a[88:91], v[196:203], v22
    s_add_u32 s43, s43, 4096
    buffer_load_dwordx4 a[136:139], v11, s[16:19], s43 offen offset:0 sc1
    v_and_b32 v76, 0xffff, v63
    v_smfmac_f32_16x16x64_bf16 v[176:179], a[88:91], v[228:235], v22
    v_sub_u32 v74, 15, v75
    v_and_b32 v63, 2.0, v58
    v_add3_u32 v63, v76, v75, v63
    v_cndmask_b32 v74, v76, v74, s[44:45]
    s_waitcnt vmcnt(12)
    v_cmp_gt_u32 s[44:45], 16, v63
    v_smfmac_f32_16x16x64_bf16 v[144:147], a[92:95], v[196:203], v22 abid:1
    buffer_load_dwordx4 a[140:143], v11, s[16:19], s43 offen offset:1024 sc1
    v_cmp_gt_u32 s[36:37], 2.0, v63
    v_smfmac_f32_16x16x64_bf16 v[180:183], a[92:95], v[228:235], v22 abid:1
    v_lshlrev_b32 v74, 2, v74
    s_waitcnt vmcnt(12)
    v_lshrrev_b64 v[76:77], v74, s[50:51]
    v_smfmac_f32_16x16x64_bf16 v[148:151], a[96:99], v[196:203], v23
    buffer_load_dwordx4 v[28:31], v11, s[16:19], s43 offen offset:2048 sc1
    buffer_load_dwordx4 a[144:147], v11, s[16:19], s43 offen offset:3072 sc1
    s_andn2_b64 s[36:37], s[36:37], s[44:45]
    v_lshrrev_b64 v[78:79], v74, s[52:53]
    v_smfmac_f32_16x16x64_bf16 v[184:187], a[96:99], v[228:235], v23
    v_bfe_u32 v74, v58, 24, 4
    v_mbcnt_lo_u32_b32 v75, s36, 0
    v_and_b32 v76, 15, v76
    v_mbcnt_hi_u32_b32 v75, s37, v75
    v_and_b32 v78, 15, v78
    s_waitcnt vmcnt(13)
    v_lshl_add_u32 v75, v75, 3, s40
    v_smfmac_f32_16x16x64_bf16 v[152:155], a[100:103], v[196:203], v23 abid:1
    s_add_u32 s43, s43, 4096
    buffer_load_dwordx4 a[148:151], v11, s[16:19], s43 offen offset:0 sc1
    v_lshl_add_u32 v76, v74, 4, v76
    v_smfmac_f32_16x16x64_bf16 v[188:191], a[100:103], v[228:235], v23 abid:1
    v_min_u32 v75, s41, v75
    v_mul_u32_u24 v78, 68, v78
    s_waitcnt vmcnt(13)
    v_cndmask_b32 v75, v82, v75, s[36:37]
    v_smfmac_f32_16x16x64_bf16 v[156:159], a[104:107], v[196:203], v49
    buffer_load_dwordx4 a[152:155], v11, s[16:19], s43 offen offset:1024 sc1
    ds_write_b64 v75, v[58:59]
    s_bcnt1_i32_b64 s30, s[36:37]
    s_lshl3_add_u32 s40, s30, s40
    v_lshl_add_u32 v76, v76, 2, s47
    v_smfmac_f32_16x16x64_bf16 v[192:195], a[104:107], v[228:235], v49
    v_and_b32 v78, 0x30c, v78
    v_cndmask_b32 v76, v82, v76, s[44:45]
    v_add3_u32 v77, v80, v78, s29
    v_and_b32 v78, 0x3fff, v58
    s_waitcnt vmcnt(12)
    s_waitcnt lgkmcnt(6)
    v_cndmask_b32 v74, v82, v77, s[44:45]
    v_smfmac_f32_16x16x64_bf16 v[124:127], a[108:111], v[204:211], v24
    buffer_load_dwordx4 a[156:159], v11, s[16:19], s43 offen offset:2048 sc1
    ds_write_b32 v76, v78
    ds_write_b32 v74, v59
    s_waitcnt lgkmcnt(6)
    v_lshrrev_b32 v74, 16, v81
    v_smfmac_f32_16x16x64_bf16 v[160:163], a[108:111], v[220:227], v24
    ds_read_b128 v[196:199], v1 offset:4096
    ds_read_b128 v[200:203], v2 offset:4096
    v_and_b32 v81, 0xffff, v81
    v_add_u32 v81, v81, v74
    s_waitcnt vmcnt(12)
    v_cmp_lt_u32 s[34:35], 16, v81
    v_smfmac_f32_16x16x64_bf16 v[128:131], a[112:115], v[204:211], v24 abid:1
    buffer_load_dwordx4 a[160:163], v11, s[16:19], s43 offen offset:3072 sc1
    s_sub_u32 s46, s40, s48
    s_add_u32 s46, s46, 56
    s_lshr_b32 s46, s46, 6
    s_mov_b32 s21, 0
    s_and_b32 s27, s34, 0x1ff
    s_cmp_gt_u32 s46, 4
    s_cselect_b32 s32, 1, s32
    s_or_b32 s32, s32, s33
    s_cbranch_scc1 M_dn
M_dnr:
    ds_read_b128 v[56:59], v9 offset:9792
    s_bcnt1_i32_b32 s30, s27
    s_cmp_gt_u32 s30, 3
    s_cselect_b32 s34, 0, s27
    s_cselect_b32 s80, 0, 1
    s_getpc_b64 s[36:37]
M_pc:
    v_bfe_u32 v74, v11, 4, 4
    v_smfmac_f32_16x16x64_bf16 v[164:167], a[112:115], v[220:227], v24 abid:1
    ds_read_b128 v[228:231], v1 offset:22528
    ds_read_b128 v[232:235], v2 offset:22528
    s_waitcnt vmcnt(12)
    v_smfmac_f32_16x16x64_bf16 v[132:135], a[116:119], v[204:211], v25
    s_add_u32 s43, s43, 4096
    buffer_load_dwordx4 a[164:167], v11, s[16:19], s43 offen offset:0 sc1
    s_ff1_i32_b32 s81, s34
    s_bitset0_b32 s34, s81
    s_mul_i32 s30, s81, 20
    s_add_u32 s31, s30, M_ovc0-M_pc
    s_add_u32 s30, s30, M_ovl0-M_pc
    s_cmp_lg_u32 s34, 0
    s_cselect_b32 s30, s31, s30
    s_cmp_lt_i32 s81, 0
    s_cselect_b32 s30, M_ovn-M_pc, s30
    s_add_u32 s72, s36, s30
    s_addc_u32 s73, s37, 0
    s_ff1_i32_b32 s82, s34
    s_bitset0_b32 s34, s82
    s_mul_i32 s30, s82, 20
    s_add_u32 s31, s30, M_ovc1-M_pc
    s_add_u32 s30, s30, M_ovl1-M_pc
    s_cmp_lg_u32 s34, 0
    s_cselect_b32 s30, s31, s30
    s_cmp_lt_i32 s82, 0
    s_cselect_b32 s30, M_ovn-M_pc, s30
    v_smfmac_f32_16x16x64_bf16 v[168:171], a[116:119], v[220:227], v25
    s_waitcnt vmcnt(12)
    v_smfmac_f32_16x16x64_bf16 v[136:139], a[120:123], v[204:211], v25 abid:1
    buffer_load_dwordx4 a[168:171], v11, s[16:19], s43 offen offset:1024 sc1
    s_add_u32 s74, s36, s30
    s_addc_u32 s75, s37, 0
    s_ff1_i32_b32 s83, s34
    s_bitset0_b32 s34, s83
    s_mul_i32 s30, s83, 20
    s_add_u32 s31, s30, M_ovc1-M_pc
    s_add_u32 s30, s30, M_ovl2-M_pc
    s_cmp_lg_u32 s34, 0
    s_cselect_b32 s30, s31, s30
    s_cmp_lt_i32 s83, 0
    s_cselect_b32 s30, M_ovn-M_pc, s30
    s_add_u32 s76, s36, s30
    s_addc_u32 s77, s37, 0
    s_waitcnt lgkmcnt(2)
    v_lshrrev_b32 v76, 18, v56
    v_smfmac_f32_16x16x64_bf16 v[172:175], a[120:123], v[220:227], v25 abid:1
    s_waitcnt vmcnt(12)
    v_lshrrev_b32 v77, 18, v58
    v_smfmac_f32_16x16x64_bf16 v[140:143], a[124:127], v[204:211], v26
    buffer_load_dwordx4 a[172:175], v11, s[16:19], s43 offen offset:2048 sc1
    v_and_b32 v78, 0x3fff, v56
    v_smfmac_f32_16x16x64_bf16 v[176:179], a[124:127], v[220:227], v26
    s_waitcnt vmcnt(12)
    v_and_b32 v79, 0x3fff, v58
    v_smfmac_f32_16x16x64_bf16 v[144:147], a[128:131], v[204:211], v26 abid:1
    buffer_load_dwordx4 a[176:179], v11, s[16:19], s43 offen offset:3072 sc1
    ds_write_b64 v9, v[78:79] offset:10056
    v_lshl_or_b32 v75, s81, 6, v74
    v_smfmac_f32_16x16x64_bf16 v[180:183], a[128:131], v[220:227], v26 abid:1
    v_cmp_eq_u32 s[44:45], v76, v75
    v_cmp_eq_u32 s[36:37], v77, v75
    s_nop 0
    v_cndmask_b32 v54, 0, v57, s[44:45]
    v_cndmask_b32 v55, 0, v59, s[36:37]
    v_lshl_or_b32 v75, s82, 6, v74
    s_waitcnt vmcnt(12)
    v_cmp_eq_u32 s[44:45], v76, v75
    v_smfmac_f32_16x16x64_bf16 v[148:151], a[132:135], v[204:211], v27
    s_add_u32 s43, s43, 4096
    buffer_load_dwordx4 v[32:35], v11, s[16:19], s43 offen offset:0 sc1
    buffer_load_dwordx4 a[180:183], v11, s[16:19], s43 offen offset:1024 sc1
    v_cmp_eq_u32 s[36:37], v77, v75
    v_smfmac_f32_16x16x64_bf16 v[184:187], a[132:135], v[220:227], v27
    v_cndmask_b32 v252, 0, v57, s[44:45]
    v_cndmask_b32 v253, 0, v59, s[36:37]
    v_lshl_or_b32 v75, s83, 6, v74
    v_cmp_eq_u32 s[44:45], v76, v75
    v_cmp_eq_u32 s[36:37], v77, v75
    s_nop 0
    s_waitcnt vmcnt(13)
    v_cndmask_b32 v254, 0, v57, s[44:45]
    v_smfmac_f32_16x16x64_bf16 v[152:155], a[136:139], v[204:211], v27 abid:1
    buffer_load_dwordx4 a[184:187], v11, s[16:19], s43 offen offset:2048 sc1
    v_cndmask_b32 v255, 0, v59, s[36:37]
    v_smfmac_f32_16x16x64_bf16 v[188:191], a[136:139], v[220:227], v27 abid:1
    ds_read_b128 v[236:239], v9 offset:9408
    ds_read_b64 v[216:217], v9 offset:10056
    s_waitcnt vmcnt(13)
    v_smfmac_f32_16x16x64_bf16 v[156:159], a[140:143], v[204:211], v49 abid:1
    buffer_load_dwordx4 a[188:191], v11, s[16:19], s43 offen offset:3072 sc1
    s_waitcnt lgkmcnt(1)
    v_xad_u32 v236, v236, v3, v4
    v_smfmac_f32_16x16x64_bf16 v[192:195], a[140:143], v[220:227], v49 abid:1
    s_waitcnt vmcnt(12)
    v_xad_u32 v237, v237, v3, v4
    v_smfmac_f32_16x16x64_bf16 v[124:127], a[144:147], v[196:203], v28
    s_add_u32 s43, s43, 4096
    buffer_load_dwordx4 a[192:195], v11, s[16:19], s43 offen offset:0 sc1
    ds_read2st64_b32 v[244:245], v236 offset0:0 offset1:72
    ds_read2st64_b32 v[246:247], v237 offset0:0 offset1:72
    v_xad_u32 v238, v238, v3, v4
    v_smfmac_f32_16x16x64_bf16 v[160:163], a[144:147], v[228:235], v28
    ds_read_b128 v[204:207], v1 offset:5120
    ds_read_b128 v[208:211], v2 offset:5120
    s_waitcnt vmcnt(12)
    v_xad_u32 v239, v239, v3, v4
    v_smfmac_f32_16x16x64_bf16 v[128:131], a[148:151], v[196:203], v28 abid:1
    buffer_load_dwordx4 a[196:199], v11, s[16:19], s43 offen offset:1024 sc1
    ds_read2st64_b32 v[248:249], v238 offset0:0 offset1:72
    ds_read2st64_b32 v[250:251], v239 offset0:0 offset1:72
    ds_read_b128 v[240:243], v8 offset:3072
    ds_read_b128 v[236:239], v9 offset:9280
    s_waitcnt lgkmcnt(8)
    v_xad_u32 v212, v216, v3, v4
    v_smfmac_f32_16x16x64_bf16 v[164:167], a[148:151], v[228:235], v28 abid:1
    ds_read_b128 v[220:223], v1 offset:23552
    ds_read_b128 v[224:227], v2 offset:23552
    ds_read2st64_b32 v[212:213], v212 offset0:0 offset1:72
    s_waitcnt vmcnt(12)
    v_xad_u32 v214, v217, v3, v4
    v_smfmac_f32_16x16x64_bf16 v[132:135], a[152:155], v[196:203], v29
    buffer_load_dwordx4 a[200:203], v11, s[16:19], s43 offen offset:2048 sc1
    ds_read2st64_b32 v[214:215], v214 offset0:0 offset1:72
    v_smfmac_f32_16x16x64_bf16 v[168:171], a[152:155], v[228:235], v29
    s_waitcnt vmcnt(12)
    v_smfmac_f32_16x16x64_bf16 v[136:139], a[156:159], v[196:203], v29 abid:1
    buffer_load_dwordx4 a[204:207], v11, s[16:19], s43 offen offset:3072 sc1
    v_smfmac_f32_16x16x64_bf16 v[172:175], a[156:159], v[228:235], v29 abid:1
    s_waitcnt vmcnt(12)
    v_smfmac_f32_16x16x64_bf16 v[140:143], a[160:163], v[196:203], v30
    s_add_u32 s43, s43, 4096
    buffer_load_dwordx4 a[208:211], v11, s[16:19], s43 offen offset:0 sc1
    s_waitcnt lgkmcnt(5)
    v_smfmac_f32_16x16x64_bf16 v[136:139], v[240:243], v[244:251], v10
    v_smfmac_f32_16x16x64_bf16 v[172:175], v[240:243], v[244:251], v10 abid:1
    s_waitcnt lgkmcnt(4)
    v_xad_u32 v236, v236, v3, v4
    v_smfmac_f32_16x16x64_bf16 v[176:179], a[160:163], v[228:235], v30
    s_waitcnt vmcnt(12)
    v_xad_u32 v237, v237, v3, v4
    v_smfmac_f32_16x16x64_bf16 v[144:147], a[164:167], v[196:203], v30 abid:1
    buffer_load_dwordx4 a[212:215], v11, s[16:19], s43 offen offset:1024 sc1
    ds_read2st64_b32 v[244:245], v236 offset0:0 offset1:72
    ds_read2st64_b32 v[246:247], v237 offset0:0 offset1:72
    v_xad_u32 v238, v238, v3, v4
    v_smfmac_f32_16x16x64_bf16 v[180:183], a[164:167], v[228:235], v30 abid:1
    s_waitcnt vmcnt(12)
    v_xad_u32 v239, v239, v3, v4
    v_smfmac_f32_16x16x64_bf16 v[148:151], a[168:171], v[196:203], v31
    buffer_load_dwordx4 v[36:39], v11, s[16:19], s43 offen offset:2048 sc1
    buffer_load_dwordx4 a[216:219], v11, s[16:19], s43 offen offset:3072 sc1
    ds_read2st64_b32 v[248:249], v238 offset0:0 offset1:72
    ds_read2st64_b32 v[250:251], v239 offset0:0 offset1:72
    ds_read_b128 v[240:243], v8 offset:1024
    ds_read_b128 v[236:239], v9 offset:9344
    v_smfmac_f32_16x16x64_bf16 v[184:187], a[168:171], v[228:235], v31
    s_waitcnt vmcnt(13)
    v_smfmac_f32_16x16x64_bf16 v[152:155], a[172:175], v[196:203], v31 abid:1
    s_add_u32 s43, s43, 4096
    buffer_load_dwordx4 a[220:223], v11, s[16:19], s43 offen offset:0 sc1
    s_waitcnt lgkmcnt(6)
    s_cmp_lt_i32 s81, 0
    s_cbranch_scc1 M_ovr0
    s_swappc_b64 s[78:79], s[72:73]
M_ovr0:
    v_smfmac_f32_16x16x64_bf16 v[188:191], a[172:175], v[228:235], v31 abid:1
    s_waitcnt vmcnt(13)
    v_smfmac_f32_16x16x64_bf16 v[156:159], a[176:179], v[196:203], v50
    buffer_load_dwordx4 a[224:227], v11, s[16:19], s43 offen offset:1024 sc1
    v_smfmac_f32_16x16x64_bf16 v[192:195], a[176:179], v[228:235], v50
    s_waitcnt vmcnt(12)
    v_smfmac_f32_16x16x64_bf16 v[124:127], a[180:183], v[204:211], v32
    buffer_load_dwordx4 a[228:231], v11, s[16:19], s43 offen offset:2048 sc1
    s_waitcnt lgkmcnt(1)
    v_smfmac_f32_16x16x64_bf16 v[128:131], v[240:243], v[244:251], v10
    v_smfmac_f32_16x16x64_bf16 v[164:167], v[240:243], v[244:251], v10 abid:1
    s_waitcnt lgkmcnt(0)
    v_xad_u32 v236, v236, v3, v4
    v_smfmac_f32_16x16x64_bf16 v[160:163], a[180:183], v[220:227], v32
    ds_read_b128 v[196:199], v1 offset:6144
    ds_read_b128 v[200:203], v2 offset:6144
    s_waitcnt vmcnt(12)
    v_xad_u32 v237, v237, v3, v4
    v_smfmac_f32_16x16x64_bf16 v[128:131], a[184:187], v[204:211], v32 abid:1
    buffer_load_dwordx4 a[232:235], v11, s[16:19], s43 offen offset:3072 sc1
    ds_read2st64_b32 v[244:245], v236 offset0:0 offset1:72
    ds_read2st64_b32 v[246:247], v237 offset0:0 offset1:72
    v_xad_u32 v238, v238, v3, v4
    v_smfmac_f32_16x16x64_bf16 v[164:167], a[184:187], v[220:227], v32 abid:1
    ds_read_b128 v[228:231], v1 offset:24576
    ds_read_b128 v[232:235], v2 offset:24576
    s_waitcnt vmcnt(12)
    v_xad_u32 v239, v239, v3, v4
    v_smfmac_f32_16x16x64_bf16 v[132:135], a[188:191], v[204:211], v33
    s_add_u32 s43, s43, 4096
    buffer_load_dwordx4 a[236:239], v11, s[16:19], s43 offen offset:0 sc1
    ds_read2st64_b32 v[248:249], v238 offset0:0 offset1:72
    ds_read2st64_b32 v[250:251], v239 offset0:0 offset1:72
    ds_read_b128 v[240:243], v8 offset:2048
    ds_read_b128 v[236:239], v9 offset:9216
    v_smfmac_f32_16x16x64_bf16 v[168:171], a[188:191], v[220:227], v33
    s_waitcnt vmcnt(12)
    v_smfmac_f32_16x16x64_bf16 v[136:139], a[192:195], v[204:211], v33 abid:1
    buffer_load_dwordx4 a[240:243], v11, s[16:19], s43 offen offset:1024 sc1
    v_smfmac_f32_16x16x64_bf16 v[172:175], a[192:195], v[220:227], v33 abid:1
    s_waitcnt vmcnt(12)
    v_smfmac_f32_16x16x64_bf16 v[140:143], a[196:199], v[204:211], v34
    buffer_load_dwordx4 a[244:247], v11, s[16:19], s43 offen offset:2048 sc1
    v_smfmac_f32_16x16x64_bf16 v[176:179], a[196:199], v[220:227], v34
    s_waitcnt vmcnt(12)
    v_smfmac_f32_16x16x64_bf16 v[144:147], a[200:203], v[204:211], v34 abid:1
    buffer_load_dwordx4 a[248:251], v11, s[16:19], s43 offen offset:3072 sc1
    s_waitcnt lgkmcnt(1)
    v_smfmac_f32_16x16x64_bf16 v[132:135], v[240:243], v[244:251], v10
    v_smfmac_f32_16x16x64_bf16 v[168:171], v[240:243], v[244:251], v10 abid:1
    s_waitcnt lgkmcnt(0)
    v_xad_u32 v236, v236, v3, v4
    v_smfmac_f32_16x16x64_bf16 v[180:183], a[200:203], v[220:227], v34 abid:1
    s_waitcnt vmcnt(12)
    v_xad_u32 v237, v237, v3, v4
    v_smfmac_f32_16x16x64_bf16 v[148:151], a[204:207], v[204:211], v35
    s_add_u32 s43, s43, 4096
    buffer_load_dwordx4 v[40:43], v11, s[16:19], s43 offen offset:0 sc1
    buffer_load_dwordx4 a[252:255], v11, s[16:19], s43 offen offset:1024 sc1
    ds_read2st64_b32 v[244:245], v236 offset0:0 offset1:72
    ds_read2st64_b32 v[246:247], v237 offset0:0 offset1:72
    v_xad_u32 v238, v238, v3, v4
    v_smfmac_f32_16x16x64_bf16 v[184:187], a[204:207], v[220:227], v35
    s_waitcnt vmcnt(13)
    v_xad_u32 v239, v239, v3, v4
    v_smfmac_f32_16x16x64_bf16 v[152:155], a[208:211], v[204:211], v35 abid:1
    buffer_load_dwordx4 v[56:59], v11, s[16:19], s43 offen offset:2048 sc1
    ds_read2st64_b32 v[248:249], v238 offset0:0 offset1:72
    ds_read2st64_b32 v[250:251], v239 offset0:0 offset1:72
    ds_read_b128 v[240:243], v8 offset:0
    ds_read_b128 v[236:239], v9 offset:9728
    v_smfmac_f32_16x16x64_bf16 v[188:191], a[208:211], v[220:227], v35 abid:1
    s_waitcnt vmcnt(13)
    v_smfmac_f32_16x16x64_bf16 v[156:159], a[212:215], v[204:211], v50 abid:1
    buffer_load_dwordx4 v[60:63], v11, s[16:19], s43 offen offset:3072 sc1
    v_smfmac_f32_16x16x64_bf16 v[192:195], a[212:215], v[220:227], v50 abid:1
    s_waitcnt vmcnt(12)
    v_smfmac_f32_16x16x64_bf16 v[124:127], a[216:219], v[196:203], v36
    s_add_u32 s43, s43, 4096
    buffer_load_dwordx4 v[64:67], v11, s[16:19], s43 offen offset:0 sc1
    v_smfmac_f32_16x16x64_bf16 v[160:163], a[216:219], v[228:235], v36
    ds_read_b128 v[204:207], v1 offset:7168
    ds_read_b128 v[208:211], v2 offset:7168
    s_waitcnt vmcnt(12)
    v_smfmac_f32_16x16x64_bf16 v[128:131], a[220:223], v[196:203], v36 abid:1
    buffer_load_dwordx4 v[68:71], v11, s[16:19], s43 offen offset:1024 sc1
    s_waitcnt lgkmcnt(3)
    v_smfmac_f32_16x16x64_bf16 v[124:127], v[240:243], v[244:251], v10
    v_smfmac_f32_16x16x64_bf16 v[160:163], v[240:243], v[244:251], v10 abid:1
    s_waitcnt lgkmcnt(2)
    v_xad_u32 v236, v236, v3, v4
    v_smfmac_f32_16x16x64_bf16 v[164:167], a[220:223], v[228:235], v36 abid:1
    ds_read_b128 v[220:223], v1 offset:25600
    ds_read_b128 v[224:227], v2 offset:25600
    s_waitcnt vmcnt(12)
    v_xad_u32 v237, v237, v3, v4
    v_smfmac_f32_16x16x64_bf16 v[132:135], a[224:227], v[196:203], v37
    buffer_load_dwordx4 v[72:75], v11, s[16:19], s43 offen offset:2048 sc1
    ds_read2st64_b32 v[244:245], v236 offset0:0 offset1:72
    ds_read2st64_b32 v[246:247], v237 offset0:0 offset1:72
    v_xad_u32 v238, v238, v3, v4
    v_smfmac_f32_16x16x64_bf16 v[168:171], a[224:227], v[228:235], v37
    s_waitcnt vmcnt(12)
    v_xad_u32 v239, v239, v3, v4
    v_smfmac_f32_16x16x64_bf16 v[136:139], a[228:231], v[196:203], v37 abid:1
    buffer_load_dwordx4 v[76:79], v11, s[16:19], s43 offen offset:3072 sc1
    ds_read2st64_b32 v[248:249], v238 offset0:0 offset1:72
    ds_read2st64_b32 v[250:251], v239 offset0:0 offset1:72
    ds_read_b128 v[240:243], v8 offset:8192
    ds_read_b128 v[236:239], v9 offset:9664
    v_smfmac_f32_16x16x64_bf16 v[172:175], a[228:231], v[228:235], v37 abid:1
    s_waitcnt vmcnt(12)
    v_smfmac_f32_16x16x64_bf16 v[140:143], a[232:235], v[196:203], v38
    s_add_u32 s43, s43, 4096
    buffer_load_dwordx4 v[80:83], v11, s[16:19], s43 offen offset:0 sc1
    v_smfmac_f32_16x16x64_bf16 v[176:179], a[232:235], v[228:235], v38
    s_waitcnt vmcnt(12)
    v_smfmac_f32_16x16x64_bf16 v[144:147], a[236:239], v[196:203], v38 abid:1
    buffer_load_dwordx4 v[84:87], v11, s[16:19], s43 offen offset:1024 sc1
    v_smfmac_f32_16x16x64_bf16 v[180:183], a[236:239], v[228:235], v38 abid:1
    s_waitcnt vmcnt(12)
    v_smfmac_f32_16x16x64_bf16 v[148:151], a[240:243], v[196:203], v39
    buffer_load_dwordx4 v[44:47], v11, s[16:19], s43 offen offset:2048 sc1
    buffer_load_dwordx4 v[88:91], v11, s[16:19], s43 offen offset:3072 sc1
    s_waitcnt lgkmcnt(1)
    v_smfmac_f32_16x16x64_bf16 v[156:159], v[240:243], v[244:251], v10
    v_smfmac_f32_16x16x64_bf16 v[192:195], v[240:243], v[244:251], v10 abid:1
    s_waitcnt lgkmcnt(0)
    v_xad_u32 v236, v236, v3, v4
    v_smfmac_f32_16x16x64_bf16 v[184:187], a[240:243], v[228:235], v39
    s_waitcnt vmcnt(13)
    v_xad_u32 v237, v237, v3, v4
    v_smfmac_f32_16x16x64_bf16 v[152:155], a[244:247], v[196:203], v39 abid:1
    s_add_u32 s43, s43, 4096
    buffer_load_dwordx4 v[92:95], v11, s[16:19], s43 offen offset:0 sc1
    ds_read2st64_b32 v[244:245], v236 offset0:0 offset1:72
    ds_read2st64_b32 v[246:247], v237 offset0:0 offset1:72
    v_xad_u32 v238, v238, v3, v4
    v_smfmac_f32_16x16x64_bf16 v[188:191], a[244:247], v[228:235], v39 abid:1
    s_waitcnt vmcnt(13)
    v_xad_u32 v239, v239, v3, v4
    v_smfmac_f32_16x16x64_bf16 v[156:159], a[248:251], v[196:203], v51
    buffer_load_dwordx4 v[96:99], v11, s[16:19], s43 offen offset:1024 sc1
    ds_read2st64_b32 v[248:249], v238 offset0:0 offset1:72
    ds_read2st64_b32 v[250:251], v239 offset0:0 offset1:72
    ds_read_b128 v[240:243], v8 offset:7168
    ds_read_b128 v[236:239], v9 offset:9536
    v_smfmac_f32_16x16x64_bf16 v[192:195], a[248:251], v[228:235], v51
    s_waitcnt vmcnt(12)
    v_smfmac_f32_16x16x64_bf16 v[124:127], a[252:255], v[204:211], v40
    buffer_load_dwordx4 v[100:103], v11, s[16:19], s43 offen offset:2048 sc1
    ds_read_b128 v[196:199], v1 offset:8192
    ds_read_b128 v[200:203], v2 offset:8192
    s_waitcnt vmcnt(12)
    v_smfmac_f32_16x16x64_bf16 v[128:131], v[56:59], v[204:211], v40 abid:1
    buffer_load_dwordx4 v[104:107], v11, s[16:19], s43 offen offset:3072 sc1
    ds_read_b128 v[228:231], v1 offset:26624
    ds_read_b128 v[232:235], v2 offset:26624
    s_waitcnt vmcnt(12)
    v_smfmac_f32_16x16x64_bf16 v[132:135], v[60:63], v[204:211], v41
    s_add_u32 s43, s43, 4096
    buffer_load_dwordx4 v[108:111], v11, s[16:19], s43 offen offset:0 sc1
    s_waitcnt lgkmcnt(5)
    v_smfmac_f32_16x16x64_bf16 v[152:155], v[240:243], v[244:251], v10
    v_smfmac_f32_16x16x64_bf16 v[188:191], v[240:243], v[244:251], v10 abid:1
    s_waitcnt lgkmcnt(4)
    v_xad_u32 v236, v236, v3, v4
    s_waitcnt vmcnt(12)
    v_xad_u32 v237, v237, v3, v4
    v_smfmac_f32_16x16x64_bf16 v[136:139], v[64:67], v[204:211], v41 abid:1
    buffer_load_dwordx4 v[112:115], v11, s[16:19], s43 offen offset:1024 sc1
    ds_read2st64_b32 v[244:245], v236 offset0:0 offset1:72
    ds_read2st64_b32 v[246:247], v237 offset0:0 offset1:72
    v_xad_u32 v238, v238, v3, v4
    s_waitcnt vmcnt(12)
    v_xad_u32 v239, v239, v3, v4
    v_smfmac_f32_16x16x64_bf16 v[140:143], v[68:71], v[204:211], v42
    buffer_load_dwordx4 v[116:119], v11, s[16:19], s43 offen offset:2048 sc1
    ds_read2st64_b32 v[248:249], v238 offset0:0 offset1:72
    ds_read2st64_b32 v[250:251], v239 offset0:0 offset1:72
    ds_read_b128 v[240:243], v8 offset:5120
    ds_read_b128 v[236:239], v9 offset:9600
    s_waitcnt vmcnt(12)
    v_smfmac_f32_16x16x64_bf16 v[144:147], v[72:75], v[204:211], v42 abid:1
    buffer_load_dwordx4 v[120:123], v11, s[16:19], s43 offen offset:3072 sc1
    s_waitcnt vmcnt(12)
    v_smfmac_f32_16x16x64_bf16 v[148:151], v[76:79], v[204:211], v43
    s_add_u32 m0, s29, 11840
    s_nop 0
    buffer_load_dword v0, s[8:11], 0 offen lds
    s_mov_b32 m0, s42
    s_nop 0
    buffer_load_dwordx4 v5, s[8:11], s22 offen offset:0 nt lds
    s_waitcnt vmcnt(13)
    v_smfmac_f32_16x16x64_bf16 v[152:155], v[80:83], v[204:211], v43 abid:1
    s_add_u32 m0, m0, 896
    s_nop 0
    buffer_load_dwordx4 v5, s[8:11], s22 offen offset:128 nt lds
    s_waitcnt lgkmcnt(1)
    v_smfmac_f32_16x16x64_bf16 v[144:147], v[240:243], v[244:251], v10
    v_smfmac_f32_16x16x64_bf16 v[180:183], v[240:243], v[244:251], v10 abid:1
    s_waitcnt lgkmcnt(0)
    v_xad_u32 v236, v236, v3, v4
    s_waitcnt vmcnt(13)
    v_xad_u32 v237, v237, v3, v4
    v_smfmac_f32_16x16x64_bf16 v[156:159], v[84:87], v[204:211], v51 abid:1
    s_add_u32 m0, m0, 896
    s_nop 0
    buffer_load_dwordx4 v5, s[8:11], s22 offen offset:256 nt lds
    ds_read2st64_b32 v[244:245], v236 offset0:0 offset1:72
    ds_read2st64_b32 v[246:247], v237 offset0:0 offset1:72
    v_xad_u32 v238, v238, v3, v4
    s_waitcnt vmcnt(12)
    v_xad_u32 v239, v239, v3, v4
    v_smfmac_f32_16x16x64_bf16 v[124:127], v[88:91], v[196:203], v44
    s_add_u32 m0, m0, 896
    s_nop 0
    buffer_load_dwordx4 v5, s[8:11], s22 offen offset:384 nt lds
    ds_read2st64_b32 v[248:249], v238 offset0:0 offset1:72
    ds_read2st64_b32 v[250:251], v239 offset0:0 offset1:72
    ds_read_b128 v[240:243], v8 offset:6144
    ds_read_b128 v[236:239], v9 offset:9472
    s_waitcnt vmcnt(12)
    v_smfmac_f32_16x16x64_bf16 v[128:131], v[92:95], v[196:203], v44 abid:1
    s_waitcnt vmcnt(11)
    v_smfmac_f32_16x16x64_bf16 v[132:135], v[96:99], v[196:203], v45
    s_waitcnt vmcnt(10)
    v_smfmac_f32_16x16x64_bf16 v[136:139], v[100:103], v[196:203], v45 abid:1
    s_waitcnt lgkmcnt(1)
    v_smfmac_f32_16x16x64_bf16 v[148:151], v[240:243], v[244:251], v10
    v_smfmac_f32_16x16x64_bf16 v[184:187], v[240:243], v[244:251], v10 abid:1
    s_waitcnt lgkmcnt(0)
    v_xad_u32 v236, v236, v3, v4
    s_waitcnt vmcnt(9)
    v_xad_u32 v237, v237, v3, v4
    v_smfmac_f32_16x16x64_bf16 v[140:143], v[104:107], v[196:203], v46
    ds_read2st64_b32 v[244:245], v236 offset0:0 offset1:72
    ds_read2st64_b32 v[246:247], v237 offset0:0 offset1:72
    v_xad_u32 v238, v238, v3, v4
    s_waitcnt vmcnt(8)
    v_xad_u32 v239, v239, v3, v4
    v_smfmac_f32_16x16x64_bf16 v[144:147], v[108:111], v[196:203], v46 abid:1
    ds_read2st64_b32 v[248:249], v238 offset0:0 offset1:72
    ds_read2st64_b32 v[250:251], v239 offset0:0 offset1:72
    ds_read_b128 v[240:243], v8 offset:4096
    s_waitcnt vmcnt(7)
    v_smfmac_f32_16x16x64_bf16 v[148:151], v[112:115], v[196:203], v47
    s_waitcnt vmcnt(6)
    v_smfmac_f32_16x16x64_bf16 v[152:155], v[116:119], v[196:203], v47 abid:1
    s_waitcnt vmcnt(5)
    v_smfmac_f32_16x16x64_bf16 v[156:159], v[120:123], v[196:203], v52
    s_waitcnt lgkmcnt(0)
    v_smfmac_f32_16x16x64_bf16 v[140:143], v[240:243], v[244:251], v10
    v_smfmac_f32_16x16x64_bf16 v[176:179], v[240:243], v[244:251], v10 abid:1
    s_cmp_gt_u32 s46, s80
    s_cbranch_scc1 M_slow
M_slowr0:
    s_cmp_eq_u32 s20, 0
    s_mov_b32 s31, 1073903880
    s_cselect_b32 s30, 162048, s31
    v_mov_b32 v11, s31
    v_writelane_b32 v11, s30, 0
    v_cvt_pk_bf16_f32 v124, v124, v125
    v_cvt_pk_bf16_f32 v125, v126, v127
    v_cvt_pk_bf16_f32 v126, v128, v129
    v_cvt_pk_bf16_f32 v127, v130, v131
    v_cvt_pk_bf16_f32 v132, v132, v133
    v_cvt_pk_bf16_f32 v133, v134, v135
    v_cvt_pk_bf16_f32 v134, v136, v137
    v_cvt_pk_bf16_f32 v135, v138, v139
    ds_read_b128 v[136:139], v9 offset:10432
    v_cndmask_b32_dpp v128, v124, v132, vcc row_ror:8 row_mask:0xf bank_mask:0xf
    v_cndmask_b32_dpp v129, v125, v133, vcc row_ror:8 row_mask:0xf bank_mask:0xf
    v_cndmask_b32_dpp v130, v126, v134, vcc row_ror:8 row_mask:0xf bank_mask:0xf
    v_cndmask_b32_dpp v131, v127, v135, vcc row_ror:8 row_mask:0xf bank_mask:0xf
    buffer_store_dwordx4 v[128:131], v6, s[12:15], s59 offen offset:0 sc1
    v_mov_b32_dpp v124, v132 row_ror:8 row_mask:0xf bank_mask:0xc
    v_mov_b32_dpp v125, v133 row_ror:8 row_mask:0xf bank_mask:0xc
    v_mov_b32_dpp v126, v134 row_ror:8 row_mask:0xf bank_mask:0xc
    v_mov_b32_dpp v127, v135 row_ror:8 row_mask:0xf bank_mask:0xc
    buffer_store_dwordx4 v[124:127], v6, s[12:15], s24 offen offset:0 sc1
    ds_read_b128 v[128:131], v9 offset:10304
    ds_read_b128 v[132:135], v9 offset:10368
    ds_read_b128 v[124:127], v9 offset:10240
    v_cvt_pk_bf16_f32 v140, v140, v141
    v_cvt_pk_bf16_f32 v141, v142, v143
    v_cvt_pk_bf16_f32 v142, v144, v145
    v_cvt_pk_bf16_f32 v143, v146, v147
    v_cvt_pk_bf16_f32 v148, v148, v149
    v_cvt_pk_bf16_f32 v149, v150, v151
    v_cvt_pk_bf16_f32 v150, v152, v153
    v_cvt_pk_bf16_f32 v151, v154, v155
    ds_read_b128 v[152:155], v9 offset:10688
    v_cndmask_b32_dpp v144, v140, v148, vcc row_ror:8 row_mask:0xf bank_mask:0xf
    v_cndmask_b32_dpp v145, v141, v149, vcc row_ror:8 row_mask:0xf bank_mask:0xf
    v_cndmask_b32_dpp v146, v142, v150, vcc row_ror:8 row_mask:0xf bank_mask:0xf
    v_cndmask_b32_dpp v147, v143, v151, vcc row_ror:8 row_mask:0xf bank_mask:0xf
    buffer_store_dwordx4 v[144:147], v6, s[12:15], s59 offen offset:128 sc1
    v_mov_b32_dpp v140, v148 row_ror:8 row_mask:0xf bank_mask:0xc
    v_mov_b32_dpp v141, v149 row_ror:8 row_mask:0xf bank_mask:0xc
    v_mov_b32_dpp v142, v150 row_ror:8 row_mask:0xf bank_mask:0xc
    v_mov_b32_dpp v143, v151 row_ror:8 row_mask:0xf bank_mask:0xc
    buffer_store_dwordx4 v[140:143], v6, s[12:15], s24 offen offset:128 sc1
    ds_read_b128 v[144:147], v9 offset:10560
    ds_read_b128 v[148:151], v9 offset:10624
    ds_read_b128 v[140:143], v9 offset:10496
    v_cvt_pk_bf16_f32 v156, v156, v157
    v_cvt_pk_bf16_f32 v157, v158, v159
    ds_write_b64 v53, v[156:157] offset:25728
    ds_read_b128 v[156:159], v9 offset:10752
    s_mov_b32 s89, 0
    s_mov_b32 s101, 34209792
    s_mov_b32 s91, 0
    s_mov_b32 s25, 36864
    s_add_u32 s90, s24, 9437184
    s_mov_b32 s28, s26
    s_add_u32 s23, s24, 18432
    s_cmp_lt_u32 s20, 2
    s_cselect_b32 s66, s23, s24
    s_cselect_b32 s99, s14, 75497472
    s_add_u32 s66, s66, s95
    v_add_u32 v4, 36864, v4
    v_add_u32 v1, 36864, v1
    v_add_u32 v2, 36864, v2
M_top:
M_top1:
    s_add_u32 s23, s24, 18432
    s_add_u32 s58, s24, 27648
    s_mov_b32 s24, s90
    s_add_u32 s59, s90, 9216
    s_waitcnt lgkmcnt(0)
    s_barrier
    ds_read_b128 v[244:247], v8 offset:10816
    v_smfmac_f32_16x16x64_bf16 v[160:163], a[252:255], v[220:227], v40
    ds_read_b128 v[196:199], v1 offset:0
    v_smfmac_f32_16x16x64_bf16 v[160:163], v[88:91], v[228:235], v44
    ds_read_b128 v[200:203], v2 offset:0
    s_cmp_lt_u32 s22, 75497472
    s_cbranch_scc0 M_bF
    s_cmp_lt_u32 s91, 2
    s_cbranch_scc1 M_bE0
M_bL:
    v_smfmac_f32_16x16x64_bf16 v[164:167], v[56:59], v[220:227], v40 abid:1
    ds_read_b128 v[204:207], v1 offset:1024
    v_smfmac_f32_16x16x64_bf16 v[164:167], v[92:95], v[228:235], v44 abid:1
    ds_read_b128 v[208:211], v2 offset:1024
    v_mov_b32 v0, 1
    v_smfmac_f32_16x16x64_bf16 v[168:171], v[60:63], v[220:227], v41
    ds_read_b128 v[212:215], v1 offset:2048
    v_smfmac_f32_16x16x64_bf16 v[168:171], v[96:99], v[228:235], v45
    ds_read_b128 v[216:219], v2 offset:2048
    v_smfmac_f32_16x16x64_bf16 v[172:175], v[64:67], v[220:227], v41 abid:1
    s_waitcnt vmcnt(6)
    s_waitcnt lgkmcnt(6)
    buffer_store_dwordx4 v[244:247], v7, s[12:15], s66 offen sc1
    v_smfmac_f32_16x16x64_bf16 v[172:175], v[100:103], v[228:235], v45 abid:1
    ds_read_b128 v[236:239], v9 offset:9408
    v_smfmac_f32_16x16x64_bf16 v[176:179], v[68:71], v[220:227], v42
    s_waitcnt vmcnt(6)
    buffer_atomic_add v0, v11, s[16:19], s92 offen sc0 sc1
    s_mov_b32 s21, 1
    v_smfmac_f32_16x16x64_bf16 v[176:179], v[104:107], v[228:235], v46
    v_smfmac_f32_16x16x64_bf16 v[180:183], v[72:75], v[220:227], v42 abid:1
    v_cvt_pk_bf16_f32 v160, v160, v161
    v_smfmac_f32_16x16x64_bf16 v[180:183], v[108:111], v[228:235], v46 abid:1
    v_cvt_pk_bf16_f32 v161, v162, v163
    v_smfmac_f32_16x16x64_bf16 v[184:187], v[76:79], v[220:227], v43
    v_cvt_pk_bf16_f32 v162, v164, v165
    v_smfmac_f32_16x16x64_bf16 v[184:187], v[112:115], v[228:235], v47
    v_cvt_pk_bf16_f32 v163, v166, v167
    v_smfmac_f32_16x16x64_bf16 v[188:191], v[80:83], v[220:227], v43 abid:1
    s_add_u32 m0, m0, 896
    v_cvt_pk_bf16_f32 v168, v168, v169
    v_smfmac_f32_16x16x64_bf16 v[188:191], v[116:119], v[228:235], v47 abid:1
    s_waitcnt vmcnt(6)
    buffer_load_dwordx4 v5, s[8:11], s22 offen offset:512 nt lds
    v_cvt_pk_bf16_f32 v169, v170, v171
    v_smfmac_f32_16x16x64_bf16 v[192:195], v[84:87], v[220:227], v51 abid:1
    v_cvt_pk_bf16_f32 v170, v172, v173
    v_smfmac_f32_16x16x64_bf16 v[192:195], v[120:123], v[228:235], v52
    ds_read_b128 v[220:223], v1 offset:3072
    s_waitcnt lgkmcnt(6)
    v_cvt_pk_bf16_f32 v171, v174, v175
    v_smfmac_f32_16x16x64_bf16 v[124:127], a[0:3], v[196:203], v12
    ds_read_b128 v[224:227], v2 offset:3072
    ds_read_b128 v[172:175], v9 offset:10432
    s_waitcnt lgkmcnt(6)
    v_cndmask_b32_dpp v164, v160, v168, vcc row_ror:8 row_mask:0xf bank_mask:0xf
    v_smfmac_f32_16x16x64_bf16 v[124:127], a[36:39], v[204:211], v16
    ds_read_b128 v[228:231], v1 offset:4096
    s_waitcnt lgkmcnt(5)
    v_cndmask_b32_dpp v165, v161, v169, vcc row_ror:8 row_mask:0xf bank_mask:0xf
    v_smfmac_f32_16x16x64_bf16 v[124:127], a[72:75], v[212:219], v20
    ds_read_b128 v[232:235], v2 offset:4096
    v_cndmask_b32_dpp v166, v162, v170, vcc row_ror:8 row_mask:0xf bank_mask:0xf
    v_smfmac_f32_16x16x64_bf16 v[128:131], a[4:7], v[196:203], v12 abid:1
    s_barrier
    v_cndmask_b32_dpp v167, v163, v171, vcc row_ror:8 row_mask:0xf bank_mask:0xf
    v_smfmac_f32_16x16x64_bf16 v[128:131], a[40:43], v[204:211], v16 abid:1
    s_waitcnt vmcnt(6)
    buffer_store_dwordx4 v[164:167], v6, s[12:15], s58 offen offset:0 sc1
    s_waitcnt lgkmcnt(5)
    v_xad_u32 v236, v236, v3, v4
    v_smfmac_f32_16x16x64_bf16 v[128:131], a[76:79], v[212:219], v20 abid:1
    v_xad_u32 v237, v237, v3, v4
    v_smfmac_f32_16x16x64_bf16 v[132:135], a[8:11], v[196:203], v13
    ds_read2st64_b32 v[244:245], v236 offset0:0 offset1:72
    ds_read_b128 v[240:243], v8 offset:3072
    v_xad_u32 v238, v238, v3, v4
    v_smfmac_f32_16x16x64_bf16 v[132:135], a[44:47], v[204:211], v17
    ds_read2st64_b32 v[246:247], v237 offset0:0 offset1:72
    v_xad_u32 v239, v239, v3, v4
    v_smfmac_f32_16x16x64_bf16 v[132:135], a[80:83], v[212:219], v21
    ds_read2st64_b32 v[248:249], v238 offset0:0 offset1:72
    v_mov_b32_dpp v160, v168 row_ror:8 row_mask:0xf bank_mask:0xc
    v_smfmac_f32_16x16x64_bf16 v[144:147], a[20:23], v[196:203], v14 abid:1
    ds_read2st64_b32 v[250:251], v239 offset0:0 offset1:72
    ds_read_b128 v[236:239], v9 offset:9280
    v_mov_b32_dpp v161, v169 row_ror:8 row_mask:0xf bank_mask:0xc
    v_smfmac_f32_16x16x64_bf16 v[144:147], a[56:59], v[204:211], v18 abid:1
    v_mov_b32_dpp v162, v170 row_ror:8 row_mask:0xf bank_mask:0xc
    v_smfmac_f32_16x16x64_bf16 v[144:147], a[92:95], v[212:219], v22 abid:1
    v_mov_b32_dpp v163, v171 row_ror:8 row_mask:0xf bank_mask:0xc
    v_smfmac_f32_16x16x64_bf16 v[140:143], a[16:19], v[196:203], v14
    s_waitcnt vmcnt(6)
    buffer_store_dwordx4 v[160:163], v6, s[12:15], s23 offen offset:0 sc1
    ds_read_b128 v[164:167], v9 offset:10304
    v_smfmac_f32_16x16x64_bf16 v[140:143], a[52:55], v[204:211], v18
    ds_read_b128 v[168:171], v9 offset:10368
    ds_read_b128 v[160:163], v9 offset:10240
    v_smfmac_f32_16x16x64_bf16 v[140:143], a[88:91], v[212:219], v22
    v_smfmac_f32_16x16x64_bf16 v[136:139], a[12:15], v[196:203], v13 abid:1
    v_smfmac_f32_16x16x64_bf16 v[136:139], a[48:51], v[204:211], v17 abid:1
    v_smfmac_f32_16x16x64_bf16 v[136:139], a[84:87], v[212:219], v21 abid:1
    s_waitcnt lgkmcnt(3)
    v_xad_u32 v236, v236, v3, v4
    v_smfmac_f32_16x16x64_bf16 v[136:139], v[240:243], v[244:251], v10
    v_xad_u32 v237, v237, v3, v4
    v_smfmac_f32_16x16x64_bf16 v[172:175], v[240:243], v[244:251], v10 abid:1
    ds_read2st64_b32 v[244:245], v236 offset0:0 offset1:72
    ds_read_b128 v[240:243], v8 offset:1024
    v_xad_u32 v238, v238, v3, v4
    v_smfmac_f32_16x16x64_bf16 v[148:151], a[24:27], v[196:203], v15
    ds_read2st64_b32 v[246:247], v237 offset0:0 offset1:72
    v_xad_u32 v239, v239, v3, v4
    v_smfmac_f32_16x16x64_bf16 v[148:151], a[60:63], v[204:211], v19
    ds_read2st64_b32 v[248:249], v238 offset0:0 offset1:72
    v_cvt_pk_bf16_f32 v192, v192, v193
    v_smfmac_f32_16x16x64_bf16 v[148:151], a[96:99], v[212:219], v23
    ds_read2st64_b32 v[250:251], v239 offset0:0 offset1:72
    ds_read_b128 v[236:239], v9 offset:9344
    v_cvt_pk_bf16_f32 v193, v194, v195
    v_smfmac_f32_16x16x64_bf16 v[152:155], a[28:31], v[196:203], v15 abid:1
    ds_write_b64 v53, v[192:193] offset:0
    ds_read_b128 v[192:195], v9 offset:10752
    v_smfmac_f32_16x16x64_bf16 v[152:155], a[64:67], v[204:211], v19 abid:1
    s_add_u32 m0, m0, 896
    v_smfmac_f32_16x16x64_bf16 v[152:155], a[100:103], v[212:219], v23 abid:1
    s_waitcnt vmcnt(6)
    buffer_load_dwordx4 v5, s[8:11], s22 offen offset:640 nt lds
    v_smfmac_f32_16x16x64_bf16 v[156:159], a[32:35], v[196:203], v48
    v_smfmac_f32_16x16x64_bf16 v[156:159], a[68:71], v[204:211], v48 abid:1
    v_smfmac_f32_16x16x64_bf16 v[156:159], a[104:107], v[212:219], v49
    ds_read_b128 v[196:199], v1 offset:5120
    v_cvt_pk_bf16_f32 v176, v176, v177
    v_smfmac_f32_16x16x64_bf16 v[124:127], a[108:111], v[220:227], v24
    ds_read_b128 v[200:203], v2 offset:5120
    v_cvt_pk_bf16_f32 v177, v178, v179
    v_smfmac_f32_16x16x64_bf16 v[124:127], a[144:147], v[228:235], v28
    ds_read_b128 v[204:207], v1 offset:6144
    ds_read_b64 v[216:217], v9 offset:10056
    v_cvt_pk_bf16_f32 v178, v180, v181
    v_smfmac_f32_16x16x64_bf16 v[128:131], a[112:115], v[220:227], v24 abid:1
    ds_read_b128 v[208:211], v2 offset:6144
    v_cvt_pk_bf16_f32 v179, v182, v183
    v_smfmac_f32_16x16x64_bf16 v[128:131], a[148:151], v[228:235], v28 abid:1
    s_waitcnt lgkmcnt(7)
    v_xad_u32 v236, v236, v3, v4
    v_smfmac_f32_16x16x64_bf16 v[128:131], v[240:243], v[244:251], v10
    s_add_u32 m0, m0, 896
    v_xad_u32 v237, v237, v3, v4
    v_smfmac_f32_16x16x64_bf16 v[164:167], v[240:243], v[244:251], v10 abid:1
    ds_read2st64_b32 v[244:245], v236 offset0:0 offset1:72
    ds_read_b128 v[240:243], v8 offset:2048
    v_xad_u32 v238, v238, v3, v4
    v_smfmac_f32_16x16x64_bf16 v[152:155], a[136:139], v[220:227], v27 abid:1
    ds_read2st64_b32 v[246:247], v237 offset0:0 offset1:72
    s_waitcnt vmcnt(6)
    v_xad_u32 v239, v239, v3, v4
    v_smfmac_f32_16x16x64_bf16 v[152:155], a[172:175], v[228:235], v31 abid:1
    ds_read2st64_b32 v[248:249], v238 offset0:0 offset1:72
    buffer_load_dwordx4 v5, s[8:11], s22 offen offset:768 nt lds
    v_cvt_pk_bf16_f32 v184, v184, v185
    v_smfmac_f32_16x16x64_bf16 v[136:139], a[120:123], v[220:227], v25 abid:1
    ds_read2st64_b32 v[250:251], v239 offset0:0 offset1:72
    ds_read_b128 v[236:239], v9 offset:9216
    v_cvt_pk_bf16_f32 v185, v186, v187
    v_smfmac_f32_16x16x64_bf16 v[136:139], a[156:159], v[228:235], v29 abid:1
    v_cvt_pk_bf16_f32 v186, v188, v189
    v_smfmac_f32_16x16x64_bf16 v[140:143], a[124:127], v[220:227], v26
    v_cvt_pk_bf16_f32 v187, v190, v191
    v_smfmac_f32_16x16x64_bf16 v[140:143], a[160:163], v[228:235], v30
    ds_read_b128 v[188:191], v9 offset:10688
    v_cndmask_b32_dpp v180, v176, v184, vcc row_ror:8 row_mask:0xf bank_mask:0xf
    v_smfmac_f32_16x16x64_bf16 v[144:147], a[128:131], v[220:227], v26 abid:1
    v_cndmask_b32_dpp v181, v177, v185, vcc row_ror:8 row_mask:0xf bank_mask:0xf
    v_smfmac_f32_16x16x64_bf16 v[144:147], a[164:167], v[228:235], v30 abid:1
    v_cndmask_b32_dpp v182, v178, v186, vcc row_ror:8 row_mask:0xf bank_mask:0xf
    v_smfmac_f32_16x16x64_bf16 v[148:151], a[132:135], v[220:227], v27
    v_cndmask_b32_dpp v183, v179, v187, vcc row_ror:8 row_mask:0xf bank_mask:0xf
    v_smfmac_f32_16x16x64_bf16 v[148:151], a[168:171], v[228:235], v31
    s_waitcnt vmcnt(6)
    buffer_store_dwordx4 v[180:183], v6, s[12:15], s58 offen offset:128 sc1
    s_waitcnt lgkmcnt(8)
    v_xad_u32 v212, v216, v3, v4
    v_smfmac_f32_16x16x64_bf16 v[132:135], a[116:119], v[220:227], v25
    ds_read2st64_b32 v[212:213], v212 offset0:0 offset1:72
    v_xad_u32 v214, v217, v3, v4
    v_smfmac_f32_16x16x64_bf16 v[132:135], a[152:155], v[228:235], v29
    ds_read2st64_b32 v[214:215], v214 offset0:0 offset1:72
    s_waitcnt lgkmcnt(3)
    v_xad_u32 v236, v236, v3, v4
    v_smfmac_f32_16x16x64_bf16 v[132:135], v[240:243], v[244:251], v10
    v_xad_u32 v237, v237, v3, v4
    v_smfmac_f32_16x16x64_bf16 v[168:171], v[240:243], v[244:251], v10 abid:1
    ds_read2st64_b32 v[244:245], v236 offset0:0 offset1:72
    ds_read_b128 v[240:243], v8 offset:0
    v_xad_u32 v238, v238, v3, v4
    v_smfmac_f32_16x16x64_bf16 v[156:159], a[140:143], v[220:227], v49 abid:1
    ds_read2st64_b32 v[246:247], v237 offset0:0 offset1:72
    v_xad_u32 v239, v239, v3, v4
    v_smfmac_f32_16x16x64_bf16 v[156:159], a[176:179], v[228:235], v50
    ds_read2st64_b32 v[248:249], v238 offset0:0 offset1:72
    ds_read_b128 v[220:223], v1 offset:7168
    v_mov_b32_dpp v176, v184 row_ror:8 row_mask:0xf bank_mask:0xc
    v_smfmac_f32_16x16x64_bf16 v[140:143], a[196:199], v[196:203], v34
    ds_read2st64_b32 v[250:251], v239 offset0:0 offset1:72
    ds_read_b128 v[236:239], v9 offset:9728
    v_mov_b32_dpp v177, v185 row_ror:8 row_mask:0xf bank_mask:0xc
    v_smfmac_f32_16x16x64_bf16 v[140:143], a[232:235], v[204:211], v38
    ds_read_b128 v[224:227], v2 offset:7168
    v_mov_b32_dpp v178, v186 row_ror:8 row_mask:0xf bank_mask:0xc
    v_smfmac_f32_16x16x64_bf16 v[128:131], a[184:187], v[196:203], v32 abid:1
    ds_read_b128 v[228:231], v1 offset:8192
    v_mov_b32_dpp v179, v187 row_ror:8 row_mask:0xf bank_mask:0xc
    v_smfmac_f32_16x16x64_bf16 v[128:131], a[220:223], v[204:211], v36 abid:1
    ds_read_b128 v[232:235], v2 offset:8192
    s_waitcnt vmcnt(6)
    buffer_store_dwordx4 v[176:179], v6, s[12:15], s23 offen offset:128 sc1
    v_smfmac_f32_16x16x64_bf16 v[132:135], a[188:191], v[196:203], v33
    ds_read_b128 v[180:183], v9 offset:10560
    ds_read_b128 v[184:187], v9 offset:10624
    ds_read_b128 v[176:179], v9 offset:10496
    v_smfmac_f32_16x16x64_bf16 v[132:135], a[224:227], v[204:211], v37
    v_smfmac_f32_16x16x64_bf16 v[136:139], a[192:195], v[196:203], v33 abid:1
    v_smfmac_f32_16x16x64_bf16 v[136:139], a[228:231], v[204:211], v37 abid:1
    v_smfmac_f32_16x16x64_bf16 v[124:127], a[180:183], v[196:203], v32
    v_smfmac_f32_16x16x64_bf16 v[124:127], a[216:219], v[204:211], v36
    s_waitcnt vmcnt(7)
    s_waitcnt lgkmcnt(6)
    v_xad_u32 v236, v236, v3, v4
    v_smfmac_f32_16x16x64_bf16 v[124:127], v[240:243], v[244:251], v10
    v_xad_u32 v237, v237, v3, v4
    v_smfmac_f32_16x16x64_bf16 v[160:163], v[240:243], v[244:251], v10 abid:1
    ds_read2st64_b32 v[244:245], v236 offset0:0 offset1:72
    ds_read_b128 v[240:243], v8 offset:8192
    v_xad_u32 v238, v238, v3, v4
    v_smfmac_f32_16x16x64_bf16 v[144:147], a[200:203], v[196:203], v34 abid:1
    ds_read2st64_b32 v[246:247], v237 offset0:0 offset1:72
    v_xad_u32 v239, v239, v3, v4
    v_smfmac_f32_16x16x64_bf16 v[144:147], a[236:239], v[204:211], v38 abid:1
    ds_read2st64_b32 v[248:249], v238 offset0:0 offset1:72
    v_mul_u32_u24 v0, s94, v0
    v_smfmac_f32_16x16x64_bf16 v[148:151], a[204:207], v[196:203], v35
    ds_read2st64_b32 v[250:251], v239 offset0:0 offset1:72
    ds_read_b128 v[236:239], v9 offset:9664
    v_add_u32 v0, s93, v0
    v_smfmac_f32_16x16x64_bf16 v[148:151], a[240:243], v[204:211], v39
    s_waitcnt lgkmcnt(6)
    s_cmp_lt_i32 s81, 0
    s_cbranch_scc1 M_ovrL
    s_swappc_b64 s[78:79], s[72:73]
M_ovrL:
    v_smfmac_f32_16x16x64_bf16 v[152:155], a[208:211], v[196:203], v35 abid:1
    s_add_u32 m0, m0, 896
    v_min_u32 v0, 75497472, v0
    v_smfmac_f32_16x16x64_bf16 v[152:155], a[244:247], v[204:211], v39 abid:1
    ds_write_b32 v11, v0
    s_waitcnt vmcnt(6)
    v_mov_b32 v0, 162048
    v_smfmac_f32_16x16x64_bf16 v[156:159], a[212:215], v[196:203], v50 abid:1
    buffer_load_dwordx4 v5, s[8:11], s22 offen offset:896 nt lds
    v_smfmac_f32_16x16x64_bf16 v[156:159], a[248:251], v[204:211], v51
    ds_read_b128 v[196:199], v1 offset:18432
    v_smfmac_f32_16x16x64_bf16 v[124:127], a[252:255], v[220:227], v40
    ds_read_b128 v[200:203], v2 offset:18432
    v_smfmac_f32_16x16x64_bf16 v[124:127], v[88:91], v[228:235], v44
    ds_read_b128 v[204:207], v1 offset:19456
    v_smfmac_f32_16x16x64_bf16 v[156:159], v[84:87], v[220:227], v51 abid:1
    ds_read_b128 v[208:211], v2 offset:19456
    v_smfmac_f32_16x16x64_bf16 v[156:159], v[120:123], v[228:235], v52
    s_waitcnt lgkmcnt(4)
    s_barrier
    v_xad_u32 v236, v236, v3, v4
    v_smfmac_f32_16x16x64_bf16 v[156:159], v[240:243], v[244:251], v10
    ds_read_b32 v0, v0
    v_xad_u32 v237, v237, v3, v4
    v_smfmac_f32_16x16x64_bf16 v[192:195], v[240:243], v[244:251], v10 abid:1
    ds_read2st64_b32 v[244:245], v236 offset0:0 offset1:72
    ds_read_b128 v[240:243], v8 offset:7168
    v_xad_u32 v238, v238, v3, v4
    v_smfmac_f32_16x16x64_bf16 v[132:135], v[60:63], v[220:227], v41
    ds_read2st64_b32 v[246:247], v237 offset0:0 offset1:72
    v_xad_u32 v239, v239, v3, v4
    v_smfmac_f32_16x16x64_bf16 v[132:135], v[96:99], v[228:235], v45
    ds_read2st64_b32 v[248:249], v238 offset0:0 offset1:72
    s_add_u32 m0, m0, 896
    v_smfmac_f32_16x16x64_bf16 v[136:139], v[64:67], v[220:227], v41 abid:1
    ds_read2st64_b32 v[250:251], v239 offset0:0 offset1:72
    ds_read_b128 v[236:239], v9 offset:9536
    s_waitcnt vmcnt(6)
    v_smfmac_f32_16x16x64_bf16 v[136:139], v[100:103], v[228:235], v45 abid:1
    buffer_load_dwordx4 v5, s[8:11], s22 offen offset:1024 nt lds
    s_waitcnt lgkmcnt(6)
    v_readfirstlane_b32 s88, v0
    v_smfmac_f32_16x16x64_bf16 v[140:143], v[68:71], v[220:227], v42
    s_cmp_lt_u32 s88, s99
    s_cselect_b32 s10, 75497472, 0
    v_smfmac_f32_16x16x64_bf16 v[140:143], v[104:107], v[228:235], v46
    v_smfmac_f32_16x16x64_bf16 v[144:147], v[72:75], v[220:227], v42 abid:1
    ds_read_b128 v[212:215], v1 offset:20480
    v_smfmac_f32_16x16x64_bf16 v[144:147], v[108:111], v[228:235], v46 abid:1
    ds_read_b128 v[216:219], v2 offset:20480
    v_smfmac_f32_16x16x64_bf16 v[148:151], v[76:79], v[220:227], v43
    v_smfmac_f32_16x16x64_bf16 v[148:151], v[112:115], v[228:235], v47
    v_smfmac_f32_16x16x64_bf16 v[152:155], v[80:83], v[220:227], v43 abid:1
    v_smfmac_f32_16x16x64_bf16 v[152:155], v[116:119], v[228:235], v47 abid:1
    s_waitcnt lgkmcnt(2)
    v_xad_u32 v236, v236, v3, v4
    v_smfmac_f32_16x16x64_bf16 v[152:155], v[240:243], v[244:251], v10
    v_xad_u32 v237, v237, v3, v4
    v_smfmac_f32_16x16x64_bf16 v[188:191], v[240:243], v[244:251], v10 abid:1
    s_cmp_gt_u32 s46, s80
    s_cbranch_scc1 M_slow
M_slowrL:
    v_xad_u32 v238, v238, v3, v4
    v_smfmac_f32_16x16x64_bf16 v[128:131], v[56:59], v[220:227], v40 abid:1
    ds_read2st64_b32 v[244:245], v236 offset0:0 offset1:72
    ds_read_b128 v[240:243], v8 offset:5120
    v_xad_u32 v239, v239, v3, v4
    v_smfmac_f32_16x16x64_bf16 v[128:131], v[92:95], v[228:235], v44 abid:1
    ds_read2st64_b32 v[246:247], v237 offset0:0 offset1:72
    ds_read_b128 v[220:223], v1 offset:21504
    v_smfmac_f32_16x16x64_bf16 v[160:163], a[0:3], v[196:203], v12
    ds_read2st64_b32 v[248:249], v238 offset0:0 offset1:72
    ds_read_b128 v[224:227], v2 offset:21504
    v_smfmac_f32_16x16x64_bf16 v[160:163], a[36:39], v[204:211], v16
    ds_read2st64_b32 v[250:251], v239 offset0:0 offset1:72
    ds_read_b128 v[236:239], v9 offset:9600
    s_waitcnt lgkmcnt(8)
    v_smfmac_f32_16x16x64_bf16 v[160:163], a[72:75], v[212:219], v20
    ds_read_b128 v[228:231], v1 offset:22528
    v_smfmac_f32_16x16x64_bf16 v[164:167], a[4:7], v[196:203], v12 abid:1
    ds_read_b128 v[232:235], v2 offset:22528
    v_cvt_pk_bf16_f32 v156, v156, v157
    v_smfmac_f32_16x16x64_bf16 v[164:167], a[40:43], v[204:211], v16 abid:1
    s_mov_b32 m0, s28
    v_cvt_pk_bf16_f32 v157, v158, v159
    v_smfmac_f32_16x16x64_bf16 v[164:167], a[76:79], v[212:219], v20 abid:1
    ds_write_b64 v53, v[156:157] offset:25728
    ds_read_b128 v[156:159], v9 offset:10752
    s_waitcnt vmcnt(6)
    v_smfmac_f32_16x16x64_bf16 v[180:183], a[20:23], v[196:203], v14 abid:1
    buffer_load_dwordx4 v5, s[8:11], s88 offen offset:0 nt lds
    v_smfmac_f32_16x16x64_bf16 v[180:183], a[56:59], v[204:211], v18 abid:1
    v_cvt_pk_bf16_f32 v124, v124, v125
    v_smfmac_f32_16x16x64_bf16 v[180:183], a[92:95], v[212:219], v22 abid:1
    s_waitcnt lgkmcnt(4)
    v_xad_u32 v236, v236, v3, v4
    v_smfmac_f32_16x16x64_bf16 v[180:183], v[240:243], v[244:251], v10 abid:1
    v_xad_u32 v237, v237, v3, v4
    v_smfmac_f32_16x16x64_bf16 v[144:147], v[240:243], v[244:251], v10
    ds_read2st64_b32 v[244:245], v236 offset0:0 offset1:72
    ds_read_b128 v[240:243], v8 offset:6144
    v_xad_u32 v238, v238, v3, v4
    v_smfmac_f32_16x16x64_bf16 v[172:175], a[12:15], v[196:203], v13 abid:1
    ds_read2st64_b32 v[246:247], v237 offset0:0 offset1:72
    v_xad_u32 v239, v239, v3, v4
    v_smfmac_f32_16x16x64_bf16 v[172:175], a[48:51], v[204:211], v17 abid:1
    ds_read2st64_b32 v[248:249], v238 offset0:0 offset1:72
    v_cvt_pk_bf16_f32 v125, v126, v127
    v_smfmac_f32_16x16x64_bf16 v[172:175], a[84:87], v[212:219], v21 abid:1
    ds_read2st64_b32 v[250:251], v239 offset0:0 offset1:72
    ds_read_b128 v[236:239], v9 offset:9472
    v_cvt_pk_bf16_f32 v126, v128, v129
    v_smfmac_f32_16x16x64_bf16 v[176:179], a[16:19], v[196:203], v14
    v_cvt_pk_bf16_f32 v127, v130, v131
    v_smfmac_f32_16x16x64_bf16 v[176:179], a[52:55], v[204:211], v18
    v_cvt_pk_bf16_f32 v132, v132, v133
    v_smfmac_f32_16x16x64_bf16 v[176:179], a[88:91], v[212:219], v22
    v_cvt_pk_bf16_f32 v133, v134, v135
    v_smfmac_f32_16x16x64_bf16 v[168:171], a[8:11], v[196:203], v13
    s_add_u32 m0, m0, 896
    v_cvt_pk_bf16_f32 v134, v136, v137
    v_smfmac_f32_16x16x64_bf16 v[168:171], a[44:47], v[204:211], v17
    s_waitcnt vmcnt(6)
    buffer_load_dwordx4 v5, s[8:11], s88 offen offset:128 nt lds
    v_cvt_pk_bf16_f32 v135, v138, v139
    v_smfmac_f32_16x16x64_bf16 v[168:171], a[80:83], v[212:219], v21
    ds_read_b128 v[136:139], v9 offset:10432
    v_cndmask_b32_dpp v128, v124, v132, vcc row_ror:8 row_mask:0xf bank_mask:0xf
    v_smfmac_f32_16x16x64_bf16 v[184:187], a[24:27], v[196:203], v15
    v_cndmask_b32_dpp v129, v125, v133, vcc row_ror:8 row_mask:0xf bank_mask:0xf
    v_smfmac_f32_16x16x64_bf16 v[184:187], a[60:63], v[204:211], v19
    v_cndmask_b32_dpp v130, v126, v134, vcc row_ror:8 row_mask:0xf bank_mask:0xf
    v_smfmac_f32_16x16x64_bf16 v[184:187], a[96:99], v[212:219], v23
    s_waitcnt lgkmcnt(1)
    v_xad_u32 v236, v236, v3, v4
    v_smfmac_f32_16x16x64_bf16 v[184:187], v[240:243], v[244:251], v10 abid:1
    v_xad_u32 v237, v237, v3, v4
    v_smfmac_f32_16x16x64_bf16 v[148:151], v[240:243], v[244:251], v10
    ds_read2st64_b32 v[244:245], v236 offset0:0 offset1:72
    ds_read_b128 v[240:243], v8 offset:4096
    v_xad_u32 v238, v238, v3, v4
    v_smfmac_f32_16x16x64_bf16 v[188:191], a[28:31], v[196:203], v15 abid:1
    ds_read2st64_b32 v[246:247], v237 offset0:0 offset1:72
    v_xad_u32 v239, v239, v3, v4
    v_smfmac_f32_16x16x64_bf16 v[188:191], a[64:67], v[204:211], v19 abid:1
    ds_read2st64_b32 v[248:249], v238 offset0:0 offset1:72
    v_cndmask_b32_dpp v131, v127, v135, vcc row_ror:8 row_mask:0xf bank_mask:0xf
    v_smfmac_f32_16x16x64_bf16 v[188:191], a[100:103], v[212:219], v23 abid:1
    ds_read2st64_b32 v[250:251], v239 offset0:0 offset1:72
    s_waitcnt vmcnt(6)
    buffer_store_dwordx4 v[128:131], v6, s[12:15], s59 offen offset:0 sc1
    v_smfmac_f32_16x16x64_bf16 v[192:195], a[32:35], v[196:203], v48
    v_mov_b32_dpp v124, v132 row_ror:8 row_mask:0xf bank_mask:0xc
    v_smfmac_f32_16x16x64_bf16 v[192:195], a[68:71], v[204:211], v48 abid:1
    v_mov_b32_dpp v125, v133 row_ror:8 row_mask:0xf bank_mask:0xc
    v_smfmac_f32_16x16x64_bf16 v[192:195], a[104:107], v[212:219], v49
    ds_read_b128 v[196:199], v1 offset:23552
    v_mov_b32_dpp v126, v134 row_ror:8 row_mask:0xf bank_mask:0xc
    v_smfmac_f32_16x16x64_bf16 v[160:163], a[108:111], v[220:227], v24
    ds_read_b128 v[200:203], v2 offset:23552
    v_mov_b32_dpp v127, v135 row_ror:8 row_mask:0xf bank_mask:0xc
    v_smfmac_f32_16x16x64_bf16 v[160:163], a[144:147], v[228:235], v28
    ds_read_b128 v[204:207], v1 offset:24576
    s_waitcnt vmcnt(6)
    buffer_store_dwordx4 v[124:127], v6, s[12:15], s24 offen offset:0 sc1
    v_smfmac_f32_16x16x64_bf16 v[164:167], a[112:115], v[220:227], v24 abid:1
    ds_read_b128 v[208:211], v2 offset:24576
    ds_read_b128 v[128:131], v9 offset:10304
    ds_read_b128 v[132:135], v9 offset:10368
    v_smfmac_f32_16x16x64_bf16 v[164:167], a[148:151], v[228:235], v28 abid:1
    ds_read_b128 v[124:127], v9 offset:10240
    v_smfmac_f32_16x16x64_bf16 v[176:179], a[124:127], v[220:227], v26
    v_smfmac_f32_16x16x64_bf16 v[176:179], a[160:163], v[228:235], v30
    s_waitcnt lgkmcnt(7)
    v_smfmac_f32_16x16x64_bf16 v[176:179], v[240:243], v[244:251], v10 abid:1
    v_smfmac_f32_16x16x64_bf16 v[140:143], v[240:243], v[244:251], v10
    v_smfmac_f32_16x16x64_bf16 v[172:175], a[120:123], v[220:227], v25 abid:1
    s_add_u32 s28, s28, 36864
    s_cmp_ge_u32 s28, 110592
    s_cselect_b32 s28, s26, s28
    v_smfmac_f32_16x16x64_bf16 v[172:175], a[156:159], v[228:235], v29 abid:1
    s_add_u32 s30, s25, 36864
    s_cmp_eq_u32 s30, 110592
    s_cselect_b32 s30, 0, s30
    v_smfmac_f32_16x16x64_bf16 v[168:171], a[116:119], v[220:227], v25
    s_sub_u32 s31, s30, s25
    s_mov_b32 s25, s30
    s_mov_b32 s90, s22
    v_smfmac_f32_16x16x64_bf16 v[168:171], a[152:155], v[228:235], v29
    s_mov_b32 s22, s88
    s_add_u32 s91, s91, 1
    s_cmp_lt_u32 s20, 2
    v_smfmac_f32_16x16x64_bf16 v[180:183], a[128:131], v[220:227], v26 abid:1
    s_cselect_b32 s66, s23, s24
    s_add_u32 s66, s66, s95
    v_smfmac_f32_16x16x64_bf16 v[180:183], a[164:167], v[228:235], v30 abid:1
    v_cvt_pk_bf16_f32 v140, v140, v141
    v_smfmac_f32_16x16x64_bf16 v[184:187], a[132:135], v[220:227], v27
    s_add_u32 m0, m0, 896
    v_cvt_pk_bf16_f32 v141, v142, v143
    v_smfmac_f32_16x16x64_bf16 v[184:187], a[168:171], v[228:235], v31
    s_waitcnt vmcnt(6)
    buffer_load_dwordx4 v5, s[8:11], s88 offen offset:256 nt lds
    v_cvt_pk_bf16_f32 v142, v144, v145
    v_smfmac_f32_16x16x64_bf16 v[188:191], a[136:139], v[220:227], v27 abid:1
    v_cvt_pk_bf16_f32 v143, v146, v147
    v_smfmac_f32_16x16x64_bf16 v[188:191], a[172:175], v[228:235], v31 abid:1
    v_cvt_pk_bf16_f32 v148, v148, v149
    v_smfmac_f32_16x16x64_bf16 v[192:195], a[140:143], v[220:227], v49 abid:1
    v_cvt_pk_bf16_f32 v149, v150, v151
    v_smfmac_f32_16x16x64_bf16 v[192:195], a[176:179], v[228:235], v50
    ds_read_b128 v[220:223], v1 offset:25600
    s_waitcnt lgkmcnt(6)
    v_cvt_pk_bf16_f32 v150, v152, v153
    v_smfmac_f32_16x16x64_bf16 v[160:163], a[180:183], v[196:203], v32
    ds_read_b128 v[224:227], v2 offset:25600
    s_waitcnt lgkmcnt(5)
    v_cvt_pk_bf16_f32 v151, v154, v155
    v_smfmac_f32_16x16x64_bf16 v[160:163], a[216:219], v[204:211], v36
    ds_read_b128 v[228:231], v1 offset:26624
    ds_read_b128 v[152:155], v9 offset:10688
    v_cndmask_b32_dpp v144, v140, v148, vcc row_ror:8 row_mask:0xf bank_mask:0xf
    v_smfmac_f32_16x16x64_bf16 v[164:167], a[184:187], v[196:203], v32 abid:1
    ds_read_b128 v[232:235], v2 offset:26624
    v_cndmask_b32_dpp v145, v141, v149, vcc row_ror:8 row_mask:0xf bank_mask:0xf
    v_smfmac_f32_16x16x64_bf16 v[164:167], a[220:223], v[204:211], v36 abid:1
    s_add_u32 m0, m0, 896
    v_cndmask_b32_dpp v146, v142, v150, vcc row_ror:8 row_mask:0xf bank_mask:0xf
    v_smfmac_f32_16x16x64_bf16 v[168:171], a[188:191], v[196:203], v33
    s_waitcnt vmcnt(6)
    buffer_load_dwordx4 v5, s[8:11], s88 offen offset:384 nt lds
    v_cndmask_b32_dpp v147, v143, v151, vcc row_ror:8 row_mask:0xf bank_mask:0xf
    v_smfmac_f32_16x16x64_bf16 v[168:171], a[224:227], v[204:211], v37
    s_waitcnt vmcnt(6)
    buffer_store_dwordx4 v[144:147], v6, s[12:15], s59 offen offset:128 sc1
    v_mov_b32_dpp v140, v148 row_ror:8 row_mask:0xf bank_mask:0xc
    v_smfmac_f32_16x16x64_bf16 v[172:175], a[192:195], v[196:203], v33 abid:1
    v_mov_b32_dpp v141, v149 row_ror:8 row_mask:0xf bank_mask:0xc
    v_smfmac_f32_16x16x64_bf16 v[172:175], a[228:231], v[204:211], v37 abid:1
    v_mov_b32_dpp v142, v150 row_ror:8 row_mask:0xf bank_mask:0xc
    v_smfmac_f32_16x16x64_bf16 v[176:179], a[196:199], v[196:203], v34
    v_mov_b32_dpp v143, v151 row_ror:8 row_mask:0xf bank_mask:0xc
    v_smfmac_f32_16x16x64_bf16 v[176:179], a[232:235], v[204:211], v38
    s_waitcnt vmcnt(6)
    buffer_store_dwordx4 v[140:143], v6, s[12:15], s24 offen offset:128 sc1
    ds_read_b128 v[144:147], v9 offset:10560
    v_smfmac_f32_16x16x64_bf16 v[180:183], a[200:203], v[196:203], v34 abid:1
    ds_read_b128 v[148:151], v9 offset:10624
    ds_read_b128 v[140:143], v9 offset:10496
    v_add_u32 v4, s31, v4
    v_smfmac_f32_16x16x64_bf16 v[180:183], a[236:239], v[204:211], v38 abid:1
    v_add_u32 v1, s31, v1
    v_smfmac_f32_16x16x64_bf16 v[184:187], a[204:207], v[196:203], v35
    v_add_u32 v2, s31, v2
    v_smfmac_f32_16x16x64_bf16 v[184:187], a[240:243], v[204:211], v39
    v_smfmac_f32_16x16x64_bf16 v[188:191], a[208:211], v[196:203], v35 abid:1
    v_smfmac_f32_16x16x64_bf16 v[188:191], a[244:247], v[204:211], v39 abid:1
    v_smfmac_f32_16x16x64_bf16 v[192:195], a[212:215], v[196:203], v50 abid:1
    v_smfmac_f32_16x16x64_bf16 v[192:195], a[248:251], v[204:211], v51
    s_waitcnt vmcnt(8)
    s_branch M_top1
M_bE0:
    v_smfmac_f32_16x16x64_bf16 v[164:167], v[56:59], v[220:227], v40 abid:1
    ds_read_b128 v[204:207], v1 offset:1024
    v_smfmac_f32_16x16x64_bf16 v[164:167], v[92:95], v[228:235], v44 abid:1
    ds_read_b128 v[208:211], v2 offset:1024
    v_mov_b32 v0, 1
    v_smfmac_f32_16x16x64_bf16 v[168:171], v[60:63], v[220:227], v41
    ds_read_b128 v[212:215], v1 offset:2048
    v_smfmac_f32_16x16x64_bf16 v[168:171], v[96:99], v[228:235], v45
    ds_read_b128 v[216:219], v2 offset:2048
    v_smfmac_f32_16x16x64_bf16 v[172:175], v[64:67], v[220:227], v41 abid:1
    s_waitcnt vmcnt(5)
    s_waitcnt lgkmcnt(6)
    buffer_store_dwordx4 v[244:247], v7, s[12:15], s66 offen sc1
    v_smfmac_f32_16x16x64_bf16 v[172:175], v[100:103], v[228:235], v45 abid:1
    ds_read_b128 v[236:239], v9 offset:9408
    v_smfmac_f32_16x16x64_bf16 v[176:179], v[68:71], v[220:227], v42
    s_waitcnt vmcnt(5)
    buffer_atomic_add v0, v11, s[16:19], s92 offen sc0 sc1
    s_mov_b32 s21, 2
    v_smfmac_f32_16x16x64_bf16 v[176:179], v[104:107], v[228:235], v46
    v_smfmac_f32_16x16x64_bf16 v[180:183], v[72:75], v[220:227], v42 abid:1
    v_cvt_pk_bf16_f32 v160, v160, v161
    v_smfmac_f32_16x16x64_bf16 v[180:183], v[108:111], v[228:235], v46 abid:1
    v_cvt_pk_bf16_f32 v161, v162, v163
    v_smfmac_f32_16x16x64_bf16 v[184:187], v[76:79], v[220:227], v43
    v_cvt_pk_bf16_f32 v162, v164, v165
    v_smfmac_f32_16x16x64_bf16 v[184:187], v[112:115], v[228:235], v47
    v_cvt_pk_bf16_f32 v163, v166, v167
    v_smfmac_f32_16x16x64_bf16 v[188:191], v[80:83], v[220:227], v43 abid:1
    s_add_u32 m0, m0, 896
    v_cvt_pk_bf16_f32 v168, v168, v169
    v_smfmac_f32_16x16x64_bf16 v[188:191], v[116:119], v[228:235], v47 abid:1
    s_waitcnt vmcnt(5)
    buffer_load_dwordx4 v5, s[8:11], s22 offen offset:512 nt lds
    v_cvt_pk_bf16_f32 v169, v170, v171
    v_smfmac_f32_16x16x64_bf16 v[192:195], v[84:87], v[220:227], v51 abid:1
    v_cvt_pk_bf16_f32 v170, v172, v173
    v_smfmac_f32_16x16x64_bf16 v[192:195], v[120:123], v[228:235], v52
    ds_read_b128 v[220:223], v1 offset:3072
    s_waitcnt lgkmcnt(6)
    v_cvt_pk_bf16_f32 v171, v174, v175
    v_smfmac_f32_16x16x64_bf16 v[124:127], a[0:3], v[196:203], v12
    ds_read_b128 v[224:227], v2 offset:3072
    ds_read_b128 v[172:175], v9 offset:10432
    s_waitcnt lgkmcnt(6)
    v_cndmask_b32_dpp v164, v160, v168, vcc row_ror:8 row_mask:0xf bank_mask:0xf
    v_smfmac_f32_16x16x64_bf16 v[124:127], a[36:39], v[204:211], v16
    ds_read_b128 v[228:231], v1 offset:4096
    s_waitcnt lgkmcnt(5)
    v_cndmask_b32_dpp v165, v161, v169, vcc row_ror:8 row_mask:0xf bank_mask:0xf
    v_smfmac_f32_16x16x64_bf16 v[124:127], a[72:75], v[212:219], v20
    ds_read_b128 v[232:235], v2 offset:4096
    v_cndmask_b32_dpp v166, v162, v170, vcc row_ror:8 row_mask:0xf bank_mask:0xf
    v_smfmac_f32_16x16x64_bf16 v[128:131], a[4:7], v[196:203], v12 abid:1
    s_barrier
    v_cndmask_b32_dpp v167, v163, v171, vcc row_ror:8 row_mask:0xf bank_mask:0xf
    v_smfmac_f32_16x16x64_bf16 v[128:131], a[40:43], v[204:211], v16 abid:1
    s_waitcnt vmcnt(5)
    buffer_store_dwordx4 v[164:167], v6, s[12:15], s58 offen offset:0 sc1
    s_waitcnt lgkmcnt(5)
    v_xad_u32 v236, v236, v3, v4
    v_smfmac_f32_16x16x64_bf16 v[128:131], a[76:79], v[212:219], v20 abid:1
    v_xad_u32 v237, v237, v3, v4
    v_smfmac_f32_16x16x64_bf16 v[132:135], a[8:11], v[196:203], v13
    ds_read2st64_b32 v[244:245], v236 offset0:0 offset1:72
    ds_read_b128 v[240:243], v8 offset:3072
    v_xad_u32 v238, v238, v3, v4
    v_smfmac_f32_16x16x64_bf16 v[132:135], a[44:47], v[204:211], v17
    ds_read2st64_b32 v[246:247], v237 offset0:0 offset1:72
    v_xad_u32 v239, v239, v3, v4
    v_smfmac_f32_16x16x64_bf16 v[132:135], a[80:83], v[212:219], v21
    ds_read2st64_b32 v[248:249], v238 offset0:0 offset1:72
    v_mov_b32_dpp v160, v168 row_ror:8 row_mask:0xf bank_mask:0xc
    v_smfmac_f32_16x16x64_bf16 v[144:147], a[20:23], v[196:203], v14 abid:1
    ds_read2st64_b32 v[250:251], v239 offset0:0 offset1:72
    ds_read_b128 v[236:239], v9 offset:9280
    v_mov_b32_dpp v161, v169 row_ror:8 row_mask:0xf bank_mask:0xc
    v_smfmac_f32_16x16x64_bf16 v[144:147], a[56:59], v[204:211], v18 abid:1
    v_mov_b32_dpp v162, v170 row_ror:8 row_mask:0xf bank_mask:0xc
    v_smfmac_f32_16x16x64_bf16 v[144:147], a[92:95], v[212:219], v22 abid:1
    v_mov_b32_dpp v163, v171 row_ror:8 row_mask:0xf bank_mask:0xc
    v_smfmac_f32_16x16x64_bf16 v[140:143], a[16:19], v[196:203], v14
    s_waitcnt vmcnt(5)
    buffer_store_dwordx4 v[160:163], v6, s[12:15], s23 offen offset:0 sc1
    ds_read_b128 v[164:167], v9 offset:10304
    v_smfmac_f32_16x16x64_bf16 v[140:143], a[52:55], v[204:211], v18
    ds_read_b128 v[168:171], v9 offset:10368
    ds_read_b128 v[160:163], v9 offset:10240
    v_smfmac_f32_16x16x64_bf16 v[140:143], a[88:91], v[212:219], v22
    v_smfmac_f32_16x16x64_bf16 v[136:139], a[12:15], v[196:203], v13 abid:1
    v_smfmac_f32_16x16x64_bf16 v[136:139], a[48:51], v[204:211], v17 abid:1
    v_smfmac_f32_16x16x64_bf16 v[136:139], a[84:87], v[212:219], v21 abid:1
    s_waitcnt lgkmcnt(3)
    v_xad_u32 v236, v236, v3, v4
    v_smfmac_f32_16x16x64_bf16 v[136:139], v[240:243], v[244:251], v10
    v_xad_u32 v237, v237, v3, v4
    v_smfmac_f32_16x16x64_bf16 v[172:175], v[240:243], v[244:251], v10 abid:1
    ds_read2st64_b32 v[244:245], v236 offset0:0 offset1:72
    ds_read_b128 v[240:243], v8 offset:1024
    v_xad_u32 v238, v238, v3, v4
    v_smfmac_f32_16x16x64_bf16 v[148:151], a[24:27], v[196:203], v15
    ds_read2st64_b32 v[246:247], v237 offset0:0 offset1:72
    v_xad_u32 v239, v239, v3, v4
    v_smfmac_f32_16x16x64_bf16 v[148:151], a[60:63], v[204:211], v19
    ds_read2st64_b32 v[248:249], v238 offset0:0 offset1:72
    v_cvt_pk_bf16_f32 v192, v192, v193
    v_smfmac_f32_16x16x64_bf16 v[148:151], a[96:99], v[212:219], v23
    ds_read2st64_b32 v[250:251], v239 offset0:0 offset1:72
    ds_read_b128 v[236:239], v9 offset:9344
    v_cvt_pk_bf16_f32 v193, v194, v195
    v_smfmac_f32_16x16x64_bf16 v[152:155], a[28:31], v[196:203], v15 abid:1
    ds_write_b64 v53, v[192:193] offset:0
    ds_read_b128 v[192:195], v9 offset:10752
    v_smfmac_f32_16x16x64_bf16 v[152:155], a[64:67], v[204:211], v19 abid:1
    s_add_u32 m0, m0, 896
    v_smfmac_f32_16x16x64_bf16 v[152:155], a[100:103], v[212:219], v23 abid:1
    s_waitcnt vmcnt(5)
    buffer_load_dwordx4 v5, s[8:11], s22 offen offset:640 nt lds
    v_smfmac_f32_16x16x64_bf16 v[156:159], a[32:35], v[196:203], v48
    v_smfmac_f32_16x16x64_bf16 v[156:159], a[68:71], v[204:211], v48 abid:1
    v_smfmac_f32_16x16x64_bf16 v[156:159], a[104:107], v[212:219], v49
    ds_read_b128 v[196:199], v1 offset:5120
    v_cvt_pk_bf16_f32 v176, v176, v177
    v_smfmac_f32_16x16x64_bf16 v[124:127], a[108:111], v[220:227], v24
    ds_read_b128 v[200:203], v2 offset:5120
    v_cvt_pk_bf16_f32 v177, v178, v179
    v_smfmac_f32_16x16x64_bf16 v[124:127], a[144:147], v[228:235], v28
    ds_read_b128 v[204:207], v1 offset:6144
    ds_read_b64 v[216:217], v9 offset:10056
    v_cvt_pk_bf16_f32 v178, v180, v181
    v_smfmac_f32_16x16x64_bf16 v[128:131], a[112:115], v[220:227], v24 abid:1
    ds_read_b128 v[208:211], v2 offset:6144
    v_cvt_pk_bf16_f32 v179, v182, v183
    v_smfmac_f32_16x16x64_bf16 v[128:131], a[148:151], v[228:235], v28 abid:1
    s_waitcnt lgkmcnt(7)
    v_xad_u32 v236, v236, v3, v4
    v_smfmac_f32_16x16x64_bf16 v[128:131], v[240:243], v[244:251], v10
    s_add_u32 m0, m0, 896
    v_xad_u32 v237, v237, v3, v4
    v_smfmac_f32_16x16x64_bf16 v[164:167], v[240:243], v[244:251], v10 abid:1
    ds_read2st64_b32 v[244:245], v236 offset0:0 offset1:72
    ds_read_b128 v[240:243], v8 offset:2048
    v_xad_u32 v238, v238, v3, v4
    v_smfmac_f32_16x16x64_bf16 v[152:155], a[136:139], v[220:227], v27 abid:1
    ds_read2st64_b32 v[246:247], v237 offset0:0 offset1:72
    s_waitcnt vmcnt(5)
    v_xad_u32 v239, v239, v3, v4
    v_smfmac_f32_16x16x64_bf16 v[152:155], a[172:175], v[228:235], v31 abid:1
    ds_read2st64_b32 v[248:249], v238 offset0:0 offset1:72
    buffer_load_dwordx4 v5, s[8:11], s22 offen offset:768 nt lds
    v_cvt_pk_bf16_f32 v184, v184, v185
    v_smfmac_f32_16x16x64_bf16 v[136:139], a[120:123], v[220:227], v25 abid:1
    ds_read2st64_b32 v[250:251], v239 offset0:0 offset1:72
    ds_read_b128 v[236:239], v9 offset:9216
    v_cvt_pk_bf16_f32 v185, v186, v187
    v_smfmac_f32_16x16x64_bf16 v[136:139], a[156:159], v[228:235], v29 abid:1
    v_cvt_pk_bf16_f32 v186, v188, v189
    v_smfmac_f32_16x16x64_bf16 v[140:143], a[124:127], v[220:227], v26
    v_cvt_pk_bf16_f32 v187, v190, v191
    v_smfmac_f32_16x16x64_bf16 v[140:143], a[160:163], v[228:235], v30
    ds_read_b128 v[188:191], v9 offset:10688
    v_cndmask_b32_dpp v180, v176, v184, vcc row_ror:8 row_mask:0xf bank_mask:0xf
    v_smfmac_f32_16x16x64_bf16 v[144:147], a[128:131], v[220:227], v26 abid:1
    v_cndmask_b32_dpp v181, v177, v185, vcc row_ror:8 row_mask:0xf bank_mask:0xf
    v_smfmac_f32_16x16x64_bf16 v[144:147], a[164:167], v[228:235], v30 abid:1
    v_cndmask_b32_dpp v182, v178, v186, vcc row_ror:8 row_mask:0xf bank_mask:0xf
    v_smfmac_f32_16x16x64_bf16 v[148:151], a[132:135], v[220:227], v27
    v_cndmask_b32_dpp v183, v179, v187, vcc row_ror:8 row_mask:0xf bank_mask:0xf
    v_smfmac_f32_16x16x64_bf16 v[148:151], a[168:171], v[228:235], v31
    s_waitcnt vmcnt(5)
    buffer_store_dwordx4 v[180:183], v6, s[12:15], s58 offen offset:128 sc1
    s_waitcnt lgkmcnt(8)
    v_xad_u32 v212, v216, v3, v4
    v_smfmac_f32_16x16x64_bf16 v[132:135], a[116:119], v[220:227], v25
    ds_read2st64_b32 v[212:213], v212 offset0:0 offset1:72
    v_xad_u32 v214, v217, v3, v4
    v_smfmac_f32_16x16x64_bf16 v[132:135], a[152:155], v[228:235], v29
    ds_read2st64_b32 v[214:215], v214 offset0:0 offset1:72
    s_waitcnt lgkmcnt(3)
    v_xad_u32 v236, v236, v3, v4
    v_smfmac_f32_16x16x64_bf16 v[132:135], v[240:243], v[244:251], v10
    v_xad_u32 v237, v237, v3, v4
    v_smfmac_f32_16x16x64_bf16 v[168:171], v[240:243], v[244:251], v10 abid:1
    ds_read2st64_b32 v[244:245], v236 offset0:0 offset1:72
    ds_read_b128 v[240:243], v8 offset:0
    v_xad_u32 v238, v238, v3, v4
    v_smfmac_f32_16x16x64_bf16 v[156:159], a[140:143], v[220:227], v49 abid:1
    ds_read2st64_b32 v[246:247], v237 offset0:0 offset1:72
    v_xad_u32 v239, v239, v3, v4
    v_smfmac_f32_16x16x64_bf16 v[156:159], a[176:179], v[228:235], v50
    ds_read2st64_b32 v[248:249], v238 offset0:0 offset1:72
    ds_read_b128 v[220:223], v1 offset:7168
    v_mov_b32_dpp v176, v184 row_ror:8 row_mask:0xf bank_mask:0xc
    v_smfmac_f32_16x16x64_bf16 v[140:143], a[196:199], v[196:203], v34
    ds_read2st64_b32 v[250:251], v239 offset0:0 offset1:72
    ds_read_b128 v[236:239], v9 offset:9728
    v_mov_b32_dpp v177, v185 row_ror:8 row_mask:0xf bank_mask:0xc
    v_smfmac_f32_16x16x64_bf16 v[140:143], a[232:235], v[204:211], v38
    ds_read_b128 v[224:227], v2 offset:7168
    v_mov_b32_dpp v178, v186 row_ror:8 row_mask:0xf bank_mask:0xc
    v_smfmac_f32_16x16x64_bf16 v[128:131], a[184:187], v[196:203], v32 abid:1
    ds_read_b128 v[228:231], v1 offset:8192
    v_mov_b32_dpp v179, v187 row_ror:8 row_mask:0xf bank_mask:0xc
    v_smfmac_f32_16x16x64_bf16 v[128:131], a[220:223], v[204:211], v36 abid:1
    ds_read_b128 v[232:235], v2 offset:8192
    s_waitcnt vmcnt(5)
    buffer_store_dwordx4 v[176:179], v6, s[12:15], s23 offen offset:128 sc1
    v_smfmac_f32_16x16x64_bf16 v[132:135], a[188:191], v[196:203], v33
    ds_read_b128 v[180:183], v9 offset:10560
    ds_read_b128 v[184:187], v9 offset:10624
    ds_read_b128 v[176:179], v9 offset:10496
    v_smfmac_f32_16x16x64_bf16 v[132:135], a[224:227], v[204:211], v37
    v_smfmac_f32_16x16x64_bf16 v[136:139], a[192:195], v[196:203], v33 abid:1
    v_smfmac_f32_16x16x64_bf16 v[136:139], a[228:231], v[204:211], v37 abid:1
    v_smfmac_f32_16x16x64_bf16 v[124:127], a[180:183], v[196:203], v32
    v_smfmac_f32_16x16x64_bf16 v[124:127], a[216:219], v[204:211], v36
    s_waitcnt vmcnt(7)
    s_waitcnt lgkmcnt(6)
    v_xad_u32 v236, v236, v3, v4
    v_smfmac_f32_16x16x64_bf16 v[124:127], v[240:243], v[244:251], v10
    v_xad_u32 v237, v237, v3, v4
    v_smfmac_f32_16x16x64_bf16 v[160:163], v[240:243], v[244:251], v10 abid:1
    ds_read2st64_b32 v[244:245], v236 offset0:0 offset1:72
    ds_read_b128 v[240:243], v8 offset:8192
    v_xad_u32 v238, v238, v3, v4
    v_smfmac_f32_16x16x64_bf16 v[144:147], a[200:203], v[196:203], v34 abid:1
    ds_read2st64_b32 v[246:247], v237 offset0:0 offset1:72
    v_xad_u32 v239, v239, v3, v4
    v_smfmac_f32_16x16x64_bf16 v[144:147], a[236:239], v[204:211], v38 abid:1
    ds_read2st64_b32 v[248:249], v238 offset0:0 offset1:72
    v_mul_u32_u24 v0, s94, v0
    v_smfmac_f32_16x16x64_bf16 v[148:151], a[204:207], v[196:203], v35
    ds_read2st64_b32 v[250:251], v239 offset0:0 offset1:72
    ds_read_b128 v[236:239], v9 offset:9664
    v_add_u32 v0, s93, v0
    v_smfmac_f32_16x16x64_bf16 v[148:151], a[240:243], v[204:211], v39
    s_waitcnt lgkmcnt(6)
    s_cmp_lt_i32 s81, 0
    s_cbranch_scc1 M_ovrE0
    s_swappc_b64 s[78:79], s[72:73]
M_ovrE0:
    v_smfmac_f32_16x16x64_bf16 v[152:155], a[208:211], v[196:203], v35 abid:1
    s_add_u32 m0, m0, 896
    v_min_u32 v0, 75497472, v0
    v_smfmac_f32_16x16x64_bf16 v[152:155], a[244:247], v[204:211], v39 abid:1
    ds_write_b32 v11, v0
    s_waitcnt vmcnt(5)
    v_mov_b32 v0, 162048
    v_smfmac_f32_16x16x64_bf16 v[156:159], a[212:215], v[196:203], v50 abid:1
    buffer_load_dwordx4 v5, s[8:11], s22 offen offset:896 nt lds
    v_smfmac_f32_16x16x64_bf16 v[156:159], a[248:251], v[204:211], v51
    ds_read_b128 v[196:199], v1 offset:18432
    v_smfmac_f32_16x16x64_bf16 v[124:127], a[252:255], v[220:227], v40
    ds_read_b128 v[200:203], v2 offset:18432
    v_smfmac_f32_16x16x64_bf16 v[124:127], v[88:91], v[228:235], v44
    ds_read_b128 v[204:207], v1 offset:19456
    v_smfmac_f32_16x16x64_bf16 v[156:159], v[84:87], v[220:227], v51 abid:1
    ds_read_b128 v[208:211], v2 offset:19456
    v_smfmac_f32_16x16x64_bf16 v[156:159], v[120:123], v[228:235], v52
    s_waitcnt lgkmcnt(4)
    s_barrier
    v_xad_u32 v236, v236, v3, v4
    v_smfmac_f32_16x16x64_bf16 v[156:159], v[240:243], v[244:251], v10
    ds_read_b32 v0, v0
    v_xad_u32 v237, v237, v3, v4
    v_smfmac_f32_16x16x64_bf16 v[192:195], v[240:243], v[244:251], v10 abid:1
    ds_read2st64_b32 v[244:245], v236 offset0:0 offset1:72
    ds_read_b128 v[240:243], v8 offset:7168
    v_xad_u32 v238, v238, v3, v4
    v_smfmac_f32_16x16x64_bf16 v[132:135], v[60:63], v[220:227], v41
    ds_read2st64_b32 v[246:247], v237 offset0:0 offset1:72
    v_xad_u32 v239, v239, v3, v4
    v_smfmac_f32_16x16x64_bf16 v[132:135], v[96:99], v[228:235], v45
    ds_read2st64_b32 v[248:249], v238 offset0:0 offset1:72
    s_add_u32 m0, m0, 896
    v_smfmac_f32_16x16x64_bf16 v[136:139], v[64:67], v[220:227], v41 abid:1
    ds_read2st64_b32 v[250:251], v239 offset0:0 offset1:72
    ds_read_b128 v[236:239], v9 offset:9536
    s_waitcnt vmcnt(5)
    v_smfmac_f32_16x16x64_bf16 v[136:139], v[100:103], v[228:235], v45 abid:1
    buffer_load_dwordx4 v5, s[8:11], s22 offen offset:1024 nt lds
    s_waitcnt lgkmcnt(6)
    v_readfirstlane_b32 s88, v0
    v_smfmac_f32_16x16x64_bf16 v[140:143], v[68:71], v[220:227], v42
    s_cmp_lt_u32 s88, s99
    s_cselect_b32 s10, 75497472, 0
    v_smfmac_f32_16x16x64_bf16 v[140:143], v[104:107], v[228:235], v46
    v_smfmac_f32_16x16x64_bf16 v[144:147], v[72:75], v[220:227], v42 abid:1
    ds_read_b128 v[212:215], v1 offset:20480
    v_smfmac_f32_16x16x64_bf16 v[144:147], v[108:111], v[228:235], v46 abid:1
    ds_read_b128 v[216:219], v2 offset:20480
    v_smfmac_f32_16x16x64_bf16 v[148:151], v[76:79], v[220:227], v43
    v_smfmac_f32_16x16x64_bf16 v[148:151], v[112:115], v[228:235], v47
    v_smfmac_f32_16x16x64_bf16 v[152:155], v[80:83], v[220:227], v43 abid:1
    v_smfmac_f32_16x16x64_bf16 v[152:155], v[116:119], v[228:235], v47 abid:1
    s_waitcnt lgkmcnt(2)
    v_xad_u32 v236, v236, v3, v4
    v_smfmac_f32_16x16x64_bf16 v[152:155], v[240:243], v[244:251], v10
    v_xad_u32 v237, v237, v3, v4
    v_smfmac_f32_16x16x64_bf16 v[188:191], v[240:243], v[244:251], v10 abid:1
    s_cmp_gt_u32 s46, s80
    s_cbranch_scc1 M_slow
M_slowrE0:
    v_xad_u32 v238, v238, v3, v4
    v_smfmac_f32_16x16x64_bf16 v[128:131], v[56:59], v[220:227], v40 abid:1
    ds_read2st64_b32 v[244:245], v236 offset0:0 offset1:72
    ds_read_b128 v[240:243], v8 offset:5120
    v_xad_u32 v239, v239, v3, v4
    v_smfmac_f32_16x16x64_bf16 v[128:131], v[92:95], v[228:235], v44 abid:1
    ds_read2st64_b32 v[246:247], v237 offset0:0 offset1:72
    ds_read_b128 v[220:223], v1 offset:21504
    v_smfmac_f32_16x16x64_bf16 v[160:163], a[0:3], v[196:203], v12
    ds_read2st64_b32 v[248:249], v238 offset0:0 offset1:72
    ds_read_b128 v[224:227], v2 offset:21504
    v_smfmac_f32_16x16x64_bf16 v[160:163], a[36:39], v[204:211], v16
    ds_read2st64_b32 v[250:251], v239 offset0:0 offset1:72
    ds_read_b128 v[236:239], v9 offset:9600
    s_waitcnt lgkmcnt(8)
    v_smfmac_f32_16x16x64_bf16 v[160:163], a[72:75], v[212:219], v20
    ds_read_b128 v[228:231], v1 offset:22528
    v_smfmac_f32_16x16x64_bf16 v[164:167], a[4:7], v[196:203], v12 abid:1
    ds_read_b128 v[232:235], v2 offset:22528
    v_cvt_pk_bf16_f32 v156, v156, v157
    v_smfmac_f32_16x16x64_bf16 v[164:167], a[40:43], v[204:211], v16 abid:1
    s_mov_b32 m0, s28
    v_cvt_pk_bf16_f32 v157, v158, v159
    v_smfmac_f32_16x16x64_bf16 v[164:167], a[76:79], v[212:219], v20 abid:1
    ds_write_b64 v53, v[156:157] offset:25728
    ds_read_b128 v[156:159], v9 offset:10752
    s_waitcnt vmcnt(5)
    v_smfmac_f32_16x16x64_bf16 v[180:183], a[20:23], v[196:203], v14 abid:1
    buffer_load_dwordx4 v5, s[8:11], s88 offen offset:0 nt lds
    v_smfmac_f32_16x16x64_bf16 v[180:183], a[56:59], v[204:211], v18 abid:1
    v_cvt_pk_bf16_f32 v124, v124, v125
    v_smfmac_f32_16x16x64_bf16 v[180:183], a[92:95], v[212:219], v22 abid:1
    s_waitcnt lgkmcnt(4)
    v_xad_u32 v236, v236, v3, v4
    v_smfmac_f32_16x16x64_bf16 v[180:183], v[240:243], v[244:251], v10 abid:1
    v_xad_u32 v237, v237, v3, v4
    v_smfmac_f32_16x16x64_bf16 v[144:147], v[240:243], v[244:251], v10
    ds_read2st64_b32 v[244:245], v236 offset0:0 offset1:72
    ds_read_b128 v[240:243], v8 offset:6144
    v_xad_u32 v238, v238, v3, v4
    v_smfmac_f32_16x16x64_bf16 v[172:175], a[12:15], v[196:203], v13 abid:1
    ds_read2st64_b32 v[246:247], v237 offset0:0 offset1:72
    v_xad_u32 v239, v239, v3, v4
    v_smfmac_f32_16x16x64_bf16 v[172:175], a[48:51], v[204:211], v17 abid:1
    ds_read2st64_b32 v[248:249], v238 offset0:0 offset1:72
    v_cvt_pk_bf16_f32 v125, v126, v127
    v_smfmac_f32_16x16x64_bf16 v[172:175], a[84:87], v[212:219], v21 abid:1
    ds_read2st64_b32 v[250:251], v239 offset0:0 offset1:72
    ds_read_b128 v[236:239], v9 offset:9472
    v_cvt_pk_bf16_f32 v126, v128, v129
    v_smfmac_f32_16x16x64_bf16 v[176:179], a[16:19], v[196:203], v14
    v_cvt_pk_bf16_f32 v127, v130, v131
    v_smfmac_f32_16x16x64_bf16 v[176:179], a[52:55], v[204:211], v18
    v_cvt_pk_bf16_f32 v132, v132, v133
    v_smfmac_f32_16x16x64_bf16 v[176:179], a[88:91], v[212:219], v22
    v_cvt_pk_bf16_f32 v133, v134, v135
    v_smfmac_f32_16x16x64_bf16 v[168:171], a[8:11], v[196:203], v13
    s_add_u32 m0, m0, 896
    v_cvt_pk_bf16_f32 v134, v136, v137
    v_smfmac_f32_16x16x64_bf16 v[168:171], a[44:47], v[204:211], v17
    s_waitcnt vmcnt(5)
    buffer_load_dwordx4 v5, s[8:11], s88 offen offset:128 nt lds
    v_cvt_pk_bf16_f32 v135, v138, v139
    v_smfmac_f32_16x16x64_bf16 v[168:171], a[80:83], v[212:219], v21
    ds_read_b128 v[136:139], v9 offset:10432
    v_cndmask_b32_dpp v128, v124, v132, vcc row_ror:8 row_mask:0xf bank_mask:0xf
    v_smfmac_f32_16x16x64_bf16 v[184:187], a[24:27], v[196:203], v15
    v_cndmask_b32_dpp v129, v125, v133, vcc row_ror:8 row_mask:0xf bank_mask:0xf
    v_smfmac_f32_16x16x64_bf16 v[184:187], a[60:63], v[204:211], v19
    v_cndmask_b32_dpp v130, v126, v134, vcc row_ror:8 row_mask:0xf bank_mask:0xf
    v_smfmac_f32_16x16x64_bf16 v[184:187], a[96:99], v[212:219], v23
    s_waitcnt lgkmcnt(1)
    v_xad_u32 v236, v236, v3, v4
    v_smfmac_f32_16x16x64_bf16 v[184:187], v[240:243], v[244:251], v10 abid:1
    v_xad_u32 v237, v237, v3, v4
    v_smfmac_f32_16x16x64_bf16 v[148:151], v[240:243], v[244:251], v10
    ds_read2st64_b32 v[244:245], v236 offset0:0 offset1:72
    ds_read_b128 v[240:243], v8 offset:4096
    v_xad_u32 v238, v238, v3, v4
    v_smfmac_f32_16x16x64_bf16 v[188:191], a[28:31], v[196:203], v15 abid:1
    ds_read2st64_b32 v[246:247], v237 offset0:0 offset1:72
    v_xad_u32 v239, v239, v3, v4
    v_smfmac_f32_16x16x64_bf16 v[188:191], a[64:67], v[204:211], v19 abid:1
    ds_read2st64_b32 v[248:249], v238 offset0:0 offset1:72
    v_cndmask_b32_dpp v131, v127, v135, vcc row_ror:8 row_mask:0xf bank_mask:0xf
    v_smfmac_f32_16x16x64_bf16 v[188:191], a[100:103], v[212:219], v23 abid:1
    ds_read2st64_b32 v[250:251], v239 offset0:0 offset1:72
    s_waitcnt vmcnt(5)
    buffer_store_dwordx4 v[128:131], v6, s[12:15], s59 offen offset:0 sc1
    v_smfmac_f32_16x16x64_bf16 v[192:195], a[32:35], v[196:203], v48
    v_mov_b32_dpp v124, v132 row_ror:8 row_mask:0xf bank_mask:0xc
    v_smfmac_f32_16x16x64_bf16 v[192:195], a[68:71], v[204:211], v48 abid:1
    v_mov_b32_dpp v125, v133 row_ror:8 row_mask:0xf bank_mask:0xc
    v_smfmac_f32_16x16x64_bf16 v[192:195], a[104:107], v[212:219], v49
    ds_read_b128 v[196:199], v1 offset:23552
    v_mov_b32_dpp v126, v134 row_ror:8 row_mask:0xf bank_mask:0xc
    v_smfmac_f32_16x16x64_bf16 v[160:163], a[108:111], v[220:227], v24
    ds_read_b128 v[200:203], v2 offset:23552
    v_mov_b32_dpp v127, v135 row_ror:8 row_mask:0xf bank_mask:0xc
    v_smfmac_f32_16x16x64_bf16 v[160:163], a[144:147], v[228:235], v28
    ds_read_b128 v[204:207], v1 offset:24576
    s_waitcnt vmcnt(5)
    buffer_store_dwordx4 v[124:127], v6, s[12:15], s24 offen offset:0 sc1
    v_smfmac_f32_16x16x64_bf16 v[164:167], a[112:115], v[220:227], v24 abid:1
    ds_read_b128 v[208:211], v2 offset:24576
    ds_read_b128 v[128:131], v9 offset:10304
    ds_read_b128 v[132:135], v9 offset:10368
    v_smfmac_f32_16x16x64_bf16 v[164:167], a[148:151], v[228:235], v28 abid:1
    ds_read_b128 v[124:127], v9 offset:10240
    v_smfmac_f32_16x16x64_bf16 v[176:179], a[124:127], v[220:227], v26
    v_smfmac_f32_16x16x64_bf16 v[176:179], a[160:163], v[228:235], v30
    s_waitcnt lgkmcnt(7)
    v_smfmac_f32_16x16x64_bf16 v[176:179], v[240:243], v[244:251], v10 abid:1
    v_smfmac_f32_16x16x64_bf16 v[140:143], v[240:243], v[244:251], v10
    v_smfmac_f32_16x16x64_bf16 v[172:175], a[120:123], v[220:227], v25 abid:1
    s_add_u32 s28, s28, 36864
    s_cmp_ge_u32 s28, 110592
    s_cselect_b32 s28, s26, s28
    v_smfmac_f32_16x16x64_bf16 v[172:175], a[156:159], v[228:235], v29 abid:1
    s_add_u32 s30, s25, 36864
    s_cmp_eq_u32 s30, 110592
    s_cselect_b32 s30, 0, s30
    v_smfmac_f32_16x16x64_bf16 v[168:171], a[116:119], v[220:227], v25
    s_sub_u32 s31, s30, s25
    s_mov_b32 s25, s30
    s_mov_b32 s90, s22
    v_smfmac_f32_16x16x64_bf16 v[168:171], a[152:155], v[228:235], v29
    s_mov_b32 s22, s88
    s_add_u32 s91, s91, 1
    s_cmp_lt_u32 s20, 2
    v_smfmac_f32_16x16x64_bf16 v[180:183], a[128:131], v[220:227], v26 abid:1
    s_cselect_b32 s66, s23, s24
    s_add_u32 s66, s66, s95
    v_smfmac_f32_16x16x64_bf16 v[180:183], a[164:167], v[228:235], v30 abid:1
    v_cvt_pk_bf16_f32 v140, v140, v141
    v_smfmac_f32_16x16x64_bf16 v[184:187], a[132:135], v[220:227], v27
    s_add_u32 m0, m0, 896
    v_cvt_pk_bf16_f32 v141, v142, v143
    v_smfmac_f32_16x16x64_bf16 v[184:187], a[168:171], v[228:235], v31
    s_waitcnt vmcnt(5)
    buffer_load_dwordx4 v5, s[8:11], s88 offen offset:256 nt lds
    v_cvt_pk_bf16_f32 v142, v144, v145
    v_smfmac_f32_16x16x64_bf16 v[188:191], a[136:139], v[220:227], v27 abid:1
    v_cvt_pk_bf16_f32 v143, v146, v147
    v_smfmac_f32_16x16x64_bf16 v[188:191], a[172:175], v[228:235], v31 abid:1
    v_cvt_pk_bf16_f32 v148, v148, v149
    v_smfmac_f32_16x16x64_bf16 v[192:195], a[140:143], v[220:227], v49 abid:1
    v_cvt_pk_bf16_f32 v149, v150, v151
    v_smfmac_f32_16x16x64_bf16 v[192:195], a[176:179], v[228:235], v50
    ds_read_b128 v[220:223], v1 offset:25600
    s_waitcnt lgkmcnt(6)
    v_cvt_pk_bf16_f32 v150, v152, v153
    v_smfmac_f32_16x16x64_bf16 v[160:163], a[180:183], v[196:203], v32
    ds_read_b128 v[224:227], v2 offset:25600
    s_waitcnt lgkmcnt(5)
    v_cvt_pk_bf16_f32 v151, v154, v155
    v_smfmac_f32_16x16x64_bf16 v[160:163], a[216:219], v[204:211], v36
    ds_read_b128 v[228:231], v1 offset:26624
    ds_read_b128 v[152:155], v9 offset:10688
    v_cndmask_b32_dpp v144, v140, v148, vcc row_ror:8 row_mask:0xf bank_mask:0xf
    v_smfmac_f32_16x16x64_bf16 v[164:167], a[184:187], v[196:203], v32 abid:1
    ds_read_b128 v[232:235], v2 offset:26624
    v_cndmask_b32_dpp v145, v141, v149, vcc row_ror:8 row_mask:0xf bank_mask:0xf
    v_smfmac_f32_16x16x64_bf16 v[164:167], a[220:223], v[204:211], v36 abid:1
    s_add_u32 m0, m0, 896
    v_cndmask_b32_dpp v146, v142, v150, vcc row_ror:8 row_mask:0xf bank_mask:0xf
    v_smfmac_f32_16x16x64_bf16 v[168:171], a[188:191], v[196:203], v33
    s_waitcnt vmcnt(5)
    buffer_load_dwordx4 v5, s[8:11], s88 offen offset:384 nt lds
    v_cndmask_b32_dpp v147, v143, v151, vcc row_ror:8 row_mask:0xf bank_mask:0xf
    v_smfmac_f32_16x16x64_bf16 v[168:171], a[224:227], v[204:211], v37
    s_waitcnt vmcnt(5)
    buffer_store_dwordx4 v[144:147], v6, s[12:15], s59 offen offset:128 sc1
    v_mov_b32_dpp v140, v148 row_ror:8 row_mask:0xf bank_mask:0xc
    v_smfmac_f32_16x16x64_bf16 v[172:175], a[192:195], v[196:203], v33 abid:1
    v_mov_b32_dpp v141, v149 row_ror:8 row_mask:0xf bank_mask:0xc
    v_smfmac_f32_16x16x64_bf16 v[172:175], a[228:231], v[204:211], v37 abid:1
    v_mov_b32_dpp v142, v150 row_ror:8 row_mask:0xf bank_mask:0xc
    v_smfmac_f32_16x16x64_bf16 v[176:179], a[196:199], v[196:203], v34
    v_mov_b32_dpp v143, v151 row_ror:8 row_mask:0xf bank_mask:0xc
    v_smfmac_f32_16x16x64_bf16 v[176:179], a[232:235], v[204:211], v38
    s_waitcnt vmcnt(5)
    buffer_store_dwordx4 v[140:143], v6, s[12:15], s24 offen offset:128 sc1
    ds_read_b128 v[144:147], v9 offset:10560
    v_smfmac_f32_16x16x64_bf16 v[180:183], a[200:203], v[196:203], v34 abid:1
    ds_read_b128 v[148:151], v9 offset:10624
    ds_read_b128 v[140:143], v9 offset:10496
    v_add_u32 v4, s31, v4
    v_smfmac_f32_16x16x64_bf16 v[180:183], a[236:239], v[204:211], v38 abid:1
    v_add_u32 v1, s31, v1
    v_smfmac_f32_16x16x64_bf16 v[184:187], a[204:207], v[196:203], v35
    v_add_u32 v2, s31, v2
    v_smfmac_f32_16x16x64_bf16 v[184:187], a[240:243], v[204:211], v39
    v_smfmac_f32_16x16x64_bf16 v[188:191], a[208:211], v[196:203], v35 abid:1
    v_smfmac_f32_16x16x64_bf16 v[188:191], a[244:247], v[204:211], v39 abid:1
    v_smfmac_f32_16x16x64_bf16 v[192:195], a[212:215], v[196:203], v50 abid:1
    v_smfmac_f32_16x16x64_bf16 v[192:195], a[248:251], v[204:211], v51
    s_waitcnt vmcnt(8)
    s_branch M_top1
M_bF:
    v_smfmac_f32_16x16x64_bf16 v[164:167], v[56:59], v[220:227], v40 abid:1
    ds_read_b128 v[204:207], v1 offset:1024
    v_smfmac_f32_16x16x64_bf16 v[164:167], v[92:95], v[228:235], v44 abid:1
    ds_read_b128 v[208:211], v2 offset:1024
    v_smfmac_f32_16x16x64_bf16 v[168:171], v[60:63], v[220:227], v41
    ds_read_b128 v[212:215], v1 offset:2048
    v_smfmac_f32_16x16x64_bf16 v[168:171], v[96:99], v[228:235], v45
    ds_read_b128 v[216:219], v2 offset:2048
    v_smfmac_f32_16x16x64_bf16 v[172:175], v[64:67], v[220:227], v41 abid:1
    s_waitcnt lgkmcnt(6)
    buffer_store_dwordx4 v[244:247], v7, s[12:15], s66 offen sc1
    v_smfmac_f32_16x16x64_bf16 v[172:175], v[100:103], v[228:235], v45 abid:1
    ds_read_b128 v[236:239], v9 offset:9408
    v_smfmac_f32_16x16x64_bf16 v[176:179], v[68:71], v[220:227], v42
    s_mov_b32 s21, 3
    v_smfmac_f32_16x16x64_bf16 v[176:179], v[104:107], v[228:235], v46
    v_smfmac_f32_16x16x64_bf16 v[180:183], v[72:75], v[220:227], v42 abid:1
    v_cvt_pk_bf16_f32 v160, v160, v161
    v_smfmac_f32_16x16x64_bf16 v[180:183], v[108:111], v[228:235], v46 abid:1
    v_cvt_pk_bf16_f32 v161, v162, v163
    v_smfmac_f32_16x16x64_bf16 v[184:187], v[76:79], v[220:227], v43
    v_cvt_pk_bf16_f32 v162, v164, v165
    v_smfmac_f32_16x16x64_bf16 v[184:187], v[112:115], v[228:235], v47
    v_cvt_pk_bf16_f32 v163, v166, v167
    v_smfmac_f32_16x16x64_bf16 v[188:191], v[80:83], v[220:227], v43 abid:1
    v_cvt_pk_bf16_f32 v168, v168, v169
    v_smfmac_f32_16x16x64_bf16 v[188:191], v[116:119], v[228:235], v47 abid:1
    v_cvt_pk_bf16_f32 v169, v170, v171
    v_smfmac_f32_16x16x64_bf16 v[192:195], v[84:87], v[220:227], v51 abid:1
    v_cvt_pk_bf16_f32 v170, v172, v173
    v_smfmac_f32_16x16x64_bf16 v[192:195], v[120:123], v[228:235], v52
    ds_read_b128 v[220:223], v1 offset:3072
    s_waitcnt lgkmcnt(6)
    v_cvt_pk_bf16_f32 v171, v174, v175
    v_smfmac_f32_16x16x64_bf16 v[124:127], a[0:3], v[196:203], v12
    ds_read_b128 v[224:227], v2 offset:3072
    ds_read_b128 v[172:175], v9 offset:10432
    s_waitcnt lgkmcnt(6)
    v_cndmask_b32_dpp v164, v160, v168, vcc row_ror:8 row_mask:0xf bank_mask:0xf
    v_smfmac_f32_16x16x64_bf16 v[124:127], a[36:39], v[204:211], v16
    ds_read_b128 v[228:231], v1 offset:4096
    s_waitcnt lgkmcnt(5)
    v_cndmask_b32_dpp v165, v161, v169, vcc row_ror:8 row_mask:0xf bank_mask:0xf
    v_smfmac_f32_16x16x64_bf16 v[124:127], a[72:75], v[212:219], v20
    ds_read_b128 v[232:235], v2 offset:4096
    s_waitcnt lgkmcnt(5)
    v_xad_u32 v236, v236, v3, v4
    v_smfmac_f32_16x16x64_bf16 v[156:159], a[32:35], v[196:203], v48
    s_barrier
    v_xad_u32 v237, v237, v3, v4
    v_smfmac_f32_16x16x64_bf16 v[156:159], a[68:71], v[204:211], v48 abid:1
    ds_read2st64_b32 v[244:245], v236 offset0:0 offset1:72
    ds_read_b128 v[240:243], v8 offset:3072
    v_xad_u32 v238, v238, v3, v4
    v_smfmac_f32_16x16x64_bf16 v[156:159], a[104:107], v[212:219], v49
    ds_read2st64_b32 v[246:247], v237 offset0:0 offset1:72
    v_xad_u32 v239, v239, v3, v4
    v_smfmac_f32_16x16x64_bf16 v[132:135], a[8:11], v[196:203], v13
    ds_read2st64_b32 v[248:249], v238 offset0:0 offset1:72
    v_cndmask_b32_dpp v166, v162, v170, vcc row_ror:8 row_mask:0xf bank_mask:0xf
    v_smfmac_f32_16x16x64_bf16 v[132:135], a[44:47], v[204:211], v17
    ds_read2st64_b32 v[250:251], v239 offset0:0 offset1:72
    ds_read_b128 v[236:239], v9 offset:9280
    v_cndmask_b32_dpp v167, v163, v171, vcc row_ror:8 row_mask:0xf bank_mask:0xf
    v_smfmac_f32_16x16x64_bf16 v[132:135], a[80:83], v[212:219], v21
    buffer_store_dwordx4 v[164:167], v6, s[12:15], s58 offen offset:0 sc1
    v_mov_b32_dpp v160, v168 row_ror:8 row_mask:0xf bank_mask:0xc
    v_smfmac_f32_16x16x64_bf16 v[140:143], a[16:19], v[196:203], v14
    v_mov_b32_dpp v161, v169 row_ror:8 row_mask:0xf bank_mask:0xc
    v_smfmac_f32_16x16x64_bf16 v[140:143], a[52:55], v[204:211], v18
    v_mov_b32_dpp v162, v170 row_ror:8 row_mask:0xf bank_mask:0xc
    v_smfmac_f32_16x16x64_bf16 v[140:143], a[88:91], v[212:219], v22
    v_mov_b32_dpp v163, v171 row_ror:8 row_mask:0xf bank_mask:0xc
    v_smfmac_f32_16x16x64_bf16 v[136:139], a[12:15], v[196:203], v13 abid:1
    buffer_store_dwordx4 v[160:163], v6, s[12:15], s23 offen offset:0 sc1
    ds_read_b128 v[164:167], v9 offset:10304
    ds_read_b128 v[168:171], v9 offset:10368
    v_smfmac_f32_16x16x64_bf16 v[136:139], a[48:51], v[204:211], v17 abid:1
    ds_read_b128 v[160:163], v9 offset:10240
    v_smfmac_f32_16x16x64_bf16 v[136:139], a[84:87], v[212:219], v21 abid:1
    s_waitcnt lgkmcnt(3)
    v_xad_u32 v236, v236, v3, v4
    v_smfmac_f32_16x16x64_bf16 v[136:139], v[240:243], v[244:251], v10
    v_xad_u32 v237, v237, v3, v4
    v_smfmac_f32_16x16x64_bf16 v[172:175], v[240:243], v[244:251], v10 abid:1
    ds_read2st64_b32 v[244:245], v236 offset0:0 offset1:72
    ds_read_b128 v[240:243], v8 offset:1024
    v_xad_u32 v238, v238, v3, v4
    v_smfmac_f32_16x16x64_bf16 v[144:147], a[20:23], v[196:203], v14 abid:1
    ds_read2st64_b32 v[246:247], v237 offset0:0 offset1:72
    v_xad_u32 v239, v239, v3, v4
    v_smfmac_f32_16x16x64_bf16 v[144:147], a[56:59], v[204:211], v18 abid:1
    ds_read2st64_b32 v[248:249], v238 offset0:0 offset1:72
    v_smfmac_f32_16x16x64_bf16 v[144:147], a[92:95], v[212:219], v22 abid:1
    ds_read2st64_b32 v[250:251], v239 offset0:0 offset1:72
    ds_read_b128 v[236:239], v9 offset:9344
    v_smfmac_f32_16x16x64_bf16 v[148:151], a[24:27], v[196:203], v15
    v_cvt_pk_bf16_f32 v192, v192, v193
    v_smfmac_f32_16x16x64_bf16 v[148:151], a[60:63], v[204:211], v19
    v_cvt_pk_bf16_f32 v193, v194, v195
    v_smfmac_f32_16x16x64_bf16 v[148:151], a[96:99], v[212:219], v23
    ds_write_b64 v53, v[192:193] offset:0
    ds_read_b128 v[192:195], v9 offset:10752
    v_smfmac_f32_16x16x64_bf16 v[152:155], a[28:31], v[196:203], v15 abid:1
    v_smfmac_f32_16x16x64_bf16 v[152:155], a[64:67], v[204:211], v19 abid:1
    v_smfmac_f32_16x16x64_bf16 v[152:155], a[100:103], v[212:219], v23 abid:1
    v_smfmac_f32_16x16x64_bf16 v[128:131], a[4:7], v[196:203], v12 abid:1
    v_smfmac_f32_16x16x64_bf16 v[128:131], a[40:43], v[204:211], v16 abid:1
    v_smfmac_f32_16x16x64_bf16 v[128:131], a[76:79], v[212:219], v20 abid:1
    s_waitcnt lgkmcnt(2)
    v_xad_u32 v236, v236, v3, v4
    v_smfmac_f32_16x16x64_bf16 v[128:131], v[240:243], v[244:251], v10
    ds_read_b128 v[196:199], v1 offset:5120
    v_xad_u32 v237, v237, v3, v4
    v_smfmac_f32_16x16x64_bf16 v[164:167], v[240:243], v[244:251], v10 abid:1
    ds_read2st64_b32 v[244:245], v236 offset0:0 offset1:72
    ds_read_b128 v[240:243], v8 offset:2048
    v_xad_u32 v238, v238, v3, v4
    v_smfmac_f32_16x16x64_bf16 v[124:127], a[108:111], v[220:227], v24
    ds_read2st64_b32 v[246:247], v237 offset0:0 offset1:72
    v_xad_u32 v239, v239, v3, v4
    v_smfmac_f32_16x16x64_bf16 v[124:127], a[144:147], v[228:235], v28
    ds_read2st64_b32 v[248:249], v238 offset0:0 offset1:72
    ds_read_b128 v[200:203], v2 offset:5120
    ds_read_b64 v[216:217], v9 offset:10056
    v_smfmac_f32_16x16x64_bf16 v[128:131], a[112:115], v[220:227], v24 abid:1
    ds_read2st64_b32 v[250:251], v239 offset0:0 offset1:72
    ds_read_b128 v[236:239], v9 offset:9216
    v_cvt_pk_bf16_f32 v176, v176, v177
    v_smfmac_f32_16x16x64_bf16 v[128:131], a[148:151], v[228:235], v28 abid:1
    ds_read_b128 v[204:207], v1 offset:6144
    v_cvt_pk_bf16_f32 v177, v178, v179
    v_smfmac_f32_16x16x64_bf16 v[140:143], a[124:127], v[220:227], v26
    ds_read_b128 v[208:211], v2 offset:6144
    v_cvt_pk_bf16_f32 v178, v180, v181
    v_smfmac_f32_16x16x64_bf16 v[140:143], a[160:163], v[228:235], v30
    v_cvt_pk_bf16_f32 v179, v182, v183
    v_smfmac_f32_16x16x64_bf16 v[136:139], a[120:123], v[220:227], v25 abid:1
    v_cvt_pk_bf16_f32 v184, v184, v185
    v_smfmac_f32_16x16x64_bf16 v[136:139], a[156:159], v[228:235], v29 abid:1
    v_cvt_pk_bf16_f32 v185, v186, v187
    v_smfmac_f32_16x16x64_bf16 v[132:135], a[116:119], v[220:227], v25
    v_cvt_pk_bf16_f32 v186, v188, v189
    v_smfmac_f32_16x16x64_bf16 v[132:135], a[152:155], v[228:235], v29
    s_waitcnt lgkmcnt(2)
    v_xad_u32 v236, v236, v3, v4
    v_smfmac_f32_16x16x64_bf16 v[132:135], v[240:243], v[244:251], v10
    v_xad_u32 v237, v237, v3, v4
    v_smfmac_f32_16x16x64_bf16 v[168:171], v[240:243], v[244:251], v10 abid:1
    ds_read2st64_b32 v[244:245], v236 offset0:0 offset1:72
    ds_read_b128 v[240:243], v8 offset:0
    v_xad_u32 v238, v238, v3, v4
    v_smfmac_f32_16x16x64_bf16 v[144:147], a[128:131], v[220:227], v26 abid:1
    ds_read2st64_b32 v[246:247], v237 offset0:0 offset1:72
    v_xad_u32 v239, v239, v3, v4
    v_smfmac_f32_16x16x64_bf16 v[144:147], a[164:167], v[228:235], v30 abid:1
    ds_read2st64_b32 v[248:249], v238 offset0:0 offset1:72
    v_cvt_pk_bf16_f32 v187, v190, v191
    v_smfmac_f32_16x16x64_bf16 v[148:151], a[132:135], v[220:227], v27
    ds_read2st64_b32 v[250:251], v239 offset0:0 offset1:72
    ds_read_b128 v[236:239], v9 offset:9728
    ds_read_b128 v[188:191], v9 offset:10688
    v_smfmac_f32_16x16x64_bf16 v[148:151], a[168:171], v[228:235], v31
    v_xad_u32 v212, v216, v3, v4
    v_smfmac_f32_16x16x64_bf16 v[152:155], a[136:139], v[220:227], v27 abid:1
    ds_read2st64_b32 v[212:213], v212 offset0:0 offset1:72
    v_xad_u32 v214, v217, v3, v4
    v_smfmac_f32_16x16x64_bf16 v[152:155], a[172:175], v[228:235], v31 abid:1
    ds_read2st64_b32 v[214:215], v214 offset0:0 offset1:72
    v_cndmask_b32_dpp v180, v176, v184, vcc row_ror:8 row_mask:0xf bank_mask:0xf
    v_smfmac_f32_16x16x64_bf16 v[156:159], a[140:143], v[220:227], v49 abid:1
    v_cndmask_b32_dpp v181, v177, v185, vcc row_ror:8 row_mask:0xf bank_mask:0xf
    v_smfmac_f32_16x16x64_bf16 v[156:159], a[176:179], v[228:235], v50
    ds_read_b128 v[220:223], v1 offset:7168
    v_cndmask_b32_dpp v182, v178, v186, vcc row_ror:8 row_mask:0xf bank_mask:0xf
    v_smfmac_f32_16x16x64_bf16 v[128:131], a[184:187], v[196:203], v32 abid:1
    ds_read_b128 v[224:227], v2 offset:7168
    s_waitcnt lgkmcnt(11)
    v_cndmask_b32_dpp v183, v179, v187, vcc row_ror:8 row_mask:0xf bank_mask:0xf
    v_smfmac_f32_16x16x64_bf16 v[128:131], a[220:223], v[204:211], v36 abid:1
    ds_read_b128 v[228:231], v1 offset:8192
    buffer_store_dwordx4 v[180:183], v6, s[12:15], s58 offen offset:128 sc1
    v_mov_b32_dpp v176, v184 row_ror:8 row_mask:0xf bank_mask:0xc
    v_smfmac_f32_16x16x64_bf16 v[124:127], a[180:183], v[196:203], v32
    ds_read_b128 v[232:235], v2 offset:8192
    v_mov_b32_dpp v177, v185 row_ror:8 row_mask:0xf bank_mask:0xc
    v_smfmac_f32_16x16x64_bf16 v[124:127], a[216:219], v[204:211], v36
    s_waitcnt lgkmcnt(7)
    v_xad_u32 v236, v236, v3, v4
    v_smfmac_f32_16x16x64_bf16 v[124:127], v[240:243], v[244:251], v10
    v_xad_u32 v237, v237, v3, v4
    v_smfmac_f32_16x16x64_bf16 v[160:163], v[240:243], v[244:251], v10 abid:1
    ds_read2st64_b32 v[244:245], v236 offset0:0 offset1:72
    ds_read_b128 v[240:243], v8 offset:8192
    v_xad_u32 v238, v238, v3, v4
    v_smfmac_f32_16x16x64_bf16 v[132:135], a[188:191], v[196:203], v33
    ds_read2st64_b32 v[246:247], v237 offset0:0 offset1:72
    v_xad_u32 v239, v239, v3, v4
    v_smfmac_f32_16x16x64_bf16 v[132:135], a[224:227], v[204:211], v37
    ds_read2st64_b32 v[248:249], v238 offset0:0 offset1:72
    v_mov_b32_dpp v178, v186 row_ror:8 row_mask:0xf bank_mask:0xc
    v_smfmac_f32_16x16x64_bf16 v[136:139], a[192:195], v[196:203], v33 abid:1
    ds_read2st64_b32 v[250:251], v239 offset0:0 offset1:72
    ds_read_b128 v[236:239], v9 offset:9664
    v_mov_b32_dpp v179, v187 row_ror:8 row_mask:0xf bank_mask:0xc
    v_smfmac_f32_16x16x64_bf16 v[136:139], a[228:231], v[204:211], v37 abid:1
    buffer_store_dwordx4 v[176:179], v6, s[12:15], s23 offen offset:128 sc1
    ds_read_b128 v[180:183], v9 offset:10560
    ds_read_b128 v[184:187], v9 offset:10624
    v_smfmac_f32_16x16x64_bf16 v[140:143], a[196:199], v[196:203], v34
    ds_read_b128 v[176:179], v9 offset:10496
    v_smfmac_f32_16x16x64_bf16 v[140:143], a[232:235], v[204:211], v38
    v_smfmac_f32_16x16x64_bf16 v[144:147], a[200:203], v[196:203], v34 abid:1
    v_smfmac_f32_16x16x64_bf16 v[144:147], a[236:239], v[204:211], v38 abid:1
    v_smfmac_f32_16x16x64_bf16 v[156:159], a[212:215], v[196:203], v50 abid:1
    v_smfmac_f32_16x16x64_bf16 v[156:159], a[248:251], v[204:211], v51
    s_waitcnt lgkmcnt(3)
    v_xad_u32 v236, v236, v3, v4
    v_smfmac_f32_16x16x64_bf16 v[156:159], v[240:243], v[244:251], v10
    v_xad_u32 v237, v237, v3, v4
    v_smfmac_f32_16x16x64_bf16 v[192:195], v[240:243], v[244:251], v10 abid:1
    ds_read2st64_b32 v[244:245], v236 offset0:0 offset1:72
    ds_read_b128 v[240:243], v8 offset:7168
    v_xad_u32 v238, v238, v3, v4
    v_smfmac_f32_16x16x64_bf16 v[152:155], a[208:211], v[196:203], v35 abid:1
    ds_read2st64_b32 v[246:247], v237 offset0:0 offset1:72
    v_xad_u32 v239, v239, v3, v4
    v_smfmac_f32_16x16x64_bf16 v[152:155], a[244:247], v[204:211], v39 abid:1
    ds_read2st64_b32 v[248:249], v238 offset0:0 offset1:72
    v_smfmac_f32_16x16x64_bf16 v[148:151], a[204:207], v[196:203], v35
    ds_read2st64_b32 v[250:251], v239 offset0:0 offset1:72
    ds_read_b128 v[236:239], v9 offset:9536
    v_smfmac_f32_16x16x64_bf16 v[148:151], a[240:243], v[204:211], v39
    ds_read_b128 v[196:199], v1 offset:18432
    v_smfmac_f32_16x16x64_bf16 v[124:127], a[252:255], v[220:227], v40
    ds_read_b128 v[200:203], v2 offset:18432
    v_smfmac_f32_16x16x64_bf16 v[124:127], v[88:91], v[228:235], v44
    ds_read_b128 v[204:207], v1 offset:19456
    v_smfmac_f32_16x16x64_bf16 v[128:131], v[56:59], v[220:227], v40 abid:1
    ds_read_b128 v[208:211], v2 offset:19456
    v_smfmac_f32_16x16x64_bf16 v[128:131], v[92:95], v[228:235], v44 abid:1
    s_waitcnt lgkmcnt(10)
    s_cmp_lt_i32 s81, 0
    s_cbranch_scc1 M_ovrF
    s_swappc_b64 s[78:79], s[72:73]
M_ovrF:
    v_smfmac_f32_16x16x64_bf16 v[132:135], v[60:63], v[220:227], v41
    s_cmp_lt_u32 s20, 2
    s_cselect_b32 s66, s23, s24
    s_add_u32 s66, s66, s95
    v_smfmac_f32_16x16x64_bf16 v[132:135], v[96:99], v[228:235], v45
    s_add_u32 s23, s24, 18432
    s_add_u32 s58, s24, 27648
    s_add_u32 s67, s23, s95
    v_smfmac_f32_16x16x64_bf16 v[152:155], v[80:83], v[220:227], v43 abid:1
    v_smfmac_f32_16x16x64_bf16 v[152:155], v[116:119], v[228:235], v47 abid:1
    s_waitcnt lgkmcnt(4)
    v_xad_u32 v236, v236, v3, v4
    v_smfmac_f32_16x16x64_bf16 v[152:155], v[240:243], v[244:251], v10
    v_xad_u32 v237, v237, v3, v4
    v_smfmac_f32_16x16x64_bf16 v[188:191], v[240:243], v[244:251], v10 abid:1
    s_cmp_gt_u32 s46, s80
    s_cbranch_scc1 M_slow
M_slowrF:
    v_xad_u32 v238, v238, v3, v4
    v_smfmac_f32_16x16x64_bf16 v[140:143], v[68:71], v[220:227], v42
    ds_read2st64_b32 v[244:245], v236 offset0:0 offset1:72
    ds_read_b128 v[240:243], v8 offset:5120
    v_xad_u32 v239, v239, v3, v4
    v_smfmac_f32_16x16x64_bf16 v[140:143], v[104:107], v[228:235], v46
    ds_read2st64_b32 v[246:247], v237 offset0:0 offset1:72
    v_smfmac_f32_16x16x64_bf16 v[156:159], v[84:87], v[220:227], v51 abid:1
    ds_read2st64_b32 v[248:249], v238 offset0:0 offset1:72
    ds_read_b128 v[212:215], v1 offset:20480
    v_smfmac_f32_16x16x64_bf16 v[156:159], v[120:123], v[228:235], v52
    ds_read2st64_b32 v[250:251], v239 offset0:0 offset1:72
    ds_read_b128 v[236:239], v9 offset:9600
    v_smfmac_f32_16x16x64_bf16 v[148:151], v[76:79], v[220:227], v43
    ds_read_b128 v[216:219], v2 offset:20480
    v_smfmac_f32_16x16x64_bf16 v[148:151], v[112:115], v[228:235], v47
    v_smfmac_f32_16x16x64_bf16 v[136:139], v[64:67], v[220:227], v41 abid:1
    v_smfmac_f32_16x16x64_bf16 v[136:139], v[100:103], v[228:235], v45 abid:1
    v_smfmac_f32_16x16x64_bf16 v[144:147], v[72:75], v[220:227], v42 abid:1
    v_smfmac_f32_16x16x64_bf16 v[144:147], v[108:111], v[228:235], v46 abid:1
    ds_read_b128 v[220:223], v1 offset:21504
    s_waitcnt lgkmcnt(2)
    v_xad_u32 v236, v236, v3, v4
    v_smfmac_f32_16x16x64_bf16 v[144:147], v[240:243], v[244:251], v10
    ds_read_b128 v[224:227], v2 offset:21504
    v_xad_u32 v237, v237, v3, v4
    v_smfmac_f32_16x16x64_bf16 v[180:183], v[240:243], v[244:251], v10 abid:1
    ds_read2st64_b32 v[244:245], v236 offset0:0 offset1:72
    ds_read_b128 v[240:243], v8 offset:6144
    v_xad_u32 v238, v238, v3, v4
    v_smfmac_f32_16x16x64_bf16 v[192:195], a[32:35], v[196:203], v48
    ds_read2st64_b32 v[246:247], v237 offset0:0 offset1:72
    ds_read_b128 v[228:231], v1 offset:22528
    v_xad_u32 v239, v239, v3, v4
    v_smfmac_f32_16x16x64_bf16 v[192:195], a[68:71], v[204:211], v48 abid:1
    ds_read2st64_b32 v[248:249], v238 offset0:0 offset1:72
    ds_read_b128 v[232:235], v2 offset:22528
    s_waitcnt lgkmcnt(8)
    v_cvt_pk_bf16_f32 v124, v124, v125
    v_smfmac_f32_16x16x64_bf16 v[192:195], a[104:107], v[212:219], v49
    ds_read2st64_b32 v[250:251], v239 offset0:0 offset1:72
    ds_read_b128 v[236:239], v9 offset:9472
    v_cvt_pk_bf16_f32 v125, v126, v127
    v_smfmac_f32_16x16x64_bf16 v[160:163], a[0:3], v[196:203], v12
    v_cvt_pk_bf16_f32 v126, v128, v129
    v_smfmac_f32_16x16x64_bf16 v[160:163], a[36:39], v[204:211], v16
    v_cvt_pk_bf16_f32 v127, v130, v131
    v_smfmac_f32_16x16x64_bf16 v[160:163], a[72:75], v[212:219], v20
    v_cvt_pk_bf16_f32 v156, v156, v157
    v_smfmac_f32_16x16x64_bf16 v[164:167], a[4:7], v[196:203], v12 abid:1
    v_cvt_pk_bf16_f32 v157, v158, v159
    v_smfmac_f32_16x16x64_bf16 v[164:167], a[40:43], v[204:211], v16 abid:1
    ds_write_b64 v53, v[156:157] offset:25728
    v_cvt_pk_bf16_f32 v132, v132, v133
    v_smfmac_f32_16x16x64_bf16 v[164:167], a[76:79], v[212:219], v20 abid:1
    v_cvt_pk_bf16_f32 v133, v134, v135
    v_smfmac_f32_16x16x64_bf16 v[168:171], a[8:11], v[196:203], v13
    v_cvt_pk_bf16_f32 v134, v136, v137
    v_smfmac_f32_16x16x64_bf16 v[168:171], a[44:47], v[204:211], v17
    v_cvt_pk_bf16_f32 v135, v138, v139
    v_smfmac_f32_16x16x64_bf16 v[168:171], a[80:83], v[212:219], v21
    s_waitcnt lgkmcnt(1)
    v_xad_u32 v236, v236, v3, v4
    v_smfmac_f32_16x16x64_bf16 v[184:187], v[240:243], v[244:251], v10 abid:1
    v_xad_u32 v237, v237, v3, v4
    v_smfmac_f32_16x16x64_bf16 v[148:151], v[240:243], v[244:251], v10
    ds_read2st64_b32 v[244:245], v236 offset0:0 offset1:72
    ds_read_b128 v[240:243], v8 offset:4096
    v_xad_u32 v238, v238, v3, v4
    v_smfmac_f32_16x16x64_bf16 v[172:175], a[12:15], v[196:203], v13 abid:1
    ds_read2st64_b32 v[246:247], v237 offset0:0 offset1:72
    v_xad_u32 v239, v239, v3, v4
    v_smfmac_f32_16x16x64_bf16 v[172:175], a[48:51], v[204:211], v17 abid:1
    ds_read2st64_b32 v[248:249], v238 offset0:0 offset1:72
    v_cndmask_b32_dpp v128, v124, v132, vcc row_ror:8 row_mask:0xf bank_mask:0xf
    v_smfmac_f32_16x16x64_bf16 v[172:175], a[84:87], v[212:219], v21 abid:1
    ds_read2st64_b32 v[250:251], v239 offset0:0 offset1:72
    ds_read_b128 v[196:199], v1 offset:23552
    v_cndmask_b32_dpp v129, v125, v133, vcc row_ror:8 row_mask:0xf bank_mask:0xf
    v_smfmac_f32_16x16x64_bf16 v[192:195], a[140:143], v[220:227], v49 abid:1
    ds_read_b128 v[200:203], v2 offset:23552
    v_cndmask_b32_dpp v130, v126, v134, vcc row_ror:8 row_mask:0xf bank_mask:0xf
    v_smfmac_f32_16x16x64_bf16 v[192:195], a[176:179], v[228:235], v50
    ds_read_b128 v[204:207], v1 offset:24576
    v_cndmask_b32_dpp v131, v127, v135, vcc row_ror:8 row_mask:0xf bank_mask:0xf
    v_smfmac_f32_16x16x64_bf16 v[160:163], a[108:111], v[220:227], v24
    ds_read_b128 v[208:211], v2 offset:24576
    buffer_store_dwordx4 v[128:131], v6, s[12:15], s59 offen offset:0 sc1
    v_mov_b32_dpp v124, v132 row_ror:8 row_mask:0xf bank_mask:0xc
    v_smfmac_f32_16x16x64_bf16 v[160:163], a[144:147], v[228:235], v28
    s_waitcnt lgkmcnt(9)
    s_barrier
    ds_read_b128 v[236:239], v8 offset:10816
    v_mov_b32_dpp v125, v133 row_ror:8 row_mask:0xf bank_mask:0xc
    v_smfmac_f32_16x16x64_bf16 v[164:167], a[112:115], v[220:227], v24 abid:1
    ds_read_b128 v[212:215], v1 offset:20480
    v_mov_b32_dpp v126, v134 row_ror:8 row_mask:0xf bank_mask:0xc
    v_smfmac_f32_16x16x64_bf16 v[164:167], a[148:151], v[228:235], v28 abid:1
    ds_read_b128 v[216:219], v2 offset:20480
    v_mov_b32_dpp v127, v135 row_ror:8 row_mask:0xf bank_mask:0xc
    v_smfmac_f32_16x16x64_bf16 v[168:171], a[116:119], v[220:227], v25
    buffer_store_dwordx4 v[124:127], v6, s[12:15], s24 offen offset:0 sc1
    v_smfmac_f32_16x16x64_bf16 v[168:171], a[152:155], v[228:235], v29
    s_waitcnt lgkmcnt(7)
    v_smfmac_f32_16x16x64_bf16 v[176:179], v[240:243], v[244:251], v10 abid:1
    v_smfmac_f32_16x16x64_bf16 v[140:143], v[240:243], v[244:251], v10
    s_waitcnt lgkmcnt(2)
    buffer_store_dwordx4 v[236:239], v7, s[12:15], s66 offen sc1
    v_smfmac_f32_16x16x64_bf16 v[172:175], a[120:123], v[220:227], v25 abid:1
    v_smfmac_f32_16x16x64_bf16 v[172:175], a[156:159], v[228:235], v29 abid:1
    ds_read_b128 v[220:223], v1 offset:25600
    v_smfmac_f32_16x16x64_bf16 v[192:195], a[212:215], v[196:203], v50 abid:1
    ds_read_b128 v[224:227], v2 offset:25600
    s_nop 0
    v_cvt_pk_bf16_f32 v140, v140, v141
    v_smfmac_f32_16x16x64_bf16 v[192:195], a[248:251], v[204:211], v51
    ds_read_b128 v[228:231], v1 offset:26624
    v_cvt_pk_bf16_f32 v141, v142, v143
    v_smfmac_f32_16x16x64_bf16 v[160:163], a[180:183], v[196:203], v32
    ds_read_b128 v[232:235], v2 offset:26624
    v_cvt_pk_bf16_f32 v142, v144, v145
    v_smfmac_f32_16x16x64_bf16 v[160:163], a[216:219], v[204:211], v36
    v_cvt_pk_bf16_f32 v143, v146, v147
    v_smfmac_f32_16x16x64_bf16 v[164:167], a[184:187], v[196:203], v32 abid:1
    v_cvt_pk_bf16_f32 v148, v148, v149
    v_smfmac_f32_16x16x64_bf16 v[164:167], a[220:223], v[204:211], v36 abid:1
    v_cvt_pk_bf16_f32 v149, v150, v151
    v_smfmac_f32_16x16x64_bf16 v[168:171], a[188:191], v[196:203], v33
    v_cvt_pk_bf16_f32 v150, v152, v153
    v_smfmac_f32_16x16x64_bf16 v[168:171], a[224:227], v[204:211], v37
    v_cvt_pk_bf16_f32 v151, v154, v155
    v_smfmac_f32_16x16x64_bf16 v[172:175], a[192:195], v[196:203], v33 abid:1
    v_cndmask_b32_dpp v144, v140, v148, vcc row_ror:8 row_mask:0xf bank_mask:0xf
    v_smfmac_f32_16x16x64_bf16 v[172:175], a[228:231], v[204:211], v37 abid:1
    ds_read_b128 v[196:199], v1 offset:18432
    s_waitcnt lgkmcnt(3)
    v_cndmask_b32_dpp v145, v141, v149, vcc row_ror:8 row_mask:0xf bank_mask:0xf
    v_smfmac_f32_16x16x64_bf16 v[192:195], v[84:87], v[220:227], v51 abid:1
    ds_read_b128 v[200:203], v2 offset:18432
    s_waitcnt lgkmcnt(2)
    v_cndmask_b32_dpp v146, v142, v150, vcc row_ror:8 row_mask:0xf bank_mask:0xf
    v_smfmac_f32_16x16x64_bf16 v[192:195], v[120:123], v[228:235], v52
    ds_read_b128 v[204:207], v1 offset:19456
    v_cndmask_b32_dpp v147, v143, v151, vcc row_ror:8 row_mask:0xf bank_mask:0xf
    v_smfmac_f32_16x16x64_bf16 v[160:163], a[252:255], v[220:227], v40
    ds_read_b128 v[208:211], v2 offset:19456
    buffer_store_dwordx4 v[144:147], v6, s[12:15], s59 offen offset:128 sc1
    v_mov_b32_dpp v140, v148 row_ror:8 row_mask:0xf bank_mask:0xc
    v_smfmac_f32_16x16x64_bf16 v[160:163], v[88:91], v[228:235], v44
    v_mov_b32_dpp v141, v149 row_ror:8 row_mask:0xf bank_mask:0xc
    v_smfmac_f32_16x16x64_bf16 v[164:167], v[56:59], v[220:227], v40 abid:1
    v_mov_b32_dpp v142, v150 row_ror:8 row_mask:0xf bank_mask:0xc
    v_smfmac_f32_16x16x64_bf16 v[164:167], v[92:95], v[228:235], v44 abid:1
    v_mov_b32_dpp v143, v151 row_ror:8 row_mask:0xf bank_mask:0xc
    v_smfmac_f32_16x16x64_bf16 v[168:171], v[60:63], v[220:227], v41
    buffer_store_dwordx4 v[140:143], v6, s[12:15], s24 offen offset:128 sc1
    v_cvt_pk_bf16_f32 v192, v192, v193
    v_smfmac_f32_16x16x64_bf16 v[168:171], v[96:99], v[228:235], v45
    v_cvt_pk_bf16_f32 v193, v194, v195
    v_smfmac_f32_16x16x64_bf16 v[172:175], v[64:67], v[220:227], v41 abid:1
    ds_write_b64 v53, v[192:193] offset:1024
    v_smfmac_f32_16x16x64_bf16 v[172:175], v[100:103], v[228:235], v45 abid:1
    ds_read_b128 v[220:223], v1 offset:21504
    s_waitcnt lgkmcnt(4)
    v_smfmac_f32_16x16x64_bf16 v[176:179], a[16:19], v[196:203], v14
    ds_read_b128 v[224:227], v2 offset:21504
    s_waitcnt lgkmcnt(3)
    v_smfmac_f32_16x16x64_bf16 v[176:179], a[52:55], v[204:211], v18
    ds_read_b128 v[228:231], v1 offset:22528
    v_smfmac_f32_16x16x64_bf16 v[176:179], a[88:91], v[212:219], v22
    ds_read_b128 v[232:235], v2 offset:22528
    s_waitcnt lgkmcnt(4)
    s_barrier
    ds_read_b128 v[236:239], v8 offset:11840
    v_smfmac_f32_16x16x64_bf16 v[180:183], a[20:23], v[196:203], v14 abid:1
    v_cvt_pk_bf16_f32 v160, v160, v161
    v_smfmac_f32_16x16x64_bf16 v[180:183], a[56:59], v[204:211], v18 abid:1
    v_cvt_pk_bf16_f32 v161, v162, v163
    v_smfmac_f32_16x16x64_bf16 v[180:183], a[92:95], v[212:219], v22 abid:1
    v_cvt_pk_bf16_f32 v162, v164, v165
    v_smfmac_f32_16x16x64_bf16 v[184:187], a[24:27], v[196:203], v15
    v_cvt_pk_bf16_f32 v163, v166, v167
    v_smfmac_f32_16x16x64_bf16 v[184:187], a[60:63], v[204:211], v19
    v_cvt_pk_bf16_f32 v168, v168, v169
    v_smfmac_f32_16x16x64_bf16 v[184:187], a[96:99], v[212:219], v23
    s_cmp_lt_u32 s20, 2
    s_waitcnt lgkmcnt(0)
    s_cbranch_scc0 M_fx
    buffer_store_dwordx4 v[236:239], v7, s[12:15], s67 offen sc1
M_fx:
    v_smfmac_f32_16x16x64_bf16 v[188:191], a[28:31], v[196:203], v15 abid:1
    v_cvt_pk_bf16_f32 v169, v170, v171
    v_smfmac_f32_16x16x64_bf16 v[188:191], a[64:67], v[204:211], v19 abid:1
    v_cvt_pk_bf16_f32 v170, v172, v173
    v_smfmac_f32_16x16x64_bf16 v[188:191], a[100:103], v[212:219], v23 abid:1
    ds_read_b128 v[196:199], v1 offset:23552
    v_cvt_pk_bf16_f32 v171, v174, v175
    v_smfmac_f32_16x16x64_bf16 v[176:179], a[124:127], v[220:227], v26
    ds_read_b128 v[200:203], v2 offset:23552
    v_cndmask_b32_dpp v164, v160, v168, vcc row_ror:8 row_mask:0xf bank_mask:0xf
    v_smfmac_f32_16x16x64_bf16 v[176:179], a[160:163], v[228:235], v30
    ds_read_b128 v[204:207], v1 offset:24576
    v_cndmask_b32_dpp v165, v161, v169, vcc row_ror:8 row_mask:0xf bank_mask:0xf
    v_smfmac_f32_16x16x64_bf16 v[180:183], a[128:131], v[220:227], v26 abid:1
    ds_read_b128 v[208:211], v2 offset:24576
    v_cndmask_b32_dpp v166, v162, v170, vcc row_ror:8 row_mask:0xf bank_mask:0xf
    v_smfmac_f32_16x16x64_bf16 v[180:183], a[164:167], v[228:235], v30 abid:1
    v_cndmask_b32_dpp v167, v163, v171, vcc row_ror:8 row_mask:0xf bank_mask:0xf
    v_smfmac_f32_16x16x64_bf16 v[184:187], a[132:135], v[220:227], v27
    buffer_store_dwordx4 v[164:167], v6, s[12:15], s58 offen offset:0 sc1
    v_mov_b32_dpp v160, v168 row_ror:8 row_mask:0xf bank_mask:0xc
    v_smfmac_f32_16x16x64_bf16 v[184:187], a[168:171], v[228:235], v31
    v_mov_b32_dpp v161, v169 row_ror:8 row_mask:0xf bank_mask:0xc
    v_smfmac_f32_16x16x64_bf16 v[188:191], a[136:139], v[220:227], v27 abid:1
    v_mov_b32_dpp v162, v170 row_ror:8 row_mask:0xf bank_mask:0xc
    v_smfmac_f32_16x16x64_bf16 v[188:191], a[172:175], v[228:235], v31 abid:1
    ds_read_b128 v[220:223], v1 offset:25600
    s_waitcnt lgkmcnt(3)
    v_mov_b32_dpp v163, v171 row_ror:8 row_mask:0xf bank_mask:0xc
    v_smfmac_f32_16x16x64_bf16 v[176:179], a[196:199], v[196:203], v34
    ds_read_b128 v[224:227], v2 offset:25600
    buffer_store_dwordx4 v[160:163], v6, s[12:15], s23 offen offset:0 sc1
    s_waitcnt lgkmcnt(2)
    v_smfmac_f32_16x16x64_bf16 v[176:179], a[232:235], v[204:211], v38
    ds_read_b128 v[228:231], v1 offset:26624
    v_smfmac_f32_16x16x64_bf16 v[180:183], a[200:203], v[196:203], v34 abid:1
    ds_read_b128 v[232:235], v2 offset:26624
    v_smfmac_f32_16x16x64_bf16 v[180:183], a[236:239], v[204:211], v38 abid:1
    v_smfmac_f32_16x16x64_bf16 v[184:187], a[204:207], v[196:203], v35
    v_smfmac_f32_16x16x64_bf16 v[184:187], a[240:243], v[204:211], v39
    v_smfmac_f32_16x16x64_bf16 v[188:191], a[208:211], v[196:203], v35 abid:1
    v_smfmac_f32_16x16x64_bf16 v[188:191], a[244:247], v[204:211], v39 abid:1
    s_waitcnt lgkmcnt(2)
    v_smfmac_f32_16x16x64_bf16 v[176:179], v[68:71], v[220:227], v42
    s_waitcnt lgkmcnt(0)
    v_smfmac_f32_16x16x64_bf16 v[176:179], v[104:107], v[228:235], v46
    v_smfmac_f32_16x16x64_bf16 v[180:183], v[72:75], v[220:227], v42 abid:1
    v_smfmac_f32_16x16x64_bf16 v[180:183], v[108:111], v[228:235], v46 abid:1
    v_smfmac_f32_16x16x64_bf16 v[184:187], v[76:79], v[220:227], v43
    v_smfmac_f32_16x16x64_bf16 v[184:187], v[112:115], v[228:235], v47
    v_smfmac_f32_16x16x64_bf16 v[188:191], v[80:83], v[220:227], v43 abid:1
    v_smfmac_f32_16x16x64_bf16 v[188:191], v[116:119], v[228:235], v47 abid:1
    s_nop 1
    v_cvt_pk_bf16_f32 v176, v176, v177
    v_cvt_pk_bf16_f32 v177, v178, v179
    v_cvt_pk_bf16_f32 v178, v180, v181
    v_cvt_pk_bf16_f32 v179, v182, v183
    v_cvt_pk_bf16_f32 v184, v184, v185
    v_cvt_pk_bf16_f32 v185, v186, v187
    v_cvt_pk_bf16_f32 v186, v188, v189
    v_cvt_pk_bf16_f32 v187, v190, v191
    v_cndmask_b32_dpp v180, v176, v184, vcc row_ror:8 row_mask:0xf bank_mask:0xf
    v_cndmask_b32_dpp v181, v177, v185, vcc row_ror:8 row_mask:0xf bank_mask:0xf
    v_cndmask_b32_dpp v182, v178, v186, vcc row_ror:8 row_mask:0xf bank_mask:0xf
    v_cndmask_b32_dpp v183, v179, v187, vcc row_ror:8 row_mask:0xf bank_mask:0xf
    buffer_store_dwordx4 v[180:183], v6, s[12:15], s58 offen offset:128 sc1
    v_mov_b32_dpp v176, v184 row_ror:8 row_mask:0xf bank_mask:0xc
    v_mov_b32_dpp v177, v185 row_ror:8 row_mask:0xf bank_mask:0xc
    v_mov_b32_dpp v178, v186 row_ror:8 row_mask:0xf bank_mask:0xc
    v_mov_b32_dpp v179, v187 row_ror:8 row_mask:0xf bank_mask:0xc
    buffer_store_dwordx4 v[176:179], v6, s[12:15], s23 offen offset:128 sc1
M_done:
M_end:
    s_endpgm
M_pf_spin:
    s_sleep 4
    v_mov_b32 v0, 0
    s_mov_b64 exec, 1
    buffer_atomic_add v0, off, s[16:19], s96 sc0 sc1
    s_mov_b64 exec, -1
    s_add_u32 s31, s31, 1
    s_waitcnt vmcnt(0)
    v_readfirstlane_b32 s30, v0
    s_nop 0
    s_sub_u32 s30, s30, s100
    s_cmp_eq_u32 s30, 27
    s_cbranch_scc1 M_pf_ok
    s_cmp_lt_u32 s31, 6
    s_cbranch_scc1 M_pf_spin
    s_cmp_eq_u32 s98, 0
    s_cbranch_scc1 M_pf_spin2
    s_mov_b32 s98, 0
    v_mov_b32 v250, 1
    s_mov_b64 exec, 1
    buffer_atomic_add v250, off, s[68:71], 0 offset:0 sc1
    s_mov_b64 exec, -1
    s_nop 3
M_pf_spin2:
    buffer_load_dword v0, off, s[68:71], 0 offset:0 sc1
    s_cmp_ge_u32 s31, 131072
    s_cbranch_scc1 M_end
    s_waitcnt vmcnt(0)
    v_readfirstlane_b32 s30, v0
    s_nop 0
    s_cmp_eq_u32 s30, 81
    s_cbranch_scc0 M_pf_spin
    s_branch M_pf_ok
M_r3:
    v_bfe_u32 v74, v60, 24, 4
    v_lshlrev_b32 v75, 1, v60
    v_lshl_add_u32 v74, v74, 2, s49
    v_and_b32 v75, 16, v75
    v_and_or_b32 v74, v60, 2.0, v74
    v_lshlrev_b32 v75, v75, 1
    ds_add_rtn_u32 v64, v74, v75
    v_and_b32 v74, 8, v60
    v_lshrrev_b32 v77, 14, v60
    v_cmp_ne_u32 s[44:45], 0, v74
    v_and_b32 v80, 0x3cf0, v77
    s_waitcnt lgkmcnt(0)
    v_lshrrev_b32 v75, 16, v64
    v_and_b32 v76, 0xffff, v64
    v_sub_u32 v74, 15, v75
    v_and_b32 v64, 2.0, v60
    v_add3_u32 v64, v76, v75, v64
    v_cndmask_b32 v74, v76, v74, s[44:45]
    v_cmp_gt_u32 s[44:45], 16, v64
    v_cmp_gt_u32 s[36:37], 2.0, v64
    v_lshlrev_b32 v74, 2, v74
    v_lshrrev_b64 v[76:77], v74, s[50:51]
    s_andn2_b64 s[36:37], s[36:37], s[44:45]
    v_lshrrev_b64 v[78:79], v74, s[52:53]
    v_bfe_u32 v74, v60, 24, 4
    v_mbcnt_lo_u32_b32 v75, s36, 0
    v_and_b32 v76, 15, v76
    v_mbcnt_hi_u32_b32 v75, s37, v75
    v_and_b32 v78, 15, v78
    v_lshl_add_u32 v75, v75, 3, s40
    v_lshl_add_u32 v76, v74, 4, v76
    v_min_u32 v75, s41, v75
    v_mul_u32_u24 v78, 68, v78
    v_cndmask_b32 v75, v82, v75, s[36:37]
    ds_write_b64 v75, v[60:61]
    s_bcnt1_i32_b64 s30, s[36:37]
    s_lshl3_add_u32 s40, s30, s40
    v_lshl_add_u32 v76, v76, 2, s47
    v_and_b32 v78, 0x30c, v78
    v_cndmask_b32 v76, v82, v76, s[44:45]
    v_add3_u32 v77, v80, v78, s29
    v_and_b32 v78, 0x3fff, v60
    v_cndmask_b32 v74, v82, v77, s[44:45]
    ds_write_b32 v76, v78
    ds_write_b32 v74, v61
    s_cmp_gt_u32 s38, s39
    s_cselect_b32 s32, 1, s32
    s_branch M_r3r
M_dn:
    s_mov_b32 s27, 0
    s_mov_b32 s46, 0x80000000
    v_mov_b32 v244, 0
    v_mov_b32 v245, 0
    v_mov_b32 v246, 0
    v_mov_b32 v247, 0
    ds_write_b128 v8, v[244:247] offset:0
    ds_write_b128 v8, v[244:247] offset:1024
    ds_write_b128 v8, v[244:247] offset:2048
    ds_write_b128 v8, v[244:247] offset:3072
    ds_write_b128 v8, v[244:247] offset:4096
    ds_write_b128 v8, v[244:247] offset:5120
    ds_write_b128 v8, v[244:247] offset:6144
    ds_write_b128 v8, v[244:247] offset:7168
    ds_write_b128 v8, v[244:247] offset:8192
    s_waitcnt lgkmcnt(0)
    s_branch M_dnr
M_ovc0:
    v_smfmac_f32_16x16x32_bf16 v[124:127], v[54:55], v[212:215], v10
    v_smfmac_f32_16x16x32_bf16 v[160:163], v[54:55], v[212:215], v10 abid:2
    s_setpc_b64 s[74:75]
    v_smfmac_f32_16x16x32_bf16 v[128:131], v[54:55], v[212:215], v10
    v_smfmac_f32_16x16x32_bf16 v[164:167], v[54:55], v[212:215], v10 abid:2
    s_setpc_b64 s[74:75]
    v_smfmac_f32_16x16x32_bf16 v[132:135], v[54:55], v[212:215], v10
    v_smfmac_f32_16x16x32_bf16 v[168:171], v[54:55], v[212:215], v10 abid:2
    s_setpc_b64 s[74:75]
    v_smfmac_f32_16x16x32_bf16 v[136:139], v[54:55], v[212:215], v10
    v_smfmac_f32_16x16x32_bf16 v[172:175], v[54:55], v[212:215], v10 abid:2
    s_setpc_b64 s[74:75]
    v_smfmac_f32_16x16x32_bf16 v[140:143], v[54:55], v[212:215], v10
    v_smfmac_f32_16x16x32_bf16 v[176:179], v[54:55], v[212:215], v10 abid:2
    s_setpc_b64 s[74:75]
    v_smfmac_f32_16x16x32_bf16 v[144:147], v[54:55], v[212:215], v10
    v_smfmac_f32_16x16x32_bf16 v[180:183], v[54:55], v[212:215], v10 abid:2
    s_setpc_b64 s[74:75]
    v_smfmac_f32_16x16x32_bf16 v[148:151], v[54:55], v[212:215], v10
    v_smfmac_f32_16x16x32_bf16 v[184:187], v[54:55], v[212:215], v10 abid:2
    s_setpc_b64 s[74:75]
    v_smfmac_f32_16x16x32_bf16 v[152:155], v[54:55], v[212:215], v10
    v_smfmac_f32_16x16x32_bf16 v[188:191], v[54:55], v[212:215], v10 abid:2
    s_setpc_b64 s[74:75]
    v_smfmac_f32_16x16x32_bf16 v[156:159], v[54:55], v[212:215], v10
    v_smfmac_f32_16x16x32_bf16 v[192:195], v[54:55], v[212:215], v10 abid:2
    s_setpc_b64 s[74:75]
M_ovl0:
    v_smfmac_f32_16x16x32_bf16 v[124:127], v[54:55], v[212:215], v10
    v_smfmac_f32_16x16x32_bf16 v[160:163], v[54:55], v[212:215], v10 abid:2
    s_setpc_b64 s[78:79]
    v_smfmac_f32_16x16x32_bf16 v[128:131], v[54:55], v[212:215], v10
    v_smfmac_f32_16x16x32_bf16 v[164:167], v[54:55], v[212:215], v10 abid:2
    s_setpc_b64 s[78:79]
    v_smfmac_f32_16x16x32_bf16 v[132:135], v[54:55], v[212:215], v10
    v_smfmac_f32_16x16x32_bf16 v[168:171], v[54:55], v[212:215], v10 abid:2
    s_setpc_b64 s[78:79]
    v_smfmac_f32_16x16x32_bf16 v[136:139], v[54:55], v[212:215], v10
    v_smfmac_f32_16x16x32_bf16 v[172:175], v[54:55], v[212:215], v10 abid:2
    s_setpc_b64 s[78:79]
    v_smfmac_f32_16x16x32_bf16 v[140:143], v[54:55], v[212:215], v10
    v_smfmac_f32_16x16x32_bf16 v[176:179], v[54:55], v[212:215], v10 abid:2
    s_setpc_b64 s[78:79]
    v_smfmac_f32_16x16x32_bf16 v[144:147], v[54:55], v[212:215], v10
    v_smfmac_f32_16x16x32_bf16 v[180:183], v[54:55], v[212:215], v10 abid:2
    s_setpc_b64 s[78:79]
    v_smfmac_f32_16x16x32_bf16 v[148:151], v[54:55], v[212:215], v10
    v_smfmac_f32_16x16x32_bf16 v[184:187], v[54:55], v[212:215], v10 abid:2
    s_setpc_b64 s[78:79]
    v_smfmac_f32_16x16x32_bf16 v[152:155], v[54:55], v[212:215], v10
    v_smfmac_f32_16x16x32_bf16 v[188:191], v[54:55], v[212:215], v10 abid:2
    s_setpc_b64 s[78:79]
    v_smfmac_f32_16x16x32_bf16 v[156:159], v[54:55], v[212:215], v10
    v_smfmac_f32_16x16x32_bf16 v[192:195], v[54:55], v[212:215], v10 abid:2
    s_setpc_b64 s[78:79]
M_ovc1:
    v_smfmac_f32_16x16x32_bf16 v[124:127], v[252:253], v[212:215], v10
    v_smfmac_f32_16x16x32_bf16 v[160:163], v[252:253], v[212:215], v10 abid:2
    s_setpc_b64 s[76:77]
    v_smfmac_f32_16x16x32_bf16 v[128:131], v[252:253], v[212:215], v10
    v_smfmac_f32_16x16x32_bf16 v[164:167], v[252:253], v[212:215], v10 abid:2
    s_setpc_b64 s[76:77]
    v_smfmac_f32_16x16x32_bf16 v[132:135], v[252:253], v[212:215], v10
    v_smfmac_f32_16x16x32_bf16 v[168:171], v[252:253], v[212:215], v10 abid:2
    s_setpc_b64 s[76:77]
    v_smfmac_f32_16x16x32_bf16 v[136:139], v[252:253], v[212:215], v10
    v_smfmac_f32_16x16x32_bf16 v[172:175], v[252:253], v[212:215], v10 abid:2
    s_setpc_b64 s[76:77]
    v_smfmac_f32_16x16x32_bf16 v[140:143], v[252:253], v[212:215], v10
    v_smfmac_f32_16x16x32_bf16 v[176:179], v[252:253], v[212:215], v10 abid:2
    s_setpc_b64 s[76:77]
    v_smfmac_f32_16x16x32_bf16 v[144:147], v[252:253], v[212:215], v10
    v_smfmac_f32_16x16x32_bf16 v[180:183], v[252:253], v[212:215], v10 abid:2
    s_setpc_b64 s[76:77]
    v_smfmac_f32_16x16x32_bf16 v[148:151], v[252:253], v[212:215], v10
    v_smfmac_f32_16x16x32_bf16 v[184:187], v[252:253], v[212:215], v10 abid:2
    s_setpc_b64 s[76:77]
    v_smfmac_f32_16x16x32_bf16 v[152:155], v[252:253], v[212:215], v10
    v_smfmac_f32_16x16x32_bf16 v[188:191], v[252:253], v[212:215], v10 abid:2
    s_setpc_b64 s[76:77]
    v_smfmac_f32_16x16x32_bf16 v[156:159], v[252:253], v[212:215], v10
    v_smfmac_f32_16x16x32_bf16 v[192:195], v[252:253], v[212:215], v10 abid:2
    s_setpc_b64 s[76:77]
M_ovl1:
    v_smfmac_f32_16x16x32_bf16 v[124:127], v[252:253], v[212:215], v10
    v_smfmac_f32_16x16x32_bf16 v[160:163], v[252:253], v[212:215], v10 abid:2
    s_setpc_b64 s[78:79]
    v_smfmac_f32_16x16x32_bf16 v[128:131], v[252:253], v[212:215], v10
    v_smfmac_f32_16x16x32_bf16 v[164:167], v[252:253], v[212:215], v10 abid:2
    s_setpc_b64 s[78:79]
    v_smfmac_f32_16x16x32_bf16 v[132:135], v[252:253], v[212:215], v10
    v_smfmac_f32_16x16x32_bf16 v[168:171], v[252:253], v[212:215], v10 abid:2
    s_setpc_b64 s[78:79]
    v_smfmac_f32_16x16x32_bf16 v[136:139], v[252:253], v[212:215], v10
    v_smfmac_f32_16x16x32_bf16 v[172:175], v[252:253], v[212:215], v10 abid:2
    s_setpc_b64 s[78:79]
    v_smfmac_f32_16x16x32_bf16 v[140:143], v[252:253], v[212:215], v10
    v_smfmac_f32_16x16x32_bf16 v[176:179], v[252:253], v[212:215], v10 abid:2
    s_setpc_b64 s[78:79]
    v_smfmac_f32_16x16x32_bf16 v[144:147], v[252:253], v[212:215], v10
    v_smfmac_f32_16x16x32_bf16 v[180:183], v[252:253], v[212:215], v10 abid:2
    s_setpc_b64 s[78:79]
    v_smfmac_f32_16x16x32_bf16 v[148:151], v[252:253], v[212:215], v10
    v_smfmac_f32_16x16x32_bf16 v[184:187], v[252:253], v[212:215], v10 abid:2
    s_setpc_b64 s[78:79]
    v_smfmac_f32_16x16x32_bf16 v[152:155], v[252:253], v[212:215], v10
    v_smfmac_f32_16x16x32_bf16 v[188:191], v[252:253], v[212:215], v10 abid:2
    s_setpc_b64 s[78:79]
    v_smfmac_f32_16x16x32_bf16 v[156:159], v[252:253], v[212:215], v10
    v_smfmac_f32_16x16x32_bf16 v[192:195], v[252:253], v[212:215], v10 abid:2
    s_setpc_b64 s[78:79]
M_ovl2:
    v_smfmac_f32_16x16x32_bf16 v[124:127], v[254:255], v[212:215], v10
    v_smfmac_f32_16x16x32_bf16 v[160:163], v[254:255], v[212:215], v10 abid:2
    s_setpc_b64 s[78:79]
    v_smfmac_f32_16x16x32_bf16 v[128:131], v[254:255], v[212:215], v10
    v_smfmac_f32_16x16x32_bf16 v[164:167], v[254:255], v[212:215], v10 abid:2
    s_setpc_b64 s[78:79]
    v_smfmac_f32_16x16x32_bf16 v[132:135], v[254:255], v[212:215], v10
    v_smfmac_f32_16x16x32_bf16 v[168:171], v[254:255], v[212:215], v10 abid:2
    s_setpc_b64 s[78:79]
    v_smfmac_f32_16x16x32_bf16 v[136:139], v[254:255], v[212:215], v10
    v_smfmac_f32_16x16x32_bf16 v[172:175], v[254:255], v[212:215], v10 abid:2
    s_setpc_b64 s[78:79]
    v_smfmac_f32_16x16x32_bf16 v[140:143], v[254:255], v[212:215], v10
    v_smfmac_f32_16x16x32_bf16 v[176:179], v[254:255], v[212:215], v10 abid:2
    s_setpc_b64 s[78:79]
    v_smfmac_f32_16x16x32_bf16 v[144:147], v[254:255], v[212:215], v10
    v_smfmac_f32_16x16x32_bf16 v[180:183], v[254:255], v[212:215], v10 abid:2
    s_setpc_b64 s[78:79]
    v_smfmac_f32_16x16x32_bf16 v[148:151], v[254:255], v[212:215], v10
    v_smfmac_f32_16x16x32_bf16 v[184:187], v[254:255], v[212:215], v10 abid:2
    s_setpc_b64 s[78:79]
    v_smfmac_f32_16x16x32_bf16 v[152:155], v[254:255], v[212:215], v10
    v_smfmac_f32_16x16x32_bf16 v[188:191], v[254:255], v[212:215], v10 abid:2
    s_setpc_b64 s[78:79]
    v_smfmac_f32_16x16x32_bf16 v[156:159], v[254:255], v[212:215], v10
    v_smfmac_f32_16x16x32_bf16 v[192:195], v[254:255], v[212:215], v10 abid:2
    s_setpc_b64 s[78:79]
M_ovn:
    s_setpc_b64 s[78:79]
M_slow:
    s_bitcmp1_b32 s46, 31
    s_cbranch_scc1 M_dense
    s_mov_b32 s56, s80
M_sl:
    s_lshl_b32 s57, s56, 6
    v_add_u32 v240, s57, v9
    ds_read_b128 v[248:251], v240 offset:9792
    s_waitcnt lgkmcnt(0)
    v_and_b32 v240, 0x3fff, v248
    v_and_b32 v241, 0x3fff, v250
    v_xad_u32 v240, v240, v3, v4
    v_xad_u32 v241, v241, v3, v4
    ds_read2st64_b32 v[244:245], v240 offset0:0 offset1:72
    ds_read2st64_b32 v[246:247], v241 offset0:0 offset1:72
    v_subrev_u32 v240, s29, v8
    v_bfe_u32 v240, v240, 4, 4
    s_waitcnt lgkmcnt(0)
    s_bitcmp1_b32 s27, 0
    s_cbranch_scc0 M_sle0
    v_lshrrev_b32 v242, 18, v248
    v_lshrrev_b32 v243, 18, v250
    v_or_b32 v241, 0, v240
    v_cmp_eq_u32 s[44:45], v242, v241
    v_cmp_eq_u32 s[54:55], v243, v241
    s_nop 0
    v_cndmask_b32 v242, 0, v249, s[44:45]
    v_cndmask_b32 v243, 0, v251, s[54:55]
    s_nop 1
    v_smfmac_f32_16x16x32_bf16 v[124:127], v[242:243], v[244:247], v10
    v_smfmac_f32_16x16x32_bf16 v[160:163], v[242:243], v[244:247], v10 abid:2
M_sle0:
    s_bitcmp1_b32 s27, 1
    s_cbranch_scc0 M_sle1
    v_lshrrev_b32 v242, 18, v248
    v_lshrrev_b32 v243, 18, v250
    v_or_b32 v241, 64, v240
    v_cmp_eq_u32 s[44:45], v242, v241
    v_cmp_eq_u32 s[54:55], v243, v241
    s_nop 0
    v_cndmask_b32 v242, 0, v249, s[44:45]
    v_cndmask_b32 v243, 0, v251, s[54:55]
    s_nop 1
    v_smfmac_f32_16x16x32_bf16 v[128:131], v[242:243], v[244:247], v10
    v_smfmac_f32_16x16x32_bf16 v[164:167], v[242:243], v[244:247], v10 abid:2
M_sle1:
    s_bitcmp1_b32 s27, 2
    s_cbranch_scc0 M_sle2
    v_lshrrev_b32 v242, 18, v248
    v_lshrrev_b32 v243, 18, v250
    v_or_b32 v241, 128, v240
    v_cmp_eq_u32 s[44:45], v242, v241
    v_cmp_eq_u32 s[54:55], v243, v241
    s_nop 0
    v_cndmask_b32 v242, 0, v249, s[44:45]
    v_cndmask_b32 v243, 0, v251, s[54:55]
    s_nop 1
    v_smfmac_f32_16x16x32_bf16 v[132:135], v[242:243], v[244:247], v10
    v_smfmac_f32_16x16x32_bf16 v[168:171], v[242:243], v[244:247], v10 abid:2
M_sle2:
    s_bitcmp1_b32 s27, 3
    s_cbranch_scc0 M_sle3
    v_lshrrev_b32 v242, 18, v248
    v_lshrrev_b32 v243, 18, v250
    v_or_b32 v241, 192, v240
    v_cmp_eq_u32 s[44:45], v242, v241
    v_cmp_eq_u32 s[54:55], v243, v241
    s_nop 0
    v_cndmask_b32 v242, 0, v249, s[44:45]
    v_cndmask_b32 v243, 0, v251, s[54:55]
    s_nop 1
    v_smfmac_f32_16x16x32_bf16 v[136:139], v[242:243], v[244:247], v10
    v_smfmac_f32_16x16x32_bf16 v[172:175], v[242:243], v[244:247], v10 abid:2
M_sle3:
    s_bitcmp1_b32 s27, 4
    s_cbranch_scc0 M_sle4
    v_lshrrev_b32 v242, 18, v248
    v_lshrrev_b32 v243, 18, v250
    v_or_b32 v241, 256, v240
    v_cmp_eq_u32 s[44:45], v242, v241
    v_cmp_eq_u32 s[54:55], v243, v241
    s_nop 0
    v_cndmask_b32 v242, 0, v249, s[44:45]
    v_cndmask_b32 v243, 0, v251, s[54:55]
    s_nop 1
    v_smfmac_f32_16x16x32_bf16 v[140:143], v[242:243], v[244:247], v10
    v_smfmac_f32_16x16x32_bf16 v[176:179], v[242:243], v[244:247], v10 abid:2
M_sle4:
    s_bitcmp1_b32 s27, 5
    s_cbranch_scc0 M_sle5
    v_lshrrev_b32 v242, 18, v248
    v_lshrrev_b32 v243, 18, v250
    v_or_b32 v241, 320, v240
    v_cmp_eq_u32 s[44:45], v242, v241
    v_cmp_eq_u32 s[54:55], v243, v241
    s_nop 0
    v_cndmask_b32 v242, 0, v249, s[44:45]
    v_cndmask_b32 v243, 0, v251, s[54:55]
    s_nop 1
    v_smfmac_f32_16x16x32_bf16 v[144:147], v[242:243], v[244:247], v10
    v_smfmac_f32_16x16x32_bf16 v[180:183], v[242:243], v[244:247], v10 abid:2
M_sle5:
    s_bitcmp1_b32 s27, 6
    s_cbranch_scc0 M_sle6
    v_lshrrev_b32 v242, 18, v248
    v_lshrrev_b32 v243, 18, v250
    v_or_b32 v241, 384, v240
    v_cmp_eq_u32 s[44:45], v242, v241
    v_cmp_eq_u32 s[54:55], v243, v241
    s_nop 0
    v_cndmask_b32 v242, 0, v249, s[44:45]
    v_cndmask_b32 v243, 0, v251, s[54:55]
    s_nop 1
    v_smfmac_f32_16x16x32_bf16 v[148:151], v[242:243], v[244:247], v10
    v_smfmac_f32_16x16x32_bf16 v[184:187], v[242:243], v[244:247], v10 abid:2
M_sle6:
    s_bitcmp1_b32 s27, 7
    s_cbranch_scc0 M_sle7
    v_lshrrev_b32 v242, 18, v248
    v_lshrrev_b32 v243, 18, v250
    v_or_b32 v241, 448, v240
    v_cmp_eq_u32 s[44:45], v242, v241
    v_cmp_eq_u32 s[54:55], v243, v241
    s_nop 0
    v_cndmask_b32 v242, 0, v249, s[44:45]
    v_cndmask_b32 v243, 0, v251, s[54:55]
    s_nop 1
    v_smfmac_f32_16x16x32_bf16 v[152:155], v[242:243], v[244:247], v10
    v_smfmac_f32_16x16x32_bf16 v[188:191], v[242:243], v[244:247], v10 abid:2
M_sle7:
    s_bitcmp1_b32 s27, 8
    s_cbranch_scc0 M_sle8
    v_lshrrev_b32 v242, 18, v248
    v_lshrrev_b32 v243, 18, v250
    v_or_b32 v241, 512, v240
    v_cmp_eq_u32 s[44:45], v242, v241
    v_cmp_eq_u32 s[54:55], v243, v241
    s_nop 0
    v_cndmask_b32 v242, 0, v249, s[44:45]
    v_cndmask_b32 v243, 0, v251, s[54:55]
    s_nop 1
    v_smfmac_f32_16x16x32_bf16 v[156:159], v[242:243], v[244:247], v10
    v_smfmac_f32_16x16x32_bf16 v[192:195], v[242:243], v[244:247], v10 abid:2
M_sle8:
    s_add_u32 s56, s56, 1
    s_cmp_lt_u32 s56, s46
    s_cbranch_scc1 M_sl
M_slx:
    s_nop 7
    s_cmp_eq_u32 s21, 1
    s_cbranch_scc1 M_slowrL
    s_cmp_eq_u32 s21, 2
    s_cbranch_scc1 M_slowrE0
    s_cmp_eq_u32 s21, 3
    s_cbranch_scc1 M_slowrF
    s_branch M_slowr0
M_dense:
    s_mul_i32 s57, s20, 82944
    s_add_u32 s57, s57, 393216
    s_mov_b32 s56, 0
    v_mov_b32 v54, v1
    v_mov_b32 v55, v2
    v_subrev_u32 v252, s29, v8
M_dn0:
    ds_read_b128 v[244:247], v54 offset:0
    ds_read_b128 v[248:251], v55 offset:0
    v_add_u32 v54, 1024, v54
    v_add_u32 v55, 1024, v55
    buffer_load_dwordx4 v[240:243], v252, s[16:19], s57 offen sc1
    s_add_u32 s57, s57, 1024
    s_waitcnt vmcnt(0) lgkmcnt(0)
    v_smfmac_f32_16x16x64_bf16 v[124:127], v[240:243], v[244:251], v10
    buffer_load_dwordx4 v[240:243], v252, s[16:19], s57 offen sc1
    s_add_u32 s57, s57, 1024
    s_waitcnt vmcnt(0) lgkmcnt(0)
    v_smfmac_f32_16x16x64_bf16 v[128:131], v[240:243], v[244:251], v10
    buffer_load_dwordx4 v[240:243], v252, s[16:19], s57 offen sc1
    s_add_u32 s57, s57, 1024
    s_waitcnt vmcnt(0) lgkmcnt(0)
    v_smfmac_f32_16x16x64_bf16 v[132:135], v[240:243], v[244:251], v10
    buffer_load_dwordx4 v[240:243], v252, s[16:19], s57 offen sc1
    s_add_u32 s57, s57, 1024
    s_waitcnt vmcnt(0) lgkmcnt(0)
    v_smfmac_f32_16x16x64_bf16 v[136:139], v[240:243], v[244:251], v10
    buffer_load_dwordx4 v[240:243], v252, s[16:19], s57 offen sc1
    s_add_u32 s57, s57, 1024
    s_waitcnt vmcnt(0) lgkmcnt(0)
    v_smfmac_f32_16x16x64_bf16 v[140:143], v[240:243], v[244:251], v10
    buffer_load_dwordx4 v[240:243], v252, s[16:19], s57 offen sc1
    s_add_u32 s57, s57, 1024
    s_waitcnt vmcnt(0) lgkmcnt(0)
    v_smfmac_f32_16x16x64_bf16 v[144:147], v[240:243], v[244:251], v10
    buffer_load_dwordx4 v[240:243], v252, s[16:19], s57 offen sc1
    s_add_u32 s57, s57, 1024
    s_waitcnt vmcnt(0) lgkmcnt(0)
    v_smfmac_f32_16x16x64_bf16 v[148:151], v[240:243], v[244:251], v10
    buffer_load_dwordx4 v[240:243], v252, s[16:19], s57 offen sc1
    s_add_u32 s57, s57, 1024
    s_waitcnt vmcnt(0) lgkmcnt(0)
    v_smfmac_f32_16x16x64_bf16 v[152:155], v[240:243], v[244:251], v10
    buffer_load_dwordx4 v[240:243], v252, s[16:19], s57 offen sc1
    s_add_u32 s57, s57, 1024
    s_waitcnt vmcnt(0) lgkmcnt(0)
    v_smfmac_f32_16x16x64_bf16 v[156:159], v[240:243], v[244:251], v10
    s_add_u32 s56, s56, 1
    s_cmp_lt_u32 s56, 9
    s_cbranch_scc1 M_dn0
    s_mul_i32 s57, s20, 82944
    s_add_u32 s57, s57, 393216
    s_mov_b32 s56, 0
    v_mov_b32 v54, v1
    v_mov_b32 v55, v2
    v_subrev_u32 v252, s29, v8
M_dn1:
    ds_read_b128 v[244:247], v54 offset:18432
    ds_read_b128 v[248:251], v55 offset:18432
    v_add_u32 v54, 1024, v54
    v_add_u32 v55, 1024, v55
    buffer_load_dwordx4 v[240:243], v252, s[16:19], s57 offen sc1
    s_add_u32 s57, s57, 1024
    s_waitcnt vmcnt(0) lgkmcnt(0)
    v_smfmac_f32_16x16x64_bf16 v[160:163], v[240:243], v[244:251], v10
    buffer_load_dwordx4 v[240:243], v252, s[16:19], s57 offen sc1
    s_add_u32 s57, s57, 1024
    s_waitcnt vmcnt(0) lgkmcnt(0)
    v_smfmac_f32_16x16x64_bf16 v[164:167], v[240:243], v[244:251], v10
    buffer_load_dwordx4 v[240:243], v252, s[16:19], s57 offen sc1
    s_add_u32 s57, s57, 1024
    s_waitcnt vmcnt(0) lgkmcnt(0)
    v_smfmac_f32_16x16x64_bf16 v[168:171], v[240:243], v[244:251], v10
    buffer_load_dwordx4 v[240:243], v252, s[16:19], s57 offen sc1
    s_add_u32 s57, s57, 1024
    s_waitcnt vmcnt(0) lgkmcnt(0)
    v_smfmac_f32_16x16x64_bf16 v[172:175], v[240:243], v[244:251], v10
    buffer_load_dwordx4 v[240:243], v252, s[16:19], s57 offen sc1
    s_add_u32 s57, s57, 1024
    s_waitcnt vmcnt(0) lgkmcnt(0)
    v_smfmac_f32_16x16x64_bf16 v[176:179], v[240:243], v[244:251], v10
    buffer_load_dwordx4 v[240:243], v252, s[16:19], s57 offen sc1
    s_add_u32 s57, s57, 1024
    s_waitcnt vmcnt(0) lgkmcnt(0)
    v_smfmac_f32_16x16x64_bf16 v[180:183], v[240:243], v[244:251], v10
    buffer_load_dwordx4 v[240:243], v252, s[16:19], s57 offen sc1
    s_add_u32 s57, s57, 1024
    s_waitcnt vmcnt(0) lgkmcnt(0)
    v_smfmac_f32_16x16x64_bf16 v[184:187], v[240:243], v[244:251], v10
    buffer_load_dwordx4 v[240:243], v252, s[16:19], s57 offen sc1
    s_add_u32 s57, s57, 1024
    s_waitcnt vmcnt(0) lgkmcnt(0)
    v_smfmac_f32_16x16x64_bf16 v[188:191], v[240:243], v[244:251], v10
    buffer_load_dwordx4 v[240:243], v252, s[16:19], s57 offen sc1
    s_add_u32 s57, s57, 1024
    s_waitcnt vmcnt(0) lgkmcnt(0)
    v_smfmac_f32_16x16x64_bf16 v[192:195], v[240:243], v[244:251], v10
    s_add_u32 s56, s56, 1
    s_cmp_lt_u32 s56, 9
    s_cbranch_scc1 M_dn1
    s_branch M_slx
M_codeend:
.section .rodata,"a"
.p2align 6
.amdhsa_kernel standalone__structured_sparse_n_m__ragged_kernel
  .amdhsa_next_free_vgpr 512
  .amdhsa_next_free_sgpr 102
  .amdhsa_accum_offset 256
  .amdhsa_group_segment_fixed_size 0
  .amdhsa_kernarg_size 48
  .amdhsa_user_sgpr_count 2
  .amdhsa_user_sgpr_kernarg_segment_ptr 1
  .amdhsa_system_sgpr_workgroup_id_x 1
  .amdhsa_float_denorm_mode_32 3
.end_amdhsa_kernel
```

```asm
; @launch grid=(256,1,1) block=(256,1,1) lds=162064
.amdgcn_target "amdgcn-amd-amdhsa--gfx950"
.text
.globl standalone__structured_sparse_n_m__ragged_kernel
.p2align 8
.type standalone__structured_sparse_n_m__ragged_kernel,@function
standalone__structured_sparse_n_m__ragged_kernel:
    s_cmp_ge_u32 s2, 256
    s_cbranch_scc1 M_end
    s_load_dwordx8 s[72:79], s[0:1], 0
    s_load_dwordx4 s[80:83], s[0:1], 32
    s_getpc_b64 s[84:85]
    s_lshr_b32 s30, s2, 3
    s_and_b32 s30, s30, 15
    s_lshl_b32 s30, s30, 11
    s_and_b32 s84, s84, 0xffffff00
    s_cmp_ge_u32 s2, 88
    s_cselect_b32 s86, M_codeend-standalone__structured_sparse_n_m__ragged_kernel, 0
    s_mov_b32 s87, 0x20000
    v_lshlrev_b32 v254, 3, v0
    s_mov_b32 exec_lo, 0x00010001
    s_mov_b32 exec_hi, 0x00010001
    buffer_load_dword v254, v254, s[84:87], s30 offen
    s_mov_b64 exec, -1
    v_lshrrev_b32 v20, 6, v0
    v_and_b32 v12, 63, v0
    v_readfirstlane_b32 s20, v20
    v_lshrrev_b32 v22, 3, v0
    v_mul_u32_u24 v22, 1152, v22
    v_lshrrev_b32 v23, 4, v0
    v_xor_b32 v23, v23, v0
    v_and_b32 v23, 7, v23
    v_lshl_add_u32 v5, v23, 4, v22
    v_lshrrev_b32 v13, 4, v12
    v_and_b32 v14, 15, v12
    v_lshlrev_b32 v11, 4, v12
    v_lshlrev_b32 v54, 3, v12
    v_lshlrev_b32 v25, 4, v13
    v_lshlrev_b32 v26, 3, v13
    s_mov_b32 s6, 663552
    s_mov_b32 s7, 0x20000
    s_mov_b32 s10, 75497472
    s_mov_b32 s11, s7
    s_mov_b32 s18, 791552
    s_mov_b32 s19, s7
    s_movk_i32 s70, 256
    s_mov_b32 s71, s7
    s_movk_i32 s86, 1152
    s_mov_b32 s87, s7
    s_mov_b32 s98, 0
    s_mul_i32 s96, s20, 16
    s_and_b32 s97, s2, 15
    s_add_u32 s96, s96, s97
    s_lshl_b32 s96, s96, 8
    s_add_u32 s96, s96, 726016
    s_mul_i32 s22, s2, 36864
    s_mul_i32 s26, s20, 9216
    s_mov_b32 s24, s22
    s_mov_b32 s42, s26
    s_lshl_b32 s28, s20, 8
    s_lshl_b32 s97, s20, 5
    s_cmp_lt_u32 s2, 81
    s_cbranch_scc0 M_x1
    s_mul_i32 s32, s2, 57
    s_lshr_b32 s32, s32, 9
    s_mul_i32 s33, s32, 9
    s_sub_u32 s33, s2, s33
    s_mul_i32 s54, s32, 73728
    s_lshl_b32 s35, s33, 7
    s_add_u32 s54, s54, s35
    s_add_u32 s55, s54, 36864
    s_lshl_b32 s36, s20, 10
    s_add_u32 m0, s36, 73728
    s_lshr_b32 s30, s33, 1
    s_and_b32 s31, s33, 1
    s_lshl1_add_u32 s37, s32, s31
    s_mul_i32 s37, s37, 176
    s_mul_i32 s38, s32, 96
    s_add_u32 s38, s38, 3168
    s_cmp_lt_u32 s33, 8
    s_cselect_b32 s30, s30, s20
    s_cselect_b32 s37, s37, s38
    s_cselect_b32 s44, 2047, 63
    s_cselect_b32 s45, s20, 3
    s_cmp_eq_u32 s45, 3
    s_cselect_b32 s99, 791552, 0
    s_mul_i32 s48, s30, 98304
    s_add_u32 s37, s37, s48
    v_mov_b32 v44, 2.0
    v_mov_b32 v45, 0
    v_mov_b32 v46, 2.0
    v_mov_b32 v47, 0
    s_waitcnt lgkmcnt(0)
    s_mov_b64 s[4:5], s[74:75]
    buffer_load_dwordx4 v5, s[4:7], s54 offen lds
    s_add_u32 m0, m0, 4096
    s_mov_b32 s45, 0
    buffer_load_dwordx4 v5, s[4:7], s55 offen lds
    s_mov_b64 s[16:17], s[82:83]
    s_mov_b64 s[8:9], s[72:73]
    s_mov_b64 s[84:85], s[76:77]
    s_mov_b64 s[68:69], s[80:81]
    v_mov_b32 v10, 0
    s_mov_b64 exec, 1
    buffer_atomic_add v10, off, s[16:19], s96 sc0 sc1
    s_mov_b64 exec, -1
    s_mov_b64 exec, s[44:45]
    s_mov_b32 s18, s99
    buffer_store_dwordx4 v[44:47], v11, s[16:19], s37 offen sc1
    s_mov_b32 s18, 791552
    s_mov_b64 exec, -1
    s_mov_b32 m0, s42
    s_nop 0
    buffer_load_dwordx4 v5, s[8:11], s22 offen offset:0 nt lds
    s_add_u32 m0, m0, 896
    s_nop 0
    buffer_load_dwordx4 v5, s[8:11], s22 offen offset:128 nt lds
    s_add_u32 m0, m0, 896
    s_nop 0
    buffer_load_dwordx4 v5, s[8:11], s22 offen offset:256 nt lds
    s_lshl_b32 s34, s31, 2
    s_add_u32 s34, s34, s20
    s_lshr_b32 s35, s20, 1
    s_lshl_b32 s35, s35, 6
    s_and_b32 s36, s20, 1
    s_lshl_b32 s36, s36, 3
    s_add_u32 s35, s35, s36
    s_lshl_b32 s36, s20, 5
    s_mul_i32 s39, s32, 10240
    s_add_u32 s39, s39, 6144
    s_lshl_b32 s40, s34, 1
    s_add_u32 s40, s40, s39
    s_lshl_b32 s38, s32, 1
    s_cmp_eq_u32 s32, 8
    s_cselect_b32 s38, 1024, s38
    s_add_u32 s38, s38, 4096
    s_cmp_lt_u32 s33, 8
    s_cselect_b32 s34, s34, 8
    s_cselect_b32 s35, s35, s36
    s_cselect_b32 s36, 4, 3
    s_cselect_b32 s40, s40, s38
    s_cselect_b32 s46, 0, s20
    s_cselect_b32 s47, 22, 12
    s_add_u32 s40, s40, s48
    s_lshl_b32 s38, s34, 10
    s_add_u32 s39, s39, s38
    s_add_u32 s39, s39, s48
    s_add_u32 s39, s39, 1024
    v_and_b32 v15, 3, v14
    v_lshlrev_b32 v15, s36, v15
    v_add_u32 v15, s35, v15
    v_lshrrev_b32 v16, 3, v14
    v_lshlrev_b32 v16, 4, v16
    v_xor_b32 v15, v15, v16
    v_lshrrev_b32 v16, 2, v14
    v_lshl_add_u32 v16, v13, 4, v16
    v_lshl_add_u32 v15, v16, 7, v15
    v_add_u32 v24, 73728, v15
    v_xor_b32 v27, 32, v24
    v_xor_b32 v28, 64, v24
    v_xor_b32 v29, 0x60, v24
    s_lshl_b32 s31, s46, 2
    s_add_u32 s31, s31, 81920
    v_mov_b32 v60, s31
    v_mov_b32 v61, 1
    ds_write_b32 v60, v61
    s_mul_i32 s49, s30, 81
    s_mul_i32 s31, s32, 9
    s_add_u32 s49, s49, s31
    s_add_u32 s49, s49, s34
    s_lshl_b32 s49, s49, 10
    s_add_u32 s49, s49, 393216
    s_lshl_b32 s31, s34, 24
    s_lshl_b32 s38, s32, 10
    s_add_u32 s31, s31, s38
    v_lshlrev_b32 v31, 18, v14
    v_lshl_add_u32 v31, v13, 5, v31
    v_add_u32 v31, s31, v31
    s_mov_b32 s50, 3437096686
    s_mov_b32 s51, 1150609561
    s_mov_b32 s52, 0x00010001
    s_mov_b32 s53, 0x00200010
    s_mov_b32 s38, 0x0202
    s_mul_i32 s57, s30, 4096
    s_add_u32 s57, s57, 726016
    s_cmp_eq_u32 s33, 8
    s_cselect_b32 s56, 0, s20
    s_cmp_eq_u32 s20, 0
    s_cselect_b32 s98, 1, 0
    v_add_u32 v74, 81984, v54
    v_lshl_add_u32 v73, s20, 1, v74
    v_mov_b32 v41, 0x01000100
    v_mov_b32 v40, 0
    v_mov_b32 v63, -2.0
    s_waitcnt vmcnt(5) lgkmcnt(0)
    s_barrier
    ds_read_b64_tr_b16 v[16:17], v24
    ds_read_b64_tr_b16 v[18:19], v27 offset:512
    ds_read_b64_tr_b16 v[20:21], v28 offset:1024
    ds_read_b64_tr_b16 v[22:23], v29 offset:1536
    s_waitcnt lgkmcnt(3)
    v_and_b32 v44, 0x7fff7fff, v16
    v_and_b32 v45, 0x7fff7fff, v17
    v_pk_max_u16 v46, v44, v45
    v_pk_min_u16 v47, v44, v45
    v_pk_min_u16 v46, v46, v46 op_sel:[0,1] op_sel_hi:[1,0]
    v_pk_max_u16 v47, v47, v47 op_sel:[0,1] op_sel_hi:[1,0]
    v_pk_max_u16 v46, v46, s52
    v_pk_max_u16 v46, v46, v47
    v_pk_sub_i16 v44, v44, v46
    v_pk_sub_i16 v45, v45, v46
    v_pk_ashrrev_i16 v44, 15, v44 op_sel_hi:[0,1]
    v_pk_ashrrev_i16 v45, 15, v45 op_sel_hi:[0,1]
    v_alignbit_b32 v47, -1, v44, 16
    v_alignbit_b32 v46, v45, v45, 16
    v_and_b32 v48, 0x00080004, v44
    v_bitop3_b32 v46, v45, v46, v47 bitop3:0xe8
    v_and_or_b32 v64, v45, s53, v48
    v_bitop3_b32 v36, v16, v44, v46 bitop3:0x10
    v_min_u32 v68, 1, v36
    s_waitcnt lgkmcnt(2)
    v_and_b32 v44, 0x7fff7fff, v18
    v_and_b32 v45, 0x7fff7fff, v19
    v_pk_max_u16 v46, v44, v45
    v_pk_min_u16 v47, v44, v45
    v_pk_min_u16 v46, v46, v46 op_sel:[0,1] op_sel_hi:[1,0]
    v_pk_max_u16 v47, v47, v47 op_sel:[0,1] op_sel_hi:[1,0]
    v_pk_max_u16 v46, v46, s52
    v_pk_max_u16 v46, v46, v47
    v_pk_sub_i16 v44, v44, v46
    v_pk_sub_i16 v45, v45, v46
    v_pk_ashrrev_i16 v44, 15, v44 op_sel_hi:[0,1]
    v_pk_ashrrev_i16 v45, 15, v45 op_sel_hi:[0,1]
    v_alignbit_b32 v47, -1, v44, 16
    v_alignbit_b32 v46, v45, v45, 16
    v_and_b32 v48, 0x00080004, v44
    v_bitop3_b32 v46, v45, v46, v47 bitop3:0xe8
    v_and_or_b32 v65, v45, s53, v48
    v_bitop3_b32 v37, v18, v44, v46 bitop3:0x10
    v_min_u32 v69, 1, v37
    s_waitcnt lgkmcnt(1)
    v_and_b32 v44, 0x7fff7fff, v20
    v_and_b32 v45, 0x7fff7fff, v21
    v_pk_max_u16 v46, v44, v45
    v_pk_min_u16 v47, v44, v45
    v_pk_min_u16 v46, v46, v46 op_sel:[0,1] op_sel_hi:[1,0]
    v_pk_max_u16 v47, v47, v47 op_sel:[0,1] op_sel_hi:[1,0]
    v_pk_max_u16 v46, v46, s52
    v_pk_max_u16 v46, v46, v47
    v_pk_sub_i16 v44, v44, v46
    v_pk_sub_i16 v45, v45, v46
    v_pk_ashrrev_i16 v44, 15, v44 op_sel_hi:[0,1]
    v_pk_ashrrev_i16 v45, 15, v45 op_sel_hi:[0,1]
    v_alignbit_b32 v47, -1, v44, 16
    v_alignbit_b32 v46, v45, v45, 16
    v_and_b32 v48, 0x00080004, v44
    v_bitop3_b32 v46, v45, v46, v47 bitop3:0xe8
    v_and_or_b32 v66, v45, s53, v48
    v_bitop3_b32 v38, v20, v44, v46 bitop3:0x10
    v_min_u32 v70, 1, v38
    s_waitcnt lgkmcnt(0)
    v_and_b32 v44, 0x7fff7fff, v22
    v_and_b32 v45, 0x7fff7fff, v23
    v_pk_max_u16 v46, v44, v45
    v_pk_min_u16 v47, v44, v45
    v_pk_min_u16 v46, v46, v46 op_sel:[0,1] op_sel_hi:[1,0]
    v_pk_max_u16 v47, v47, v47 op_sel:[0,1] op_sel_hi:[1,0]
    v_pk_max_u16 v46, v46, s52
    v_pk_max_u16 v46, v46, v47
    v_pk_sub_i16 v44, v44, v46
    v_pk_sub_i16 v45, v45, v46
    v_pk_ashrrev_i16 v44, 15, v44 op_sel_hi:[0,1]
    v_pk_ashrrev_i16 v45, 15, v45 op_sel_hi:[0,1]
    v_alignbit_b32 v47, -1, v44, 16
    v_alignbit_b32 v46, v45, v45, 16
    v_and_b32 v48, 0x00080004, v44
    v_bitop3_b32 v46, v45, v46, v47 bitop3:0xe8
    v_and_or_b32 v67, v45, s53, v48
    v_bitop3_b32 v39, v22, v44, v46 bitop3:0x10
    v_min_u32 v71, 1, v39
    v_add_u32 v72, v68, v69
    v_add3_u32 v72, v72, v70, v71
    buffer_store_dwordx4 v[36:39], v11, s[16:19], s49 offen sc1
    v_cmp_ne_u32 vcc, 0, v72
    s_and_saveexec_b64 s[44:45], vcc
    ds_add_rtn_u32 v62, v60, v72
    s_mov_b64 exec, -1
    v_lshrrev_b32 v48, 16, v64
    v_or_b32 v48, v48, v64
    v_lshrrev_b64 v[52:53], v48, s[50:51]
    v_and_b32 v64, 15, v52
    v_lshl_or_b32 v40, v64, 0, v40
    v_lshrrev_b32 v48, 16, v65
    v_or_b32 v48, v48, v65
    v_lshrrev_b64 v[52:53], v48, s[50:51]
    v_and_b32 v65, 15, v52
    v_lshl_or_b32 v40, v65, 4, v40
    v_lshrrev_b32 v48, 16, v66
    v_or_b32 v48, v48, v66
    v_lshrrev_b64 v[52:53], v48, s[50:51]
    v_and_b32 v66, 15, v52
    v_lshl_or_b32 v40, v66, 8, v40
    v_lshrrev_b32 v48, 16, v67
    v_or_b32 v48, v48, v67
    v_lshrrev_b64 v[52:53], v48, s[50:51]
    v_and_b32 v67, 15, v52
    v_lshl_or_b32 v40, v67, 12, v40
    v_lshrrev_b32 v44, 2, v40
    v_lshlrev_b32 v45, 2, v40
    s_movk_i32 s31, 0x3333
    v_not_b32 v47, v40
    v_bfi_b32 v44, s31, v44, v45
    s_movk_i32 s31, 0x1111
    s_nop 0
    v_mov_b32_dpp v47, v44 row_shr:4 row_mask:0xf bank_mask:0xf
    v_xor_b32 v47, v47, v40
    v_lshrrev_b32 v45, 1, v47
    v_or_b32 v47, v47, v45
    v_lshrrev_b32 v45, 2, v47
    v_bitop3_b32 v47, v47, v45, s31 bitop3:0x2a
    s_nop 1
    v_xor_b32_dpp v47, v47, v47 row_shr:4 row_mask:0xf bank_mask:0xe
    s_nop 1
    v_xor_b32_dpp v47, v47, v47 row_shr:8 row_mask:0xf bank_mask:0xc
    v_mul_u32_u24 v47, 15, v47
    v_bfi_b32 v40, v47, v44, v40
    ds_write_b16 v73, v40
    v_bfe_u32 v64, v40, 0, 4
    v_mul_u32_u24 v46, 0x4001, v64
    v_and_b32 v46, 0x30003, v46
    v_mad_u32_u24 v46, v46, s38, v41
    v_perm_b32 v32, v17, v16, v46
    v_bfe_u32 v65, v40, 4, 4
    v_mul_u32_u24 v46, 0x4001, v65
    v_and_b32 v46, 0x30003, v46
    v_mad_u32_u24 v46, v46, s38, v41
    v_perm_b32 v33, v19, v18, v46
    s_waitcnt vmcnt(4) lgkmcnt(0)
    s_barrier
    ds_read_b64 v[50:51], v74
    v_bfe_u32 v66, v40, 8, 4
    v_mul_u32_u24 v46, 0x4001, v66
    v_and_b32 v46, 0x30003, v46
    v_mad_u32_u24 v46, v46, s38, v41
    v_perm_b32 v34, v21, v20, v46
    v_bfe_u32 v67, v40, 12, 4
    v_mul_u32_u24 v46, 0x4001, v67
    v_and_b32 v46, 0x30003, v46
    v_mad_u32_u24 v46, v46, s38, v41
    v_perm_b32 v35, v23, v22, v46
    buffer_store_dwordx4 v[32:35], v11, s[16:19], s39 offen sc1
    s_cmp_eq_u32 s33, 8
    s_cbranch_scc0 F_i1
    buffer_store_short v40, v11, s[16:19], s40 offen sc1
    s_branch F_i2
F_i1:
    s_cmp_eq_u32 s20, 0
    s_cbranch_scc0 F_i2
    s_waitcnt lgkmcnt(0)
    buffer_store_dwordx2 v[50:51], v11, s[16:19], s40 offen sc1
F_i2:
    s_cbranch_vccz F_z
    v_cmp_ne_u32 vcc, 0, v36
    s_and_saveexec_b64 s[44:45], vcc
    s_cbranch_execz F_e0
    v_cmp_gt_u32 vcc, s47, v62
    v_add_u32 v42, 0, v31
    v_lshlrev_b32 v44, 3, v62
    v_add_u32 v62, 1, v62
    v_cndmask_b32 v42, v63, v42, vcc
    v_cndmask_b32 v43, 0, v36, vcc
    v_cndmask_b32 v44, 0, v44, vcc
    buffer_store_dwordx2 v[42:43], v44, s[16:19], s37 offen sc1
F_e0:
    s_mov_b64 exec, -1
    v_cmp_ne_u32 vcc, 0, v37
    s_and_saveexec_b64 s[44:45], vcc
    s_cbranch_execz F_e1
    v_cmp_gt_u32 vcc, s47, v62
    v_add_u32 v42, 8, v31
    v_lshlrev_b32 v44, 3, v62
    v_add_u32 v62, 1, v62
    v_cndmask_b32 v42, v63, v42, vcc
    v_cndmask_b32 v43, 0, v37, vcc
    v_cndmask_b32 v44, 0, v44, vcc
    buffer_store_dwordx2 v[42:43], v44, s[16:19], s37 offen sc1
F_e1:
    s_mov_b64 exec, -1
    v_cmp_ne_u32 vcc, 0, v38
    s_and_saveexec_b64 s[44:45], vcc
    s_cbranch_execz F_e2
    v_cmp_gt_u32 vcc, s47, v62
    v_add_u32 v42, 16, v31
    v_lshlrev_b32 v44, 3, v62
    v_add_u32 v62, 1, v62
    v_cndmask_b32 v42, v63, v42, vcc
    v_cndmask_b32 v43, 0, v38, vcc
    v_cndmask_b32 v44, 0, v44, vcc
    buffer_store_dwordx2 v[42:43], v44, s[16:19], s37 offen sc1
F_e2:
    s_mov_b64 exec, -1
    v_cmp_ne_u32 vcc, 0, v39
    s_and_saveexec_b64 s[44:45], vcc
    s_cbranch_execz F_e3
    v_cmp_gt_u32 vcc, s47, v62
    v_add_u32 v42, 24, v31
    v_lshlrev_b32 v44, 3, v62
    v_add_u32 v62, 1, v62
    v_cndmask_b32 v42, v63, v42, vcc
    v_cndmask_b32 v43, 0, v39, vcc
    v_cndmask_b32 v44, 0, v44, vcc
    buffer_store_dwordx2 v[42:43], v44, s[16:19], s37 offen sc1
F_e3:
    s_mov_b64 exec, -1
F_z:
    s_cmp_lg_u32 s2, 0
    s_cbranch_scc1 M_set
    v_mov_b32 v64, 0
    v_mov_b32 v65, 0
    v_mov_b32 v66, 0
    v_mov_b32 v67, 0
    s_mov_b32 s40, 724992
    buffer_store_dwordx4 v[64:67], v11, s[16:19], s40 offen sc1
    s_branch M_set
F_sig:
    v_lshlrev_b32 v30, 8, v12
    s_waitcnt vmcnt(0)
    s_barrier
    s_cmp_lg_u32 s56, 0
    s_cbranch_scc1 F_end
    s_bfm_b64 exec, 16, 0
    buffer_atomic_add v61, v30, s[16:19], s57 offen sc1
    s_mov_b64 exec, -1
F_end:
    s_add_u32 m0, m0, 896
    s_nop 0
    buffer_load_dwordx4 v5, s[8:11], s22 offen offset:384 nt lds
    s_add_u32 m0, m0, 896
    s_nop 0
    buffer_load_dwordx4 v5, s[8:11], s22 offen offset:512 nt lds
    s_branch M_x2
M_x1:
    s_waitcnt lgkmcnt(0)
    s_mov_b64 s[4:5], s[74:75]
    s_mov_b64 s[16:17], s[82:83]
    s_mov_b64 s[8:9], s[72:73]
    s_mov_b64 s[84:85], s[76:77]
    s_mov_b64 s[68:69], s[80:81]
    v_mov_b32 v10, 0
    s_mov_b64 exec, 1
    buffer_atomic_add v10, off, s[16:19], s96 sc0 sc1
    s_mov_b64 exec, -1
    s_mov_b32 m0, s42
    s_nop 0
    buffer_load_dwordx4 v5, s[8:11], s22 offen offset:0 nt lds
    s_add_u32 m0, m0, 896
    s_nop 0
    buffer_load_dwordx4 v5, s[8:11], s22 offen offset:128 nt lds
    s_add_u32 m0, m0, 896
    s_nop 0
    buffer_load_dwordx4 v5, s[8:11], s22 offen offset:256 nt lds
    s_add_u32 m0, m0, 896
    s_nop 0
    buffer_load_dwordx4 v5, s[8:11], s22 offen offset:384 nt lds
    s_add_u32 m0, m0, 896
    s_nop 0
    buffer_load_dwordx4 v5, s[8:11], s22 offen offset:512 nt lds
M_set:
    s_mov_b32 s12, s78
    s_mov_b32 s13, s79
    s_mov_b32 s14, 75497472
    s_mov_b32 s15, 0x20000
    s_mul_i32 s29, s20, 12864
    s_add_u32 s29, s29, 110592
    v_lshrrev_b32 v24, 1, v14
    v_and_b32 v27, 7, v14
    v_lshlrev_b32 v22, 7, v27
    v_lshl_or_b32 v3, v24, 4, v22
    v_lshrrev_b32 v23, 3, v14
    v_mul_u32_u24 v4, 9216, v23
    v_xad_u32 v1, v25, v3, v4
    v_xor_b32 v2, 64, v1
    v_add_u32 v9, s29, v25
    v_add_u32 v8, s29, v11
    v_mul_u32_u24 v24, 1152, v27
    v_lshl_add_u32 v24, v23, 6, v24
    v_add3_u32 v6, v24, v25, s28
    v_lshrrev_b32 v24, 3, v12
    v_xor_b32 v28, v24, v12
    v_and_b32 v28, 7, v28
    v_mul_u32_u24 v24, 1152, v24
    v_lshl_add_u32 v24, v28, 4, v24
    v_add_u32 v7, 1024, v24
    s_lshl_b32 s30, s20, 1
    v_lshrrev_b32 v24, 1, v13
    v_add_u32 v24, s30, v24
    v_xor_b32 v24, v24, v27
    v_lshl_add_u32 v24, v24, 4, v22
    v_and_b32 v28, 8, v26
    v_mul_u32_u24 v29, 12864, v23
    v_add3_u32 v24, v24, v28, v29
    v_add_u32 v53, 121408, v24
    s_lshr_b32 s30, s2, 3
    s_and_b32 s30, s30, 1
    s_mul_i32 s92, s30, 256
    s_add_u32 s92, s92, 562944
    s_add_u32 s30, s30, 768
    s_mul_i32 s93, s30, 36864
    s_mov_b32 s94, 73728
    s_and_b32 s95, s20, 1
    s_mul_i32 s95, s95, 9216
    s_add_u32 s59, s24, 9216
    s_mul_i32 s43, s20, 98304
    s_add_u32 s47, s29, 9216
    s_add_u32 s48, s29, 9792
    s_add_u32 s49, s29, 10112
    s_add_u32 s54, s29, 1073751872
    s_add_u32 s38, s26, 73728
    s_add_u32 s35, s38, 1024
    s_add_u32 s39, s38, 1536
    s_mov_b32 s40, s48
    s_add_u32 s41, s48, 256
    s_mov_b32 s50, 3130536464
    s_mov_b32 s51, 1164430831
    s_mov_b32 s52, 3696531472
    s_mov_b32 s53, 598435823
    v_mov_b32 v16, 0
    v_mov_b32 v17, 0
    v_mov_b32 v18, 0
    v_mov_b32 v19, 0
    v_cmp_gt_u32 s[44:45], 36, v12
    v_mov_b32 v20, 2.0
    s_nop 0
    v_cndmask_b32 v20, 0, v20, s[44:45]
    v_mov_b32 v21, v20
    v_mov_b32 v22, v20
    v_mov_b32 v23, v20
    v_mov_b32 v68, 1073741824
    v_mov_b32 v69, 0
    v_mov_b32 v70, 1073741824
    v_mov_b32 v71, 0
    v_lshl_add_u32 v84, v12, 2, s49
    v_add_u32 v55, s38, v54
    v_add_u32 v24, s38, v11
    ds_write_b128 v8, v[16:19] offset:0
    ds_write_b128 v8, v[16:19] offset:1024
    ds_write_b128 v8, v[16:19] offset:2048
    ds_write_b128 v8, v[16:19] offset:3072
    ds_write_b128 v8, v[16:19] offset:4096
    ds_write_b128 v8, v[16:19] offset:5120
    ds_write_b128 v8, v[16:19] offset:6144
    ds_write_b128 v8, v[16:19] offset:7168
    ds_write_b128 v8, v[16:19] offset:8192
    ds_write_b128 v24, v[68:71]
    ds_write_b128 v24, v[68:71] offset:1024
    ds_write_b128 v8, v[20:23] offset:9216
    s_cmp_lt_u32 s2, 81
    s_cbranch_scc1 F_sig
M_x2:
    s_add_u32 m0, m0, 896
    s_nop 0
    buffer_load_dwordx4 v5, s[8:11], s22 offen offset:640 nt lds
    s_add_u32 m0, m0, 896
    s_nop 0
    buffer_load_dwordx4 v5, s[8:11], s22 offen offset:768 nt lds
    s_add_u32 m0, m0, 896
    s_nop 0
    buffer_load_dwordx4 v5, s[8:11], s22 offen offset:896 nt lds
    s_add_u32 m0, m0, 896
    s_nop 0
    buffer_load_dwordx4 v5, s[8:11], s22 offen offset:1024 nt lds
    s_add_u32 s22, s22, 9437184
    s_add_u32 s42, s42, 36864
    buffer_load_dwordx4 v[196:199], v25, s[84:87], s28 offen offset:0
    buffer_load_dwordx4 v[200:203], v25, s[84:87], s28 offen offset:64
    buffer_load_dwordx4 v[204:207], v25, s[84:87], s28 offen offset:128
    buffer_load_dwordx4 v[208:211], v25, s[84:87], s28 offen offset:192
    buffer_load_dwordx2 v[212:213], v26, s[84:87], s97 offen offset:1024
    s_mov_b32 m0, s42
    s_nop 0
    buffer_load_dwordx4 v5, s[8:11], s22 offen offset:0 nt lds
    s_add_u32 m0, m0, 896
    s_nop 0
    buffer_load_dwordx4 v5, s[8:11], s22 offen offset:128 nt lds
    s_add_u32 m0, m0, 896
    s_nop 0
    buffer_load_dwordx4 v5, s[8:11], s22 offen offset:256 nt lds
    s_add_u32 m0, m0, 896
    s_nop 0
    buffer_load_dwordx4 v5, s[8:11], s22 offen offset:384 nt lds
    s_add_u32 m0, m0, 896
    s_nop 0
    buffer_load_dwordx4 v5, s[8:11], s22 offen offset:512 nt lds
    s_add_u32 m0, m0, 896
    s_nop 0
    buffer_load_dwordx4 v5, s[8:11], s22 offen offset:640 nt lds
    s_add_u32 m0, m0, 896
    s_nop 0
    buffer_load_dwordx4 v5, s[8:11], s22 offen offset:768 nt lds
    s_add_u32 m0, m0, 896
    s_nop 0
    buffer_load_dwordx4 v5, s[8:11], s22 offen offset:896 nt lds
    s_add_u32 m0, m0, 896
    s_nop 0
    buffer_load_dwordx4 v5, s[8:11], s22 offen offset:1024 nt lds
    s_add_u32 s22, s22, 9437184
    s_add_u32 s42, s42, 36864
    s_waitcnt vmcnt(3)
    v_mov_b32 v0, 0
    s_mov_b64 exec, 1
    buffer_atomic_add v0, off, s[16:19], s96 sc0 sc1
    s_mov_b64 exec, -1
    v_readlane_b32 s100, v10, 0
    v_mov_b32 v10, 0xeeee4444
    v_lshlrev_b32 v124, 16, v196
    v_and_b32 v125, 0xffff0000, v196
    v_lshlrev_b32 v126, 16, v197
    v_and_b32 v127, 0xffff0000, v197
    v_lshlrev_b32 v128, 16, v198
    v_and_b32 v129, 0xffff0000, v198
    v_lshlrev_b32 v130, 16, v199
    v_and_b32 v131, 0xffff0000, v199
    v_lshlrev_b32 v132, 16, v200
    v_and_b32 v133, 0xffff0000, v200
    v_lshlrev_b32 v134, 16, v201
    v_and_b32 v135, 0xffff0000, v201
    v_lshlrev_b32 v136, 16, v202
    v_and_b32 v137, 0xffff0000, v202
    v_lshlrev_b32 v138, 16, v203
    v_and_b32 v139, 0xffff0000, v203
    v_lshlrev_b32 v140, 16, v204
    v_and_b32 v141, 0xffff0000, v204
    v_lshlrev_b32 v142, 16, v205
    v_and_b32 v143, 0xffff0000, v205
    v_lshlrev_b32 v144, 16, v206
    v_and_b32 v145, 0xffff0000, v206
    v_lshlrev_b32 v146, 16, v207
    v_and_b32 v147, 0xffff0000, v207
    v_lshlrev_b32 v148, 16, v208
    v_and_b32 v149, 0xffff0000, v208
    v_lshlrev_b32 v150, 16, v209
    v_and_b32 v151, 0xffff0000, v209
    v_lshlrev_b32 v152, 16, v210
    v_and_b32 v153, 0xffff0000, v210
    v_lshlrev_b32 v154, 16, v211
    v_and_b32 v155, 0xffff0000, v211
    v_lshlrev_b32 v156, 16, v212
    v_and_b32 v157, 0xffff0000, v212
    v_lshlrev_b32 v158, 16, v213
    v_and_b32 v159, 0xffff0000, v213
    s_mov_b32 exec_lo, 0x00010001
    s_mov_b32 exec_hi, 0x00010001
    ds_write_b128 v9, v[124:127] offset:10240
    ds_write_b128 v9, v[128:131] offset:10304
    ds_write_b128 v9, v[132:135] offset:10368
    ds_write_b128 v9, v[136:139] offset:10432
    ds_write_b128 v9, v[140:143] offset:10496
    ds_write_b128 v9, v[144:147] offset:10560
    ds_write_b128 v9, v[148:151] offset:10624
    ds_write_b128 v9, v[152:155] offset:10688
    ds_write_b128 v9, v[156:159] offset:10752
    s_mov_b64 exec, -1
    s_mul_i32 s30, s20, 256
    s_add_u32 s30, s30, s2
    s_sub_u32 s30, s30, 0
    s_cmp_lt_u32 s2, 0
    s_cselect_b32 s30, 1023, s30
    s_lshl_b32 s30, s30, 1
    v_lshrrev_b32 v244, 5, v12
    v_add_u32 v248, s30, v244
    v_mov_b32 v244, -1
    v_mov_b32 v245, 0
    v_subrev_u32 v246, 664, v248
    v_cmp_gt_u32 vcc, 12, v246
    v_mov_b32 v247, 0
    s_nop 0
    v_cndmask_b32 v244, v244, v246, vcc
    v_cndmask_b32 v245, v245, v247, vcc
    v_subrev_u32 v246, 638, v248
    v_cmp_gt_u32 vcc, 26, v246
    v_mov_b32 v247, 1
    s_nop 0
    v_cndmask_b32 v244, v244, v246, vcc
    v_cndmask_b32 v245, v245, v247, vcc
    v_subrev_u32 v246, 598, v248
    v_cmp_gt_u32 vcc, 40, v246
    v_mov_b32 v247, 2
    s_nop 0
    v_cndmask_b32 v244, v244, v246, vcc
    v_cndmask_b32 v245, v245, v247, vcc
    v_subrev_u32 v246, 542, v248
    v_cmp_gt_u32 vcc, 56, v246
    v_mov_b32 v247, 3
    s_nop 0
    v_cndmask_b32 v244, v244, v246, vcc
    v_cndmask_b32 v245, v245, v247, vcc
    v_subrev_u32 v246, 468, v248
    v_cmp_gt_u32 vcc, 74, v246
    v_mov_b32 v247, 4
    s_nop 0
    v_cndmask_b32 v244, v244, v246, vcc
    v_cndmask_b32 v245, v245, v247, vcc
    v_subrev_u32 v246, 376, v248
    v_cmp_gt_u32 vcc, 92, v246
    v_mov_b32 v247, 5
    s_nop 0
    v_cndmask_b32 v244, v244, v246, vcc
    v_cndmask_b32 v245, v245, v247, vcc
    v_subrev_u32 v246, 268, v248
    v_cmp_gt_u32 vcc, 108, v246
    v_mov_b32 v247, 6
    s_nop 0
    v_cndmask_b32 v244, v244, v246, vcc
    v_cndmask_b32 v245, v245, v247, vcc
    v_subrev_u32 v246, 142, v248
    v_cmp_gt_u32 vcc, 126, v246
    v_mov_b32 v247, 7
    s_nop 0
    v_cndmask_b32 v244, v244, v246, vcc
    v_cndmask_b32 v245, v245, v247, vcc
    v_subrev_u32 v246, 0, v248
    v_cmp_gt_u32 vcc, 142, v246
    v_mov_b32 v247, 8
    s_nop 0
    v_cndmask_b32 v244, v244, v246, vcc
    v_cndmask_b32 v245, v245, v247, vcc
    v_sub_u32 v244, 2047, v244
    v_mul_u32_u24 v244, 36864, v244
    v_lshl_add_u32 v244, v245, 7, v244
    v_and_b32 v245, 31, v12
    v_mul_u32_u24 v245, 1152, v245
    v_add_u32 v249, v244, v245
    s_mov_b32 vcc_lo, 0xff00ff00
    s_mov_b32 vcc_hi, 0xff00ff00
    s_waitcnt vmcnt(0)
    v_readfirstlane_b32 s30, v0
    s_mov_b32 s31, 0
    s_sub_u32 s30, s30, s100
    s_cmp_eq_u32 s30, 27
    s_cbranch_scc0 M_pf_spin
M_pf_ok:
    s_lshr_b32 s30, s2, 3
    s_sub_u32 s31, s30, 11
    s_cselect_b32 s30, s30, s31
    s_mul_i32 s30, s30, 3072
    s_add_u32 s30, s30, s43
    s_add_u32 s30, s30, 33792
    v_lshlrev_b32 v244, 3, v11
    v_mov_b32 v0, v249
    buffer_load_dwordx4 v[56:59], v11, s[16:19], s43 offen offset:0 sc1
    buffer_load_dwordx4 v[60:63], v11, s[16:19], s43 offen offset:1024 sc1
    buffer_load_dwordx4 v[64:67], v11, s[16:19], s43 offen offset:2048 sc1
    s_mov_b32 exec_hi, 268435455
    buffer_load_dwordx4 v[68:71], v11, s[16:19], s43 offen offset:3072 sc1
    s_mov_b32 exec_hi, -1
    s_add_u32 s43, s43, 4096
    buffer_load_dwordx4 v[48:51], v11, s[16:19], s43 offen offset:0 sc1
    buffer_load_dword v52, v11, s[16:19], s43 offen offset:1024 sc1
    buffer_load_dwordx4 v[12:15], v11, s[16:19], s43 offen offset:2048 sc1
    buffer_load_dwordx4 a[0:3], v11, s[16:19], s43 offen offset:3072 sc1
    s_add_u32 s43, s43, 4096
    buffer_load_dwordx4 a[4:7], v11, s[16:19], s43 offen offset:0 sc1
    buffer_load_dwordx4 a[8:11], v11, s[16:19], s43 offen offset:1024 sc1
    buffer_load_dwordx4 a[12:15], v11, s[16:19], s43 offen offset:2048 sc1
    buffer_load_dwordx4 a[16:19], v11, s[16:19], s43 offen offset:3072 sc1
    s_add_u32 s43, s43, 4096
    s_bfm_b64 exec, 24, 0
    buffer_load_dword v244, v244, s[16:19], s30 offen sc1
    s_mov_b64 exec, -1
    buffer_load_dwordx4 a[20:23], v11, s[16:19], s43 offen offset:0 sc1
    buffer_load_dwordx4 a[24:27], v11, s[16:19], s43 offen offset:1024 sc1
    buffer_load_dwordx4 a[28:31], v11, s[16:19], s43 offen offset:2048 sc1
    buffer_load_dwordx4 a[32:35], v11, s[16:19], s43 offen offset:3072 sc1
    s_add_u32 s43, s43, 4096
    buffer_load_dwordx4 v[16:19], v11, s[16:19], s43 offen offset:0 sc1
    buffer_load_dwordx4 a[36:39], v11, s[16:19], s43 offen offset:1024 sc1
    buffer_load_dwordx4 a[40:43], v11, s[16:19], s43 offen offset:2048 sc1
    buffer_load_dwordx4 a[44:47], v11, s[16:19], s43 offen offset:3072 sc1
    s_add_u32 s43, s43, 4096
    buffer_load_dwordx4 a[48:51], v11, s[16:19], s43 offen offset:0 sc1
    buffer_load_dwordx4 a[52:55], v11, s[16:19], s43 offen offset:1024 sc1
    buffer_load_dwordx4 a[56:59], v11, s[16:19], s43 offen offset:2048 sc1
    buffer_load_dwordx4 a[60:63], v11, s[16:19], s43 offen offset:3072 sc1
    s_add_u32 s43, s43, 4096
    buffer_load_dwordx4 a[64:67], v11, s[16:19], s43 offen offset:0 sc1
    buffer_load_dwordx4 a[68:71], v11, s[16:19], s43 offen offset:1024 sc1
    buffer_load_dwordx4 v[20:23], v11, s[16:19], s43 offen offset:2048 sc1
    buffer_load_dwordx4 a[72:75], v11, s[16:19], s43 offen offset:3072 sc1
    s_add_u32 s43, s43, 4096
    buffer_load_dwordx4 a[76:79], v11, s[16:19], s43 offen offset:0 sc1
    buffer_load_dwordx4 a[80:83], v11, s[16:19], s43 offen offset:1024 sc1
    buffer_load_dwordx4 a[84:87], v11, s[16:19], s43 offen offset:2048 sc1
    buffer_load_dwordx4 a[88:91], v11, s[16:19], s43 offen offset:3072 sc1
    s_add_u32 s43, s43, 4096
    buffer_load_dwordx4 a[92:95], v11, s[16:19], s43 offen offset:0 sc1
    ds_read_b128 v[160:163], v9 offset:10240
    ds_read_b128 v[164:167], v9 offset:10304
    ds_read_b128 v[168:171], v9 offset:10368
    ds_read_b128 v[172:175], v9 offset:10432
    ds_read_b128 v[176:179], v9 offset:10496
    ds_read_b128 v[180:183], v9 offset:10560
    ds_read_b128 v[184:187], v9 offset:10624
    ds_read_b128 v[188:191], v9 offset:10688
    ds_read_b128 v[192:195], v9 offset:10752
    s_cmp_eq_u32 s98, 0
    s_cbranch_scc1 M_cnt
    s_mov_b32 s98, 0
    v_mov_b32 v250, 1
    s_mov_b64 exec, 1
    buffer_atomic_add v250, off, s[68:71], 0 offset:0 sc1
    s_mov_b64 exec, -1
    s_nop 3
M_cnt:
    s_waitcnt vmcnt(26)
    s_barrier
    ds_read_b128 v[196:199], v1 offset:0
    ds_read_b128 v[200:203], v2 offset:0
    ds_read_b128 v[228:231], v1 offset:18432
    ds_read_b128 v[232:235], v2 offset:18432
    s_waitcnt lgkmcnt(2)
    v_smfmac_f32_16x16x64_bf16 v[124:127], a[0:3], v[196:203], v12
    buffer_load_dwordx4 a[96:99], v11, s[16:19], s43 offen offset:1024 sc1
    s_waitcnt lgkmcnt(0)
    v_mov_b32 v82, s54
    v_smfmac_f32_16x16x64_bf16 v[160:163], a[0:3], v[228:235], v12
    ds_read_b128 v[204:207], v1 offset:1024
    ds_read_b128 v[208:211], v2 offset:1024
    v_or3_b32 v78, v56, v60, v64
    v_or_b32 v78, v78, v68
    v_cmp_gt_i32 s[32:33], 0, v78
    v_cmp_gt_u32 s[36:37], 2.0, v56
    s_nop 1
    v_mbcnt_lo_u32_b32 v74, s36, 0
    s_waitcnt vmcnt(26)
    v_mbcnt_hi_u32_b32 v74, s37, v74
    v_smfmac_f32_16x16x64_bf16 v[128:131], a[4:7], v[196:203], v12 abid:1
    buffer_load_dwordx4 a[100:103], v11, s[16:19], s43 offen offset:2048 sc1
    v_lshl_add_u32 v74, v74, 3, s38
    v_smfmac_f32_16x16x64_bf16 v[164:167], a[4:7], v[228:235], v12 abid:1
    ds_read_b128 v[220:223], v1 offset:19456
    ds_read_b128 v[224:227], v2 offset:19456
    v_min_u32 v74, s39, v74
    s_waitcnt vmcnt(26)
    v_cndmask_b32 v74, v82, v74, s[36:37]
    v_smfmac_f32_16x16x64_bf16 v[132:135], a[8:11], v[196:203], v13
    buffer_load_dwordx4 a[104:107], v11, s[16:19], s43 offen offset:3072 sc1
    ds_write_b64 v74, v[56:57]
    s_bcnt1_i32_b64 s30, s[36:37]
    s_lshl3_add_u32 s38, s30, s38
    v_cmp_gt_u32 s[44:45], 2.0, v58
    v_smfmac_f32_16x16x64_bf16 v[168:171], a[8:11], v[228:235], v13
    s_nop 0
    v_mbcnt_lo_u32_b32 v75, s44, 0
    v_mbcnt_hi_u32_b32 v75, s45, v75
    v_lshl_add_u32 v75, v75, 3, s38
    v_min_u32 v75, s39, v75
    s_waitcnt vmcnt(26)
    v_cndmask_b32 v75, v82, v75, s[44:45]
    v_smfmac_f32_16x16x64_bf16 v[136:139], a[12:15], v[196:203], v13 abid:1
    s_add_u32 s43, s43, 4096
    buffer_load_dwordx4 v[24:27], v11, s[16:19], s43 offen offset:0 sc1
    buffer_load_dwordx4 a[108:111], v11, s[16:19], s43 offen offset:1024 sc1
    ds_write_b64 v75, v[58:59]
    s_bcnt1_i32_b64 s30, s[44:45]
    s_lshl3_add_u32 s38, s30, s38
    v_cmp_gt_u32 s[36:37], 2.0, v60
    v_smfmac_f32_16x16x64_bf16 v[172:175], a[12:15], v[228:235], v13 abid:1
    s_nop 0
    v_mbcnt_lo_u32_b32 v74, s36, 0
    v_mbcnt_hi_u32_b32 v74, s37, v74
    v_lshl_add_u32 v74, v74, 3, s38
    s_waitcnt vmcnt(27)
    v_min_u32 v74, s39, v74
    v_smfmac_f32_16x16x64_bf16 v[140:143], a[16:19], v[196:203], v14
    buffer_load_dwordx4 a[112:115], v11, s[16:19], s43 offen offset:2048 sc1
    v_cndmask_b32 v74, v82, v74, s[36:37]
    v_smfmac_f32_16x16x64_bf16 v[176:179], a[16:19], v[228:235], v14
    ds_write_b64 v74, v[60:61]
    s_bcnt1_i32_b64 s30, s[36:37]
    s_lshl3_add_u32 s38, s30, s38
    v_cmp_gt_u32 s[44:45], 2.0, v62
    s_nop 1
    v_mbcnt_lo_u32_b32 v75, s44, 0
    s_waitcnt vmcnt(26)
    v_mbcnt_hi_u32_b32 v75, s45, v75
    v_smfmac_f32_16x16x64_bf16 v[144:147], a[20:23], v[196:203], v14 abid:1
    buffer_load_dwordx4 a[116:119], v11, s[16:19], s43 offen offset:3072 sc1
    v_lshl_add_u32 v75, v75, 3, s38
    v_smfmac_f32_16x16x64_bf16 v[180:183], a[20:23], v[228:235], v14 abid:1
    v_min_u32 v75, s39, v75
    s_waitcnt vmcnt(26)
    v_cndmask_b32 v75, v82, v75, s[44:45]
    v_smfmac_f32_16x16x64_bf16 v[148:151], a[24:27], v[196:203], v15
    s_add_u32 s43, s43, 4096
    buffer_load_dwordx4 a[120:123], v11, s[16:19], s43 offen offset:0 sc1
    ds_write_b64 v75, v[62:63]
    s_bcnt1_i32_b64 s30, s[44:45]
    s_lshl3_add_u32 s38, s30, s38
    v_cmp_gt_u32 s[36:37], 2.0, v64
    v_smfmac_f32_16x16x64_bf16 v[184:187], a[24:27], v[228:235], v15
    s_nop 0
    v_mbcnt_lo_u32_b32 v74, s36, 0
    v_mbcnt_hi_u32_b32 v74, s37, v74
    v_lshl_add_u32 v74, v74, 3, s38
    v_min_u32 v74, s39, v74
    s_waitcnt vmcnt(26)
    v_cndmask_b32 v74, v82, v74, s[36:37]
    v_smfmac_f32_16x16x64_bf16 v[152:155], a[28:31], v[196:203], v15 abid:1
    buffer_load_dwordx4 a[124:127], v11, s[16:19], s43 offen offset:1024 sc1
    ds_write_b64 v74, v[64:65]
    s_bcnt1_i32_b64 s30, s[36:37]
    s_lshl3_add_u32 s38, s30, s38
    v_cmp_gt_u32 s[44:45], 2.0, v66
    v_smfmac_f32_16x16x64_bf16 v[188:191], a[28:31], v[228:235], v15 abid:1
    s_nop 0
    v_mbcnt_lo_u32_b32 v75, s44, 0
    v_mbcnt_hi_u32_b32 v75, s45, v75
    v_lshl_add_u32 v75, v75, 3, s38
    s_waitcnt vmcnt(26)
    v_min_u32 v75, s39, v75
    v_smfmac_f32_16x16x64_bf16 v[156:159], a[32:35], v[196:203], v48
    buffer_load_dwordx4 a[128:131], v11, s[16:19], s43 offen offset:2048 sc1
    v_cndmask_b32 v75, v82, v75, s[44:45]
    v_smfmac_f32_16x16x64_bf16 v[192:195], a[32:35], v[228:235], v48
    ds_write_b64 v75, v[66:67]
    s_bcnt1_i32_b64 s30, s[44:45]
    s_lshl3_add_u32 s38, s30, s38
    v_cmp_gt_u32 s[36:37], 2.0, v68
    s_nop 1
    s_waitcnt vmcnt(25)
    s_waitcnt lgkmcnt(8)
    v_mbcnt_lo_u32_b32 v74, s36, 0
    v_smfmac_f32_16x16x64_bf16 v[124:127], a[36:39], v[204:211], v16
    buffer_load_dwordx4 a[132:135], v11, s[16:19], s43 offen offset:3072 sc1
    s_waitcnt lgkmcnt(6)
    v_mbcnt_hi_u32_b32 v74, s37, v74
    v_smfmac_f32_16x16x64_bf16 v[160:163], a[36:39], v[220:227], v16
    ds_read_b128 v[196:199], v1 offset:2048
    ds_read_b128 v[200:203], v2 offset:2048
    v_lshl_add_u32 v74, v74, 3, s38
    v_min_u32 v74, s39, v74
    s_waitcnt vmcnt(25)
    v_cndmask_b32 v74, v82, v74, s[36:37]
    v_smfmac_f32_16x16x64_bf16 v[128:131], a[40:43], v[204:211], v16 abid:1
    s_add_u32 s43, s43, 4096
    buffer_load_dwordx4 a[136:139], v11, s[16:19], s43 offen offset:0 sc1
    ds_write_b64 v74, v[68:69]
    s_bcnt1_i32_b64 s30, s[36:37]
    s_lshl3_add_u32 s38, s30, s38
    v_cmp_gt_u32 s[44:45], 2.0, v70
    v_smfmac_f32_16x16x64_bf16 v[164:167], a[40:43], v[220:227], v16 abid:1
    ds_read_b128 v[228:231], v1 offset:20480
    ds_read_b128 v[232:235], v2 offset:20480
    v_mbcnt_lo_u32_b32 v75, s44, 0
    v_mbcnt_hi_u32_b32 v75, s45, v75
    v_lshl_add_u32 v75, v75, 3, s38
    v_min_u32 v75, s39, v75
    s_waitcnt vmcnt(25)
    v_cndmask_b32 v75, v82, v75, s[44:45]
    v_smfmac_f32_16x16x64_bf16 v[132:135], a[44:47], v[204:211], v17
    buffer_load_dwordx4 a[140:143], v11, s[16:19], s43 offen offset:1024 sc1
    ds_write_b64 v75, v[70:71]
    s_bcnt1_i32_b64 s30, s[44:45]
    s_lshl3_add_u32 s38, s30, s38
    ds_read_b64 v[56:57], v55 offset:0
    ds_read_b64 v[58:59], v55 offset:512
    ds_read_b64 v[60:61], v55 offset:1024
    v_smfmac_f32_16x16x64_bf16 v[168:171], a[44:47], v[220:227], v17
    s_waitcnt vmcnt(25)
    v_smfmac_f32_16x16x64_bf16 v[136:139], a[48:51], v[204:211], v17 abid:1
    buffer_load_dwordx4 v[28:31], v11, s[16:19], s43 offen offset:2048 sc1
    buffer_load_dwordx4 a[144:147], v11, s[16:19], s43 offen offset:3072 sc1
    v_smfmac_f32_16x16x64_bf16 v[172:175], a[48:51], v[220:227], v17 abid:1
    s_waitcnt vmcnt(26)
    v_smfmac_f32_16x16x64_bf16 v[140:143], a[52:55], v[204:211], v18
    s_add_u32 s43, s43, 4096
    buffer_load_dwordx4 a[148:151], v11, s[16:19], s43 offen offset:0 sc1
    s_waitcnt lgkmcnt(2)
    v_bfe_u32 v74, v56, 24, 4
    v_smfmac_f32_16x16x64_bf16 v[176:179], a[52:55], v[220:227], v18
    v_lshlrev_b32 v75, 1, v56
    v_lshl_add_u32 v74, v74, 2, s49
    v_and_b32 v75, 16, v75
    s_waitcnt vmcnt(26)
    v_and_or_b32 v74, v56, 2.0, v74
    v_smfmac_f32_16x16x64_bf16 v[144:147], a[56:59], v[204:211], v18 abid:1
    buffer_load_dwordx4 a[152:155], v11, s[16:19], s43 offen offset:1024 sc1
    v_lshlrev_b32 v75, v75, 1
    v_smfmac_f32_16x16x64_bf16 v[180:183], a[56:59], v[220:227], v18 abid:1
    ds_add_rtn_u32 v62, v74, v75
    s_waitcnt lgkmcnt(2)
    v_bfe_u32 v76, v58, 24, 4
    v_lshlrev_b32 v77, 1, v58
    v_lshl_add_u32 v76, v76, 2, s49
    s_waitcnt vmcnt(26)
    v_and_b32 v77, 16, v77
    v_smfmac_f32_16x16x64_bf16 v[148:151], a[60:63], v[204:211], v19
    buffer_load_dwordx4 a[156:159], v11, s[16:19], s43 offen offset:2048 sc1
    v_and_or_b32 v76, v58, 2.0, v76
    v_smfmac_f32_16x16x64_bf16 v[184:187], a[60:63], v[220:227], v19
    s_waitcnt vmcnt(26)
    v_lshlrev_b32 v77, v77, 1
    v_smfmac_f32_16x16x64_bf16 v[152:155], a[64:67], v[204:211], v19 abid:1
    buffer_load_dwordx4 a[160:163], v11, s[16:19], s43 offen offset:3072 sc1
    ds_add_rtn_u32 v63, v76, v77
    s_waitcnt lgkmcnt(2)
    s_cmp_gt_u32 s38, s35
    s_cbranch_scc1 M_r3
M_r3r:
    ds_read_b32 v81, v84
    v_and_b32 v74, 8, v56
    v_smfmac_f32_16x16x64_bf16 v[188:191], a[64:67], v[220:227], v19 abid:1
    v_lshrrev_b32 v77, 14, v56
    v_cmp_ne_u32 s[44:45], 0, v74
    v_and_b32 v80, 0x3cf0, v77
    s_waitcnt lgkmcnt(2)
    v_lshrrev_b32 v75, 16, v62
    v_and_b32 v76, 0xffff, v62
    s_waitcnt vmcnt(26)
    v_sub_u32 v74, 15, v75
    v_smfmac_f32_16x16x64_bf16 v[156:159], a[68:71], v[204:211], v48 abid:1
    s_add_u32 s43, s43, 4096
    buffer_load_dwordx4 a[164:167], v11, s[16:19], s43 offen offset:0 sc1
    v_and_b32 v62, 2.0, v56
    v_smfmac_f32_16x16x64_bf16 v[192:195], a[68:71], v[220:227], v48 abid:1
    v_add3_u32 v62, v76, v75, v62
    v_cndmask_b32 v74, v76, v74, s[44:45]
    v_cmp_gt_u32 s[44:45], 16, v62
    v_cmp_gt_u32 s[36:37], 2.0, v62
    v_lshlrev_b32 v74, 2, v74
    s_waitcnt vmcnt(25)
    v_lshrrev_b64 v[76:77], v74, s[50:51]
    v_smfmac_f32_16x16x64_bf16 v[124:127], a[72:75], v[196:203], v20
    buffer_load_dwordx4 a[168:171], v11, s[16:19], s43 offen offset:1024 sc1
    s_andn2_b64 s[36:37], s[36:37], s[44:45]
    v_lshrrev_b64 v[78:79], v74, s[52:53]
    v_smfmac_f32_16x16x64_bf16 v[160:163], a[72:75], v[228:235], v20
    ds_read_b128 v[204:207], v1 offset:3072
    ds_read_b128 v[208:211], v2 offset:3072
    v_bfe_u32 v74, v56, 24, 4
    v_mbcnt_lo_u32_b32 v75, s36, 0
    v_and_b32 v76, 15, v76
    v_mbcnt_hi_u32_b32 v75, s37, v75
    v_and_b32 v78, 15, v78
    s_waitcnt vmcnt(25)
    v_lshl_add_u32 v75, v75, 3, s40
    v_smfmac_f32_16x16x64_bf16 v[128:131], a[76:79], v[196:203], v20 abid:1
    buffer_load_dwordx4 a[172:175], v11, s[16:19], s43 offen offset:2048 sc1
    v_lshl_add_u32 v76, v74, 4, v76
    v_smfmac_f32_16x16x64_bf16 v[164:167], a[76:79], v[228:235], v20 abid:1
    ds_read_b128 v[220:223], v1 offset:21504
    ds_read_b128 v[224:227], v2 offset:21504
    v_min_u32 v75, s41, v75
    v_mul_u32_u24 v78, 68, v78
    s_waitcnt vmcnt(25)
    v_cndmask_b32 v75, v82, v75, s[36:37]
    v_smfmac_f32_16x16x64_bf16 v[132:135], a[80:83], v[196:203], v21
    buffer_load_dwordx4 a[176:179], v11, s[16:19], s43 offen offset:3072 sc1
    ds_write_b64 v75, v[56:57]
    s_bcnt1_i32_b64 s30, s[36:37]
    s_lshl3_add_u32 s40, s30, s40
    v_lshl_add_u32 v76, v76, 2, s47
    v_smfmac_f32_16x16x64_bf16 v[168:171], a[80:83], v[228:235], v21
    v_and_b32 v78, 0x30c, v78
    v_cndmask_b32 v76, v82, v76, s[44:45]
    v_add3_u32 v77, v80, v78, s29
    v_and_b32 v78, 0x3fff, v56
    s_waitcnt vmcnt(25)
    v_cndmask_b32 v74, v82, v77, s[44:45]
    v_smfmac_f32_16x16x64_bf16 v[136:139], a[84:87], v[196:203], v21 abid:1
    s_add_u32 s43, s43, 4096
    buffer_load_dwordx4 v[32:35], v11, s[16:19], s43 offen offset:0 sc1
    buffer_load_dwordx4 a[180:183], v11, s[16:19], s43 offen offset:1024 sc1
    ds_write_b32 v76, v78
    ds_write_b32 v74, v57
    v_and_b32 v74, 8, v58
    v_smfmac_f32_16x16x64_bf16 v[172:175], a[84:87], v[228:235], v21 abid:1
    v_lshrrev_b32 v77, 14, v58
    v_cmp_ne_u32 s[44:45], 0, v74
    v_and_b32 v80, 0x3cf0, v77
    s_waitcnt lgkmcnt(8)
    s_waitcnt vmcnt(26)
    v_lshrrev_b32 v75, 16, v63
    v_smfmac_f32_16x16x64_bf16 v[140:143], a[88:91], v[196:203], v22
    buffer_load_dwordx4 a[184:187], v11, s[16:19], s43 offen offset:2048 sc1
    v_and_b32 v76, 0xffff, v63
    v_smfmac_f32_16x16x64_bf16 v[176:179], a[88:91], v[228:235], v22
    v_sub_u32 v74, 15, v75
    v_and_b32 v63, 2.0, v58
    v_add3_u32 v63, v76, v75, v63
    v_cndmask_b32 v74, v76, v74, s[44:45]
    s_waitcnt vmcnt(26)
    v_cmp_gt_u32 s[44:45], 16, v63
    v_smfmac_f32_16x16x64_bf16 v[144:147], a[92:95], v[196:203], v22 abid:1
    buffer_load_dwordx4 a[188:191], v11, s[16:19], s43 offen offset:3072 sc1
    v_cmp_gt_u32 s[36:37], 2.0, v63
    v_smfmac_f32_16x16x64_bf16 v[180:183], a[92:95], v[228:235], v22 abid:1
    v_lshlrev_b32 v74, 2, v74
    s_waitcnt vmcnt(26)
    v_lshrrev_b64 v[76:77], v74, s[50:51]
    v_smfmac_f32_16x16x64_bf16 v[148:151], a[96:99], v[196:203], v23
    s_add_u32 s43, s43, 4096
    buffer_load_dwordx4 a[192:195], v11, s[16:19], s43 offen offset:0 sc1
    s_andn2_b64 s[36:37], s[36:37], s[44:45]
    v_lshrrev_b64 v[78:79], v74, s[52:53]
    v_smfmac_f32_16x16x64_bf16 v[184:187], a[96:99], v[228:235], v23
    v_bfe_u32 v74, v58, 24, 4
    v_mbcnt_lo_u32_b32 v75, s36, 0
    v_and_b32 v76, 15, v76
    v_mbcnt_hi_u32_b32 v75, s37, v75
    v_and_b32 v78, 15, v78
    s_waitcnt vmcnt(26)
    v_lshl_add_u32 v75, v75, 3, s40
    v_smfmac_f32_16x16x64_bf16 v[152:155], a[100:103], v[196:203], v23 abid:1
    buffer_load_dwordx4 a[196:199], v11, s[16:19], s43 offen offset:1024 sc1
    v_lshl_add_u32 v76, v74, 4, v76
    v_smfmac_f32_16x16x64_bf16 v[188:191], a[100:103], v[228:235], v23 abid:1
    v_min_u32 v75, s41, v75
    v_mul_u32_u24 v78, 68, v78
    s_waitcnt vmcnt(26)
    v_cndmask_b32 v75, v82, v75, s[36:37]
    v_smfmac_f32_16x16x64_bf16 v[156:159], a[104:107], v[196:203], v49
    buffer_load_dwordx4 a[200:203], v11, s[16:19], s43 offen offset:2048 sc1
    ds_write_b64 v75, v[58:59]
    s_bcnt1_i32_b64 s30, s[36:37]
    s_lshl3_add_u32 s40, s30, s40
    v_lshl_add_u32 v76, v76, 2, s47
    v_smfmac_f32_16x16x64_bf16 v[192:195], a[104:107], v[228:235], v49
    v_and_b32 v78, 0x30c, v78
    v_cndmask_b32 v76, v82, v76, s[44:45]
    v_add3_u32 v77, v80, v78, s29
    v_and_b32 v78, 0x3fff, v58
    s_waitcnt vmcnt(25)
    s_waitcnt lgkmcnt(6)
    v_cndmask_b32 v74, v82, v77, s[44:45]
    v_smfmac_f32_16x16x64_bf16 v[124:127], a[108:111], v[204:211], v24
    buffer_load_dwordx4 a[204:207], v11, s[16:19], s43 offen offset:3072 sc1
    ds_write_b32 v76, v78
    ds_write_b32 v74, v59
    s_waitcnt lgkmcnt(6)
    v_lshrrev_b32 v74, 16, v81
    v_smfmac_f32_16x16x64_bf16 v[160:163], a[108:111], v[220:227], v24
    ds_read_b128 v[196:199], v1 offset:4096
    ds_read_b128 v[200:203], v2 offset:4096
    v_and_b32 v81, 0xffff, v81
    v_add_u32 v81, v81, v74
    s_waitcnt vmcnt(25)
    v_cmp_lt_u32 s[34:35], 16, v81
    v_smfmac_f32_16x16x64_bf16 v[128:131], a[112:115], v[204:211], v24 abid:1
    s_add_u32 s43, s43, 4096
    buffer_load_dwordx4 a[208:211], v11, s[16:19], s43 offen offset:0 sc1
    s_sub_u32 s46, s40, s48
    s_add_u32 s46, s46, 56
    s_lshr_b32 s46, s46, 6
    s_mov_b32 s21, 0
    s_and_b32 s27, s34, 0x1ff
    s_cmp_gt_u32 s46, 4
    s_cselect_b32 s32, 1, s32
    s_or_b32 s32, s32, s33
    s_cbranch_scc1 M_dn
M_dnr:
    ds_read_b128 v[56:59], v9 offset:9792
    s_bcnt1_i32_b32 s30, s27
    s_cmp_gt_u32 s30, 3
    s_cselect_b32 s34, 0, s27
    s_cselect_b32 s80, 0, 1
    s_getpc_b64 s[36:37]
M_pc:
    v_bfe_u32 v74, v11, 4, 4
    v_smfmac_f32_16x16x64_bf16 v[164:167], a[112:115], v[220:227], v24 abid:1
    ds_read_b128 v[228:231], v1 offset:22528
    ds_read_b128 v[232:235], v2 offset:22528
    s_waitcnt vmcnt(25)
    v_smfmac_f32_16x16x64_bf16 v[132:135], a[116:119], v[204:211], v25
    buffer_load_dwordx4 a[212:215], v11, s[16:19], s43 offen offset:1024 sc1
    s_ff1_i32_b32 s81, s34
    s_bitset0_b32 s34, s81
    s_mul_i32 s30, s81, 20
    s_add_u32 s31, s30, M_ovc0-M_pc
    s_add_u32 s30, s30, M_ovl0-M_pc
    s_cmp_lg_u32 s34, 0
    s_cselect_b32 s30, s31, s30
    s_cmp_lt_i32 s81, 0
    s_cselect_b32 s30, M_ovn-M_pc, s30
    s_add_u32 s72, s36, s30
    s_addc_u32 s73, s37, 0
    s_ff1_i32_b32 s82, s34
    s_bitset0_b32 s34, s82
    s_mul_i32 s30, s82, 20
    s_add_u32 s31, s30, M_ovc1-M_pc
    s_add_u32 s30, s30, M_ovl1-M_pc
    s_cmp_lg_u32 s34, 0
    s_cselect_b32 s30, s31, s30
    s_cmp_lt_i32 s82, 0
    s_cselect_b32 s30, M_ovn-M_pc, s30
    v_smfmac_f32_16x16x64_bf16 v[168:171], a[116:119], v[220:227], v25
    s_waitcnt vmcnt(25)
    v_smfmac_f32_16x16x64_bf16 v[136:139], a[120:123], v[204:211], v25 abid:1
    buffer_load_dwordx4 v[36:39], v11, s[16:19], s43 offen offset:2048 sc1
    buffer_load_dwordx4 a[216:219], v11, s[16:19], s43 offen offset:3072 sc1
    s_add_u32 s74, s36, s30
    s_addc_u32 s75, s37, 0
    s_ff1_i32_b32 s83, s34
    s_bitset0_b32 s34, s83
    s_mul_i32 s30, s83, 20
    s_add_u32 s31, s30, M_ovc1-M_pc
    s_add_u32 s30, s30, M_ovl2-M_pc
    s_cmp_lg_u32 s34, 0
    s_cselect_b32 s30, s31, s30
    s_cmp_lt_i32 s83, 0
    s_cselect_b32 s30, M_ovn-M_pc, s30
    s_add_u32 s76, s36, s30
    s_addc_u32 s77, s37, 0
    s_waitcnt lgkmcnt(2)
    v_lshrrev_b32 v76, 18, v56
    v_smfmac_f32_16x16x64_bf16 v[172:175], a[120:123], v[220:227], v25 abid:1
    s_waitcnt vmcnt(26)
    v_lshrrev_b32 v77, 18, v58
    v_smfmac_f32_16x16x64_bf16 v[140:143], a[124:127], v[204:211], v26
    s_add_u32 s43, s43, 4096
    buffer_load_dwordx4 a[220:223], v11, s[16:19], s43 offen offset:0 sc1
    v_and_b32 v78, 0x3fff, v56
    v_smfmac_f32_16x16x64_bf16 v[176:179], a[124:127], v[220:227], v26
    s_waitcnt vmcnt(26)
    v_and_b32 v79, 0x3fff, v58
    v_smfmac_f32_16x16x64_bf16 v[144:147], a[128:131], v[204:211], v26 abid:1
    buffer_load_dwordx4 a[224:227], v11, s[16:19], s43 offen offset:1024 sc1
    ds_write_b64 v9, v[78:79] offset:10056
    v_lshl_or_b32 v75, s81, 6, v74
    v_smfmac_f32_16x16x64_bf16 v[180:183], a[128:131], v[220:227], v26 abid:1
    v_cmp_eq_u32 s[44:45], v76, v75
    v_cmp_eq_u32 s[36:37], v77, v75
    s_nop 0
    v_cndmask_b32 v54, 0, v57, s[44:45]
    v_cndmask_b32 v55, 0, v59, s[36:37]
    v_lshl_or_b32 v75, s82, 6, v74
    s_waitcnt vmcnt(26)
    v_cmp_eq_u32 s[44:45], v76, v75
    v_smfmac_f32_16x16x64_bf16 v[148:151], a[132:135], v[204:211], v27
    buffer_load_dwordx4 a[228:231], v11, s[16:19], s43 offen offset:2048 sc1
    v_cmp_eq_u32 s[36:37], v77, v75
    v_smfmac_f32_16x16x64_bf16 v[184:187], a[132:135], v[220:227], v27
    v_cndmask_b32 v252, 0, v57, s[44:45]
    v_cndmask_b32 v253, 0, v59, s[36:37]
    v_lshl_or_b32 v75, s83, 6, v74
    v_cmp_eq_u32 s[44:45], v76, v75
    v_cmp_eq_u32 s[36:37], v77, v75
    s_nop 0
    s_waitcnt vmcnt(26)
    v_cndmask_b32 v254, 0, v57, s[44:45]
    v_smfmac_f32_16x16x64_bf16 v[152:155], a[136:139], v[204:211], v27 abid:1
    buffer_load_dwordx4 a[232:235], v11, s[16:19], s43 offen offset:3072 sc1
    v_cndmask_b32 v255, 0, v59, s[36:37]
    v_smfmac_f32_16x16x64_bf16 v[188:191], a[136:139], v[220:227], v27 abid:1
    ds_read_b128 v[236:239], v9 offset:9408
    ds_read_b64 v[216:217], v9 offset:10056
    s_waitcnt vmcnt(26)
    v_smfmac_f32_16x16x64_bf16 v[156:159], a[140:143], v[204:211], v49 abid:1
    s_add_u32 s43, s43, 4096
    buffer_load_dwordx4 a[236:239], v11, s[16:19], s43 offen offset:0 sc1
    s_waitcnt lgkmcnt(1)
    v_xad_u32 v236, v236, v3, v4
    v_smfmac_f32_16x16x64_bf16 v[192:195], a[140:143], v[220:227], v49 abid:1
    s_waitcnt vmcnt(25)
    v_xad_u32 v237, v237, v3, v4
    v_smfmac_f32_16x16x64_bf16 v[124:127], a[144:147], v[196:203], v28
    buffer_load_dwordx4 a[240:243], v11, s[16:19], s43 offen offset:1024 sc1
    ds_read2st64_b32 v[244:245], v236 offset0:0 offset1:72
    ds_read2st64_b32 v[246:247], v237 offset0:0 offset1:72
    v_xad_u32 v238, v238, v3, v4
    v_smfmac_f32_16x16x64_bf16 v[160:163], a[144:147], v[228:235], v28
    ds_read_b128 v[204:207], v1 offset:5120
    ds_read_b128 v[208:211], v2 offset:5120
    s_waitcnt vmcnt(25)
    v_xad_u32 v239, v239, v3, v4
    v_smfmac_f32_16x16x64_bf16 v[128:131], a[148:151], v[196:203], v28 abid:1
    buffer_load_dwordx4 a[244:247], v11, s[16:19], s43 offen offset:2048 sc1
    ds_read2st64_b32 v[248:249], v238 offset0:0 offset1:72
    ds_read2st64_b32 v[250:251], v239 offset0:0 offset1:72
    ds_read_b128 v[240:243], v8 offset:3072
    ds_read_b128 v[236:239], v9 offset:9280
    s_waitcnt lgkmcnt(8)
    v_xad_u32 v212, v216, v3, v4
    v_smfmac_f32_16x16x64_bf16 v[164:167], a[148:151], v[228:235], v28 abid:1
    ds_read_b128 v[220:223], v1 offset:23552
    ds_read_b128 v[224:227], v2 offset:23552
    ds_read2st64_b32 v[212:213], v212 offset0:0 offset1:72
    s_waitcnt vmcnt(25)
    v_xad_u32 v214, v217, v3, v4
    v_smfmac_f32_16x16x64_bf16 v[132:135], a[152:155], v[196:203], v29
    buffer_load_dwordx4 a[248:251], v11, s[16:19], s43 offen offset:3072 sc1
    ds_read2st64_b32 v[214:215], v214 offset0:0 offset1:72
    v_smfmac_f32_16x16x64_bf16 v[168:171], a[152:155], v[228:235], v29
    s_waitcnt vmcnt(25)
    v_smfmac_f32_16x16x64_bf16 v[136:139], a[156:159], v[196:203], v29 abid:1
    s_add_u32 s43, s43, 4096
    buffer_load_dwordx4 v[40:43], v11, s[16:19], s43 offen offset:0 sc1
    buffer_load_dwordx4 a[252:255], v11, s[16:19], s43 offen offset:1024 sc1
    v_smfmac_f32_16x16x64_bf16 v[172:175], a[156:159], v[228:235], v29 abid:1
    s_waitcnt vmcnt(26)
    v_smfmac_f32_16x16x64_bf16 v[140:143], a[160:163], v[196:203], v30
    buffer_load_dwordx4 v[56:59], v11, s[16:19], s43 offen offset:2048 sc1
    s_waitcnt lgkmcnt(5)
    v_smfmac_f32_16x16x64_bf16 v[136:139], v[240:243], v[244:251], v10
    v_smfmac_f32_16x16x64_bf16 v[172:175], v[240:243], v[244:251], v10 abid:1
    s_waitcnt lgkmcnt(4)
    v_xad_u32 v236, v236, v3, v4
    v_smfmac_f32_16x16x64_bf16 v[176:179], a[160:163], v[228:235], v30
    s_waitcnt vmcnt(26)
    v_xad_u32 v237, v237, v3, v4
    v_smfmac_f32_16x16x64_bf16 v[144:147], a[164:167], v[196:203], v30 abid:1
    buffer_load_dwordx4 v[60:63], v11, s[16:19], s43 offen offset:3072 sc1
    ds_read2st64_b32 v[244:245], v236 offset0:0 offset1:72
    ds_read2st64_b32 v[246:247], v237 offset0:0 offset1:72
    v_xad_u32 v238, v238, v3, v4
    v_smfmac_f32_16x16x64_bf16 v[180:183], a[164:167], v[228:235], v30 abid:1
    s_waitcnt vmcnt(26)
    v_xad_u32 v239, v239, v3, v4
    v_smfmac_f32_16x16x64_bf16 v[148:151], a[168:171], v[196:203], v31
    s_add_u32 s43, s43, 4096
    buffer_load_dwordx4 v[64:67], v11, s[16:19], s43 offen offset:0 sc1
    ds_read2st64_b32 v[248:249], v238 offset0:0 offset1:72
    ds_read2st64_b32 v[250:251], v239 offset0:0 offset1:72
    ds_read_b128 v[240:243], v8 offset:1024
    ds_read_b128 v[236:239], v9 offset:9344
    v_smfmac_f32_16x16x64_bf16 v[184:187], a[168:171], v[228:235], v31
    s_waitcnt vmcnt(26)
    v_smfmac_f32_16x16x64_bf16 v[152:155], a[172:175], v[196:203], v31 abid:1
    buffer_load_dwordx4 v[68:71], v11, s[16:19], s43 offen offset:1024 sc1
    s_waitcnt lgkmcnt(6)
    s_cmp_lt_i32 s81, 0
    s_cbranch_scc1 M_ovr0
    s_swappc_b64 s[78:79], s[72:73]
M_ovr0:
    v_smfmac_f32_16x16x64_bf16 v[188:191], a[172:175], v[228:235], v31 abid:1
    s_waitcnt vmcnt(26)
    v_smfmac_f32_16x16x64_bf16 v[156:159], a[176:179], v[196:203], v50
    buffer_load_dwordx4 v[72:75], v11, s[16:19], s43 offen offset:2048 sc1
    v_smfmac_f32_16x16x64_bf16 v[192:195], a[176:179], v[228:235], v50
    s_waitcnt vmcnt(25)
    v_smfmac_f32_16x16x64_bf16 v[124:127], a[180:183], v[204:211], v32
    buffer_load_dwordx4 v[76:79], v11, s[16:19], s43 offen offset:3072 sc1
    s_waitcnt lgkmcnt(1)
    v_smfmac_f32_16x16x64_bf16 v[128:131], v[240:243], v[244:251], v10
    v_smfmac_f32_16x16x64_bf16 v[164:167], v[240:243], v[244:251], v10 abid:1
    s_waitcnt lgkmcnt(0)
    v_xad_u32 v236, v236, v3, v4
    v_smfmac_f32_16x16x64_bf16 v[160:163], a[180:183], v[220:227], v32
    ds_read_b128 v[196:199], v1 offset:6144
    ds_read_b128 v[200:203], v2 offset:6144
    s_waitcnt vmcnt(25)
    v_xad_u32 v237, v237, v3, v4
    v_smfmac_f32_16x16x64_bf16 v[128:131], a[184:187], v[204:211], v32 abid:1
    s_add_u32 s43, s43, 4096
    buffer_load_dwordx4 v[80:83], v11, s[16:19], s43 offen offset:0 sc1
    ds_read2st64_b32 v[244:245], v236 offset0:0 offset1:72
    ds_read2st64_b32 v[246:247], v237 offset0:0 offset1:72
    v_xad_u32 v238, v238, v3, v4
    v_smfmac_f32_16x16x64_bf16 v[164:167], a[184:187], v[220:227], v32 abid:1
    ds_read_b128 v[228:231], v1 offset:24576
    ds_read_b128 v[232:235], v2 offset:24576
    s_waitcnt vmcnt(25)
    v_xad_u32 v239, v239, v3, v4
    v_smfmac_f32_16x16x64_bf16 v[132:135], a[188:191], v[204:211], v33
    buffer_load_dwordx4 v[84:87], v11, s[16:19], s43 offen offset:1024 sc1
    ds_read2st64_b32 v[248:249], v238 offset0:0 offset1:72
    ds_read2st64_b32 v[250:251], v239 offset0:0 offset1:72
    ds_read_b128 v[240:243], v8 offset:2048
    ds_read_b128 v[236:239], v9 offset:9216
    v_smfmac_f32_16x16x64_bf16 v[168:171], a[188:191], v[220:227], v33
    s_waitcnt vmcnt(25)
    v_smfmac_f32_16x16x64_bf16 v[136:139], a[192:195], v[204:211], v33 abid:1
    buffer_load_dwordx4 v[44:47], v11, s[16:19], s43 offen offset:2048 sc1
    buffer_load_dwordx4 v[88:91], v11, s[16:19], s43 offen offset:3072 sc1
    v_smfmac_f32_16x16x64_bf16 v[172:175], a[192:195], v[220:227], v33 abid:1
    s_waitcnt vmcnt(26)
    v_smfmac_f32_16x16x64_bf16 v[140:143], a[196:199], v[204:211], v34
    s_add_u32 s43, s43, 4096
    buffer_load_dwordx4 v[92:95], v11, s[16:19], s43 offen offset:0 sc1
    v_smfmac_f32_16x16x64_bf16 v[176:179], a[196:199], v[220:227], v34
    s_waitcnt vmcnt(26)
    v_smfmac_f32_16x16x64_bf16 v[144:147], a[200:203], v[204:211], v34 abid:1
    buffer_load_dwordx4 v[96:99], v11, s[16:19], s43 offen offset:1024 sc1
    s_waitcnt lgkmcnt(1)
    v_smfmac_f32_16x16x64_bf16 v[132:135], v[240:243], v[244:251], v10
    v_smfmac_f32_16x16x64_bf16 v[168:171], v[240:243], v[244:251], v10 abid:1
    s_waitcnt lgkmcnt(0)
    v_xad_u32 v236, v236, v3, v4
    v_smfmac_f32_16x16x64_bf16 v[180:183], a[200:203], v[220:227], v34 abid:1
    s_waitcnt vmcnt(26)
    v_xad_u32 v237, v237, v3, v4
    v_smfmac_f32_16x16x64_bf16 v[148:151], a[204:207], v[204:211], v35
    buffer_load_dwordx4 v[100:103], v11, s[16:19], s43 offen offset:2048 sc1
    ds_read2st64_b32 v[244:245], v236 offset0:0 offset1:72
    ds_read2st64_b32 v[246:247], v237 offset0:0 offset1:72
    v_xad_u32 v238, v238, v3, v4
    v_smfmac_f32_16x16x64_bf16 v[184:187], a[204:207], v[220:227], v35
    s_waitcnt vmcnt(26)
    v_xad_u32 v239, v239, v3, v4
    v_smfmac_f32_16x16x64_bf16 v[152:155], a[208:211], v[204:211], v35 abid:1
    buffer_load_dwordx4 v[104:107], v11, s[16:19], s43 offen offset:3072 sc1
    ds_read2st64_b32 v[248:249], v238 offset0:0 offset1:72
    ds_read2st64_b32 v[250:251], v239 offset0:0 offset1:72
    ds_read_b128 v[240:243], v8 offset:0
    ds_read_b128 v[236:239], v9 offset:9728
    v_smfmac_f32_16x16x64_bf16 v[188:191], a[208:211], v[220:227], v35 abid:1
    s_waitcnt vmcnt(26)
    v_smfmac_f32_16x16x64_bf16 v[156:159], a[212:215], v[204:211], v50 abid:1
    s_add_u32 s43, s43, 4096
    buffer_load_dwordx4 v[108:111], v11, s[16:19], s43 offen offset:0 sc1
    v_smfmac_f32_16x16x64_bf16 v[192:195], a[212:215], v[220:227], v50 abid:1
    s_waitcnt vmcnt(25)
    v_smfmac_f32_16x16x64_bf16 v[124:127], a[216:219], v[196:203], v36
    buffer_load_dwordx4 v[112:115], v11, s[16:19], s43 offen offset:1024 sc1
    v_smfmac_f32_16x16x64_bf16 v[160:163], a[216:219], v[228:235], v36
    ds_read_b128 v[204:207], v1 offset:7168
    ds_read_b128 v[208:211], v2 offset:7168
    s_waitcnt vmcnt(25)
    v_smfmac_f32_16x16x64_bf16 v[128:131], a[220:223], v[196:203], v36 abid:1
    buffer_load_dwordx4 v[116:119], v11, s[16:19], s43 offen offset:2048 sc1
    s_waitcnt lgkmcnt(3)
    v_smfmac_f32_16x16x64_bf16 v[124:127], v[240:243], v[244:251], v10
    v_smfmac_f32_16x16x64_bf16 v[160:163], v[240:243], v[244:251], v10 abid:1
    s_waitcnt lgkmcnt(2)
    v_xad_u32 v236, v236, v3, v4
    v_smfmac_f32_16x16x64_bf16 v[164:167], a[220:223], v[228:235], v36 abid:1
    ds_read_b128 v[220:223], v1 offset:25600
    ds_read_b128 v[224:227], v2 offset:25600
    s_waitcnt vmcnt(25)
    v_xad_u32 v237, v237, v3, v4
    v_smfmac_f32_16x16x64_bf16 v[132:135], a[224:227], v[196:203], v37
    buffer_load_dwordx4 v[120:123], v11, s[16:19], s43 offen offset:3072 sc1
    ds_read2st64_b32 v[244:245], v236 offset0:0 offset1:72
    ds_read2st64_b32 v[246:247], v237 offset0:0 offset1:72
    v_xad_u32 v238, v238, v3, v4
    v_smfmac_f32_16x16x64_bf16 v[168:171], a[224:227], v[228:235], v37
    s_waitcnt vmcnt(25)
    v_xad_u32 v239, v239, v3, v4
    v_smfmac_f32_16x16x64_bf16 v[136:139], a[228:231], v[196:203], v37 abid:1
    s_add_u32 m0, s29, 11840
    s_nop 0
    buffer_load_dword v0, s[8:11], 0 offen lds
    s_mov_b32 m0, s42
    s_nop 0
    buffer_load_dwordx4 v5, s[8:11], s22 offen offset:0 nt lds
    ds_read2st64_b32 v[248:249], v238 offset0:0 offset1:72
    ds_read2st64_b32 v[250:251], v239 offset0:0 offset1:72
    ds_read_b128 v[240:243], v8 offset:8192
    ds_read_b128 v[236:239], v9 offset:9664
    v_smfmac_f32_16x16x64_bf16 v[172:175], a[228:231], v[228:235], v37 abid:1
    s_waitcnt vmcnt(26)
    v_smfmac_f32_16x16x64_bf16 v[140:143], a[232:235], v[196:203], v38
    s_add_u32 m0, m0, 896
    s_nop 0
    buffer_load_dwordx4 v5, s[8:11], s22 offen offset:128 nt lds
    v_smfmac_f32_16x16x64_bf16 v[176:179], a[232:235], v[228:235], v38
    s_waitcnt vmcnt(26)
    v_smfmac_f32_16x16x64_bf16 v[144:147], a[236:239], v[196:203], v38 abid:1
    s_add_u32 m0, m0, 896
    s_nop 0
    buffer_load_dwordx4 v5, s[8:11], s22 offen offset:256 nt lds
    v_smfmac_f32_16x16x64_bf16 v[180:183], a[236:239], v[228:235], v38 abid:1
    s_waitcnt vmcnt(26)
    v_smfmac_f32_16x16x64_bf16 v[148:151], a[240:243], v[196:203], v39
    s_add_u32 m0, m0, 896
    s_nop 0
    buffer_load_dwordx4 v5, s[8:11], s22 offen offset:384 nt lds
    s_waitcnt lgkmcnt(1)
    v_smfmac_f32_16x16x64_bf16 v[156:159], v[240:243], v[244:251], v10
    v_smfmac_f32_16x16x64_bf16 v[192:195], v[240:243], v[244:251], v10 abid:1
    s_waitcnt lgkmcnt(0)
    v_xad_u32 v236, v236, v3, v4
    v_smfmac_f32_16x16x64_bf16 v[184:187], a[240:243], v[228:235], v39
    s_waitcnt vmcnt(26)
    v_xad_u32 v237, v237, v3, v4
    v_smfmac_f32_16x16x64_bf16 v[152:155], a[244:247], v[196:203], v39 abid:1
    ds_read2st64_b32 v[244:245], v236 offset0:0 offset1:72
    ds_read2st64_b32 v[246:247], v237 offset0:0 offset1:72
    v_xad_u32 v238, v238, v3, v4
    v_smfmac_f32_16x16x64_bf16 v[188:191], a[244:247], v[228:235], v39 abid:1
    s_waitcnt vmcnt(25)
    v_xad_u32 v239, v239, v3, v4
    v_smfmac_f32_16x16x64_bf16 v[156:159], a[248:251], v[196:203], v51
    ds_read2st64_b32 v[248:249], v238 offset0:0 offset1:72
    ds_read2st64_b32 v[250:251], v239 offset0:0 offset1:72
    ds_read_b128 v[240:243], v8 offset:7168
    ds_read_b128 v[236:239], v9 offset:9536
    v_smfmac_f32_16x16x64_bf16 v[192:195], a[248:251], v[228:235], v51
    s_waitcnt vmcnt(23)
    v_smfmac_f32_16x16x64_bf16 v[124:127], a[252:255], v[204:211], v40
    ds_read_b128 v[196:199], v1 offset:8192
    ds_read_b128 v[200:203], v2 offset:8192
    s_waitcnt vmcnt(22)
    v_smfmac_f32_16x16x64_bf16 v[128:131], v[56:59], v[204:211], v40 abid:1
    ds_read_b128 v[228:231], v1 offset:26624
    ds_read_b128 v[232:235], v2 offset:26624
    s_waitcnt vmcnt(21)
    v_smfmac_f32_16x16x64_bf16 v[132:135], v[60:63], v[204:211], v41
    s_waitcnt lgkmcnt(5)
    v_smfmac_f32_16x16x64_bf16 v[152:155], v[240:243], v[244:251], v10
    v_smfmac_f32_16x16x64_bf16 v[188:191], v[240:243], v[244:251], v10 abid:1
    s_waitcnt lgkmcnt(4)
    v_xad_u32 v236, v236, v3, v4
    s_waitcnt vmcnt(20)
    v_xad_u32 v237, v237, v3, v4
    v_smfmac_f32_16x16x64_bf16 v[136:139], v[64:67], v[204:211], v41 abid:1
    ds_read2st64_b32 v[244:245], v236 offset0:0 offset1:72
    ds_read2st64_b32 v[246:247], v237 offset0:0 offset1:72
    v_xad_u32 v238, v238, v3, v4
    s_waitcnt vmcnt(19)
    v_xad_u32 v239, v239, v3, v4
    v_smfmac_f32_16x16x64_bf16 v[140:143], v[68:71], v[204:211], v42
    ds_read2st64_b32 v[248:249], v238 offset0:0 offset1:72
    ds_read2st64_b32 v[250:251], v239 offset0:0 offset1:72
    ds_read_b128 v[240:243], v8 offset:5120
    ds_read_b128 v[236:239], v9 offset:9600
    s_waitcnt vmcnt(18)
    v_smfmac_f32_16x16x64_bf16 v[144:147], v[72:75], v[204:211], v42 abid:1
    s_waitcnt vmcnt(17)
    v_smfmac_f32_16x16x64_bf16 v[148:151], v[76:79], v[204:211], v43
    s_waitcnt vmcnt(16)
    v_smfmac_f32_16x16x64_bf16 v[152:155], v[80:83], v[204:211], v43 abid:1
    s_waitcnt lgkmcnt(1)
    v_smfmac_f32_16x16x64_bf16 v[144:147], v[240:243], v[244:251], v10
    v_smfmac_f32_16x16x64_bf16 v[180:183], v[240:243], v[244:251], v10 abid:1
    s_waitcnt lgkmcnt(0)
    v_xad_u32 v236, v236, v3, v4
    s_waitcnt vmcnt(15)
    v_xad_u32 v237, v237, v3, v4
    v_smfmac_f32_16x16x64_bf16 v[156:159], v[84:87], v[204:211], v51 abid:1
    ds_read2st64_b32 v[244:245], v236 offset0:0 offset1:72
    ds_read2st64_b32 v[246:247], v237 offset0:0 offset1:72
    v_xad_u32 v238, v238, v3, v4
    s_waitcnt vmcnt(13)
    v_xad_u32 v239, v239, v3, v4
    v_smfmac_f32_16x16x64_bf16 v[124:127], v[88:91], v[196:203], v44
    ds_read2st64_b32 v[248:249], v238 offset0:0 offset1:72
    ds_read2st64_b32 v[250:251], v239 offset0:0 offset1:72
    ds_read_b128 v[240:243], v8 offset:6144
    ds_read_b128 v[236:239], v9 offset:9472
    s_waitcnt vmcnt(12)
    v_smfmac_f32_16x16x64_bf16 v[128:131], v[92:95], v[196:203], v44 abid:1
    s_waitcnt vmcnt(11)
    v_smfmac_f32_16x16x64_bf16 v[132:135], v[96:99], v[196:203], v45
    s_waitcnt vmcnt(10)
    v_smfmac_f32_16x16x64_bf16 v[136:139], v[100:103], v[196:203], v45 abid:1
    s_waitcnt lgkmcnt(1)
    v_smfmac_f32_16x16x64_bf16 v[148:151], v[240:243], v[244:251], v10
    v_smfmac_f32_16x16x64_bf16 v[184:187], v[240:243], v[244:251], v10 abid:1
    s_waitcnt lgkmcnt(0)
    v_xad_u32 v236, v236, v3, v4
    s_waitcnt vmcnt(9)
    v_xad_u32 v237, v237, v3, v4
    v_smfmac_f32_16x16x64_bf16 v[140:143], v[104:107], v[196:203], v46
    ds_read2st64_b32 v[244:245], v236 offset0:0 offset1:72
    ds_read2st64_b32 v[246:247], v237 offset0:0 offset1:72
    v_xad_u32 v238, v238, v3, v4
    s_waitcnt vmcnt(8)
    v_xad_u32 v239, v239, v3, v4
    v_smfmac_f32_16x16x64_bf16 v[144:147], v[108:111], v[196:203], v46 abid:1
    ds_read2st64_b32 v[248:249], v238 offset0:0 offset1:72
    ds_read2st64_b32 v[250:251], v239 offset0:0 offset1:72
    ds_read_b128 v[240:243], v8 offset:4096
    s_waitcnt vmcnt(7)
    v_smfmac_f32_16x16x64_bf16 v[148:151], v[112:115], v[196:203], v47
    s_waitcnt vmcnt(6)
    v_smfmac_f32_16x16x64_bf16 v[152:155], v[116:119], v[196:203], v47 abid:1
    s_waitcnt vmcnt(5)
    v_smfmac_f32_16x16x64_bf16 v[156:159], v[120:123], v[196:203], v52
    s_waitcnt lgkmcnt(0)
    v_smfmac_f32_16x16x64_bf16 v[140:143], v[240:243], v[244:251], v10
    v_smfmac_f32_16x16x64_bf16 v[176:179], v[240:243], v[244:251], v10 abid:1
    s_cmp_gt_u32 s46, s80
    s_cbranch_scc1 M_slow
M_slowr0:
    s_cmp_eq_u32 s20, 0
    s_mov_b32 s31, 1073903880
    s_cselect_b32 s30, 162048, s31
    v_mov_b32 v11, s31
    v_writelane_b32 v11, s30, 0
    v_cvt_pk_bf16_f32 v124, v124, v125
    v_cvt_pk_bf16_f32 v125, v126, v127
    v_cvt_pk_bf16_f32 v126, v128, v129
    v_cvt_pk_bf16_f32 v127, v130, v131
    v_cvt_pk_bf16_f32 v132, v132, v133
    v_cvt_pk_bf16_f32 v133, v134, v135
    v_cvt_pk_bf16_f32 v134, v136, v137
    v_cvt_pk_bf16_f32 v135, v138, v139
    ds_read_b128 v[136:139], v9 offset:10432
    v_cndmask_b32_dpp v128, v124, v132, vcc row_ror:8 row_mask:0xf bank_mask:0xf
    v_cndmask_b32_dpp v129, v125, v133, vcc row_ror:8 row_mask:0xf bank_mask:0xf
    v_cndmask_b32_dpp v130, v126, v134, vcc row_ror:8 row_mask:0xf bank_mask:0xf
    v_cndmask_b32_dpp v131, v127, v135, vcc row_ror:8 row_mask:0xf bank_mask:0xf
    buffer_store_dwordx4 v[128:131], v6, s[12:15], s59 offen offset:0 sc1
    v_mov_b32_dpp v124, v132 row_ror:8 row_mask:0xf bank_mask:0xc
    v_mov_b32_dpp v125, v133 row_ror:8 row_mask:0xf bank_mask:0xc
    v_mov_b32_dpp v126, v134 row_ror:8 row_mask:0xf bank_mask:0xc
    v_mov_b32_dpp v127, v135 row_ror:8 row_mask:0xf bank_mask:0xc
    buffer_store_dwordx4 v[124:127], v6, s[12:15], s24 offen offset:0 sc1
    ds_read_b128 v[128:131], v9 offset:10304
    ds_read_b128 v[132:135], v9 offset:10368
    ds_read_b128 v[124:127], v9 offset:10240
    v_cvt_pk_bf16_f32 v140, v140, v141
    v_cvt_pk_bf16_f32 v141, v142, v143
    v_cvt_pk_bf16_f32 v142, v144, v145
    v_cvt_pk_bf16_f32 v143, v146, v147
    v_cvt_pk_bf16_f32 v148, v148, v149
    v_cvt_pk_bf16_f32 v149, v150, v151
    v_cvt_pk_bf16_f32 v150, v152, v153
    v_cvt_pk_bf16_f32 v151, v154, v155
    ds_read_b128 v[152:155], v9 offset:10688
    v_cndmask_b32_dpp v144, v140, v148, vcc row_ror:8 row_mask:0xf bank_mask:0xf
    v_cndmask_b32_dpp v145, v141, v149, vcc row_ror:8 row_mask:0xf bank_mask:0xf
    v_cndmask_b32_dpp v146, v142, v150, vcc row_ror:8 row_mask:0xf bank_mask:0xf
    v_cndmask_b32_dpp v147, v143, v151, vcc row_ror:8 row_mask:0xf bank_mask:0xf
    buffer_store_dwordx4 v[144:147], v6, s[12:15], s59 offen offset:128 sc1
    v_mov_b32_dpp v140, v148 row_ror:8 row_mask:0xf bank_mask:0xc
    v_mov_b32_dpp v141, v149 row_ror:8 row_mask:0xf bank_mask:0xc
    v_mov_b32_dpp v142, v150 row_ror:8 row_mask:0xf bank_mask:0xc
    v_mov_b32_dpp v143, v151 row_ror:8 row_mask:0xf bank_mask:0xc
    buffer_store_dwordx4 v[140:143], v6, s[12:15], s24 offen offset:128 sc1
    ds_read_b128 v[144:147], v9 offset:10560
    ds_read_b128 v[148:151], v9 offset:10624
    ds_read_b128 v[140:143], v9 offset:10496
    v_cvt_pk_bf16_f32 v156, v156, v157
    v_cvt_pk_bf16_f32 v157, v158, v159
    ds_write_b64 v53, v[156:157] offset:25728
    ds_read_b128 v[156:159], v9 offset:10752
    s_mov_b32 s89, 0
    s_mov_b32 s101, 34209792
    s_mov_b32 s91, 0
    s_mov_b32 s25, 36864
    s_add_u32 s90, s24, 9437184
    s_mov_b32 s28, s26
    s_add_u32 s23, s24, 18432
    s_cmp_lt_u32 s20, 2
    s_cselect_b32 s66, s23, s24
    s_cselect_b32 s99, s14, 75497472
    s_add_u32 s66, s66, s95
    v_add_u32 v4, 36864, v4
    v_add_u32 v1, 36864, v1
    v_add_u32 v2, 36864, v2
M_top:
M_top1:
    s_add_u32 s23, s24, 18432
    s_add_u32 s58, s24, 27648
    s_mov_b32 s24, s90
    s_add_u32 s59, s90, 9216
    s_waitcnt lgkmcnt(0)
    s_barrier
    ds_read_b128 v[244:247], v8 offset:10816
    v_smfmac_f32_16x16x64_bf16 v[160:163], a[252:255], v[220:227], v40
    ds_read_b128 v[196:199], v1 offset:0
    v_smfmac_f32_16x16x64_bf16 v[160:163], v[88:91], v[228:235], v44
    ds_read_b128 v[200:203], v2 offset:0
    s_cmp_lt_u32 s22, 75497472
    s_cbranch_scc0 M_bF
    s_cmp_lt_u32 s91, 2
    s_cbranch_scc1 M_bE0
M_bL:
    v_smfmac_f32_16x16x64_bf16 v[164:167], v[56:59], v[220:227], v40 abid:1
    ds_read_b128 v[204:207], v1 offset:1024
    v_smfmac_f32_16x16x64_bf16 v[164:167], v[92:95], v[228:235], v44 abid:1
    ds_read_b128 v[208:211], v2 offset:1024
    v_mov_b32 v0, 1
    v_smfmac_f32_16x16x64_bf16 v[168:171], v[60:63], v[220:227], v41
    ds_read_b128 v[212:215], v1 offset:2048
    v_smfmac_f32_16x16x64_bf16 v[168:171], v[96:99], v[228:235], v45
    ds_read_b128 v[216:219], v2 offset:2048
    v_smfmac_f32_16x16x64_bf16 v[172:175], v[64:67], v[220:227], v41 abid:1
    s_waitcnt vmcnt(6)
    s_waitcnt lgkmcnt(6)
    buffer_store_dwordx4 v[244:247], v7, s[12:15], s66 offen sc1
    v_smfmac_f32_16x16x64_bf16 v[172:175], v[100:103], v[228:235], v45 abid:1
    ds_read_b128 v[236:239], v9 offset:9408
    v_smfmac_f32_16x16x64_bf16 v[176:179], v[68:71], v[220:227], v42
    s_waitcnt vmcnt(6)
    buffer_atomic_add v0, v11, s[16:19], s92 offen sc0 sc1
    s_mov_b32 s21, 1
    v_smfmac_f32_16x16x64_bf16 v[176:179], v[104:107], v[228:235], v46
    v_smfmac_f32_16x16x64_bf16 v[180:183], v[72:75], v[220:227], v42 abid:1
    v_cvt_pk_bf16_f32 v160, v160, v161
    v_smfmac_f32_16x16x64_bf16 v[180:183], v[108:111], v[228:235], v46 abid:1
    v_cvt_pk_bf16_f32 v161, v162, v163
    v_smfmac_f32_16x16x64_bf16 v[184:187], v[76:79], v[220:227], v43
    v_cvt_pk_bf16_f32 v162, v164, v165
    v_smfmac_f32_16x16x64_bf16 v[184:187], v[112:115], v[228:235], v47
    v_cvt_pk_bf16_f32 v163, v166, v167
    v_smfmac_f32_16x16x64_bf16 v[188:191], v[80:83], v[220:227], v43 abid:1
    s_add_u32 m0, m0, 896
    v_cvt_pk_bf16_f32 v168, v168, v169
    v_smfmac_f32_16x16x64_bf16 v[188:191], v[116:119], v[228:235], v47 abid:1
    s_waitcnt vmcnt(6)
    buffer_load_dwordx4 v5, s[8:11], s22 offen offset:512 nt lds
    v_cvt_pk_bf16_f32 v169, v170, v171
    v_smfmac_f32_16x16x64_bf16 v[192:195], v[84:87], v[220:227], v51 abid:1
    v_cvt_pk_bf16_f32 v170, v172, v173
    v_smfmac_f32_16x16x64_bf16 v[192:195], v[120:123], v[228:235], v52
    ds_read_b128 v[220:223], v1 offset:3072
    s_waitcnt lgkmcnt(6)
    v_cvt_pk_bf16_f32 v171, v174, v175
    v_smfmac_f32_16x16x64_bf16 v[124:127], a[0:3], v[196:203], v12
    ds_read_b128 v[224:227], v2 offset:3072
    ds_read_b128 v[172:175], v9 offset:10432
    s_waitcnt lgkmcnt(6)
    v_cndmask_b32_dpp v164, v160, v168, vcc row_ror:8 row_mask:0xf bank_mask:0xf
    v_smfmac_f32_16x16x64_bf16 v[124:127], a[36:39], v[204:211], v16
    ds_read_b128 v[228:231], v1 offset:4096
    s_waitcnt lgkmcnt(5)
    v_cndmask_b32_dpp v165, v161, v169, vcc row_ror:8 row_mask:0xf bank_mask:0xf
    v_smfmac_f32_16x16x64_bf16 v[124:127], a[72:75], v[212:219], v20
    ds_read_b128 v[232:235], v2 offset:4096
    v_cndmask_b32_dpp v166, v162, v170, vcc row_ror:8 row_mask:0xf bank_mask:0xf
    v_smfmac_f32_16x16x64_bf16 v[128:131], a[4:7], v[196:203], v12 abid:1
    s_barrier
    v_cndmask_b32_dpp v167, v163, v171, vcc row_ror:8 row_mask:0xf bank_mask:0xf
    v_smfmac_f32_16x16x64_bf16 v[128:131], a[40:43], v[204:211], v16 abid:1
    s_waitcnt vmcnt(6)
    buffer_store_dwordx4 v[164:167], v6, s[12:15], s58 offen offset:0 sc1
    s_waitcnt lgkmcnt(5)
    v_xad_u32 v236, v236, v3, v4
    v_smfmac_f32_16x16x64_bf16 v[128:131], a[76:79], v[212:219], v20 abid:1
    v_xad_u32 v237, v237, v3, v4
    v_smfmac_f32_16x16x64_bf16 v[132:135], a[8:11], v[196:203], v13
    ds_read2st64_b32 v[244:245], v236 offset0:0 offset1:72
    ds_read_b128 v[240:243], v8 offset:3072
    v_xad_u32 v238, v238, v3, v4
    v_smfmac_f32_16x16x64_bf16 v[132:135], a[44:47], v[204:211], v17
    ds_read2st64_b32 v[246:247], v237 offset0:0 offset1:72
    v_xad_u32 v239, v239, v3, v4
    v_smfmac_f32_16x16x64_bf16 v[132:135], a[80:83], v[212:219], v21
    ds_read2st64_b32 v[248:249], v238 offset0:0 offset1:72
    v_mov_b32_dpp v160, v168 row_ror:8 row_mask:0xf bank_mask:0xc
    v_smfmac_f32_16x16x64_bf16 v[144:147], a[20:23], v[196:203], v14 abid:1
    ds_read2st64_b32 v[250:251], v239 offset0:0 offset1:72
    ds_read_b128 v[236:239], v9 offset:9280
    v_mov_b32_dpp v161, v169 row_ror:8 row_mask:0xf bank_mask:0xc
    v_smfmac_f32_16x16x64_bf16 v[144:147], a[56:59], v[204:211], v18 abid:1
    v_mov_b32_dpp v162, v170 row_ror:8 row_mask:0xf bank_mask:0xc
    v_smfmac_f32_16x16x64_bf16 v[144:147], a[92:95], v[212:219], v22 abid:1
    v_mov_b32_dpp v163, v171 row_ror:8 row_mask:0xf bank_mask:0xc
    v_smfmac_f32_16x16x64_bf16 v[140:143], a[16:19], v[196:203], v14
    s_waitcnt vmcnt(6)
    buffer_store_dwordx4 v[160:163], v6, s[12:15], s23 offen offset:0 sc1
    ds_read_b128 v[164:167], v9 offset:10304
    v_smfmac_f32_16x16x64_bf16 v[140:143], a[52:55], v[204:211], v18
    ds_read_b128 v[168:171], v9 offset:10368
    ds_read_b128 v[160:163], v9 offset:10240
    v_smfmac_f32_16x16x64_bf16 v[140:143], a[88:91], v[212:219], v22
    v_smfmac_f32_16x16x64_bf16 v[136:139], a[12:15], v[196:203], v13 abid:1
    v_smfmac_f32_16x16x64_bf16 v[136:139], a[48:51], v[204:211], v17 abid:1
    v_smfmac_f32_16x16x64_bf16 v[136:139], a[84:87], v[212:219], v21 abid:1
    s_waitcnt lgkmcnt(3)
    v_xad_u32 v236, v236, v3, v4
    v_smfmac_f32_16x16x64_bf16 v[136:139], v[240:243], v[244:251], v10
    v_xad_u32 v237, v237, v3, v4
    v_smfmac_f32_16x16x64_bf16 v[172:175], v[240:243], v[244:251], v10 abid:1
    ds_read2st64_b32 v[244:245], v236 offset0:0 offset1:72
    ds_read_b128 v[240:243], v8 offset:1024
    v_xad_u32 v238, v238, v3, v4
    v_smfmac_f32_16x16x64_bf16 v[148:151], a[24:27], v[196:203], v15
    ds_read2st64_b32 v[246:247], v237 offset0:0 offset1:72
    v_xad_u32 v239, v239, v3, v4
    v_smfmac_f32_16x16x64_bf16 v[148:151], a[60:63], v[204:211], v19
    ds_read2st64_b32 v[248:249], v238 offset0:0 offset1:72
    v_cvt_pk_bf16_f32 v192, v192, v193
    v_smfmac_f32_16x16x64_bf16 v[148:151], a[96:99], v[212:219], v23
    ds_read2st64_b32 v[250:251], v239 offset0:0 offset1:72
    ds_read_b128 v[236:239], v9 offset:9344
    v_cvt_pk_bf16_f32 v193, v194, v195
    v_smfmac_f32_16x16x64_bf16 v[152:155], a[28:31], v[196:203], v15 abid:1
    ds_write_b64 v53, v[192:193] offset:0
    ds_read_b128 v[192:195], v9 offset:10752
    v_smfmac_f32_16x16x64_bf16 v[152:155], a[64:67], v[204:211], v19 abid:1
    s_add_u32 m0, m0, 896
    v_smfmac_f32_16x16x64_bf16 v[152:155], a[100:103], v[212:219], v23 abid:1
    s_waitcnt vmcnt(6)
    buffer_load_dwordx4 v5, s[8:11], s22 offen offset:640 nt lds
    v_smfmac_f32_16x16x64_bf16 v[156:159], a[32:35], v[196:203], v48
    v_smfmac_f32_16x16x64_bf16 v[156:159], a[68:71], v[204:211], v48 abid:1
    v_smfmac_f32_16x16x64_bf16 v[156:159], a[104:107], v[212:219], v49
    ds_read_b128 v[196:199], v1 offset:5120
    v_cvt_pk_bf16_f32 v176, v176, v177
    v_smfmac_f32_16x16x64_bf16 v[124:127], a[108:111], v[220:227], v24
    ds_read_b128 v[200:203], v2 offset:5120
    v_cvt_pk_bf16_f32 v177, v178, v179
    v_smfmac_f32_16x16x64_bf16 v[124:127], a[144:147], v[228:235], v28
    ds_read_b128 v[204:207], v1 offset:6144
    ds_read_b64 v[216:217], v9 offset:10056
    v_cvt_pk_bf16_f32 v178, v180, v181
    v_smfmac_f32_16x16x64_bf16 v[128:131], a[112:115], v[220:227], v24 abid:1
    ds_read_b128 v[208:211], v2 offset:6144
    v_cvt_pk_bf16_f32 v179, v182, v183
    v_smfmac_f32_16x16x64_bf16 v[128:131], a[148:151], v[228:235], v28 abid:1
    s_waitcnt lgkmcnt(7)
    v_xad_u32 v236, v236, v3, v4
    v_smfmac_f32_16x16x64_bf16 v[128:131], v[240:243], v[244:251], v10
    s_add_u32 m0, m0, 896
    v_xad_u32 v237, v237, v3, v4
    v_smfmac_f32_16x16x64_bf16 v[164:167], v[240:243], v[244:251], v10 abid:1
    ds_read2st64_b32 v[244:245], v236 offset0:0 offset1:72
    ds_read_b128 v[240:243], v8 offset:2048
    v_xad_u32 v238, v238, v3, v4
    v_smfmac_f32_16x16x64_bf16 v[152:155], a[136:139], v[220:227], v27 abid:1
    ds_read2st64_b32 v[246:247], v237 offset0:0 offset1:72
    s_waitcnt vmcnt(6)
    v_xad_u32 v239, v239, v3, v4
    v_smfmac_f32_16x16x64_bf16 v[152:155], a[172:175], v[228:235], v31 abid:1
    ds_read2st64_b32 v[248:249], v238 offset0:0 offset1:72
    buffer_load_dwordx4 v5, s[8:11], s22 offen offset:768 nt lds
    v_cvt_pk_bf16_f32 v184, v184, v185
    v_smfmac_f32_16x16x64_bf16 v[136:139], a[120:123], v[220:227], v25 abid:1
    ds_read2st64_b32 v[250:251], v239 offset0:0 offset1:72
    ds_read_b128 v[236:239], v9 offset:9216
    v_cvt_pk_bf16_f32 v185, v186, v187
    v_smfmac_f32_16x16x64_bf16 v[136:139], a[156:159], v[228:235], v29 abid:1
    v_cvt_pk_bf16_f32 v186, v188, v189
    v_smfmac_f32_16x16x64_bf16 v[140:143], a[124:127], v[220:227], v26
    v_cvt_pk_bf16_f32 v187, v190, v191
    v_smfmac_f32_16x16x64_bf16 v[140:143], a[160:163], v[228:235], v30
    ds_read_b128 v[188:191], v9 offset:10688
    v_cndmask_b32_dpp v180, v176, v184, vcc row_ror:8 row_mask:0xf bank_mask:0xf
    v_smfmac_f32_16x16x64_bf16 v[144:147], a[128:131], v[220:227], v26 abid:1
    v_cndmask_b32_dpp v181, v177, v185, vcc row_ror:8 row_mask:0xf bank_mask:0xf
    v_smfmac_f32_16x16x64_bf16 v[144:147], a[164:167], v[228:235], v30 abid:1
    v_cndmask_b32_dpp v182, v178, v186, vcc row_ror:8 row_mask:0xf bank_mask:0xf
    v_smfmac_f32_16x16x64_bf16 v[148:151], a[132:135], v[220:227], v27
    v_cndmask_b32_dpp v183, v179, v187, vcc row_ror:8 row_mask:0xf bank_mask:0xf
    v_smfmac_f32_16x16x64_bf16 v[148:151], a[168:171], v[228:235], v31
    s_waitcnt vmcnt(6)
    buffer_store_dwordx4 v[180:183], v6, s[12:15], s58 offen offset:128 sc1
    s_waitcnt lgkmcnt(8)
    v_xad_u32 v212, v216, v3, v4
    v_smfmac_f32_16x16x64_bf16 v[132:135], a[116:119], v[220:227], v25
    ds_read2st64_b32 v[212:213], v212 offset0:0 offset1:72
    v_xad_u32 v214, v217, v3, v4
    v_smfmac_f32_16x16x64_bf16 v[132:135], a[152:155], v[228:235], v29
    ds_read2st64_b32 v[214:215], v214 offset0:0 offset1:72
    s_waitcnt lgkmcnt(3)
    v_xad_u32 v236, v236, v3, v4
    v_smfmac_f32_16x16x64_bf16 v[132:135], v[240:243], v[244:251], v10
    v_xad_u32 v237, v237, v3, v4
    v_smfmac_f32_16x16x64_bf16 v[168:171], v[240:243], v[244:251], v10 abid:1
    ds_read2st64_b32 v[244:245], v236 offset0:0 offset1:72
    ds_read_b128 v[240:243], v8 offset:0
    v_xad_u32 v238, v238, v3, v4
    v_smfmac_f32_16x16x64_bf16 v[156:159], a[140:143], v[220:227], v49 abid:1
    ds_read2st64_b32 v[246:247], v237 offset0:0 offset1:72
    v_xad_u32 v239, v239, v3, v4
    v_smfmac_f32_16x16x64_bf16 v[156:159], a[176:179], v[228:235], v50
    ds_read2st64_b32 v[248:249], v238 offset0:0 offset1:72
    v_mov_b32_dpp v176, v184 row_ror:8 row_mask:0xf bank_mask:0xc
    v_smfmac_f32_16x16x64_bf16 v[140:143], a[196:199], v[196:203], v34
    ds_read2st64_b32 v[250:251], v239 offset0:0 offset1:72
    ds_read_b128 v[236:239], v9 offset:9728
    v_mov_b32_dpp v177, v185 row_ror:8 row_mask:0xf bank_mask:0xc
    v_smfmac_f32_16x16x64_bf16 v[140:143], a[232:235], v[204:211], v38
    v_mov_b32_dpp v178, v186 row_ror:8 row_mask:0xf bank_mask:0xc
    v_smfmac_f32_16x16x64_bf16 v[128:131], a[184:187], v[196:203], v32 abid:1
    v_mov_b32_dpp v179, v187 row_ror:8 row_mask:0xf bank_mask:0xc
    v_smfmac_f32_16x16x64_bf16 v[128:131], a[220:223], v[204:211], v36 abid:1
    s_waitcnt vmcnt(6)
    buffer_store_dwordx4 v[176:179], v6, s[12:15], s23 offen offset:128 sc1
    ds_read_b128 v[180:183], v9 offset:10560
    v_smfmac_f32_16x16x64_bf16 v[132:135], a[188:191], v[196:203], v33
    ds_read_b128 v[184:187], v9 offset:10624
    ds_read_b128 v[176:179], v9 offset:10496
    v_smfmac_f32_16x16x64_bf16 v[132:135], a[224:227], v[204:211], v37
    v_smfmac_f32_16x16x64_bf16 v[136:139], a[192:195], v[196:203], v33 abid:1
    ds_read_b128 v[220:223], v1 offset:7168
    v_smfmac_f32_16x16x64_bf16 v[136:139], a[228:231], v[204:211], v37 abid:1
    ds_read_b128 v[224:227], v2 offset:7168
    v_smfmac_f32_16x16x64_bf16 v[124:127], a[180:183], v[196:203], v32
    ds_read_b128 v[228:231], v1 offset:8192
    v_smfmac_f32_16x16x64_bf16 v[124:127], a[216:219], v[204:211], v36
    s_waitcnt vmcnt(7)
    s_waitcnt lgkmcnt(6)
    v_xad_u32 v236, v236, v3, v4
    v_smfmac_f32_16x16x64_bf16 v[124:127], v[240:243], v[244:251], v10
    ds_read_b128 v[232:235], v2 offset:8192
    v_xad_u32 v237, v237, v3, v4
    v_smfmac_f32_16x16x64_bf16 v[160:163], v[240:243], v[244:251], v10 abid:1
    ds_read2st64_b32 v[244:245], v236 offset0:0 offset1:72
    ds_read_b128 v[240:243], v8 offset:8192
    v_xad_u32 v238, v238, v3, v4
    v_smfmac_f32_16x16x64_bf16 v[144:147], a[200:203], v[196:203], v34 abid:1
    ds_read2st64_b32 v[246:247], v237 offset0:0 offset1:72
    v_xad_u32 v239, v239, v3, v4
    v_smfmac_f32_16x16x64_bf16 v[144:147], a[236:239], v[204:211], v38 abid:1
    ds_read2st64_b32 v[248:249], v238 offset0:0 offset1:72
    v_mul_u32_u24 v0, s94, v0
    v_smfmac_f32_16x16x64_bf16 v[148:151], a[204:207], v[196:203], v35
    ds_read2st64_b32 v[250:251], v239 offset0:0 offset1:72
    ds_read_b128 v[236:239], v9 offset:9664
    v_add_u32 v0, s93, v0
    v_smfmac_f32_16x16x64_bf16 v[148:151], a[240:243], v[204:211], v39
    s_waitcnt lgkmcnt(10)
    s_cmp_lt_i32 s81, 0
    s_cbranch_scc1 M_ovrL
    s_swappc_b64 s[78:79], s[72:73]
M_ovrL:
    v_smfmac_f32_16x16x64_bf16 v[152:155], a[208:211], v[196:203], v35 abid:1
    s_add_u32 m0, m0, 896
    v_min_u32 v0, 75497472, v0
    v_smfmac_f32_16x16x64_bf16 v[152:155], a[244:247], v[204:211], v39 abid:1
    ds_write_b32 v11, v0
    s_waitcnt vmcnt(6)
    v_mov_b32 v0, 162048
    v_smfmac_f32_16x16x64_bf16 v[156:159], a[212:215], v[196:203], v50 abid:1
    buffer_load_dwordx4 v5, s[8:11], s22 offen offset:896 nt lds
    v_smfmac_f32_16x16x64_bf16 v[156:159], a[248:251], v[204:211], v51
    s_waitcnt lgkmcnt(9)
    v_smfmac_f32_16x16x64_bf16 v[124:127], a[252:255], v[220:227], v40
    ds_read_b128 v[196:199], v1 offset:18432
    s_waitcnt lgkmcnt(8)
    v_smfmac_f32_16x16x64_bf16 v[124:127], v[88:91], v[228:235], v44
    ds_read_b128 v[200:203], v2 offset:18432
    v_smfmac_f32_16x16x64_bf16 v[156:159], v[84:87], v[220:227], v51 abid:1
    ds_read_b128 v[204:207], v1 offset:19456
    v_smfmac_f32_16x16x64_bf16 v[156:159], v[120:123], v[228:235], v52
    s_waitcnt lgkmcnt(3)
    s_barrier
    v_xad_u32 v236, v236, v3, v4
    v_smfmac_f32_16x16x64_bf16 v[156:159], v[240:243], v[244:251], v10
    ds_read_b128 v[208:211], v2 offset:19456
    ds_read_b32 v0, v0
    v_xad_u32 v237, v237, v3, v4
    v_smfmac_f32_16x16x64_bf16 v[192:195], v[240:243], v[244:251], v10 abid:1
    ds_read2st64_b32 v[244:245], v236 offset0:0 offset1:72
    ds_read_b128 v[240:243], v8 offset:7168
    v_xad_u32 v238, v238, v3, v4
    v_smfmac_f32_16x16x64_bf16 v[132:135], v[60:63], v[220:227], v41
    ds_read2st64_b32 v[246:247], v237 offset0:0 offset1:72
    v_xad_u32 v239, v239, v3, v4
    v_smfmac_f32_16x16x64_bf16 v[132:135], v[96:99], v[228:235], v45
    ds_read2st64_b32 v[248:249], v238 offset0:0 offset1:72
    s_add_u32 m0, m0, 896
    v_smfmac_f32_16x16x64_bf16 v[136:139], v[64:67], v[220:227], v41 abid:1
    ds_read2st64_b32 v[250:251], v239 offset0:0 offset1:72
    ds_read_b128 v[236:239], v9 offset:9536
    s_waitcnt vmcnt(6)
    v_smfmac_f32_16x16x64_bf16 v[136:139], v[100:103], v[228:235], v45 abid:1
    buffer_load_dwordx4 v5, s[8:11], s22 offen offset:1024 nt lds
    s_waitcnt lgkmcnt(6)
    v_readfirstlane_b32 s88, v0
    v_smfmac_f32_16x16x64_bf16 v[140:143], v[68:71], v[220:227], v42
    s_cmp_lt_u32 s88, s99
    s_cselect_b32 s10, 75497472, 0
    v_smfmac_f32_16x16x64_bf16 v[140:143], v[104:107], v[228:235], v46
    s_cmp_lt_u32 s88, s14
    s_cbranch_scc0 M_q
M_nq:
    v_smfmac_f32_16x16x64_bf16 v[144:147], v[72:75], v[220:227], v42 abid:1
    ds_read_b128 v[212:215], v1 offset:20480
    v_smfmac_f32_16x16x64_bf16 v[144:147], v[108:111], v[228:235], v46 abid:1
    ds_read_b128 v[216:219], v2 offset:20480
    v_smfmac_f32_16x16x64_bf16 v[148:151], v[76:79], v[220:227], v43
    v_smfmac_f32_16x16x64_bf16 v[148:151], v[112:115], v[228:235], v47
    v_smfmac_f32_16x16x64_bf16 v[152:155], v[80:83], v[220:227], v43 abid:1
    v_smfmac_f32_16x16x64_bf16 v[152:155], v[116:119], v[228:235], v47 abid:1
    s_waitcnt lgkmcnt(2)
    v_xad_u32 v236, v236, v3, v4
    v_smfmac_f32_16x16x64_bf16 v[152:155], v[240:243], v[244:251], v10
    v_xad_u32 v237, v237, v3, v4
    v_smfmac_f32_16x16x64_bf16 v[188:191], v[240:243], v[244:251], v10 abid:1
    s_cmp_gt_u32 s46, s80
    s_cbranch_scc1 M_slow
M_slowrL:
    v_xad_u32 v238, v238, v3, v4
    v_smfmac_f32_16x16x64_bf16 v[128:131], v[56:59], v[220:227], v40 abid:1
    ds_read2st64_b32 v[244:245], v236 offset0:0 offset1:72
    ds_read_b128 v[240:243], v8 offset:5120
    v_xad_u32 v239, v239, v3, v4
    v_smfmac_f32_16x16x64_bf16 v[128:131], v[92:95], v[228:235], v44 abid:1
    ds_read2st64_b32 v[246:247], v237 offset0:0 offset1:72
    v_smfmac_f32_16x16x64_bf16 v[160:163], a[0:3], v[196:203], v12
    ds_read2st64_b32 v[248:249], v238 offset0:0 offset1:72
    v_smfmac_f32_16x16x64_bf16 v[160:163], a[36:39], v[204:211], v16
    ds_read2st64_b32 v[250:251], v239 offset0:0 offset1:72
    ds_read_b128 v[236:239], v9 offset:9600
    s_waitcnt lgkmcnt(6)
    v_smfmac_f32_16x16x64_bf16 v[160:163], a[72:75], v[212:219], v20
    v_smfmac_f32_16x16x64_bf16 v[164:167], a[4:7], v[196:203], v12 abid:1
    s_mov_b32 m0, s28
    v_cvt_pk_bf16_f32 v156, v156, v157
    v_smfmac_f32_16x16x64_bf16 v[164:167], a[40:43], v[204:211], v16 abid:1
    s_waitcnt vmcnt(6)
    buffer_load_dwordx4 v5, s[8:11], s88 offen offset:0 nt lds
    v_cvt_pk_bf16_f32 v157, v158, v159
    v_smfmac_f32_16x16x64_bf16 v[164:167], a[76:79], v[212:219], v20 abid:1
    ds_write_b64 v53, v[156:157] offset:25728
    ds_read_b128 v[156:159], v9 offset:10752
    v_smfmac_f32_16x16x64_bf16 v[180:183], a[20:23], v[196:203], v14 abid:1
    v_smfmac_f32_16x16x64_bf16 v[180:183], a[56:59], v[204:211], v18 abid:1
    ds_read_b128 v[220:223], v1 offset:21504
    v_cvt_pk_bf16_f32 v124, v124, v125
    v_smfmac_f32_16x16x64_bf16 v[180:183], a[92:95], v[212:219], v22 abid:1
    s_waitcnt lgkmcnt(3)
    v_xad_u32 v236, v236, v3, v4
    v_smfmac_f32_16x16x64_bf16 v[180:183], v[240:243], v[244:251], v10 abid:1
    v_xad_u32 v237, v237, v3, v4
    v_smfmac_f32_16x16x64_bf16 v[144:147], v[240:243], v[244:251], v10
    ds_read2st64_b32 v[244:245], v236 offset0:0 offset1:72
    ds_read_b128 v[240:243], v8 offset:6144
    v_xad_u32 v238, v238, v3, v4
    v_smfmac_f32_16x16x64_bf16 v[172:175], a[12:15], v[196:203], v13 abid:1
    ds_read2st64_b32 v[246:247], v237 offset0:0 offset1:72
    v_xad_u32 v239, v239, v3, v4
    v_smfmac_f32_16x16x64_bf16 v[172:175], a[48:51], v[204:211], v17 abid:1
    ds_read2st64_b32 v[248:249], v238 offset0:0 offset1:72
    v_cvt_pk_bf16_f32 v125, v126, v127
    v_smfmac_f32_16x16x64_bf16 v[172:175], a[84:87], v[212:219], v21 abid:1
    ds_read2st64_b32 v[250:251], v239 offset0:0 offset1:72
    ds_read_b128 v[236:239], v9 offset:9472
    v_cvt_pk_bf16_f32 v126, v128, v129
    v_smfmac_f32_16x16x64_bf16 v[176:179], a[16:19], v[196:203], v14
    v_cvt_pk_bf16_f32 v127, v130, v131
    v_smfmac_f32_16x16x64_bf16 v[176:179], a[52:55], v[204:211], v18
    v_cvt_pk_bf16_f32 v132, v132, v133
    v_smfmac_f32_16x16x64_bf16 v[176:179], a[88:91], v[212:219], v22
    v_cvt_pk_bf16_f32 v133, v134, v135
    v_smfmac_f32_16x16x64_bf16 v[168:171], a[8:11], v[196:203], v13
    s_add_u32 m0, m0, 896
    v_cvt_pk_bf16_f32 v134, v136, v137
    v_smfmac_f32_16x16x64_bf16 v[168:171], a[44:47], v[204:211], v17
    s_waitcnt vmcnt(6)
    buffer_load_dwordx4 v5, s[8:11], s88 offen offset:128 nt lds
    v_cvt_pk_bf16_f32 v135, v138, v139
    v_smfmac_f32_16x16x64_bf16 v[168:171], a[80:83], v[212:219], v21
    ds_read_b128 v[224:227], v2 offset:21504
    ds_read_b128 v[136:139], v9 offset:10432
    v_cndmask_b32_dpp v128, v124, v132, vcc row_ror:8 row_mask:0xf bank_mask:0xf
    v_smfmac_f32_16x16x64_bf16 v[184:187], a[24:27], v[196:203], v15
    ds_read_b128 v[228:231], v1 offset:22528
    v_cndmask_b32_dpp v129, v125, v133, vcc row_ror:8 row_mask:0xf bank_mask:0xf
    v_smfmac_f32_16x16x64_bf16 v[184:187], a[60:63], v[204:211], v19
    ds_read_b128 v[232:235], v2 offset:22528
    v_cndmask_b32_dpp v130, v126, v134, vcc row_ror:8 row_mask:0xf bank_mask:0xf
    v_smfmac_f32_16x16x64_bf16 v[184:187], a[96:99], v[212:219], v23
    s_waitcnt lgkmcnt(4)
    v_xad_u32 v236, v236, v3, v4
    v_smfmac_f32_16x16x64_bf16 v[184:187], v[240:243], v[244:251], v10 abid:1
    v_xad_u32 v237, v237, v3, v4
    v_smfmac_f32_16x16x64_bf16 v[148:151], v[240:243], v[244:251], v10
    ds_read2st64_b32 v[244:245], v236 offset0:0 offset1:72
    ds_read_b128 v[240:243], v8 offset:4096
    v_xad_u32 v238, v238, v3, v4
    v_smfmac_f32_16x16x64_bf16 v[188:191], a[28:31], v[196:203], v15 abid:1
    ds_read2st64_b32 v[246:247], v237 offset0:0 offset1:72
    v_xad_u32 v239, v239, v3, v4
    v_smfmac_f32_16x16x64_bf16 v[188:191], a[64:67], v[204:211], v19 abid:1
    ds_read2st64_b32 v[248:249], v238 offset0:0 offset1:72
    v_cndmask_b32_dpp v131, v127, v135, vcc row_ror:8 row_mask:0xf bank_mask:0xf
    v_smfmac_f32_16x16x64_bf16 v[188:191], a[100:103], v[212:219], v23 abid:1
    ds_read2st64_b32 v[250:251], v239 offset0:0 offset1:72
    s_waitcnt vmcnt(6)
    buffer_store_dwordx4 v[128:131], v6, s[12:15], s59 offen offset:0 sc1
    v_smfmac_f32_16x16x64_bf16 v[192:195], a[32:35], v[196:203], v48
    v_mov_b32_dpp v124, v132 row_ror:8 row_mask:0xf bank_mask:0xc
    v_smfmac_f32_16x16x64_bf16 v[192:195], a[68:71], v[204:211], v48 abid:1
    v_mov_b32_dpp v125, v133 row_ror:8 row_mask:0xf bank_mask:0xc
    v_smfmac_f32_16x16x64_bf16 v[192:195], a[104:107], v[212:219], v49
    s_waitcnt lgkmcnt(8)
    v_mov_b32_dpp v126, v134 row_ror:8 row_mask:0xf bank_mask:0xc
    v_smfmac_f32_16x16x64_bf16 v[160:163], a[108:111], v[220:227], v24
    s_waitcnt lgkmcnt(5)
    v_mov_b32_dpp v127, v135 row_ror:8 row_mask:0xf bank_mask:0xc
    v_smfmac_f32_16x16x64_bf16 v[160:163], a[144:147], v[228:235], v28
    ds_read_b128 v[196:199], v1 offset:23552
    s_waitcnt vmcnt(6)
    buffer_store_dwordx4 v[124:127], v6, s[12:15], s24 offen offset:0 sc1
    v_smfmac_f32_16x16x64_bf16 v[164:167], a[112:115], v[220:227], v24 abid:1
    ds_read_b128 v[200:203], v2 offset:23552
    ds_read_b128 v[128:131], v9 offset:10304
    ds_read_b128 v[132:135], v9 offset:10368
    v_smfmac_f32_16x16x64_bf16 v[164:167], a[148:151], v[228:235], v28 abid:1
    ds_read_b128 v[204:207], v1 offset:24576
    ds_read_b128 v[124:127], v9 offset:10240
    v_smfmac_f32_16x16x64_bf16 v[176:179], a[124:127], v[220:227], v26
    ds_read_b128 v[208:211], v2 offset:24576
    v_smfmac_f32_16x16x64_bf16 v[176:179], a[160:163], v[228:235], v30
    s_waitcnt lgkmcnt(7)
    v_smfmac_f32_16x16x64_bf16 v[176:179], v[240:243], v[244:251], v10 abid:1
    v_smfmac_f32_16x16x64_bf16 v[140:143], v[240:243], v[244:251], v10
    v_smfmac_f32_16x16x64_bf16 v[172:175], a[120:123], v[220:227], v25 abid:1
    s_add_u32 s28, s28, 36864
    s_cmp_ge_u32 s28, 110592
    s_cselect_b32 s28, s26, s28
    v_smfmac_f32_16x16x64_bf16 v[172:175], a[156:159], v[228:235], v29 abid:1
    s_add_u32 s30, s25, 36864
    s_cmp_eq_u32 s30, 110592
    s_cselect_b32 s30, 0, s30
    v_smfmac_f32_16x16x64_bf16 v[168:171], a[116:119], v[220:227], v25
    s_sub_u32 s31, s30, s25
    s_mov_b32 s25, s30
    s_mov_b32 s90, s22
    v_smfmac_f32_16x16x64_bf16 v[168:171], a[152:155], v[228:235], v29
    s_mov_b32 s22, s88
    s_add_u32 s91, s91, 1
    s_cmp_lt_u32 s20, 2
    v_smfmac_f32_16x16x64_bf16 v[180:183], a[128:131], v[220:227], v26 abid:1
    s_cselect_b32 s66, s23, s24
    s_add_u32 s66, s66, s95
    v_smfmac_f32_16x16x64_bf16 v[180:183], a[164:167], v[228:235], v30 abid:1
    v_cvt_pk_bf16_f32 v140, v140, v141
    v_smfmac_f32_16x16x64_bf16 v[184:187], a[132:135], v[220:227], v27
    s_add_u32 m0, m0, 896
    v_cvt_pk_bf16_f32 v141, v142, v143
    v_smfmac_f32_16x16x64_bf16 v[184:187], a[168:171], v[228:235], v31
    s_waitcnt vmcnt(6)
    buffer_load_dwordx4 v5, s[8:11], s88 offen offset:256 nt lds
    v_cvt_pk_bf16_f32 v142, v144, v145
    v_smfmac_f32_16x16x64_bf16 v[188:191], a[136:139], v[220:227], v27 abid:1
    v_cvt_pk_bf16_f32 v143, v146, v147
    v_smfmac_f32_16x16x64_bf16 v[188:191], a[172:175], v[228:235], v31 abid:1
    v_cvt_pk_bf16_f32 v148, v148, v149
    v_smfmac_f32_16x16x64_bf16 v[192:195], a[140:143], v[220:227], v49 abid:1
    v_cvt_pk_bf16_f32 v149, v150, v151
    v_smfmac_f32_16x16x64_bf16 v[192:195], a[176:179], v[228:235], v50
    ds_read_b128 v[220:223], v1 offset:25600
    s_waitcnt lgkmcnt(6)
    v_cvt_pk_bf16_f32 v150, v152, v153
    v_smfmac_f32_16x16x64_bf16 v[160:163], a[180:183], v[196:203], v32
    ds_read_b128 v[224:227], v2 offset:25600
    s_waitcnt lgkmcnt(2)
    v_cvt_pk_bf16_f32 v151, v154, v155
    v_smfmac_f32_16x16x64_bf16 v[160:163], a[216:219], v[204:211], v36
    ds_read_b128 v[228:231], v1 offset:26624
    ds_read_b128 v[152:155], v9 offset:10688
    v_cndmask_b32_dpp v144, v140, v148, vcc row_ror:8 row_mask:0xf bank_mask:0xf
    v_smfmac_f32_16x16x64_bf16 v[164:167], a[184:187], v[196:203], v32 abid:1
    ds_read_b128 v[232:235], v2 offset:26624
    v_cndmask_b32_dpp v145, v141, v149, vcc row_ror:8 row_mask:0xf bank_mask:0xf
    v_smfmac_f32_16x16x64_bf16 v[164:167], a[220:223], v[204:211], v36 abid:1
    s_add_u32 m0, m0, 896
    v_cndmask_b32_dpp v146, v142, v150, vcc row_ror:8 row_mask:0xf bank_mask:0xf
    v_smfmac_f32_16x16x64_bf16 v[168:171], a[188:191], v[196:203], v33
    s_waitcnt vmcnt(6)
    buffer_load_dwordx4 v5, s[8:11], s88 offen offset:384 nt lds
    v_cndmask_b32_dpp v147, v143, v151, vcc row_ror:8 row_mask:0xf bank_mask:0xf
    v_smfmac_f32_16x16x64_bf16 v[168:171], a[224:227], v[204:211], v37
    s_waitcnt vmcnt(6)
    buffer_store_dwordx4 v[144:147], v6, s[12:15], s59 offen offset:128 sc1
    v_mov_b32_dpp v140, v148 row_ror:8 row_mask:0xf bank_mask:0xc
    v_smfmac_f32_16x16x64_bf16 v[172:175], a[192:195], v[196:203], v33 abid:1
    v_mov_b32_dpp v141, v149 row_ror:8 row_mask:0xf bank_mask:0xc
    v_smfmac_f32_16x16x64_bf16 v[172:175], a[228:231], v[204:211], v37 abid:1
    v_mov_b32_dpp v142, v150 row_ror:8 row_mask:0xf bank_mask:0xc
    v_smfmac_f32_16x16x64_bf16 v[176:179], a[196:199], v[196:203], v34
    v_mov_b32_dpp v143, v151 row_ror:8 row_mask:0xf bank_mask:0xc
    v_smfmac_f32_16x16x64_bf16 v[176:179], a[232:235], v[204:211], v38
    s_waitcnt vmcnt(6)
    buffer_store_dwordx4 v[140:143], v6, s[12:15], s24 offen offset:128 sc1
    ds_read_b128 v[144:147], v9 offset:10560
    v_smfmac_f32_16x16x64_bf16 v[180:183], a[200:203], v[196:203], v34 abid:1
    ds_read_b128 v[148:151], v9 offset:10624
    ds_read_b128 v[140:143], v9 offset:10496
    v_add_u32 v4, s31, v4
    v_smfmac_f32_16x16x64_bf16 v[180:183], a[236:239], v[204:211], v38 abid:1
    v_add_u32 v1, s31, v1
    v_smfmac_f32_16x16x64_bf16 v[184:187], a[204:207], v[196:203], v35
    v_add_u32 v2, s31, v2
    v_smfmac_f32_16x16x64_bf16 v[184:187], a[240:243], v[204:211], v39
    v_smfmac_f32_16x16x64_bf16 v[188:191], a[208:211], v[196:203], v35 abid:1
    v_smfmac_f32_16x16x64_bf16 v[188:191], a[244:247], v[204:211], v39 abid:1
    v_smfmac_f32_16x16x64_bf16 v[192:195], a[212:215], v[196:203], v50 abid:1
    v_smfmac_f32_16x16x64_bf16 v[192:195], a[248:251], v[204:211], v51
    s_waitcnt vmcnt(8)
    s_branch M_top1
M_bE0:
    v_smfmac_f32_16x16x64_bf16 v[164:167], v[56:59], v[220:227], v40 abid:1
    ds_read_b128 v[204:207], v1 offset:1024
    v_smfmac_f32_16x16x64_bf16 v[164:167], v[92:95], v[228:235], v44 abid:1
    ds_read_b128 v[208:211], v2 offset:1024
    v_mov_b32 v0, 1
    v_smfmac_f32_16x16x64_bf16 v[168:171], v[60:63], v[220:227], v41
    ds_read_b128 v[212:215], v1 offset:2048
    v_smfmac_f32_16x16x64_bf16 v[168:171], v[96:99], v[228:235], v45
    ds_read_b128 v[216:219], v2 offset:2048
    v_smfmac_f32_16x16x64_bf16 v[172:175], v[64:67], v[220:227], v41 abid:1
    s_waitcnt vmcnt(5)
    s_waitcnt lgkmcnt(6)
    buffer_store_dwordx4 v[244:247], v7, s[12:15], s66 offen sc1
    v_smfmac_f32_16x16x64_bf16 v[172:175], v[100:103], v[228:235], v45 abid:1
    ds_read_b128 v[236:239], v9 offset:9408
    v_smfmac_f32_16x16x64_bf16 v[176:179], v[68:71], v[220:227], v42
    s_waitcnt vmcnt(5)
    buffer_atomic_add v0, v11, s[16:19], s92 offen sc0 sc1
    s_mov_b32 s21, 2
    v_smfmac_f32_16x16x64_bf16 v[176:179], v[104:107], v[228:235], v46
    v_smfmac_f32_16x16x64_bf16 v[180:183], v[72:75], v[220:227], v42 abid:1
    v_cvt_pk_bf16_f32 v160, v160, v161
    v_smfmac_f32_16x16x64_bf16 v[180:183], v[108:111], v[228:235], v46 abid:1
    v_cvt_pk_bf16_f32 v161, v162, v163
    v_smfmac_f32_16x16x64_bf16 v[184:187], v[76:79], v[220:227], v43
    v_cvt_pk_bf16_f32 v162, v164, v165
    v_smfmac_f32_16x16x64_bf16 v[184:187], v[112:115], v[228:235], v47
    v_cvt_pk_bf16_f32 v163, v166, v167
    v_smfmac_f32_16x16x64_bf16 v[188:191], v[80:83], v[220:227], v43 abid:1
    s_add_u32 m0, m0, 896
    v_cvt_pk_bf16_f32 v168, v168, v169
    v_smfmac_f32_16x16x64_bf16 v[188:191], v[116:119], v[228:235], v47 abid:1
    s_waitcnt vmcnt(5)
    buffer_load_dwordx4 v5, s[8:11], s22 offen offset:512 nt lds
    v_cvt_pk_bf16_f32 v169, v170, v171
    v_smfmac_f32_16x16x64_bf16 v[192:195], v[84:87], v[220:227], v51 abid:1
    v_cvt_pk_bf16_f32 v170, v172, v173
    v_smfmac_f32_16x16x64_bf16 v[192:195], v[120:123], v[228:235], v52
    ds_read_b128 v[220:223], v1 offset:3072
    s_waitcnt lgkmcnt(6)
    v_cvt_pk_bf16_f32 v171, v174, v175
    v_smfmac_f32_16x16x64_bf16 v[124:127], a[0:3], v[196:203], v12
    ds_read_b128 v[224:227], v2 offset:3072
    ds_read_b128 v[172:175], v9 offset:10432
    s_waitcnt lgkmcnt(6)
    v_cndmask_b32_dpp v164, v160, v168, vcc row_ror:8 row_mask:0xf bank_mask:0xf
    v_smfmac_f32_16x16x64_bf16 v[124:127], a[36:39], v[204:211], v16
    ds_read_b128 v[228:231], v1 offset:4096
    s_waitcnt lgkmcnt(5)
    v_cndmask_b32_dpp v165, v161, v169, vcc row_ror:8 row_mask:0xf bank_mask:0xf
    v_smfmac_f32_16x16x64_bf16 v[124:127], a[72:75], v[212:219], v20
    ds_read_b128 v[232:235], v2 offset:4096
    v_cndmask_b32_dpp v166, v162, v170, vcc row_ror:8 row_mask:0xf bank_mask:0xf
    v_smfmac_f32_16x16x64_bf16 v[128:131], a[4:7], v[196:203], v12 abid:1
    s_barrier
    v_cndmask_b32_dpp v167, v163, v171, vcc row_ror:8 row_mask:0xf bank_mask:0xf
    v_smfmac_f32_16x16x64_bf16 v[128:131], a[40:43], v[204:211], v16 abid:1
    s_waitcnt vmcnt(5)
    buffer_store_dwordx4 v[164:167], v6, s[12:15], s58 offen offset:0 sc1
    s_waitcnt lgkmcnt(5)
    v_xad_u32 v236, v236, v3, v4
    v_smfmac_f32_16x16x64_bf16 v[128:131], a[76:79], v[212:219], v20 abid:1
    v_xad_u32 v237, v237, v3, v4
    v_smfmac_f32_16x16x64_bf16 v[132:135], a[8:11], v[196:203], v13
    ds_read2st64_b32 v[244:245], v236 offset0:0 offset1:72
    ds_read_b128 v[240:243], v8 offset:3072
    v_xad_u32 v238, v238, v3, v4
    v_smfmac_f32_16x16x64_bf16 v[132:135], a[44:47], v[204:211], v17
    ds_read2st64_b32 v[246:247], v237 offset0:0 offset1:72
    v_xad_u32 v239, v239, v3, v4
    v_smfmac_f32_16x16x64_bf16 v[132:135], a[80:83], v[212:219], v21
    ds_read2st64_b32 v[248:249], v238 offset0:0 offset1:72
    v_mov_b32_dpp v160, v168 row_ror:8 row_mask:0xf bank_mask:0xc
    v_smfmac_f32_16x16x64_bf16 v[144:147], a[20:23], v[196:203], v14 abid:1
    ds_read2st64_b32 v[250:251], v239 offset0:0 offset1:72
    ds_read_b128 v[236:239], v9 offset:9280
    v_mov_b32_dpp v161, v169 row_ror:8 row_mask:0xf bank_mask:0xc
    v_smfmac_f32_16x16x64_bf16 v[144:147], a[56:59], v[204:211], v18 abid:1
    v_mov_b32_dpp v162, v170 row_ror:8 row_mask:0xf bank_mask:0xc
    v_smfmac_f32_16x16x64_bf16 v[144:147], a[92:95], v[212:219], v22 abid:1
    v_mov_b32_dpp v163, v171 row_ror:8 row_mask:0xf bank_mask:0xc
    v_smfmac_f32_16x16x64_bf16 v[140:143], a[16:19], v[196:203], v14
    s_waitcnt vmcnt(5)
    buffer_store_dwordx4 v[160:163], v6, s[12:15], s23 offen offset:0 sc1
    ds_read_b128 v[164:167], v9 offset:10304
    v_smfmac_f32_16x16x64_bf16 v[140:143], a[52:55], v[204:211], v18
    ds_read_b128 v[168:171], v9 offset:10368
    ds_read_b128 v[160:163], v9 offset:10240
    v_smfmac_f32_16x16x64_bf16 v[140:143], a[88:91], v[212:219], v22
    v_smfmac_f32_16x16x64_bf16 v[136:139], a[12:15], v[196:203], v13 abid:1
    v_smfmac_f32_16x16x64_bf16 v[136:139], a[48:51], v[204:211], v17 abid:1
    v_smfmac_f32_16x16x64_bf16 v[136:139], a[84:87], v[212:219], v21 abid:1
    s_waitcnt lgkmcnt(3)
    v_xad_u32 v236, v236, v3, v4
    v_smfmac_f32_16x16x64_bf16 v[136:139], v[240:243], v[244:251], v10
    v_xad_u32 v237, v237, v3, v4
    v_smfmac_f32_16x16x64_bf16 v[172:175], v[240:243], v[244:251], v10 abid:1
    ds_read2st64_b32 v[244:245], v236 offset0:0 offset1:72
    ds_read_b128 v[240:243], v8 offset:1024
    v_xad_u32 v238, v238, v3, v4
    v_smfmac_f32_16x16x64_bf16 v[148:151], a[24:27], v[196:203], v15
    ds_read2st64_b32 v[246:247], v237 offset0:0 offset1:72
    v_xad_u32 v239, v239, v3, v4
    v_smfmac_f32_16x16x64_bf16 v[148:151], a[60:63], v[204:211], v19
    ds_read2st64_b32 v[248:249], v238 offset0:0 offset1:72
    v_cvt_pk_bf16_f32 v192, v192, v193
    v_smfmac_f32_16x16x64_bf16 v[148:151], a[96:99], v[212:219], v23
    ds_read2st64_b32 v[250:251], v239 offset0:0 offset1:72
    ds_read_b128 v[236:239], v9 offset:9344
    v_cvt_pk_bf16_f32 v193, v194, v195
    v_smfmac_f32_16x16x64_bf16 v[152:155], a[28:31], v[196:203], v15 abid:1
    ds_write_b64 v53, v[192:193] offset:0
    ds_read_b128 v[192:195], v9 offset:10752
    v_smfmac_f32_16x16x64_bf16 v[152:155], a[64:67], v[204:211], v19 abid:1
    s_add_u32 m0, m0, 896
    v_smfmac_f32_16x16x64_bf16 v[152:155], a[100:103], v[212:219], v23 abid:1
    s_waitcnt vmcnt(5)
    buffer_load_dwordx4 v5, s[8:11], s22 offen offset:640 nt lds
    v_smfmac_f32_16x16x64_bf16 v[156:159], a[32:35], v[196:203], v48
    v_smfmac_f32_16x16x64_bf16 v[156:159], a[68:71], v[204:211], v48 abid:1
    v_smfmac_f32_16x16x64_bf16 v[156:159], a[104:107], v[212:219], v49
    ds_read_b128 v[196:199], v1 offset:5120
    v_cvt_pk_bf16_f32 v176, v176, v177
    v_smfmac_f32_16x16x64_bf16 v[124:127], a[108:111], v[220:227], v24
    ds_read_b128 v[200:203], v2 offset:5120
    v_cvt_pk_bf16_f32 v177, v178, v179
    v_smfmac_f32_16x16x64_bf16 v[124:127], a[144:147], v[228:235], v28
    ds_read_b128 v[204:207], v1 offset:6144
    ds_read_b64 v[216:217], v9 offset:10056
    v_cvt_pk_bf16_f32 v178, v180, v181
    v_smfmac_f32_16x16x64_bf16 v[128:131], a[112:115], v[220:227], v24 abid:1
    ds_read_b128 v[208:211], v2 offset:6144
    v_cvt_pk_bf16_f32 v179, v182, v183
    v_smfmac_f32_16x16x64_bf16 v[128:131], a[148:151], v[228:235], v28 abid:1
    s_waitcnt lgkmcnt(7)
    v_xad_u32 v236, v236, v3, v4
    v_smfmac_f32_16x16x64_bf16 v[128:131], v[240:243], v[244:251], v10
    s_add_u32 m0, m0, 896
    v_xad_u32 v237, v237, v3, v4
    v_smfmac_f32_16x16x64_bf16 v[164:167], v[240:243], v[244:251], v10 abid:1
    ds_read2st64_b32 v[244:245], v236 offset0:0 offset1:72
    ds_read_b128 v[240:243], v8 offset:2048
    v_xad_u32 v238, v238, v3, v4
    v_smfmac_f32_16x16x64_bf16 v[152:155], a[136:139], v[220:227], v27 abid:1
    ds_read2st64_b32 v[246:247], v237 offset0:0 offset1:72
    s_waitcnt vmcnt(5)
    v_xad_u32 v239, v239, v3, v4
    v_smfmac_f32_16x16x64_bf16 v[152:155], a[172:175], v[228:235], v31 abid:1
    ds_read2st64_b32 v[248:249], v238 offset0:0 offset1:72
    buffer_load_dwordx4 v5, s[8:11], s22 offen offset:768 nt lds
    v_cvt_pk_bf16_f32 v184, v184, v185
    v_smfmac_f32_16x16x64_bf16 v[136:139], a[120:123], v[220:227], v25 abid:1
    ds_read2st64_b32 v[250:251], v239 offset0:0 offset1:72
    ds_read_b128 v[236:239], v9 offset:9216
    v_cvt_pk_bf16_f32 v185, v186, v187
    v_smfmac_f32_16x16x64_bf16 v[136:139], a[156:159], v[228:235], v29 abid:1
    v_cvt_pk_bf16_f32 v186, v188, v189
    v_smfmac_f32_16x16x64_bf16 v[140:143], a[124:127], v[220:227], v26
    v_cvt_pk_bf16_f32 v187, v190, v191
    v_smfmac_f32_16x16x64_bf16 v[140:143], a[160:163], v[228:235], v30
    ds_read_b128 v[188:191], v9 offset:10688
    v_cndmask_b32_dpp v180, v176, v184, vcc row_ror:8 row_mask:0xf bank_mask:0xf
    v_smfmac_f32_16x16x64_bf16 v[144:147], a[128:131], v[220:227], v26 abid:1
    v_cndmask_b32_dpp v181, v177, v185, vcc row_ror:8 row_mask:0xf bank_mask:0xf
    v_smfmac_f32_16x16x64_bf16 v[144:147], a[164:167], v[228:235], v30 abid:1
    v_cndmask_b32_dpp v182, v178, v186, vcc row_ror:8 row_mask:0xf bank_mask:0xf
    v_smfmac_f32_16x16x64_bf16 v[148:151], a[132:135], v[220:227], v27
    v_cndmask_b32_dpp v183, v179, v187, vcc row_ror:8 row_mask:0xf bank_mask:0xf
    v_smfmac_f32_16x16x64_bf16 v[148:151], a[168:171], v[228:235], v31
    s_waitcnt vmcnt(5)
    buffer_store_dwordx4 v[180:183], v6, s[12:15], s58 offen offset:128 sc1
    s_waitcnt lgkmcnt(8)
    v_xad_u32 v212, v216, v3, v4
    v_smfmac_f32_16x16x64_bf16 v[132:135], a[116:119], v[220:227], v25
    ds_read2st64_b32 v[212:213], v212 offset0:0 offset1:72
    v_xad_u32 v214, v217, v3, v4
    v_smfmac_f32_16x16x64_bf16 v[132:135], a[152:155], v[228:235], v29
    ds_read2st64_b32 v[214:215], v214 offset0:0 offset1:72
    s_waitcnt lgkmcnt(3)
    v_xad_u32 v236, v236, v3, v4
    v_smfmac_f32_16x16x64_bf16 v[132:135], v[240:243], v[244:251], v10
    v_xad_u32 v237, v237, v3, v4
    v_smfmac_f32_16x16x64_bf16 v[168:171], v[240:243], v[244:251], v10 abid:1
    ds_read2st64_b32 v[244:245], v236 offset0:0 offset1:72
    ds_read_b128 v[240:243], v8 offset:0
    v_xad_u32 v238, v238, v3, v4
    v_smfmac_f32_16x16x64_bf16 v[156:159], a[140:143], v[220:227], v49 abid:1
    ds_read2st64_b32 v[246:247], v237 offset0:0 offset1:72
    v_xad_u32 v239, v239, v3, v4
    v_smfmac_f32_16x16x64_bf16 v[156:159], a[176:179], v[228:235], v50
    ds_read2st64_b32 v[248:249], v238 offset0:0 offset1:72
    v_mov_b32_dpp v176, v184 row_ror:8 row_mask:0xf bank_mask:0xc
    v_smfmac_f32_16x16x64_bf16 v[140:143], a[196:199], v[196:203], v34
    ds_read2st64_b32 v[250:251], v239 offset0:0 offset1:72
    ds_read_b128 v[236:239], v9 offset:9728
    v_mov_b32_dpp v177, v185 row_ror:8 row_mask:0xf bank_mask:0xc
    v_smfmac_f32_16x16x64_bf16 v[140:143], a[232:235], v[204:211], v38
    v_mov_b32_dpp v178, v186 row_ror:8 row_mask:0xf bank_mask:0xc
    v_smfmac_f32_16x16x64_bf16 v[128:131], a[184:187], v[196:203], v32 abid:1
    v_mov_b32_dpp v179, v187 row_ror:8 row_mask:0xf bank_mask:0xc
    v_smfmac_f32_16x16x64_bf16 v[128:131], a[220:223], v[204:211], v36 abid:1
    s_waitcnt vmcnt(5)
    buffer_store_dwordx4 v[176:179], v6, s[12:15], s23 offen offset:128 sc1
    ds_read_b128 v[180:183], v9 offset:10560
    v_smfmac_f32_16x16x64_bf16 v[132:135], a[188:191], v[196:203], v33
    ds_read_b128 v[184:187], v9 offset:10624
    ds_read_b128 v[176:179], v9 offset:10496
    v_smfmac_f32_16x16x64_bf16 v[132:135], a[224:227], v[204:211], v37
    v_smfmac_f32_16x16x64_bf16 v[136:139], a[192:195], v[196:203], v33 abid:1
    ds_read_b128 v[220:223], v1 offset:7168
    v_smfmac_f32_16x16x64_bf16 v[136:139], a[228:231], v[204:211], v37 abid:1
    ds_read_b128 v[224:227], v2 offset:7168
    v_smfmac_f32_16x16x64_bf16 v[124:127], a[180:183], v[196:203], v32
    ds_read_b128 v[228:231], v1 offset:8192
    v_smfmac_f32_16x16x64_bf16 v[124:127], a[216:219], v[204:211], v36
    s_waitcnt vmcnt(7)
    s_waitcnt lgkmcnt(6)
    v_xad_u32 v236, v236, v3, v4
    v_smfmac_f32_16x16x64_bf16 v[124:127], v[240:243], v[244:251], v10
    ds_read_b128 v[232:235], v2 offset:8192
    v_xad_u32 v237, v237, v3, v4
    v_smfmac_f32_16x16x64_bf16 v[160:163], v[240:243], v[244:251], v10 abid:1
    ds_read2st64_b32 v[244:245], v236 offset0:0 offset1:72
    ds_read_b128 v[240:243], v8 offset:8192
    v_xad_u32 v238, v238, v3, v4
    v_smfmac_f32_16x16x64_bf16 v[144:147], a[200:203], v[196:203], v34 abid:1
    ds_read2st64_b32 v[246:247], v237 offset0:0 offset1:72
    v_xad_u32 v239, v239, v3, v4
    v_smfmac_f32_16x16x64_bf16 v[144:147], a[236:239], v[204:211], v38 abid:1
    ds_read2st64_b32 v[248:249], v238 offset0:0 offset1:72
    v_mul_u32_u24 v0, s94, v0
    v_smfmac_f32_16x16x64_bf16 v[148:151], a[204:207], v[196:203], v35
    ds_read2st64_b32 v[250:251], v239 offset0:0 offset1:72
    ds_read_b128 v[236:239], v9 offset:9664
    v_add_u32 v0, s93, v0
    v_smfmac_f32_16x16x64_bf16 v[148:151], a[240:243], v[204:211], v39
    s_waitcnt lgkmcnt(10)
    s_cmp_lt_i32 s81, 0
    s_cbranch_scc1 M_ovrE0
    s_swappc_b64 s[78:79], s[72:73]
M_ovrE0:
    v_smfmac_f32_16x16x64_bf16 v[152:155], a[208:211], v[196:203], v35 abid:1
    s_add_u32 m0, m0, 896
    v_min_u32 v0, 75497472, v0
    v_smfmac_f32_16x16x64_bf16 v[152:155], a[244:247], v[204:211], v39 abid:1
    ds_write_b32 v11, v0
    s_waitcnt vmcnt(5)
    v_mov_b32 v0, 162048
    v_smfmac_f32_16x16x64_bf16 v[156:159], a[212:215], v[196:203], v50 abid:1
    buffer_load_dwordx4 v5, s[8:11], s22 offen offset:896 nt lds
    v_smfmac_f32_16x16x64_bf16 v[156:159], a[248:251], v[204:211], v51
    s_waitcnt lgkmcnt(9)
    v_smfmac_f32_16x16x64_bf16 v[124:127], a[252:255], v[220:227], v40
    ds_read_b128 v[196:199], v1 offset:18432
    s_waitcnt lgkmcnt(8)
    v_smfmac_f32_16x16x64_bf16 v[124:127], v[88:91], v[228:235], v44
    ds_read_b128 v[200:203], v2 offset:18432
    v_smfmac_f32_16x16x64_bf16 v[156:159], v[84:87], v[220:227], v51 abid:1
    ds_read_b128 v[204:207], v1 offset:19456
    v_smfmac_f32_16x16x64_bf16 v[156:159], v[120:123], v[228:235], v52
    s_waitcnt lgkmcnt(3)
    s_barrier
    v_xad_u32 v236, v236, v3, v4
    v_smfmac_f32_16x16x64_bf16 v[156:159], v[240:243], v[244:251], v10
    ds_read_b128 v[208:211], v2 offset:19456
    ds_read_b32 v0, v0
    v_xad_u32 v237, v237, v3, v4
    v_smfmac_f32_16x16x64_bf16 v[192:195], v[240:243], v[244:251], v10 abid:1
    ds_read2st64_b32 v[244:245], v236 offset0:0 offset1:72
    ds_read_b128 v[240:243], v8 offset:7168
    v_xad_u32 v238, v238, v3, v4
    v_smfmac_f32_16x16x64_bf16 v[132:135], v[60:63], v[220:227], v41
    ds_read2st64_b32 v[246:247], v237 offset0:0 offset1:72
    v_xad_u32 v239, v239, v3, v4
    v_smfmac_f32_16x16x64_bf16 v[132:135], v[96:99], v[228:235], v45
    ds_read2st64_b32 v[248:249], v238 offset0:0 offset1:72
    s_add_u32 m0, m0, 896
    v_smfmac_f32_16x16x64_bf16 v[136:139], v[64:67], v[220:227], v41 abid:1
    ds_read2st64_b32 v[250:251], v239 offset0:0 offset1:72
    ds_read_b128 v[236:239], v9 offset:9536
    s_waitcnt vmcnt(5)
    v_smfmac_f32_16x16x64_bf16 v[136:139], v[100:103], v[228:235], v45 abid:1
    buffer_load_dwordx4 v5, s[8:11], s22 offen offset:1024 nt lds
    s_waitcnt lgkmcnt(6)
    v_readfirstlane_b32 s88, v0
    v_smfmac_f32_16x16x64_bf16 v[140:143], v[68:71], v[220:227], v42
    s_cmp_lt_u32 s88, s99
    s_cselect_b32 s10, 75497472, 0
    v_smfmac_f32_16x16x64_bf16 v[140:143], v[104:107], v[228:235], v46
    v_smfmac_f32_16x16x64_bf16 v[144:147], v[72:75], v[220:227], v42 abid:1
    ds_read_b128 v[212:215], v1 offset:20480
    v_smfmac_f32_16x16x64_bf16 v[144:147], v[108:111], v[228:235], v46 abid:1
    ds_read_b128 v[216:219], v2 offset:20480
    v_smfmac_f32_16x16x64_bf16 v[148:151], v[76:79], v[220:227], v43
    v_smfmac_f32_16x16x64_bf16 v[148:151], v[112:115], v[228:235], v47
    v_smfmac_f32_16x16x64_bf16 v[152:155], v[80:83], v[220:227], v43 abid:1
    v_smfmac_f32_16x16x64_bf16 v[152:155], v[116:119], v[228:235], v47 abid:1
    s_waitcnt lgkmcnt(2)
    v_xad_u32 v236, v236, v3, v4
    v_smfmac_f32_16x16x64_bf16 v[152:155], v[240:243], v[244:251], v10
    v_xad_u32 v237, v237, v3, v4
    v_smfmac_f32_16x16x64_bf16 v[188:191], v[240:243], v[244:251], v10 abid:1
    s_cmp_gt_u32 s46, s80
    s_cbranch_scc1 M_slow
M_slowrE0:
    v_xad_u32 v238, v238, v3, v4
    v_smfmac_f32_16x16x64_bf16 v[128:131], v[56:59], v[220:227], v40 abid:1
    ds_read2st64_b32 v[244:245], v236 offset0:0 offset1:72
    ds_read_b128 v[240:243], v8 offset:5120
    v_xad_u32 v239, v239, v3, v4
    v_smfmac_f32_16x16x64_bf16 v[128:131], v[92:95], v[228:235], v44 abid:1
    ds_read2st64_b32 v[246:247], v237 offset0:0 offset1:72
    v_smfmac_f32_16x16x64_bf16 v[160:163], a[0:3], v[196:203], v12
    ds_read2st64_b32 v[248:249], v238 offset0:0 offset1:72
    v_smfmac_f32_16x16x64_bf16 v[160:163], a[36:39], v[204:211], v16
    ds_read2st64_b32 v[250:251], v239 offset0:0 offset1:72
    ds_read_b128 v[236:239], v9 offset:9600
    s_waitcnt lgkmcnt(6)
    v_smfmac_f32_16x16x64_bf16 v[160:163], a[72:75], v[212:219], v20
    v_smfmac_f32_16x16x64_bf16 v[164:167], a[4:7], v[196:203], v12 abid:1
    s_mov_b32 m0, s28
    v_cvt_pk_bf16_f32 v156, v156, v157
    v_smfmac_f32_16x16x64_bf16 v[164:167], a[40:43], v[204:211], v16 abid:1
    s_waitcnt vmcnt(5)
    buffer_load_dwordx4 v5, s[8:11], s88 offen offset:0 nt lds
    v_cvt_pk_bf16_f32 v157, v158, v159
    v_smfmac_f32_16x16x64_bf16 v[164:167], a[76:79], v[212:219], v20 abid:1
    ds_write_b64 v53, v[156:157] offset:25728
    ds_read_b128 v[156:159], v9 offset:10752
    v_smfmac_f32_16x16x64_bf16 v[180:183], a[20:23], v[196:203], v14 abid:1
    v_smfmac_f32_16x16x64_bf16 v[180:183], a[56:59], v[204:211], v18 abid:1
    ds_read_b128 v[220:223], v1 offset:21504
    v_cvt_pk_bf16_f32 v124, v124, v125
    v_smfmac_f32_16x16x64_bf16 v[180:183], a[92:95], v[212:219], v22 abid:1
    s_waitcnt lgkmcnt(3)
    v_xad_u32 v236, v236, v3, v4
    v_smfmac_f32_16x16x64_bf16 v[180:183], v[240:243], v[244:251], v10 abid:1
    v_xad_u32 v237, v237, v3, v4
    v_smfmac_f32_16x16x64_bf16 v[144:147], v[240:243], v[244:251], v10
    ds_read2st64_b32 v[244:245], v236 offset0:0 offset1:72
    ds_read_b128 v[240:243], v8 offset:6144
    v_xad_u32 v238, v238, v3, v4
    v_smfmac_f32_16x16x64_bf16 v[172:175], a[12:15], v[196:203], v13 abid:1
    ds_read2st64_b32 v[246:247], v237 offset0:0 offset1:72
    v_xad_u32 v239, v239, v3, v4
    v_smfmac_f32_16x16x64_bf16 v[172:175], a[48:51], v[204:211], v17 abid:1
    ds_read2st64_b32 v[248:249], v238 offset0:0 offset1:72
    v_cvt_pk_bf16_f32 v125, v126, v127
    v_smfmac_f32_16x16x64_bf16 v[172:175], a[84:87], v[212:219], v21 abid:1
    ds_read2st64_b32 v[250:251], v239 offset0:0 offset1:72
    ds_read_b128 v[236:239], v9 offset:9472
    v_cvt_pk_bf16_f32 v126, v128, v129
    v_smfmac_f32_16x16x64_bf16 v[176:179], a[16:19], v[196:203], v14
    v_cvt_pk_bf16_f32 v127, v130, v131
    v_smfmac_f32_16x16x64_bf16 v[176:179], a[52:55], v[204:211], v18
    v_cvt_pk_bf16_f32 v132, v132, v133
    v_smfmac_f32_16x16x64_bf16 v[176:179], a[88:91], v[212:219], v22
    v_cvt_pk_bf16_f32 v133, v134, v135
    v_smfmac_f32_16x16x64_bf16 v[168:171], a[8:11], v[196:203], v13
    s_add_u32 m0, m0, 896
    v_cvt_pk_bf16_f32 v134, v136, v137
    v_smfmac_f32_16x16x64_bf16 v[168:171], a[44:47], v[204:211], v17
    s_waitcnt vmcnt(5)
    buffer_load_dwordx4 v5, s[8:11], s88 offen offset:128 nt lds
    v_cvt_pk_bf16_f32 v135, v138, v139
    v_smfmac_f32_16x16x64_bf16 v[168:171], a[80:83], v[212:219], v21
    ds_read_b128 v[224:227], v2 offset:21504
    ds_read_b128 v[136:139], v9 offset:10432
    v_cndmask_b32_dpp v128, v124, v132, vcc row_ror:8 row_mask:0xf bank_mask:0xf
    v_smfmac_f32_16x16x64_bf16 v[184:187], a[24:27], v[196:203], v15
    ds_read_b128 v[228:231], v1 offset:22528
    v_cndmask_b32_dpp v129, v125, v133, vcc row_ror:8 row_mask:0xf bank_mask:0xf
    v_smfmac_f32_16x16x64_bf16 v[184:187], a[60:63], v[204:211], v19
    ds_read_b128 v[232:235], v2 offset:22528
    v_cndmask_b32_dpp v130, v126, v134, vcc row_ror:8 row_mask:0xf bank_mask:0xf
    v_smfmac_f32_16x16x64_bf16 v[184:187], a[96:99], v[212:219], v23
    s_waitcnt lgkmcnt(4)
    v_xad_u32 v236, v236, v3, v4
    v_smfmac_f32_16x16x64_bf16 v[184:187], v[240:243], v[244:251], v10 abid:1
    v_xad_u32 v237, v237, v3, v4
    v_smfmac_f32_16x16x64_bf16 v[148:151], v[240:243], v[244:251], v10
    ds_read2st64_b32 v[244:245], v236 offset0:0 offset1:72
    ds_read_b128 v[240:243], v8 offset:4096
    v_xad_u32 v238, v238, v3, v4
    v_smfmac_f32_16x16x64_bf16 v[188:191], a[28:31], v[196:203], v15 abid:1
    ds_read2st64_b32 v[246:247], v237 offset0:0 offset1:72
    v_xad_u32 v239, v239, v3, v4
    v_smfmac_f32_16x16x64_bf16 v[188:191], a[64:67], v[204:211], v19 abid:1
    ds_read2st64_b32 v[248:249], v238 offset0:0 offset1:72
    v_cndmask_b32_dpp v131, v127, v135, vcc row_ror:8 row_mask:0xf bank_mask:0xf
    v_smfmac_f32_16x16x64_bf16 v[188:191], a[100:103], v[212:219], v23 abid:1
    ds_read2st64_b32 v[250:251], v239 offset0:0 offset1:72
    s_waitcnt vmcnt(5)
    buffer_store_dwordx4 v[128:131], v6, s[12:15], s59 offen offset:0 sc1
    v_smfmac_f32_16x16x64_bf16 v[192:195], a[32:35], v[196:203], v48
    v_mov_b32_dpp v124, v132 row_ror:8 row_mask:0xf bank_mask:0xc
    v_smfmac_f32_16x16x64_bf16 v[192:195], a[68:71], v[204:211], v48 abid:1
    v_mov_b32_dpp v125, v133 row_ror:8 row_mask:0xf bank_mask:0xc
    v_smfmac_f32_16x16x64_bf16 v[192:195], a[104:107], v[212:219], v49
    s_waitcnt lgkmcnt(8)
    v_mov_b32_dpp v126, v134 row_ror:8 row_mask:0xf bank_mask:0xc
    v_smfmac_f32_16x16x64_bf16 v[160:163], a[108:111], v[220:227], v24
    s_waitcnt lgkmcnt(5)
    v_mov_b32_dpp v127, v135 row_ror:8 row_mask:0xf bank_mask:0xc
    v_smfmac_f32_16x16x64_bf16 v[160:163], a[144:147], v[228:235], v28
    ds_read_b128 v[196:199], v1 offset:23552
    s_waitcnt vmcnt(5)
    buffer_store_dwordx4 v[124:127], v6, s[12:15], s24 offen offset:0 sc1
    v_smfmac_f32_16x16x64_bf16 v[164:167], a[112:115], v[220:227], v24 abid:1
    ds_read_b128 v[200:203], v2 offset:23552
    ds_read_b128 v[128:131], v9 offset:10304
    ds_read_b128 v[132:135], v9 offset:10368
    v_smfmac_f32_16x16x64_bf16 v[164:167], a[148:151], v[228:235], v28 abid:1
    ds_read_b128 v[204:207], v1 offset:24576
    ds_read_b128 v[124:127], v9 offset:10240
    v_smfmac_f32_16x16x64_bf16 v[176:179], a[124:127], v[220:227], v26
    ds_read_b128 v[208:211], v2 offset:24576
    v_smfmac_f32_16x16x64_bf16 v[176:179], a[160:163], v[228:235], v30
    s_waitcnt lgkmcnt(7)
    v_smfmac_f32_16x16x64_bf16 v[176:179], v[240:243], v[244:251], v10 abid:1
    v_smfmac_f32_16x16x64_bf16 v[140:143], v[240:243], v[244:251], v10
    v_smfmac_f32_16x16x64_bf16 v[172:175], a[120:123], v[220:227], v25 abid:1
    s_add_u32 s28, s28, 36864
    s_cmp_ge_u32 s28, 110592
    s_cselect_b32 s28, s26, s28
    v_smfmac_f32_16x16x64_bf16 v[172:175], a[156:159], v[228:235], v29 abid:1
    s_add_u32 s30, s25, 36864
    s_cmp_eq_u32 s30, 110592
    s_cselect_b32 s30, 0, s30
    v_smfmac_f32_16x16x64_bf16 v[168:171], a[116:119], v[220:227], v25
    s_sub_u32 s31, s30, s25
    s_mov_b32 s25, s30
    s_mov_b32 s90, s22
    v_smfmac_f32_16x16x64_bf16 v[168:171], a[152:155], v[228:235], v29
    s_mov_b32 s22, s88
    s_add_u32 s91, s91, 1
    s_cmp_lt_u32 s20, 2
    v_smfmac_f32_16x16x64_bf16 v[180:183], a[128:131], v[220:227], v26 abid:1
    s_cselect_b32 s66, s23, s24
    s_add_u32 s66, s66, s95
    v_smfmac_f32_16x16x64_bf16 v[180:183], a[164:167], v[228:235], v30 abid:1
    v_cvt_pk_bf16_f32 v140, v140, v141
    v_smfmac_f32_16x16x64_bf16 v[184:187], a[132:135], v[220:227], v27
    s_add_u32 m0, m0, 896
    v_cvt_pk_bf16_f32 v141, v142, v143
    v_smfmac_f32_16x16x64_bf16 v[184:187], a[168:171], v[228:235], v31
    s_waitcnt vmcnt(5)
    buffer_load_dwordx4 v5, s[8:11], s88 offen offset:256 nt lds
    v_cvt_pk_bf16_f32 v142, v144, v145
    v_smfmac_f32_16x16x64_bf16 v[188:191], a[136:139], v[220:227], v27 abid:1
    v_cvt_pk_bf16_f32 v143, v146, v147
    v_smfmac_f32_16x16x64_bf16 v[188:191], a[172:175], v[228:235], v31 abid:1
    v_cvt_pk_bf16_f32 v148, v148, v149
    v_smfmac_f32_16x16x64_bf16 v[192:195], a[140:143], v[220:227], v49 abid:1
    v_cvt_pk_bf16_f32 v149, v150, v151
    v_smfmac_f32_16x16x64_bf16 v[192:195], a[176:179], v[228:235], v50
    ds_read_b128 v[220:223], v1 offset:25600
    s_waitcnt lgkmcnt(6)
    v_cvt_pk_bf16_f32 v150, v152, v153
    v_smfmac_f32_16x16x64_bf16 v[160:163], a[180:183], v[196:203], v32
    ds_read_b128 v[224:227], v2 offset:25600
    s_waitcnt lgkmcnt(2)
    v_cvt_pk_bf16_f32 v151, v154, v155
    v_smfmac_f32_16x16x64_bf16 v[160:163], a[216:219], v[204:211], v36
    ds_read_b128 v[228:231], v1 offset:26624
    ds_read_b128 v[152:155], v9 offset:10688
    v_cndmask_b32_dpp v144, v140, v148, vcc row_ror:8 row_mask:0xf bank_mask:0xf
    v_smfmac_f32_16x16x64_bf16 v[164:167], a[184:187], v[196:203], v32 abid:1
    ds_read_b128 v[232:235], v2 offset:26624
    v_cndmask_b32_dpp v145, v141, v149, vcc row_ror:8 row_mask:0xf bank_mask:0xf
    v_smfmac_f32_16x16x64_bf16 v[164:167], a[220:223], v[204:211], v36 abid:1
    s_add_u32 m0, m0, 896
    v_cndmask_b32_dpp v146, v142, v150, vcc row_ror:8 row_mask:0xf bank_mask:0xf
    v_smfmac_f32_16x16x64_bf16 v[168:171], a[188:191], v[196:203], v33
    s_waitcnt vmcnt(5)
    buffer_load_dwordx4 v5, s[8:11], s88 offen offset:384 nt lds
    v_cndmask_b32_dpp v147, v143, v151, vcc row_ror:8 row_mask:0xf bank_mask:0xf
    v_smfmac_f32_16x16x64_bf16 v[168:171], a[224:227], v[204:211], v37
    s_waitcnt vmcnt(5)
    buffer_store_dwordx4 v[144:147], v6, s[12:15], s59 offen offset:128 sc1
    v_mov_b32_dpp v140, v148 row_ror:8 row_mask:0xf bank_mask:0xc
    v_smfmac_f32_16x16x64_bf16 v[172:175], a[192:195], v[196:203], v33 abid:1
    v_mov_b32_dpp v141, v149 row_ror:8 row_mask:0xf bank_mask:0xc
    v_smfmac_f32_16x16x64_bf16 v[172:175], a[228:231], v[204:211], v37 abid:1
    v_mov_b32_dpp v142, v150 row_ror:8 row_mask:0xf bank_mask:0xc
    v_smfmac_f32_16x16x64_bf16 v[176:179], a[196:199], v[196:203], v34
    v_mov_b32_dpp v143, v151 row_ror:8 row_mask:0xf bank_mask:0xc
    v_smfmac_f32_16x16x64_bf16 v[176:179], a[232:235], v[204:211], v38
    s_waitcnt vmcnt(5)
    buffer_store_dwordx4 v[140:143], v6, s[12:15], s24 offen offset:128 sc1
    ds_read_b128 v[144:147], v9 offset:10560
    v_smfmac_f32_16x16x64_bf16 v[180:183], a[200:203], v[196:203], v34 abid:1
    ds_read_b128 v[148:151], v9 offset:10624
    ds_read_b128 v[140:143], v9 offset:10496
    v_add_u32 v4, s31, v4
    v_smfmac_f32_16x16x64_bf16 v[180:183], a[236:239], v[204:211], v38 abid:1
    v_add_u32 v1, s31, v1
    v_smfmac_f32_16x16x64_bf16 v[184:187], a[204:207], v[196:203], v35
    v_add_u32 v2, s31, v2
    v_smfmac_f32_16x16x64_bf16 v[184:187], a[240:243], v[204:211], v39
    v_smfmac_f32_16x16x64_bf16 v[188:191], a[208:211], v[196:203], v35 abid:1
    v_smfmac_f32_16x16x64_bf16 v[188:191], a[244:247], v[204:211], v39 abid:1
    v_smfmac_f32_16x16x64_bf16 v[192:195], a[212:215], v[196:203], v50 abid:1
    v_smfmac_f32_16x16x64_bf16 v[192:195], a[248:251], v[204:211], v51
    s_waitcnt vmcnt(8)
    s_branch M_top1
M_q:
    s_mov_b32 s21, 3
    v_smfmac_f32_16x16x64_bf16 v[144:147], v[72:75], v[220:227], v42 abid:1
    ds_read_b128 v[212:215], v1 offset:20480
    v_smfmac_f32_16x16x64_bf16 v[144:147], v[108:111], v[228:235], v46 abid:1
    ds_read_b128 v[216:219], v2 offset:20480
    v_smfmac_f32_16x16x64_bf16 v[148:151], v[76:79], v[220:227], v43
    v_smfmac_f32_16x16x64_bf16 v[148:151], v[112:115], v[228:235], v47
    v_smfmac_f32_16x16x64_bf16 v[152:155], v[80:83], v[220:227], v43 abid:1
    v_smfmac_f32_16x16x64_bf16 v[152:155], v[116:119], v[228:235], v47 abid:1
    s_waitcnt lgkmcnt(2)
    v_xad_u32 v236, v236, v3, v4
    v_smfmac_f32_16x16x64_bf16 v[152:155], v[240:243], v[244:251], v10
    v_xad_u32 v237, v237, v3, v4
    v_smfmac_f32_16x16x64_bf16 v[188:191], v[240:243], v[244:251], v10 abid:1
    s_cmp_gt_u32 s46, s80
    s_cbranch_scc1 M_slow
M_slowrQ:
    v_xad_u32 v238, v238, v3, v4
    v_smfmac_f32_16x16x64_bf16 v[128:131], v[56:59], v[220:227], v40 abid:1
    ds_read2st64_b32 v[244:245], v236 offset0:0 offset1:72
    ds_read_b128 v[240:243], v8 offset:5120
    v_xad_u32 v239, v239, v3, v4
    v_smfmac_f32_16x16x64_bf16 v[128:131], v[92:95], v[228:235], v44 abid:1
    ds_read2st64_b32 v[246:247], v237 offset0:0 offset1:72
    v_smfmac_f32_16x16x64_bf16 v[160:163], a[0:3], v[196:203], v12
    ds_read2st64_b32 v[248:249], v238 offset0:0 offset1:72
    v_smfmac_f32_16x16x64_bf16 v[160:163], a[36:39], v[204:211], v16
    ds_read2st64_b32 v[250:251], v239 offset0:0 offset1:72
    ds_read_b128 v[236:239], v9 offset:9600
    s_waitcnt lgkmcnt(6)
    v_smfmac_f32_16x16x64_bf16 v[160:163], a[72:75], v[212:219], v20
    v_smfmac_f32_16x16x64_bf16 v[164:167], a[4:7], v[196:203], v12 abid:1
    v_cvt_pk_bf16_f32 v156, v156, v157
    v_smfmac_f32_16x16x64_bf16 v[164:167], a[40:43], v[204:211], v16 abid:1
    v_cvt_pk_bf16_f32 v157, v158, v159
    v_smfmac_f32_16x16x64_bf16 v[164:167], a[76:79], v[212:219], v20 abid:1
    ds_write_b64 v53, v[156:157] offset:25728
    ds_read_b128 v[156:159], v9 offset:10752
    v_smfmac_f32_16x16x64_bf16 v[180:183], a[20:23], v[196:203], v14 abid:1
    v_smfmac_f32_16x16x64_bf16 v[180:183], a[56:59], v[204:211], v18 abid:1
    ds_read_b128 v[220:223], v1 offset:21504
    v_cvt_pk_bf16_f32 v124, v124, v125
    v_smfmac_f32_16x16x64_bf16 v[180:183], a[92:95], v[212:219], v22 abid:1
    s_waitcnt lgkmcnt(3)
    v_xad_u32 v236, v236, v3, v4
    v_smfmac_f32_16x16x64_bf16 v[180:183], v[240:243], v[244:251], v10 abid:1
    v_xad_u32 v237, v237, v3, v4
    v_smfmac_f32_16x16x64_bf16 v[144:147], v[240:243], v[244:251], v10
    ds_read2st64_b32 v[244:245], v236 offset0:0 offset1:72
    ds_read_b128 v[240:243], v8 offset:6144
    v_xad_u32 v238, v238, v3, v4
    v_smfmac_f32_16x16x64_bf16 v[172:175], a[12:15], v[196:203], v13 abid:1
    ds_read2st64_b32 v[246:247], v237 offset0:0 offset1:72
    v_xad_u32 v239, v239, v3, v4
    v_smfmac_f32_16x16x64_bf16 v[172:175], a[48:51], v[204:211], v17 abid:1
    ds_read2st64_b32 v[248:249], v238 offset0:0 offset1:72
    v_cvt_pk_bf16_f32 v125, v126, v127
    v_smfmac_f32_16x16x64_bf16 v[172:175], a[84:87], v[212:219], v21 abid:1
    ds_read2st64_b32 v[250:251], v239 offset0:0 offset1:72
    ds_read_b128 v[236:239], v9 offset:9472
    v_cvt_pk_bf16_f32 v126, v128, v129
    v_smfmac_f32_16x16x64_bf16 v[176:179], a[16:19], v[196:203], v14
    v_cvt_pk_bf16_f32 v127, v130, v131
    v_smfmac_f32_16x16x64_bf16 v[176:179], a[52:55], v[204:211], v18
    v_cvt_pk_bf16_f32 v132, v132, v133
    v_smfmac_f32_16x16x64_bf16 v[176:179], a[88:91], v[212:219], v22
    v_cvt_pk_bf16_f32 v133, v134, v135
    v_smfmac_f32_16x16x64_bf16 v[168:171], a[8:11], v[196:203], v13
    v_cvt_pk_bf16_f32 v134, v136, v137
    v_smfmac_f32_16x16x64_bf16 v[168:171], a[44:47], v[204:211], v17
    v_cvt_pk_bf16_f32 v135, v138, v139
    v_smfmac_f32_16x16x64_bf16 v[168:171], a[80:83], v[212:219], v21
    ds_read_b128 v[224:227], v2 offset:21504
    ds_read_b128 v[136:139], v9 offset:10432
    v_cndmask_b32_dpp v128, v124, v132, vcc row_ror:8 row_mask:0xf bank_mask:0xf
    v_smfmac_f32_16x16x64_bf16 v[184:187], a[24:27], v[196:203], v15
    ds_read_b128 v[228:231], v1 offset:22528
    v_cndmask_b32_dpp v129, v125, v133, vcc row_ror:8 row_mask:0xf bank_mask:0xf
    v_smfmac_f32_16x16x64_bf16 v[184:187], a[60:63], v[204:211], v19
    ds_read_b128 v[232:235], v2 offset:22528
    v_cndmask_b32_dpp v130, v126, v134, vcc row_ror:8 row_mask:0xf bank_mask:0xf
    v_smfmac_f32_16x16x64_bf16 v[184:187], a[96:99], v[212:219], v23
    s_waitcnt lgkmcnt(4)
    v_xad_u32 v236, v236, v3, v4
    v_smfmac_f32_16x16x64_bf16 v[184:187], v[240:243], v[244:251], v10 abid:1
    v_xad_u32 v237, v237, v3, v4
    v_smfmac_f32_16x16x64_bf16 v[148:151], v[240:243], v[244:251], v10
    ds_read2st64_b32 v[244:245], v236 offset0:0 offset1:72
    ds_read_b128 v[240:243], v8 offset:4096
    v_xad_u32 v238, v238, v3, v4
    v_smfmac_f32_16x16x64_bf16 v[188:191], a[28:31], v[196:203], v15 abid:1
    ds_read2st64_b32 v[246:247], v237 offset0:0 offset1:72
    v_xad_u32 v239, v239, v3, v4
    v_smfmac_f32_16x16x64_bf16 v[188:191], a[64:67], v[204:211], v19 abid:1
    ds_read2st64_b32 v[248:249], v238 offset0:0 offset1:72
    v_cndmask_b32_dpp v131, v127, v135, vcc row_ror:8 row_mask:0xf bank_mask:0xf
    v_smfmac_f32_16x16x64_bf16 v[188:191], a[100:103], v[212:219], v23 abid:1
    ds_read2st64_b32 v[250:251], v239 offset0:0 offset1:72
    buffer_store_dwordx4 v[128:131], v6, s[12:15], s59 offen offset:0 sc1
    v_smfmac_f32_16x16x64_bf16 v[192:195], a[32:35], v[196:203], v48
    v_mov_b32_dpp v124, v132 row_ror:8 row_mask:0xf bank_mask:0xc
    v_smfmac_f32_16x16x64_bf16 v[192:195], a[68:71], v[204:211], v48 abid:1
    v_mov_b32_dpp v125, v133 row_ror:8 row_mask:0xf bank_mask:0xc
    v_smfmac_f32_16x16x64_bf16 v[192:195], a[104:107], v[212:219], v49
    s_waitcnt lgkmcnt(8)
    v_mov_b32_dpp v126, v134 row_ror:8 row_mask:0xf bank_mask:0xc
    v_smfmac_f32_16x16x64_bf16 v[160:163], a[108:111], v[220:227], v24
    s_waitcnt lgkmcnt(5)
    v_mov_b32_dpp v127, v135 row_ror:8 row_mask:0xf bank_mask:0xc
    v_smfmac_f32_16x16x64_bf16 v[160:163], a[144:147], v[228:235], v28
    ds_read_b128 v[196:199], v1 offset:23552
    buffer_store_dwordx4 v[124:127], v6, s[12:15], s24 offen offset:0 sc1
    v_smfmac_f32_16x16x64_bf16 v[164:167], a[112:115], v[220:227], v24 abid:1
    ds_read_b128 v[200:203], v2 offset:23552
    ds_read_b128 v[128:131], v9 offset:10304
    ds_read_b128 v[132:135], v9 offset:10368
    v_smfmac_f32_16x16x64_bf16 v[164:167], a[148:151], v[228:235], v28 abid:1
    ds_read_b128 v[204:207], v1 offset:24576
    ds_read_b128 v[124:127], v9 offset:10240
    v_smfmac_f32_16x16x64_bf16 v[176:179], a[124:127], v[220:227], v26
    ds_read_b128 v[208:211], v2 offset:24576
    v_smfmac_f32_16x16x64_bf16 v[176:179], a[160:163], v[228:235], v30
    s_waitcnt lgkmcnt(7)
    v_smfmac_f32_16x16x64_bf16 v[176:179], v[240:243], v[244:251], v10 abid:1
    v_smfmac_f32_16x16x64_bf16 v[140:143], v[240:243], v[244:251], v10
    v_smfmac_f32_16x16x64_bf16 v[172:175], a[120:123], v[220:227], v25 abid:1
    s_add_u32 s28, s28, 36864
    s_cmp_ge_u32 s28, 110592
    s_cselect_b32 s28, s26, s28
    v_smfmac_f32_16x16x64_bf16 v[172:175], a[156:159], v[228:235], v29 abid:1
    s_add_u32 s30, s25, 36864
    s_cmp_eq_u32 s30, 110592
    s_cselect_b32 s30, 0, s30
    v_smfmac_f32_16x16x64_bf16 v[168:171], a[116:119], v[220:227], v25
    s_sub_u32 s31, s30, s25
    s_mov_b32 s25, s30
    s_mov_b32 s90, s22
    v_smfmac_f32_16x16x64_bf16 v[168:171], a[152:155], v[228:235], v29
    s_mov_b32 s22, s88
    s_add_u32 s91, s91, 1
    s_cmp_lt_u32 s20, 2
    v_smfmac_f32_16x16x64_bf16 v[180:183], a[128:131], v[220:227], v26 abid:1
    s_cselect_b32 s66, s23, s24
    s_add_u32 s66, s66, s95
    v_smfmac_f32_16x16x64_bf16 v[180:183], a[164:167], v[228:235], v30 abid:1
    v_cvt_pk_bf16_f32 v140, v140, v141
    v_smfmac_f32_16x16x64_bf16 v[184:187], a[132:135], v[220:227], v27
    v_cvt_pk_bf16_f32 v141, v142, v143
    v_smfmac_f32_16x16x64_bf16 v[184:187], a[168:171], v[228:235], v31
    v_cvt_pk_bf16_f32 v142, v144, v145
    v_smfmac_f32_16x16x64_bf16 v[188:191], a[136:139], v[220:227], v27 abid:1
    v_cvt_pk_bf16_f32 v143, v146, v147
    v_smfmac_f32_16x16x64_bf16 v[188:191], a[172:175], v[228:235], v31 abid:1
    v_cvt_pk_bf16_f32 v148, v148, v149
    v_smfmac_f32_16x16x64_bf16 v[192:195], a[140:143], v[220:227], v49 abid:1
    v_cvt_pk_bf16_f32 v149, v150, v151
    v_smfmac_f32_16x16x64_bf16 v[192:195], a[176:179], v[228:235], v50
    ds_read_b128 v[220:223], v1 offset:25600
    s_waitcnt lgkmcnt(6)
    v_cvt_pk_bf16_f32 v150, v152, v153
    v_smfmac_f32_16x16x64_bf16 v[160:163], a[180:183], v[196:203], v32
    ds_read_b128 v[224:227], v2 offset:25600
    s_waitcnt lgkmcnt(2)
    v_cvt_pk_bf16_f32 v151, v154, v155
    v_smfmac_f32_16x16x64_bf16 v[160:163], a[216:219], v[204:211], v36
    ds_read_b128 v[228:231], v1 offset:26624
    ds_read_b128 v[152:155], v9 offset:10688
    v_cndmask_b32_dpp v144, v140, v148, vcc row_ror:8 row_mask:0xf bank_mask:0xf
    v_smfmac_f32_16x16x64_bf16 v[164:167], a[184:187], v[196:203], v32 abid:1
    ds_read_b128 v[232:235], v2 offset:26624
    v_cndmask_b32_dpp v145, v141, v149, vcc row_ror:8 row_mask:0xf bank_mask:0xf
    v_smfmac_f32_16x16x64_bf16 v[164:167], a[220:223], v[204:211], v36 abid:1
    v_cndmask_b32_dpp v146, v142, v150, vcc row_ror:8 row_mask:0xf bank_mask:0xf
    v_smfmac_f32_16x16x64_bf16 v[168:171], a[188:191], v[196:203], v33
    v_cndmask_b32_dpp v147, v143, v151, vcc row_ror:8 row_mask:0xf bank_mask:0xf
    v_smfmac_f32_16x16x64_bf16 v[168:171], a[224:227], v[204:211], v37
    buffer_store_dwordx4 v[144:147], v6, s[12:15], s59 offen offset:128 sc1
    v_mov_b32_dpp v140, v148 row_ror:8 row_mask:0xf bank_mask:0xc
    v_smfmac_f32_16x16x64_bf16 v[172:175], a[192:195], v[196:203], v33 abid:1
    v_mov_b32_dpp v141, v149 row_ror:8 row_mask:0xf bank_mask:0xc
    v_smfmac_f32_16x16x64_bf16 v[172:175], a[228:231], v[204:211], v37 abid:1
    v_mov_b32_dpp v142, v150 row_ror:8 row_mask:0xf bank_mask:0xc
    v_smfmac_f32_16x16x64_bf16 v[176:179], a[196:199], v[196:203], v34
    v_mov_b32_dpp v143, v151 row_ror:8 row_mask:0xf bank_mask:0xc
    v_smfmac_f32_16x16x64_bf16 v[176:179], a[232:235], v[204:211], v38
    buffer_store_dwordx4 v[140:143], v6, s[12:15], s24 offen offset:128 sc1
    ds_read_b128 v[144:147], v9 offset:10560
    v_smfmac_f32_16x16x64_bf16 v[180:183], a[200:203], v[196:203], v34 abid:1
    ds_read_b128 v[148:151], v9 offset:10624
    ds_read_b128 v[140:143], v9 offset:10496
    v_add_u32 v4, s31, v4
    v_smfmac_f32_16x16x64_bf16 v[180:183], a[236:239], v[204:211], v38 abid:1
    v_add_u32 v1, s31, v1
    v_smfmac_f32_16x16x64_bf16 v[184:187], a[204:207], v[196:203], v35
    v_add_u32 v2, s31, v2
    v_smfmac_f32_16x16x64_bf16 v[184:187], a[240:243], v[204:211], v39
    v_smfmac_f32_16x16x64_bf16 v[188:191], a[208:211], v[196:203], v35 abid:1
    v_smfmac_f32_16x16x64_bf16 v[188:191], a[244:247], v[204:211], v39 abid:1
    v_smfmac_f32_16x16x64_bf16 v[192:195], a[212:215], v[196:203], v50 abid:1
    v_smfmac_f32_16x16x64_bf16 v[192:195], a[248:251], v[204:211], v51
    s_waitcnt vmcnt(4)
    s_branch M_top1
M_bF:
    v_smfmac_f32_16x16x64_bf16 v[164:167], v[56:59], v[220:227], v40 abid:1
    ds_read_b128 v[204:207], v1 offset:1024
    v_smfmac_f32_16x16x64_bf16 v[164:167], v[92:95], v[228:235], v44 abid:1
    ds_read_b128 v[208:211], v2 offset:1024
    v_smfmac_f32_16x16x64_bf16 v[168:171], v[60:63], v[220:227], v41
    ds_read_b128 v[212:215], v1 offset:2048
    v_smfmac_f32_16x16x64_bf16 v[168:171], v[96:99], v[228:235], v45
    ds_read_b128 v[216:219], v2 offset:2048
    v_smfmac_f32_16x16x64_bf16 v[172:175], v[64:67], v[220:227], v41 abid:1
    s_waitcnt lgkmcnt(6)
    buffer_store_dwordx4 v[244:247], v7, s[12:15], s66 offen sc1
    v_smfmac_f32_16x16x64_bf16 v[172:175], v[100:103], v[228:235], v45 abid:1
    ds_read_b128 v[236:239], v9 offset:9408
    v_smfmac_f32_16x16x64_bf16 v[176:179], v[68:71], v[220:227], v42
    s_mov_b32 s21, 4
    v_smfmac_f32_16x16x64_bf16 v[176:179], v[104:107], v[228:235], v46
    v_smfmac_f32_16x16x64_bf16 v[180:183], v[72:75], v[220:227], v42 abid:1
    v_cvt_pk_bf16_f32 v160, v160, v161
    v_smfmac_f32_16x16x64_bf16 v[180:183], v[108:111], v[228:235], v46 abid:1
    v_cvt_pk_bf16_f32 v161, v162, v163
    v_smfmac_f32_16x16x64_bf16 v[184:187], v[76:79], v[220:227], v43
    v_cvt_pk_bf16_f32 v162, v164, v165
    v_smfmac_f32_16x16x64_bf16 v[184:187], v[112:115], v[228:235], v47
    v_cvt_pk_bf16_f32 v163, v166, v167
    v_smfmac_f32_16x16x64_bf16 v[188:191], v[80:83], v[220:227], v43 abid:1
    v_cvt_pk_bf16_f32 v168, v168, v169
    v_smfmac_f32_16x16x64_bf16 v[188:191], v[116:119], v[228:235], v47 abid:1
    v_cvt_pk_bf16_f32 v169, v170, v171
    v_smfmac_f32_16x16x64_bf16 v[192:195], v[84:87], v[220:227], v51 abid:1
    v_cvt_pk_bf16_f32 v170, v172, v173
    v_smfmac_f32_16x16x64_bf16 v[192:195], v[120:123], v[228:235], v52
    ds_read_b128 v[220:223], v1 offset:3072
    s_waitcnt lgkmcnt(6)
    v_cvt_pk_bf16_f32 v171, v174, v175
    v_smfmac_f32_16x16x64_bf16 v[124:127], a[0:3], v[196:203], v12
    ds_read_b128 v[224:227], v2 offset:3072
    ds_read_b128 v[172:175], v9 offset:10432
    s_waitcnt lgkmcnt(6)
    v_cndmask_b32_dpp v164, v160, v168, vcc row_ror:8 row_mask:0xf bank_mask:0xf
    v_smfmac_f32_16x16x64_bf16 v[124:127], a[36:39], v[204:211], v16
    ds_read_b128 v[228:231], v1 offset:4096
    s_waitcnt lgkmcnt(5)
    v_cndmask_b32_dpp v165, v161, v169, vcc row_ror:8 row_mask:0xf bank_mask:0xf
    v_smfmac_f32_16x16x64_bf16 v[124:127], a[72:75], v[212:219], v20
    ds_read_b128 v[232:235], v2 offset:4096
    s_waitcnt lgkmcnt(5)
    v_xad_u32 v236, v236, v3, v4
    v_smfmac_f32_16x16x64_bf16 v[156:159], a[32:35], v[196:203], v48
    s_barrier
    v_xad_u32 v237, v237, v3, v4
    v_smfmac_f32_16x16x64_bf16 v[156:159], a[68:71], v[204:211], v48 abid:1
    ds_read2st64_b32 v[244:245], v236 offset0:0 offset1:72
    ds_read_b128 v[240:243], v8 offset:3072
    v_xad_u32 v238, v238, v3, v4
    v_smfmac_f32_16x16x64_bf16 v[156:159], a[104:107], v[212:219], v49
    ds_read2st64_b32 v[246:247], v237 offset0:0 offset1:72
    v_xad_u32 v239, v239, v3, v4
    v_smfmac_f32_16x16x64_bf16 v[132:135], a[8:11], v[196:203], v13
    ds_read2st64_b32 v[248:249], v238 offset0:0 offset1:72
    v_cndmask_b32_dpp v166, v162, v170, vcc row_ror:8 row_mask:0xf bank_mask:0xf
    v_smfmac_f32_16x16x64_bf16 v[132:135], a[44:47], v[204:211], v17
    ds_read2st64_b32 v[250:251], v239 offset0:0 offset1:72
    ds_read_b128 v[236:239], v9 offset:9280
    v_cndmask_b32_dpp v167, v163, v171, vcc row_ror:8 row_mask:0xf bank_mask:0xf
    v_smfmac_f32_16x16x64_bf16 v[132:135], a[80:83], v[212:219], v21
    buffer_store_dwordx4 v[164:167], v6, s[12:15], s58 offen offset:0 sc1
    v_mov_b32_dpp v160, v168 row_ror:8 row_mask:0xf bank_mask:0xc
    v_smfmac_f32_16x16x64_bf16 v[140:143], a[16:19], v[196:203], v14
    v_mov_b32_dpp v161, v169 row_ror:8 row_mask:0xf bank_mask:0xc
    v_smfmac_f32_16x16x64_bf16 v[140:143], a[52:55], v[204:211], v18
    v_mov_b32_dpp v162, v170 row_ror:8 row_mask:0xf bank_mask:0xc
    v_smfmac_f32_16x16x64_bf16 v[140:143], a[88:91], v[212:219], v22
    v_mov_b32_dpp v163, v171 row_ror:8 row_mask:0xf bank_mask:0xc
    v_smfmac_f32_16x16x64_bf16 v[136:139], a[12:15], v[196:203], v13 abid:1
    buffer_store_dwordx4 v[160:163], v6, s[12:15], s23 offen offset:0 sc1
    ds_read_b128 v[164:167], v9 offset:10304
    ds_read_b128 v[168:171], v9 offset:10368
    v_smfmac_f32_16x16x64_bf16 v[136:139], a[48:51], v[204:211], v17 abid:1
    ds_read_b128 v[160:163], v9 offset:10240
    v_smfmac_f32_16x16x64_bf16 v[136:139], a[84:87], v[212:219], v21 abid:1
    s_waitcnt lgkmcnt(3)
    v_xad_u32 v236, v236, v3, v4
    v_smfmac_f32_16x16x64_bf16 v[136:139], v[240:243], v[244:251], v10
    v_xad_u32 v237, v237, v3, v4
    v_smfmac_f32_16x16x64_bf16 v[172:175], v[240:243], v[244:251], v10 abid:1
    ds_read2st64_b32 v[244:245], v236 offset0:0 offset1:72
    ds_read_b128 v[240:243], v8 offset:1024
    v_xad_u32 v238, v238, v3, v4
    v_smfmac_f32_16x16x64_bf16 v[144:147], a[20:23], v[196:203], v14 abid:1
    ds_read2st64_b32 v[246:247], v237 offset0:0 offset1:72
    v_xad_u32 v239, v239, v3, v4
    v_smfmac_f32_16x16x64_bf16 v[144:147], a[56:59], v[204:211], v18 abid:1
    ds_read2st64_b32 v[248:249], v238 offset0:0 offset1:72
    v_smfmac_f32_16x16x64_bf16 v[144:147], a[92:95], v[212:219], v22 abid:1
    ds_read2st64_b32 v[250:251], v239 offset0:0 offset1:72
    ds_read_b128 v[236:239], v9 offset:9344
    v_smfmac_f32_16x16x64_bf16 v[148:151], a[24:27], v[196:203], v15
    v_cvt_pk_bf16_f32 v192, v192, v193
    v_smfmac_f32_16x16x64_bf16 v[148:151], a[60:63], v[204:211], v19
    v_cvt_pk_bf16_f32 v193, v194, v195
    v_smfmac_f32_16x16x64_bf16 v[148:151], a[96:99], v[212:219], v23
    ds_write_b64 v53, v[192:193] offset:0
    ds_read_b128 v[192:195], v9 offset:10752
    v_smfmac_f32_16x16x64_bf16 v[152:155], a[28:31], v[196:203], v15 abid:1
    v_smfmac_f32_16x16x64_bf16 v[152:155], a[64:67], v[204:211], v19 abid:1
    v_smfmac_f32_16x16x64_bf16 v[152:155], a[100:103], v[212:219], v23 abid:1
    v_smfmac_f32_16x16x64_bf16 v[128:131], a[4:7], v[196:203], v12 abid:1
    v_smfmac_f32_16x16x64_bf16 v[128:131], a[40:43], v[204:211], v16 abid:1
    v_smfmac_f32_16x16x64_bf16 v[128:131], a[76:79], v[212:219], v20 abid:1
    s_waitcnt lgkmcnt(2)
    v_xad_u32 v236, v236, v3, v4
    v_smfmac_f32_16x16x64_bf16 v[128:131], v[240:243], v[244:251], v10
    v_xad_u32 v237, v237, v3, v4
    v_smfmac_f32_16x16x64_bf16 v[164:167], v[240:243], v[244:251], v10 abid:1
    ds_read2st64_b32 v[244:245], v236 offset0:0 offset1:72
    ds_read_b128 v[240:243], v8 offset:2048
    v_xad_u32 v238, v238, v3, v4
    v_smfmac_f32_16x16x64_bf16 v[124:127], a[108:111], v[220:227], v24
    ds_read2st64_b32 v[246:247], v237 offset0:0 offset1:72
    v_xad_u32 v239, v239, v3, v4
    v_smfmac_f32_16x16x64_bf16 v[124:127], a[144:147], v[228:235], v28
    ds_read2st64_b32 v[248:249], v238 offset0:0 offset1:72
    ds_read_b64 v[216:217], v9 offset:10056
    v_cvt_pk_bf16_f32 v176, v176, v177
    v_smfmac_f32_16x16x64_bf16 v[128:131], a[112:115], v[220:227], v24 abid:1
    ds_read2st64_b32 v[250:251], v239 offset0:0 offset1:72
    ds_read_b128 v[236:239], v9 offset:9216
    v_cvt_pk_bf16_f32 v177, v178, v179
    v_smfmac_f32_16x16x64_bf16 v[128:131], a[148:151], v[228:235], v28 abid:1
    v_cvt_pk_bf16_f32 v178, v180, v181
    v_smfmac_f32_16x16x64_bf16 v[140:143], a[124:127], v[220:227], v26
    v_cvt_pk_bf16_f32 v179, v182, v183
    v_smfmac_f32_16x16x64_bf16 v[140:143], a[160:163], v[228:235], v30
    v_cvt_pk_bf16_f32 v184, v184, v185
    v_smfmac_f32_16x16x64_bf16 v[136:139], a[120:123], v[220:227], v25 abid:1
    v_cvt_pk_bf16_f32 v185, v186, v187
    v_smfmac_f32_16x16x64_bf16 v[136:139], a[156:159], v[228:235], v29 abid:1
    ds_read_b128 v[196:199], v1 offset:5120
    v_cvt_pk_bf16_f32 v186, v188, v189
    v_smfmac_f32_16x16x64_bf16 v[132:135], a[116:119], v[220:227], v25
    ds_read_b128 v[200:203], v2 offset:5120
    v_cvt_pk_bf16_f32 v187, v190, v191
    v_smfmac_f32_16x16x64_bf16 v[132:135], a[152:155], v[228:235], v29
    ds_read_b128 v[188:191], v9 offset:10688
    s_waitcnt lgkmcnt(3)
    v_xad_u32 v236, v236, v3, v4
    v_smfmac_f32_16x16x64_bf16 v[132:135], v[240:243], v[244:251], v10
    ds_read_b128 v[204:207], v1 offset:6144
    v_xad_u32 v237, v237, v3, v4
    v_smfmac_f32_16x16x64_bf16 v[168:171], v[240:243], v[244:251], v10 abid:1
    ds_read2st64_b32 v[244:245], v236 offset0:0 offset1:72
    ds_read_b128 v[240:243], v8 offset:0
    v_xad_u32 v238, v238, v3, v4
    v_smfmac_f32_16x16x64_bf16 v[144:147], a[128:131], v[220:227], v26 abid:1
    ds_read2st64_b32 v[246:247], v237 offset0:0 offset1:72
    v_xad_u32 v239, v239, v3, v4
    v_smfmac_f32_16x16x64_bf16 v[144:147], a[164:167], v[228:235], v30 abid:1
    ds_read2st64_b32 v[248:249], v238 offset0:0 offset1:72
    ds_read_b128 v[208:211], v2 offset:6144
    v_cndmask_b32_dpp v180, v176, v184, vcc row_ror:8 row_mask:0xf bank_mask:0xf
    v_smfmac_f32_16x16x64_bf16 v[148:151], a[132:135], v[220:227], v27
    ds_read2st64_b32 v[250:251], v239 offset0:0 offset1:72
    ds_read_b128 v[236:239], v9 offset:9728
    v_cndmask_b32_dpp v181, v177, v185, vcc row_ror:8 row_mask:0xf bank_mask:0xf
    v_smfmac_f32_16x16x64_bf16 v[148:151], a[168:171], v[228:235], v31
    v_xad_u32 v212, v216, v3, v4
    v_smfmac_f32_16x16x64_bf16 v[152:155], a[136:139], v[220:227], v27 abid:1
    ds_read2st64_b32 v[212:213], v212 offset0:0 offset1:72
    v_xad_u32 v214, v217, v3, v4
    v_smfmac_f32_16x16x64_bf16 v[152:155], a[172:175], v[228:235], v31 abid:1
    ds_read2st64_b32 v[214:215], v214 offset0:0 offset1:72
    v_cndmask_b32_dpp v182, v178, v186, vcc row_ror:8 row_mask:0xf bank_mask:0xf
    v_smfmac_f32_16x16x64_bf16 v[156:159], a[140:143], v[220:227], v49 abid:1
    v_cndmask_b32_dpp v183, v179, v187, vcc row_ror:8 row_mask:0xf bank_mask:0xf
    v_smfmac_f32_16x16x64_bf16 v[156:159], a[176:179], v[228:235], v50
    buffer_store_dwordx4 v[180:183], v6, s[12:15], s58 offen offset:128 sc1
    s_waitcnt lgkmcnt(11)
    v_mov_b32_dpp v176, v184 row_ror:8 row_mask:0xf bank_mask:0xc
    v_smfmac_f32_16x16x64_bf16 v[128:131], a[184:187], v[196:203], v32 abid:1
    s_waitcnt lgkmcnt(4)
    v_mov_b32_dpp v177, v185 row_ror:8 row_mask:0xf bank_mask:0xc
    v_smfmac_f32_16x16x64_bf16 v[128:131], a[220:223], v[204:211], v36 abid:1
    v_mov_b32_dpp v178, v186 row_ror:8 row_mask:0xf bank_mask:0xc
    v_smfmac_f32_16x16x64_bf16 v[124:127], a[180:183], v[196:203], v32
    ds_read_b128 v[220:223], v1 offset:7168
    v_mov_b32_dpp v179, v187 row_ror:8 row_mask:0xf bank_mask:0xc
    v_smfmac_f32_16x16x64_bf16 v[124:127], a[216:219], v[204:211], v36
    buffer_store_dwordx4 v[176:179], v6, s[12:15], s23 offen offset:128 sc1
    s_waitcnt lgkmcnt(3)
    v_xad_u32 v236, v236, v3, v4
    v_smfmac_f32_16x16x64_bf16 v[124:127], v[240:243], v[244:251], v10
    ds_read_b128 v[224:227], v2 offset:7168
    ds_read_b128 v[180:183], v9 offset:10560
    v_xad_u32 v237, v237, v3, v4
    v_smfmac_f32_16x16x64_bf16 v[160:163], v[240:243], v[244:251], v10 abid:1
    ds_read2st64_b32 v[244:245], v236 offset0:0 offset1:72
    ds_read_b128 v[240:243], v8 offset:8192
    v_xad_u32 v238, v238, v3, v4
    v_smfmac_f32_16x16x64_bf16 v[132:135], a[188:191], v[196:203], v33
    ds_read2st64_b32 v[246:247], v237 offset0:0 offset1:72
    ds_read_b128 v[184:187], v9 offset:10624
    v_xad_u32 v239, v239, v3, v4
    v_smfmac_f32_16x16x64_bf16 v[132:135], a[224:227], v[204:211], v37
    ds_read2st64_b32 v[248:249], v238 offset0:0 offset1:72
    ds_read_b128 v[176:179], v9 offset:10496
    v_smfmac_f32_16x16x64_bf16 v[136:139], a[192:195], v[196:203], v33 abid:1
    ds_read2st64_b32 v[250:251], v239 offset0:0 offset1:72
    ds_read_b128 v[236:239], v9 offset:9664
    v_smfmac_f32_16x16x64_bf16 v[136:139], a[228:231], v[204:211], v37 abid:1
    v_smfmac_f32_16x16x64_bf16 v[140:143], a[196:199], v[196:203], v34
    v_smfmac_f32_16x16x64_bf16 v[140:143], a[232:235], v[204:211], v38
    ds_read_b128 v[228:231], v1 offset:8192
    v_smfmac_f32_16x16x64_bf16 v[144:147], a[200:203], v[196:203], v34 abid:1
    ds_read_b128 v[232:235], v2 offset:8192
    v_smfmac_f32_16x16x64_bf16 v[144:147], a[236:239], v[204:211], v38 abid:1
    s_waitcnt lgkmcnt(4)
    s_cmp_lt_i32 s81, 0
    s_cbranch_scc1 M_ovrF
    s_swappc_b64 s[78:79], s[72:73]
M_ovrF:
    v_smfmac_f32_16x16x64_bf16 v[156:159], a[212:215], v[196:203], v50 abid:1
    v_smfmac_f32_16x16x64_bf16 v[156:159], a[248:251], v[204:211], v51
    s_waitcnt lgkmcnt(2)
    v_xad_u32 v236, v236, v3, v4
    v_smfmac_f32_16x16x64_bf16 v[156:159], v[240:243], v[244:251], v10
    v_xad_u32 v237, v237, v3, v4
    v_smfmac_f32_16x16x64_bf16 v[192:195], v[240:243], v[244:251], v10 abid:1
    ds_read2st64_b32 v[244:245], v236 offset0:0 offset1:72
    ds_read_b128 v[240:243], v8 offset:7168
    v_xad_u32 v238, v238, v3, v4
    v_smfmac_f32_16x16x64_bf16 v[152:155], a[208:211], v[196:203], v35 abid:1
    ds_read2st64_b32 v[246:247], v237 offset0:0 offset1:72
    v_xad_u32 v239, v239, v3, v4
    v_smfmac_f32_16x16x64_bf16 v[152:155], a[244:247], v[204:211], v39 abid:1
    ds_read2st64_b32 v[248:249], v238 offset0:0 offset1:72
    v_smfmac_f32_16x16x64_bf16 v[148:151], a[204:207], v[196:203], v35
    ds_read2st64_b32 v[250:251], v239 offset0:0 offset1:72
    ds_read_b128 v[236:239], v9 offset:9536
    v_smfmac_f32_16x16x64_bf16 v[148:151], a[240:243], v[204:211], v39
    v_smfmac_f32_16x16x64_bf16 v[124:127], a[252:255], v[220:227], v40
    s_waitcnt lgkmcnt(6)
    v_smfmac_f32_16x16x64_bf16 v[124:127], v[88:91], v[228:235], v44
    v_smfmac_f32_16x16x64_bf16 v[128:131], v[56:59], v[220:227], v40 abid:1
    v_smfmac_f32_16x16x64_bf16 v[128:131], v[92:95], v[228:235], v44 abid:1
    s_cmp_lt_u32 s20, 2
    s_cselect_b32 s66, s23, s24
    s_add_u32 s66, s66, s95
    v_smfmac_f32_16x16x64_bf16 v[132:135], v[60:63], v[220:227], v41
    ds_read_b128 v[196:199], v1 offset:18432
    s_add_u32 s23, s24, 18432
    s_add_u32 s58, s24, 27648
    v_smfmac_f32_16x16x64_bf16 v[132:135], v[96:99], v[228:235], v45
    ds_read_b128 v[200:203], v2 offset:18432
    s_add_u32 s67, s23, s95
    v_smfmac_f32_16x16x64_bf16 v[152:155], v[80:83], v[220:227], v43 abid:1
    ds_read_b128 v[204:207], v1 offset:19456
    v_smfmac_f32_16x16x64_bf16 v[152:155], v[116:119], v[228:235], v47 abid:1
    s_waitcnt lgkmcnt(3)
    v_xad_u32 v236, v236, v3, v4
    v_smfmac_f32_16x16x64_bf16 v[152:155], v[240:243], v[244:251], v10
    ds_read_b128 v[208:211], v2 offset:19456
    v_xad_u32 v237, v237, v3, v4
    v_smfmac_f32_16x16x64_bf16 v[188:191], v[240:243], v[244:251], v10 abid:1
    s_cmp_gt_u32 s46, s80
    s_cbranch_scc1 M_slow
M_slowrF:
    v_xad_u32 v238, v238, v3, v4
    v_smfmac_f32_16x16x64_bf16 v[140:143], v[68:71], v[220:227], v42
    ds_read2st64_b32 v[244:245], v236 offset0:0 offset1:72
    ds_read_b128 v[240:243], v8 offset:5120
    v_xad_u32 v239, v239, v3, v4
    v_smfmac_f32_16x16x64_bf16 v[140:143], v[104:107], v[228:235], v46
    ds_read2st64_b32 v[246:247], v237 offset0:0 offset1:72
    v_smfmac_f32_16x16x64_bf16 v[156:159], v[84:87], v[220:227], v51 abid:1
    ds_read2st64_b32 v[248:249], v238 offset0:0 offset1:72
    ds_read_b128 v[212:215], v1 offset:20480
    v_smfmac_f32_16x16x64_bf16 v[156:159], v[120:123], v[228:235], v52
    ds_read2st64_b32 v[250:251], v239 offset0:0 offset1:72
    ds_read_b128 v[236:239], v9 offset:9600
    v_smfmac_f32_16x16x64_bf16 v[148:151], v[76:79], v[220:227], v43
    ds_read_b128 v[216:219], v2 offset:20480
    v_smfmac_f32_16x16x64_bf16 v[148:151], v[112:115], v[228:235], v47
    v_smfmac_f32_16x16x64_bf16 v[136:139], v[64:67], v[220:227], v41 abid:1
    v_smfmac_f32_16x16x64_bf16 v[136:139], v[100:103], v[228:235], v45 abid:1
    v_smfmac_f32_16x16x64_bf16 v[144:147], v[72:75], v[220:227], v42 abid:1
    v_smfmac_f32_16x16x64_bf16 v[144:147], v[108:111], v[228:235], v46 abid:1
    ds_read_b128 v[220:223], v1 offset:21504
    s_waitcnt lgkmcnt(2)
    v_xad_u32 v236, v236, v3, v4
    v_smfmac_f32_16x16x64_bf16 v[144:147], v[240:243], v[244:251], v10
    ds_read_b128 v[224:227], v2 offset:21504
    v_xad_u32 v237, v237, v3, v4
    v_smfmac_f32_16x16x64_bf16 v[180:183], v[240:243], v[244:251], v10 abid:1
    ds_read2st64_b32 v[244:245], v236 offset0:0 offset1:72
    ds_read_b128 v[240:243], v8 offset:6144
    v_xad_u32 v238, v238, v3, v4
    v_smfmac_f32_16x16x64_bf16 v[192:195], a[32:35], v[196:203], v48
    ds_read2st64_b32 v[246:247], v237 offset0:0 offset1:72
    ds_read_b128 v[228:231], v1 offset:22528
    v_xad_u32 v239, v239, v3, v4
    v_smfmac_f32_16x16x64_bf16 v[192:195], a[68:71], v[204:211], v48 abid:1
    ds_read2st64_b32 v[248:249], v238 offset0:0 offset1:72
    ds_read_b128 v[232:235], v2 offset:22528
    s_waitcnt lgkmcnt(8)
    v_cvt_pk_bf16_f32 v124, v124, v125
    v_smfmac_f32_16x16x64_bf16 v[192:195], a[104:107], v[212:219], v49
    ds_read2st64_b32 v[250:251], v239 offset0:0 offset1:72
    ds_read_b128 v[236:239], v9 offset:9472
    v_cvt_pk_bf16_f32 v125, v126, v127
    v_smfmac_f32_16x16x64_bf16 v[160:163], a[0:3], v[196:203], v12
    v_cvt_pk_bf16_f32 v126, v128, v129
    v_smfmac_f32_16x16x64_bf16 v[160:163], a[36:39], v[204:211], v16
    v_cvt_pk_bf16_f32 v127, v130, v131
    v_smfmac_f32_16x16x64_bf16 v[160:163], a[72:75], v[212:219], v20
    v_cvt_pk_bf16_f32 v156, v156, v157
    v_smfmac_f32_16x16x64_bf16 v[164:167], a[4:7], v[196:203], v12 abid:1
    v_cvt_pk_bf16_f32 v157, v158, v159
    v_smfmac_f32_16x16x64_bf16 v[164:167], a[40:43], v[204:211], v16 abid:1
    ds_write_b64 v53, v[156:157] offset:25728
    v_cvt_pk_bf16_f32 v132, v132, v133
    v_smfmac_f32_16x16x64_bf16 v[164:167], a[76:79], v[212:219], v20 abid:1
    v_cvt_pk_bf16_f32 v133, v134, v135
    v_smfmac_f32_16x16x64_bf16 v[168:171], a[8:11], v[196:203], v13
    v_cvt_pk_bf16_f32 v134, v136, v137
    v_smfmac_f32_16x16x64_bf16 v[168:171], a[44:47], v[204:211], v17
    v_cvt_pk_bf16_f32 v135, v138, v139
    v_smfmac_f32_16x16x64_bf16 v[168:171], a[80:83], v[212:219], v21
    s_waitcnt lgkmcnt(1)
    v_xad_u32 v236, v236, v3, v4
    v_smfmac_f32_16x16x64_bf16 v[184:187], v[240:243], v[244:251], v10 abid:1
    v_xad_u32 v237, v237, v3, v4
    v_smfmac_f32_16x16x64_bf16 v[148:151], v[240:243], v[244:251], v10
    ds_read2st64_b32 v[244:245], v236 offset0:0 offset1:72
    ds_read_b128 v[240:243], v8 offset:4096
    v_xad_u32 v238, v238, v3, v4
    v_smfmac_f32_16x16x64_bf16 v[172:175], a[12:15], v[196:203], v13 abid:1
    ds_read2st64_b32 v[246:247], v237 offset0:0 offset1:72
    v_xad_u32 v239, v239, v3, v4
    v_smfmac_f32_16x16x64_bf16 v[172:175], a[48:51], v[204:211], v17 abid:1
    ds_read2st64_b32 v[248:249], v238 offset0:0 offset1:72
    v_cndmask_b32_dpp v128, v124, v132, vcc row_ror:8 row_mask:0xf bank_mask:0xf
    v_smfmac_f32_16x16x64_bf16 v[172:175], a[84:87], v[212:219], v21 abid:1
    ds_read2st64_b32 v[250:251], v239 offset0:0 offset1:72
    ds_read_b128 v[196:199], v1 offset:23552
    v_cndmask_b32_dpp v129, v125, v133, vcc row_ror:8 row_mask:0xf bank_mask:0xf
    v_smfmac_f32_16x16x64_bf16 v[192:195], a[140:143], v[220:227], v49 abid:1
    ds_read_b128 v[200:203], v2 offset:23552
    v_cndmask_b32_dpp v130, v126, v134, vcc row_ror:8 row_mask:0xf bank_mask:0xf
    v_smfmac_f32_16x16x64_bf16 v[192:195], a[176:179], v[228:235], v50
    ds_read_b128 v[204:207], v1 offset:24576
    v_cndmask_b32_dpp v131, v127, v135, vcc row_ror:8 row_mask:0xf bank_mask:0xf
    v_smfmac_f32_16x16x64_bf16 v[160:163], a[108:111], v[220:227], v24
    ds_read_b128 v[208:211], v2 offset:24576
    buffer_store_dwordx4 v[128:131], v6, s[12:15], s59 offen offset:0 sc1
    v_mov_b32_dpp v124, v132 row_ror:8 row_mask:0xf bank_mask:0xc
    v_smfmac_f32_16x16x64_bf16 v[160:163], a[144:147], v[228:235], v28
    s_waitcnt lgkmcnt(9)
    s_barrier
    ds_read_b128 v[236:239], v8 offset:10816
    v_mov_b32_dpp v125, v133 row_ror:8 row_mask:0xf bank_mask:0xc
    v_smfmac_f32_16x16x64_bf16 v[164:167], a[112:115], v[220:227], v24 abid:1
    ds_read_b128 v[212:215], v1 offset:20480
    v_mov_b32_dpp v126, v134 row_ror:8 row_mask:0xf bank_mask:0xc
    v_smfmac_f32_16x16x64_bf16 v[164:167], a[148:151], v[228:235], v28 abid:1
    ds_read_b128 v[216:219], v2 offset:20480
    v_mov_b32_dpp v127, v135 row_ror:8 row_mask:0xf bank_mask:0xc
    v_smfmac_f32_16x16x64_bf16 v[168:171], a[116:119], v[220:227], v25
    buffer_store_dwordx4 v[124:127], v6, s[12:15], s24 offen offset:0 sc1
    v_smfmac_f32_16x16x64_bf16 v[168:171], a[152:155], v[228:235], v29
    s_waitcnt lgkmcnt(7)
    v_smfmac_f32_16x16x64_bf16 v[176:179], v[240:243], v[244:251], v10 abid:1
    v_smfmac_f32_16x16x64_bf16 v[140:143], v[240:243], v[244:251], v10
    s_waitcnt lgkmcnt(2)
    buffer_store_dwordx4 v[236:239], v7, s[12:15], s66 offen sc1
    v_smfmac_f32_16x16x64_bf16 v[172:175], a[120:123], v[220:227], v25 abid:1
    v_smfmac_f32_16x16x64_bf16 v[172:175], a[156:159], v[228:235], v29 abid:1
    ds_read_b128 v[220:223], v1 offset:25600
    v_smfmac_f32_16x16x64_bf16 v[192:195], a[212:215], v[196:203], v50 abid:1
    ds_read_b128 v[224:227], v2 offset:25600
    s_nop 0
    v_cvt_pk_bf16_f32 v140, v140, v141
    v_smfmac_f32_16x16x64_bf16 v[192:195], a[248:251], v[204:211], v51
    ds_read_b128 v[228:231], v1 offset:26624
    v_cvt_pk_bf16_f32 v141, v142, v143
    v_smfmac_f32_16x16x64_bf16 v[160:163], a[180:183], v[196:203], v32
    ds_read_b128 v[232:235], v2 offset:26624
    v_cvt_pk_bf16_f32 v142, v144, v145
    v_smfmac_f32_16x16x64_bf16 v[160:163], a[216:219], v[204:211], v36
    v_cvt_pk_bf16_f32 v143, v146, v147
    v_smfmac_f32_16x16x64_bf16 v[164:167], a[184:187], v[196:203], v32 abid:1
    v_cvt_pk_bf16_f32 v148, v148, v149
    v_smfmac_f32_16x16x64_bf16 v[164:167], a[220:223], v[204:211], v36 abid:1
    v_cvt_pk_bf16_f32 v149, v150, v151
    v_smfmac_f32_16x16x64_bf16 v[168:171], a[188:191], v[196:203], v33
    v_cvt_pk_bf16_f32 v150, v152, v153
    v_smfmac_f32_16x16x64_bf16 v[168:171], a[224:227], v[204:211], v37
    v_cvt_pk_bf16_f32 v151, v154, v155
    v_smfmac_f32_16x16x64_bf16 v[172:175], a[192:195], v[196:203], v33 abid:1
    v_cndmask_b32_dpp v144, v140, v148, vcc row_ror:8 row_mask:0xf bank_mask:0xf
    v_smfmac_f32_16x16x64_bf16 v[172:175], a[228:231], v[204:211], v37 abid:1
    ds_read_b128 v[196:199], v1 offset:18432
    s_waitcnt lgkmcnt(3)
    v_cndmask_b32_dpp v145, v141, v149, vcc row_ror:8 row_mask:0xf bank_mask:0xf
    v_smfmac_f32_16x16x64_bf16 v[192:195], v[84:87], v[220:227], v51 abid:1
    ds_read_b128 v[200:203], v2 offset:18432
    s_waitcnt lgkmcnt(2)
    v_cndmask_b32_dpp v146, v142, v150, vcc row_ror:8 row_mask:0xf bank_mask:0xf
    v_smfmac_f32_16x16x64_bf16 v[192:195], v[120:123], v[228:235], v52
    ds_read_b128 v[204:207], v1 offset:19456
    v_cndmask_b32_dpp v147, v143, v151, vcc row_ror:8 row_mask:0xf bank_mask:0xf
    v_smfmac_f32_16x16x64_bf16 v[160:163], a[252:255], v[220:227], v40
    ds_read_b128 v[208:211], v2 offset:19456
    buffer_store_dwordx4 v[144:147], v6, s[12:15], s59 offen offset:128 sc1
    v_mov_b32_dpp v140, v148 row_ror:8 row_mask:0xf bank_mask:0xc
    v_smfmac_f32_16x16x64_bf16 v[160:163], v[88:91], v[228:235], v44
    v_mov_b32_dpp v141, v149 row_ror:8 row_mask:0xf bank_mask:0xc
    v_smfmac_f32_16x16x64_bf16 v[164:167], v[56:59], v[220:227], v40 abid:1
    v_mov_b32_dpp v142, v150 row_ror:8 row_mask:0xf bank_mask:0xc
    v_smfmac_f32_16x16x64_bf16 v[164:167], v[92:95], v[228:235], v44 abid:1
    v_mov_b32_dpp v143, v151 row_ror:8 row_mask:0xf bank_mask:0xc
    v_smfmac_f32_16x16x64_bf16 v[168:171], v[60:63], v[220:227], v41
    buffer_store_dwordx4 v[140:143], v6, s[12:15], s24 offen offset:128 sc1
    v_cvt_pk_bf16_f32 v192, v192, v193
    v_smfmac_f32_16x16x64_bf16 v[168:171], v[96:99], v[228:235], v45
    v_cvt_pk_bf16_f32 v193, v194, v195
    v_smfmac_f32_16x16x64_bf16 v[172:175], v[64:67], v[220:227], v41 abid:1
    ds_write_b64 v53, v[192:193] offset:1024
    v_smfmac_f32_16x16x64_bf16 v[172:175], v[100:103], v[228:235], v45 abid:1
    ds_read_b128 v[220:223], v1 offset:21504
    s_waitcnt lgkmcnt(4)
    v_smfmac_f32_16x16x64_bf16 v[176:179], a[16:19], v[196:203], v14
    ds_read_b128 v[224:227], v2 offset:21504
    s_waitcnt lgkmcnt(3)
    v_smfmac_f32_16x16x64_bf16 v[176:179], a[52:55], v[204:211], v18
    ds_read_b128 v[228:231], v1 offset:22528
    v_smfmac_f32_16x16x64_bf16 v[176:179], a[88:91], v[212:219], v22
    ds_read_b128 v[232:235], v2 offset:22528
    s_waitcnt lgkmcnt(4)
    s_barrier
    ds_read_b128 v[236:239], v8 offset:11840
    v_smfmac_f32_16x16x64_bf16 v[180:183], a[20:23], v[196:203], v14 abid:1
    v_cvt_pk_bf16_f32 v160, v160, v161
    v_smfmac_f32_16x16x64_bf16 v[180:183], a[56:59], v[204:211], v18 abid:1
    v_cvt_pk_bf16_f32 v161, v162, v163
    v_smfmac_f32_16x16x64_bf16 v[180:183], a[92:95], v[212:219], v22 abid:1
    v_cvt_pk_bf16_f32 v162, v164, v165
    v_smfmac_f32_16x16x64_bf16 v[184:187], a[24:27], v[196:203], v15
    v_cvt_pk_bf16_f32 v163, v166, v167
    v_smfmac_f32_16x16x64_bf16 v[184:187], a[60:63], v[204:211], v19
    v_cvt_pk_bf16_f32 v168, v168, v169
    v_smfmac_f32_16x16x64_bf16 v[184:187], a[96:99], v[212:219], v23
    s_cmp_lt_u32 s20, 2
    s_waitcnt lgkmcnt(0)
    s_cbranch_scc0 M_fx
    buffer_store_dwordx4 v[236:239], v7, s[12:15], s67 offen sc1
M_fx:
    v_smfmac_f32_16x16x64_bf16 v[188:191], a[28:31], v[196:203], v15 abid:1
    v_cvt_pk_bf16_f32 v169, v170, v171
    v_smfmac_f32_16x16x64_bf16 v[188:191], a[64:67], v[204:211], v19 abid:1
    v_cvt_pk_bf16_f32 v170, v172, v173
    v_smfmac_f32_16x16x64_bf16 v[188:191], a[100:103], v[212:219], v23 abid:1
    ds_read_b128 v[196:199], v1 offset:23552
    v_cvt_pk_bf16_f32 v171, v174, v175
    v_smfmac_f32_16x16x64_bf16 v[176:179], a[124:127], v[220:227], v26
    ds_read_b128 v[200:203], v2 offset:23552
    v_cndmask_b32_dpp v164, v160, v168, vcc row_ror:8 row_mask:0xf bank_mask:0xf
    v_smfmac_f32_16x16x64_bf16 v[176:179], a[160:163], v[228:235], v30
    ds_read_b128 v[204:207], v1 offset:24576
    v_cndmask_b32_dpp v165, v161, v169, vcc row_ror:8 row_mask:0xf bank_mask:0xf
    v_smfmac_f32_16x16x64_bf16 v[180:183], a[128:131], v[220:227], v26 abid:1
    ds_read_b128 v[208:211], v2 offset:24576
    v_cndmask_b32_dpp v166, v162, v170, vcc row_ror:8 row_mask:0xf bank_mask:0xf
    v_smfmac_f32_16x16x64_bf16 v[180:183], a[164:167], v[228:235], v30 abid:1
    v_cndmask_b32_dpp v167, v163, v171, vcc row_ror:8 row_mask:0xf bank_mask:0xf
    v_smfmac_f32_16x16x64_bf16 v[184:187], a[132:135], v[220:227], v27
    buffer_store_dwordx4 v[164:167], v6, s[12:15], s58 offen offset:0 sc1
    v_mov_b32_dpp v160, v168 row_ror:8 row_mask:0xf bank_mask:0xc
    v_smfmac_f32_16x16x64_bf16 v[184:187], a[168:171], v[228:235], v31
    v_mov_b32_dpp v161, v169 row_ror:8 row_mask:0xf bank_mask:0xc
    v_smfmac_f32_16x16x64_bf16 v[188:191], a[136:139], v[220:227], v27 abid:1
    v_mov_b32_dpp v162, v170 row_ror:8 row_mask:0xf bank_mask:0xc
    v_smfmac_f32_16x16x64_bf16 v[188:191], a[172:175], v[228:235], v31 abid:1
    ds_read_b128 v[220:223], v1 offset:25600
    s_waitcnt lgkmcnt(3)
    v_mov_b32_dpp v163, v171 row_ror:8 row_mask:0xf bank_mask:0xc
    v_smfmac_f32_16x16x64_bf16 v[176:179], a[196:199], v[196:203], v34
    ds_read_b128 v[224:227], v2 offset:25600
    buffer_store_dwordx4 v[160:163], v6, s[12:15], s23 offen offset:0 sc1
    s_waitcnt lgkmcnt(2)
    v_smfmac_f32_16x16x64_bf16 v[176:179], a[232:235], v[204:211], v38
    ds_read_b128 v[228:231], v1 offset:26624
    v_smfmac_f32_16x16x64_bf16 v[180:183], a[200:203], v[196:203], v34 abid:1
    ds_read_b128 v[232:235], v2 offset:26624
    v_smfmac_f32_16x16x64_bf16 v[180:183], a[236:239], v[204:211], v38 abid:1
    v_smfmac_f32_16x16x64_bf16 v[184:187], a[204:207], v[196:203], v35
    v_smfmac_f32_16x16x64_bf16 v[184:187], a[240:243], v[204:211], v39
    v_smfmac_f32_16x16x64_bf16 v[188:191], a[208:211], v[196:203], v35 abid:1
    v_smfmac_f32_16x16x64_bf16 v[188:191], a[244:247], v[204:211], v39 abid:1
    s_waitcnt lgkmcnt(2)
    v_smfmac_f32_16x16x64_bf16 v[176:179], v[68:71], v[220:227], v42
    s_waitcnt lgkmcnt(0)
    v_smfmac_f32_16x16x64_bf16 v[176:179], v[104:107], v[228:235], v46
    v_smfmac_f32_16x16x64_bf16 v[180:183], v[72:75], v[220:227], v42 abid:1
    v_smfmac_f32_16x16x64_bf16 v[180:183], v[108:111], v[228:235], v46 abid:1
    v_smfmac_f32_16x16x64_bf16 v[184:187], v[76:79], v[220:227], v43
    v_smfmac_f32_16x16x64_bf16 v[184:187], v[112:115], v[228:235], v47
    v_smfmac_f32_16x16x64_bf16 v[188:191], v[80:83], v[220:227], v43 abid:1
    v_smfmac_f32_16x16x64_bf16 v[188:191], v[116:119], v[228:235], v47 abid:1
    s_nop 1
    v_cvt_pk_bf16_f32 v176, v176, v177
    v_cvt_pk_bf16_f32 v177, v178, v179
    v_cvt_pk_bf16_f32 v178, v180, v181
    v_cvt_pk_bf16_f32 v179, v182, v183
    v_cvt_pk_bf16_f32 v184, v184, v185
    v_cvt_pk_bf16_f32 v185, v186, v187
    v_cvt_pk_bf16_f32 v186, v188, v189
    v_cvt_pk_bf16_f32 v187, v190, v191
    v_cndmask_b32_dpp v180, v176, v184, vcc row_ror:8 row_mask:0xf bank_mask:0xf
    v_cndmask_b32_dpp v181, v177, v185, vcc row_ror:8 row_mask:0xf bank_mask:0xf
    v_cndmask_b32_dpp v182, v178, v186, vcc row_ror:8 row_mask:0xf bank_mask:0xf
    v_cndmask_b32_dpp v183, v179, v187, vcc row_ror:8 row_mask:0xf bank_mask:0xf
    buffer_store_dwordx4 v[180:183], v6, s[12:15], s58 offen offset:128 sc1
    v_mov_b32_dpp v176, v184 row_ror:8 row_mask:0xf bank_mask:0xc
    v_mov_b32_dpp v177, v185 row_ror:8 row_mask:0xf bank_mask:0xc
    v_mov_b32_dpp v178, v186 row_ror:8 row_mask:0xf bank_mask:0xc
    v_mov_b32_dpp v179, v187 row_ror:8 row_mask:0xf bank_mask:0xc
    buffer_store_dwordx4 v[176:179], v6, s[12:15], s23 offen offset:128 sc1
M_done:
M_end:
    s_endpgm
M_pf_spin:
    s_sleep 4
    v_mov_b32 v0, 0
    s_mov_b64 exec, 1
    buffer_atomic_add v0, off, s[16:19], s96 sc0 sc1
    s_mov_b64 exec, -1
    s_add_u32 s31, s31, 1
    s_waitcnt vmcnt(0)
    v_readfirstlane_b32 s30, v0
    s_nop 0
    s_sub_u32 s30, s30, s100
    s_cmp_eq_u32 s30, 27
    s_cbranch_scc1 M_pf_ok
    s_cmp_lt_u32 s31, 6
    s_cbranch_scc1 M_pf_spin
    s_cmp_eq_u32 s98, 0
    s_cbranch_scc1 M_pf_spin2
    s_mov_b32 s98, 0
    v_mov_b32 v250, 1
    s_mov_b64 exec, 1
    buffer_atomic_add v250, off, s[68:71], 0 offset:0 sc1
    s_mov_b64 exec, -1
    s_nop 3
M_pf_spin2:
    buffer_load_dword v0, off, s[68:71], 0 offset:0 sc1
    s_cmp_ge_u32 s31, 131072
    s_cbranch_scc1 M_end
    s_waitcnt vmcnt(0)
    v_readfirstlane_b32 s30, v0
    s_nop 0
    s_cmp_eq_u32 s30, 81
    s_cbranch_scc0 M_pf_spin
    s_branch M_pf_ok
M_r3:
    v_bfe_u32 v74, v60, 24, 4
    v_lshlrev_b32 v75, 1, v60
    v_lshl_add_u32 v74, v74, 2, s49
    v_and_b32 v75, 16, v75
    v_and_or_b32 v74, v60, 2.0, v74
    v_lshlrev_b32 v75, v75, 1
    ds_add_rtn_u32 v64, v74, v75
    v_and_b32 v74, 8, v60
    v_lshrrev_b32 v77, 14, v60
    v_cmp_ne_u32 s[44:45], 0, v74
    v_and_b32 v80, 0x3cf0, v77
    s_waitcnt lgkmcnt(0)
    v_lshrrev_b32 v75, 16, v64
    v_and_b32 v76, 0xffff, v64
    v_sub_u32 v74, 15, v75
    v_and_b32 v64, 2.0, v60
    v_add3_u32 v64, v76, v75, v64
    v_cndmask_b32 v74, v76, v74, s[44:45]
    v_cmp_gt_u32 s[44:45], 16, v64
    v_cmp_gt_u32 s[36:37], 2.0, v64
    v_lshlrev_b32 v74, 2, v74
    v_lshrrev_b64 v[76:77], v74, s[50:51]
    s_andn2_b64 s[36:37], s[36:37], s[44:45]
    v_lshrrev_b64 v[78:79], v74, s[52:53]
    v_bfe_u32 v74, v60, 24, 4
    v_mbcnt_lo_u32_b32 v75, s36, 0
    v_and_b32 v76, 15, v76
    v_mbcnt_hi_u32_b32 v75, s37, v75
    v_and_b32 v78, 15, v78
    v_lshl_add_u32 v75, v75, 3, s40
    v_lshl_add_u32 v76, v74, 4, v76
    v_min_u32 v75, s41, v75
    v_mul_u32_u24 v78, 68, v78
    v_cndmask_b32 v75, v82, v75, s[36:37]
    ds_write_b64 v75, v[60:61]
    s_bcnt1_i32_b64 s30, s[36:37]
    s_lshl3_add_u32 s40, s30, s40
    v_lshl_add_u32 v76, v76, 2, s47
    v_and_b32 v78, 0x30c, v78
    v_cndmask_b32 v76, v82, v76, s[44:45]
    v_add3_u32 v77, v80, v78, s29
    v_and_b32 v78, 0x3fff, v60
    v_cndmask_b32 v74, v82, v77, s[44:45]
    ds_write_b32 v76, v78
    ds_write_b32 v74, v61
    s_cmp_gt_u32 s38, s39
    s_cselect_b32 s32, 1, s32
    s_branch M_r3r
M_dn:
    s_mov_b32 s27, 0
    s_mov_b32 s46, 0x80000000
    v_mov_b32 v244, 0
    v_mov_b32 v245, 0
    v_mov_b32 v246, 0
    v_mov_b32 v247, 0
    ds_write_b128 v8, v[244:247] offset:0
    ds_write_b128 v8, v[244:247] offset:1024
    ds_write_b128 v8, v[244:247] offset:2048
    ds_write_b128 v8, v[244:247] offset:3072
    ds_write_b128 v8, v[244:247] offset:4096
    ds_write_b128 v8, v[244:247] offset:5120
    ds_write_b128 v8, v[244:247] offset:6144
    ds_write_b128 v8, v[244:247] offset:7168
    ds_write_b128 v8, v[244:247] offset:8192
    s_waitcnt lgkmcnt(0)
    s_branch M_dnr
M_ovc0:
    v_smfmac_f32_16x16x32_bf16 v[124:127], v[54:55], v[212:215], v10
    v_smfmac_f32_16x16x32_bf16 v[160:163], v[54:55], v[212:215], v10 abid:2
    s_setpc_b64 s[74:75]
    v_smfmac_f32_16x16x32_bf16 v[128:131], v[54:55], v[212:215], v10
    v_smfmac_f32_16x16x32_bf16 v[164:167], v[54:55], v[212:215], v10 abid:2
    s_setpc_b64 s[74:75]
    v_smfmac_f32_16x16x32_bf16 v[132:135], v[54:55], v[212:215], v10
    v_smfmac_f32_16x16x32_bf16 v[168:171], v[54:55], v[212:215], v10 abid:2
    s_setpc_b64 s[74:75]
    v_smfmac_f32_16x16x32_bf16 v[136:139], v[54:55], v[212:215], v10
    v_smfmac_f32_16x16x32_bf16 v[172:175], v[54:55], v[212:215], v10 abid:2
    s_setpc_b64 s[74:75]
    v_smfmac_f32_16x16x32_bf16 v[140:143], v[54:55], v[212:215], v10
    v_smfmac_f32_16x16x32_bf16 v[176:179], v[54:55], v[212:215], v10 abid:2
    s_setpc_b64 s[74:75]
    v_smfmac_f32_16x16x32_bf16 v[144:147], v[54:55], v[212:215], v10
    v_smfmac_f32_16x16x32_bf16 v[180:183], v[54:55], v[212:215], v10 abid:2
    s_setpc_b64 s[74:75]
    v_smfmac_f32_16x16x32_bf16 v[148:151], v[54:55], v[212:215], v10
    v_smfmac_f32_16x16x32_bf16 v[184:187], v[54:55], v[212:215], v10 abid:2
    s_setpc_b64 s[74:75]
    v_smfmac_f32_16x16x32_bf16 v[152:155], v[54:55], v[212:215], v10
    v_smfmac_f32_16x16x32_bf16 v[188:191], v[54:55], v[212:215], v10 abid:2
    s_setpc_b64 s[74:75]
    v_smfmac_f32_16x16x32_bf16 v[156:159], v[54:55], v[212:215], v10
    v_smfmac_f32_16x16x32_bf16 v[192:195], v[54:55], v[212:215], v10 abid:2
    s_setpc_b64 s[74:75]
M_ovl0:
    v_smfmac_f32_16x16x32_bf16 v[124:127], v[54:55], v[212:215], v10
    v_smfmac_f32_16x16x32_bf16 v[160:163], v[54:55], v[212:215], v10 abid:2
    s_setpc_b64 s[78:79]
    v_smfmac_f32_16x16x32_bf16 v[128:131], v[54:55], v[212:215], v10
    v_smfmac_f32_16x16x32_bf16 v[164:167], v[54:55], v[212:215], v10 abid:2
    s_setpc_b64 s[78:79]
    v_smfmac_f32_16x16x32_bf16 v[132:135], v[54:55], v[212:215], v10
    v_smfmac_f32_16x16x32_bf16 v[168:171], v[54:55], v[212:215], v10 abid:2
    s_setpc_b64 s[78:79]
    v_smfmac_f32_16x16x32_bf16 v[136:139], v[54:55], v[212:215], v10
    v_smfmac_f32_16x16x32_bf16 v[172:175], v[54:55], v[212:215], v10 abid:2
    s_setpc_b64 s[78:79]
    v_smfmac_f32_16x16x32_bf16 v[140:143], v[54:55], v[212:215], v10
    v_smfmac_f32_16x16x32_bf16 v[176:179], v[54:55], v[212:215], v10 abid:2
    s_setpc_b64 s[78:79]
    v_smfmac_f32_16x16x32_bf16 v[144:147], v[54:55], v[212:215], v10
    v_smfmac_f32_16x16x32_bf16 v[180:183], v[54:55], v[212:215], v10 abid:2
    s_setpc_b64 s[78:79]
    v_smfmac_f32_16x16x32_bf16 v[148:151], v[54:55], v[212:215], v10
    v_smfmac_f32_16x16x32_bf16 v[184:187], v[54:55], v[212:215], v10 abid:2
    s_setpc_b64 s[78:79]
    v_smfmac_f32_16x16x32_bf16 v[152:155], v[54:55], v[212:215], v10
    v_smfmac_f32_16x16x32_bf16 v[188:191], v[54:55], v[212:215], v10 abid:2
    s_setpc_b64 s[78:79]
    v_smfmac_f32_16x16x32_bf16 v[156:159], v[54:55], v[212:215], v10
    v_smfmac_f32_16x16x32_bf16 v[192:195], v[54:55], v[212:215], v10 abid:2
    s_setpc_b64 s[78:79]
M_ovc1:
    v_smfmac_f32_16x16x32_bf16 v[124:127], v[252:253], v[212:215], v10
    v_smfmac_f32_16x16x32_bf16 v[160:163], v[252:253], v[212:215], v10 abid:2
    s_setpc_b64 s[76:77]
    v_smfmac_f32_16x16x32_bf16 v[128:131], v[252:253], v[212:215], v10
    v_smfmac_f32_16x16x32_bf16 v[164:167], v[252:253], v[212:215], v10 abid:2
    s_setpc_b64 s[76:77]
    v_smfmac_f32_16x16x32_bf16 v[132:135], v[252:253], v[212:215], v10
    v_smfmac_f32_16x16x32_bf16 v[168:171], v[252:253], v[212:215], v10 abid:2
    s_setpc_b64 s[76:77]
    v_smfmac_f32_16x16x32_bf16 v[136:139], v[252:253], v[212:215], v10
    v_smfmac_f32_16x16x32_bf16 v[172:175], v[252:253], v[212:215], v10 abid:2
    s_setpc_b64 s[76:77]
    v_smfmac_f32_16x16x32_bf16 v[140:143], v[252:253], v[212:215], v10
    v_smfmac_f32_16x16x32_bf16 v[176:179], v[252:253], v[212:215], v10 abid:2
    s_setpc_b64 s[76:77]
    v_smfmac_f32_16x16x32_bf16 v[144:147], v[252:253], v[212:215], v10
    v_smfmac_f32_16x16x32_bf16 v[180:183], v[252:253], v[212:215], v10 abid:2
    s_setpc_b64 s[76:77]
    v_smfmac_f32_16x16x32_bf16 v[148:151], v[252:253], v[212:215], v10
    v_smfmac_f32_16x16x32_bf16 v[184:187], v[252:253], v[212:215], v10 abid:2
    s_setpc_b64 s[76:77]
    v_smfmac_f32_16x16x32_bf16 v[152:155], v[252:253], v[212:215], v10
    v_smfmac_f32_16x16x32_bf16 v[188:191], v[252:253], v[212:215], v10 abid:2
    s_setpc_b64 s[76:77]
    v_smfmac_f32_16x16x32_bf16 v[156:159], v[252:253], v[212:215], v10
    v_smfmac_f32_16x16x32_bf16 v[192:195], v[252:253], v[212:215], v10 abid:2
    s_setpc_b64 s[76:77]
M_ovl1:
    v_smfmac_f32_16x16x32_bf16 v[124:127], v[252:253], v[212:215], v10
    v_smfmac_f32_16x16x32_bf16 v[160:163], v[252:253], v[212:215], v10 abid:2
    s_setpc_b64 s[78:79]
    v_smfmac_f32_16x16x32_bf16 v[128:131], v[252:253], v[212:215], v10
    v_smfmac_f32_16x16x32_bf16 v[164:167], v[252:253], v[212:215], v10 abid:2
    s_setpc_b64 s[78:79]
    v_smfmac_f32_16x16x32_bf16 v[132:135], v[252:253], v[212:215], v10
    v_smfmac_f32_16x16x32_bf16 v[168:171], v[252:253], v[212:215], v10 abid:2
    s_setpc_b64 s[78:79]
    v_smfmac_f32_16x16x32_bf16 v[136:139], v[252:253], v[212:215], v10
    v_smfmac_f32_16x16x32_bf16 v[172:175], v[252:253], v[212:215], v10 abid:2
    s_setpc_b64 s[78:79]
    v_smfmac_f32_16x16x32_bf16 v[140:143], v[252:253], v[212:215], v10
    v_smfmac_f32_16x16x32_bf16 v[176:179], v[252:253], v[212:215], v10 abid:2
    s_setpc_b64 s[78:79]
    v_smfmac_f32_16x16x32_bf16 v[144:147], v[252:253], v[212:215], v10
    v_smfmac_f32_16x16x32_bf16 v[180:183], v[252:253], v[212:215], v10 abid:2
    s_setpc_b64 s[78:79]
    v_smfmac_f32_16x16x32_bf16 v[148:151], v[252:253], v[212:215], v10
    v_smfmac_f32_16x16x32_bf16 v[184:187], v[252:253], v[212:215], v10 abid:2
    s_setpc_b64 s[78:79]
    v_smfmac_f32_16x16x32_bf16 v[152:155], v[252:253], v[212:215], v10
    v_smfmac_f32_16x16x32_bf16 v[188:191], v[252:253], v[212:215], v10 abid:2
    s_setpc_b64 s[78:79]
    v_smfmac_f32_16x16x32_bf16 v[156:159], v[252:253], v[212:215], v10
    v_smfmac_f32_16x16x32_bf16 v[192:195], v[252:253], v[212:215], v10 abid:2
    s_setpc_b64 s[78:79]
M_ovl2:
    v_smfmac_f32_16x16x32_bf16 v[124:127], v[254:255], v[212:215], v10
    v_smfmac_f32_16x16x32_bf16 v[160:163], v[254:255], v[212:215], v10 abid:2
    s_setpc_b64 s[78:79]
    v_smfmac_f32_16x16x32_bf16 v[128:131], v[254:255], v[212:215], v10
    v_smfmac_f32_16x16x32_bf16 v[164:167], v[254:255], v[212:215], v10 abid:2
    s_setpc_b64 s[78:79]
    v_smfmac_f32_16x16x32_bf16 v[132:135], v[254:255], v[212:215], v10
    v_smfmac_f32_16x16x32_bf16 v[168:171], v[254:255], v[212:215], v10 abid:2
    s_setpc_b64 s[78:79]
    v_smfmac_f32_16x16x32_bf16 v[136:139], v[254:255], v[212:215], v10
    v_smfmac_f32_16x16x32_bf16 v[172:175], v[254:255], v[212:215], v10 abid:2
    s_setpc_b64 s[78:79]
    v_smfmac_f32_16x16x32_bf16 v[140:143], v[254:255], v[212:215], v10
    v_smfmac_f32_16x16x32_bf16 v[176:179], v[254:255], v[212:215], v10 abid:2
    s_setpc_b64 s[78:79]
    v_smfmac_f32_16x16x32_bf16 v[144:147], v[254:255], v[212:215], v10
    v_smfmac_f32_16x16x32_bf16 v[180:183], v[254:255], v[212:215], v10 abid:2
    s_setpc_b64 s[78:79]
    v_smfmac_f32_16x16x32_bf16 v[148:151], v[254:255], v[212:215], v10
    v_smfmac_f32_16x16x32_bf16 v[184:187], v[254:255], v[212:215], v10 abid:2
    s_setpc_b64 s[78:79]
    v_smfmac_f32_16x16x32_bf16 v[152:155], v[254:255], v[212:215], v10
    v_smfmac_f32_16x16x32_bf16 v[188:191], v[254:255], v[212:215], v10 abid:2
    s_setpc_b64 s[78:79]
    v_smfmac_f32_16x16x32_bf16 v[156:159], v[254:255], v[212:215], v10
    v_smfmac_f32_16x16x32_bf16 v[192:195], v[254:255], v[212:215], v10 abid:2
    s_setpc_b64 s[78:79]
M_ovn:
    s_setpc_b64 s[78:79]
M_slow:
    s_bitcmp1_b32 s46, 31
    s_cbranch_scc1 M_dense
    s_mov_b32 s56, s80
M_sl:
    s_lshl_b32 s57, s56, 6
    v_add_u32 v240, s57, v9
    ds_read_b128 v[248:251], v240 offset:9792
    s_waitcnt lgkmcnt(0)
    v_and_b32 v240, 0x3fff, v248
    v_and_b32 v241, 0x3fff, v250
    v_xad_u32 v240, v240, v3, v4
    v_xad_u32 v241, v241, v3, v4
    ds_read2st64_b32 v[244:245], v240 offset0:0 offset1:72
    ds_read2st64_b32 v[246:247], v241 offset0:0 offset1:72
    v_subrev_u32 v240, s29, v8
    v_bfe_u32 v240, v240, 4, 4
    s_waitcnt lgkmcnt(0)
    s_bitcmp1_b32 s27, 0
    s_cbranch_scc0 M_sle0
    v_lshrrev_b32 v242, 18, v248
    v_lshrrev_b32 v243, 18, v250
    v_or_b32 v241, 0, v240
    v_cmp_eq_u32 s[44:45], v242, v241
    v_cmp_eq_u32 s[54:55], v243, v241
    s_nop 0
    v_cndmask_b32 v242, 0, v249, s[44:45]
    v_cndmask_b32 v243, 0, v251, s[54:55]
    s_nop 1
    v_smfmac_f32_16x16x32_bf16 v[124:127], v[242:243], v[244:247], v10
    v_smfmac_f32_16x16x32_bf16 v[160:163], v[242:243], v[244:247], v10 abid:2
M_sle0:
    s_bitcmp1_b32 s27, 1
    s_cbranch_scc0 M_sle1
    v_lshrrev_b32 v242, 18, v248
    v_lshrrev_b32 v243, 18, v250
    v_or_b32 v241, 64, v240
    v_cmp_eq_u32 s[44:45], v242, v241
    v_cmp_eq_u32 s[54:55], v243, v241
    s_nop 0
    v_cndmask_b32 v242, 0, v249, s[44:45]
    v_cndmask_b32 v243, 0, v251, s[54:55]
    s_nop 1
    v_smfmac_f32_16x16x32_bf16 v[128:131], v[242:243], v[244:247], v10
    v_smfmac_f32_16x16x32_bf16 v[164:167], v[242:243], v[244:247], v10 abid:2
M_sle1:
    s_bitcmp1_b32 s27, 2
    s_cbranch_scc0 M_sle2
    v_lshrrev_b32 v242, 18, v248
    v_lshrrev_b32 v243, 18, v250
    v_or_b32 v241, 128, v240
    v_cmp_eq_u32 s[44:45], v242, v241
    v_cmp_eq_u32 s[54:55], v243, v241
    s_nop 0
    v_cndmask_b32 v242, 0, v249, s[44:45]
    v_cndmask_b32 v243, 0, v251, s[54:55]
    s_nop 1
    v_smfmac_f32_16x16x32_bf16 v[132:135], v[242:243], v[244:247], v10
    v_smfmac_f32_16x16x32_bf16 v[168:171], v[242:243], v[244:247], v10 abid:2
M_sle2:
    s_bitcmp1_b32 s27, 3
    s_cbranch_scc0 M_sle3
    v_lshrrev_b32 v242, 18, v248
    v_lshrrev_b32 v243, 18, v250
    v_or_b32 v241, 192, v240
    v_cmp_eq_u32 s[44:45], v242, v241
    v_cmp_eq_u32 s[54:55], v243, v241
    s_nop 0
    v_cndmask_b32 v242, 0, v249, s[44:45]
    v_cndmask_b32 v243, 0, v251, s[54:55]
    s_nop 1
    v_smfmac_f32_16x16x32_bf16 v[136:139], v[242:243], v[244:247], v10
    v_smfmac_f32_16x16x32_bf16 v[172:175], v[242:243], v[244:247], v10 abid:2
M_sle3:
    s_bitcmp1_b32 s27, 4
    s_cbranch_scc0 M_sle4
    v_lshrrev_b32 v242, 18, v248
    v_lshrrev_b32 v243, 18, v250
    v_or_b32 v241, 256, v240
    v_cmp_eq_u32 s[44:45], v242, v241
    v_cmp_eq_u32 s[54:55], v243, v241
    s_nop 0
    v_cndmask_b32 v242, 0, v249, s[44:45]
    v_cndmask_b32 v243, 0, v251, s[54:55]
    s_nop 1
    v_smfmac_f32_16x16x32_bf16 v[140:143], v[242:243], v[244:247], v10
    v_smfmac_f32_16x16x32_bf16 v[176:179], v[242:243], v[244:247], v10 abid:2
M_sle4:
    s_bitcmp1_b32 s27, 5
    s_cbranch_scc0 M_sle5
    v_lshrrev_b32 v242, 18, v248
    v_lshrrev_b32 v243, 18, v250
    v_or_b32 v241, 320, v240
    v_cmp_eq_u32 s[44:45], v242, v241
    v_cmp_eq_u32 s[54:55], v243, v241
    s_nop 0
    v_cndmask_b32 v242, 0, v249, s[44:45]
    v_cndmask_b32 v243, 0, v251, s[54:55]
    s_nop 1
    v_smfmac_f32_16x16x32_bf16 v[144:147], v[242:243], v[244:247], v10
    v_smfmac_f32_16x16x32_bf16 v[180:183], v[242:243], v[244:247], v10 abid:2
M_sle5:
    s_bitcmp1_b32 s27, 6
    s_cbranch_scc0 M_sle6
    v_lshrrev_b32 v242, 18, v248
    v_lshrrev_b32 v243, 18, v250
    v_or_b32 v241, 384, v240
    v_cmp_eq_u32 s[44:45], v242, v241
    v_cmp_eq_u32 s[54:55], v243, v241
    s_nop 0
    v_cndmask_b32 v242, 0, v249, s[44:45]
    v_cndmask_b32 v243, 0, v251, s[54:55]
    s_nop 1
    v_smfmac_f32_16x16x32_bf16 v[148:151], v[242:243], v[244:247], v10
    v_smfmac_f32_16x16x32_bf16 v[184:187], v[242:243], v[244:247], v10 abid:2
M_sle6:
    s_bitcmp1_b32 s27, 7
    s_cbranch_scc0 M_sle7
    v_lshrrev_b32 v242, 18, v248
    v_lshrrev_b32 v243, 18, v250
    v_or_b32 v241, 448, v240
    v_cmp_eq_u32 s[44:45], v242, v241
    v_cmp_eq_u32 s[54:55], v243, v241
    s_nop 0
    v_cndmask_b32 v242, 0, v249, s[44:45]
    v_cndmask_b32 v243, 0, v251, s[54:55]
    s_nop 1
    v_smfmac_f32_16x16x32_bf16 v[152:155], v[242:243], v[244:247], v10
    v_smfmac_f32_16x16x32_bf16 v[188:191], v[242:243], v[244:247], v10 abid:2
M_sle7:
    s_bitcmp1_b32 s27, 8
    s_cbranch_scc0 M_sle8
    v_lshrrev_b32 v242, 18, v248
    v_lshrrev_b32 v243, 18, v250
    v_or_b32 v241, 512, v240
    v_cmp_eq_u32 s[44:45], v242, v241
    v_cmp_eq_u32 s[54:55], v243, v241
    s_nop 0
    v_cndmask_b32 v242, 0, v249, s[44:45]
    v_cndmask_b32 v243, 0, v251, s[54:55]
    s_nop 1
    v_smfmac_f32_16x16x32_bf16 v[156:159], v[242:243], v[244:247], v10
    v_smfmac_f32_16x16x32_bf16 v[192:195], v[242:243], v[244:247], v10 abid:2
M_sle8:
    s_add_u32 s56, s56, 1
    s_cmp_lt_u32 s56, s46
    s_cbranch_scc1 M_sl
M_slx:
    s_nop 7
    s_cmp_eq_u32 s21, 1
    s_cbranch_scc1 M_slowrL
    s_cmp_eq_u32 s21, 2
    s_cbranch_scc1 M_slowrE0
    s_cmp_eq_u32 s21, 3
    s_cbranch_scc1 M_slowrQ
    s_cmp_eq_u32 s21, 4
    s_cbranch_scc1 M_slowrF
    s_branch M_slowr0
M_dense:
    s_mul_i32 s57, s20, 82944
    s_add_u32 s57, s57, 393216
    s_mov_b32 s56, 0
    v_mov_b32 v54, v1
    v_mov_b32 v55, v2
    v_subrev_u32 v252, s29, v8
M_dn0:
    ds_read_b128 v[244:247], v54 offset:0
    ds_read_b128 v[248:251], v55 offset:0
    v_add_u32 v54, 1024, v54
    v_add_u32 v55, 1024, v55
    buffer_load_dwordx4 v[240:243], v252, s[16:19], s57 offen sc1
    s_add_u32 s57, s57, 1024
    s_waitcnt vmcnt(0) lgkmcnt(0)
    v_smfmac_f32_16x16x64_bf16 v[124:127], v[240:243], v[244:251], v10
    buffer_load_dwordx4 v[240:243], v252, s[16:19], s57 offen sc1
    s_add_u32 s57, s57, 1024
    s_waitcnt vmcnt(0) lgkmcnt(0)
    v_smfmac_f32_16x16x64_bf16 v[128:131], v[240:243], v[244:251], v10
    buffer_load_dwordx4 v[240:243], v252, s[16:19], s57 offen sc1
    s_add_u32 s57, s57, 1024
    s_waitcnt vmcnt(0) lgkmcnt(0)
    v_smfmac_f32_16x16x64_bf16 v[132:135], v[240:243], v[244:251], v10
    buffer_load_dwordx4 v[240:243], v252, s[16:19], s57 offen sc1
    s_add_u32 s57, s57, 1024
    s_waitcnt vmcnt(0) lgkmcnt(0)
    v_smfmac_f32_16x16x64_bf16 v[136:139], v[240:243], v[244:251], v10
    buffer_load_dwordx4 v[240:243], v252, s[16:19], s57 offen sc1
    s_add_u32 s57, s57, 1024
    s_waitcnt vmcnt(0) lgkmcnt(0)
    v_smfmac_f32_16x16x64_bf16 v[140:143], v[240:243], v[244:251], v10
    buffer_load_dwordx4 v[240:243], v252, s[16:19], s57 offen sc1
    s_add_u32 s57, s57, 1024
    s_waitcnt vmcnt(0) lgkmcnt(0)
    v_smfmac_f32_16x16x64_bf16 v[144:147], v[240:243], v[244:251], v10
    buffer_load_dwordx4 v[240:243], v252, s[16:19], s57 offen sc1
    s_add_u32 s57, s57, 1024
    s_waitcnt vmcnt(0) lgkmcnt(0)
    v_smfmac_f32_16x16x64_bf16 v[148:151], v[240:243], v[244:251], v10
    buffer_load_dwordx4 v[240:243], v252, s[16:19], s57 offen sc1
    s_add_u32 s57, s57, 1024
    s_waitcnt vmcnt(0) lgkmcnt(0)
    v_smfmac_f32_16x16x64_bf16 v[152:155], v[240:243], v[244:251], v10
    buffer_load_dwordx4 v[240:243], v252, s[16:19], s57 offen sc1
    s_add_u32 s57, s57, 1024
    s_waitcnt vmcnt(0) lgkmcnt(0)
    v_smfmac_f32_16x16x64_bf16 v[156:159], v[240:243], v[244:251], v10
    s_add_u32 s56, s56, 1
    s_cmp_lt_u32 s56, 9
    s_cbranch_scc1 M_dn0
    s_mul_i32 s57, s20, 82944
    s_add_u32 s57, s57, 393216
    s_mov_b32 s56, 0
    v_mov_b32 v54, v1
    v_mov_b32 v55, v2
    v_subrev_u32 v252, s29, v8
M_dn1:
    ds_read_b128 v[244:247], v54 offset:18432
    ds_read_b128 v[248:251], v55 offset:18432
    v_add_u32 v54, 1024, v54
    v_add_u32 v55, 1024, v55
    buffer_load_dwordx4 v[240:243], v252, s[16:19], s57 offen sc1
    s_add_u32 s57, s57, 1024
    s_waitcnt vmcnt(0) lgkmcnt(0)
    v_smfmac_f32_16x16x64_bf16 v[160:163], v[240:243], v[244:251], v10
    buffer_load_dwordx4 v[240:243], v252, s[16:19], s57 offen sc1
    s_add_u32 s57, s57, 1024
    s_waitcnt vmcnt(0) lgkmcnt(0)
    v_smfmac_f32_16x16x64_bf16 v[164:167], v[240:243], v[244:251], v10
    buffer_load_dwordx4 v[240:243], v252, s[16:19], s57 offen sc1
    s_add_u32 s57, s57, 1024
    s_waitcnt vmcnt(0) lgkmcnt(0)
    v_smfmac_f32_16x16x64_bf16 v[168:171], v[240:243], v[244:251], v10
    buffer_load_dwordx4 v[240:243], v252, s[16:19], s57 offen sc1
    s_add_u32 s57, s57, 1024
    s_waitcnt vmcnt(0) lgkmcnt(0)
    v_smfmac_f32_16x16x64_bf16 v[172:175], v[240:243], v[244:251], v10
    buffer_load_dwordx4 v[240:243], v252, s[16:19], s57 offen sc1
    s_add_u32 s57, s57, 1024
    s_waitcnt vmcnt(0) lgkmcnt(0)
    v_smfmac_f32_16x16x64_bf16 v[176:179], v[240:243], v[244:251], v10
    buffer_load_dwordx4 v[240:243], v252, s[16:19], s57 offen sc1
    s_add_u32 s57, s57, 1024
    s_waitcnt vmcnt(0) lgkmcnt(0)
    v_smfmac_f32_16x16x64_bf16 v[180:183], v[240:243], v[244:251], v10
    buffer_load_dwordx4 v[240:243], v252, s[16:19], s57 offen sc1
    s_add_u32 s57, s57, 1024
    s_waitcnt vmcnt(0) lgkmcnt(0)
    v_smfmac_f32_16x16x64_bf16 v[184:187], v[240:243], v[244:251], v10
    buffer_load_dwordx4 v[240:243], v252, s[16:19], s57 offen sc1
    s_add_u32 s57, s57, 1024
    s_waitcnt vmcnt(0) lgkmcnt(0)
    v_smfmac_f32_16x16x64_bf16 v[188:191], v[240:243], v[244:251], v10
    buffer_load_dwordx4 v[240:243], v252, s[16:19], s57 offen sc1
    s_add_u32 s57, s57, 1024
    s_waitcnt vmcnt(0) lgkmcnt(0)
    v_smfmac_f32_16x16x64_bf16 v[192:195], v[240:243], v[244:251], v10
    s_add_u32 s56, s56, 1
    s_cmp_lt_u32 s56, 9
    s_cbranch_scc1 M_dn1
    s_branch M_slx
M_codeend:
.section .rodata,"a"
.p2align 6
.amdhsa_kernel standalone__structured_sparse_n_m__ragged_kernel
  .amdhsa_next_free_vgpr 512
  .amdhsa_next_free_sgpr 102
  .amdhsa_accum_offset 256
  .amdhsa_group_segment_fixed_size 0
  .amdhsa_kernarg_size 48
  .amdhsa_user_sgpr_count 2
  .amdhsa_user_sgpr_kernarg_segment_ptr 1
  .amdhsa_system_sgpr_workgroup_id_x 1
  .amdhsa_float_denorm_mode_32 3
.end_amdhsa_kernel
```

```asm
; @launch grid=(256,1,1) block=(256,1,1) lds=162064
.amdgcn_target "amdgcn-amd-amdhsa--gfx950"
.text
.globl standalone__structured_sparse_n_m__ragged_kernel
.p2align 8
.type standalone__structured_sparse_n_m__ragged_kernel,@function
standalone__structured_sparse_n_m__ragged_kernel:
    s_cmp_ge_u32 s2, 256
    s_cbranch_scc1 M_end
    s_load_dwordx8 s[72:79], s[0:1], 0
    s_load_dwordx4 s[80:83], s[0:1], 32
    s_getpc_b64 s[84:85]
    s_lshr_b32 s30, s2, 3
    s_and_b32 s30, s30, 15
    s_lshl_b32 s30, s30, 11
    s_and_b32 s84, s84, 0xffffff00
    s_cmp_ge_u32 s2, 88
    s_cselect_b32 s86, M_codeend-standalone__structured_sparse_n_m__ragged_kernel, 0
    s_mov_b32 s87, 0x20000
    v_lshlrev_b32 v254, 3, v0
    s_mov_b32 exec_lo, 0x00010001
    s_mov_b32 exec_hi, 0x00010001
    buffer_load_dword v254, v254, s[84:87], s30 offen
    s_mov_b64 exec, -1
    v_lshrrev_b32 v20, 6, v0
    v_and_b32 v12, 63, v0
    v_readfirstlane_b32 s20, v20
    v_lshrrev_b32 v22, 3, v0
    v_mul_u32_u24 v22, 1152, v22
    v_lshrrev_b32 v23, 4, v0
    v_xor_b32 v23, v23, v0
    v_and_b32 v23, 7, v23
    v_lshl_add_u32 v5, v23, 4, v22
    v_lshrrev_b32 v13, 4, v12
    v_and_b32 v14, 15, v12
    v_lshlrev_b32 v11, 4, v12
    v_lshlrev_b32 v54, 3, v12
    v_lshlrev_b32 v25, 4, v13
    v_lshlrev_b32 v26, 3, v13
    s_mov_b32 s6, 663552
    s_mov_b32 s7, 0x20000
    s_mov_b32 s10, 75497472
    s_mov_b32 s11, s7
    s_mov_b32 s18, 791552
    s_mov_b32 s19, s7
    s_movk_i32 s70, 256
    s_mov_b32 s71, s7
    s_movk_i32 s86, 1152
    s_mov_b32 s87, s7
    s_mov_b32 s98, 0
    s_mul_i32 s96, s20, 16
    s_and_b32 s97, s2, 15
    s_add_u32 s96, s96, s97
    s_lshl_b32 s96, s96, 8
    s_add_u32 s96, s96, 726016
    s_mul_i32 s22, s2, 36864
    s_mul_i32 s26, s20, 9216
    s_mov_b32 s24, s22
    s_mov_b32 s42, s26
    s_lshl_b32 s28, s20, 8
    s_lshl_b32 s97, s20, 5
    s_cmp_lt_u32 s2, 81
    s_cbranch_scc0 M_x1
    s_mul_i32 s32, s2, 57
    s_lshr_b32 s32, s32, 9
    s_mul_i32 s33, s32, 9
    s_sub_u32 s33, s2, s33
    s_mul_i32 s54, s32, 73728
    s_lshl_b32 s35, s33, 7
    s_add_u32 s54, s54, s35
    s_add_u32 s55, s54, 36864
    s_lshl_b32 s36, s20, 10
    s_add_u32 m0, s36, 73728
    s_lshr_b32 s30, s33, 1
    s_and_b32 s31, s33, 1
    s_lshl1_add_u32 s37, s32, s31
    s_mul_i32 s37, s37, 176
    s_mul_i32 s38, s32, 96
    s_add_u32 s38, s38, 3168
    s_cmp_lt_u32 s33, 8
    s_cselect_b32 s30, s30, s20
    s_cselect_b32 s37, s37, s38
    s_cselect_b32 s44, 2047, 63
    s_cselect_b32 s45, s20, 3
    s_cmp_eq_u32 s45, 3
    s_cselect_b32 s99, 791552, 0
    s_mul_i32 s48, s30, 98304
    s_add_u32 s37, s37, s48
    v_mov_b32 v44, 2.0
    v_mov_b32 v45, 0
    v_mov_b32 v46, 2.0
    v_mov_b32 v47, 0
    s_waitcnt lgkmcnt(0)
    s_mov_b64 s[4:5], s[74:75]
    buffer_load_dwordx4 v5, s[4:7], s54 offen lds
    s_add_u32 m0, m0, 4096
    s_mov_b32 s45, 0
    buffer_load_dwordx4 v5, s[4:7], s55 offen lds
    s_mov_b64 s[16:17], s[82:83]
    s_mov_b64 s[8:9], s[72:73]
    s_mov_b64 s[84:85], s[76:77]
    s_mov_b64 s[68:69], s[80:81]
    v_mov_b32 v10, 0
    s_mov_b64 exec, 1
    buffer_atomic_add v10, off, s[16:19], s96 sc0 sc1
    s_mov_b64 exec, -1
    s_mov_b64 exec, s[44:45]
    s_mov_b32 s18, s99
    buffer_store_dwordx4 v[44:47], v11, s[16:19], s37 offen sc1
    s_mov_b32 s18, 791552
    s_mov_b64 exec, -1
    s_mov_b32 m0, s42
    s_nop 0
    buffer_load_dwordx4 v5, s[8:11], s22 offen offset:0 nt lds
    s_add_u32 m0, m0, 896
    s_nop 0
    buffer_load_dwordx4 v5, s[8:11], s22 offen offset:128 nt lds
    s_add_u32 m0, m0, 896
    s_nop 0
    buffer_load_dwordx4 v5, s[8:11], s22 offen offset:256 nt lds
    s_lshl_b32 s34, s31, 2
    s_add_u32 s34, s34, s20
    s_lshr_b32 s35, s20, 1
    s_lshl_b32 s35, s35, 6
    s_and_b32 s36, s20, 1
    s_lshl_b32 s36, s36, 3
    s_add_u32 s35, s35, s36
    s_lshl_b32 s36, s20, 5
    s_mul_i32 s39, s32, 10240
    s_add_u32 s39, s39, 6144
    s_lshl_b32 s40, s34, 1
    s_add_u32 s40, s40, s39
    s_lshl_b32 s38, s32, 1
    s_cmp_eq_u32 s32, 8
    s_cselect_b32 s38, 1024, s38
    s_add_u32 s38, s38, 4096
    s_cmp_lt_u32 s33, 8
    s_cselect_b32 s34, s34, 8
    s_cselect_b32 s35, s35, s36
    s_cselect_b32 s36, 4, 3
    s_cselect_b32 s40, s40, s38
    s_cselect_b32 s46, 0, s20
    s_cselect_b32 s47, 22, 12
    s_add_u32 s40, s40, s48
    s_lshl_b32 s38, s34, 10
    s_add_u32 s39, s39, s38
    s_add_u32 s39, s39, s48
    s_add_u32 s39, s39, 1024
    v_and_b32 v15, 3, v14
    v_lshlrev_b32 v15, s36, v15
    v_add_u32 v15, s35, v15
    v_lshrrev_b32 v16, 3, v14
    v_lshlrev_b32 v16, 4, v16
    v_xor_b32 v15, v15, v16
    v_lshrrev_b32 v16, 2, v14
    v_lshl_add_u32 v16, v13, 4, v16
    v_lshl_add_u32 v15, v16, 7, v15
    v_add_u32 v24, 73728, v15
    v_xor_b32 v27, 32, v24
    v_xor_b32 v28, 64, v24
    v_xor_b32 v29, 0x60, v24
    s_lshl_b32 s31, s46, 2
    s_add_u32 s31, s31, 81920
    v_mov_b32 v60, s31
    v_mov_b32 v61, 1
    ds_write_b32 v60, v61
    s_mul_i32 s49, s30, 81
    s_mul_i32 s31, s32, 9
    s_add_u32 s49, s49, s31
    s_add_u32 s49, s49, s34
    s_lshl_b32 s49, s49, 10
    s_add_u32 s49, s49, 393216
    s_lshl_b32 s31, s34, 24
    s_lshl_b32 s38, s32, 10
    s_add_u32 s31, s31, s38
    v_lshlrev_b32 v31, 18, v14
    v_lshl_add_u32 v31, v13, 5, v31
    v_add_u32 v31, s31, v31
    s_mov_b32 s50, 3437096686
    s_mov_b32 s51, 1150609561
    s_mov_b32 s52, 0x00010001
    s_mov_b32 s53, 0x00200010
    s_mov_b32 s38, 0x0202
    s_mul_i32 s57, s30, 4096
    s_add_u32 s57, s57, 726016
    s_cmp_eq_u32 s33, 8
    s_cselect_b32 s56, 0, s20
    s_cmp_eq_u32 s20, 0
    s_cselect_b32 s98, 1, 0
    v_add_u32 v74, 81984, v54
    v_lshl_add_u32 v73, s20, 1, v74
    v_mov_b32 v41, 0x01000100
    v_mov_b32 v40, 0
    v_mov_b32 v63, -2.0
    s_waitcnt vmcnt(5) lgkmcnt(0)
    s_barrier
    ds_read_b64_tr_b16 v[16:17], v24
    ds_read_b64_tr_b16 v[18:19], v27 offset:512
    ds_read_b64_tr_b16 v[20:21], v28 offset:1024
    ds_read_b64_tr_b16 v[22:23], v29 offset:1536
    s_waitcnt lgkmcnt(3)
    v_and_b32 v44, 0x7fff7fff, v16
    v_and_b32 v45, 0x7fff7fff, v17
    v_pk_max_u16 v46, v44, v45
    v_pk_min_u16 v47, v44, v45
    v_pk_min_u16 v46, v46, v46 op_sel:[0,1] op_sel_hi:[1,0]
    v_pk_max_u16 v47, v47, v47 op_sel:[0,1] op_sel_hi:[1,0]
    v_pk_max_u16 v46, v46, s52
    v_pk_max_u16 v46, v46, v47
    v_pk_sub_i16 v44, v44, v46
    v_pk_sub_i16 v45, v45, v46
    v_pk_ashrrev_i16 v44, 15, v44 op_sel_hi:[0,1]
    v_pk_ashrrev_i16 v45, 15, v45 op_sel_hi:[0,1]
    v_alignbit_b32 v47, -1, v44, 16
    v_alignbit_b32 v46, v45, v45, 16
    v_and_b32 v48, 0x00080004, v44
    v_bitop3_b32 v46, v45, v46, v47 bitop3:0xe8
    v_and_or_b32 v64, v45, s53, v48
    v_bitop3_b32 v36, v16, v44, v46 bitop3:0x10
    v_min_u32 v68, 1, v36
    s_waitcnt lgkmcnt(2)
    v_and_b32 v44, 0x7fff7fff, v18
    v_and_b32 v45, 0x7fff7fff, v19
    v_pk_max_u16 v46, v44, v45
    v_pk_min_u16 v47, v44, v45
    v_pk_min_u16 v46, v46, v46 op_sel:[0,1] op_sel_hi:[1,0]
    v_pk_max_u16 v47, v47, v47 op_sel:[0,1] op_sel_hi:[1,0]
    v_pk_max_u16 v46, v46, s52
    v_pk_max_u16 v46, v46, v47
    v_pk_sub_i16 v44, v44, v46
    v_pk_sub_i16 v45, v45, v46
    v_pk_ashrrev_i16 v44, 15, v44 op_sel_hi:[0,1]
    v_pk_ashrrev_i16 v45, 15, v45 op_sel_hi:[0,1]
    v_alignbit_b32 v47, -1, v44, 16
    v_alignbit_b32 v46, v45, v45, 16
    v_and_b32 v48, 0x00080004, v44
    v_bitop3_b32 v46, v45, v46, v47 bitop3:0xe8
    v_and_or_b32 v65, v45, s53, v48
    v_bitop3_b32 v37, v18, v44, v46 bitop3:0x10
    v_min_u32 v69, 1, v37
    s_waitcnt lgkmcnt(1)
    v_and_b32 v44, 0x7fff7fff, v20
    v_and_b32 v45, 0x7fff7fff, v21
    v_pk_max_u16 v46, v44, v45
    v_pk_min_u16 v47, v44, v45
    v_pk_min_u16 v46, v46, v46 op_sel:[0,1] op_sel_hi:[1,0]
    v_pk_max_u16 v47, v47, v47 op_sel:[0,1] op_sel_hi:[1,0]
    v_pk_max_u16 v46, v46, s52
    v_pk_max_u16 v46, v46, v47
    v_pk_sub_i16 v44, v44, v46
    v_pk_sub_i16 v45, v45, v46
    v_pk_ashrrev_i16 v44, 15, v44 op_sel_hi:[0,1]
    v_pk_ashrrev_i16 v45, 15, v45 op_sel_hi:[0,1]
    v_alignbit_b32 v47, -1, v44, 16
    v_alignbit_b32 v46, v45, v45, 16
    v_and_b32 v48, 0x00080004, v44
    v_bitop3_b32 v46, v45, v46, v47 bitop3:0xe8
    v_and_or_b32 v66, v45, s53, v48
    v_bitop3_b32 v38, v20, v44, v46 bitop3:0x10
    v_min_u32 v70, 1, v38
    s_waitcnt lgkmcnt(0)
    v_and_b32 v44, 0x7fff7fff, v22
    v_and_b32 v45, 0x7fff7fff, v23
    v_pk_max_u16 v46, v44, v45
    v_pk_min_u16 v47, v44, v45
    v_pk_min_u16 v46, v46, v46 op_sel:[0,1] op_sel_hi:[1,0]
    v_pk_max_u16 v47, v47, v47 op_sel:[0,1] op_sel_hi:[1,0]
    v_pk_max_u16 v46, v46, s52
    v_pk_max_u16 v46, v46, v47
    v_pk_sub_i16 v44, v44, v46
    v_pk_sub_i16 v45, v45, v46
    v_pk_ashrrev_i16 v44, 15, v44 op_sel_hi:[0,1]
    v_pk_ashrrev_i16 v45, 15, v45 op_sel_hi:[0,1]
    v_alignbit_b32 v47, -1, v44, 16
    v_alignbit_b32 v46, v45, v45, 16
    v_and_b32 v48, 0x00080004, v44
    v_bitop3_b32 v46, v45, v46, v47 bitop3:0xe8
    v_and_or_b32 v67, v45, s53, v48
    v_bitop3_b32 v39, v22, v44, v46 bitop3:0x10
    v_min_u32 v71, 1, v39
    v_add_u32 v72, v68, v69
    v_add3_u32 v72, v72, v70, v71
    buffer_store_dwordx4 v[36:39], v11, s[16:19], s49 offen sc1
    v_cmp_ne_u32 vcc, 0, v72
    s_and_saveexec_b64 s[44:45], vcc
    ds_add_rtn_u32 v62, v60, v72
    s_mov_b64 exec, -1
    v_lshrrev_b32 v48, 16, v64
    v_or_b32 v48, v48, v64
    v_lshrrev_b64 v[52:53], v48, s[50:51]
    v_and_b32 v64, 15, v52
    v_lshl_or_b32 v40, v64, 0, v40
    v_lshrrev_b32 v48, 16, v65
    v_or_b32 v48, v48, v65
    v_lshrrev_b64 v[52:53], v48, s[50:51]
    v_and_b32 v65, 15, v52
    v_lshl_or_b32 v40, v65, 4, v40
    v_lshrrev_b32 v48, 16, v66
    v_or_b32 v48, v48, v66
    v_lshrrev_b64 v[52:53], v48, s[50:51]
    v_and_b32 v66, 15, v52
    v_lshl_or_b32 v40, v66, 8, v40
    v_lshrrev_b32 v48, 16, v67
    v_or_b32 v48, v48, v67
    v_lshrrev_b64 v[52:53], v48, s[50:51]
    v_and_b32 v67, 15, v52
    v_lshl_or_b32 v40, v67, 12, v40
    v_lshrrev_b32 v44, 2, v40
    v_lshlrev_b32 v45, 2, v40
    s_movk_i32 s31, 0x3333
    v_not_b32 v47, v40
    v_bfi_b32 v44, s31, v44, v45
    s_movk_i32 s31, 0x1111
    s_nop 0
    v_mov_b32_dpp v47, v44 row_shr:4 row_mask:0xf bank_mask:0xf
    v_xor_b32 v47, v47, v40
    v_lshrrev_b32 v45, 1, v47
    v_or_b32 v47, v47, v45
    v_lshrrev_b32 v45, 2, v47
    v_bitop3_b32 v47, v47, v45, s31 bitop3:0x2a
    s_nop 1
    v_xor_b32_dpp v47, v47, v47 row_shr:4 row_mask:0xf bank_mask:0xe
    s_nop 1
    v_xor_b32_dpp v47, v47, v47 row_shr:8 row_mask:0xf bank_mask:0xc
    v_mul_u32_u24 v47, 15, v47
    v_bfi_b32 v40, v47, v44, v40
    ds_write_b16 v73, v40
    v_bfe_u32 v64, v40, 0, 4
    v_mul_u32_u24 v46, 0x4001, v64
    v_and_b32 v46, 0x30003, v46
    v_mad_u32_u24 v46, v46, s38, v41
    v_perm_b32 v32, v17, v16, v46
    v_bfe_u32 v65, v40, 4, 4
    v_mul_u32_u24 v46, 0x4001, v65
    v_and_b32 v46, 0x30003, v46
    v_mad_u32_u24 v46, v46, s38, v41
    v_perm_b32 v33, v19, v18, v46
    s_waitcnt vmcnt(4) lgkmcnt(0)
    s_barrier
    ds_read_b64 v[50:51], v74
    v_bfe_u32 v66, v40, 8, 4
    v_mul_u32_u24 v46, 0x4001, v66
    v_and_b32 v46, 0x30003, v46
    v_mad_u32_u24 v46, v46, s38, v41
    v_perm_b32 v34, v21, v20, v46
    v_bfe_u32 v67, v40, 12, 4
    v_mul_u32_u24 v46, 0x4001, v67
    v_and_b32 v46, 0x30003, v46
    v_mad_u32_u24 v46, v46, s38, v41
    v_perm_b32 v35, v23, v22, v46
    buffer_store_dwordx4 v[32:35], v11, s[16:19], s39 offen sc1
    s_cmp_eq_u32 s33, 8
    s_cbranch_scc0 F_i1
    buffer_store_short v40, v11, s[16:19], s40 offen sc1
    s_branch F_i2
F_i1:
    s_cmp_eq_u32 s20, 0
    s_cbranch_scc0 F_i2
    s_waitcnt lgkmcnt(0)
    buffer_store_dwordx2 v[50:51], v11, s[16:19], s40 offen sc1
F_i2:
    s_cbranch_vccz F_z
    v_cmp_ne_u32 vcc, 0, v36
    s_and_saveexec_b64 s[44:45], vcc
    s_cbranch_execz F_e0
    v_cmp_gt_u32 vcc, s47, v62
    v_add_u32 v42, 0, v31
    v_lshlrev_b32 v44, 3, v62
    v_add_u32 v62, 1, v62
    v_cndmask_b32 v42, v63, v42, vcc
    v_cndmask_b32 v43, 0, v36, vcc
    v_cndmask_b32 v44, 0, v44, vcc
    buffer_store_dwordx2 v[42:43], v44, s[16:19], s37 offen sc1
F_e0:
    s_mov_b64 exec, -1
    v_cmp_ne_u32 vcc, 0, v37
    s_and_saveexec_b64 s[44:45], vcc
    s_cbranch_execz F_e1
    v_cmp_gt_u32 vcc, s47, v62
    v_add_u32 v42, 8, v31
    v_lshlrev_b32 v44, 3, v62
    v_add_u32 v62, 1, v62
    v_cndmask_b32 v42, v63, v42, vcc
    v_cndmask_b32 v43, 0, v37, vcc
    v_cndmask_b32 v44, 0, v44, vcc
    buffer_store_dwordx2 v[42:43], v44, s[16:19], s37 offen sc1
F_e1:
    s_mov_b64 exec, -1
    v_cmp_ne_u32 vcc, 0, v38
    s_and_saveexec_b64 s[44:45], vcc
    s_cbranch_execz F_e2
    v_cmp_gt_u32 vcc, s47, v62
    v_add_u32 v42, 16, v31
    v_lshlrev_b32 v44, 3, v62
    v_add_u32 v62, 1, v62
    v_cndmask_b32 v42, v63, v42, vcc
    v_cndmask_b32 v43, 0, v38, vcc
    v_cndmask_b32 v44, 0, v44, vcc
    buffer_store_dwordx2 v[42:43], v44, s[16:19], s37 offen sc1
F_e2:
    s_mov_b64 exec, -1
    v_cmp_ne_u32 vcc, 0, v39
    s_and_saveexec_b64 s[44:45], vcc
    s_cbranch_execz F_e3
    v_cmp_gt_u32 vcc, s47, v62
    v_add_u32 v42, 24, v31
    v_lshlrev_b32 v44, 3, v62
    v_add_u32 v62, 1, v62
    v_cndmask_b32 v42, v63, v42, vcc
    v_cndmask_b32 v43, 0, v39, vcc
    v_cndmask_b32 v44, 0, v44, vcc
    buffer_store_dwordx2 v[42:43], v44, s[16:19], s37 offen sc1
F_e3:
    s_mov_b64 exec, -1
F_z:
    s_cmp_lg_u32 s2, 0
    s_cbranch_scc1 M_set
    v_mov_b32 v64, 0
    v_mov_b32 v65, 0
    v_mov_b32 v66, 0
    v_mov_b32 v67, 0
    s_mov_b32 s40, 724992
    buffer_store_dwordx4 v[64:67], v11, s[16:19], s40 offen sc1
    s_branch M_set
F_sig:
    v_lshlrev_b32 v30, 8, v12
    s_waitcnt vmcnt(0)
    s_barrier
    s_cmp_lg_u32 s56, 0
    s_cbranch_scc1 F_end
    s_bfm_b64 exec, 16, 0
    buffer_atomic_add v61, v30, s[16:19], s57 offen sc1
    s_mov_b64 exec, -1
F_end:
    s_add_u32 m0, m0, 896
    s_nop 0
    buffer_load_dwordx4 v5, s[8:11], s22 offen offset:384 nt lds
    s_add_u32 m0, m0, 896
    s_nop 0
    buffer_load_dwordx4 v5, s[8:11], s22 offen offset:512 nt lds
    s_branch M_x2
M_x1:
    s_waitcnt lgkmcnt(0)
    s_mov_b64 s[4:5], s[74:75]
    s_mov_b64 s[16:17], s[82:83]
    s_mov_b64 s[8:9], s[72:73]
    s_mov_b64 s[84:85], s[76:77]
    s_mov_b64 s[68:69], s[80:81]
    v_mov_b32 v10, 0
    s_mov_b64 exec, 1
    buffer_atomic_add v10, off, s[16:19], s96 sc0 sc1
    s_mov_b64 exec, -1
    s_mov_b32 m0, s42
    s_nop 0
    buffer_load_dwordx4 v5, s[8:11], s22 offen offset:0 nt lds
    s_add_u32 m0, m0, 896
    s_nop 0
    buffer_load_dwordx4 v5, s[8:11], s22 offen offset:128 nt lds
    s_add_u32 m0, m0, 896
    s_nop 0
    buffer_load_dwordx4 v5, s[8:11], s22 offen offset:256 nt lds
    s_add_u32 m0, m0, 896
    s_nop 0
    buffer_load_dwordx4 v5, s[8:11], s22 offen offset:384 nt lds
    s_add_u32 m0, m0, 896
    s_nop 0
    buffer_load_dwordx4 v5, s[8:11], s22 offen offset:512 nt lds
M_set:
    s_mov_b32 s12, s78
    s_mov_b32 s13, s79
    s_mov_b32 s14, 75497472
    s_mov_b32 s15, 0x20000
    s_mul_i32 s29, s20, 12864
    s_add_u32 s29, s29, 110592
    v_lshrrev_b32 v24, 1, v14
    v_and_b32 v27, 7, v14
    v_lshlrev_b32 v22, 7, v27
    v_lshl_or_b32 v3, v24, 4, v22
    v_lshrrev_b32 v23, 3, v14
    v_mul_u32_u24 v4, 9216, v23
    v_xad_u32 v1, v25, v3, v4
    v_xor_b32 v2, 64, v1
    v_add_u32 v9, s29, v25
    v_add_u32 v8, s29, v11
    v_mul_u32_u24 v24, 1152, v27
    v_lshl_add_u32 v24, v23, 6, v24
    v_add3_u32 v6, v24, v25, s28
    v_lshrrev_b32 v24, 3, v12
    v_xor_b32 v28, v24, v12
    v_and_b32 v28, 7, v28
    v_mul_u32_u24 v24, 1152, v24
    v_lshl_add_u32 v24, v28, 4, v24
    v_add_u32 v7, 1024, v24
    s_lshl_b32 s30, s20, 1
    v_lshrrev_b32 v24, 1, v13
    v_add_u32 v24, s30, v24
    v_xor_b32 v24, v24, v27
    v_lshl_add_u32 v24, v24, 4, v22
    v_and_b32 v28, 8, v26
    v_mul_u32_u24 v29, 12864, v23
    v_add3_u32 v24, v24, v28, v29
    v_add_u32 v53, 121408, v24
    s_lshr_b32 s30, s2, 3
    s_and_b32 s30, s30, 1
    s_mul_i32 s92, s30, 256
    s_add_u32 s92, s92, 562944
    s_add_u32 s30, s30, 768
    s_mul_i32 s93, s30, 36864
    s_mov_b32 s94, 73728
    s_and_b32 s95, s20, 1
    s_mul_i32 s95, s95, 9216
    s_add_u32 s59, s24, 9216
    s_mul_i32 s43, s20, 98304
    s_add_u32 s47, s29, 9216
    s_add_u32 s48, s29, 9792
    s_add_u32 s49, s29, 10112
    s_add_u32 s54, s29, 1073751872
    s_add_u32 s38, s26, 73728
    s_add_u32 s35, s38, 1024
    s_add_u32 s39, s38, 1536
    s_mov_b32 s40, s48
    s_add_u32 s41, s48, 256
    s_mov_b32 s50, 3130536464
    s_mov_b32 s51, 1164430831
    s_mov_b32 s52, 3696531472
    s_mov_b32 s53, 598435823
    v_mov_b32 v16, 0
    v_mov_b32 v17, 0
    v_mov_b32 v18, 0
    v_mov_b32 v19, 0
    v_cmp_gt_u32 s[44:45], 36, v12
    v_mov_b32 v20, 2.0
    s_nop 0
    v_cndmask_b32 v20, 0, v20, s[44:45]
    v_mov_b32 v21, v20
    v_mov_b32 v22, v20
    v_mov_b32 v23, v20
    v_mov_b32 v104, 1073741824
    v_mov_b32 v105, 0
    v_mov_b32 v106, 1073741824
    v_mov_b32 v107, 0
    v_lshl_add_u32 v121, v12, 2, s49
    v_add_u32 v55, s38, v54
    v_add_u32 v24, s38, v11
    ds_write_b128 v8, v[16:19] offset:0
    ds_write_b128 v8, v[16:19] offset:1024
    ds_write_b128 v8, v[16:19] offset:2048
    ds_write_b128 v8, v[16:19] offset:3072
    ds_write_b128 v8, v[16:19] offset:4096
    ds_write_b128 v8, v[16:19] offset:5120
    ds_write_b128 v8, v[16:19] offset:6144
    ds_write_b128 v8, v[16:19] offset:7168
    ds_write_b128 v8, v[16:19] offset:8192
    ds_write_b128 v24, v[104:107]
    ds_write_b128 v24, v[104:107] offset:1024
    ds_write_b128 v8, v[20:23] offset:9216
    s_cmp_lt_u32 s2, 81
    s_cbranch_scc1 F_sig
M_x2:
    s_add_u32 m0, m0, 896
    s_nop 0
    buffer_load_dwordx4 v5, s[8:11], s22 offen offset:640 nt lds
    s_add_u32 m0, m0, 896
    s_nop 0
    buffer_load_dwordx4 v5, s[8:11], s22 offen offset:768 nt lds
    s_add_u32 m0, m0, 896
    s_nop 0
    buffer_load_dwordx4 v5, s[8:11], s22 offen offset:896 nt lds
    s_add_u32 m0, m0, 896
    s_nop 0
    buffer_load_dwordx4 v5, s[8:11], s22 offen offset:1024 nt lds
    s_add_u32 s22, s22, 9437184
    s_add_u32 s42, s42, 36864
    buffer_load_dwordx4 v[196:199], v25, s[84:87], s28 offen offset:0
    buffer_load_dwordx4 v[200:203], v25, s[84:87], s28 offen offset:64
    buffer_load_dwordx4 v[204:207], v25, s[84:87], s28 offen offset:128
    buffer_load_dwordx4 v[208:211], v25, s[84:87], s28 offen offset:192
    buffer_load_dwordx2 v[212:213], v26, s[84:87], s97 offen offset:1024
    s_mov_b32 m0, s42
    s_nop 0
    buffer_load_dwordx4 v5, s[8:11], s22 offen offset:0 nt lds
    s_add_u32 m0, m0, 896
    s_nop 0
    buffer_load_dwordx4 v5, s[8:11], s22 offen offset:128 nt lds
    s_add_u32 m0, m0, 896
    s_nop 0
    buffer_load_dwordx4 v5, s[8:11], s22 offen offset:256 nt lds
    s_add_u32 m0, m0, 896
    s_nop 0
    buffer_load_dwordx4 v5, s[8:11], s22 offen offset:384 nt lds
    s_add_u32 m0, m0, 896
    s_nop 0
    buffer_load_dwordx4 v5, s[8:11], s22 offen offset:512 nt lds
    s_add_u32 m0, m0, 896
    s_nop 0
    buffer_load_dwordx4 v5, s[8:11], s22 offen offset:640 nt lds
    s_add_u32 m0, m0, 896
    s_nop 0
    buffer_load_dwordx4 v5, s[8:11], s22 offen offset:768 nt lds
    s_add_u32 m0, m0, 896
    s_nop 0
    buffer_load_dwordx4 v5, s[8:11], s22 offen offset:896 nt lds
    s_add_u32 m0, m0, 896
    s_nop 0
    buffer_load_dwordx4 v5, s[8:11], s22 offen offset:1024 nt lds
    s_add_u32 s22, s22, 9437184
    s_add_u32 s42, s42, 36864
    s_waitcnt vmcnt(3)
    v_mov_b32 v0, 0
    s_mov_b64 exec, 1
    buffer_atomic_add v0, off, s[16:19], s96 sc0 sc1
    s_mov_b64 exec, -1
    v_readlane_b32 s100, v10, 0
    v_mov_b32 v10, 0xeeee4444
    v_lshlrev_b32 v124, 16, v196
    v_and_b32 v125, 0xffff0000, v196
    v_lshlrev_b32 v126, 16, v197
    v_and_b32 v127, 0xffff0000, v197
    v_lshlrev_b32 v128, 16, v198
    v_and_b32 v129, 0xffff0000, v198
    v_lshlrev_b32 v130, 16, v199
    v_and_b32 v131, 0xffff0000, v199
    v_lshlrev_b32 v132, 16, v200
    v_and_b32 v133, 0xffff0000, v200
    v_lshlrev_b32 v134, 16, v201
    v_and_b32 v135, 0xffff0000, v201
    v_lshlrev_b32 v136, 16, v202
    v_and_b32 v137, 0xffff0000, v202
    v_lshlrev_b32 v138, 16, v203
    v_and_b32 v139, 0xffff0000, v203
    v_lshlrev_b32 v140, 16, v204
    v_and_b32 v141, 0xffff0000, v204
    v_lshlrev_b32 v142, 16, v205
    v_and_b32 v143, 0xffff0000, v205
    v_lshlrev_b32 v144, 16, v206
    v_and_b32 v145, 0xffff0000, v206
    v_lshlrev_b32 v146, 16, v207
    v_and_b32 v147, 0xffff0000, v207
    v_lshlrev_b32 v148, 16, v208
    v_and_b32 v149, 0xffff0000, v208
    v_lshlrev_b32 v150, 16, v209
    v_and_b32 v151, 0xffff0000, v209
    v_lshlrev_b32 v152, 16, v210
    v_and_b32 v153, 0xffff0000, v210
    v_lshlrev_b32 v154, 16, v211
    v_and_b32 v155, 0xffff0000, v211
    v_lshlrev_b32 v156, 16, v212
    v_and_b32 v157, 0xffff0000, v212
    v_lshlrev_b32 v158, 16, v213
    v_and_b32 v159, 0xffff0000, v213
    s_mov_b32 exec_lo, 0x00010001
    s_mov_b32 exec_hi, 0x00010001
    ds_write_b128 v9, v[124:127] offset:10240
    ds_write_b128 v9, v[128:131] offset:10304
    ds_write_b128 v9, v[132:135] offset:10368
    ds_write_b128 v9, v[136:139] offset:10432
    ds_write_b128 v9, v[140:143] offset:10496
    ds_write_b128 v9, v[144:147] offset:10560
    ds_write_b128 v9, v[148:151] offset:10624
    ds_write_b128 v9, v[152:155] offset:10688
    ds_write_b128 v9, v[156:159] offset:10752
    s_mov_b64 exec, -1
    s_mul_i32 s30, s20, 256
    s_add_u32 s30, s30, s2
    s_sub_u32 s30, s30, 0
    s_cmp_lt_u32 s2, 0
    s_cselect_b32 s30, 1023, s30
    s_lshl_b32 s30, s30, 1
    v_lshrrev_b32 v244, 5, v12
    v_add_u32 v248, s30, v244
    v_mov_b32 v244, -1
    v_mov_b32 v245, 0
    v_subrev_u32 v246, 664, v248
    v_cmp_gt_u32 vcc, 12, v246
    v_mov_b32 v247, 0
    s_nop 0
    v_cndmask_b32 v244, v244, v246, vcc
    v_cndmask_b32 v245, v245, v247, vcc
    v_subrev_u32 v246, 638, v248
    v_cmp_gt_u32 vcc, 26, v246
    v_mov_b32 v247, 1
    s_nop 0
    v_cndmask_b32 v244, v244, v246, vcc
    v_cndmask_b32 v245, v245, v247, vcc
    v_subrev_u32 v246, 598, v248
    v_cmp_gt_u32 vcc, 40, v246
    v_mov_b32 v247, 2
    s_nop 0
    v_cndmask_b32 v244, v244, v246, vcc
    v_cndmask_b32 v245, v245, v247, vcc
    v_subrev_u32 v246, 542, v248
    v_cmp_gt_u32 vcc, 56, v246
    v_mov_b32 v247, 3
    s_nop 0
    v_cndmask_b32 v244, v244, v246, vcc
    v_cndmask_b32 v245, v245, v247, vcc
    v_subrev_u32 v246, 468, v248
    v_cmp_gt_u32 vcc, 74, v246
    v_mov_b32 v247, 4
    s_nop 0
    v_cndmask_b32 v244, v244, v246, vcc
    v_cndmask_b32 v245, v245, v247, vcc
    v_subrev_u32 v246, 376, v248
    v_cmp_gt_u32 vcc, 92, v246
    v_mov_b32 v247, 5
    s_nop 0
    v_cndmask_b32 v244, v244, v246, vcc
    v_cndmask_b32 v245, v245, v247, vcc
    v_subrev_u32 v246, 268, v248
    v_cmp_gt_u32 vcc, 108, v246
    v_mov_b32 v247, 6
    s_nop 0
    v_cndmask_b32 v244, v244, v246, vcc
    v_cndmask_b32 v245, v245, v247, vcc
    v_subrev_u32 v246, 142, v248
    v_cmp_gt_u32 vcc, 126, v246
    v_mov_b32 v247, 7
    s_nop 0
    v_cndmask_b32 v244, v244, v246, vcc
    v_cndmask_b32 v245, v245, v247, vcc
    v_subrev_u32 v246, 0, v248
    v_cmp_gt_u32 vcc, 142, v246
    v_mov_b32 v247, 8
    s_nop 0
    v_cndmask_b32 v244, v244, v246, vcc
    v_cndmask_b32 v245, v245, v247, vcc
    v_sub_u32 v244, 2047, v244
    v_mul_u32_u24 v244, 36864, v244
    v_lshl_add_u32 v244, v245, 7, v244
    v_and_b32 v245, 31, v12
    v_mul_u32_u24 v245, 1152, v245
    v_add_u32 v249, v244, v245
    s_mov_b32 vcc_lo, 0xff00ff00
    s_mov_b32 vcc_hi, 0xff00ff00
    s_waitcnt vmcnt(0)
    v_readfirstlane_b32 s30, v0
    s_mov_b32 s31, 0
    s_sub_u32 s30, s30, s100
    s_cmp_eq_u32 s30, 27
    s_cbranch_scc0 M_pf_spin
M_pf_ok:
    s_lshr_b32 s30, s2, 3
    s_sub_u32 s31, s30, 11
    s_cselect_b32 s30, s30, s31
    s_mul_i32 s30, s30, 3072
    s_add_u32 s30, s30, s43
    s_add_u32 s30, s30, 33792
    v_lshlrev_b32 v244, 3, v11
    v_mov_b32 v0, v249
    buffer_load_dwordx4 v[92:95], v11, s[16:19], s43 offen offset:0 sc1
    buffer_load_dwordx4 v[96:99], v11, s[16:19], s43 offen offset:1024 sc1
    buffer_load_dwordx4 v[100:103], v11, s[16:19], s43 offen offset:2048 sc1
    s_mov_b32 exec_hi, 268435455
    buffer_load_dwordx4 v[104:107], v11, s[16:19], s43 offen offset:3072 sc1
    s_mov_b32 exec_hi, -1
    s_add_u32 s43, s43, 4096
    buffer_load_dwordx4 v[48:51], v11, s[16:19], s43 offen offset:0 sc1
    buffer_load_dword v52, v11, s[16:19], s43 offen offset:1024 sc1
    buffer_load_dwordx4 v[12:15], v11, s[16:19], s43 offen offset:2048 sc1
    buffer_load_dwordx4 a[0:3], v11, s[16:19], s43 offen offset:3072 sc1
    s_add_u32 s43, s43, 4096
    buffer_load_dwordx4 a[4:7], v11, s[16:19], s43 offen offset:0 sc1
    buffer_load_dwordx4 a[8:11], v11, s[16:19], s43 offen offset:1024 sc1
    buffer_load_dwordx4 a[12:15], v11, s[16:19], s43 offen offset:2048 sc1
    buffer_load_dwordx4 a[16:19], v11, s[16:19], s43 offen offset:3072 sc1
    s_add_u32 s43, s43, 4096
    s_bfm_b64 exec, 24, 0
    buffer_load_dword v244, v244, s[16:19], s30 offen sc1
    s_mov_b64 exec, -1
    buffer_load_dwordx4 a[20:23], v11, s[16:19], s43 offen offset:0 sc1
    buffer_load_dwordx4 a[24:27], v11, s[16:19], s43 offen offset:1024 sc1
    buffer_load_dwordx4 a[28:31], v11, s[16:19], s43 offen offset:2048 sc1
    buffer_load_dwordx4 a[32:35], v11, s[16:19], s43 offen offset:3072 sc1
    s_add_u32 s43, s43, 4096
    buffer_load_dwordx4 v[16:19], v11, s[16:19], s43 offen offset:0 sc1
    buffer_load_dwordx4 a[36:39], v11, s[16:19], s43 offen offset:1024 sc1
    buffer_load_dwordx4 a[40:43], v11, s[16:19], s43 offen offset:2048 sc1
    buffer_load_dwordx4 a[44:47], v11, s[16:19], s43 offen offset:3072 sc1
    s_add_u32 s43, s43, 4096
    buffer_load_dwordx4 a[48:51], v11, s[16:19], s43 offen offset:0 sc1
    buffer_load_dwordx4 a[52:55], v11, s[16:19], s43 offen offset:1024 sc1
    buffer_load_dwordx4 a[56:59], v11, s[16:19], s43 offen offset:2048 sc1
    buffer_load_dwordx4 a[60:63], v11, s[16:19], s43 offen offset:3072 sc1
    s_add_u32 s43, s43, 4096
    buffer_load_dwordx4 a[64:67], v11, s[16:19], s43 offen offset:0 sc1
    buffer_load_dwordx4 a[68:71], v11, s[16:19], s43 offen offset:1024 sc1
    buffer_load_dwordx4 v[20:23], v11, s[16:19], s43 offen offset:2048 sc1
    buffer_load_dwordx4 a[72:75], v11, s[16:19], s43 offen offset:3072 sc1
    s_add_u32 s43, s43, 4096
    buffer_load_dwordx4 a[76:79], v11, s[16:19], s43 offen offset:0 sc1
    buffer_load_dwordx4 a[80:83], v11, s[16:19], s43 offen offset:1024 sc1
    buffer_load_dwordx4 a[84:87], v11, s[16:19], s43 offen offset:2048 sc1
    buffer_load_dwordx4 a[88:91], v11, s[16:19], s43 offen offset:3072 sc1
    s_add_u32 s43, s43, 4096
    buffer_load_dwordx4 a[92:95], v11, s[16:19], s43 offen offset:0 sc1
    ds_read_b128 v[160:163], v9 offset:10240
    ds_read_b128 v[164:167], v9 offset:10304
    ds_read_b128 v[168:171], v9 offset:10368
    ds_read_b128 v[172:175], v9 offset:10432
    ds_read_b128 v[176:179], v9 offset:10496
    ds_read_b128 v[180:183], v9 offset:10560
    ds_read_b128 v[184:187], v9 offset:10624
    ds_read_b128 v[188:191], v9 offset:10688
    ds_read_b128 v[192:195], v9 offset:10752
    s_cmp_eq_u32 s98, 0
    s_cbranch_scc1 M_cnt
    s_mov_b32 s98, 0
    v_mov_b32 v250, 1
    s_mov_b64 exec, 1
    buffer_atomic_add v250, off, s[68:71], 0 offset:0 sc1
    s_mov_b64 exec, -1
    s_nop 3
M_cnt:
    s_waitcnt vmcnt(26)
    s_barrier
    ds_read_b128 v[196:199], v1 offset:0
    ds_read_b128 v[200:203], v2 offset:0
    ds_read_b128 v[228:231], v1 offset:18432
    ds_read_b128 v[232:235], v2 offset:18432
    s_waitcnt lgkmcnt(2)
    v_smfmac_f32_16x16x64_bf16 v[124:127], a[0:3], v[196:203], v12
    buffer_load_dwordx4 a[96:99], v11, s[16:19], s43 offen offset:1024 sc1
    s_waitcnt lgkmcnt(0)
    v_mov_b32 v118, s54
    v_smfmac_f32_16x16x64_bf16 v[160:163], a[0:3], v[228:235], v12
    ds_read_b128 v[204:207], v1 offset:1024
    ds_read_b128 v[208:211], v2 offset:1024
    v_or3_b32 v114, v92, v96, v100
    v_or_b32 v114, v114, v104
    v_cmp_gt_i32 s[32:33], 0, v114
    v_cmp_gt_u32 s[36:37], 2.0, v92
    s_nop 1
    v_mbcnt_lo_u32_b32 v110, s36, 0
    s_waitcnt vmcnt(26)
    v_mbcnt_hi_u32_b32 v110, s37, v110
    v_smfmac_f32_16x16x64_bf16 v[128:131], a[4:7], v[196:203], v12 abid:1
    buffer_load_dwordx4 a[100:103], v11, s[16:19], s43 offen offset:2048 sc1
    v_lshl_add_u32 v110, v110, 3, s38
    v_smfmac_f32_16x16x64_bf16 v[164:167], a[4:7], v[228:235], v12 abid:1
    ds_read_b128 v[220:223], v1 offset:19456
    ds_read_b128 v[224:227], v2 offset:19456
    v_min_u32 v110, s39, v110
    s_waitcnt vmcnt(26)
    v_cndmask_b32 v110, v118, v110, s[36:37]
    v_smfmac_f32_16x16x64_bf16 v[132:135], a[8:11], v[196:203], v13
    buffer_load_dwordx4 a[104:107], v11, s[16:19], s43 offen offset:3072 sc1
    ds_write_b64 v110, v[92:93]
    s_bcnt1_i32_b64 s30, s[36:37]
    s_lshl3_add_u32 s38, s30, s38
    v_cmp_gt_u32 s[44:45], 2.0, v94
    v_smfmac_f32_16x16x64_bf16 v[168:171], a[8:11], v[228:235], v13
    s_nop 0
    v_mbcnt_lo_u32_b32 v111, s44, 0
    v_mbcnt_hi_u32_b32 v111, s45, v111
    v_lshl_add_u32 v111, v111, 3, s38
    v_min_u32 v111, s39, v111
    s_waitcnt vmcnt(26)
    v_cndmask_b32 v111, v118, v111, s[44:45]
    v_smfmac_f32_16x16x64_bf16 v[136:139], a[12:15], v[196:203], v13 abid:1
    s_add_u32 s43, s43, 4096
    buffer_load_dwordx4 v[24:27], v11, s[16:19], s43 offen offset:0 sc1
    buffer_load_dwordx4 a[108:111], v11, s[16:19], s43 offen offset:1024 sc1
    ds_write_b64 v111, v[94:95]
    s_bcnt1_i32_b64 s30, s[44:45]
    s_lshl3_add_u32 s38, s30, s38
    v_cmp_gt_u32 s[36:37], 2.0, v96
    v_smfmac_f32_16x16x64_bf16 v[172:175], a[12:15], v[228:235], v13 abid:1
    s_nop 0
    v_mbcnt_lo_u32_b32 v110, s36, 0
    v_mbcnt_hi_u32_b32 v110, s37, v110
    v_lshl_add_u32 v110, v110, 3, s38
    s_waitcnt vmcnt(27)
    v_min_u32 v110, s39, v110
    v_smfmac_f32_16x16x64_bf16 v[140:143], a[16:19], v[196:203], v14
    buffer_load_dwordx4 a[112:115], v11, s[16:19], s43 offen offset:2048 sc1
    v_cndmask_b32 v110, v118, v110, s[36:37]
    v_smfmac_f32_16x16x64_bf16 v[176:179], a[16:19], v[228:235], v14
    ds_write_b64 v110, v[96:97]
    s_bcnt1_i32_b64 s30, s[36:37]
    s_lshl3_add_u32 s38, s30, s38
    v_cmp_gt_u32 s[44:45], 2.0, v98
    s_nop 1
    v_mbcnt_lo_u32_b32 v111, s44, 0
    s_waitcnt vmcnt(26)
    v_mbcnt_hi_u32_b32 v111, s45, v111
    v_smfmac_f32_16x16x64_bf16 v[144:147], a[20:23], v[196:203], v14 abid:1
    buffer_load_dwordx4 a[116:119], v11, s[16:19], s43 offen offset:3072 sc1
    v_lshl_add_u32 v111, v111, 3, s38
    v_smfmac_f32_16x16x64_bf16 v[180:183], a[20:23], v[228:235], v14 abid:1
    v_min_u32 v111, s39, v111
    s_waitcnt vmcnt(26)
    v_cndmask_b32 v111, v118, v111, s[44:45]
    v_smfmac_f32_16x16x64_bf16 v[148:151], a[24:27], v[196:203], v15
    s_add_u32 s43, s43, 4096
    buffer_load_dwordx4 a[120:123], v11, s[16:19], s43 offen offset:0 sc1
    ds_write_b64 v111, v[98:99]
    s_bcnt1_i32_b64 s30, s[44:45]
    s_lshl3_add_u32 s38, s30, s38
    v_cmp_gt_u32 s[36:37], 2.0, v100
    v_smfmac_f32_16x16x64_bf16 v[184:187], a[24:27], v[228:235], v15
    s_nop 0
    v_mbcnt_lo_u32_b32 v110, s36, 0
    v_mbcnt_hi_u32_b32 v110, s37, v110
    v_lshl_add_u32 v110, v110, 3, s38
    v_min_u32 v110, s39, v110
    s_waitcnt vmcnt(26)
    v_cndmask_b32 v110, v118, v110, s[36:37]
    v_smfmac_f32_16x16x64_bf16 v[152:155], a[28:31], v[196:203], v15 abid:1
    buffer_load_dwordx4 a[124:127], v11, s[16:19], s43 offen offset:1024 sc1
    ds_write_b64 v110, v[100:101]
    s_bcnt1_i32_b64 s30, s[36:37]
    s_lshl3_add_u32 s38, s30, s38
    v_cmp_gt_u32 s[44:45], 2.0, v102
    v_smfmac_f32_16x16x64_bf16 v[188:191], a[28:31], v[228:235], v15 abid:1
    s_nop 0
    v_mbcnt_lo_u32_b32 v111, s44, 0
    v_mbcnt_hi_u32_b32 v111, s45, v111
    v_lshl_add_u32 v111, v111, 3, s38
    s_waitcnt vmcnt(26)
    v_min_u32 v111, s39, v111
    v_smfmac_f32_16x16x64_bf16 v[156:159], a[32:35], v[196:203], v48
    buffer_load_dwordx4 a[128:131], v11, s[16:19], s43 offen offset:2048 sc1
    v_cndmask_b32 v111, v118, v111, s[44:45]
    v_smfmac_f32_16x16x64_bf16 v[192:195], a[32:35], v[228:235], v48
    ds_write_b64 v111, v[102:103]
    s_bcnt1_i32_b64 s30, s[44:45]
    s_lshl3_add_u32 s38, s30, s38
    v_cmp_gt_u32 s[36:37], 2.0, v104
    s_nop 1
    s_waitcnt vmcnt(25)
    s_waitcnt lgkmcnt(8)
    v_mbcnt_lo_u32_b32 v110, s36, 0
    v_smfmac_f32_16x16x64_bf16 v[124:127], a[36:39], v[204:211], v16
    buffer_load_dwordx4 a[132:135], v11, s[16:19], s43 offen offset:3072 sc1
    s_waitcnt lgkmcnt(6)
    v_mbcnt_hi_u32_b32 v110, s37, v110
    v_smfmac_f32_16x16x64_bf16 v[160:163], a[36:39], v[220:227], v16
    ds_read_b128 v[196:199], v1 offset:2048
    ds_read_b128 v[200:203], v2 offset:2048
    v_lshl_add_u32 v110, v110, 3, s38
    v_min_u32 v110, s39, v110
    s_waitcnt vmcnt(25)
    v_cndmask_b32 v110, v118, v110, s[36:37]
    v_smfmac_f32_16x16x64_bf16 v[128:131], a[40:43], v[204:211], v16 abid:1
    s_add_u32 s43, s43, 4096
    buffer_load_dwordx4 a[136:139], v11, s[16:19], s43 offen offset:0 sc1
    ds_write_b64 v110, v[104:105]
    s_bcnt1_i32_b64 s30, s[36:37]
    s_lshl3_add_u32 s38, s30, s38
    v_cmp_gt_u32 s[44:45], 2.0, v106
    v_smfmac_f32_16x16x64_bf16 v[164:167], a[40:43], v[220:227], v16 abid:1
    ds_read_b128 v[228:231], v1 offset:20480
    ds_read_b128 v[232:235], v2 offset:20480
    v_mbcnt_lo_u32_b32 v111, s44, 0
    v_mbcnt_hi_u32_b32 v111, s45, v111
    v_lshl_add_u32 v111, v111, 3, s38
    v_min_u32 v111, s39, v111
    s_waitcnt vmcnt(25)
    v_cndmask_b32 v111, v118, v111, s[44:45]
    v_smfmac_f32_16x16x64_bf16 v[132:135], a[44:47], v[204:211], v17
    buffer_load_dwordx4 a[140:143], v11, s[16:19], s43 offen offset:1024 sc1
    ds_write_b64 v111, v[106:107]
    s_bcnt1_i32_b64 s30, s[44:45]
    s_lshl3_add_u32 s38, s30, s38
    ds_read_b64 v[92:93], v55 offset:0
    ds_read_b64 v[94:95], v55 offset:512
    ds_read_b64 v[96:97], v55 offset:1024
    v_smfmac_f32_16x16x64_bf16 v[168:171], a[44:47], v[220:227], v17
    s_waitcnt vmcnt(25)
    v_smfmac_f32_16x16x64_bf16 v[136:139], a[48:51], v[204:211], v17 abid:1
    buffer_load_dwordx4 v[28:31], v11, s[16:19], s43 offen offset:2048 sc1
    buffer_load_dwordx4 a[144:147], v11, s[16:19], s43 offen offset:3072 sc1
    v_smfmac_f32_16x16x64_bf16 v[172:175], a[48:51], v[220:227], v17 abid:1
    s_waitcnt vmcnt(26)
    v_smfmac_f32_16x16x64_bf16 v[140:143], a[52:55], v[204:211], v18
    s_add_u32 s43, s43, 4096
    buffer_load_dwordx4 a[148:151], v11, s[16:19], s43 offen offset:0 sc1
    s_waitcnt lgkmcnt(2)
    v_bfe_u32 v110, v92, 24, 4
    v_smfmac_f32_16x16x64_bf16 v[176:179], a[52:55], v[220:227], v18
    v_lshlrev_b32 v111, 1, v92
    v_lshl_add_u32 v110, v110, 2, s49
    v_and_b32 v111, 16, v111
    s_waitcnt vmcnt(26)
    v_and_or_b32 v110, v92, 2.0, v110
    v_smfmac_f32_16x16x64_bf16 v[144:147], a[56:59], v[204:211], v18 abid:1
    buffer_load_dwordx4 a[152:155], v11, s[16:19], s43 offen offset:1024 sc1
    v_lshlrev_b32 v111, v111, 1
    v_smfmac_f32_16x16x64_bf16 v[180:183], a[56:59], v[220:227], v18 abid:1
    ds_add_rtn_u32 v98, v110, v111
    s_waitcnt lgkmcnt(2)
    v_bfe_u32 v112, v94, 24, 4
    v_lshlrev_b32 v113, 1, v94
    v_lshl_add_u32 v112, v112, 2, s49
    s_waitcnt vmcnt(26)
    v_and_b32 v113, 16, v113
    v_smfmac_f32_16x16x64_bf16 v[148:151], a[60:63], v[204:211], v19
    buffer_load_dwordx4 a[156:159], v11, s[16:19], s43 offen offset:2048 sc1
    v_and_or_b32 v112, v94, 2.0, v112
    v_smfmac_f32_16x16x64_bf16 v[184:187], a[60:63], v[220:227], v19
    s_waitcnt vmcnt(26)
    v_lshlrev_b32 v113, v113, 1
    v_smfmac_f32_16x16x64_bf16 v[152:155], a[64:67], v[204:211], v19 abid:1
    buffer_load_dwordx4 a[160:163], v11, s[16:19], s43 offen offset:3072 sc1
    ds_add_rtn_u32 v99, v112, v113
    s_waitcnt lgkmcnt(2)
    s_cmp_gt_u32 s38, s35
    s_cbranch_scc1 M_r3
M_r3r:
    ds_read_b32 v117, v121
    v_and_b32 v110, 8, v92
    v_smfmac_f32_16x16x64_bf16 v[188:191], a[64:67], v[220:227], v19 abid:1
    v_lshrrev_b32 v113, 14, v92
    v_cmp_ne_u32 s[44:45], 0, v110
    v_and_b32 v116, 0x3cf0, v113
    s_waitcnt lgkmcnt(2)
    v_lshrrev_b32 v111, 16, v98
    v_and_b32 v112, 0xffff, v98
    s_waitcnt vmcnt(26)
    v_sub_u32 v110, 15, v111
    v_smfmac_f32_16x16x64_bf16 v[156:159], a[68:71], v[204:211], v48 abid:1
    s_add_u32 s43, s43, 4096
    buffer_load_dwordx4 a[164:167], v11, s[16:19], s43 offen offset:0 sc1
    v_and_b32 v98, 2.0, v92
    v_smfmac_f32_16x16x64_bf16 v[192:195], a[68:71], v[220:227], v48 abid:1
    v_add3_u32 v98, v112, v111, v98
    v_cndmask_b32 v110, v112, v110, s[44:45]
    v_cmp_gt_u32 s[44:45], 16, v98
    v_cmp_gt_u32 s[36:37], 2.0, v98
    v_lshlrev_b32 v110, 2, v110
    s_waitcnt vmcnt(25)
    v_lshrrev_b64 v[112:113], v110, s[50:51]
    v_smfmac_f32_16x16x64_bf16 v[124:127], a[72:75], v[196:203], v20
    buffer_load_dwordx4 a[168:171], v11, s[16:19], s43 offen offset:1024 sc1
    s_andn2_b64 s[36:37], s[36:37], s[44:45]
    v_lshrrev_b64 v[114:115], v110, s[52:53]
    v_smfmac_f32_16x16x64_bf16 v[160:163], a[72:75], v[228:235], v20
    ds_read_b128 v[204:207], v1 offset:3072
    ds_read_b128 v[208:211], v2 offset:3072
    v_bfe_u32 v110, v92, 24, 4
    v_mbcnt_lo_u32_b32 v111, s36, 0
    v_and_b32 v112, 15, v112
    v_mbcnt_hi_u32_b32 v111, s37, v111
    v_and_b32 v114, 15, v114
    s_waitcnt vmcnt(25)
    v_lshl_add_u32 v111, v111, 3, s40
    v_smfmac_f32_16x16x64_bf16 v[128:131], a[76:79], v[196:203], v20 abid:1
    buffer_load_dwordx4 a[172:175], v11, s[16:19], s43 offen offset:2048 sc1
    v_lshl_add_u32 v112, v110, 4, v112
    v_smfmac_f32_16x16x64_bf16 v[164:167], a[76:79], v[228:235], v20 abid:1
    ds_read_b128 v[220:223], v1 offset:21504
    ds_read_b128 v[224:227], v2 offset:21504
    v_min_u32 v111, s41, v111
    v_mul_u32_u24 v114, 68, v114
    s_waitcnt vmcnt(25)
    v_cndmask_b32 v111, v118, v111, s[36:37]
    v_smfmac_f32_16x16x64_bf16 v[132:135], a[80:83], v[196:203], v21
    buffer_load_dwordx4 a[176:179], v11, s[16:19], s43 offen offset:3072 sc1
    ds_write_b64 v111, v[92:93]
    s_bcnt1_i32_b64 s30, s[36:37]
    s_lshl3_add_u32 s40, s30, s40
    v_lshl_add_u32 v112, v112, 2, s47
    v_smfmac_f32_16x16x64_bf16 v[168:171], a[80:83], v[228:235], v21
    v_and_b32 v114, 0x30c, v114
    v_cndmask_b32 v112, v118, v112, s[44:45]
    v_add3_u32 v113, v116, v114, s29
    v_and_b32 v114, 0x3fff, v92
    s_waitcnt vmcnt(25)
    v_cndmask_b32 v110, v118, v113, s[44:45]
    v_smfmac_f32_16x16x64_bf16 v[136:139], a[84:87], v[196:203], v21 abid:1
    s_add_u32 s43, s43, 4096
    buffer_load_dwordx4 v[32:35], v11, s[16:19], s43 offen offset:0 sc1
    buffer_load_dwordx4 a[180:183], v11, s[16:19], s43 offen offset:1024 sc1
    ds_write_b32 v112, v114
    ds_write_b32 v110, v93
    v_and_b32 v110, 8, v94
    v_smfmac_f32_16x16x64_bf16 v[172:175], a[84:87], v[228:235], v21 abid:1
    v_lshrrev_b32 v113, 14, v94
    v_cmp_ne_u32 s[44:45], 0, v110
    v_and_b32 v116, 0x3cf0, v113
    s_waitcnt lgkmcnt(8)
    s_waitcnt vmcnt(26)
    v_lshrrev_b32 v111, 16, v99
    v_smfmac_f32_16x16x64_bf16 v[140:143], a[88:91], v[196:203], v22
    buffer_load_dwordx4 a[184:187], v11, s[16:19], s43 offen offset:2048 sc1
    v_and_b32 v112, 0xffff, v99
    v_smfmac_f32_16x16x64_bf16 v[176:179], a[88:91], v[228:235], v22
    v_sub_u32 v110, 15, v111
    v_and_b32 v99, 2.0, v94
    v_add3_u32 v99, v112, v111, v99
    v_cndmask_b32 v110, v112, v110, s[44:45]
    s_waitcnt vmcnt(26)
    v_cmp_gt_u32 s[44:45], 16, v99
    v_smfmac_f32_16x16x64_bf16 v[144:147], a[92:95], v[196:203], v22 abid:1
    buffer_load_dwordx4 a[188:191], v11, s[16:19], s43 offen offset:3072 sc1
    v_cmp_gt_u32 s[36:37], 2.0, v99
    v_smfmac_f32_16x16x64_bf16 v[180:183], a[92:95], v[228:235], v22 abid:1
    v_lshlrev_b32 v110, 2, v110
    s_waitcnt vmcnt(26)
    v_lshrrev_b64 v[112:113], v110, s[50:51]
    v_smfmac_f32_16x16x64_bf16 v[148:151], a[96:99], v[196:203], v23
    s_add_u32 s43, s43, 4096
    buffer_load_dwordx4 a[192:195], v11, s[16:19], s43 offen offset:0 sc1
    s_andn2_b64 s[36:37], s[36:37], s[44:45]
    v_lshrrev_b64 v[114:115], v110, s[52:53]
    v_smfmac_f32_16x16x64_bf16 v[184:187], a[96:99], v[228:235], v23
    v_bfe_u32 v110, v94, 24, 4
    v_mbcnt_lo_u32_b32 v111, s36, 0
    v_and_b32 v112, 15, v112
    v_mbcnt_hi_u32_b32 v111, s37, v111
    v_and_b32 v114, 15, v114
    s_waitcnt vmcnt(26)
    v_lshl_add_u32 v111, v111, 3, s40
    v_smfmac_f32_16x16x64_bf16 v[152:155], a[100:103], v[196:203], v23 abid:1
    buffer_load_dwordx4 a[196:199], v11, s[16:19], s43 offen offset:1024 sc1
    v_lshl_add_u32 v112, v110, 4, v112
    v_smfmac_f32_16x16x64_bf16 v[188:191], a[100:103], v[228:235], v23 abid:1
    v_min_u32 v111, s41, v111
    v_mul_u32_u24 v114, 68, v114
    s_waitcnt vmcnt(26)
    v_cndmask_b32 v111, v118, v111, s[36:37]
    v_smfmac_f32_16x16x64_bf16 v[156:159], a[104:107], v[196:203], v49
    buffer_load_dwordx4 a[200:203], v11, s[16:19], s43 offen offset:2048 sc1
    ds_write_b64 v111, v[94:95]
    s_bcnt1_i32_b64 s30, s[36:37]
    s_lshl3_add_u32 s40, s30, s40
    v_lshl_add_u32 v112, v112, 2, s47
    v_smfmac_f32_16x16x64_bf16 v[192:195], a[104:107], v[228:235], v49
    v_and_b32 v114, 0x30c, v114
    v_cndmask_b32 v112, v118, v112, s[44:45]
    v_add3_u32 v113, v116, v114, s29
    v_and_b32 v114, 0x3fff, v94
    s_waitcnt vmcnt(25)
    s_waitcnt lgkmcnt(6)
    v_cndmask_b32 v110, v118, v113, s[44:45]
    v_smfmac_f32_16x16x64_bf16 v[124:127], a[108:111], v[204:211], v24
    buffer_load_dwordx4 a[204:207], v11, s[16:19], s43 offen offset:3072 sc1
    ds_write_b32 v112, v114
    ds_write_b32 v110, v95
    s_waitcnt lgkmcnt(6)
    v_lshrrev_b32 v110, 16, v117
    v_smfmac_f32_16x16x64_bf16 v[160:163], a[108:111], v[220:227], v24
    ds_read_b128 v[196:199], v1 offset:4096
    ds_read_b128 v[200:203], v2 offset:4096
    v_and_b32 v117, 0xffff, v117
    v_add_u32 v117, v117, v110
    s_waitcnt vmcnt(25)
    v_cmp_lt_u32 s[34:35], 16, v117
    v_smfmac_f32_16x16x64_bf16 v[128:131], a[112:115], v[204:211], v24 abid:1
    s_add_u32 s43, s43, 4096
    buffer_load_dwordx4 a[208:211], v11, s[16:19], s43 offen offset:0 sc1
    s_sub_u32 s46, s40, s48
    s_add_u32 s46, s46, 56
    s_lshr_b32 s46, s46, 6
    s_mov_b32 s21, 0
    s_and_b32 s27, s34, 0x1ff
    s_cmp_gt_u32 s46, 4
    s_cselect_b32 s32, 1, s32
    s_or_b32 s32, s32, s33
    s_cbranch_scc1 M_dn
M_dnr:
    ds_read_b128 v[92:95], v9 offset:9792
    s_bcnt1_i32_b32 s30, s27
    s_cmp_gt_u32 s30, 3
    s_cselect_b32 s34, 0, s27
    s_cselect_b32 s80, 0, 1
    s_getpc_b64 s[36:37]
M_pc:
    v_bfe_u32 v110, v11, 4, 4
    v_smfmac_f32_16x16x64_bf16 v[164:167], a[112:115], v[220:227], v24 abid:1
    ds_read_b128 v[228:231], v1 offset:22528
    ds_read_b128 v[232:235], v2 offset:22528
    s_waitcnt vmcnt(25)
    v_smfmac_f32_16x16x64_bf16 v[132:135], a[116:119], v[204:211], v25
    buffer_load_dwordx4 a[212:215], v11, s[16:19], s43 offen offset:1024 sc1
    s_ff1_i32_b32 s81, s34
    s_bitset0_b32 s34, s81
    s_mul_i32 s30, s81, 20
    s_add_u32 s31, s30, M_ovc0-M_pc
    s_add_u32 s30, s30, M_ovl0-M_pc
    s_cmp_lg_u32 s34, 0
    s_cselect_b32 s30, s31, s30
    s_cmp_lt_i32 s81, 0
    s_cselect_b32 s30, M_ovn-M_pc, s30
    s_add_u32 s72, s36, s30
    s_addc_u32 s73, s37, 0
    s_ff1_i32_b32 s82, s34
    s_bitset0_b32 s34, s82
    s_mul_i32 s30, s82, 20
    s_add_u32 s31, s30, M_ovc1-M_pc
    s_add_u32 s30, s30, M_ovl1-M_pc
    s_cmp_lg_u32 s34, 0
    s_cselect_b32 s30, s31, s30
    s_cmp_lt_i32 s82, 0
    s_cselect_b32 s30, M_ovn-M_pc, s30
    v_smfmac_f32_16x16x64_bf16 v[168:171], a[116:119], v[220:227], v25
    s_waitcnt vmcnt(25)
    v_smfmac_f32_16x16x64_bf16 v[136:139], a[120:123], v[204:211], v25 abid:1
    buffer_load_dwordx4 v[36:39], v11, s[16:19], s43 offen offset:2048 sc1
    buffer_load_dwordx4 a[216:219], v11, s[16:19], s43 offen offset:3072 sc1
    s_add_u32 s74, s36, s30
    s_addc_u32 s75, s37, 0
    s_ff1_i32_b32 s83, s34
    s_bitset0_b32 s34, s83
    s_mul_i32 s30, s83, 20
    s_add_u32 s31, s30, M_ovc1-M_pc
    s_add_u32 s30, s30, M_ovl2-M_pc
    s_cmp_lg_u32 s34, 0
    s_cselect_b32 s30, s31, s30
    s_cmp_lt_i32 s83, 0
    s_cselect_b32 s30, M_ovn-M_pc, s30
    s_add_u32 s76, s36, s30
    s_addc_u32 s77, s37, 0
    s_waitcnt lgkmcnt(2)
    v_lshrrev_b32 v112, 18, v92
    v_smfmac_f32_16x16x64_bf16 v[172:175], a[120:123], v[220:227], v25 abid:1
    s_waitcnt vmcnt(26)
    v_lshrrev_b32 v113, 18, v94
    v_smfmac_f32_16x16x64_bf16 v[140:143], a[124:127], v[204:211], v26
    s_add_u32 s43, s43, 4096
    buffer_load_dwordx4 a[220:223], v11, s[16:19], s43 offen offset:0 sc1
    v_and_b32 v114, 0x3fff, v92
    v_smfmac_f32_16x16x64_bf16 v[176:179], a[124:127], v[220:227], v26
    s_waitcnt vmcnt(26)
    v_and_b32 v115, 0x3fff, v94
    v_smfmac_f32_16x16x64_bf16 v[144:147], a[128:131], v[204:211], v26 abid:1
    buffer_load_dwordx4 a[224:227], v11, s[16:19], s43 offen offset:1024 sc1
    ds_write_b64 v9, v[114:115] offset:10056
    v_lshl_or_b32 v111, s81, 6, v110
    v_smfmac_f32_16x16x64_bf16 v[180:183], a[128:131], v[220:227], v26 abid:1
    v_cmp_eq_u32 s[44:45], v112, v111
    v_cmp_eq_u32 s[36:37], v113, v111
    s_nop 0
    v_cndmask_b32 v54, 0, v93, s[44:45]
    v_cndmask_b32 v55, 0, v95, s[36:37]
    v_lshl_or_b32 v111, s82, 6, v110
    s_waitcnt vmcnt(26)
    v_cmp_eq_u32 s[44:45], v112, v111
    v_smfmac_f32_16x16x64_bf16 v[148:151], a[132:135], v[204:211], v27
    buffer_load_dwordx4 a[228:231], v11, s[16:19], s43 offen offset:2048 sc1
    v_cmp_eq_u32 s[36:37], v113, v111
    v_smfmac_f32_16x16x64_bf16 v[184:187], a[132:135], v[220:227], v27
    v_cndmask_b32 v252, 0, v93, s[44:45]
    v_cndmask_b32 v253, 0, v95, s[36:37]
    v_lshl_or_b32 v111, s83, 6, v110
    v_cmp_eq_u32 s[44:45], v112, v111
    v_cmp_eq_u32 s[36:37], v113, v111
    s_nop 0
    s_waitcnt vmcnt(26)
    v_cndmask_b32 v254, 0, v93, s[44:45]
    v_smfmac_f32_16x16x64_bf16 v[152:155], a[136:139], v[204:211], v27 abid:1
    buffer_load_dwordx4 a[232:235], v11, s[16:19], s43 offen offset:3072 sc1
    v_cndmask_b32 v255, 0, v95, s[36:37]
    v_smfmac_f32_16x16x64_bf16 v[188:191], a[136:139], v[220:227], v27 abid:1
    ds_read_b128 v[236:239], v9 offset:9408
    ds_read_b64 v[216:217], v9 offset:10056
    s_waitcnt vmcnt(26)
    v_smfmac_f32_16x16x64_bf16 v[156:159], a[140:143], v[204:211], v49 abid:1
    s_add_u32 s43, s43, 4096
    buffer_load_dwordx4 a[236:239], v11, s[16:19], s43 offen offset:0 sc1
    s_waitcnt lgkmcnt(1)
    v_xad_u32 v236, v236, v3, v4
    v_smfmac_f32_16x16x64_bf16 v[192:195], a[140:143], v[220:227], v49 abid:1
    s_waitcnt vmcnt(25)
    v_xad_u32 v237, v237, v3, v4
    v_smfmac_f32_16x16x64_bf16 v[124:127], a[144:147], v[196:203], v28
    buffer_load_dwordx4 a[240:243], v11, s[16:19], s43 offen offset:1024 sc1
    ds_read2st64_b32 v[244:245], v236 offset0:0 offset1:72
    ds_read2st64_b32 v[246:247], v237 offset0:0 offset1:72
    v_xad_u32 v238, v238, v3, v4
    v_smfmac_f32_16x16x64_bf16 v[160:163], a[144:147], v[228:235], v28
    ds_read_b128 v[204:207], v1 offset:5120
    ds_read_b128 v[208:211], v2 offset:5120
    s_waitcnt vmcnt(25)
    v_xad_u32 v239, v239, v3, v4
    v_smfmac_f32_16x16x64_bf16 v[128:131], a[148:151], v[196:203], v28 abid:1
    buffer_load_dwordx4 a[244:247], v11, s[16:19], s43 offen offset:2048 sc1
    ds_read2st64_b32 v[248:249], v238 offset0:0 offset1:72
    ds_read2st64_b32 v[250:251], v239 offset0:0 offset1:72
    ds_read_b128 v[240:243], v8 offset:3072
    ds_read_b128 v[236:239], v9 offset:9280
    s_waitcnt lgkmcnt(8)
    v_xad_u32 v212, v216, v3, v4
    v_smfmac_f32_16x16x64_bf16 v[164:167], a[148:151], v[228:235], v28 abid:1
    ds_read_b128 v[220:223], v1 offset:23552
    ds_read_b128 v[224:227], v2 offset:23552
    ds_read2st64_b32 v[212:213], v212 offset0:0 offset1:72
    s_waitcnt vmcnt(25)
    v_xad_u32 v214, v217, v3, v4
    v_smfmac_f32_16x16x64_bf16 v[132:135], a[152:155], v[196:203], v29
    buffer_load_dwordx4 a[248:251], v11, s[16:19], s43 offen offset:3072 sc1
    ds_read2st64_b32 v[214:215], v214 offset0:0 offset1:72
    v_smfmac_f32_16x16x64_bf16 v[168:171], a[152:155], v[228:235], v29
    s_waitcnt vmcnt(25)
    v_smfmac_f32_16x16x64_bf16 v[136:139], a[156:159], v[196:203], v29 abid:1
    s_add_u32 s43, s43, 4096
    buffer_load_dwordx4 v[40:43], v11, s[16:19], s43 offen offset:0 sc1
    buffer_load_dwordx4 a[252:255], v11, s[16:19], s43 offen offset:1024 sc1
    v_smfmac_f32_16x16x64_bf16 v[172:175], a[156:159], v[228:235], v29 abid:1
    s_waitcnt vmcnt(26)
    v_smfmac_f32_16x16x64_bf16 v[140:143], a[160:163], v[196:203], v30
    buffer_load_dwordx4 v[56:59], v11, s[16:19], s43 offen offset:2048 sc1
    s_waitcnt lgkmcnt(5)
    v_smfmac_f32_16x16x64_bf16 v[136:139], v[240:243], v[244:251], v10
    v_smfmac_f32_16x16x64_bf16 v[172:175], v[240:243], v[244:251], v10 abid:1
    s_waitcnt lgkmcnt(4)
    v_xad_u32 v236, v236, v3, v4
    v_smfmac_f32_16x16x64_bf16 v[176:179], a[160:163], v[228:235], v30
    s_waitcnt vmcnt(26)
    v_xad_u32 v237, v237, v3, v4
    v_smfmac_f32_16x16x64_bf16 v[144:147], a[164:167], v[196:203], v30 abid:1
    buffer_load_dwordx4 v[60:63], v11, s[16:19], s43 offen offset:3072 sc1
    ds_read2st64_b32 v[244:245], v236 offset0:0 offset1:72
    ds_read2st64_b32 v[246:247], v237 offset0:0 offset1:72
    v_xad_u32 v238, v238, v3, v4
    v_smfmac_f32_16x16x64_bf16 v[180:183], a[164:167], v[228:235], v30 abid:1
    s_waitcnt vmcnt(26)
    v_xad_u32 v239, v239, v3, v4
    v_smfmac_f32_16x16x64_bf16 v[148:151], a[168:171], v[196:203], v31
    s_add_u32 s43, s43, 4096
    buffer_load_dwordx4 v[64:67], v11, s[16:19], s43 offen offset:0 sc1
    ds_read2st64_b32 v[248:249], v238 offset0:0 offset1:72
    ds_read2st64_b32 v[250:251], v239 offset0:0 offset1:72
    ds_read_b128 v[240:243], v8 offset:1024
    ds_read_b128 v[236:239], v9 offset:9344
    v_smfmac_f32_16x16x64_bf16 v[184:187], a[168:171], v[228:235], v31
    s_waitcnt vmcnt(26)
    v_smfmac_f32_16x16x64_bf16 v[152:155], a[172:175], v[196:203], v31 abid:1
    buffer_load_dwordx4 v[68:71], v11, s[16:19], s43 offen offset:1024 sc1
    s_waitcnt lgkmcnt(6)
    s_cmp_lt_i32 s81, 0
    s_cbranch_scc1 M_ovr0
    s_swappc_b64 s[78:79], s[72:73]
M_ovr0:
    v_smfmac_f32_16x16x64_bf16 v[188:191], a[172:175], v[228:235], v31 abid:1
    s_waitcnt vmcnt(26)
    v_smfmac_f32_16x16x64_bf16 v[156:159], a[176:179], v[196:203], v50
    buffer_load_dwordx4 v[72:75], v11, s[16:19], s43 offen offset:2048 sc1
    v_smfmac_f32_16x16x64_bf16 v[192:195], a[176:179], v[228:235], v50
    s_waitcnt vmcnt(25)
    v_smfmac_f32_16x16x64_bf16 v[124:127], a[180:183], v[204:211], v32
    buffer_load_dwordx4 v[76:79], v11, s[16:19], s43 offen offset:3072 sc1
    s_waitcnt lgkmcnt(1)
    v_smfmac_f32_16x16x64_bf16 v[128:131], v[240:243], v[244:251], v10
    v_smfmac_f32_16x16x64_bf16 v[164:167], v[240:243], v[244:251], v10 abid:1
    s_waitcnt lgkmcnt(0)
    v_xad_u32 v236, v236, v3, v4
    v_smfmac_f32_16x16x64_bf16 v[160:163], a[180:183], v[220:227], v32
    ds_read_b128 v[196:199], v1 offset:6144
    ds_read_b128 v[200:203], v2 offset:6144
    s_waitcnt vmcnt(25)
    v_xad_u32 v237, v237, v3, v4
    v_smfmac_f32_16x16x64_bf16 v[128:131], a[184:187], v[204:211], v32 abid:1
    s_add_u32 s43, s43, 4096
    buffer_load_dwordx4 v[80:83], v11, s[16:19], s43 offen offset:0 sc1
    ds_read2st64_b32 v[244:245], v236 offset0:0 offset1:72
    ds_read2st64_b32 v[246:247], v237 offset0:0 offset1:72
    v_xad_u32 v238, v238, v3, v4
    v_smfmac_f32_16x16x64_bf16 v[164:167], a[184:187], v[220:227], v32 abid:1
    ds_read_b128 v[228:231], v1 offset:24576
    ds_read_b128 v[232:235], v2 offset:24576
    s_waitcnt vmcnt(25)
    v_xad_u32 v239, v239, v3, v4
    v_smfmac_f32_16x16x64_bf16 v[132:135], a[188:191], v[204:211], v33
    buffer_load_dwordx4 v[84:87], v11, s[16:19], s43 offen offset:1024 sc1
    ds_read2st64_b32 v[248:249], v238 offset0:0 offset1:72
    ds_read2st64_b32 v[250:251], v239 offset0:0 offset1:72
    ds_read_b128 v[240:243], v8 offset:2048
    ds_read_b128 v[236:239], v9 offset:9216
    v_smfmac_f32_16x16x64_bf16 v[168:171], a[188:191], v[220:227], v33
    s_waitcnt vmcnt(25)
    v_smfmac_f32_16x16x64_bf16 v[136:139], a[192:195], v[204:211], v33 abid:1
    buffer_load_dwordx4 v[44:47], v11, s[16:19], s43 offen offset:2048 sc1
    buffer_load_dwordx4 v[88:91], v11, s[16:19], s43 offen offset:3072 sc1
    v_smfmac_f32_16x16x64_bf16 v[172:175], a[192:195], v[220:227], v33 abid:1
    s_waitcnt vmcnt(26)
    v_smfmac_f32_16x16x64_bf16 v[140:143], a[196:199], v[204:211], v34
    s_add_u32 s43, s43, 4096
    buffer_load_dwordx4 v[92:95], v11, s[16:19], s43 offen offset:0 sc1
    v_smfmac_f32_16x16x64_bf16 v[176:179], a[196:199], v[220:227], v34
    s_waitcnt vmcnt(26)
    v_smfmac_f32_16x16x64_bf16 v[144:147], a[200:203], v[204:211], v34 abid:1
    buffer_load_dwordx4 v[96:99], v11, s[16:19], s43 offen offset:1024 sc1
    s_waitcnt lgkmcnt(1)
    v_smfmac_f32_16x16x64_bf16 v[132:135], v[240:243], v[244:251], v10
    v_smfmac_f32_16x16x64_bf16 v[168:171], v[240:243], v[244:251], v10 abid:1
    s_waitcnt lgkmcnt(0)
    v_xad_u32 v236, v236, v3, v4
    v_smfmac_f32_16x16x64_bf16 v[180:183], a[200:203], v[220:227], v34 abid:1
    s_waitcnt vmcnt(26)
    v_xad_u32 v237, v237, v3, v4
    v_smfmac_f32_16x16x64_bf16 v[148:151], a[204:207], v[204:211], v35
    buffer_load_dwordx4 v[100:103], v11, s[16:19], s43 offen offset:2048 sc1
    ds_read2st64_b32 v[244:245], v236 offset0:0 offset1:72
    ds_read2st64_b32 v[246:247], v237 offset0:0 offset1:72
    v_xad_u32 v238, v238, v3, v4
    v_smfmac_f32_16x16x64_bf16 v[184:187], a[204:207], v[220:227], v35
    s_waitcnt vmcnt(26)
    v_xad_u32 v239, v239, v3, v4
    v_smfmac_f32_16x16x64_bf16 v[152:155], a[208:211], v[204:211], v35 abid:1
    buffer_load_dwordx4 v[104:107], v11, s[16:19], s43 offen offset:3072 sc1
    ds_read2st64_b32 v[248:249], v238 offset0:0 offset1:72
    ds_read2st64_b32 v[250:251], v239 offset0:0 offset1:72
    ds_read_b128 v[240:243], v8 offset:0
    ds_read_b128 v[236:239], v9 offset:9728
    v_smfmac_f32_16x16x64_bf16 v[188:191], a[208:211], v[220:227], v35 abid:1
    s_waitcnt vmcnt(26)
    v_smfmac_f32_16x16x64_bf16 v[156:159], a[212:215], v[204:211], v50 abid:1
    s_add_u32 s43, s43, 4096
    buffer_load_dwordx4 v[108:111], v11, s[16:19], s43 offen offset:0 sc1
    v_smfmac_f32_16x16x64_bf16 v[192:195], a[212:215], v[220:227], v50 abid:1
    s_waitcnt vmcnt(25)
    v_smfmac_f32_16x16x64_bf16 v[124:127], a[216:219], v[196:203], v36
    buffer_load_dwordx4 v[112:115], v11, s[16:19], s43 offen offset:1024 sc1
    v_smfmac_f32_16x16x64_bf16 v[160:163], a[216:219], v[228:235], v36
    ds_read_b128 v[204:207], v1 offset:7168
    ds_read_b128 v[208:211], v2 offset:7168
    s_waitcnt vmcnt(25)
    v_smfmac_f32_16x16x64_bf16 v[128:131], a[220:223], v[196:203], v36 abid:1
    buffer_load_dwordx4 v[116:119], v11, s[16:19], s43 offen offset:2048 sc1
    s_waitcnt lgkmcnt(3)
    v_smfmac_f32_16x16x64_bf16 v[124:127], v[240:243], v[244:251], v10
    v_smfmac_f32_16x16x64_bf16 v[160:163], v[240:243], v[244:251], v10 abid:1
    s_waitcnt lgkmcnt(2)
    v_xad_u32 v236, v236, v3, v4
    v_smfmac_f32_16x16x64_bf16 v[164:167], a[220:223], v[228:235], v36 abid:1
    ds_read_b128 v[220:223], v1 offset:25600
    ds_read_b128 v[224:227], v2 offset:25600
    s_waitcnt vmcnt(25)
    v_xad_u32 v237, v237, v3, v4
    v_smfmac_f32_16x16x64_bf16 v[132:135], a[224:227], v[196:203], v37
    buffer_load_dwordx4 v[120:123], v11, s[16:19], s43 offen offset:3072 sc1
    ds_read2st64_b32 v[244:245], v236 offset0:0 offset1:72
    ds_read2st64_b32 v[246:247], v237 offset0:0 offset1:72
    v_xad_u32 v238, v238, v3, v4
    v_smfmac_f32_16x16x64_bf16 v[168:171], a[224:227], v[228:235], v37
    s_waitcnt vmcnt(25)
    v_xad_u32 v239, v239, v3, v4
    v_smfmac_f32_16x16x64_bf16 v[136:139], a[228:231], v[196:203], v37 abid:1
    s_add_u32 m0, s29, 11840
    s_nop 0
    buffer_load_dword v0, s[8:11], 0 offen lds
    s_mov_b32 m0, s42
    s_nop 0
    buffer_load_dwordx4 v5, s[8:11], s22 offen offset:0 nt lds
    ds_read2st64_b32 v[248:249], v238 offset0:0 offset1:72
    ds_read2st64_b32 v[250:251], v239 offset0:0 offset1:72
    ds_read_b128 v[240:243], v8 offset:8192
    ds_read_b128 v[236:239], v9 offset:9664
    v_smfmac_f32_16x16x64_bf16 v[172:175], a[228:231], v[228:235], v37 abid:1
    s_waitcnt vmcnt(26)
    v_smfmac_f32_16x16x64_bf16 v[140:143], a[232:235], v[196:203], v38
    s_add_u32 m0, m0, 896
    s_nop 0
    buffer_load_dwordx4 v5, s[8:11], s22 offen offset:128 nt lds
    v_smfmac_f32_16x16x64_bf16 v[176:179], a[232:235], v[228:235], v38
    s_waitcnt vmcnt(26)
    v_smfmac_f32_16x16x64_bf16 v[144:147], a[236:239], v[196:203], v38 abid:1
    s_add_u32 m0, m0, 896
    s_nop 0
    buffer_load_dwordx4 v5, s[8:11], s22 offen offset:256 nt lds
    v_smfmac_f32_16x16x64_bf16 v[180:183], a[236:239], v[228:235], v38 abid:1
    s_waitcnt vmcnt(26)
    v_smfmac_f32_16x16x64_bf16 v[148:151], a[240:243], v[196:203], v39
    s_add_u32 m0, m0, 896
    s_nop 0
    buffer_load_dwordx4 v5, s[8:11], s22 offen offset:384 nt lds
    s_waitcnt lgkmcnt(1)
    v_smfmac_f32_16x16x64_bf16 v[156:159], v[240:243], v[244:251], v10
    v_smfmac_f32_16x16x64_bf16 v[192:195], v[240:243], v[244:251], v10 abid:1
    s_waitcnt lgkmcnt(0)
    v_xad_u32 v236, v236, v3, v4
    v_smfmac_f32_16x16x64_bf16 v[184:187], a[240:243], v[228:235], v39
    s_waitcnt vmcnt(26)
    v_xad_u32 v237, v237, v3, v4
    v_smfmac_f32_16x16x64_bf16 v[152:155], a[244:247], v[196:203], v39 abid:1
    ds_read2st64_b32 v[244:245], v236 offset0:0 offset1:72
    ds_read2st64_b32 v[246:247], v237 offset0:0 offset1:72
    v_xad_u32 v238, v238, v3, v4
    v_smfmac_f32_16x16x64_bf16 v[188:191], a[244:247], v[228:235], v39 abid:1
    s_waitcnt vmcnt(25)
    v_xad_u32 v239, v239, v3, v4
    v_smfmac_f32_16x16x64_bf16 v[156:159], a[248:251], v[196:203], v51
    ds_read2st64_b32 v[248:249], v238 offset0:0 offset1:72
    ds_read2st64_b32 v[250:251], v239 offset0:0 offset1:72
    ds_read_b128 v[240:243], v8 offset:7168
    ds_read_b128 v[236:239], v9 offset:9536
    v_smfmac_f32_16x16x64_bf16 v[192:195], a[248:251], v[228:235], v51
    s_waitcnt vmcnt(23)
    v_smfmac_f32_16x16x64_bf16 v[124:127], a[252:255], v[204:211], v40
    ds_read_b128 v[196:199], v1 offset:8192
    ds_read_b128 v[200:203], v2 offset:8192
    s_waitcnt vmcnt(22)
    v_smfmac_f32_16x16x64_bf16 v[128:131], v[56:59], v[204:211], v40 abid:1
    ds_read_b128 v[228:231], v1 offset:26624
    ds_read_b128 v[232:235], v2 offset:26624
    s_waitcnt vmcnt(21)
    v_smfmac_f32_16x16x64_bf16 v[132:135], v[60:63], v[204:211], v41
    s_waitcnt lgkmcnt(5)
    v_smfmac_f32_16x16x64_bf16 v[152:155], v[240:243], v[244:251], v10
    v_smfmac_f32_16x16x64_bf16 v[188:191], v[240:243], v[244:251], v10 abid:1
    s_waitcnt lgkmcnt(4)
    v_xad_u32 v236, v236, v3, v4
    s_waitcnt vmcnt(20)
    v_xad_u32 v237, v237, v3, v4
    v_smfmac_f32_16x16x64_bf16 v[136:139], v[64:67], v[204:211], v41 abid:1
    ds_read2st64_b32 v[244:245], v236 offset0:0 offset1:72
    ds_read2st64_b32 v[246:247], v237 offset0:0 offset1:72
    v_xad_u32 v238, v238, v3, v4
    s_waitcnt vmcnt(19)
    v_xad_u32 v239, v239, v3, v4
    v_smfmac_f32_16x16x64_bf16 v[140:143], v[68:71], v[204:211], v42
    ds_read2st64_b32 v[248:249], v238 offset0:0 offset1:72
    ds_read2st64_b32 v[250:251], v239 offset0:0 offset1:72
    ds_read_b128 v[240:243], v8 offset:5120
    ds_read_b128 v[236:239], v9 offset:9600
    s_waitcnt vmcnt(18)
    v_smfmac_f32_16x16x64_bf16 v[144:147], v[72:75], v[204:211], v42 abid:1
    s_waitcnt vmcnt(17)
    v_smfmac_f32_16x16x64_bf16 v[148:151], v[76:79], v[204:211], v43
    s_waitcnt vmcnt(16)
    v_smfmac_f32_16x16x64_bf16 v[152:155], v[80:83], v[204:211], v43 abid:1
    s_waitcnt lgkmcnt(1)
    v_smfmac_f32_16x16x64_bf16 v[144:147], v[240:243], v[244:251], v10
    v_smfmac_f32_16x16x64_bf16 v[180:183], v[240:243], v[244:251], v10 abid:1
    s_waitcnt lgkmcnt(0)
    v_xad_u32 v236, v236, v3, v4
    s_waitcnt vmcnt(15)
    v_xad_u32 v237, v237, v3, v4
    v_smfmac_f32_16x16x64_bf16 v[156:159], v[84:87], v[204:211], v51 abid:1
    ds_read2st64_b32 v[244:245], v236 offset0:0 offset1:72
    ds_read2st64_b32 v[246:247], v237 offset0:0 offset1:72
    v_xad_u32 v238, v238, v3, v4
    s_waitcnt vmcnt(13)
    v_xad_u32 v239, v239, v3, v4
    v_smfmac_f32_16x16x64_bf16 v[124:127], v[88:91], v[196:203], v44
    ds_read2st64_b32 v[248:249], v238 offset0:0 offset1:72
    ds_read2st64_b32 v[250:251], v239 offset0:0 offset1:72
    ds_read_b128 v[240:243], v8 offset:6144
    ds_read_b128 v[236:239], v9 offset:9472
    s_waitcnt vmcnt(12)
    v_smfmac_f32_16x16x64_bf16 v[128:131], v[92:95], v[196:203], v44 abid:1
    s_waitcnt vmcnt(11)
    v_smfmac_f32_16x16x64_bf16 v[132:135], v[96:99], v[196:203], v45
    s_waitcnt vmcnt(10)
    v_smfmac_f32_16x16x64_bf16 v[136:139], v[100:103], v[196:203], v45 abid:1
    s_waitcnt lgkmcnt(1)
    v_smfmac_f32_16x16x64_bf16 v[148:151], v[240:243], v[244:251], v10
    v_smfmac_f32_16x16x64_bf16 v[184:187], v[240:243], v[244:251], v10 abid:1
    s_waitcnt lgkmcnt(0)
    v_xad_u32 v236, v236, v3, v4
    s_waitcnt vmcnt(9)
    v_xad_u32 v237, v237, v3, v4
    v_smfmac_f32_16x16x64_bf16 v[140:143], v[104:107], v[196:203], v46
    ds_read2st64_b32 v[244:245], v236 offset0:0 offset1:72
    ds_read2st64_b32 v[246:247], v237 offset0:0 offset1:72
    v_xad_u32 v238, v238, v3, v4
    s_waitcnt vmcnt(8)
    v_xad_u32 v239, v239, v3, v4
    v_smfmac_f32_16x16x64_bf16 v[144:147], v[108:111], v[196:203], v46 abid:1
    ds_read2st64_b32 v[248:249], v238 offset0:0 offset1:72
    ds_read2st64_b32 v[250:251], v239 offset0:0 offset1:72
    ds_read_b128 v[240:243], v8 offset:4096
    s_waitcnt vmcnt(7)
    v_smfmac_f32_16x16x64_bf16 v[148:151], v[112:115], v[196:203], v47
    s_waitcnt vmcnt(6)
    v_smfmac_f32_16x16x64_bf16 v[152:155], v[116:119], v[196:203], v47 abid:1
    s_waitcnt vmcnt(5)
    v_smfmac_f32_16x16x64_bf16 v[156:159], v[120:123], v[196:203], v52
    s_waitcnt lgkmcnt(0)
    v_smfmac_f32_16x16x64_bf16 v[140:143], v[240:243], v[244:251], v10
    v_smfmac_f32_16x16x64_bf16 v[176:179], v[240:243], v[244:251], v10 abid:1
    s_cmp_gt_u32 s46, s80
    s_cbranch_scc1 M_slow
M_slowr0:
    s_cmp_eq_u32 s20, 0
    s_mov_b32 s31, 1073903880
    s_cselect_b32 s30, 162048, s31
    v_mov_b32 v11, s31
    v_writelane_b32 v11, s30, 0
    v_cvt_pk_bf16_f32 v124, v124, v125
    v_cvt_pk_bf16_f32 v125, v126, v127
    v_cvt_pk_bf16_f32 v126, v128, v129
    v_cvt_pk_bf16_f32 v127, v130, v131
    v_cvt_pk_bf16_f32 v132, v132, v133
    v_cvt_pk_bf16_f32 v133, v134, v135
    v_cvt_pk_bf16_f32 v134, v136, v137
    v_cvt_pk_bf16_f32 v135, v138, v139
    ds_read_b128 v[136:139], v9 offset:10432
    v_cndmask_b32_dpp v128, v124, v132, vcc row_ror:8 row_mask:0xf bank_mask:0xf
    v_cndmask_b32_dpp v129, v125, v133, vcc row_ror:8 row_mask:0xf bank_mask:0xf
    v_cndmask_b32_dpp v130, v126, v134, vcc row_ror:8 row_mask:0xf bank_mask:0xf
    v_cndmask_b32_dpp v131, v127, v135, vcc row_ror:8 row_mask:0xf bank_mask:0xf
    buffer_store_dwordx4 v[128:131], v6, s[12:15], s59 offen offset:0 sc1
    v_mov_b32_dpp v124, v132 row_ror:8 row_mask:0xf bank_mask:0xc
    v_mov_b32_dpp v125, v133 row_ror:8 row_mask:0xf bank_mask:0xc
    v_mov_b32_dpp v126, v134 row_ror:8 row_mask:0xf bank_mask:0xc
    v_mov_b32_dpp v127, v135 row_ror:8 row_mask:0xf bank_mask:0xc
    buffer_store_dwordx4 v[124:127], v6, s[12:15], s24 offen offset:0 sc1
    ds_read_b128 v[128:131], v9 offset:10304
    ds_read_b128 v[132:135], v9 offset:10368
    ds_read_b128 v[124:127], v9 offset:10240
    v_cvt_pk_bf16_f32 v140, v140, v141
    v_cvt_pk_bf16_f32 v141, v142, v143
    v_cvt_pk_bf16_f32 v142, v144, v145
    v_cvt_pk_bf16_f32 v143, v146, v147
    v_cvt_pk_bf16_f32 v148, v148, v149
    v_cvt_pk_bf16_f32 v149, v150, v151
    v_cvt_pk_bf16_f32 v150, v152, v153
    v_cvt_pk_bf16_f32 v151, v154, v155
    ds_read_b128 v[152:155], v9 offset:10688
    v_cndmask_b32_dpp v144, v140, v148, vcc row_ror:8 row_mask:0xf bank_mask:0xf
    v_cndmask_b32_dpp v145, v141, v149, vcc row_ror:8 row_mask:0xf bank_mask:0xf
    v_cndmask_b32_dpp v146, v142, v150, vcc row_ror:8 row_mask:0xf bank_mask:0xf
    v_cndmask_b32_dpp v147, v143, v151, vcc row_ror:8 row_mask:0xf bank_mask:0xf
    buffer_store_dwordx4 v[144:147], v6, s[12:15], s59 offen offset:128 sc1
    v_mov_b32_dpp v140, v148 row_ror:8 row_mask:0xf bank_mask:0xc
    v_mov_b32_dpp v141, v149 row_ror:8 row_mask:0xf bank_mask:0xc
    v_mov_b32_dpp v142, v150 row_ror:8 row_mask:0xf bank_mask:0xc
    v_mov_b32_dpp v143, v151 row_ror:8 row_mask:0xf bank_mask:0xc
    buffer_store_dwordx4 v[140:143], v6, s[12:15], s24 offen offset:128 sc1
    ds_read_b128 v[144:147], v9 offset:10560
    ds_read_b128 v[148:151], v9 offset:10624
    ds_read_b128 v[140:143], v9 offset:10496
    v_cvt_pk_bf16_f32 v156, v156, v157
    v_cvt_pk_bf16_f32 v157, v158, v159
    ds_write_b64 v53, v[156:157] offset:25728
    ds_read_b128 v[156:159], v9 offset:10752
    s_mov_b32 s89, 0
    s_mov_b32 s101, 34209792
    s_mov_b32 s91, 0
    s_mov_b32 s25, 36864
    s_add_u32 s90, s24, 9437184
    s_mov_b32 s28, s26
    s_add_u32 s23, s24, 18432
    s_cmp_lt_u32 s20, 2
    s_cselect_b32 s66, s23, s24
    s_cselect_b32 s99, s14, 75497472
    s_add_u32 s66, s66, s95
    v_add_u32 v4, 36864, v4
    v_add_u32 v1, 36864, v1
    v_add_u32 v2, 36864, v2
M_top:
M_top1:
    s_add_u32 s23, s24, 18432
    s_add_u32 s58, s24, 27648
    s_mov_b32 s24, s90
    s_add_u32 s59, s90, 9216
    s_waitcnt lgkmcnt(0)
    s_barrier
    ds_read_b128 v[244:247], v8 offset:10816
    v_smfmac_f32_16x16x64_bf16 v[160:163], a[252:255], v[220:227], v40
    ds_read_b128 v[196:199], v1 offset:0
    v_smfmac_f32_16x16x64_bf16 v[160:163], v[88:91], v[228:235], v44
    ds_read_b128 v[200:203], v2 offset:0
    s_cmp_lt_u32 s22, 75497472
    s_cbranch_scc0 M_bF
    s_cmp_eq_u32 s91, 1
    s_cbranch_scc1 M_bE0
M_bL:
    v_smfmac_f32_16x16x64_bf16 v[164:167], v[56:59], v[220:227], v40 abid:1
    ds_read_b128 v[204:207], v1 offset:1024
    v_smfmac_f32_16x16x64_bf16 v[164:167], v[92:95], v[228:235], v44 abid:1
    ds_read_b128 v[208:211], v2 offset:1024
    v_mov_b32 v0, 1
    v_smfmac_f32_16x16x64_bf16 v[168:171], v[60:63], v[220:227], v41
    ds_read_b128 v[212:215], v1 offset:2048
    v_smfmac_f32_16x16x64_bf16 v[168:171], v[96:99], v[228:235], v45
    ds_read_b128 v[216:219], v2 offset:2048
    v_smfmac_f32_16x16x64_bf16 v[172:175], v[64:67], v[220:227], v41 abid:1
    s_waitcnt vmcnt(6)
    s_waitcnt lgkmcnt(6)
    buffer_store_dwordx4 v[244:247], v7, s[12:15], s66 offen sc1
    v_smfmac_f32_16x16x64_bf16 v[172:175], v[100:103], v[228:235], v45 abid:1
    ds_read_b128 v[236:239], v9 offset:9408
    v_smfmac_f32_16x16x64_bf16 v[176:179], v[68:71], v[220:227], v42
    s_waitcnt vmcnt(6)
    buffer_atomic_add v0, v11, s[16:19], s92 offen sc0 sc1
    s_mov_b32 s21, 1
    v_smfmac_f32_16x16x64_bf16 v[176:179], v[104:107], v[228:235], v46
    v_smfmac_f32_16x16x64_bf16 v[180:183], v[72:75], v[220:227], v42 abid:1
    v_cvt_pk_bf16_f32 v160, v160, v161
    v_smfmac_f32_16x16x64_bf16 v[180:183], v[108:111], v[228:235], v46 abid:1
    v_cvt_pk_bf16_f32 v161, v162, v163
    v_smfmac_f32_16x16x64_bf16 v[184:187], v[76:79], v[220:227], v43
    v_cvt_pk_bf16_f32 v162, v164, v165
    v_smfmac_f32_16x16x64_bf16 v[184:187], v[112:115], v[228:235], v47
    v_cvt_pk_bf16_f32 v163, v166, v167
    v_smfmac_f32_16x16x64_bf16 v[188:191], v[80:83], v[220:227], v43 abid:1
    s_add_u32 m0, m0, 896
    v_cvt_pk_bf16_f32 v168, v168, v169
    v_smfmac_f32_16x16x64_bf16 v[188:191], v[116:119], v[228:235], v47 abid:1
    s_waitcnt vmcnt(6)
    buffer_load_dwordx4 v5, s[8:11], s22 offen offset:512 nt lds
    v_cvt_pk_bf16_f32 v169, v170, v171
    v_smfmac_f32_16x16x64_bf16 v[192:195], v[84:87], v[220:227], v51 abid:1
    v_cvt_pk_bf16_f32 v170, v172, v173
    v_smfmac_f32_16x16x64_bf16 v[192:195], v[120:123], v[228:235], v52
    ds_read_b128 v[220:223], v1 offset:3072
    s_waitcnt lgkmcnt(6)
    v_cvt_pk_bf16_f32 v171, v174, v175
    v_smfmac_f32_16x16x64_bf16 v[124:127], a[0:3], v[196:203], v12
    ds_read_b128 v[224:227], v2 offset:3072
    ds_read_b128 v[172:175], v9 offset:10432
    s_waitcnt lgkmcnt(6)
    v_cndmask_b32_dpp v164, v160, v168, vcc row_ror:8 row_mask:0xf bank_mask:0xf
    v_smfmac_f32_16x16x64_bf16 v[124:127], a[36:39], v[204:211], v16
    ds_read_b128 v[228:231], v1 offset:4096
    s_waitcnt lgkmcnt(5)
    v_cndmask_b32_dpp v165, v161, v169, vcc row_ror:8 row_mask:0xf bank_mask:0xf
    v_smfmac_f32_16x16x64_bf16 v[124:127], a[72:75], v[212:219], v20
    ds_read_b128 v[232:235], v2 offset:4096
    v_cndmask_b32_dpp v166, v162, v170, vcc row_ror:8 row_mask:0xf bank_mask:0xf
    v_smfmac_f32_16x16x64_bf16 v[128:131], a[4:7], v[196:203], v12 abid:1
    s_barrier
    v_cndmask_b32_dpp v167, v163, v171, vcc row_ror:8 row_mask:0xf bank_mask:0xf
    v_smfmac_f32_16x16x64_bf16 v[128:131], a[40:43], v[204:211], v16 abid:1
    s_waitcnt vmcnt(6)
    buffer_store_dwordx4 v[164:167], v6, s[12:15], s58 offen offset:0 sc1
    s_waitcnt lgkmcnt(5)
    v_xad_u32 v236, v236, v3, v4
    v_smfmac_f32_16x16x64_bf16 v[128:131], a[76:79], v[212:219], v20 abid:1
    v_xad_u32 v237, v237, v3, v4
    v_smfmac_f32_16x16x64_bf16 v[132:135], a[8:11], v[196:203], v13
    ds_read2st64_b32 v[244:245], v236 offset0:0 offset1:72
    ds_read_b128 v[240:243], v8 offset:3072
    v_xad_u32 v238, v238, v3, v4
    v_smfmac_f32_16x16x64_bf16 v[132:135], a[44:47], v[204:211], v17
    ds_read2st64_b32 v[246:247], v237 offset0:0 offset1:72
    v_xad_u32 v239, v239, v3, v4
    v_smfmac_f32_16x16x64_bf16 v[132:135], a[80:83], v[212:219], v21
    ds_read2st64_b32 v[248:249], v238 offset0:0 offset1:72
    v_mov_b32_dpp v160, v168 row_ror:8 row_mask:0xf bank_mask:0xc
    v_smfmac_f32_16x16x64_bf16 v[144:147], a[20:23], v[196:203], v14 abid:1
    ds_read2st64_b32 v[250:251], v239 offset0:0 offset1:72
    ds_read_b128 v[236:239], v9 offset:9280
    v_mov_b32_dpp v161, v169 row_ror:8 row_mask:0xf bank_mask:0xc
    v_smfmac_f32_16x16x64_bf16 v[144:147], a[56:59], v[204:211], v18 abid:1
    v_mov_b32_dpp v162, v170 row_ror:8 row_mask:0xf bank_mask:0xc
    v_smfmac_f32_16x16x64_bf16 v[144:147], a[92:95], v[212:219], v22 abid:1
    v_mov_b32_dpp v163, v171 row_ror:8 row_mask:0xf bank_mask:0xc
    v_smfmac_f32_16x16x64_bf16 v[140:143], a[16:19], v[196:203], v14
    s_waitcnt vmcnt(6)
    buffer_store_dwordx4 v[160:163], v6, s[12:15], s23 offen offset:0 sc1
    ds_read_b128 v[164:167], v9 offset:10304
    v_smfmac_f32_16x16x64_bf16 v[140:143], a[52:55], v[204:211], v18
    ds_read_b128 v[168:171], v9 offset:10368
    ds_read_b128 v[160:163], v9 offset:10240
    v_smfmac_f32_16x16x64_bf16 v[140:143], a[88:91], v[212:219], v22
    v_smfmac_f32_16x16x64_bf16 v[136:139], a[12:15], v[196:203], v13 abid:1
    v_smfmac_f32_16x16x64_bf16 v[136:139], a[48:51], v[204:211], v17 abid:1
    v_smfmac_f32_16x16x64_bf16 v[136:139], a[84:87], v[212:219], v21 abid:1
    s_waitcnt lgkmcnt(3)
    v_xad_u32 v236, v236, v3, v4
    v_smfmac_f32_16x16x64_bf16 v[136:139], v[240:243], v[244:251], v10
    v_xad_u32 v237, v237, v3, v4
    v_smfmac_f32_16x16x64_bf16 v[172:175], v[240:243], v[244:251], v10 abid:1
    ds_read2st64_b32 v[244:245], v236 offset0:0 offset1:72
    ds_read_b128 v[240:243], v8 offset:1024
    v_xad_u32 v238, v238, v3, v4
    v_smfmac_f32_16x16x64_bf16 v[148:151], a[24:27], v[196:203], v15
    ds_read2st64_b32 v[246:247], v237 offset0:0 offset1:72
    v_xad_u32 v239, v239, v3, v4
    v_smfmac_f32_16x16x64_bf16 v[148:151], a[60:63], v[204:211], v19
    ds_read2st64_b32 v[248:249], v238 offset0:0 offset1:72
    v_cvt_pk_bf16_f32 v192, v192, v193
    v_smfmac_f32_16x16x64_bf16 v[148:151], a[96:99], v[212:219], v23
    ds_read2st64_b32 v[250:251], v239 offset0:0 offset1:72
    ds_read_b128 v[236:239], v9 offset:9344
    v_cvt_pk_bf16_f32 v193, v194, v195
    v_smfmac_f32_16x16x64_bf16 v[152:155], a[28:31], v[196:203], v15 abid:1
    ds_write_b64 v53, v[192:193] offset:0
    ds_read_b128 v[192:195], v9 offset:10752
    v_smfmac_f32_16x16x64_bf16 v[152:155], a[64:67], v[204:211], v19 abid:1
    s_add_u32 m0, m0, 896
    v_smfmac_f32_16x16x64_bf16 v[152:155], a[100:103], v[212:219], v23 abid:1
    s_waitcnt vmcnt(6)
    buffer_load_dwordx4 v5, s[8:11], s22 offen offset:640 nt lds
    v_smfmac_f32_16x16x64_bf16 v[156:159], a[32:35], v[196:203], v48
    v_smfmac_f32_16x16x64_bf16 v[156:159], a[68:71], v[204:211], v48 abid:1
    v_smfmac_f32_16x16x64_bf16 v[156:159], a[104:107], v[212:219], v49
    ds_read_b128 v[196:199], v1 offset:5120
    v_cvt_pk_bf16_f32 v176, v176, v177
    v_smfmac_f32_16x16x64_bf16 v[124:127], a[108:111], v[220:227], v24
    ds_read_b128 v[200:203], v2 offset:5120
    v_cvt_pk_bf16_f32 v177, v178, v179
    v_smfmac_f32_16x16x64_bf16 v[124:127], a[144:147], v[228:235], v28
    ds_read_b128 v[204:207], v1 offset:6144
    ds_read_b64 v[216:217], v9 offset:10056
    v_cvt_pk_bf16_f32 v178, v180, v181
    v_smfmac_f32_16x16x64_bf16 v[128:131], a[112:115], v[220:227], v24 abid:1
    ds_read_b128 v[208:211], v2 offset:6144
    v_cvt_pk_bf16_f32 v179, v182, v183
    v_smfmac_f32_16x16x64_bf16 v[128:131], a[148:151], v[228:235], v28 abid:1
    s_waitcnt lgkmcnt(7)
    v_xad_u32 v236, v236, v3, v4
    v_smfmac_f32_16x16x64_bf16 v[128:131], v[240:243], v[244:251], v10
    s_add_u32 m0, m0, 896
    v_xad_u32 v237, v237, v3, v4
    v_smfmac_f32_16x16x64_bf16 v[164:167], v[240:243], v[244:251], v10 abid:1
    ds_read2st64_b32 v[244:245], v236 offset0:0 offset1:72
    ds_read_b128 v[240:243], v8 offset:2048
    v_xad_u32 v238, v238, v3, v4
    v_smfmac_f32_16x16x64_bf16 v[152:155], a[136:139], v[220:227], v27 abid:1
    ds_read2st64_b32 v[246:247], v237 offset0:0 offset1:72
    s_waitcnt vmcnt(6)
    v_xad_u32 v239, v239, v3, v4
    v_smfmac_f32_16x16x64_bf16 v[152:155], a[172:175], v[228:235], v31 abid:1
    ds_read2st64_b32 v[248:249], v238 offset0:0 offset1:72
    buffer_load_dwordx4 v5, s[8:11], s22 offen offset:768 nt lds
    v_cvt_pk_bf16_f32 v184, v184, v185
    v_smfmac_f32_16x16x64_bf16 v[136:139], a[120:123], v[220:227], v25 abid:1
    ds_read2st64_b32 v[250:251], v239 offset0:0 offset1:72
    ds_read_b128 v[236:239], v9 offset:9216
    v_cvt_pk_bf16_f32 v185, v186, v187
    v_smfmac_f32_16x16x64_bf16 v[136:139], a[156:159], v[228:235], v29 abid:1
    v_cvt_pk_bf16_f32 v186, v188, v189
    v_smfmac_f32_16x16x64_bf16 v[140:143], a[124:127], v[220:227], v26
    v_cvt_pk_bf16_f32 v187, v190, v191
    v_smfmac_f32_16x16x64_bf16 v[140:143], a[160:163], v[228:235], v30
    ds_read_b128 v[188:191], v9 offset:10688
    v_cndmask_b32_dpp v180, v176, v184, vcc row_ror:8 row_mask:0xf bank_mask:0xf
    v_smfmac_f32_16x16x64_bf16 v[144:147], a[128:131], v[220:227], v26 abid:1
    v_cndmask_b32_dpp v181, v177, v185, vcc row_ror:8 row_mask:0xf bank_mask:0xf
    v_smfmac_f32_16x16x64_bf16 v[144:147], a[164:167], v[228:235], v30 abid:1
    v_cndmask_b32_dpp v182, v178, v186, vcc row_ror:8 row_mask:0xf bank_mask:0xf
    v_smfmac_f32_16x16x64_bf16 v[148:151], a[132:135], v[220:227], v27
    v_cndmask_b32_dpp v183, v179, v187, vcc row_ror:8 row_mask:0xf bank_mask:0xf
    v_smfmac_f32_16x16x64_bf16 v[148:151], a[168:171], v[228:235], v31
    s_waitcnt vmcnt(6)
    buffer_store_dwordx4 v[180:183], v6, s[12:15], s58 offen offset:128 sc1
    s_waitcnt lgkmcnt(8)
    v_xad_u32 v212, v216, v3, v4
    v_smfmac_f32_16x16x64_bf16 v[132:135], a[116:119], v[220:227], v25
    ds_read2st64_b32 v[212:213], v212 offset0:0 offset1:72
    v_xad_u32 v214, v217, v3, v4
    v_smfmac_f32_16x16x64_bf16 v[132:135], a[152:155], v[228:235], v29
    ds_read2st64_b32 v[214:215], v214 offset0:0 offset1:72
    s_waitcnt lgkmcnt(3)
    v_xad_u32 v236, v236, v3, v4
    v_smfmac_f32_16x16x64_bf16 v[132:135], v[240:243], v[244:251], v10
    v_xad_u32 v237, v237, v3, v4
    v_smfmac_f32_16x16x64_bf16 v[168:171], v[240:243], v[244:251], v10 abid:1
    ds_read2st64_b32 v[244:245], v236 offset0:0 offset1:72
    ds_read_b128 v[240:243], v8 offset:0
    v_xad_u32 v238, v238, v3, v4
    v_smfmac_f32_16x16x64_bf16 v[156:159], a[140:143], v[220:227], v49 abid:1
    ds_read2st64_b32 v[246:247], v237 offset0:0 offset1:72
    v_xad_u32 v239, v239, v3, v4
    v_smfmac_f32_16x16x64_bf16 v[156:159], a[176:179], v[228:235], v50
    ds_read2st64_b32 v[248:249], v238 offset0:0 offset1:72
    v_mov_b32_dpp v176, v184 row_ror:8 row_mask:0xf bank_mask:0xc
    v_smfmac_f32_16x16x64_bf16 v[140:143], a[196:199], v[196:203], v34
    ds_read2st64_b32 v[250:251], v239 offset0:0 offset1:72
    ds_read_b128 v[236:239], v9 offset:9728
    v_mov_b32_dpp v177, v185 row_ror:8 row_mask:0xf bank_mask:0xc
    v_smfmac_f32_16x16x64_bf16 v[140:143], a[232:235], v[204:211], v38
    v_mov_b32_dpp v178, v186 row_ror:8 row_mask:0xf bank_mask:0xc
    v_smfmac_f32_16x16x64_bf16 v[128:131], a[184:187], v[196:203], v32 abid:1
    v_mov_b32_dpp v179, v187 row_ror:8 row_mask:0xf bank_mask:0xc
    v_smfmac_f32_16x16x64_bf16 v[128:131], a[220:223], v[204:211], v36 abid:1
    s_waitcnt vmcnt(6)
    buffer_store_dwordx4 v[176:179], v6, s[12:15], s23 offen offset:128 sc1
    ds_read_b128 v[180:183], v9 offset:10560
    v_smfmac_f32_16x16x64_bf16 v[132:135], a[188:191], v[196:203], v33
    ds_read_b128 v[184:187], v9 offset:10624
    ds_read_b128 v[176:179], v9 offset:10496
    v_smfmac_f32_16x16x64_bf16 v[132:135], a[224:227], v[204:211], v37
    v_smfmac_f32_16x16x64_bf16 v[136:139], a[192:195], v[196:203], v33 abid:1
    ds_read_b128 v[220:223], v1 offset:7168
    v_smfmac_f32_16x16x64_bf16 v[136:139], a[228:231], v[204:211], v37 abid:1
    ds_read_b128 v[224:227], v2 offset:7168
    v_smfmac_f32_16x16x64_bf16 v[124:127], a[180:183], v[196:203], v32
    ds_read_b128 v[228:231], v1 offset:8192
    v_smfmac_f32_16x16x64_bf16 v[124:127], a[216:219], v[204:211], v36
    s_waitcnt vmcnt(7)
    s_waitcnt lgkmcnt(6)
    v_xad_u32 v236, v236, v3, v4
    v_smfmac_f32_16x16x64_bf16 v[124:127], v[240:243], v[244:251], v10
    ds_read_b128 v[232:235], v2 offset:8192
    v_xad_u32 v237, v237, v3, v4
    v_smfmac_f32_16x16x64_bf16 v[160:163], v[240:243], v[244:251], v10 abid:1
    ds_read2st64_b32 v[244:245], v236 offset0:0 offset1:72
    ds_read_b128 v[240:243], v8 offset:8192
    v_xad_u32 v238, v238, v3, v4
    v_smfmac_f32_16x16x64_bf16 v[144:147], a[200:203], v[196:203], v34 abid:1
    ds_read2st64_b32 v[246:247], v237 offset0:0 offset1:72
    v_xad_u32 v239, v239, v3, v4
    v_smfmac_f32_16x16x64_bf16 v[144:147], a[236:239], v[204:211], v38 abid:1
    ds_read2st64_b32 v[248:249], v238 offset0:0 offset1:72
    v_mul_u32_u24 v0, s94, v0
    v_smfmac_f32_16x16x64_bf16 v[148:151], a[204:207], v[196:203], v35
    ds_read2st64_b32 v[250:251], v239 offset0:0 offset1:72
    ds_read_b128 v[236:239], v9 offset:9664
    v_add_u32 v0, s93, v0
    v_smfmac_f32_16x16x64_bf16 v[148:151], a[240:243], v[204:211], v39
    s_waitcnt lgkmcnt(10)
    s_cmp_lt_i32 s81, 0
    s_cbranch_scc1 M_ovrL
    s_swappc_b64 s[78:79], s[72:73]
M_ovrL:
    v_smfmac_f32_16x16x64_bf16 v[152:155], a[208:211], v[196:203], v35 abid:1
    s_add_u32 m0, m0, 896
    v_min_u32 v0, 75497472, v0
    v_smfmac_f32_16x16x64_bf16 v[152:155], a[244:247], v[204:211], v39 abid:1
    ds_write_b32 v11, v0
    s_waitcnt vmcnt(6)
    v_mov_b32 v0, 162048
    v_smfmac_f32_16x16x64_bf16 v[156:159], a[212:215], v[196:203], v50 abid:1
    buffer_load_dwordx4 v5, s[8:11], s22 offen offset:896 nt lds
    v_smfmac_f32_16x16x64_bf16 v[156:159], a[248:251], v[204:211], v51
    s_waitcnt lgkmcnt(9)
    v_smfmac_f32_16x16x64_bf16 v[124:127], a[252:255], v[220:227], v40
    ds_read_b128 v[196:199], v1 offset:18432
    s_waitcnt lgkmcnt(8)
    v_smfmac_f32_16x16x64_bf16 v[124:127], v[88:91], v[228:235], v44
    ds_read_b128 v[200:203], v2 offset:18432
    v_smfmac_f32_16x16x64_bf16 v[156:159], v[84:87], v[220:227], v51 abid:1
    ds_read_b128 v[204:207], v1 offset:19456
    v_smfmac_f32_16x16x64_bf16 v[156:159], v[120:123], v[228:235], v52
    s_waitcnt lgkmcnt(3)
    s_barrier
    v_xad_u32 v236, v236, v3, v4
    v_smfmac_f32_16x16x64_bf16 v[156:159], v[240:243], v[244:251], v10
    ds_read_b128 v[208:211], v2 offset:19456
    ds_read_b32 v0, v0
    v_xad_u32 v237, v237, v3, v4
    v_smfmac_f32_16x16x64_bf16 v[192:195], v[240:243], v[244:251], v10 abid:1
    ds_read2st64_b32 v[244:245], v236 offset0:0 offset1:72
    ds_read_b128 v[240:243], v8 offset:7168
    v_xad_u32 v238, v238, v3, v4
    v_smfmac_f32_16x16x64_bf16 v[132:135], v[60:63], v[220:227], v41
    ds_read2st64_b32 v[246:247], v237 offset0:0 offset1:72
    v_xad_u32 v239, v239, v3, v4
    v_smfmac_f32_16x16x64_bf16 v[132:135], v[96:99], v[228:235], v45
    ds_read2st64_b32 v[248:249], v238 offset0:0 offset1:72
    s_add_u32 m0, m0, 896
    v_smfmac_f32_16x16x64_bf16 v[136:139], v[64:67], v[220:227], v41 abid:1
    ds_read2st64_b32 v[250:251], v239 offset0:0 offset1:72
    ds_read_b128 v[236:239], v9 offset:9536
    s_waitcnt vmcnt(6)
    v_smfmac_f32_16x16x64_bf16 v[136:139], v[100:103], v[228:235], v45 abid:1
    buffer_load_dwordx4 v5, s[8:11], s22 offen offset:1024 nt lds
    s_waitcnt lgkmcnt(6)
    v_readfirstlane_b32 s88, v0
    v_smfmac_f32_16x16x64_bf16 v[140:143], v[68:71], v[220:227], v42
    s_cmp_lt_u32 s88, s99
    s_cselect_b32 s10, 75497472, 0
    v_smfmac_f32_16x16x64_bf16 v[140:143], v[104:107], v[228:235], v46
    s_cmp_lt_u32 s88, s14
    s_cbranch_scc0 M_q
M_nq:
    v_smfmac_f32_16x16x64_bf16 v[144:147], v[72:75], v[220:227], v42 abid:1
    ds_read_b128 v[212:215], v1 offset:20480
    v_smfmac_f32_16x16x64_bf16 v[144:147], v[108:111], v[228:235], v46 abid:1
    ds_read_b128 v[216:219], v2 offset:20480
    v_smfmac_f32_16x16x64_bf16 v[148:151], v[76:79], v[220:227], v43
    v_smfmac_f32_16x16x64_bf16 v[148:151], v[112:115], v[228:235], v47
    v_smfmac_f32_16x16x64_bf16 v[152:155], v[80:83], v[220:227], v43 abid:1
    v_smfmac_f32_16x16x64_bf16 v[152:155], v[116:119], v[228:235], v47 abid:1
    s_waitcnt lgkmcnt(2)
    v_xad_u32 v236, v236, v3, v4
    v_smfmac_f32_16x16x64_bf16 v[152:155], v[240:243], v[244:251], v10
    v_xad_u32 v237, v237, v3, v4
    v_smfmac_f32_16x16x64_bf16 v[188:191], v[240:243], v[244:251], v10 abid:1
    s_cmp_gt_u32 s46, s80
    s_cbranch_scc1 M_slow
M_slowrL:
    v_xad_u32 v238, v238, v3, v4
    v_smfmac_f32_16x16x64_bf16 v[128:131], v[56:59], v[220:227], v40 abid:1
    ds_read2st64_b32 v[244:245], v236 offset0:0 offset1:72
    ds_read_b128 v[240:243], v8 offset:5120
    v_xad_u32 v239, v239, v3, v4
    v_smfmac_f32_16x16x64_bf16 v[128:131], v[92:95], v[228:235], v44 abid:1
    ds_read2st64_b32 v[246:247], v237 offset0:0 offset1:72
    v_smfmac_f32_16x16x64_bf16 v[160:163], a[0:3], v[196:203], v12
    ds_read2st64_b32 v[248:249], v238 offset0:0 offset1:72
    v_smfmac_f32_16x16x64_bf16 v[160:163], a[36:39], v[204:211], v16
    ds_read2st64_b32 v[250:251], v239 offset0:0 offset1:72
    ds_read_b128 v[236:239], v9 offset:9600
    s_waitcnt lgkmcnt(6)
    v_smfmac_f32_16x16x64_bf16 v[160:163], a[72:75], v[212:219], v20
    v_smfmac_f32_16x16x64_bf16 v[164:167], a[4:7], v[196:203], v12 abid:1
    s_mov_b32 m0, s28
    v_cvt_pk_bf16_f32 v156, v156, v157
    v_smfmac_f32_16x16x64_bf16 v[164:167], a[40:43], v[204:211], v16 abid:1
    s_waitcnt vmcnt(6)
    buffer_load_dwordx4 v5, s[8:11], s88 offen offset:0 nt lds
    v_cvt_pk_bf16_f32 v157, v158, v159
    v_smfmac_f32_16x16x64_bf16 v[164:167], a[76:79], v[212:219], v20 abid:1
    ds_write_b64 v53, v[156:157] offset:25728
    ds_read_b128 v[156:159], v9 offset:10752
    v_smfmac_f32_16x16x64_bf16 v[180:183], a[20:23], v[196:203], v14 abid:1
    v_smfmac_f32_16x16x64_bf16 v[180:183], a[56:59], v[204:211], v18 abid:1
    ds_read_b128 v[220:223], v1 offset:21504
    v_cvt_pk_bf16_f32 v124, v124, v125
    v_smfmac_f32_16x16x64_bf16 v[180:183], a[92:95], v[212:219], v22 abid:1
    s_waitcnt lgkmcnt(3)
    v_xad_u32 v236, v236, v3, v4
    v_smfmac_f32_16x16x64_bf16 v[180:183], v[240:243], v[244:251], v10 abid:1
    v_xad_u32 v237, v237, v3, v4
    v_smfmac_f32_16x16x64_bf16 v[144:147], v[240:243], v[244:251], v10
    ds_read2st64_b32 v[244:245], v236 offset0:0 offset1:72
    ds_read_b128 v[240:243], v8 offset:6144
    v_xad_u32 v238, v238, v3, v4
    v_smfmac_f32_16x16x64_bf16 v[172:175], a[12:15], v[196:203], v13 abid:1
    ds_read2st64_b32 v[246:247], v237 offset0:0 offset1:72
    v_xad_u32 v239, v239, v3, v4
    v_smfmac_f32_16x16x64_bf16 v[172:175], a[48:51], v[204:211], v17 abid:1
    ds_read2st64_b32 v[248:249], v238 offset0:0 offset1:72
    v_cvt_pk_bf16_f32 v125, v126, v127
    v_smfmac_f32_16x16x64_bf16 v[172:175], a[84:87], v[212:219], v21 abid:1
    ds_read2st64_b32 v[250:251], v239 offset0:0 offset1:72
    ds_read_b128 v[236:239], v9 offset:9472
    v_cvt_pk_bf16_f32 v126, v128, v129
    v_smfmac_f32_16x16x64_bf16 v[176:179], a[16:19], v[196:203], v14
    v_cvt_pk_bf16_f32 v127, v130, v131
    v_smfmac_f32_16x16x64_bf16 v[176:179], a[52:55], v[204:211], v18
    v_cvt_pk_bf16_f32 v132, v132, v133
    v_smfmac_f32_16x16x64_bf16 v[176:179], a[88:91], v[212:219], v22
    v_cvt_pk_bf16_f32 v133, v134, v135
    v_smfmac_f32_16x16x64_bf16 v[168:171], a[8:11], v[196:203], v13
    s_add_u32 m0, m0, 896
    v_cvt_pk_bf16_f32 v134, v136, v137
    v_smfmac_f32_16x16x64_bf16 v[168:171], a[44:47], v[204:211], v17
    s_waitcnt vmcnt(6)
    buffer_load_dwordx4 v5, s[8:11], s88 offen offset:128 nt lds
    v_cvt_pk_bf16_f32 v135, v138, v139
    v_smfmac_f32_16x16x64_bf16 v[168:171], a[80:83], v[212:219], v21
    ds_read_b128 v[224:227], v2 offset:21504
    ds_read_b128 v[136:139], v9 offset:10432
    v_cndmask_b32_dpp v128, v124, v132, vcc row_ror:8 row_mask:0xf bank_mask:0xf
    v_smfmac_f32_16x16x64_bf16 v[184:187], a[24:27], v[196:203], v15
    ds_read_b128 v[228:231], v1 offset:22528
    v_cndmask_b32_dpp v129, v125, v133, vcc row_ror:8 row_mask:0xf bank_mask:0xf
    v_smfmac_f32_16x16x64_bf16 v[184:187], a[60:63], v[204:211], v19
    ds_read_b128 v[232:235], v2 offset:22528
    v_cndmask_b32_dpp v130, v126, v134, vcc row_ror:8 row_mask:0xf bank_mask:0xf
    v_smfmac_f32_16x16x64_bf16 v[184:187], a[96:99], v[212:219], v23
    s_waitcnt lgkmcnt(4)
    v_xad_u32 v236, v236, v3, v4
    v_smfmac_f32_16x16x64_bf16 v[184:187], v[240:243], v[244:251], v10 abid:1
    v_xad_u32 v237, v237, v3, v4
    v_smfmac_f32_16x16x64_bf16 v[148:151], v[240:243], v[244:251], v10
    ds_read2st64_b32 v[244:245], v236 offset0:0 offset1:72
    ds_read_b128 v[240:243], v8 offset:4096
    v_xad_u32 v238, v238, v3, v4
    v_smfmac_f32_16x16x64_bf16 v[188:191], a[28:31], v[196:203], v15 abid:1
    ds_read2st64_b32 v[246:247], v237 offset0:0 offset1:72
    v_xad_u32 v239, v239, v3, v4
    v_smfmac_f32_16x16x64_bf16 v[188:191], a[64:67], v[204:211], v19 abid:1
    ds_read2st64_b32 v[248:249], v238 offset0:0 offset1:72
    v_cndmask_b32_dpp v131, v127, v135, vcc row_ror:8 row_mask:0xf bank_mask:0xf
    v_smfmac_f32_16x16x64_bf16 v[188:191], a[100:103], v[212:219], v23 abid:1
    ds_read2st64_b32 v[250:251], v239 offset0:0 offset1:72
    s_waitcnt vmcnt(6)
    buffer_store_dwordx4 v[128:131], v6, s[12:15], s59 offen offset:0 sc1
    v_smfmac_f32_16x16x64_bf16 v[192:195], a[32:35], v[196:203], v48
    v_mov_b32_dpp v124, v132 row_ror:8 row_mask:0xf bank_mask:0xc
    v_smfmac_f32_16x16x64_bf16 v[192:195], a[68:71], v[204:211], v48 abid:1
    v_mov_b32_dpp v125, v133 row_ror:8 row_mask:0xf bank_mask:0xc
    v_smfmac_f32_16x16x64_bf16 v[192:195], a[104:107], v[212:219], v49
    s_waitcnt lgkmcnt(8)
    v_mov_b32_dpp v126, v134 row_ror:8 row_mask:0xf bank_mask:0xc
    v_smfmac_f32_16x16x64_bf16 v[160:163], a[108:111], v[220:227], v24
    s_waitcnt lgkmcnt(5)
    v_mov_b32_dpp v127, v135 row_ror:8 row_mask:0xf bank_mask:0xc
    v_smfmac_f32_16x16x64_bf16 v[160:163], a[144:147], v[228:235], v28
    ds_read_b128 v[196:199], v1 offset:23552
    s_waitcnt vmcnt(6)
    buffer_store_dwordx4 v[124:127], v6, s[12:15], s24 offen offset:0 sc1
    v_smfmac_f32_16x16x64_bf16 v[164:167], a[112:115], v[220:227], v24 abid:1
    ds_read_b128 v[200:203], v2 offset:23552
    ds_read_b128 v[128:131], v9 offset:10304
    ds_read_b128 v[132:135], v9 offset:10368
    v_smfmac_f32_16x16x64_bf16 v[164:167], a[148:151], v[228:235], v28 abid:1
    ds_read_b128 v[204:207], v1 offset:24576
    ds_read_b128 v[124:127], v9 offset:10240
    v_smfmac_f32_16x16x64_bf16 v[176:179], a[124:127], v[220:227], v26
    ds_read_b128 v[208:211], v2 offset:24576
    v_smfmac_f32_16x16x64_bf16 v[176:179], a[160:163], v[228:235], v30
    s_waitcnt lgkmcnt(7)
    v_smfmac_f32_16x16x64_bf16 v[176:179], v[240:243], v[244:251], v10 abid:1
    v_smfmac_f32_16x16x64_bf16 v[140:143], v[240:243], v[244:251], v10
    v_smfmac_f32_16x16x64_bf16 v[172:175], a[120:123], v[220:227], v25 abid:1
    s_add_u32 s28, s28, 36864
    s_cmp_ge_u32 s28, 110592
    s_cselect_b32 s28, s26, s28
    v_smfmac_f32_16x16x64_bf16 v[172:175], a[156:159], v[228:235], v29 abid:1
    s_add_u32 s30, s25, 36864
    s_cmp_eq_u32 s30, 110592
    s_cselect_b32 s30, 0, s30
    v_smfmac_f32_16x16x64_bf16 v[168:171], a[116:119], v[220:227], v25
    s_sub_u32 s31, s30, s25
    s_mov_b32 s25, s30
    s_mov_b32 s90, s22
    v_smfmac_f32_16x16x64_bf16 v[168:171], a[152:155], v[228:235], v29
    s_mov_b32 s22, s88
    s_add_u32 s91, s91, 1
    s_cmp_lt_u32 s20, 2
    v_smfmac_f32_16x16x64_bf16 v[180:183], a[128:131], v[220:227], v26 abid:1
    s_cselect_b32 s66, s23, s24
    s_add_u32 s66, s66, s95
    v_smfmac_f32_16x16x64_bf16 v[180:183], a[164:167], v[228:235], v30 abid:1
    v_cvt_pk_bf16_f32 v140, v140, v141
    v_smfmac_f32_16x16x64_bf16 v[184:187], a[132:135], v[220:227], v27
    s_add_u32 m0, m0, 896
    v_cvt_pk_bf16_f32 v141, v142, v143
    v_smfmac_f32_16x16x64_bf16 v[184:187], a[168:171], v[228:235], v31
    s_waitcnt vmcnt(6)
    buffer_load_dwordx4 v5, s[8:11], s88 offen offset:256 nt lds
    v_cvt_pk_bf16_f32 v142, v144, v145
    v_smfmac_f32_16x16x64_bf16 v[188:191], a[136:139], v[220:227], v27 abid:1
    v_cvt_pk_bf16_f32 v143, v146, v147
    v_smfmac_f32_16x16x64_bf16 v[188:191], a[172:175], v[228:235], v31 abid:1
    v_cvt_pk_bf16_f32 v148, v148, v149
    v_smfmac_f32_16x16x64_bf16 v[192:195], a[140:143], v[220:227], v49 abid:1
    v_cvt_pk_bf16_f32 v149, v150, v151
    v_smfmac_f32_16x16x64_bf16 v[192:195], a[176:179], v[228:235], v50
    ds_read_b128 v[220:223], v1 offset:25600
    s_waitcnt lgkmcnt(6)
    v_cvt_pk_bf16_f32 v150, v152, v153
    v_smfmac_f32_16x16x64_bf16 v[160:163], a[180:183], v[196:203], v32
    ds_read_b128 v[224:227], v2 offset:25600
    s_waitcnt lgkmcnt(2)
    v_cvt_pk_bf16_f32 v151, v154, v155
    v_smfmac_f32_16x16x64_bf16 v[160:163], a[216:219], v[204:211], v36
    ds_read_b128 v[228:231], v1 offset:26624
    ds_read_b128 v[152:155], v9 offset:10688
    v_cndmask_b32_dpp v144, v140, v148, vcc row_ror:8 row_mask:0xf bank_mask:0xf
    v_smfmac_f32_16x16x64_bf16 v[164:167], a[184:187], v[196:203], v32 abid:1
    ds_read_b128 v[232:235], v2 offset:26624
    v_cndmask_b32_dpp v145, v141, v149, vcc row_ror:8 row_mask:0xf bank_mask:0xf
    v_smfmac_f32_16x16x64_bf16 v[164:167], a[220:223], v[204:211], v36 abid:1
    s_add_u32 m0, m0, 896
    v_cndmask_b32_dpp v146, v142, v150, vcc row_ror:8 row_mask:0xf bank_mask:0xf
    v_smfmac_f32_16x16x64_bf16 v[168:171], a[188:191], v[196:203], v33
    s_waitcnt vmcnt(6)
    buffer_load_dwordx4 v5, s[8:11], s88 offen offset:384 nt lds
    v_cndmask_b32_dpp v147, v143, v151, vcc row_ror:8 row_mask:0xf bank_mask:0xf
    v_smfmac_f32_16x16x64_bf16 v[168:171], a[224:227], v[204:211], v37
    s_waitcnt vmcnt(6)
    buffer_store_dwordx4 v[144:147], v6, s[12:15], s59 offen offset:128 sc1
    v_mov_b32_dpp v140, v148 row_ror:8 row_mask:0xf bank_mask:0xc
    v_smfmac_f32_16x16x64_bf16 v[172:175], a[192:195], v[196:203], v33 abid:1
    v_mov_b32_dpp v141, v149 row_ror:8 row_mask:0xf bank_mask:0xc
    v_smfmac_f32_16x16x64_bf16 v[172:175], a[228:231], v[204:211], v37 abid:1
    v_mov_b32_dpp v142, v150 row_ror:8 row_mask:0xf bank_mask:0xc
    v_smfmac_f32_16x16x64_bf16 v[176:179], a[196:199], v[196:203], v34
    v_mov_b32_dpp v143, v151 row_ror:8 row_mask:0xf bank_mask:0xc
    v_smfmac_f32_16x16x64_bf16 v[176:179], a[232:235], v[204:211], v38
    s_waitcnt vmcnt(6)
    buffer_store_dwordx4 v[140:143], v6, s[12:15], s24 offen offset:128 sc1
    ds_read_b128 v[144:147], v9 offset:10560
    v_smfmac_f32_16x16x64_bf16 v[180:183], a[200:203], v[196:203], v34 abid:1
    ds_read_b128 v[148:151], v9 offset:10624
    ds_read_b128 v[140:143], v9 offset:10496
    v_add_u32 v4, s31, v4
    v_smfmac_f32_16x16x64_bf16 v[180:183], a[236:239], v[204:211], v38 abid:1
    v_add_u32 v1, s31, v1
    v_smfmac_f32_16x16x64_bf16 v[184:187], a[204:207], v[196:203], v35
    v_add_u32 v2, s31, v2
    v_smfmac_f32_16x16x64_bf16 v[184:187], a[240:243], v[204:211], v39
    v_smfmac_f32_16x16x64_bf16 v[188:191], a[208:211], v[196:203], v35 abid:1
    v_smfmac_f32_16x16x64_bf16 v[188:191], a[244:247], v[204:211], v39 abid:1
    v_smfmac_f32_16x16x64_bf16 v[192:195], a[212:215], v[196:203], v50 abid:1
    v_smfmac_f32_16x16x64_bf16 v[192:195], a[248:251], v[204:211], v51
    s_waitcnt vmcnt(8)
    s_branch M_top1
M_bE0:
    v_smfmac_f32_16x16x64_bf16 v[164:167], v[56:59], v[220:227], v40 abid:1
    ds_read_b128 v[204:207], v1 offset:1024
    v_smfmac_f32_16x16x64_bf16 v[164:167], v[92:95], v[228:235], v44 abid:1
    ds_read_b128 v[208:211], v2 offset:1024
    v_mov_b32 v0, 1
    v_smfmac_f32_16x16x64_bf16 v[168:171], v[60:63], v[220:227], v41
    ds_read_b128 v[212:215], v1 offset:2048
    v_smfmac_f32_16x16x64_bf16 v[168:171], v[96:99], v[228:235], v45
    ds_read_b128 v[216:219], v2 offset:2048
    v_smfmac_f32_16x16x64_bf16 v[172:175], v[64:67], v[220:227], v41 abid:1
    s_waitcnt vmcnt(5)
    s_waitcnt lgkmcnt(6)
    buffer_store_dwordx4 v[244:247], v7, s[12:15], s66 offen sc1
    v_smfmac_f32_16x16x64_bf16 v[172:175], v[100:103], v[228:235], v45 abid:1
    ds_read_b128 v[236:239], v9 offset:9408
    v_smfmac_f32_16x16x64_bf16 v[176:179], v[68:71], v[220:227], v42
    s_waitcnt vmcnt(5)
    buffer_atomic_add v0, v11, s[16:19], s92 offen sc0 sc1
    s_mov_b32 s21, 2
    v_smfmac_f32_16x16x64_bf16 v[176:179], v[104:107], v[228:235], v46
    v_smfmac_f32_16x16x64_bf16 v[180:183], v[72:75], v[220:227], v42 abid:1
    v_cvt_pk_bf16_f32 v160, v160, v161
    v_smfmac_f32_16x16x64_bf16 v[180:183], v[108:111], v[228:235], v46 abid:1
    v_cvt_pk_bf16_f32 v161, v162, v163
    v_smfmac_f32_16x16x64_bf16 v[184:187], v[76:79], v[220:227], v43
    v_cvt_pk_bf16_f32 v162, v164, v165
    v_smfmac_f32_16x16x64_bf16 v[184:187], v[112:115], v[228:235], v47
    v_cvt_pk_bf16_f32 v163, v166, v167
    v_smfmac_f32_16x16x64_bf16 v[188:191], v[80:83], v[220:227], v43 abid:1
    s_add_u32 m0, m0, 896
    v_cvt_pk_bf16_f32 v168, v168, v169
    v_smfmac_f32_16x16x64_bf16 v[188:191], v[116:119], v[228:235], v47 abid:1
    s_waitcnt vmcnt(5)
    buffer_load_dwordx4 v5, s[8:11], s22 offen offset:512 nt lds
    v_cvt_pk_bf16_f32 v169, v170, v171
    v_smfmac_f32_16x16x64_bf16 v[192:195], v[84:87], v[220:227], v51 abid:1
    v_cvt_pk_bf16_f32 v170, v172, v173
    v_smfmac_f32_16x16x64_bf16 v[192:195], v[120:123], v[228:235], v52
    ds_read_b128 v[220:223], v1 offset:3072
    s_waitcnt lgkmcnt(6)
    v_cvt_pk_bf16_f32 v171, v174, v175
    v_smfmac_f32_16x16x64_bf16 v[124:127], a[0:3], v[196:203], v12
    ds_read_b128 v[224:227], v2 offset:3072
    ds_read_b128 v[172:175], v9 offset:10432
    s_waitcnt lgkmcnt(6)
    v_cndmask_b32_dpp v164, v160, v168, vcc row_ror:8 row_mask:0xf bank_mask:0xf
    v_smfmac_f32_16x16x64_bf16 v[124:127], a[36:39], v[204:211], v16
    ds_read_b128 v[228:231], v1 offset:4096
    s_waitcnt lgkmcnt(5)
    v_cndmask_b32_dpp v165, v161, v169, vcc row_ror:8 row_mask:0xf bank_mask:0xf
    v_smfmac_f32_16x16x64_bf16 v[124:127], a[72:75], v[212:219], v20
    ds_read_b128 v[232:235], v2 offset:4096
    v_cndmask_b32_dpp v166, v162, v170, vcc row_ror:8 row_mask:0xf bank_mask:0xf
    v_smfmac_f32_16x16x64_bf16 v[128:131], a[4:7], v[196:203], v12 abid:1
    s_barrier
    v_cndmask_b32_dpp v167, v163, v171, vcc row_ror:8 row_mask:0xf bank_mask:0xf
    v_smfmac_f32_16x16x64_bf16 v[128:131], a[40:43], v[204:211], v16 abid:1
    s_waitcnt vmcnt(5)
    buffer_store_dwordx4 v[164:167], v6, s[12:15], s58 offen offset:0 sc1
    s_waitcnt lgkmcnt(5)
    v_xad_u32 v236, v236, v3, v4
    v_smfmac_f32_16x16x64_bf16 v[128:131], a[76:79], v[212:219], v20 abid:1
    v_xad_u32 v237, v237, v3, v4
    v_smfmac_f32_16x16x64_bf16 v[132:135], a[8:11], v[196:203], v13
    ds_read2st64_b32 v[244:245], v236 offset0:0 offset1:72
    ds_read_b128 v[240:243], v8 offset:3072
    v_xad_u32 v238, v238, v3, v4
    v_smfmac_f32_16x16x64_bf16 v[132:135], a[44:47], v[204:211], v17
    ds_read2st64_b32 v[246:247], v237 offset0:0 offset1:72
    v_xad_u32 v239, v239, v3, v4
    v_smfmac_f32_16x16x64_bf16 v[132:135], a[80:83], v[212:219], v21
    ds_read2st64_b32 v[248:249], v238 offset0:0 offset1:72
    v_mov_b32_dpp v160, v168 row_ror:8 row_mask:0xf bank_mask:0xc
    v_smfmac_f32_16x16x64_bf16 v[144:147], a[20:23], v[196:203], v14 abid:1
    ds_read2st64_b32 v[250:251], v239 offset0:0 offset1:72
    ds_read_b128 v[236:239], v9 offset:9280
    v_mov_b32_dpp v161, v169 row_ror:8 row_mask:0xf bank_mask:0xc
    v_smfmac_f32_16x16x64_bf16 v[144:147], a[56:59], v[204:211], v18 abid:1
    v_mov_b32_dpp v162, v170 row_ror:8 row_mask:0xf bank_mask:0xc
    v_smfmac_f32_16x16x64_bf16 v[144:147], a[92:95], v[212:219], v22 abid:1
    v_mov_b32_dpp v163, v171 row_ror:8 row_mask:0xf bank_mask:0xc
    v_smfmac_f32_16x16x64_bf16 v[140:143], a[16:19], v[196:203], v14
    s_waitcnt vmcnt(5)
    buffer_store_dwordx4 v[160:163], v6, s[12:15], s23 offen offset:0 sc1
    ds_read_b128 v[164:167], v9 offset:10304
    v_smfmac_f32_16x16x64_bf16 v[140:143], a[52:55], v[204:211], v18
    ds_read_b128 v[168:171], v9 offset:10368
    ds_read_b128 v[160:163], v9 offset:10240
    v_smfmac_f32_16x16x64_bf16 v[140:143], a[88:91], v[212:219], v22
    v_smfmac_f32_16x16x64_bf16 v[136:139], a[12:15], v[196:203], v13 abid:1
    v_smfmac_f32_16x16x64_bf16 v[136:139], a[48:51], v[204:211], v17 abid:1
    v_smfmac_f32_16x16x64_bf16 v[136:139], a[84:87], v[212:219], v21 abid:1
    s_waitcnt lgkmcnt(3)
    v_xad_u32 v236, v236, v3, v4
    v_smfmac_f32_16x16x64_bf16 v[136:139], v[240:243], v[244:251], v10
    v_xad_u32 v237, v237, v3, v4
    v_smfmac_f32_16x16x64_bf16 v[172:175], v[240:243], v[244:251], v10 abid:1
    ds_read2st64_b32 v[244:245], v236 offset0:0 offset1:72
    ds_read_b128 v[240:243], v8 offset:1024
    v_xad_u32 v238, v238, v3, v4
    v_smfmac_f32_16x16x64_bf16 v[148:151], a[24:27], v[196:203], v15
    ds_read2st64_b32 v[246:247], v237 offset0:0 offset1:72
    v_xad_u32 v239, v239, v3, v4
    v_smfmac_f32_16x16x64_bf16 v[148:151], a[60:63], v[204:211], v19
    ds_read2st64_b32 v[248:249], v238 offset0:0 offset1:72
    v_cvt_pk_bf16_f32 v192, v192, v193
    v_smfmac_f32_16x16x64_bf16 v[148:151], a[96:99], v[212:219], v23
    ds_read2st64_b32 v[250:251], v239 offset0:0 offset1:72
    ds_read_b128 v[236:239], v9 offset:9344
    v_cvt_pk_bf16_f32 v193, v194, v195
    v_smfmac_f32_16x16x64_bf16 v[152:155], a[28:31], v[196:203], v15 abid:1
    ds_write_b64 v53, v[192:193] offset:0
    ds_read_b128 v[192:195], v9 offset:10752
    v_smfmac_f32_16x16x64_bf16 v[152:155], a[64:67], v[204:211], v19 abid:1
    s_add_u32 m0, m0, 896
    v_smfmac_f32_16x16x64_bf16 v[152:155], a[100:103], v[212:219], v23 abid:1
    s_waitcnt vmcnt(5)
    buffer_load_dwordx4 v5, s[8:11], s22 offen offset:640 nt lds
    v_smfmac_f32_16x16x64_bf16 v[156:159], a[32:35], v[196:203], v48
    v_smfmac_f32_16x16x64_bf16 v[156:159], a[68:71], v[204:211], v48 abid:1
    v_smfmac_f32_16x16x64_bf16 v[156:159], a[104:107], v[212:219], v49
    ds_read_b128 v[196:199], v1 offset:5120
    v_cvt_pk_bf16_f32 v176, v176, v177
    v_smfmac_f32_16x16x64_bf16 v[124:127], a[108:111], v[220:227], v24
    ds_read_b128 v[200:203], v2 offset:5120
    v_cvt_pk_bf16_f32 v177, v178, v179
    v_smfmac_f32_16x16x64_bf16 v[124:127], a[144:147], v[228:235], v28
    ds_read_b128 v[204:207], v1 offset:6144
    ds_read_b64 v[216:217], v9 offset:10056
    v_cvt_pk_bf16_f32 v178, v180, v181
    v_smfmac_f32_16x16x64_bf16 v[128:131], a[112:115], v[220:227], v24 abid:1
    ds_read_b128 v[208:211], v2 offset:6144
    v_cvt_pk_bf16_f32 v179, v182, v183
    v_smfmac_f32_16x16x64_bf16 v[128:131], a[148:151], v[228:235], v28 abid:1
    s_waitcnt lgkmcnt(7)
    v_xad_u32 v236, v236, v3, v4
    v_smfmac_f32_16x16x64_bf16 v[128:131], v[240:243], v[244:251], v10
    s_add_u32 m0, m0, 896
    v_xad_u32 v237, v237, v3, v4
    v_smfmac_f32_16x16x64_bf16 v[164:167], v[240:243], v[244:251], v10 abid:1
    ds_read2st64_b32 v[244:245], v236 offset0:0 offset1:72
    ds_read_b128 v[240:243], v8 offset:2048
    v_xad_u32 v238, v238, v3, v4
    v_smfmac_f32_16x16x64_bf16 v[152:155], a[136:139], v[220:227], v27 abid:1
    ds_read2st64_b32 v[246:247], v237 offset0:0 offset1:72
    s_waitcnt vmcnt(5)
    v_xad_u32 v239, v239, v3, v4
    v_smfmac_f32_16x16x64_bf16 v[152:155], a[172:175], v[228:235], v31 abid:1
    ds_read2st64_b32 v[248:249], v238 offset0:0 offset1:72
    buffer_load_dwordx4 v5, s[8:11], s22 offen offset:768 nt lds
    v_cvt_pk_bf16_f32 v184, v184, v185
    v_smfmac_f32_16x16x64_bf16 v[136:139], a[120:123], v[220:227], v25 abid:1
    ds_read2st64_b32 v[250:251], v239 offset0:0 offset1:72
    ds_read_b128 v[236:239], v9 offset:9216
    v_cvt_pk_bf16_f32 v185, v186, v187
    v_smfmac_f32_16x16x64_bf16 v[136:139], a[156:159], v[228:235], v29 abid:1
    v_cvt_pk_bf16_f32 v186, v188, v189
    v_smfmac_f32_16x16x64_bf16 v[140:143], a[124:127], v[220:227], v26
    v_cvt_pk_bf16_f32 v187, v190, v191
    v_smfmac_f32_16x16x64_bf16 v[140:143], a[160:163], v[228:235], v30
    ds_read_b128 v[188:191], v9 offset:10688
    v_cndmask_b32_dpp v180, v176, v184, vcc row_ror:8 row_mask:0xf bank_mask:0xf
    v_smfmac_f32_16x16x64_bf16 v[144:147], a[128:131], v[220:227], v26 abid:1
    v_cndmask_b32_dpp v181, v177, v185, vcc row_ror:8 row_mask:0xf bank_mask:0xf
    v_smfmac_f32_16x16x64_bf16 v[144:147], a[164:167], v[228:235], v30 abid:1
    v_cndmask_b32_dpp v182, v178, v186, vcc row_ror:8 row_mask:0xf bank_mask:0xf
    v_smfmac_f32_16x16x64_bf16 v[148:151], a[132:135], v[220:227], v27
    v_cndmask_b32_dpp v183, v179, v187, vcc row_ror:8 row_mask:0xf bank_mask:0xf
    v_smfmac_f32_16x16x64_bf16 v[148:151], a[168:171], v[228:235], v31
    s_waitcnt vmcnt(5)
    buffer_store_dwordx4 v[180:183], v6, s[12:15], s58 offen offset:128 sc1
    s_waitcnt lgkmcnt(8)
    v_xad_u32 v212, v216, v3, v4
    v_smfmac_f32_16x16x64_bf16 v[132:135], a[116:119], v[220:227], v25
    ds_read2st64_b32 v[212:213], v212 offset0:0 offset1:72
    v_xad_u32 v214, v217, v3, v4
    v_smfmac_f32_16x16x64_bf16 v[132:135], a[152:155], v[228:235], v29
    ds_read2st64_b32 v[214:215], v214 offset0:0 offset1:72
    s_waitcnt lgkmcnt(3)
    v_xad_u32 v236, v236, v3, v4
    v_smfmac_f32_16x16x64_bf16 v[132:135], v[240:243], v[244:251], v10
    v_xad_u32 v237, v237, v3, v4
    v_smfmac_f32_16x16x64_bf16 v[168:171], v[240:243], v[244:251], v10 abid:1
    ds_read2st64_b32 v[244:245], v236 offset0:0 offset1:72
    ds_read_b128 v[240:243], v8 offset:0
    v_xad_u32 v238, v238, v3, v4
    v_smfmac_f32_16x16x64_bf16 v[156:159], a[140:143], v[220:227], v49 abid:1
    ds_read2st64_b32 v[246:247], v237 offset0:0 offset1:72
    v_xad_u32 v239, v239, v3, v4
    v_smfmac_f32_16x16x64_bf16 v[156:159], a[176:179], v[228:235], v50
    ds_read2st64_b32 v[248:249], v238 offset0:0 offset1:72
    v_mov_b32_dpp v176, v184 row_ror:8 row_mask:0xf bank_mask:0xc
    v_smfmac_f32_16x16x64_bf16 v[140:143], a[196:199], v[196:203], v34
    ds_read2st64_b32 v[250:251], v239 offset0:0 offset1:72
    ds_read_b128 v[236:239], v9 offset:9728
    v_mov_b32_dpp v177, v185 row_ror:8 row_mask:0xf bank_mask:0xc
    v_smfmac_f32_16x16x64_bf16 v[140:143], a[232:235], v[204:211], v38
    v_mov_b32_dpp v178, v186 row_ror:8 row_mask:0xf bank_mask:0xc
    v_smfmac_f32_16x16x64_bf16 v[128:131], a[184:187], v[196:203], v32 abid:1
    v_mov_b32_dpp v179, v187 row_ror:8 row_mask:0xf bank_mask:0xc
    v_smfmac_f32_16x16x64_bf16 v[128:131], a[220:223], v[204:211], v36 abid:1
    s_waitcnt vmcnt(5)
    buffer_store_dwordx4 v[176:179], v6, s[12:15], s23 offen offset:128 sc1
    ds_read_b128 v[180:183], v9 offset:10560
    v_smfmac_f32_16x16x64_bf16 v[132:135], a[188:191], v[196:203], v33
    ds_read_b128 v[184:187], v9 offset:10624
    ds_read_b128 v[176:179], v9 offset:10496
    v_smfmac_f32_16x16x64_bf16 v[132:135], a[224:227], v[204:211], v37
    v_smfmac_f32_16x16x64_bf16 v[136:139], a[192:195], v[196:203], v33 abid:1
    ds_read_b128 v[220:223], v1 offset:7168
    v_smfmac_f32_16x16x64_bf16 v[136:139], a[228:231], v[204:211], v37 abid:1
    ds_read_b128 v[224:227], v2 offset:7168
    v_smfmac_f32_16x16x64_bf16 v[124:127], a[180:183], v[196:203], v32
    ds_read_b128 v[228:231], v1 offset:8192
    v_smfmac_f32_16x16x64_bf16 v[124:127], a[216:219], v[204:211], v36
    s_waitcnt vmcnt(7)
    s_waitcnt lgkmcnt(6)
    v_xad_u32 v236, v236, v3, v4
    v_smfmac_f32_16x16x64_bf16 v[124:127], v[240:243], v[244:251], v10
    ds_read_b128 v[232:235], v2 offset:8192
    v_xad_u32 v237, v237, v3, v4
    v_smfmac_f32_16x16x64_bf16 v[160:163], v[240:243], v[244:251], v10 abid:1
    ds_read2st64_b32 v[244:245], v236 offset0:0 offset1:72
    ds_read_b128 v[240:243], v8 offset:8192
    v_xad_u32 v238, v238, v3, v4
    v_smfmac_f32_16x16x64_bf16 v[144:147], a[200:203], v[196:203], v34 abid:1
    ds_read2st64_b32 v[246:247], v237 offset0:0 offset1:72
    v_xad_u32 v239, v239, v3, v4
    v_smfmac_f32_16x16x64_bf16 v[144:147], a[236:239], v[204:211], v38 abid:1
    ds_read2st64_b32 v[248:249], v238 offset0:0 offset1:72
    v_mul_u32_u24 v0, s94, v0
    v_smfmac_f32_16x16x64_bf16 v[148:151], a[204:207], v[196:203], v35
    ds_read2st64_b32 v[250:251], v239 offset0:0 offset1:72
    ds_read_b128 v[236:239], v9 offset:9664
    v_add_u32 v0, s93, v0
    v_smfmac_f32_16x16x64_bf16 v[148:151], a[240:243], v[204:211], v39
    s_waitcnt lgkmcnt(10)
    s_cmp_lt_i32 s81, 0
    s_cbranch_scc1 M_ovrE0
    s_swappc_b64 s[78:79], s[72:73]
M_ovrE0:
    v_smfmac_f32_16x16x64_bf16 v[152:155], a[208:211], v[196:203], v35 abid:1
    s_add_u32 m0, m0, 896
    v_min_u32 v0, 75497472, v0
    v_smfmac_f32_16x16x64_bf16 v[152:155], a[244:247], v[204:211], v39 abid:1
    ds_write_b32 v11, v0
    s_waitcnt vmcnt(5)
    v_mov_b32 v0, 162048
    v_smfmac_f32_16x16x64_bf16 v[156:159], a[212:215], v[196:203], v50 abid:1
    buffer_load_dwordx4 v5, s[8:11], s22 offen offset:896 nt lds
    v_smfmac_f32_16x16x64_bf16 v[156:159], a[248:251], v[204:211], v51
    s_waitcnt lgkmcnt(9)
    v_smfmac_f32_16x16x64_bf16 v[124:127], a[252:255], v[220:227], v40
    ds_read_b128 v[196:199], v1 offset:18432
    s_waitcnt lgkmcnt(8)
    v_smfmac_f32_16x16x64_bf16 v[124:127], v[88:91], v[228:235], v44
    ds_read_b128 v[200:203], v2 offset:18432
    v_smfmac_f32_16x16x64_bf16 v[156:159], v[84:87], v[220:227], v51 abid:1
    ds_read_b128 v[204:207], v1 offset:19456
    v_smfmac_f32_16x16x64_bf16 v[156:159], v[120:123], v[228:235], v52
    s_waitcnt lgkmcnt(3)
    s_barrier
    v_xad_u32 v236, v236, v3, v4
    v_smfmac_f32_16x16x64_bf16 v[156:159], v[240:243], v[244:251], v10
    ds_read_b128 v[208:211], v2 offset:19456
    ds_read_b32 v0, v0
    v_xad_u32 v237, v237, v3, v4
    v_smfmac_f32_16x16x64_bf16 v[192:195], v[240:243], v[244:251], v10 abid:1
    ds_read2st64_b32 v[244:245], v236 offset0:0 offset1:72
    ds_read_b128 v[240:243], v8 offset:7168
    v_xad_u32 v238, v238, v3, v4
    v_smfmac_f32_16x16x64_bf16 v[132:135], v[60:63], v[220:227], v41
    ds_read2st64_b32 v[246:247], v237 offset0:0 offset1:72
    v_xad_u32 v239, v239, v3, v4
    v_smfmac_f32_16x16x64_bf16 v[132:135], v[96:99], v[228:235], v45
    ds_read2st64_b32 v[248:249], v238 offset0:0 offset1:72
    s_add_u32 m0, m0, 896
    v_smfmac_f32_16x16x64_bf16 v[136:139], v[64:67], v[220:227], v41 abid:1
    ds_read2st64_b32 v[250:251], v239 offset0:0 offset1:72
    ds_read_b128 v[236:239], v9 offset:9536
    s_waitcnt vmcnt(5)
    v_smfmac_f32_16x16x64_bf16 v[136:139], v[100:103], v[228:235], v45 abid:1
    buffer_load_dwordx4 v5, s[8:11], s22 offen offset:1024 nt lds
    s_waitcnt lgkmcnt(6)
    v_readfirstlane_b32 s88, v0
    v_smfmac_f32_16x16x64_bf16 v[140:143], v[68:71], v[220:227], v42
    s_cmp_lt_u32 s88, s99
    s_cselect_b32 s10, 75497472, 0
    v_smfmac_f32_16x16x64_bf16 v[140:143], v[104:107], v[228:235], v46
    v_smfmac_f32_16x16x64_bf16 v[144:147], v[72:75], v[220:227], v42 abid:1
    ds_read_b128 v[212:215], v1 offset:20480
    v_smfmac_f32_16x16x64_bf16 v[144:147], v[108:111], v[228:235], v46 abid:1
    ds_read_b128 v[216:219], v2 offset:20480
    v_smfmac_f32_16x16x64_bf16 v[148:151], v[76:79], v[220:227], v43
    v_smfmac_f32_16x16x64_bf16 v[148:151], v[112:115], v[228:235], v47
    v_smfmac_f32_16x16x64_bf16 v[152:155], v[80:83], v[220:227], v43 abid:1
    v_smfmac_f32_16x16x64_bf16 v[152:155], v[116:119], v[228:235], v47 abid:1
    s_waitcnt lgkmcnt(2)
    v_xad_u32 v236, v236, v3, v4
    v_smfmac_f32_16x16x64_bf16 v[152:155], v[240:243], v[244:251], v10
    v_xad_u32 v237, v237, v3, v4
    v_smfmac_f32_16x16x64_bf16 v[188:191], v[240:243], v[244:251], v10 abid:1
    s_cmp_gt_u32 s46, s80
    s_cbranch_scc1 M_slow
M_slowrE0:
    v_xad_u32 v238, v238, v3, v4
    v_smfmac_f32_16x16x64_bf16 v[128:131], v[56:59], v[220:227], v40 abid:1
    ds_read2st64_b32 v[244:245], v236 offset0:0 offset1:72
    ds_read_b128 v[240:243], v8 offset:5120
    v_xad_u32 v239, v239, v3, v4
    v_smfmac_f32_16x16x64_bf16 v[128:131], v[92:95], v[228:235], v44 abid:1
    ds_read2st64_b32 v[246:247], v237 offset0:0 offset1:72
    v_smfmac_f32_16x16x64_bf16 v[160:163], a[0:3], v[196:203], v12
    ds_read2st64_b32 v[248:249], v238 offset0:0 offset1:72
    v_smfmac_f32_16x16x64_bf16 v[160:163], a[36:39], v[204:211], v16
    ds_read2st64_b32 v[250:251], v239 offset0:0 offset1:72
    ds_read_b128 v[236:239], v9 offset:9600
    s_waitcnt lgkmcnt(6)
    v_smfmac_f32_16x16x64_bf16 v[160:163], a[72:75], v[212:219], v20
    v_smfmac_f32_16x16x64_bf16 v[164:167], a[4:7], v[196:203], v12 abid:1
    s_mov_b32 m0, s28
    v_cvt_pk_bf16_f32 v156, v156, v157
    v_smfmac_f32_16x16x64_bf16 v[164:167], a[40:43], v[204:211], v16 abid:1
    s_waitcnt vmcnt(5)
    buffer_load_dwordx4 v5, s[8:11], s88 offen offset:0 nt lds
    v_cvt_pk_bf16_f32 v157, v158, v159
    v_smfmac_f32_16x16x64_bf16 v[164:167], a[76:79], v[212:219], v20 abid:1
    ds_write_b64 v53, v[156:157] offset:25728
    ds_read_b128 v[156:159], v9 offset:10752
    v_smfmac_f32_16x16x64_bf16 v[180:183], a[20:23], v[196:203], v14 abid:1
    v_smfmac_f32_16x16x64_bf16 v[180:183], a[56:59], v[204:211], v18 abid:1
    ds_read_b128 v[220:223], v1 offset:21504
    v_cvt_pk_bf16_f32 v124, v124, v125
    v_smfmac_f32_16x16x64_bf16 v[180:183], a[92:95], v[212:219], v22 abid:1
    s_waitcnt lgkmcnt(3)
    v_xad_u32 v236, v236, v3, v4
    v_smfmac_f32_16x16x64_bf16 v[180:183], v[240:243], v[244:251], v10 abid:1
    v_xad_u32 v237, v237, v3, v4
    v_smfmac_f32_16x16x64_bf16 v[144:147], v[240:243], v[244:251], v10
    ds_read2st64_b32 v[244:245], v236 offset0:0 offset1:72
    ds_read_b128 v[240:243], v8 offset:6144
    v_xad_u32 v238, v238, v3, v4
    v_smfmac_f32_16x16x64_bf16 v[172:175], a[12:15], v[196:203], v13 abid:1
    ds_read2st64_b32 v[246:247], v237 offset0:0 offset1:72
    v_xad_u32 v239, v239, v3, v4
    v_smfmac_f32_16x16x64_bf16 v[172:175], a[48:51], v[204:211], v17 abid:1
    ds_read2st64_b32 v[248:249], v238 offset0:0 offset1:72
    v_cvt_pk_bf16_f32 v125, v126, v127
    v_smfmac_f32_16x16x64_bf16 v[172:175], a[84:87], v[212:219], v21 abid:1
    ds_read2st64_b32 v[250:251], v239 offset0:0 offset1:72
    ds_read_b128 v[236:239], v9 offset:9472
    v_cvt_pk_bf16_f32 v126, v128, v129
    v_smfmac_f32_16x16x64_bf16 v[176:179], a[16:19], v[196:203], v14
    v_cvt_pk_bf16_f32 v127, v130, v131
    v_smfmac_f32_16x16x64_bf16 v[176:179], a[52:55], v[204:211], v18
    v_cvt_pk_bf16_f32 v132, v132, v133
    v_smfmac_f32_16x16x64_bf16 v[176:179], a[88:91], v[212:219], v22
    v_cvt_pk_bf16_f32 v133, v134, v135
    v_smfmac_f32_16x16x64_bf16 v[168:171], a[8:11], v[196:203], v13
    s_add_u32 m0, m0, 896
    v_cvt_pk_bf16_f32 v134, v136, v137
    v_smfmac_f32_16x16x64_bf16 v[168:171], a[44:47], v[204:211], v17
    s_waitcnt vmcnt(5)
    buffer_load_dwordx4 v5, s[8:11], s88 offen offset:128 nt lds
    v_cvt_pk_bf16_f32 v135, v138, v139
    v_smfmac_f32_16x16x64_bf16 v[168:171], a[80:83], v[212:219], v21
    ds_read_b128 v[224:227], v2 offset:21504
    ds_read_b128 v[136:139], v9 offset:10432
    v_cndmask_b32_dpp v128, v124, v132, vcc row_ror:8 row_mask:0xf bank_mask:0xf
    v_smfmac_f32_16x16x64_bf16 v[184:187], a[24:27], v[196:203], v15
    ds_read_b128 v[228:231], v1 offset:22528
    v_cndmask_b32_dpp v129, v125, v133, vcc row_ror:8 row_mask:0xf bank_mask:0xf
    v_smfmac_f32_16x16x64_bf16 v[184:187], a[60:63], v[204:211], v19
    ds_read_b128 v[232:235], v2 offset:22528
    v_cndmask_b32_dpp v130, v126, v134, vcc row_ror:8 row_mask:0xf bank_mask:0xf
    v_smfmac_f32_16x16x64_bf16 v[184:187], a[96:99], v[212:219], v23
    s_waitcnt lgkmcnt(4)
    v_xad_u32 v236, v236, v3, v4
    v_smfmac_f32_16x16x64_bf16 v[184:187], v[240:243], v[244:251], v10 abid:1
    v_xad_u32 v237, v237, v3, v4
    v_smfmac_f32_16x16x64_bf16 v[148:151], v[240:243], v[244:251], v10
    ds_read2st64_b32 v[244:245], v236 offset0:0 offset1:72
    ds_read_b128 v[240:243], v8 offset:4096
    v_xad_u32 v238, v238, v3, v4
    v_smfmac_f32_16x16x64_bf16 v[188:191], a[28:31], v[196:203], v15 abid:1
    ds_read2st64_b32 v[246:247], v237 offset0:0 offset1:72
    v_xad_u32 v239, v239, v3, v4
    v_smfmac_f32_16x16x64_bf16 v[188:191], a[64:67], v[204:211], v19 abid:1
    ds_read2st64_b32 v[248:249], v238 offset0:0 offset1:72
    v_cndmask_b32_dpp v131, v127, v135, vcc row_ror:8 row_mask:0xf bank_mask:0xf
    v_smfmac_f32_16x16x64_bf16 v[188:191], a[100:103], v[212:219], v23 abid:1
    ds_read2st64_b32 v[250:251], v239 offset0:0 offset1:72
    s_waitcnt vmcnt(5)
    buffer_store_dwordx4 v[128:131], v6, s[12:15], s59 offen offset:0 sc1
    v_smfmac_f32_16x16x64_bf16 v[192:195], a[32:35], v[196:203], v48
    v_mov_b32_dpp v124, v132 row_ror:8 row_mask:0xf bank_mask:0xc
    v_smfmac_f32_16x16x64_bf16 v[192:195], a[68:71], v[204:211], v48 abid:1
    v_mov_b32_dpp v125, v133 row_ror:8 row_mask:0xf bank_mask:0xc
    v_smfmac_f32_16x16x64_bf16 v[192:195], a[104:107], v[212:219], v49
    s_waitcnt lgkmcnt(8)
    v_mov_b32_dpp v126, v134 row_ror:8 row_mask:0xf bank_mask:0xc
    v_smfmac_f32_16x16x64_bf16 v[160:163], a[108:111], v[220:227], v24
    s_waitcnt lgkmcnt(5)
    v_mov_b32_dpp v127, v135 row_ror:8 row_mask:0xf bank_mask:0xc
    v_smfmac_f32_16x16x64_bf16 v[160:163], a[144:147], v[228:235], v28
    ds_read_b128 v[196:199], v1 offset:23552
    s_waitcnt vmcnt(5)
    buffer_store_dwordx4 v[124:127], v6, s[12:15], s24 offen offset:0 sc1
    v_smfmac_f32_16x16x64_bf16 v[164:167], a[112:115], v[220:227], v24 abid:1
    ds_read_b128 v[200:203], v2 offset:23552
    ds_read_b128 v[128:131], v9 offset:10304
    ds_read_b128 v[132:135], v9 offset:10368
    v_smfmac_f32_16x16x64_bf16 v[164:167], a[148:151], v[228:235], v28 abid:1
    ds_read_b128 v[204:207], v1 offset:24576
    ds_read_b128 v[124:127], v9 offset:10240
    v_smfmac_f32_16x16x64_bf16 v[176:179], a[124:127], v[220:227], v26
    ds_read_b128 v[208:211], v2 offset:24576
    v_smfmac_f32_16x16x64_bf16 v[176:179], a[160:163], v[228:235], v30
    s_waitcnt lgkmcnt(7)
    v_smfmac_f32_16x16x64_bf16 v[176:179], v[240:243], v[244:251], v10 abid:1
    v_smfmac_f32_16x16x64_bf16 v[140:143], v[240:243], v[244:251], v10
    v_smfmac_f32_16x16x64_bf16 v[172:175], a[120:123], v[220:227], v25 abid:1
    s_add_u32 s28, s28, 36864
    s_cmp_ge_u32 s28, 110592
    s_cselect_b32 s28, s26, s28
    v_smfmac_f32_16x16x64_bf16 v[172:175], a[156:159], v[228:235], v29 abid:1
    s_add_u32 s30, s25, 36864
    s_cmp_eq_u32 s30, 110592
    s_cselect_b32 s30, 0, s30
    v_smfmac_f32_16x16x64_bf16 v[168:171], a[116:119], v[220:227], v25
    s_sub_u32 s31, s30, s25
    s_mov_b32 s25, s30
    s_mov_b32 s90, s22
    v_smfmac_f32_16x16x64_bf16 v[168:171], a[152:155], v[228:235], v29
    s_mov_b32 s22, s88
    s_add_u32 s91, s91, 1
    s_cmp_lt_u32 s20, 2
    v_smfmac_f32_16x16x64_bf16 v[180:183], a[128:131], v[220:227], v26 abid:1
    s_cselect_b32 s66, s23, s24
    s_add_u32 s66, s66, s95
    v_smfmac_f32_16x16x64_bf16 v[180:183], a[164:167], v[228:235], v30 abid:1
    v_cvt_pk_bf16_f32 v140, v140, v141
    v_smfmac_f32_16x16x64_bf16 v[184:187], a[132:135], v[220:227], v27
    s_add_u32 m0, m0, 896
    v_cvt_pk_bf16_f32 v141, v142, v143
    v_smfmac_f32_16x16x64_bf16 v[184:187], a[168:171], v[228:235], v31
    s_waitcnt vmcnt(5)
    buffer_load_dwordx4 v5, s[8:11], s88 offen offset:256 nt lds
    v_cvt_pk_bf16_f32 v142, v144, v145
    v_smfmac_f32_16x16x64_bf16 v[188:191], a[136:139], v[220:227], v27 abid:1
    v_cvt_pk_bf16_f32 v143, v146, v147
    v_smfmac_f32_16x16x64_bf16 v[188:191], a[172:175], v[228:235], v31 abid:1
    v_cvt_pk_bf16_f32 v148, v148, v149
    v_smfmac_f32_16x16x64_bf16 v[192:195], a[140:143], v[220:227], v49 abid:1
    v_cvt_pk_bf16_f32 v149, v150, v151
    v_smfmac_f32_16x16x64_bf16 v[192:195], a[176:179], v[228:235], v50
    ds_read_b128 v[220:223], v1 offset:25600
    s_waitcnt lgkmcnt(6)
    v_cvt_pk_bf16_f32 v150, v152, v153
    v_smfmac_f32_16x16x64_bf16 v[160:163], a[180:183], v[196:203], v32
    ds_read_b128 v[224:227], v2 offset:25600
    s_waitcnt lgkmcnt(2)
    v_cvt_pk_bf16_f32 v151, v154, v155
    v_smfmac_f32_16x16x64_bf16 v[160:163], a[216:219], v[204:211], v36
    ds_read_b128 v[228:231], v1 offset:26624
    ds_read_b128 v[152:155], v9 offset:10688
    v_cndmask_b32_dpp v144, v140, v148, vcc row_ror:8 row_mask:0xf bank_mask:0xf
    v_smfmac_f32_16x16x64_bf16 v[164:167], a[184:187], v[196:203], v32 abid:1
    ds_read_b128 v[232:235], v2 offset:26624
    v_cndmask_b32_dpp v145, v141, v149, vcc row_ror:8 row_mask:0xf bank_mask:0xf
    v_smfmac_f32_16x16x64_bf16 v[164:167], a[220:223], v[204:211], v36 abid:1
    s_add_u32 m0, m0, 896
    v_cndmask_b32_dpp v146, v142, v150, vcc row_ror:8 row_mask:0xf bank_mask:0xf
    v_smfmac_f32_16x16x64_bf16 v[168:171], a[188:191], v[196:203], v33
    s_waitcnt vmcnt(5)
    buffer_load_dwordx4 v5, s[8:11], s88 offen offset:384 nt lds
    v_cndmask_b32_dpp v147, v143, v151, vcc row_ror:8 row_mask:0xf bank_mask:0xf
    v_smfmac_f32_16x16x64_bf16 v[168:171], a[224:227], v[204:211], v37
    s_waitcnt vmcnt(5)
    buffer_store_dwordx4 v[144:147], v6, s[12:15], s59 offen offset:128 sc1
    v_mov_b32_dpp v140, v148 row_ror:8 row_mask:0xf bank_mask:0xc
    v_smfmac_f32_16x16x64_bf16 v[172:175], a[192:195], v[196:203], v33 abid:1
    v_mov_b32_dpp v141, v149 row_ror:8 row_mask:0xf bank_mask:0xc
    v_smfmac_f32_16x16x64_bf16 v[172:175], a[228:231], v[204:211], v37 abid:1
    v_mov_b32_dpp v142, v150 row_ror:8 row_mask:0xf bank_mask:0xc
    v_smfmac_f32_16x16x64_bf16 v[176:179], a[196:199], v[196:203], v34
    v_mov_b32_dpp v143, v151 row_ror:8 row_mask:0xf bank_mask:0xc
    v_smfmac_f32_16x16x64_bf16 v[176:179], a[232:235], v[204:211], v38
    s_waitcnt vmcnt(5)
    buffer_store_dwordx4 v[140:143], v6, s[12:15], s24 offen offset:128 sc1
    ds_read_b128 v[144:147], v9 offset:10560
    v_smfmac_f32_16x16x64_bf16 v[180:183], a[200:203], v[196:203], v34 abid:1
    ds_read_b128 v[148:151], v9 offset:10624
    ds_read_b128 v[140:143], v9 offset:10496
    v_add_u32 v4, s31, v4
    v_smfmac_f32_16x16x64_bf16 v[180:183], a[236:239], v[204:211], v38 abid:1
    v_add_u32 v1, s31, v1
    v_smfmac_f32_16x16x64_bf16 v[184:187], a[204:207], v[196:203], v35
    v_add_u32 v2, s31, v2
    v_smfmac_f32_16x16x64_bf16 v[184:187], a[240:243], v[204:211], v39
    v_smfmac_f32_16x16x64_bf16 v[188:191], a[208:211], v[196:203], v35 abid:1
    v_smfmac_f32_16x16x64_bf16 v[188:191], a[244:247], v[204:211], v39 abid:1
    v_smfmac_f32_16x16x64_bf16 v[192:195], a[212:215], v[196:203], v50 abid:1
    v_smfmac_f32_16x16x64_bf16 v[192:195], a[248:251], v[204:211], v51
    s_waitcnt vmcnt(8)
    s_branch M_top1
M_q:
    s_mov_b32 s21, 3
    v_smfmac_f32_16x16x64_bf16 v[144:147], v[72:75], v[220:227], v42 abid:1
    ds_read_b128 v[212:215], v1 offset:20480
    v_smfmac_f32_16x16x64_bf16 v[144:147], v[108:111], v[228:235], v46 abid:1
    ds_read_b128 v[216:219], v2 offset:20480
    v_smfmac_f32_16x16x64_bf16 v[148:151], v[76:79], v[220:227], v43
    v_smfmac_f32_16x16x64_bf16 v[148:151], v[112:115], v[228:235], v47
    v_smfmac_f32_16x16x64_bf16 v[152:155], v[80:83], v[220:227], v43 abid:1
    v_smfmac_f32_16x16x64_bf16 v[152:155], v[116:119], v[228:235], v47 abid:1
    s_waitcnt lgkmcnt(2)
    v_xad_u32 v236, v236, v3, v4
    v_smfmac_f32_16x16x64_bf16 v[152:155], v[240:243], v[244:251], v10
    v_xad_u32 v237, v237, v3, v4
    v_smfmac_f32_16x16x64_bf16 v[188:191], v[240:243], v[244:251], v10 abid:1
    s_cmp_gt_u32 s46, s80
    s_cbranch_scc1 M_slow
M_slowrQ:
    v_xad_u32 v238, v238, v3, v4
    v_smfmac_f32_16x16x64_bf16 v[128:131], v[56:59], v[220:227], v40 abid:1
    ds_read2st64_b32 v[244:245], v236 offset0:0 offset1:72
    ds_read_b128 v[240:243], v8 offset:5120
    v_xad_u32 v239, v239, v3, v4
    v_smfmac_f32_16x16x64_bf16 v[128:131], v[92:95], v[228:235], v44 abid:1
    ds_read2st64_b32 v[246:247], v237 offset0:0 offset1:72
    v_smfmac_f32_16x16x64_bf16 v[160:163], a[0:3], v[196:203], v12
    ds_read2st64_b32 v[248:249], v238 offset0:0 offset1:72
    v_smfmac_f32_16x16x64_bf16 v[160:163], a[36:39], v[204:211], v16
    ds_read2st64_b32 v[250:251], v239 offset0:0 offset1:72
    ds_read_b128 v[236:239], v9 offset:9600
    s_waitcnt lgkmcnt(6)
    v_smfmac_f32_16x16x64_bf16 v[160:163], a[72:75], v[212:219], v20
    v_smfmac_f32_16x16x64_bf16 v[164:167], a[4:7], v[196:203], v12 abid:1
    v_cvt_pk_bf16_f32 v156, v156, v157
    v_smfmac_f32_16x16x64_bf16 v[164:167], a[40:43], v[204:211], v16 abid:1
    v_cvt_pk_bf16_f32 v157, v158, v159
    v_smfmac_f32_16x16x64_bf16 v[164:167], a[76:79], v[212:219], v20 abid:1
    ds_write_b64 v53, v[156:157] offset:25728
    ds_read_b128 v[156:159], v9 offset:10752
    v_smfmac_f32_16x16x64_bf16 v[180:183], a[20:23], v[196:203], v14 abid:1
    v_smfmac_f32_16x16x64_bf16 v[180:183], a[56:59], v[204:211], v18 abid:1
    ds_read_b128 v[220:223], v1 offset:21504
    v_cvt_pk_bf16_f32 v124, v124, v125
    v_smfmac_f32_16x16x64_bf16 v[180:183], a[92:95], v[212:219], v22 abid:1
    s_waitcnt lgkmcnt(3)
    v_xad_u32 v236, v236, v3, v4
    v_smfmac_f32_16x16x64_bf16 v[180:183], v[240:243], v[244:251], v10 abid:1
    v_xad_u32 v237, v237, v3, v4
    v_smfmac_f32_16x16x64_bf16 v[144:147], v[240:243], v[244:251], v10
    ds_read2st64_b32 v[244:245], v236 offset0:0 offset1:72
    ds_read_b128 v[240:243], v8 offset:6144
    v_xad_u32 v238, v238, v3, v4
    v_smfmac_f32_16x16x64_bf16 v[172:175], a[12:15], v[196:203], v13 abid:1
    ds_read2st64_b32 v[246:247], v237 offset0:0 offset1:72
    v_xad_u32 v239, v239, v3, v4
    v_smfmac_f32_16x16x64_bf16 v[172:175], a[48:51], v[204:211], v17 abid:1
    ds_read2st64_b32 v[248:249], v238 offset0:0 offset1:72
    v_cvt_pk_bf16_f32 v125, v126, v127
    v_smfmac_f32_16x16x64_bf16 v[172:175], a[84:87], v[212:219], v21 abid:1
    ds_read2st64_b32 v[250:251], v239 offset0:0 offset1:72
    ds_read_b128 v[236:239], v9 offset:9472
    v_cvt_pk_bf16_f32 v126, v128, v129
    v_smfmac_f32_16x16x64_bf16 v[176:179], a[16:19], v[196:203], v14
    v_cvt_pk_bf16_f32 v127, v130, v131
    v_smfmac_f32_16x16x64_bf16 v[176:179], a[52:55], v[204:211], v18
    v_cvt_pk_bf16_f32 v132, v132, v133
    v_smfmac_f32_16x16x64_bf16 v[176:179], a[88:91], v[212:219], v22
    v_cvt_pk_bf16_f32 v133, v134, v135
    v_smfmac_f32_16x16x64_bf16 v[168:171], a[8:11], v[196:203], v13
    v_cvt_pk_bf16_f32 v134, v136, v137
    v_smfmac_f32_16x16x64_bf16 v[168:171], a[44:47], v[204:211], v17
    v_cvt_pk_bf16_f32 v135, v138, v139
    v_smfmac_f32_16x16x64_bf16 v[168:171], a[80:83], v[212:219], v21
    ds_read_b128 v[224:227], v2 offset:21504
    ds_read_b128 v[136:139], v9 offset:10432
    v_cndmask_b32_dpp v128, v124, v132, vcc row_ror:8 row_mask:0xf bank_mask:0xf
    v_smfmac_f32_16x16x64_bf16 v[184:187], a[24:27], v[196:203], v15
    ds_read_b128 v[228:231], v1 offset:22528
    v_cndmask_b32_dpp v129, v125, v133, vcc row_ror:8 row_mask:0xf bank_mask:0xf
    v_smfmac_f32_16x16x64_bf16 v[184:187], a[60:63], v[204:211], v19
    ds_read_b128 v[232:235], v2 offset:22528
    v_cndmask_b32_dpp v130, v126, v134, vcc row_ror:8 row_mask:0xf bank_mask:0xf
    v_smfmac_f32_16x16x64_bf16 v[184:187], a[96:99], v[212:219], v23
    s_waitcnt lgkmcnt(4)
    v_xad_u32 v236, v236, v3, v4
    v_smfmac_f32_16x16x64_bf16 v[184:187], v[240:243], v[244:251], v10 abid:1
    v_xad_u32 v237, v237, v3, v4
    v_smfmac_f32_16x16x64_bf16 v[148:151], v[240:243], v[244:251], v10
    ds_read2st64_b32 v[244:245], v236 offset0:0 offset1:72
    ds_read_b128 v[240:243], v8 offset:4096
    v_xad_u32 v238, v238, v3, v4
    v_smfmac_f32_16x16x64_bf16 v[188:191], a[28:31], v[196:203], v15 abid:1
    ds_read2st64_b32 v[246:247], v237 offset0:0 offset1:72
    v_xad_u32 v239, v239, v3, v4
    v_smfmac_f32_16x16x64_bf16 v[188:191], a[64:67], v[204:211], v19 abid:1
    ds_read2st64_b32 v[248:249], v238 offset0:0 offset1:72
    v_cndmask_b32_dpp v131, v127, v135, vcc row_ror:8 row_mask:0xf bank_mask:0xf
    v_smfmac_f32_16x16x64_bf16 v[188:191], a[100:103], v[212:219], v23 abid:1
    ds_read2st64_b32 v[250:251], v239 offset0:0 offset1:72
    buffer_store_dwordx4 v[128:131], v6, s[12:15], s59 offen offset:0 sc1
    v_smfmac_f32_16x16x64_bf16 v[192:195], a[32:35], v[196:203], v48
    v_mov_b32_dpp v124, v132 row_ror:8 row_mask:0xf bank_mask:0xc
    v_smfmac_f32_16x16x64_bf16 v[192:195], a[68:71], v[204:211], v48 abid:1
    v_mov_b32_dpp v125, v133 row_ror:8 row_mask:0xf bank_mask:0xc
    v_smfmac_f32_16x16x64_bf16 v[192:195], a[104:107], v[212:219], v49
    s_waitcnt lgkmcnt(8)
    v_mov_b32_dpp v126, v134 row_ror:8 row_mask:0xf bank_mask:0xc
    v_smfmac_f32_16x16x64_bf16 v[160:163], a[108:111], v[220:227], v24
    s_waitcnt lgkmcnt(5)
    v_mov_b32_dpp v127, v135 row_ror:8 row_mask:0xf bank_mask:0xc
    v_smfmac_f32_16x16x64_bf16 v[160:163], a[144:147], v[228:235], v28
    ds_read_b128 v[196:199], v1 offset:23552
    buffer_store_dwordx4 v[124:127], v6, s[12:15], s24 offen offset:0 sc1
    v_smfmac_f32_16x16x64_bf16 v[164:167], a[112:115], v[220:227], v24 abid:1
    ds_read_b128 v[200:203], v2 offset:23552
    ds_read_b128 v[128:131], v9 offset:10304
    ds_read_b128 v[132:135], v9 offset:10368
    v_smfmac_f32_16x16x64_bf16 v[164:167], a[148:151], v[228:235], v28 abid:1
    ds_read_b128 v[204:207], v1 offset:24576
    ds_read_b128 v[124:127], v9 offset:10240
    v_smfmac_f32_16x16x64_bf16 v[176:179], a[124:127], v[220:227], v26
    ds_read_b128 v[208:211], v2 offset:24576
    v_smfmac_f32_16x16x64_bf16 v[176:179], a[160:163], v[228:235], v30
    s_waitcnt lgkmcnt(7)
    v_smfmac_f32_16x16x64_bf16 v[176:179], v[240:243], v[244:251], v10 abid:1
    v_smfmac_f32_16x16x64_bf16 v[140:143], v[240:243], v[244:251], v10
    v_smfmac_f32_16x16x64_bf16 v[172:175], a[120:123], v[220:227], v25 abid:1
    s_add_u32 s28, s28, 36864
    s_cmp_ge_u32 s28, 110592
    s_cselect_b32 s28, s26, s28
    v_smfmac_f32_16x16x64_bf16 v[172:175], a[156:159], v[228:235], v29 abid:1
    s_add_u32 s30, s25, 36864
    s_cmp_eq_u32 s30, 110592
    s_cselect_b32 s30, 0, s30
    v_smfmac_f32_16x16x64_bf16 v[168:171], a[116:119], v[220:227], v25
    s_sub_u32 s31, s30, s25
    s_mov_b32 s25, s30
    s_mov_b32 s90, s22
    v_smfmac_f32_16x16x64_bf16 v[168:171], a[152:155], v[228:235], v29
    s_mov_b32 s22, s88
    s_add_u32 s91, s91, 1
    s_cmp_lt_u32 s20, 2
    v_smfmac_f32_16x16x64_bf16 v[180:183], a[128:131], v[220:227], v26 abid:1
    s_cselect_b32 s66, s23, s24
    s_add_u32 s66, s66, s95
    v_smfmac_f32_16x16x64_bf16 v[180:183], a[164:167], v[228:235], v30 abid:1
    v_cvt_pk_bf16_f32 v140, v140, v141
    v_smfmac_f32_16x16x64_bf16 v[184:187], a[132:135], v[220:227], v27
    v_cvt_pk_bf16_f32 v141, v142, v143
    v_smfmac_f32_16x16x64_bf16 v[184:187], a[168:171], v[228:235], v31
    v_cvt_pk_bf16_f32 v142, v144, v145
    v_smfmac_f32_16x16x64_bf16 v[188:191], a[136:139], v[220:227], v27 abid:1
    v_cvt_pk_bf16_f32 v143, v146, v147
    v_smfmac_f32_16x16x64_bf16 v[188:191], a[172:175], v[228:235], v31 abid:1
    v_cvt_pk_bf16_f32 v148, v148, v149
    v_smfmac_f32_16x16x64_bf16 v[192:195], a[140:143], v[220:227], v49 abid:1
    v_cvt_pk_bf16_f32 v149, v150, v151
    v_smfmac_f32_16x16x64_bf16 v[192:195], a[176:179], v[228:235], v50
    ds_read_b128 v[220:223], v1 offset:25600
    s_waitcnt lgkmcnt(6)
    v_cvt_pk_bf16_f32 v150, v152, v153
    v_smfmac_f32_16x16x64_bf16 v[160:163], a[180:183], v[196:203], v32
    ds_read_b128 v[224:227], v2 offset:25600
    s_waitcnt lgkmcnt(2)
    v_cvt_pk_bf16_f32 v151, v154, v155
    v_smfmac_f32_16x16x64_bf16 v[160:163], a[216:219], v[204:211], v36
    ds_read_b128 v[228:231], v1 offset:26624
    ds_read_b128 v[152:155], v9 offset:10688
    v_cndmask_b32_dpp v144, v140, v148, vcc row_ror:8 row_mask:0xf bank_mask:0xf
    v_smfmac_f32_16x16x64_bf16 v[164:167], a[184:187], v[196:203], v32 abid:1
    ds_read_b128 v[232:235], v2 offset:26624
    v_cndmask_b32_dpp v145, v141, v149, vcc row_ror:8 row_mask:0xf bank_mask:0xf
    v_smfmac_f32_16x16x64_bf16 v[164:167], a[220:223], v[204:211], v36 abid:1
    v_cndmask_b32_dpp v146, v142, v150, vcc row_ror:8 row_mask:0xf bank_mask:0xf
    v_smfmac_f32_16x16x64_bf16 v[168:171], a[188:191], v[196:203], v33
    v_cndmask_b32_dpp v147, v143, v151, vcc row_ror:8 row_mask:0xf bank_mask:0xf
    v_smfmac_f32_16x16x64_bf16 v[168:171], a[224:227], v[204:211], v37
    buffer_store_dwordx4 v[144:147], v6, s[12:15], s59 offen offset:128 sc1
    v_mov_b32_dpp v140, v148 row_ror:8 row_mask:0xf bank_mask:0xc
    v_smfmac_f32_16x16x64_bf16 v[172:175], a[192:195], v[196:203], v33 abid:1
    v_mov_b32_dpp v141, v149 row_ror:8 row_mask:0xf bank_mask:0xc
    v_smfmac_f32_16x16x64_bf16 v[172:175], a[228:231], v[204:211], v37 abid:1
    v_mov_b32_dpp v142, v150 row_ror:8 row_mask:0xf bank_mask:0xc
    v_smfmac_f32_16x16x64_bf16 v[176:179], a[196:199], v[196:203], v34
    v_mov_b32_dpp v143, v151 row_ror:8 row_mask:0xf bank_mask:0xc
    v_smfmac_f32_16x16x64_bf16 v[176:179], a[232:235], v[204:211], v38
    buffer_store_dwordx4 v[140:143], v6, s[12:15], s24 offen offset:128 sc1
    ds_read_b128 v[144:147], v9 offset:10560
    v_smfmac_f32_16x16x64_bf16 v[180:183], a[200:203], v[196:203], v34 abid:1
    ds_read_b128 v[148:151], v9 offset:10624
    ds_read_b128 v[140:143], v9 offset:10496
    v_add_u32 v4, s31, v4
    v_smfmac_f32_16x16x64_bf16 v[180:183], a[236:239], v[204:211], v38 abid:1
    v_add_u32 v1, s31, v1
    v_smfmac_f32_16x16x64_bf16 v[184:187], a[204:207], v[196:203], v35
    v_add_u32 v2, s31, v2
    v_smfmac_f32_16x16x64_bf16 v[184:187], a[240:243], v[204:211], v39
    v_smfmac_f32_16x16x64_bf16 v[188:191], a[208:211], v[196:203], v35 abid:1
    v_smfmac_f32_16x16x64_bf16 v[188:191], a[244:247], v[204:211], v39 abid:1
    v_smfmac_f32_16x16x64_bf16 v[192:195], a[212:215], v[196:203], v50 abid:1
    v_smfmac_f32_16x16x64_bf16 v[192:195], a[248:251], v[204:211], v51
    s_waitcnt vmcnt(4)
    s_branch M_top1
M_bF:
    v_smfmac_f32_16x16x64_bf16 v[164:167], v[56:59], v[220:227], v40 abid:1
    ds_read_b128 v[204:207], v1 offset:1024
    v_smfmac_f32_16x16x64_bf16 v[164:167], v[92:95], v[228:235], v44 abid:1
    ds_read_b128 v[208:211], v2 offset:1024
    v_smfmac_f32_16x16x64_bf16 v[168:171], v[60:63], v[220:227], v41
    ds_read_b128 v[212:215], v1 offset:2048
    v_smfmac_f32_16x16x64_bf16 v[168:171], v[96:99], v[228:235], v45
    ds_read_b128 v[216:219], v2 offset:2048
    v_smfmac_f32_16x16x64_bf16 v[172:175], v[64:67], v[220:227], v41 abid:1
    s_waitcnt lgkmcnt(6)
    buffer_store_dwordx4 v[244:247], v7, s[12:15], s66 offen sc1
    v_smfmac_f32_16x16x64_bf16 v[172:175], v[100:103], v[228:235], v45 abid:1
    ds_read_b128 v[236:239], v9 offset:9408
    v_smfmac_f32_16x16x64_bf16 v[176:179], v[68:71], v[220:227], v42
    s_mov_b32 s21, 4
    v_smfmac_f32_16x16x64_bf16 v[176:179], v[104:107], v[228:235], v46
    v_smfmac_f32_16x16x64_bf16 v[180:183], v[72:75], v[220:227], v42 abid:1
    v_cvt_pk_bf16_f32 v160, v160, v161
    v_smfmac_f32_16x16x64_bf16 v[180:183], v[108:111], v[228:235], v46 abid:1
    v_cvt_pk_bf16_f32 v161, v162, v163
    v_smfmac_f32_16x16x64_bf16 v[184:187], v[76:79], v[220:227], v43
    v_cvt_pk_bf16_f32 v162, v164, v165
    v_smfmac_f32_16x16x64_bf16 v[184:187], v[112:115], v[228:235], v47
    v_cvt_pk_bf16_f32 v163, v166, v167
    v_smfmac_f32_16x16x64_bf16 v[188:191], v[80:83], v[220:227], v43 abid:1
    v_cvt_pk_bf16_f32 v168, v168, v169
    v_smfmac_f32_16x16x64_bf16 v[188:191], v[116:119], v[228:235], v47 abid:1
    v_cvt_pk_bf16_f32 v169, v170, v171
    v_smfmac_f32_16x16x64_bf16 v[192:195], v[84:87], v[220:227], v51 abid:1
    v_cvt_pk_bf16_f32 v170, v172, v173
    v_smfmac_f32_16x16x64_bf16 v[192:195], v[120:123], v[228:235], v52
    ds_read_b128 v[220:223], v1 offset:3072
    s_waitcnt lgkmcnt(6)
    v_cvt_pk_bf16_f32 v171, v174, v175
    v_smfmac_f32_16x16x64_bf16 v[124:127], a[0:3], v[196:203], v12
    ds_read_b128 v[224:227], v2 offset:3072
    ds_read_b128 v[172:175], v9 offset:10432
    s_waitcnt lgkmcnt(6)
    v_cndmask_b32_dpp v164, v160, v168, vcc row_ror:8 row_mask:0xf bank_mask:0xf
    v_smfmac_f32_16x16x64_bf16 v[124:127], a[36:39], v[204:211], v16
    ds_read_b128 v[228:231], v1 offset:4096
    s_waitcnt lgkmcnt(5)
    v_cndmask_b32_dpp v165, v161, v169, vcc row_ror:8 row_mask:0xf bank_mask:0xf
    v_smfmac_f32_16x16x64_bf16 v[124:127], a[72:75], v[212:219], v20
    ds_read_b128 v[232:235], v2 offset:4096
    s_waitcnt lgkmcnt(5)
    v_xad_u32 v236, v236, v3, v4
    v_smfmac_f32_16x16x64_bf16 v[156:159], a[32:35], v[196:203], v48
    s_barrier
    v_xad_u32 v237, v237, v3, v4
    v_smfmac_f32_16x16x64_bf16 v[156:159], a[68:71], v[204:211], v48 abid:1
    ds_read2st64_b32 v[244:245], v236 offset0:0 offset1:72
    ds_read_b128 v[240:243], v8 offset:3072
    v_xad_u32 v238, v238, v3, v4
    v_smfmac_f32_16x16x64_bf16 v[156:159], a[104:107], v[212:219], v49
    ds_read2st64_b32 v[246:247], v237 offset0:0 offset1:72
    v_xad_u32 v239, v239, v3, v4
    v_smfmac_f32_16x16x64_bf16 v[132:135], a[8:11], v[196:203], v13
    ds_read2st64_b32 v[248:249], v238 offset0:0 offset1:72
    v_cndmask_b32_dpp v166, v162, v170, vcc row_ror:8 row_mask:0xf bank_mask:0xf
    v_smfmac_f32_16x16x64_bf16 v[132:135], a[44:47], v[204:211], v17
    ds_read2st64_b32 v[250:251], v239 offset0:0 offset1:72
    ds_read_b128 v[236:239], v9 offset:9280
    v_cndmask_b32_dpp v167, v163, v171, vcc row_ror:8 row_mask:0xf bank_mask:0xf
    v_smfmac_f32_16x16x64_bf16 v[132:135], a[80:83], v[212:219], v21
    buffer_store_dwordx4 v[164:167], v6, s[12:15], s58 offen offset:0 sc1
    v_mov_b32_dpp v160, v168 row_ror:8 row_mask:0xf bank_mask:0xc
    v_smfmac_f32_16x16x64_bf16 v[140:143], a[16:19], v[196:203], v14
    v_mov_b32_dpp v161, v169 row_ror:8 row_mask:0xf bank_mask:0xc
    v_smfmac_f32_16x16x64_bf16 v[140:143], a[52:55], v[204:211], v18
    v_mov_b32_dpp v162, v170 row_ror:8 row_mask:0xf bank_mask:0xc
    v_smfmac_f32_16x16x64_bf16 v[140:143], a[88:91], v[212:219], v22
    v_mov_b32_dpp v163, v171 row_ror:8 row_mask:0xf bank_mask:0xc
    v_smfmac_f32_16x16x64_bf16 v[136:139], a[12:15], v[196:203], v13 abid:1
    buffer_store_dwordx4 v[160:163], v6, s[12:15], s23 offen offset:0 sc1
    ds_read_b128 v[164:167], v9 offset:10304
    ds_read_b128 v[168:171], v9 offset:10368
    v_smfmac_f32_16x16x64_bf16 v[136:139], a[48:51], v[204:211], v17 abid:1
    ds_read_b128 v[160:163], v9 offset:10240
    v_smfmac_f32_16x16x64_bf16 v[136:139], a[84:87], v[212:219], v21 abid:1
    s_waitcnt lgkmcnt(3)
    v_xad_u32 v236, v236, v3, v4
    v_smfmac_f32_16x16x64_bf16 v[136:139], v[240:243], v[244:251], v10
    v_xad_u32 v237, v237, v3, v4
    v_smfmac_f32_16x16x64_bf16 v[172:175], v[240:243], v[244:251], v10 abid:1
    ds_read2st64_b32 v[244:245], v236 offset0:0 offset1:72
    ds_read_b128 v[240:243], v8 offset:1024
    v_xad_u32 v238, v238, v3, v4
    v_smfmac_f32_16x16x64_bf16 v[144:147], a[20:23], v[196:203], v14 abid:1
    ds_read2st64_b32 v[246:247], v237 offset0:0 offset1:72
    v_xad_u32 v239, v239, v3, v4
    v_smfmac_f32_16x16x64_bf16 v[144:147], a[56:59], v[204:211], v18 abid:1
    ds_read2st64_b32 v[248:249], v238 offset0:0 offset1:72
    v_smfmac_f32_16x16x64_bf16 v[144:147], a[92:95], v[212:219], v22 abid:1
    ds_read2st64_b32 v[250:251], v239 offset0:0 offset1:72
    ds_read_b128 v[236:239], v9 offset:9344
    v_smfmac_f32_16x16x64_bf16 v[148:151], a[24:27], v[196:203], v15
    v_cvt_pk_bf16_f32 v192, v192, v193
    v_smfmac_f32_16x16x64_bf16 v[148:151], a[60:63], v[204:211], v19
    v_cvt_pk_bf16_f32 v193, v194, v195
    v_smfmac_f32_16x16x64_bf16 v[148:151], a[96:99], v[212:219], v23
    ds_write_b64 v53, v[192:193] offset:0
    ds_read_b128 v[192:195], v9 offset:10752
    v_smfmac_f32_16x16x64_bf16 v[152:155], a[28:31], v[196:203], v15 abid:1
    v_smfmac_f32_16x16x64_bf16 v[152:155], a[64:67], v[204:211], v19 abid:1
    v_smfmac_f32_16x16x64_bf16 v[152:155], a[100:103], v[212:219], v23 abid:1
    v_smfmac_f32_16x16x64_bf16 v[128:131], a[4:7], v[196:203], v12 abid:1
    v_smfmac_f32_16x16x64_bf16 v[128:131], a[40:43], v[204:211], v16 abid:1
    v_smfmac_f32_16x16x64_bf16 v[128:131], a[76:79], v[212:219], v20 abid:1
    s_waitcnt lgkmcnt(2)
    v_xad_u32 v236, v236, v3, v4
    v_smfmac_f32_16x16x64_bf16 v[128:131], v[240:243], v[244:251], v10
    v_xad_u32 v237, v237, v3, v4
    v_smfmac_f32_16x16x64_bf16 v[164:167], v[240:243], v[244:251], v10 abid:1
    ds_read2st64_b32 v[244:245], v236 offset0:0 offset1:72
    ds_read_b128 v[240:243], v8 offset:2048
    v_xad_u32 v238, v238, v3, v4
    v_smfmac_f32_16x16x64_bf16 v[124:127], a[108:111], v[220:227], v24
    ds_read2st64_b32 v[246:247], v237 offset0:0 offset1:72
    v_xad_u32 v239, v239, v3, v4
    v_smfmac_f32_16x16x64_bf16 v[124:127], a[144:147], v[228:235], v28
    ds_read2st64_b32 v[248:249], v238 offset0:0 offset1:72
    ds_read_b64 v[216:217], v9 offset:10056
    v_cvt_pk_bf16_f32 v176, v176, v177
    v_smfmac_f32_16x16x64_bf16 v[128:131], a[112:115], v[220:227], v24 abid:1
    ds_read2st64_b32 v[250:251], v239 offset0:0 offset1:72
    ds_read_b128 v[236:239], v9 offset:9216
    v_cvt_pk_bf16_f32 v177, v178, v179
    v_smfmac_f32_16x16x64_bf16 v[128:131], a[148:151], v[228:235], v28 abid:1
    v_cvt_pk_bf16_f32 v178, v180, v181
    v_smfmac_f32_16x16x64_bf16 v[140:143], a[124:127], v[220:227], v26
    v_cvt_pk_bf16_f32 v179, v182, v183
    v_smfmac_f32_16x16x64_bf16 v[140:143], a[160:163], v[228:235], v30
    v_cvt_pk_bf16_f32 v184, v184, v185
    v_smfmac_f32_16x16x64_bf16 v[136:139], a[120:123], v[220:227], v25 abid:1
    v_cvt_pk_bf16_f32 v185, v186, v187
    v_smfmac_f32_16x16x64_bf16 v[136:139], a[156:159], v[228:235], v29 abid:1
    ds_read_b128 v[196:199], v1 offset:5120
    v_cvt_pk_bf16_f32 v186, v188, v189
    v_smfmac_f32_16x16x64_bf16 v[132:135], a[116:119], v[220:227], v25
    ds_read_b128 v[200:203], v2 offset:5120
    v_cvt_pk_bf16_f32 v187, v190, v191
    v_smfmac_f32_16x16x64_bf16 v[132:135], a[152:155], v[228:235], v29
    ds_read_b128 v[188:191], v9 offset:10688
    s_waitcnt lgkmcnt(3)
    v_xad_u32 v236, v236, v3, v4
    v_smfmac_f32_16x16x64_bf16 v[132:135], v[240:243], v[244:251], v10
    ds_read_b128 v[204:207], v1 offset:6144
    v_xad_u32 v237, v237, v3, v4
    v_smfmac_f32_16x16x64_bf16 v[168:171], v[240:243], v[244:251], v10 abid:1
    ds_read2st64_b32 v[244:245], v236 offset0:0 offset1:72
    ds_read_b128 v[240:243], v8 offset:0
    v_xad_u32 v238, v238, v3, v4
    v_smfmac_f32_16x16x64_bf16 v[144:147], a[128:131], v[220:227], v26 abid:1
    ds_read2st64_b32 v[246:247], v237 offset0:0 offset1:72
    v_xad_u32 v239, v239, v3, v4
    v_smfmac_f32_16x16x64_bf16 v[144:147], a[164:167], v[228:235], v30 abid:1
    ds_read2st64_b32 v[248:249], v238 offset0:0 offset1:72
    ds_read_b128 v[208:211], v2 offset:6144
    v_cndmask_b32_dpp v180, v176, v184, vcc row_ror:8 row_mask:0xf bank_mask:0xf
    v_smfmac_f32_16x16x64_bf16 v[148:151], a[132:135], v[220:227], v27
    ds_read2st64_b32 v[250:251], v239 offset0:0 offset1:72
    ds_read_b128 v[236:239], v9 offset:9728
    v_cndmask_b32_dpp v181, v177, v185, vcc row_ror:8 row_mask:0xf bank_mask:0xf
    v_smfmac_f32_16x16x64_bf16 v[148:151], a[168:171], v[228:235], v31
    v_xad_u32 v212, v216, v3, v4
    v_smfmac_f32_16x16x64_bf16 v[152:155], a[136:139], v[220:227], v27 abid:1
    ds_read2st64_b32 v[212:213], v212 offset0:0 offset1:72
    v_xad_u32 v214, v217, v3, v4
    v_smfmac_f32_16x16x64_bf16 v[152:155], a[172:175], v[228:235], v31 abid:1
    ds_read2st64_b32 v[214:215], v214 offset0:0 offset1:72
    v_cndmask_b32_dpp v182, v178, v186, vcc row_ror:8 row_mask:0xf bank_mask:0xf
    v_smfmac_f32_16x16x64_bf16 v[156:159], a[140:143], v[220:227], v49 abid:1
    v_cndmask_b32_dpp v183, v179, v187, vcc row_ror:8 row_mask:0xf bank_mask:0xf
    v_smfmac_f32_16x16x64_bf16 v[156:159], a[176:179], v[228:235], v50
    buffer_store_dwordx4 v[180:183], v6, s[12:15], s58 offen offset:128 sc1
    s_waitcnt lgkmcnt(11)
    v_mov_b32_dpp v176, v184 row_ror:8 row_mask:0xf bank_mask:0xc
    v_smfmac_f32_16x16x64_bf16 v[128:131], a[184:187], v[196:203], v32 abid:1
    s_waitcnt lgkmcnt(4)
    v_mov_b32_dpp v177, v185 row_ror:8 row_mask:0xf bank_mask:0xc
    v_smfmac_f32_16x16x64_bf16 v[128:131], a[220:223], v[204:211], v36 abid:1
    v_mov_b32_dpp v178, v186 row_ror:8 row_mask:0xf bank_mask:0xc
    v_smfmac_f32_16x16x64_bf16 v[124:127], a[180:183], v[196:203], v32
    ds_read_b128 v[220:223], v1 offset:7168
    v_mov_b32_dpp v179, v187 row_ror:8 row_mask:0xf bank_mask:0xc
    v_smfmac_f32_16x16x64_bf16 v[124:127], a[216:219], v[204:211], v36
    buffer_store_dwordx4 v[176:179], v6, s[12:15], s23 offen offset:128 sc1
    s_waitcnt lgkmcnt(3)
    v_xad_u32 v236, v236, v3, v4
    v_smfmac_f32_16x16x64_bf16 v[124:127], v[240:243], v[244:251], v10
    ds_read_b128 v[224:227], v2 offset:7168
    ds_read_b128 v[180:183], v9 offset:10560
    v_xad_u32 v237, v237, v3, v4
    v_smfmac_f32_16x16x64_bf16 v[160:163], v[240:243], v[244:251], v10 abid:1
    ds_read2st64_b32 v[244:245], v236 offset0:0 offset1:72
    ds_read_b128 v[240:243], v8 offset:8192
    v_xad_u32 v238, v238, v3, v4
    v_smfmac_f32_16x16x64_bf16 v[132:135], a[188:191], v[196:203], v33
    ds_read2st64_b32 v[246:247], v237 offset0:0 offset1:72
    ds_read_b128 v[184:187], v9 offset:10624
    v_xad_u32 v239, v239, v3, v4
    v_smfmac_f32_16x16x64_bf16 v[132:135], a[224:227], v[204:211], v37
    ds_read2st64_b32 v[248:249], v238 offset0:0 offset1:72
    ds_read_b128 v[176:179], v9 offset:10496
    v_smfmac_f32_16x16x64_bf16 v[136:139], a[192:195], v[196:203], v33 abid:1
    ds_read2st64_b32 v[250:251], v239 offset0:0 offset1:72
    ds_read_b128 v[236:239], v9 offset:9664
    v_smfmac_f32_16x16x64_bf16 v[136:139], a[228:231], v[204:211], v37 abid:1
    v_smfmac_f32_16x16x64_bf16 v[140:143], a[196:199], v[196:203], v34
    v_smfmac_f32_16x16x64_bf16 v[140:143], a[232:235], v[204:211], v38
    ds_read_b128 v[228:231], v1 offset:8192
    v_smfmac_f32_16x16x64_bf16 v[144:147], a[200:203], v[196:203], v34 abid:1
    ds_read_b128 v[232:235], v2 offset:8192
    v_smfmac_f32_16x16x64_bf16 v[144:147], a[236:239], v[204:211], v38 abid:1
    s_waitcnt lgkmcnt(4)
    s_cmp_lt_i32 s81, 0
    s_cbranch_scc1 M_ovrF
    s_swappc_b64 s[78:79], s[72:73]
M_ovrF:
    v_smfmac_f32_16x16x64_bf16 v[156:159], a[212:215], v[196:203], v50 abid:1
    v_smfmac_f32_16x16x64_bf16 v[156:159], a[248:251], v[204:211], v51
    s_waitcnt lgkmcnt(2)
    v_xad_u32 v236, v236, v3, v4
    v_smfmac_f32_16x16x64_bf16 v[156:159], v[240:243], v[244:251], v10
    v_xad_u32 v237, v237, v3, v4
    v_smfmac_f32_16x16x64_bf16 v[192:195], v[240:243], v[244:251], v10 abid:1
    ds_read2st64_b32 v[244:245], v236 offset0:0 offset1:72
    ds_read_b128 v[240:243], v8 offset:7168
    v_xad_u32 v238, v238, v3, v4
    v_smfmac_f32_16x16x64_bf16 v[152:155], a[208:211], v[196:203], v35 abid:1
    ds_read2st64_b32 v[246:247], v237 offset0:0 offset1:72
    v_xad_u32 v239, v239, v3, v4
    v_smfmac_f32_16x16x64_bf16 v[152:155], a[244:247], v[204:211], v39 abid:1
    ds_read2st64_b32 v[248:249], v238 offset0:0 offset1:72
    v_smfmac_f32_16x16x64_bf16 v[148:151], a[204:207], v[196:203], v35
    ds_read2st64_b32 v[250:251], v239 offset0:0 offset1:72
    ds_read_b128 v[236:239], v9 offset:9536
    v_smfmac_f32_16x16x64_bf16 v[148:151], a[240:243], v[204:211], v39
    v_smfmac_f32_16x16x64_bf16 v[124:127], a[252:255], v[220:227], v40
    s_waitcnt lgkmcnt(6)
    v_smfmac_f32_16x16x64_bf16 v[124:127], v[88:91], v[228:235], v44
    v_smfmac_f32_16x16x64_bf16 v[128:131], v[56:59], v[220:227], v40 abid:1
    v_smfmac_f32_16x16x64_bf16 v[128:131], v[92:95], v[228:235], v44 abid:1
    s_cmp_lt_u32 s20, 2
    s_cselect_b32 s66, s23, s24
    s_add_u32 s66, s66, s95
    v_smfmac_f32_16x16x64_bf16 v[132:135], v[60:63], v[220:227], v41
    ds_read_b128 v[196:199], v1 offset:18432
    s_add_u32 s23, s24, 18432
    s_add_u32 s58, s24, 27648
    v_smfmac_f32_16x16x64_bf16 v[132:135], v[96:99], v[228:235], v45
    ds_read_b128 v[200:203], v2 offset:18432
    s_add_u32 s67, s23, s95
    v_smfmac_f32_16x16x64_bf16 v[152:155], v[80:83], v[220:227], v43 abid:1
    ds_read_b128 v[204:207], v1 offset:19456
    v_smfmac_f32_16x16x64_bf16 v[152:155], v[116:119], v[228:235], v47 abid:1
    s_waitcnt lgkmcnt(3)
    v_xad_u32 v236, v236, v3, v4
    v_smfmac_f32_16x16x64_bf16 v[152:155], v[240:243], v[244:251], v10
    ds_read_b128 v[208:211], v2 offset:19456
    v_xad_u32 v237, v237, v3, v4
    v_smfmac_f32_16x16x64_bf16 v[188:191], v[240:243], v[244:251], v10 abid:1
    s_cmp_gt_u32 s46, s80
    s_cbranch_scc1 M_slow
M_slowrF:
    v_xad_u32 v238, v238, v3, v4
    v_smfmac_f32_16x16x64_bf16 v[140:143], v[68:71], v[220:227], v42
    ds_read2st64_b32 v[244:245], v236 offset0:0 offset1:72
    ds_read_b128 v[240:243], v8 offset:5120
    v_xad_u32 v239, v239, v3, v4
    v_smfmac_f32_16x16x64_bf16 v[140:143], v[104:107], v[228:235], v46
    ds_read2st64_b32 v[246:247], v237 offset0:0 offset1:72
    v_smfmac_f32_16x16x64_bf16 v[156:159], v[84:87], v[220:227], v51 abid:1
    ds_read2st64_b32 v[248:249], v238 offset0:0 offset1:72
    ds_read_b128 v[212:215], v1 offset:20480
    v_smfmac_f32_16x16x64_bf16 v[156:159], v[120:123], v[228:235], v52
    ds_read2st64_b32 v[250:251], v239 offset0:0 offset1:72
    ds_read_b128 v[236:239], v9 offset:9600
    v_smfmac_f32_16x16x64_bf16 v[148:151], v[76:79], v[220:227], v43
    ds_read_b128 v[216:219], v2 offset:20480
    v_smfmac_f32_16x16x64_bf16 v[148:151], v[112:115], v[228:235], v47
    v_smfmac_f32_16x16x64_bf16 v[136:139], v[64:67], v[220:227], v41 abid:1
    v_smfmac_f32_16x16x64_bf16 v[136:139], v[100:103], v[228:235], v45 abid:1
    v_smfmac_f32_16x16x64_bf16 v[144:147], v[72:75], v[220:227], v42 abid:1
    v_smfmac_f32_16x16x64_bf16 v[144:147], v[108:111], v[228:235], v46 abid:1
    ds_read_b128 v[220:223], v1 offset:21504
    s_waitcnt lgkmcnt(2)
    v_xad_u32 v236, v236, v3, v4
    v_smfmac_f32_16x16x64_bf16 v[144:147], v[240:243], v[244:251], v10
    ds_read_b128 v[224:227], v2 offset:21504
    v_xad_u32 v237, v237, v3, v4
    v_smfmac_f32_16x16x64_bf16 v[180:183], v[240:243], v[244:251], v10 abid:1
    ds_read2st64_b32 v[244:245], v236 offset0:0 offset1:72
    ds_read_b128 v[240:243], v8 offset:6144
    v_xad_u32 v238, v238, v3, v4
    v_smfmac_f32_16x16x64_bf16 v[192:195], a[32:35], v[196:203], v48
    ds_read2st64_b32 v[246:247], v237 offset0:0 offset1:72
    ds_read_b128 v[228:231], v1 offset:22528
    v_xad_u32 v239, v239, v3, v4
    v_smfmac_f32_16x16x64_bf16 v[192:195], a[68:71], v[204:211], v48 abid:1
    ds_read2st64_b32 v[248:249], v238 offset0:0 offset1:72
    ds_read_b128 v[232:235], v2 offset:22528
    s_waitcnt lgkmcnt(8)
    v_cvt_pk_bf16_f32 v124, v124, v125
    v_smfmac_f32_16x16x64_bf16 v[192:195], a[104:107], v[212:219], v49
    ds_read2st64_b32 v[250:251], v239 offset0:0 offset1:72
    ds_read_b128 v[236:239], v9 offset:9472
    v_cvt_pk_bf16_f32 v125, v126, v127
    v_smfmac_f32_16x16x64_bf16 v[160:163], a[0:3], v[196:203], v12
    v_cvt_pk_bf16_f32 v126, v128, v129
    v_smfmac_f32_16x16x64_bf16 v[160:163], a[36:39], v[204:211], v16
    v_cvt_pk_bf16_f32 v127, v130, v131
    v_smfmac_f32_16x16x64_bf16 v[160:163], a[72:75], v[212:219], v20
    v_cvt_pk_bf16_f32 v156, v156, v157
    v_smfmac_f32_16x16x64_bf16 v[164:167], a[4:7], v[196:203], v12 abid:1
    v_cvt_pk_bf16_f32 v157, v158, v159
    v_smfmac_f32_16x16x64_bf16 v[164:167], a[40:43], v[204:211], v16 abid:1
    ds_write_b64 v53, v[156:157] offset:25728
    v_cvt_pk_bf16_f32 v132, v132, v133
    v_smfmac_f32_16x16x64_bf16 v[164:167], a[76:79], v[212:219], v20 abid:1
    v_cvt_pk_bf16_f32 v133, v134, v135
    v_smfmac_f32_16x16x64_bf16 v[168:171], a[8:11], v[196:203], v13
    v_cvt_pk_bf16_f32 v134, v136, v137
    v_smfmac_f32_16x16x64_bf16 v[168:171], a[44:47], v[204:211], v17
    v_cvt_pk_bf16_f32 v135, v138, v139
    v_smfmac_f32_16x16x64_bf16 v[168:171], a[80:83], v[212:219], v21
    s_waitcnt lgkmcnt(1)
    v_xad_u32 v236, v236, v3, v4
    v_smfmac_f32_16x16x64_bf16 v[184:187], v[240:243], v[244:251], v10 abid:1
    v_xad_u32 v237, v237, v3, v4
    v_smfmac_f32_16x16x64_bf16 v[148:151], v[240:243], v[244:251], v10
    ds_read2st64_b32 v[244:245], v236 offset0:0 offset1:72
    ds_read_b128 v[240:243], v8 offset:4096
    v_xad_u32 v238, v238, v3, v4
    v_smfmac_f32_16x16x64_bf16 v[172:175], a[12:15], v[196:203], v13 abid:1
    ds_read2st64_b32 v[246:247], v237 offset0:0 offset1:72
    v_xad_u32 v239, v239, v3, v4
    v_smfmac_f32_16x16x64_bf16 v[172:175], a[48:51], v[204:211], v17 abid:1
    ds_read2st64_b32 v[248:249], v238 offset0:0 offset1:72
    v_cndmask_b32_dpp v128, v124, v132, vcc row_ror:8 row_mask:0xf bank_mask:0xf
    v_smfmac_f32_16x16x64_bf16 v[172:175], a[84:87], v[212:219], v21 abid:1
    ds_read2st64_b32 v[250:251], v239 offset0:0 offset1:72
    ds_read_b128 v[196:199], v1 offset:23552
    v_cndmask_b32_dpp v129, v125, v133, vcc row_ror:8 row_mask:0xf bank_mask:0xf
    v_smfmac_f32_16x16x64_bf16 v[192:195], a[140:143], v[220:227], v49 abid:1
    ds_read_b128 v[200:203], v2 offset:23552
    v_cndmask_b32_dpp v130, v126, v134, vcc row_ror:8 row_mask:0xf bank_mask:0xf
    v_smfmac_f32_16x16x64_bf16 v[192:195], a[176:179], v[228:235], v50
    ds_read_b128 v[204:207], v1 offset:24576
    v_cndmask_b32_dpp v131, v127, v135, vcc row_ror:8 row_mask:0xf bank_mask:0xf
    v_smfmac_f32_16x16x64_bf16 v[160:163], a[108:111], v[220:227], v24
    ds_read_b128 v[208:211], v2 offset:24576
    buffer_store_dwordx4 v[128:131], v6, s[12:15], s59 offen offset:0 sc1
    v_mov_b32_dpp v124, v132 row_ror:8 row_mask:0xf bank_mask:0xc
    v_smfmac_f32_16x16x64_bf16 v[160:163], a[144:147], v[228:235], v28
    s_waitcnt lgkmcnt(9)
    s_barrier
    ds_read_b128 v[236:239], v8 offset:10816
    v_mov_b32_dpp v125, v133 row_ror:8 row_mask:0xf bank_mask:0xc
    v_smfmac_f32_16x16x64_bf16 v[164:167], a[112:115], v[220:227], v24 abid:1
    ds_read_b128 v[212:215], v1 offset:20480
    v_mov_b32_dpp v126, v134 row_ror:8 row_mask:0xf bank_mask:0xc
    v_smfmac_f32_16x16x64_bf16 v[164:167], a[148:151], v[228:235], v28 abid:1
    ds_read_b128 v[216:219], v2 offset:20480
    v_mov_b32_dpp v127, v135 row_ror:8 row_mask:0xf bank_mask:0xc
    v_smfmac_f32_16x16x64_bf16 v[168:171], a[116:119], v[220:227], v25
    buffer_store_dwordx4 v[124:127], v6, s[12:15], s24 offen offset:0 sc1
    v_smfmac_f32_16x16x64_bf16 v[168:171], a[152:155], v[228:235], v29
    s_waitcnt lgkmcnt(7)
    v_smfmac_f32_16x16x64_bf16 v[176:179], v[240:243], v[244:251], v10 abid:1
    v_smfmac_f32_16x16x64_bf16 v[140:143], v[240:243], v[244:251], v10
    s_waitcnt lgkmcnt(2)
    buffer_store_dwordx4 v[236:239], v7, s[12:15], s66 offen sc1
    v_smfmac_f32_16x16x64_bf16 v[172:175], a[120:123], v[220:227], v25 abid:1
    v_smfmac_f32_16x16x64_bf16 v[172:175], a[156:159], v[228:235], v29 abid:1
    ds_read_b128 v[220:223], v1 offset:25600
    v_smfmac_f32_16x16x64_bf16 v[192:195], a[212:215], v[196:203], v50 abid:1
    ds_read_b128 v[224:227], v2 offset:25600
    s_nop 0
    v_cvt_pk_bf16_f32 v140, v140, v141
    v_smfmac_f32_16x16x64_bf16 v[192:195], a[248:251], v[204:211], v51
    ds_read_b128 v[228:231], v1 offset:26624
    v_cvt_pk_bf16_f32 v141, v142, v143
    v_smfmac_f32_16x16x64_bf16 v[160:163], a[180:183], v[196:203], v32
    ds_read_b128 v[232:235], v2 offset:26624
    v_cvt_pk_bf16_f32 v142, v144, v145
    v_smfmac_f32_16x16x64_bf16 v[160:163], a[216:219], v[204:211], v36
    v_cvt_pk_bf16_f32 v143, v146, v147
    v_smfmac_f32_16x16x64_bf16 v[164:167], a[184:187], v[196:203], v32 abid:1
    v_cvt_pk_bf16_f32 v148, v148, v149
    v_smfmac_f32_16x16x64_bf16 v[164:167], a[220:223], v[204:211], v36 abid:1
    v_cvt_pk_bf16_f32 v149, v150, v151
    v_smfmac_f32_16x16x64_bf16 v[168:171], a[188:191], v[196:203], v33
    v_cvt_pk_bf16_f32 v150, v152, v153
    v_smfmac_f32_16x16x64_bf16 v[168:171], a[224:227], v[204:211], v37
    v_cvt_pk_bf16_f32 v151, v154, v155
    v_smfmac_f32_16x16x64_bf16 v[172:175], a[192:195], v[196:203], v33 abid:1
    v_cndmask_b32_dpp v144, v140, v148, vcc row_ror:8 row_mask:0xf bank_mask:0xf
    v_smfmac_f32_16x16x64_bf16 v[172:175], a[228:231], v[204:211], v37 abid:1
    ds_read_b128 v[196:199], v1 offset:18432
    s_waitcnt lgkmcnt(3)
    v_cndmask_b32_dpp v145, v141, v149, vcc row_ror:8 row_mask:0xf bank_mask:0xf
    v_smfmac_f32_16x16x64_bf16 v[192:195], v[84:87], v[220:227], v51 abid:1
    ds_read_b128 v[200:203], v2 offset:18432
    s_waitcnt lgkmcnt(2)
    v_cndmask_b32_dpp v146, v142, v150, vcc row_ror:8 row_mask:0xf bank_mask:0xf
    v_smfmac_f32_16x16x64_bf16 v[192:195], v[120:123], v[228:235], v52
    ds_read_b128 v[204:207], v1 offset:19456
    v_cndmask_b32_dpp v147, v143, v151, vcc row_ror:8 row_mask:0xf bank_mask:0xf
    v_smfmac_f32_16x16x64_bf16 v[160:163], a[252:255], v[220:227], v40
    ds_read_b128 v[208:211], v2 offset:19456
    buffer_store_dwordx4 v[144:147], v6, s[12:15], s59 offen offset:128 sc1
    v_mov_b32_dpp v140, v148 row_ror:8 row_mask:0xf bank_mask:0xc
    v_smfmac_f32_16x16x64_bf16 v[160:163], v[88:91], v[228:235], v44
    v_mov_b32_dpp v141, v149 row_ror:8 row_mask:0xf bank_mask:0xc
    v_smfmac_f32_16x16x64_bf16 v[164:167], v[56:59], v[220:227], v40 abid:1
    v_mov_b32_dpp v142, v150 row_ror:8 row_mask:0xf bank_mask:0xc
    v_smfmac_f32_16x16x64_bf16 v[164:167], v[92:95], v[228:235], v44 abid:1
    v_mov_b32_dpp v143, v151 row_ror:8 row_mask:0xf bank_mask:0xc
    v_smfmac_f32_16x16x64_bf16 v[168:171], v[60:63], v[220:227], v41
    buffer_store_dwordx4 v[140:143], v6, s[12:15], s24 offen offset:128 sc1
    v_cvt_pk_bf16_f32 v192, v192, v193
    v_smfmac_f32_16x16x64_bf16 v[168:171], v[96:99], v[228:235], v45
    v_cvt_pk_bf16_f32 v193, v194, v195
    v_smfmac_f32_16x16x64_bf16 v[172:175], v[64:67], v[220:227], v41 abid:1
    ds_write_b64 v53, v[192:193] offset:1024
    v_smfmac_f32_16x16x64_bf16 v[172:175], v[100:103], v[228:235], v45 abid:1
    ds_read_b128 v[220:223], v1 offset:21504
    s_waitcnt lgkmcnt(4)
    v_smfmac_f32_16x16x64_bf16 v[176:179], a[16:19], v[196:203], v14
    ds_read_b128 v[224:227], v2 offset:21504
    s_waitcnt lgkmcnt(3)
    v_smfmac_f32_16x16x64_bf16 v[176:179], a[52:55], v[204:211], v18
    ds_read_b128 v[228:231], v1 offset:22528
    v_smfmac_f32_16x16x64_bf16 v[176:179], a[88:91], v[212:219], v22
    ds_read_b128 v[232:235], v2 offset:22528
    s_waitcnt lgkmcnt(4)
    s_barrier
    ds_read_b128 v[236:239], v8 offset:11840
    v_smfmac_f32_16x16x64_bf16 v[180:183], a[20:23], v[196:203], v14 abid:1
    v_cvt_pk_bf16_f32 v160, v160, v161
    v_smfmac_f32_16x16x64_bf16 v[180:183], a[56:59], v[204:211], v18 abid:1
    v_cvt_pk_bf16_f32 v161, v162, v163
    v_smfmac_f32_16x16x64_bf16 v[180:183], a[92:95], v[212:219], v22 abid:1
    v_cvt_pk_bf16_f32 v162, v164, v165
    v_smfmac_f32_16x16x64_bf16 v[184:187], a[24:27], v[196:203], v15
    v_cvt_pk_bf16_f32 v163, v166, v167
    v_smfmac_f32_16x16x64_bf16 v[184:187], a[60:63], v[204:211], v19
    v_cvt_pk_bf16_f32 v168, v168, v169
    v_smfmac_f32_16x16x64_bf16 v[184:187], a[96:99], v[212:219], v23
    s_cmp_lt_u32 s20, 2
    s_waitcnt lgkmcnt(0)
    s_cbranch_scc0 M_fx
    buffer_store_dwordx4 v[236:239], v7, s[12:15], s67 offen sc1
M_fx:
    v_smfmac_f32_16x16x64_bf16 v[188:191], a[28:31], v[196:203], v15 abid:1
    v_cvt_pk_bf16_f32 v169, v170, v171
    v_smfmac_f32_16x16x64_bf16 v[188:191], a[64:67], v[204:211], v19 abid:1
    v_cvt_pk_bf16_f32 v170, v172, v173
    v_smfmac_f32_16x16x64_bf16 v[188:191], a[100:103], v[212:219], v23 abid:1
    ds_read_b128 v[196:199], v1 offset:23552
    v_cvt_pk_bf16_f32 v171, v174, v175
    v_smfmac_f32_16x16x64_bf16 v[176:179], a[124:127], v[220:227], v26
    ds_read_b128 v[200:203], v2 offset:23552
    v_cndmask_b32_dpp v164, v160, v168, vcc row_ror:8 row_mask:0xf bank_mask:0xf
    v_smfmac_f32_16x16x64_bf16 v[176:179], a[160:163], v[228:235], v30
    ds_read_b128 v[204:207], v1 offset:24576
    v_cndmask_b32_dpp v165, v161, v169, vcc row_ror:8 row_mask:0xf bank_mask:0xf
    v_smfmac_f32_16x16x64_bf16 v[180:183], a[128:131], v[220:227], v26 abid:1
    ds_read_b128 v[208:211], v2 offset:24576
    v_cndmask_b32_dpp v166, v162, v170, vcc row_ror:8 row_mask:0xf bank_mask:0xf
    v_smfmac_f32_16x16x64_bf16 v[180:183], a[164:167], v[228:235], v30 abid:1
    v_cndmask_b32_dpp v167, v163, v171, vcc row_ror:8 row_mask:0xf bank_mask:0xf
    v_smfmac_f32_16x16x64_bf16 v[184:187], a[132:135], v[220:227], v27
    buffer_store_dwordx4 v[164:167], v6, s[12:15], s58 offen offset:0 sc1
    v_mov_b32_dpp v160, v168 row_ror:8 row_mask:0xf bank_mask:0xc
    v_smfmac_f32_16x16x64_bf16 v[184:187], a[168:171], v[228:235], v31
    v_mov_b32_dpp v161, v169 row_ror:8 row_mask:0xf bank_mask:0xc
    v_smfmac_f32_16x16x64_bf16 v[188:191], a[136:139], v[220:227], v27 abid:1
    v_mov_b32_dpp v162, v170 row_ror:8 row_mask:0xf bank_mask:0xc
    v_smfmac_f32_16x16x64_bf16 v[188:191], a[172:175], v[228:235], v31 abid:1
    ds_read_b128 v[220:223], v1 offset:25600
    s_waitcnt lgkmcnt(3)
    v_mov_b32_dpp v163, v171 row_ror:8 row_mask:0xf bank_mask:0xc
    v_smfmac_f32_16x16x64_bf16 v[176:179], a[196:199], v[196:203], v34
    ds_read_b128 v[224:227], v2 offset:25600
    buffer_store_dwordx4 v[160:163], v6, s[12:15], s23 offen offset:0 sc1
    s_waitcnt lgkmcnt(2)
    v_smfmac_f32_16x16x64_bf16 v[176:179], a[232:235], v[204:211], v38
    ds_read_b128 v[228:231], v1 offset:26624
    v_smfmac_f32_16x16x64_bf16 v[180:183], a[200:203], v[196:203], v34 abid:1
    ds_read_b128 v[232:235], v2 offset:26624
    v_smfmac_f32_16x16x64_bf16 v[180:183], a[236:239], v[204:211], v38 abid:1
    v_smfmac_f32_16x16x64_bf16 v[184:187], a[204:207], v[196:203], v35
    v_smfmac_f32_16x16x64_bf16 v[184:187], a[240:243], v[204:211], v39
    v_smfmac_f32_16x16x64_bf16 v[188:191], a[208:211], v[196:203], v35 abid:1
    v_smfmac_f32_16x16x64_bf16 v[188:191], a[244:247], v[204:211], v39 abid:1
    s_waitcnt lgkmcnt(2)
    v_smfmac_f32_16x16x64_bf16 v[176:179], v[68:71], v[220:227], v42
    s_waitcnt lgkmcnt(0)
    v_smfmac_f32_16x16x64_bf16 v[176:179], v[104:107], v[228:235], v46
    v_smfmac_f32_16x16x64_bf16 v[180:183], v[72:75], v[220:227], v42 abid:1
    v_smfmac_f32_16x16x64_bf16 v[180:183], v[108:111], v[228:235], v46 abid:1
    v_smfmac_f32_16x16x64_bf16 v[184:187], v[76:79], v[220:227], v43
    v_smfmac_f32_16x16x64_bf16 v[184:187], v[112:115], v[228:235], v47
    v_smfmac_f32_16x16x64_bf16 v[188:191], v[80:83], v[220:227], v43 abid:1
    v_smfmac_f32_16x16x64_bf16 v[188:191], v[116:119], v[228:235], v47 abid:1
    s_nop 1
    v_cvt_pk_bf16_f32 v176, v176, v177
    v_cvt_pk_bf16_f32 v177, v178, v179
    v_cvt_pk_bf16_f32 v178, v180, v181
    v_cvt_pk_bf16_f32 v179, v182, v183
    v_cvt_pk_bf16_f32 v184, v184, v185
    v_cvt_pk_bf16_f32 v185, v186, v187
    v_cvt_pk_bf16_f32 v186, v188, v189
    v_cvt_pk_bf16_f32 v187, v190, v191
    v_cndmask_b32_dpp v180, v176, v184, vcc row_ror:8 row_mask:0xf bank_mask:0xf
    v_cndmask_b32_dpp v181, v177, v185, vcc row_ror:8 row_mask:0xf bank_mask:0xf
    v_cndmask_b32_dpp v182, v178, v186, vcc row_ror:8 row_mask:0xf bank_mask:0xf
    v_cndmask_b32_dpp v183, v179, v187, vcc row_ror:8 row_mask:0xf bank_mask:0xf
    buffer_store_dwordx4 v[180:183], v6, s[12:15], s58 offen offset:128 sc1
    v_mov_b32_dpp v176, v184 row_ror:8 row_mask:0xf bank_mask:0xc
    v_mov_b32_dpp v177, v185 row_ror:8 row_mask:0xf bank_mask:0xc
    v_mov_b32_dpp v178, v186 row_ror:8 row_mask:0xf bank_mask:0xc
    v_mov_b32_dpp v179, v187 row_ror:8 row_mask:0xf bank_mask:0xc
    buffer_store_dwordx4 v[176:179], v6, s[12:15], s23 offen offset:128 sc1
M_done:
M_end:
    s_endpgm
M_pf_spin:
    s_sleep 4
    v_mov_b32 v0, 0
    s_mov_b64 exec, 1
    buffer_atomic_add v0, off, s[16:19], s96 sc0 sc1
    s_mov_b64 exec, -1
    s_add_u32 s31, s31, 1
    s_waitcnt vmcnt(0)
    v_readfirstlane_b32 s30, v0
    s_nop 0
    s_sub_u32 s30, s30, s100
    s_cmp_eq_u32 s30, 27
    s_cbranch_scc1 M_pf_ok
    s_cmp_lt_u32 s31, 6
    s_cbranch_scc1 M_pf_spin
    s_cmp_eq_u32 s98, 0
    s_cbranch_scc1 M_pf_spin2
    s_mov_b32 s98, 0
    v_mov_b32 v250, 1
    s_mov_b64 exec, 1
    buffer_atomic_add v250, off, s[68:71], 0 offset:0 sc1
    s_mov_b64 exec, -1
    s_nop 3
M_pf_spin2:
    buffer_load_dword v0, off, s[68:71], 0 offset:0 sc1
    s_cmp_ge_u32 s31, 131072
    s_cbranch_scc1 M_end
    s_waitcnt vmcnt(0)
    v_readfirstlane_b32 s30, v0
    s_nop 0
    s_cmp_eq_u32 s30, 81
    s_cbranch_scc0 M_pf_spin
    s_branch M_pf_ok
M_r3:
    v_bfe_u32 v110, v96, 24, 4
    v_lshlrev_b32 v111, 1, v96
    v_lshl_add_u32 v110, v110, 2, s49
    v_and_b32 v111, 16, v111
    v_and_or_b32 v110, v96, 2.0, v110
    v_lshlrev_b32 v111, v111, 1
    ds_add_rtn_u32 v100, v110, v111
    v_and_b32 v110, 8, v96
    v_lshrrev_b32 v113, 14, v96
    v_cmp_ne_u32 s[44:45], 0, v110
    v_and_b32 v116, 0x3cf0, v113
    s_waitcnt lgkmcnt(0)
    v_lshrrev_b32 v111, 16, v100
    v_and_b32 v112, 0xffff, v100
    v_sub_u32 v110, 15, v111
    v_and_b32 v100, 2.0, v96
    v_add3_u32 v100, v112, v111, v100
    v_cndmask_b32 v110, v112, v110, s[44:45]
    v_cmp_gt_u32 s[44:45], 16, v100
    v_cmp_gt_u32 s[36:37], 2.0, v100
    v_lshlrev_b32 v110, 2, v110
    v_lshrrev_b64 v[112:113], v110, s[50:51]
    s_andn2_b64 s[36:37], s[36:37], s[44:45]
    v_lshrrev_b64 v[114:115], v110, s[52:53]
    v_bfe_u32 v110, v96, 24, 4
    v_mbcnt_lo_u32_b32 v111, s36, 0
    v_and_b32 v112, 15, v112
    v_mbcnt_hi_u32_b32 v111, s37, v111
    v_and_b32 v114, 15, v114
    v_lshl_add_u32 v111, v111, 3, s40
    v_lshl_add_u32 v112, v110, 4, v112
    v_min_u32 v111, s41, v111
    v_mul_u32_u24 v114, 68, v114
    v_cndmask_b32 v111, v118, v111, s[36:37]
    ds_write_b64 v111, v[96:97]
    s_bcnt1_i32_b64 s30, s[36:37]
    s_lshl3_add_u32 s40, s30, s40
    v_lshl_add_u32 v112, v112, 2, s47
    v_and_b32 v114, 0x30c, v114
    v_cndmask_b32 v112, v118, v112, s[44:45]
    v_add3_u32 v113, v116, v114, s29
    v_and_b32 v114, 0x3fff, v96
    v_cndmask_b32 v110, v118, v113, s[44:45]
    ds_write_b32 v112, v114
    ds_write_b32 v110, v97
    s_cmp_gt_u32 s38, s39
    s_cselect_b32 s32, 1, s32
    s_branch M_r3r
M_dn:
    s_mov_b32 s27, 0
    s_mov_b32 s46, 0x80000000
    v_mov_b32 v244, 0
    v_mov_b32 v245, 0
    v_mov_b32 v246, 0
    v_mov_b32 v247, 0
    ds_write_b128 v8, v[244:247] offset:0
    ds_write_b128 v8, v[244:247] offset:1024
    ds_write_b128 v8, v[244:247] offset:2048
    ds_write_b128 v8, v[244:247] offset:3072
    ds_write_b128 v8, v[244:247] offset:4096
    ds_write_b128 v8, v[244:247] offset:5120
    ds_write_b128 v8, v[244:247] offset:6144
    ds_write_b128 v8, v[244:247] offset:7168
    ds_write_b128 v8, v[244:247] offset:8192
    s_waitcnt lgkmcnt(0)
    s_branch M_dnr
M_ovc0:
    v_smfmac_f32_16x16x32_bf16 v[124:127], v[54:55], v[212:215], v10
    v_smfmac_f32_16x16x32_bf16 v[160:163], v[54:55], v[212:215], v10 abid:2
    s_setpc_b64 s[74:75]
    v_smfmac_f32_16x16x32_bf16 v[128:131], v[54:55], v[212:215], v10
    v_smfmac_f32_16x16x32_bf16 v[164:167], v[54:55], v[212:215], v10 abid:2
    s_setpc_b64 s[74:75]
    v_smfmac_f32_16x16x32_bf16 v[132:135], v[54:55], v[212:215], v10
    v_smfmac_f32_16x16x32_bf16 v[168:171], v[54:55], v[212:215], v10 abid:2
    s_setpc_b64 s[74:75]
    v_smfmac_f32_16x16x32_bf16 v[136:139], v[54:55], v[212:215], v10
    v_smfmac_f32_16x16x32_bf16 v[172:175], v[54:55], v[212:215], v10 abid:2
    s_setpc_b64 s[74:75]
    v_smfmac_f32_16x16x32_bf16 v[140:143], v[54:55], v[212:215], v10
    v_smfmac_f32_16x16x32_bf16 v[176:179], v[54:55], v[212:215], v10 abid:2
    s_setpc_b64 s[74:75]
    v_smfmac_f32_16x16x32_bf16 v[144:147], v[54:55], v[212:215], v10
    v_smfmac_f32_16x16x32_bf16 v[180:183], v[54:55], v[212:215], v10 abid:2
    s_setpc_b64 s[74:75]
    v_smfmac_f32_16x16x32_bf16 v[148:151], v[54:55], v[212:215], v10
    v_smfmac_f32_16x16x32_bf16 v[184:187], v[54:55], v[212:215], v10 abid:2
    s_setpc_b64 s[74:75]
    v_smfmac_f32_16x16x32_bf16 v[152:155], v[54:55], v[212:215], v10
    v_smfmac_f32_16x16x32_bf16 v[188:191], v[54:55], v[212:215], v10 abid:2
    s_setpc_b64 s[74:75]
    v_smfmac_f32_16x16x32_bf16 v[156:159], v[54:55], v[212:215], v10
    v_smfmac_f32_16x16x32_bf16 v[192:195], v[54:55], v[212:215], v10 abid:2
    s_setpc_b64 s[74:75]
M_ovl0:
    v_smfmac_f32_16x16x32_bf16 v[124:127], v[54:55], v[212:215], v10
    v_smfmac_f32_16x16x32_bf16 v[160:163], v[54:55], v[212:215], v10 abid:2
    s_setpc_b64 s[78:79]
    v_smfmac_f32_16x16x32_bf16 v[128:131], v[54:55], v[212:215], v10
    v_smfmac_f32_16x16x32_bf16 v[164:167], v[54:55], v[212:215], v10 abid:2
    s_setpc_b64 s[78:79]
    v_smfmac_f32_16x16x32_bf16 v[132:135], v[54:55], v[212:215], v10
    v_smfmac_f32_16x16x32_bf16 v[168:171], v[54:55], v[212:215], v10 abid:2
    s_setpc_b64 s[78:79]
    v_smfmac_f32_16x16x32_bf16 v[136:139], v[54:55], v[212:215], v10
    v_smfmac_f32_16x16x32_bf16 v[172:175], v[54:55], v[212:215], v10 abid:2
    s_setpc_b64 s[78:79]
    v_smfmac_f32_16x16x32_bf16 v[140:143], v[54:55], v[212:215], v10
    v_smfmac_f32_16x16x32_bf16 v[176:179], v[54:55], v[212:215], v10 abid:2
    s_setpc_b64 s[78:79]
    v_smfmac_f32_16x16x32_bf16 v[144:147], v[54:55], v[212:215], v10
    v_smfmac_f32_16x16x32_bf16 v[180:183], v[54:55], v[212:215], v10 abid:2
    s_setpc_b64 s[78:79]
    v_smfmac_f32_16x16x32_bf16 v[148:151], v[54:55], v[212:215], v10
    v_smfmac_f32_16x16x32_bf16 v[184:187], v[54:55], v[212:215], v10 abid:2
    s_setpc_b64 s[78:79]
    v_smfmac_f32_16x16x32_bf16 v[152:155], v[54:55], v[212:215], v10
    v_smfmac_f32_16x16x32_bf16 v[188:191], v[54:55], v[212:215], v10 abid:2
    s_setpc_b64 s[78:79]
    v_smfmac_f32_16x16x32_bf16 v[156:159], v[54:55], v[212:215], v10
    v_smfmac_f32_16x16x32_bf16 v[192:195], v[54:55], v[212:215], v10 abid:2
    s_setpc_b64 s[78:79]
M_ovc1:
    v_smfmac_f32_16x16x32_bf16 v[124:127], v[252:253], v[212:215], v10
    v_smfmac_f32_16x16x32_bf16 v[160:163], v[252:253], v[212:215], v10 abid:2
    s_setpc_b64 s[76:77]
    v_smfmac_f32_16x16x32_bf16 v[128:131], v[252:253], v[212:215], v10
    v_smfmac_f32_16x16x32_bf16 v[164:167], v[252:253], v[212:215], v10 abid:2
    s_setpc_b64 s[76:77]
    v_smfmac_f32_16x16x32_bf16 v[132:135], v[252:253], v[212:215], v10
    v_smfmac_f32_16x16x32_bf16 v[168:171], v[252:253], v[212:215], v10 abid:2
    s_setpc_b64 s[76:77]
    v_smfmac_f32_16x16x32_bf16 v[136:139], v[252:253], v[212:215], v10
    v_smfmac_f32_16x16x32_bf16 v[172:175], v[252:253], v[212:215], v10 abid:2
    s_setpc_b64 s[76:77]
    v_smfmac_f32_16x16x32_bf16 v[140:143], v[252:253], v[212:215], v10
    v_smfmac_f32_16x16x32_bf16 v[176:179], v[252:253], v[212:215], v10 abid:2
    s_setpc_b64 s[76:77]
    v_smfmac_f32_16x16x32_bf16 v[144:147], v[252:253], v[212:215], v10
    v_smfmac_f32_16x16x32_bf16 v[180:183], v[252:253], v[212:215], v10 abid:2
    s_setpc_b64 s[76:77]
    v_smfmac_f32_16x16x32_bf16 v[148:151], v[252:253], v[212:215], v10
    v_smfmac_f32_16x16x32_bf16 v[184:187], v[252:253], v[212:215], v10 abid:2
    s_setpc_b64 s[76:77]
    v_smfmac_f32_16x16x32_bf16 v[152:155], v[252:253], v[212:215], v10
    v_smfmac_f32_16x16x32_bf16 v[188:191], v[252:253], v[212:215], v10 abid:2
    s_setpc_b64 s[76:77]
    v_smfmac_f32_16x16x32_bf16 v[156:159], v[252:253], v[212:215], v10
    v_smfmac_f32_16x16x32_bf16 v[192:195], v[252:253], v[212:215], v10 abid:2
    s_setpc_b64 s[76:77]
M_ovl1:
    v_smfmac_f32_16x16x32_bf16 v[124:127], v[252:253], v[212:215], v10
    v_smfmac_f32_16x16x32_bf16 v[160:163], v[252:253], v[212:215], v10 abid:2
    s_setpc_b64 s[78:79]
    v_smfmac_f32_16x16x32_bf16 v[128:131], v[252:253], v[212:215], v10
    v_smfmac_f32_16x16x32_bf16 v[164:167], v[252:253], v[212:215], v10 abid:2
    s_setpc_b64 s[78:79]
    v_smfmac_f32_16x16x32_bf16 v[132:135], v[252:253], v[212:215], v10
    v_smfmac_f32_16x16x32_bf16 v[168:171], v[252:253], v[212:215], v10 abid:2
    s_setpc_b64 s[78:79]
    v_smfmac_f32_16x16x32_bf16 v[136:139], v[252:253], v[212:215], v10
    v_smfmac_f32_16x16x32_bf16 v[172:175], v[252:253], v[212:215], v10 abid:2
    s_setpc_b64 s[78:79]
    v_smfmac_f32_16x16x32_bf16 v[140:143], v[252:253], v[212:215], v10
    v_smfmac_f32_16x16x32_bf16 v[176:179], v[252:253], v[212:215], v10 abid:2
    s_setpc_b64 s[78:79]
    v_smfmac_f32_16x16x32_bf16 v[144:147], v[252:253], v[212:215], v10
    v_smfmac_f32_16x16x32_bf16 v[180:183], v[252:253], v[212:215], v10 abid:2
    s_setpc_b64 s[78:79]
    v_smfmac_f32_16x16x32_bf16 v[148:151], v[252:253], v[212:215], v10
    v_smfmac_f32_16x16x32_bf16 v[184:187], v[252:253], v[212:215], v10 abid:2
    s_setpc_b64 s[78:79]
    v_smfmac_f32_16x16x32_bf16 v[152:155], v[252:253], v[212:215], v10
    v_smfmac_f32_16x16x32_bf16 v[188:191], v[252:253], v[212:215], v10 abid:2
    s_setpc_b64 s[78:79]
    v_smfmac_f32_16x16x32_bf16 v[156:159], v[252:253], v[212:215], v10
    v_smfmac_f32_16x16x32_bf16 v[192:195], v[252:253], v[212:215], v10 abid:2
    s_setpc_b64 s[78:79]
M_ovl2:
    v_smfmac_f32_16x16x32_bf16 v[124:127], v[254:255], v[212:215], v10
    v_smfmac_f32_16x16x32_bf16 v[160:163], v[254:255], v[212:215], v10 abid:2
    s_setpc_b64 s[78:79]
    v_smfmac_f32_16x16x32_bf16 v[128:131], v[254:255], v[212:215], v10
    v_smfmac_f32_16x16x32_bf16 v[164:167], v[254:255], v[212:215], v10 abid:2
    s_setpc_b64 s[78:79]
    v_smfmac_f32_16x16x32_bf16 v[132:135], v[254:255], v[212:215], v10
    v_smfmac_f32_16x16x32_bf16 v[168:171], v[254:255], v[212:215], v10 abid:2
    s_setpc_b64 s[78:79]
    v_smfmac_f32_16x16x32_bf16 v[136:139], v[254:255], v[212:215], v10
    v_smfmac_f32_16x16x32_bf16 v[172:175], v[254:255], v[212:215], v10 abid:2
    s_setpc_b64 s[78:79]
    v_smfmac_f32_16x16x32_bf16 v[140:143], v[254:255], v[212:215], v10
    v_smfmac_f32_16x16x32_bf16 v[176:179], v[254:255], v[212:215], v10 abid:2
    s_setpc_b64 s[78:79]
    v_smfmac_f32_16x16x32_bf16 v[144:147], v[254:255], v[212:215], v10
    v_smfmac_f32_16x16x32_bf16 v[180:183], v[254:255], v[212:215], v10 abid:2
    s_setpc_b64 s[78:79]
    v_smfmac_f32_16x16x32_bf16 v[148:151], v[254:255], v[212:215], v10
    v_smfmac_f32_16x16x32_bf16 v[184:187], v[254:255], v[212:215], v10 abid:2
    s_setpc_b64 s[78:79]
    v_smfmac_f32_16x16x32_bf16 v[152:155], v[254:255], v[212:215], v10
    v_smfmac_f32_16x16x32_bf16 v[188:191], v[254:255], v[212:215], v10 abid:2
    s_setpc_b64 s[78:79]
    v_smfmac_f32_16x16x32_bf16 v[156:159], v[254:255], v[212:215], v10
    v_smfmac_f32_16x16x32_bf16 v[192:195], v[254:255], v[212:215], v10 abid:2
    s_setpc_b64 s[78:79]
M_ovn:
    s_setpc_b64 s[78:79]
M_slow:
    s_bitcmp1_b32 s46, 31
    s_cbranch_scc1 M_dense
    s_mov_b32 s56, s80
M_sl:
    s_lshl_b32 s57, s56, 6
    v_add_u32 v240, s57, v9
    ds_read_b128 v[248:251], v240 offset:9792
    s_waitcnt lgkmcnt(0)
    v_and_b32 v240, 0x3fff, v248
    v_and_b32 v241, 0x3fff, v250
    v_xad_u32 v240, v240, v3, v4
    v_xad_u32 v241, v241, v3, v4
    ds_read2st64_b32 v[244:245], v240 offset0:0 offset1:72
    ds_read2st64_b32 v[246:247], v241 offset0:0 offset1:72
    v_subrev_u32 v240, s29, v8
    v_bfe_u32 v240, v240, 4, 4
    s_waitcnt lgkmcnt(0)
    s_bitcmp1_b32 s27, 0
    s_cbranch_scc0 M_sle0
    v_lshrrev_b32 v242, 18, v248
    v_lshrrev_b32 v243, 18, v250
    v_or_b32 v241, 0, v240
    v_cmp_eq_u32 s[44:45], v242, v241
    v_cmp_eq_u32 s[54:55], v243, v241
    s_nop 0
    v_cndmask_b32 v242, 0, v249, s[44:45]
    v_cndmask_b32 v243, 0, v251, s[54:55]
    s_nop 1
    v_smfmac_f32_16x16x32_bf16 v[124:127], v[242:243], v[244:247], v10
    v_smfmac_f32_16x16x32_bf16 v[160:163], v[242:243], v[244:247], v10 abid:2
M_sle0:
    s_bitcmp1_b32 s27, 1
    s_cbranch_scc0 M_sle1
    v_lshrrev_b32 v242, 18, v248
    v_lshrrev_b32 v243, 18, v250
    v_or_b32 v241, 64, v240
    v_cmp_eq_u32 s[44:45], v242, v241
    v_cmp_eq_u32 s[54:55], v243, v241
    s_nop 0
    v_cndmask_b32 v242, 0, v249, s[44:45]
    v_cndmask_b32 v243, 0, v251, s[54:55]
    s_nop 1
    v_smfmac_f32_16x16x32_bf16 v[128:131], v[242:243], v[244:247], v10
    v_smfmac_f32_16x16x32_bf16 v[164:167], v[242:243], v[244:247], v10 abid:2
M_sle1:
    s_bitcmp1_b32 s27, 2
    s_cbranch_scc0 M_sle2
    v_lshrrev_b32 v242, 18, v248
    v_lshrrev_b32 v243, 18, v250
    v_or_b32 v241, 128, v240
    v_cmp_eq_u32 s[44:45], v242, v241
    v_cmp_eq_u32 s[54:55], v243, v241
    s_nop 0
    v_cndmask_b32 v242, 0, v249, s[44:45]
    v_cndmask_b32 v243, 0, v251, s[54:55]
    s_nop 1
    v_smfmac_f32_16x16x32_bf16 v[132:135], v[242:243], v[244:247], v10
    v_smfmac_f32_16x16x32_bf16 v[168:171], v[242:243], v[244:247], v10 abid:2
M_sle2:
    s_bitcmp1_b32 s27, 3
    s_cbranch_scc0 M_sle3
    v_lshrrev_b32 v242, 18, v248
    v_lshrrev_b32 v243, 18, v250
    v_or_b32 v241, 192, v240
    v_cmp_eq_u32 s[44:45], v242, v241
    v_cmp_eq_u32 s[54:55], v243, v241
    s_nop 0
    v_cndmask_b32 v242, 0, v249, s[44:45]
    v_cndmask_b32 v243, 0, v251, s[54:55]
    s_nop 1
    v_smfmac_f32_16x16x32_bf16 v[136:139], v[242:243], v[244:247], v10
    v_smfmac_f32_16x16x32_bf16 v[172:175], v[242:243], v[244:247], v10 abid:2
M_sle3:
    s_bitcmp1_b32 s27, 4
    s_cbranch_scc0 M_sle4
    v_lshrrev_b32 v242, 18, v248
    v_lshrrev_b32 v243, 18, v250
    v_or_b32 v241, 256, v240
    v_cmp_eq_u32 s[44:45], v242, v241
    v_cmp_eq_u32 s[54:55], v243, v241
    s_nop 0
    v_cndmask_b32 v242, 0, v249, s[44:45]
    v_cndmask_b32 v243, 0, v251, s[54:55]
    s_nop 1
    v_smfmac_f32_16x16x32_bf16 v[140:143], v[242:243], v[244:247], v10
    v_smfmac_f32_16x16x32_bf16 v[176:179], v[242:243], v[244:247], v10 abid:2
M_sle4:
    s_bitcmp1_b32 s27, 5
    s_cbranch_scc0 M_sle5
    v_lshrrev_b32 v242, 18, v248
    v_lshrrev_b32 v243, 18, v250
    v_or_b32 v241, 320, v240
    v_cmp_eq_u32 s[44:45], v242, v241
    v_cmp_eq_u32 s[54:55], v243, v241
    s_nop 0
    v_cndmask_b32 v242, 0, v249, s[44:45]
    v_cndmask_b32 v243, 0, v251, s[54:55]
    s_nop 1
    v_smfmac_f32_16x16x32_bf16 v[144:147], v[242:243], v[244:247], v10
    v_smfmac_f32_16x16x32_bf16 v[180:183], v[242:243], v[244:247], v10 abid:2
M_sle5:
    s_bitcmp1_b32 s27, 6
    s_cbranch_scc0 M_sle6
    v_lshrrev_b32 v242, 18, v248
    v_lshrrev_b32 v243, 18, v250
    v_or_b32 v241, 384, v240
    v_cmp_eq_u32 s[44:45], v242, v241
    v_cmp_eq_u32 s[54:55], v243, v241
    s_nop 0
    v_cndmask_b32 v242, 0, v249, s[44:45]
    v_cndmask_b32 v243, 0, v251, s[54:55]
    s_nop 1
    v_smfmac_f32_16x16x32_bf16 v[148:151], v[242:243], v[244:247], v10
    v_smfmac_f32_16x16x32_bf16 v[184:187], v[242:243], v[244:247], v10 abid:2
M_sle6:
    s_bitcmp1_b32 s27, 7
    s_cbranch_scc0 M_sle7
    v_lshrrev_b32 v242, 18, v248
    v_lshrrev_b32 v243, 18, v250
    v_or_b32 v241, 448, v240
    v_cmp_eq_u32 s[44:45], v242, v241
    v_cmp_eq_u32 s[54:55], v243, v241
    s_nop 0
    v_cndmask_b32 v242, 0, v249, s[44:45]
    v_cndmask_b32 v243, 0, v251, s[54:55]
    s_nop 1
    v_smfmac_f32_16x16x32_bf16 v[152:155], v[242:243], v[244:247], v10
    v_smfmac_f32_16x16x32_bf16 v[188:191], v[242:243], v[244:247], v10 abid:2
M_sle7:
    s_bitcmp1_b32 s27, 8
    s_cbranch_scc0 M_sle8
    v_lshrrev_b32 v242, 18, v248
    v_lshrrev_b32 v243, 18, v250
    v_or_b32 v241, 512, v240
    v_cmp_eq_u32 s[44:45], v242, v241
    v_cmp_eq_u32 s[54:55], v243, v241
    s_nop 0
    v_cndmask_b32 v242, 0, v249, s[44:45]
    v_cndmask_b32 v243, 0, v251, s[54:55]
    s_nop 1
    v_smfmac_f32_16x16x32_bf16 v[156:159], v[242:243], v[244:247], v10
    v_smfmac_f32_16x16x32_bf16 v[192:195], v[242:243], v[244:247], v10 abid:2
M_sle8:
    s_add_u32 s56, s56, 1
    s_cmp_lt_u32 s56, s46
    s_cbranch_scc1 M_sl
M_slx:
    s_nop 7
    s_cmp_eq_u32 s21, 1
    s_cbranch_scc1 M_slowrL
    s_cmp_eq_u32 s21, 2
    s_cbranch_scc1 M_slowrE0
    s_cmp_eq_u32 s21, 3
    s_cbranch_scc1 M_slowrQ
    s_cmp_eq_u32 s21, 4
    s_cbranch_scc1 M_slowrF
    s_branch M_slowr0
M_dense:
    s_mul_i32 s57, s20, 82944
    s_add_u32 s57, s57, 393216
    s_mov_b32 s56, 0
    v_mov_b32 v54, v1
    v_mov_b32 v55, v2
    v_subrev_u32 v252, s29, v8
M_dn0:
    ds_read_b128 v[244:247], v54 offset:0
    ds_read_b128 v[248:251], v55 offset:0
    v_add_u32 v54, 1024, v54
    v_add_u32 v55, 1024, v55
    buffer_load_dwordx4 v[240:243], v252, s[16:19], s57 offen sc1
    s_add_u32 s57, s57, 1024
    s_waitcnt vmcnt(0) lgkmcnt(0)
    v_smfmac_f32_16x16x64_bf16 v[124:127], v[240:243], v[244:251], v10
    buffer_load_dwordx4 v[240:243], v252, s[16:19], s57 offen sc1
    s_add_u32 s57, s57, 1024
    s_waitcnt vmcnt(0) lgkmcnt(0)
    v_smfmac_f32_16x16x64_bf16 v[128:131], v[240:243], v[244:251], v10
    buffer_load_dwordx4 v[240:243], v252, s[16:19], s57 offen sc1
    s_add_u32 s57, s57, 1024
    s_waitcnt vmcnt(0) lgkmcnt(0)
    v_smfmac_f32_16x16x64_bf16 v[132:135], v[240:243], v[244:251], v10
    buffer_load_dwordx4 v[240:243], v252, s[16:19], s57 offen sc1
    s_add_u32 s57, s57, 1024
    s_waitcnt vmcnt(0) lgkmcnt(0)
    v_smfmac_f32_16x16x64_bf16 v[136:139], v[240:243], v[244:251], v10
    buffer_load_dwordx4 v[240:243], v252, s[16:19], s57 offen sc1
    s_add_u32 s57, s57, 1024
    s_waitcnt vmcnt(0) lgkmcnt(0)
    v_smfmac_f32_16x16x64_bf16 v[140:143], v[240:243], v[244:251], v10
    buffer_load_dwordx4 v[240:243], v252, s[16:19], s57 offen sc1
    s_add_u32 s57, s57, 1024
    s_waitcnt vmcnt(0) lgkmcnt(0)
    v_smfmac_f32_16x16x64_bf16 v[144:147], v[240:243], v[244:251], v10
    buffer_load_dwordx4 v[240:243], v252, s[16:19], s57 offen sc1
    s_add_u32 s57, s57, 1024
    s_waitcnt vmcnt(0) lgkmcnt(0)
    v_smfmac_f32_16x16x64_bf16 v[148:151], v[240:243], v[244:251], v10
    buffer_load_dwordx4 v[240:243], v252, s[16:19], s57 offen sc1
    s_add_u32 s57, s57, 1024
    s_waitcnt vmcnt(0) lgkmcnt(0)
    v_smfmac_f32_16x16x64_bf16 v[152:155], v[240:243], v[244:251], v10
    buffer_load_dwordx4 v[240:243], v252, s[16:19], s57 offen sc1
    s_add_u32 s57, s57, 1024
    s_waitcnt vmcnt(0) lgkmcnt(0)
    v_smfmac_f32_16x16x64_bf16 v[156:159], v[240:243], v[244:251], v10
    s_add_u32 s56, s56, 1
    s_cmp_lt_u32 s56, 9
    s_cbranch_scc1 M_dn0
    s_mul_i32 s57, s20, 82944
    s_add_u32 s57, s57, 393216
    s_mov_b32 s56, 0
    v_mov_b32 v54, v1
    v_mov_b32 v55, v2
    v_subrev_u32 v252, s29, v8
M_dn1:
    ds_read_b128 v[244:247], v54 offset:18432
    ds_read_b128 v[248:251], v55 offset:18432
    v_add_u32 v54, 1024, v54
    v_add_u32 v55, 1024, v55
    buffer_load_dwordx4 v[240:243], v252, s[16:19], s57 offen sc1
    s_add_u32 s57, s57, 1024
    s_waitcnt vmcnt(0) lgkmcnt(0)
    v_smfmac_f32_16x16x64_bf16 v[160:163], v[240:243], v[244:251], v10
    buffer_load_dwordx4 v[240:243], v252, s[16:19], s57 offen sc1
    s_add_u32 s57, s57, 1024
    s_waitcnt vmcnt(0) lgkmcnt(0)
    v_smfmac_f32_16x16x64_bf16 v[164:167], v[240:243], v[244:251], v10
    buffer_load_dwordx4 v[240:243], v252, s[16:19], s57 offen sc1
    s_add_u32 s57, s57, 1024
    s_waitcnt vmcnt(0) lgkmcnt(0)
    v_smfmac_f32_16x16x64_bf16 v[168:171], v[240:243], v[244:251], v10
    buffer_load_dwordx4 v[240:243], v252, s[16:19], s57 offen sc1
    s_add_u32 s57, s57, 1024
    s_waitcnt vmcnt(0) lgkmcnt(0)
    v_smfmac_f32_16x16x64_bf16 v[172:175], v[240:243], v[244:251], v10
    buffer_load_dwordx4 v[240:243], v252, s[16:19], s57 offen sc1
    s_add_u32 s57, s57, 1024
    s_waitcnt vmcnt(0) lgkmcnt(0)
    v_smfmac_f32_16x16x64_bf16 v[176:179], v[240:243], v[244:251], v10
    buffer_load_dwordx4 v[240:243], v252, s[16:19], s57 offen sc1
    s_add_u32 s57, s57, 1024
    s_waitcnt vmcnt(0) lgkmcnt(0)
    v_smfmac_f32_16x16x64_bf16 v[180:183], v[240:243], v[244:251], v10
    buffer_load_dwordx4 v[240:243], v252, s[16:19], s57 offen sc1
    s_add_u32 s57, s57, 1024
    s_waitcnt vmcnt(0) lgkmcnt(0)
    v_smfmac_f32_16x16x64_bf16 v[184:187], v[240:243], v[244:251], v10
    buffer_load_dwordx4 v[240:243], v252, s[16:19], s57 offen sc1
    s_add_u32 s57, s57, 1024
    s_waitcnt vmcnt(0) lgkmcnt(0)
    v_smfmac_f32_16x16x64_bf16 v[188:191], v[240:243], v[244:251], v10
    buffer_load_dwordx4 v[240:243], v252, s[16:19], s57 offen sc1
    s_add_u32 s57, s57, 1024
    s_waitcnt vmcnt(0) lgkmcnt(0)
    v_smfmac_f32_16x16x64_bf16 v[192:195], v[240:243], v[244:251], v10
    s_add_u32 s56, s56, 1
    s_cmp_lt_u32 s56, 9
    s_cbranch_scc1 M_dn1
    s_branch M_slx
M_codeend:
.section .rodata,"a"
.p2align 6
.amdhsa_kernel standalone__structured_sparse_n_m__ragged_kernel
  .amdhsa_next_free_vgpr 512
  .amdhsa_next_free_sgpr 102
  .amdhsa_accum_offset 256
  .amdhsa_group_segment_fixed_size 0
  .amdhsa_kernarg_size 48
  .amdhsa_user_sgpr_count 2
  .amdhsa_user_sgpr_kernarg_segment_ptr 1
  .amdhsa_system_sgpr_workgroup_id_x 1
  .amdhsa_float_denorm_mode_32 3
.end_amdhsa_kernel
```

```asm
; @launch grid=(256,1,1) block=(256,1,1) lds=162064
.amdgcn_target "amdgcn-amd-amdhsa--gfx950"
.text
.globl standalone__structured_sparse_n_m__ragged_kernel
.p2align 8
.type standalone__structured_sparse_n_m__ragged_kernel,@function
standalone__structured_sparse_n_m__ragged_kernel:
    s_cmp_ge_u32 s2, 256
    s_cbranch_scc1 M_end
    s_load_dwordx8 s[72:79], s[0:1], 0
    s_load_dwordx4 s[80:83], s[0:1], 32
    s_getpc_b64 s[84:85]
    s_lshr_b32 s30, s2, 3
    s_and_b32 s30, s30, 15
    s_lshl_b32 s30, s30, 11
    s_and_b32 s84, s84, 0xffffff00
    s_cmp_ge_u32 s2, 88
    s_cselect_b32 s86, M_codeend-standalone__structured_sparse_n_m__ragged_kernel, 0
    s_mov_b32 s87, 0x20000
    v_lshlrev_b32 v254, 3, v0
    s_mov_b32 exec_lo, 0x00010001
    s_mov_b32 exec_hi, 0x00010001
    buffer_load_dword v254, v254, s[84:87], s30 offen
    s_mov_b64 exec, -1
    v_lshrrev_b32 v20, 6, v0
    v_and_b32 v12, 63, v0
    v_readfirstlane_b32 s20, v20
    v_lshrrev_b32 v22, 3, v0
    v_mul_u32_u24 v22, 1152, v22
    v_lshrrev_b32 v23, 4, v0
    v_xor_b32 v23, v23, v0
    v_and_b32 v23, 7, v23
    v_lshl_add_u32 v5, v23, 4, v22
    v_lshrrev_b32 v13, 4, v12
    v_and_b32 v14, 15, v12
    v_lshlrev_b32 v11, 4, v12
    v_lshlrev_b32 v54, 3, v12
    v_lshlrev_b32 v25, 4, v13
    v_lshlrev_b32 v26, 3, v13
    s_mov_b32 s6, 663552
    s_mov_b32 s7, 0x20000
    s_mov_b32 s10, 75497472
    s_mov_b32 s11, s7
    s_mov_b32 s18, 791552
    s_mov_b32 s19, s7
    s_movk_i32 s70, 256
    s_mov_b32 s71, s7
    s_movk_i32 s86, 1152
    s_mov_b32 s87, s7
    s_mov_b32 s98, 0
    s_mul_i32 s96, s20, 16
    s_and_b32 s97, s2, 15
    s_add_u32 s96, s96, s97
    s_lshl_b32 s96, s96, 8
    s_add_u32 s96, s96, 726016
    s_mul_i32 s22, s2, 36864
    s_mul_i32 s26, s20, 9216
    s_mov_b32 s24, s22
    s_mov_b32 s42, s26
    s_lshl_b32 s28, s20, 8
    s_lshl_b32 s97, s20, 5
    s_cmp_lt_u32 s2, 81
    s_cbranch_scc0 M_x1
    s_mul_i32 s32, s2, 57
    s_lshr_b32 s32, s32, 9
    s_mul_i32 s33, s32, 9
    s_sub_u32 s33, s2, s33
    s_mul_i32 s54, s32, 73728
    s_lshl_b32 s35, s33, 7
    s_add_u32 s54, s54, s35
    s_add_u32 s55, s54, 36864
    s_lshl_b32 s36, s20, 10
    s_add_u32 m0, s36, 73728
    s_lshr_b32 s30, s33, 1
    s_and_b32 s31, s33, 1
    s_lshl1_add_u32 s37, s32, s31
    s_mul_i32 s37, s37, 176
    s_mul_i32 s38, s32, 96
    s_add_u32 s38, s38, 3168
    s_cmp_lt_u32 s33, 8
    s_cselect_b32 s30, s30, s20
    s_cselect_b32 s37, s37, s38
    s_cselect_b32 s44, 2047, 63
    s_cselect_b32 s45, s20, 3
    s_cmp_eq_u32 s45, 3
    s_cselect_b32 s99, 791552, 0
    s_mul_i32 s48, s30, 98304
    s_add_u32 s37, s37, s48
    v_mov_b32 v44, 2.0
    v_mov_b32 v45, 0
    v_mov_b32 v46, 2.0
    v_mov_b32 v47, 0
    s_waitcnt lgkmcnt(0)
    s_mov_b64 s[4:5], s[74:75]
    buffer_load_dwordx4 v5, s[4:7], s54 offen lds
    s_add_u32 m0, m0, 4096
    s_mov_b32 s45, 0
    buffer_load_dwordx4 v5, s[4:7], s55 offen lds
    s_mov_b64 s[16:17], s[82:83]
    s_mov_b64 s[8:9], s[72:73]
    s_mov_b64 s[84:85], s[76:77]
    s_mov_b64 s[68:69], s[80:81]
    v_mov_b32 v10, 0
    s_mov_b64 exec, 1
    buffer_atomic_add v10, off, s[16:19], s96 sc0 sc1
    s_mov_b64 exec, -1
    s_mov_b64 exec, s[44:45]
    s_mov_b32 s18, s99
    buffer_store_dwordx4 v[44:47], v11, s[16:19], s37 offen sc1
    s_mov_b32 s18, 791552
    s_mov_b64 exec, -1
    s_mov_b32 m0, s42
    s_nop 0
    buffer_load_dwordx4 v5, s[8:11], s22 offen offset:0 nt lds
    s_add_u32 m0, m0, 896
    s_nop 0
    buffer_load_dwordx4 v5, s[8:11], s22 offen offset:128 nt lds
    s_add_u32 m0, m0, 896
    s_nop 0
    buffer_load_dwordx4 v5, s[8:11], s22 offen offset:256 nt lds
    s_lshl_b32 s34, s31, 2
    s_add_u32 s34, s34, s20
    s_lshr_b32 s35, s20, 1
    s_lshl_b32 s35, s35, 6
    s_and_b32 s36, s20, 1
    s_lshl_b32 s36, s36, 3
    s_add_u32 s35, s35, s36
    s_lshl_b32 s36, s20, 5
    s_mul_i32 s39, s32, 10240
    s_add_u32 s39, s39, 6144
    s_lshl_b32 s40, s34, 1
    s_add_u32 s40, s40, s39
    s_lshl_b32 s38, s32, 1
    s_cmp_eq_u32 s32, 8
    s_cselect_b32 s38, 1024, s38
    s_add_u32 s38, s38, 4096
    s_cmp_lt_u32 s33, 8
    s_cselect_b32 s34, s34, 8
    s_cselect_b32 s35, s35, s36
    s_cselect_b32 s36, 4, 3
    s_cselect_b32 s40, s40, s38
    s_cselect_b32 s46, 0, s20
    s_cselect_b32 s47, 22, 12
    s_add_u32 s40, s40, s48
    s_lshl_b32 s38, s34, 10
    s_add_u32 s39, s39, s38
    s_add_u32 s39, s39, s48
    s_add_u32 s39, s39, 1024
    v_and_b32 v15, 3, v14
    v_lshlrev_b32 v15, s36, v15
    v_add_u32 v15, s35, v15
    v_lshrrev_b32 v16, 3, v14
    v_lshlrev_b32 v16, 4, v16
    v_xor_b32 v15, v15, v16
    v_lshrrev_b32 v16, 2, v14
    v_lshl_add_u32 v16, v13, 4, v16
    v_lshl_add_u32 v15, v16, 7, v15
    v_add_u32 v24, 73728, v15
    v_xor_b32 v27, 32, v24
    v_xor_b32 v28, 64, v24
    v_xor_b32 v29, 0x60, v24
    s_lshl_b32 s31, s46, 2
    s_add_u32 s31, s31, 81920
    v_mov_b32 v60, s31
    v_mov_b32 v61, 1
    ds_write_b32 v60, v61
    s_mul_i32 s49, s30, 81
    s_mul_i32 s31, s32, 9
    s_add_u32 s49, s49, s31
    s_add_u32 s49, s49, s34
    s_lshl_b32 s49, s49, 10
    s_add_u32 s49, s49, 393216
    s_lshl_b32 s31, s34, 24
    s_lshl_b32 s38, s32, 10
    s_add_u32 s31, s31, s38
    v_lshlrev_b32 v31, 18, v14
    v_lshl_add_u32 v31, v13, 5, v31
    v_add_u32 v31, s31, v31
    s_mov_b32 s50, 3437096686
    s_mov_b32 s51, 1150609561
    s_mov_b32 s52, 0x00010001
    s_mov_b32 s53, 0x00200010
    s_mov_b32 s38, 0x0202
    s_mul_i32 s57, s30, 4096
    s_add_u32 s57, s57, 726016
    s_cmp_eq_u32 s33, 8
    s_cselect_b32 s56, 0, s20
    s_cmp_eq_u32 s20, 0
    s_cselect_b32 s98, 1, 0
    v_add_u32 v74, 81984, v54
    v_lshl_add_u32 v73, s20, 1, v74
    v_mov_b32 v41, 0x01000100
    v_mov_b32 v40, 0
    v_mov_b32 v63, -2.0
    s_waitcnt vmcnt(5) lgkmcnt(0)
    s_barrier
    ds_read_b64_tr_b16 v[16:17], v24
    ds_read_b64_tr_b16 v[18:19], v27 offset:512
    ds_read_b64_tr_b16 v[20:21], v28 offset:1024
    ds_read_b64_tr_b16 v[22:23], v29 offset:1536
    s_waitcnt lgkmcnt(3)
    v_and_b32 v44, 0x7fff7fff, v16
    v_and_b32 v45, 0x7fff7fff, v17
    v_pk_max_u16 v46, v44, v45
    v_pk_min_u16 v47, v44, v45
    v_pk_min_u16 v46, v46, v46 op_sel:[0,1] op_sel_hi:[1,0]
    v_pk_max_u16 v47, v47, v47 op_sel:[0,1] op_sel_hi:[1,0]
    v_pk_max_u16 v46, v46, s52
    v_pk_max_u16 v46, v46, v47
    v_pk_sub_i16 v44, v44, v46
    v_pk_sub_i16 v45, v45, v46
    v_pk_ashrrev_i16 v44, 15, v44 op_sel_hi:[0,1]
    v_pk_ashrrev_i16 v45, 15, v45 op_sel_hi:[0,1]
    v_alignbit_b32 v47, -1, v44, 16
    v_alignbit_b32 v46, v45, v45, 16
    v_and_b32 v48, 0x00080004, v44
    v_bitop3_b32 v46, v45, v46, v47 bitop3:0xe8
    v_and_or_b32 v64, v45, s53, v48
    v_bitop3_b32 v36, v16, v44, v46 bitop3:0x10
    v_min_u32 v68, 1, v36
    s_waitcnt lgkmcnt(2)
    v_and_b32 v44, 0x7fff7fff, v18
    v_and_b32 v45, 0x7fff7fff, v19
    v_pk_max_u16 v46, v44, v45
    v_pk_min_u16 v47, v44, v45
    v_pk_min_u16 v46, v46, v46 op_sel:[0,1] op_sel_hi:[1,0]
    v_pk_max_u16 v47, v47, v47 op_sel:[0,1] op_sel_hi:[1,0]
    v_pk_max_u16 v46, v46, s52
    v_pk_max_u16 v46, v46, v47
    v_pk_sub_i16 v44, v44, v46
    v_pk_sub_i16 v45, v45, v46
    v_pk_ashrrev_i16 v44, 15, v44 op_sel_hi:[0,1]
    v_pk_ashrrev_i16 v45, 15, v45 op_sel_hi:[0,1]
    v_alignbit_b32 v47, -1, v44, 16
    v_alignbit_b32 v46, v45, v45, 16
    v_and_b32 v48, 0x00080004, v44
    v_bitop3_b32 v46, v45, v46, v47 bitop3:0xe8
    v_and_or_b32 v65, v45, s53, v48
    v_bitop3_b32 v37, v18, v44, v46 bitop3:0x10
    v_min_u32 v69, 1, v37
    s_waitcnt lgkmcnt(1)
    v_and_b32 v44, 0x7fff7fff, v20
    v_and_b32 v45, 0x7fff7fff, v21
    v_pk_max_u16 v46, v44, v45
    v_pk_min_u16 v47, v44, v45
    v_pk_min_u16 v46, v46, v46 op_sel:[0,1] op_sel_hi:[1,0]
    v_pk_max_u16 v47, v47, v47 op_sel:[0,1] op_sel_hi:[1,0]
    v_pk_max_u16 v46, v46, s52
    v_pk_max_u16 v46, v46, v47
    v_pk_sub_i16 v44, v44, v46
    v_pk_sub_i16 v45, v45, v46
    v_pk_ashrrev_i16 v44, 15, v44 op_sel_hi:[0,1]
    v_pk_ashrrev_i16 v45, 15, v45 op_sel_hi:[0,1]
    v_alignbit_b32 v47, -1, v44, 16
    v_alignbit_b32 v46, v45, v45, 16
    v_and_b32 v48, 0x00080004, v44
    v_bitop3_b32 v46, v45, v46, v47 bitop3:0xe8
    v_and_or_b32 v66, v45, s53, v48
    v_bitop3_b32 v38, v20, v44, v46 bitop3:0x10
    v_min_u32 v70, 1, v38
    s_waitcnt lgkmcnt(0)
    v_and_b32 v44, 0x7fff7fff, v22
    v_and_b32 v45, 0x7fff7fff, v23
    v_pk_max_u16 v46, v44, v45
    v_pk_min_u16 v47, v44, v45
    v_pk_min_u16 v46, v46, v46 op_sel:[0,1] op_sel_hi:[1,0]
    v_pk_max_u16 v47, v47, v47 op_sel:[0,1] op_sel_hi:[1,0]
    v_pk_max_u16 v46, v46, s52
    v_pk_max_u16 v46, v46, v47
    v_pk_sub_i16 v44, v44, v46
    v_pk_sub_i16 v45, v45, v46
    v_pk_ashrrev_i16 v44, 15, v44 op_sel_hi:[0,1]
    v_pk_ashrrev_i16 v45, 15, v45 op_sel_hi:[0,1]
    v_alignbit_b32 v47, -1, v44, 16
    v_alignbit_b32 v46, v45, v45, 16
    v_and_b32 v48, 0x00080004, v44
    v_bitop3_b32 v46, v45, v46, v47 bitop3:0xe8
    v_and_or_b32 v67, v45, s53, v48
    v_bitop3_b32 v39, v22, v44, v46 bitop3:0x10
    v_min_u32 v71, 1, v39
    v_add_u32 v72, v68, v69
    v_add3_u32 v72, v72, v70, v71
    buffer_store_dwordx4 v[36:39], v11, s[16:19], s49 offen sc1
    v_cmp_ne_u32 vcc, 0, v72
    s_and_saveexec_b64 s[44:45], vcc
    ds_add_rtn_u32 v62, v60, v72
    s_mov_b64 exec, -1
    v_lshrrev_b32 v48, 16, v64
    v_or_b32 v48, v48, v64
    v_lshrrev_b64 v[52:53], v48, s[50:51]
    v_and_b32 v64, 15, v52
    v_lshl_or_b32 v40, v64, 0, v40
    v_lshrrev_b32 v48, 16, v65
    v_or_b32 v48, v48, v65
    v_lshrrev_b64 v[52:53], v48, s[50:51]
    v_and_b32 v65, 15, v52
    v_lshl_or_b32 v40, v65, 4, v40
    v_lshrrev_b32 v48, 16, v66
    v_or_b32 v48, v48, v66
    v_lshrrev_b64 v[52:53], v48, s[50:51]
    v_and_b32 v66, 15, v52
    v_lshl_or_b32 v40, v66, 8, v40
    v_lshrrev_b32 v48, 16, v67
    v_or_b32 v48, v48, v67
    v_lshrrev_b64 v[52:53], v48, s[50:51]
    v_and_b32 v67, 15, v52
    v_lshl_or_b32 v40, v67, 12, v40
    v_lshrrev_b32 v44, 2, v40
    v_lshlrev_b32 v45, 2, v40
    s_movk_i32 s31, 0x3333
    v_not_b32 v47, v40
    v_bfi_b32 v44, s31, v44, v45
    s_movk_i32 s31, 0x1111
    s_nop 0
    v_mov_b32_dpp v47, v44 row_shr:4 row_mask:0xf bank_mask:0xf
    v_xor_b32 v47, v47, v40
    v_lshrrev_b32 v45, 1, v47
    v_or_b32 v47, v47, v45
    v_lshrrev_b32 v45, 2, v47
    v_bitop3_b32 v47, v47, v45, s31 bitop3:0x2a
    s_nop 1
    v_xor_b32_dpp v47, v47, v47 row_shr:4 row_mask:0xf bank_mask:0xe
    s_nop 1
    v_xor_b32_dpp v47, v47, v47 row_shr:8 row_mask:0xf bank_mask:0xc
    v_mul_u32_u24 v47, 15, v47
    v_bfi_b32 v40, v47, v44, v40
    ds_write_b16 v73, v40
    v_bfe_u32 v64, v40, 0, 4
    v_mul_u32_u24 v46, 0x4001, v64
    v_and_b32 v46, 0x30003, v46
    v_mad_u32_u24 v46, v46, s38, v41
    v_perm_b32 v32, v17, v16, v46
    v_bfe_u32 v65, v40, 4, 4
    v_mul_u32_u24 v46, 0x4001, v65
    v_and_b32 v46, 0x30003, v46
    v_mad_u32_u24 v46, v46, s38, v41
    v_perm_b32 v33, v19, v18, v46
    s_waitcnt vmcnt(4) lgkmcnt(0)
    s_barrier
    ds_read_b64 v[50:51], v74
    v_bfe_u32 v66, v40, 8, 4
    v_mul_u32_u24 v46, 0x4001, v66
    v_and_b32 v46, 0x30003, v46
    v_mad_u32_u24 v46, v46, s38, v41
    v_perm_b32 v34, v21, v20, v46
    v_bfe_u32 v67, v40, 12, 4
    v_mul_u32_u24 v46, 0x4001, v67
    v_and_b32 v46, 0x30003, v46
    v_mad_u32_u24 v46, v46, s38, v41
    v_perm_b32 v35, v23, v22, v46
    buffer_store_dwordx4 v[32:35], v11, s[16:19], s39 offen sc1
    s_cmp_eq_u32 s33, 8
    s_cbranch_scc0 F_i1
    buffer_store_short v40, v11, s[16:19], s40 offen sc1
    s_branch F_i2
F_i1:
    s_cmp_eq_u32 s20, 0
    s_cbranch_scc0 F_i2
    s_waitcnt lgkmcnt(0)
    buffer_store_dwordx2 v[50:51], v11, s[16:19], s40 offen sc1
F_i2:
    s_cbranch_vccz F_z
    v_cmp_ne_u32 vcc, 0, v36
    s_and_saveexec_b64 s[44:45], vcc
    s_cbranch_execz F_e0
    v_cmp_gt_u32 vcc, s47, v62
    v_add_u32 v42, 0, v31
    v_lshlrev_b32 v44, 3, v62
    v_add_u32 v62, 1, v62
    v_cndmask_b32 v42, v63, v42, vcc
    v_cndmask_b32 v43, 0, v36, vcc
    v_cndmask_b32 v44, 0, v44, vcc
    buffer_store_dwordx2 v[42:43], v44, s[16:19], s37 offen sc1
F_e0:
    s_mov_b64 exec, -1
    v_cmp_ne_u32 vcc, 0, v37
    s_and_saveexec_b64 s[44:45], vcc
    s_cbranch_execz F_e1
    v_cmp_gt_u32 vcc, s47, v62
    v_add_u32 v42, 8, v31
    v_lshlrev_b32 v44, 3, v62
    v_add_u32 v62, 1, v62
    v_cndmask_b32 v42, v63, v42, vcc
    v_cndmask_b32 v43, 0, v37, vcc
    v_cndmask_b32 v44, 0, v44, vcc
    buffer_store_dwordx2 v[42:43], v44, s[16:19], s37 offen sc1
F_e1:
    s_mov_b64 exec, -1
    v_cmp_ne_u32 vcc, 0, v38
    s_and_saveexec_b64 s[44:45], vcc
    s_cbranch_execz F_e2
    v_cmp_gt_u32 vcc, s47, v62
    v_add_u32 v42, 16, v31
    v_lshlrev_b32 v44, 3, v62
    v_add_u32 v62, 1, v62
    v_cndmask_b32 v42, v63, v42, vcc
    v_cndmask_b32 v43, 0, v38, vcc
    v_cndmask_b32 v44, 0, v44, vcc
    buffer_store_dwordx2 v[42:43], v44, s[16:19], s37 offen sc1
F_e2:
    s_mov_b64 exec, -1
    v_cmp_ne_u32 vcc, 0, v39
    s_and_saveexec_b64 s[44:45], vcc
    s_cbranch_execz F_e3
    v_cmp_gt_u32 vcc, s47, v62
    v_add_u32 v42, 24, v31
    v_lshlrev_b32 v44, 3, v62
    v_add_u32 v62, 1, v62
    v_cndmask_b32 v42, v63, v42, vcc
    v_cndmask_b32 v43, 0, v39, vcc
    v_cndmask_b32 v44, 0, v44, vcc
    buffer_store_dwordx2 v[42:43], v44, s[16:19], s37 offen sc1
F_e3:
    s_mov_b64 exec, -1
F_z:
    s_cmp_lg_u32 s2, 0
    s_cbranch_scc1 M_set
    v_mov_b32 v64, 0
    v_mov_b32 v65, 0
    v_mov_b32 v66, 0
    v_mov_b32 v67, 0
    s_mov_b32 s40, 724992
    buffer_store_dwordx4 v[64:67], v11, s[16:19], s40 offen sc1
    s_branch M_set
F_sig:
    v_lshlrev_b32 v30, 8, v12
    s_waitcnt vmcnt(0)
    s_barrier
    s_cmp_lg_u32 s56, 0
    s_cbranch_scc1 F_end
    s_bfm_b64 exec, 16, 0
    buffer_atomic_add v61, v30, s[16:19], s57 offen sc1
    s_mov_b64 exec, -1
F_end:
    s_add_u32 m0, m0, 896
    s_nop 0
    buffer_load_dwordx4 v5, s[8:11], s22 offen offset:384 nt lds
    s_add_u32 m0, m0, 896
    s_nop 0
    buffer_load_dwordx4 v5, s[8:11], s22 offen offset:512 nt lds
    s_branch M_x2
M_x1:
    s_waitcnt lgkmcnt(0)
    s_mov_b64 s[4:5], s[74:75]
    s_mov_b64 s[16:17], s[82:83]
    s_mov_b64 s[8:9], s[72:73]
    s_mov_b64 s[84:85], s[76:77]
    s_mov_b64 s[68:69], s[80:81]
    v_mov_b32 v10, 0
    s_mov_b64 exec, 1
    buffer_atomic_add v10, off, s[16:19], s96 sc0 sc1
    s_mov_b64 exec, -1
    s_mov_b32 m0, s42
    s_nop 0
    buffer_load_dwordx4 v5, s[8:11], s22 offen offset:0 nt lds
    s_add_u32 m0, m0, 896
    s_nop 0
    buffer_load_dwordx4 v5, s[8:11], s22 offen offset:128 nt lds
    s_add_u32 m0, m0, 896
    s_nop 0
    buffer_load_dwordx4 v5, s[8:11], s22 offen offset:256 nt lds
    s_add_u32 m0, m0, 896
    s_nop 0
    buffer_load_dwordx4 v5, s[8:11], s22 offen offset:384 nt lds
    s_add_u32 m0, m0, 896
    s_nop 0
    buffer_load_dwordx4 v5, s[8:11], s22 offen offset:512 nt lds
M_set:
    s_mov_b32 s12, s78
    s_mov_b32 s13, s79
    s_mov_b32 s14, 75497472
    s_mov_b32 s15, 0x20000
    s_mul_i32 s29, s20, 12864
    s_add_u32 s29, s29, 110592
    v_lshrrev_b32 v24, 1, v14
    v_and_b32 v27, 7, v14
    v_lshlrev_b32 v22, 7, v27
    v_lshl_or_b32 v3, v24, 4, v22
    v_lshrrev_b32 v23, 3, v14
    v_mul_u32_u24 v4, 9216, v23
    v_xad_u32 v1, v25, v3, v4
    v_xor_b32 v2, 64, v1
    v_add_u32 v9, s29, v25
    v_add_u32 v8, s29, v11
    v_mul_u32_u24 v24, 1152, v27
    v_lshl_add_u32 v24, v23, 6, v24
    v_add3_u32 v6, v24, v25, s28
    v_lshrrev_b32 v24, 3, v12
    v_xor_b32 v28, v24, v12
    v_and_b32 v28, 7, v28
    v_mul_u32_u24 v24, 1152, v24
    v_lshl_add_u32 v24, v28, 4, v24
    v_add_u32 v7, 1024, v24
    s_lshl_b32 s30, s20, 1
    v_lshrrev_b32 v24, 1, v13
    v_add_u32 v24, s30, v24
    v_xor_b32 v24, v24, v27
    v_lshl_add_u32 v24, v24, 4, v22
    v_and_b32 v28, 8, v26
    v_mul_u32_u24 v29, 12864, v23
    v_add3_u32 v24, v24, v28, v29
    v_add_u32 v53, 121408, v24
    s_lshr_b32 s30, s2, 3
    s_and_b32 s30, s30, 1
    s_mul_i32 s92, s30, 256
    s_add_u32 s92, s92, 562944
    s_add_u32 s30, s30, 768
    s_mul_i32 s93, s30, 36864
    s_mov_b32 s94, 73728
    s_and_b32 s95, s20, 1
    s_mul_i32 s95, s95, 9216
    s_add_u32 s59, s24, 9216
    s_mul_i32 s43, s20, 98304
    s_add_u32 s47, s29, 9216
    s_add_u32 s48, s29, 9792
    s_add_u32 s49, s29, 10112
    s_add_u32 s54, s29, 1073751872
    s_add_u32 s38, s26, 73728
    s_add_u32 s35, s38, 1024
    s_add_u32 s39, s38, 1536
    s_mov_b32 s40, s48
    s_add_u32 s41, s48, 256
    s_mov_b32 s50, 3130536464
    s_mov_b32 s51, 1164430831
    s_mov_b32 s52, 3696531472
    s_mov_b32 s53, 598435823
    v_mov_b32 v16, 0
    v_mov_b32 v17, 0
    v_mov_b32 v18, 0
    v_mov_b32 v19, 0
    v_cmp_gt_u32 s[44:45], 36, v12
    v_mov_b32 v20, 2.0
    s_nop 0
    v_cndmask_b32 v20, 0, v20, s[44:45]
    v_mov_b32 v21, v20
    v_mov_b32 v22, v20
    v_mov_b32 v23, v20
    v_mov_b32 v104, 1073741824
    v_mov_b32 v105, 0
    v_mov_b32 v106, 1073741824
    v_mov_b32 v107, 0
    v_lshl_add_u32 v121, v12, 2, s49
    v_add_u32 v55, s38, v54
    v_add_u32 v24, s38, v11
    ds_write_b128 v8, v[16:19] offset:0
    ds_write_b128 v8, v[16:19] offset:1024
    ds_write_b128 v8, v[16:19] offset:2048
    ds_write_b128 v8, v[16:19] offset:3072
    ds_write_b128 v8, v[16:19] offset:4096
    ds_write_b128 v8, v[16:19] offset:5120
    ds_write_b128 v8, v[16:19] offset:6144
    ds_write_b128 v8, v[16:19] offset:7168
    ds_write_b128 v8, v[16:19] offset:8192
    ds_write_b128 v24, v[104:107]
    ds_write_b128 v24, v[104:107] offset:1024
    ds_write_b128 v8, v[20:23] offset:9216
    s_cmp_lt_u32 s2, 81
    s_cbranch_scc1 F_sig
M_x2:
    s_add_u32 m0, m0, 896
    s_nop 0
    buffer_load_dwordx4 v5, s[8:11], s22 offen offset:640 nt lds
    s_add_u32 m0, m0, 896
    s_nop 0
    buffer_load_dwordx4 v5, s[8:11], s22 offen offset:768 nt lds
    s_add_u32 m0, m0, 896
    s_nop 0
    buffer_load_dwordx4 v5, s[8:11], s22 offen offset:896 nt lds
    s_add_u32 m0, m0, 896
    s_nop 0
    buffer_load_dwordx4 v5, s[8:11], s22 offen offset:1024 nt lds
    s_add_u32 s22, s22, 9437184
    s_add_u32 s42, s42, 36864
    buffer_load_dwordx4 v[196:199], v25, s[84:87], s28 offen offset:0
    buffer_load_dwordx4 v[200:203], v25, s[84:87], s28 offen offset:64
    buffer_load_dwordx4 v[204:207], v25, s[84:87], s28 offen offset:128
    buffer_load_dwordx4 v[208:211], v25, s[84:87], s28 offen offset:192
    buffer_load_dwordx2 v[212:213], v26, s[84:87], s97 offen offset:1024
    s_mov_b32 m0, s42
    s_nop 0
    buffer_load_dwordx4 v5, s[8:11], s22 offen offset:0 nt lds
    s_add_u32 m0, m0, 896
    s_nop 0
    buffer_load_dwordx4 v5, s[8:11], s22 offen offset:128 nt lds
    s_add_u32 m0, m0, 896
    s_nop 0
    buffer_load_dwordx4 v5, s[8:11], s22 offen offset:256 nt lds
    s_add_u32 m0, m0, 896
    s_nop 0
    buffer_load_dwordx4 v5, s[8:11], s22 offen offset:384 nt lds
    s_add_u32 m0, m0, 896
    s_nop 0
    buffer_load_dwordx4 v5, s[8:11], s22 offen offset:512 nt lds
    s_add_u32 m0, m0, 896
    s_nop 0
    buffer_load_dwordx4 v5, s[8:11], s22 offen offset:640 nt lds
    s_add_u32 m0, m0, 896
    s_nop 0
    buffer_load_dwordx4 v5, s[8:11], s22 offen offset:768 nt lds
    s_add_u32 m0, m0, 896
    s_nop 0
    buffer_load_dwordx4 v5, s[8:11], s22 offen offset:896 nt lds
    s_add_u32 m0, m0, 896
    s_nop 0
    buffer_load_dwordx4 v5, s[8:11], s22 offen offset:1024 nt lds
    s_add_u32 s22, s22, 9437184
    s_add_u32 s42, s42, 36864
    s_waitcnt vmcnt(3)
    v_mov_b32 v0, 0
    s_mov_b64 exec, 1
    buffer_atomic_add v0, off, s[16:19], s96 sc0 sc1
    s_mov_b64 exec, -1
    v_readlane_b32 s100, v10, 0
    v_mov_b32 v10, 0xeeee4444
    v_lshlrev_b32 v124, 16, v196
    v_and_b32 v125, 0xffff0000, v196
    v_lshlrev_b32 v126, 16, v197
    v_and_b32 v127, 0xffff0000, v197
    v_lshlrev_b32 v128, 16, v198
    v_and_b32 v129, 0xffff0000, v198
    v_lshlrev_b32 v130, 16, v199
    v_and_b32 v131, 0xffff0000, v199
    v_lshlrev_b32 v132, 16, v200
    v_and_b32 v133, 0xffff0000, v200
    v_lshlrev_b32 v134, 16, v201
    v_and_b32 v135, 0xffff0000, v201
    v_lshlrev_b32 v136, 16, v202
    v_and_b32 v137, 0xffff0000, v202
    v_lshlrev_b32 v138, 16, v203
    v_and_b32 v139, 0xffff0000, v203
    v_lshlrev_b32 v140, 16, v204
    v_and_b32 v141, 0xffff0000, v204
    v_lshlrev_b32 v142, 16, v205
    v_and_b32 v143, 0xffff0000, v205
    v_lshlrev_b32 v144, 16, v206
    v_and_b32 v145, 0xffff0000, v206
    v_lshlrev_b32 v146, 16, v207
    v_and_b32 v147, 0xffff0000, v207
    v_lshlrev_b32 v148, 16, v208
    v_and_b32 v149, 0xffff0000, v208
    v_lshlrev_b32 v150, 16, v209
    v_and_b32 v151, 0xffff0000, v209
    v_lshlrev_b32 v152, 16, v210
    v_and_b32 v153, 0xffff0000, v210
    v_lshlrev_b32 v154, 16, v211
    v_and_b32 v155, 0xffff0000, v211
    v_lshlrev_b32 v156, 16, v212
    v_and_b32 v157, 0xffff0000, v212
    v_lshlrev_b32 v158, 16, v213
    v_and_b32 v159, 0xffff0000, v213
    s_mov_b32 exec_lo, 0x00010001
    s_mov_b32 exec_hi, 0x00010001
    ds_write_b128 v9, v[124:127] offset:10240
    ds_write_b128 v9, v[128:131] offset:10304
    ds_write_b128 v9, v[132:135] offset:10368
    ds_write_b128 v9, v[136:139] offset:10432
    ds_write_b128 v9, v[140:143] offset:10496
    ds_write_b128 v9, v[144:147] offset:10560
    ds_write_b128 v9, v[148:151] offset:10624
    ds_write_b128 v9, v[152:155] offset:10688
    ds_write_b128 v9, v[156:159] offset:10752
    s_mov_b64 exec, -1
    s_mul_i32 s30, s20, 175
    s_xor_b32 s31, s2, 0
    s_add_u32 s30, s30, s31
    s_sub_u32 s30, s30, 81
    s_cmp_lt_u32 s2, 81
    s_cselect_b32 s30, 1023, s30
    s_lshl_b32 s30, s30, 1
    v_lshrrev_b32 v244, 5, v12
    v_add_u32 v248, s30, v244
    v_mov_b32 v244, -1
    v_mov_b32 v245, 0
    v_subrev_u32 v246, 664, v248
    v_cmp_gt_u32 vcc, 12, v246
    v_mov_b32 v247, 0
    s_nop 0
    v_cndmask_b32 v244, v244, v246, vcc
    v_cndmask_b32 v245, v245, v247, vcc
    v_subrev_u32 v246, 638, v248
    v_cmp_gt_u32 vcc, 26, v246
    v_mov_b32 v247, 1
    s_nop 0
    v_cndmask_b32 v244, v244, v246, vcc
    v_cndmask_b32 v245, v245, v247, vcc
    v_subrev_u32 v246, 598, v248
    v_cmp_gt_u32 vcc, 40, v246
    v_mov_b32 v247, 2
    s_nop 0
    v_cndmask_b32 v244, v244, v246, vcc
    v_cndmask_b32 v245, v245, v247, vcc
    v_subrev_u32 v246, 542, v248
    v_cmp_gt_u32 vcc, 56, v246
    v_mov_b32 v247, 3
    s_nop 0
    v_cndmask_b32 v244, v244, v246, vcc
    v_cndmask_b32 v245, v245, v247, vcc
    v_subrev_u32 v246, 468, v248
    v_cmp_gt_u32 vcc, 74, v246
    v_mov_b32 v247, 4
    s_nop 0
    v_cndmask_b32 v244, v244, v246, vcc
    v_cndmask_b32 v245, v245, v247, vcc
    v_subrev_u32 v246, 376, v248
    v_cmp_gt_u32 vcc, 92, v246
    v_mov_b32 v247, 5
    s_nop 0
    v_cndmask_b32 v244, v244, v246, vcc
    v_cndmask_b32 v245, v245, v247, vcc
    v_subrev_u32 v246, 268, v248
    v_cmp_gt_u32 vcc, 108, v246
    v_mov_b32 v247, 6
    s_nop 0
    v_cndmask_b32 v244, v244, v246, vcc
    v_cndmask_b32 v245, v245, v247, vcc
    v_subrev_u32 v246, 142, v248
    v_cmp_gt_u32 vcc, 126, v246
    v_mov_b32 v247, 7
    s_nop 0
    v_cndmask_b32 v244, v244, v246, vcc
    v_cndmask_b32 v245, v245, v247, vcc
    v_subrev_u32 v246, 0, v248
    v_cmp_gt_u32 vcc, 142, v246
    v_mov_b32 v247, 8
    s_nop 0
    v_cndmask_b32 v244, v244, v246, vcc
    v_cndmask_b32 v245, v245, v247, vcc
    v_sub_u32 v244, 2047, v244
    v_mul_u32_u24 v244, 36864, v244
    v_lshl_add_u32 v244, v245, 7, v244
    v_and_b32 v245, 31, v12
    v_mul_u32_u24 v245, 1152, v245
    v_add_u32 v249, v244, v245
    s_mov_b32 vcc_lo, 0xff00ff00
    s_mov_b32 vcc_hi, 0xff00ff00
    s_waitcnt vmcnt(0)
    v_readfirstlane_b32 s30, v0
    s_mov_b32 s31, 0
    s_sub_u32 s30, s30, s100
    s_cmp_eq_u32 s30, 27
    s_cbranch_scc0 M_pf_spin
M_pf_ok:
    s_lshr_b32 s30, s2, 3
    s_sub_u32 s31, s30, 11
    s_cselect_b32 s30, s30, s31
    s_mul_i32 s30, s30, 3072
    s_add_u32 s30, s30, s43
    s_add_u32 s30, s30, 33792
    v_lshlrev_b32 v244, 3, v11
    v_mov_b32 v0, v249
    buffer_load_dwordx4 v[92:95], v11, s[16:19], s43 offen offset:0 sc1
    buffer_load_dwordx4 v[96:99], v11, s[16:19], s43 offen offset:1024 sc1
    buffer_load_dwordx4 v[100:103], v11, s[16:19], s43 offen offset:2048 sc1
    s_mov_b32 exec_hi, 268435455
    buffer_load_dwordx4 v[104:107], v11, s[16:19], s43 offen offset:3072 sc1
    s_mov_b32 exec_hi, -1
    s_add_u32 s43, s43, 4096
    buffer_load_dwordx4 v[48:51], v11, s[16:19], s43 offen offset:0 sc1
    buffer_load_dword v52, v11, s[16:19], s43 offen offset:1024 sc1
    buffer_load_dwordx4 v[12:15], v11, s[16:19], s43 offen offset:2048 sc1
    buffer_load_dwordx4 a[0:3], v11, s[16:19], s43 offen offset:3072 sc1
    s_add_u32 s43, s43, 4096
    buffer_load_dwordx4 a[4:7], v11, s[16:19], s43 offen offset:0 sc1
    buffer_load_dwordx4 a[8:11], v11, s[16:19], s43 offen offset:1024 sc1
    buffer_load_dwordx4 a[12:15], v11, s[16:19], s43 offen offset:2048 sc1
    buffer_load_dwordx4 a[16:19], v11, s[16:19], s43 offen offset:3072 sc1
    s_add_u32 s43, s43, 4096
    s_bfm_b64 exec, 24, 0
    buffer_load_dword v244, v244, s[16:19], s30 offen sc1
    s_mov_b64 exec, -1
    buffer_load_dwordx4 a[20:23], v11, s[16:19], s43 offen offset:0 sc1
    buffer_load_dwordx4 a[24:27], v11, s[16:19], s43 offen offset:1024 sc1
    buffer_load_dwordx4 a[28:31], v11, s[16:19], s43 offen offset:2048 sc1
    buffer_load_dwordx4 a[32:35], v11, s[16:19], s43 offen offset:3072 sc1
    s_add_u32 s43, s43, 4096
    buffer_load_dwordx4 v[16:19], v11, s[16:19], s43 offen offset:0 sc1
    buffer_load_dwordx4 a[36:39], v11, s[16:19], s43 offen offset:1024 sc1
    buffer_load_dwordx4 a[40:43], v11, s[16:19], s43 offen offset:2048 sc1
    buffer_load_dwordx4 a[44:47], v11, s[16:19], s43 offen offset:3072 sc1
    s_add_u32 s43, s43, 4096
    buffer_load_dwordx4 a[48:51], v11, s[16:19], s43 offen offset:0 sc1
    buffer_load_dwordx4 a[52:55], v11, s[16:19], s43 offen offset:1024 sc1
    buffer_load_dwordx4 a[56:59], v11, s[16:19], s43 offen offset:2048 sc1
    buffer_load_dwordx4 a[60:63], v11, s[16:19], s43 offen offset:3072 sc1
    s_add_u32 s43, s43, 4096
    buffer_load_dwordx4 a[64:67], v11, s[16:19], s43 offen offset:0 sc1
    buffer_load_dwordx4 a[68:71], v11, s[16:19], s43 offen offset:1024 sc1
    buffer_load_dwordx4 v[20:23], v11, s[16:19], s43 offen offset:2048 sc1
    buffer_load_dwordx4 a[72:75], v11, s[16:19], s43 offen offset:3072 sc1
    s_add_u32 s43, s43, 4096
    buffer_load_dwordx4 a[76:79], v11, s[16:19], s43 offen offset:0 sc1
    buffer_load_dwordx4 a[80:83], v11, s[16:19], s43 offen offset:1024 sc1
    buffer_load_dwordx4 a[84:87], v11, s[16:19], s43 offen offset:2048 sc1
    buffer_load_dwordx4 a[88:91], v11, s[16:19], s43 offen offset:3072 sc1
    s_add_u32 s43, s43, 4096
    buffer_load_dwordx4 a[92:95], v11, s[16:19], s43 offen offset:0 sc1
    buffer_load_dwordx4 a[96:99], v11, s[16:19], s43 offen offset:1024 sc1
    buffer_load_dwordx4 a[100:103], v11, s[16:19], s43 offen offset:2048 sc1
    buffer_load_dwordx4 a[104:107], v11, s[16:19], s43 offen offset:3072 sc1
    s_add_u32 s43, s43, 4096
    buffer_load_dwordx4 v[24:27], v11, s[16:19], s43 offen offset:0 sc1
    buffer_load_dwordx4 a[108:111], v11, s[16:19], s43 offen offset:1024 sc1
    ds_read_b128 v[160:163], v9 offset:10240
    ds_read_b128 v[164:167], v9 offset:10304
    ds_read_b128 v[168:171], v9 offset:10368
    ds_read_b128 v[172:175], v9 offset:10432
    ds_read_b128 v[176:179], v9 offset:10496
    ds_read_b128 v[180:183], v9 offset:10560
    ds_read_b128 v[184:187], v9 offset:10624
    ds_read_b128 v[188:191], v9 offset:10688
    ds_read_b128 v[192:195], v9 offset:10752
    s_cmp_eq_u32 s98, 0
    s_cbranch_scc1 M_cnt
    s_mov_b32 s98, 0
    v_mov_b32 v250, 1
    s_mov_b64 exec, 1
    buffer_atomic_add v250, off, s[68:71], 0 offset:0 sc1
    s_mov_b64 exec, -1
    s_nop 3
M_cnt:
    s_waitcnt vmcnt(31)
    s_barrier
    ds_read_b128 v[196:199], v1 offset:0
    ds_read_b128 v[200:203], v2 offset:0
    ds_read_b128 v[228:231], v1 offset:18432
    ds_read_b128 v[232:235], v2 offset:18432
    s_waitcnt lgkmcnt(2)
    v_smfmac_f32_16x16x64_bf16 v[124:127], a[0:3], v[196:203], v12
    buffer_load_dwordx4 a[112:115], v11, s[16:19], s43 offen offset:2048 sc1
    s_waitcnt lgkmcnt(0)
    v_mov_b32 v118, s54
    v_smfmac_f32_16x16x64_bf16 v[160:163], a[0:3], v[228:235], v12
    ds_read_b128 v[204:207], v1 offset:1024
    ds_read_b128 v[208:211], v2 offset:1024
    v_or3_b32 v114, v92, v96, v100
    v_or_b32 v114, v114, v104
    v_cmp_gt_i32 s[32:33], 0, v114
    v_cmp_gt_u32 s[36:37], 2.0, v92
    s_nop 1
    v_mbcnt_lo_u32_b32 v110, s36, 0
    s_waitcnt vmcnt(31)
    v_mbcnt_hi_u32_b32 v110, s37, v110
    v_smfmac_f32_16x16x64_bf16 v[128:131], a[4:7], v[196:203], v12 abid:1
    buffer_load_dwordx4 a[116:119], v11, s[16:19], s43 offen offset:3072 sc1
    v_lshl_add_u32 v110, v110, 3, s38
    v_smfmac_f32_16x16x64_bf16 v[164:167], a[4:7], v[228:235], v12 abid:1
    ds_read_b128 v[220:223], v1 offset:19456
    ds_read_b128 v[224:227], v2 offset:19456
    v_min_u32 v110, s39, v110
    s_waitcnt vmcnt(31)
    v_cndmask_b32 v110, v118, v110, s[36:37]
    v_smfmac_f32_16x16x64_bf16 v[132:135], a[8:11], v[196:203], v13
    s_add_u32 s43, s43, 4096
    buffer_load_dwordx4 a[120:123], v11, s[16:19], s43 offen offset:0 sc1
    ds_write_b64 v110, v[92:93]
    s_bcnt1_i32_b64 s30, s[36:37]
    s_lshl3_add_u32 s38, s30, s38
    v_cmp_gt_u32 s[44:45], 2.0, v94
    v_smfmac_f32_16x16x64_bf16 v[168:171], a[8:11], v[228:235], v13
    s_nop 0
    v_mbcnt_lo_u32_b32 v111, s44, 0
    v_mbcnt_hi_u32_b32 v111, s45, v111
    v_lshl_add_u32 v111, v111, 3, s38
    v_min_u32 v111, s39, v111
    s_waitcnt vmcnt(31)
    v_cndmask_b32 v111, v118, v111, s[44:45]
    v_smfmac_f32_16x16x64_bf16 v[136:139], a[12:15], v[196:203], v13 abid:1
    buffer_load_dwordx4 a[124:127], v11, s[16:19], s43 offen offset:1024 sc1
    ds_write_b64 v111, v[94:95]
    s_bcnt1_i32_b64 s30, s[44:45]
    s_lshl3_add_u32 s38, s30, s38
    v_cmp_gt_u32 s[36:37], 2.0, v96
    v_smfmac_f32_16x16x64_bf16 v[172:175], a[12:15], v[228:235], v13 abid:1
    s_nop 0
    v_mbcnt_lo_u32_b32 v110, s36, 0
    v_mbcnt_hi_u32_b32 v110, s37, v110
    v_lshl_add_u32 v110, v110, 3, s38
    s_waitcnt vmcnt(31)
    v_min_u32 v110, s39, v110
    v_smfmac_f32_16x16x64_bf16 v[140:143], a[16:19], v[196:203], v14
    buffer_load_dwordx4 a[128:131], v11, s[16:19], s43 offen offset:2048 sc1
    v_cndmask_b32 v110, v118, v110, s[36:37]
    v_smfmac_f32_16x16x64_bf16 v[176:179], a[16:19], v[228:235], v14
    ds_write_b64 v110, v[96:97]
    s_bcnt1_i32_b64 s30, s[36:37]
    s_lshl3_add_u32 s38, s30, s38
    v_cmp_gt_u32 s[44:45], 2.0, v98
    s_nop 1
    v_mbcnt_lo_u32_b32 v111, s44, 0
    s_waitcnt vmcnt(30)
    v_mbcnt_hi_u32_b32 v111, s45, v111
    v_smfmac_f32_16x16x64_bf16 v[144:147], a[20:23], v[196:203], v14 abid:1
    buffer_load_dwordx4 a[132:135], v11, s[16:19], s43 offen offset:3072 sc1
    v_lshl_add_u32 v111, v111, 3, s38
    v_smfmac_f32_16x16x64_bf16 v[180:183], a[20:23], v[228:235], v14 abid:1
    v_min_u32 v111, s39, v111
    s_waitcnt vmcnt(30)
    v_cndmask_b32 v111, v118, v111, s[44:45]
    v_smfmac_f32_16x16x64_bf16 v[148:151], a[24:27], v[196:203], v15
    s_add_u32 s43, s43, 4096
    buffer_load_dwordx4 a[136:139], v11, s[16:19], s43 offen offset:0 sc1
    ds_write_b64 v111, v[98:99]
    s_bcnt1_i32_b64 s30, s[44:45]
    s_lshl3_add_u32 s38, s30, s38
    v_cmp_gt_u32 s[36:37], 2.0, v100
    v_smfmac_f32_16x16x64_bf16 v[184:187], a[24:27], v[228:235], v15
    s_nop 0
    v_mbcnt_lo_u32_b32 v110, s36, 0
    v_mbcnt_hi_u32_b32 v110, s37, v110
    v_lshl_add_u32 v110, v110, 3, s38
    v_min_u32 v110, s39, v110
    s_waitcnt vmcnt(30)
    v_cndmask_b32 v110, v118, v110, s[36:37]
    v_smfmac_f32_16x16x64_bf16 v[152:155], a[28:31], v[196:203], v15 abid:1
    buffer_load_dwordx4 a[140:143], v11, s[16:19], s43 offen offset:1024 sc1
    ds_write_b64 v110, v[100:101]
    s_bcnt1_i32_b64 s30, s[36:37]
    s_lshl3_add_u32 s38, s30, s38
    v_cmp_gt_u32 s[44:45], 2.0, v102
    v_smfmac_f32_16x16x64_bf16 v[188:191], a[28:31], v[228:235], v15 abid:1
    s_nop 0
    v_mbcnt_lo_u32_b32 v111, s44, 0
    v_mbcnt_hi_u32_b32 v111, s45, v111
    v_lshl_add_u32 v111, v111, 3, s38
    s_waitcnt vmcnt(30)
    v_min_u32 v111, s39, v111
    v_smfmac_f32_16x16x64_bf16 v[156:159], a[32:35], v[196:203], v48
    buffer_load_dwordx4 v[28:31], v11, s[16:19], s43 offen offset:2048 sc1
    buffer_load_dwordx4 a[144:147], v11, s[16:19], s43 offen offset:3072 sc1
    v_cndmask_b32 v111, v118, v111, s[44:45]
    v_smfmac_f32_16x16x64_bf16 v[192:195], a[32:35], v[228:235], v48
    ds_write_b64 v111, v[102:103]
    s_bcnt1_i32_b64 s30, s[44:45]
    s_lshl3_add_u32 s38, s30, s38
    v_cmp_gt_u32 s[36:37], 2.0, v104
    s_nop 1
    s_waitcnt vmcnt(30)
    s_waitcnt lgkmcnt(8)
    v_mbcnt_lo_u32_b32 v110, s36, 0
    v_smfmac_f32_16x16x64_bf16 v[124:127], a[36:39], v[204:211], v16
    s_add_u32 s43, s43, 4096
    buffer_load_dwordx4 a[148:151], v11, s[16:19], s43 offen offset:0 sc1
    s_waitcnt lgkmcnt(6)
    v_mbcnt_hi_u32_b32 v110, s37, v110
    v_smfmac_f32_16x16x64_bf16 v[160:163], a[36:39], v[220:227], v16
    ds_read_b128 v[196:199], v1 offset:2048
    ds_read_b128 v[200:203], v2 offset:2048
    v_lshl_add_u32 v110, v110, 3, s38
    v_min_u32 v110, s39, v110
    s_waitcnt vmcnt(30)
    v_cndmask_b32 v110, v118, v110, s[36:37]
    v_smfmac_f32_16x16x64_bf16 v[128:131], a[40:43], v[204:211], v16 abid:1
    buffer_load_dwordx4 a[152:155], v11, s[16:19], s43 offen offset:1024 sc1
    ds_write_b64 v110, v[104:105]
    s_bcnt1_i32_b64 s30, s[36:37]
    s_lshl3_add_u32 s38, s30, s38
    v_cmp_gt_u32 s[44:45], 2.0, v106
    v_smfmac_f32_16x16x64_bf16 v[164:167], a[40:43], v[220:227], v16 abid:1
    ds_read_b128 v[228:231], v1 offset:20480
    ds_read_b128 v[232:235], v2 offset:20480
    v_mbcnt_lo_u32_b32 v111, s44, 0
    v_mbcnt_hi_u32_b32 v111, s45, v111
    v_lshl_add_u32 v111, v111, 3, s38
    v_min_u32 v111, s39, v111
    s_waitcnt vmcnt(30)
    v_cndmask_b32 v111, v118, v111, s[44:45]
    v_smfmac_f32_16x16x64_bf16 v[132:135], a[44:47], v[204:211], v17
    buffer_load_dwordx4 a[156:159], v11, s[16:19], s43 offen offset:2048 sc1
    ds_write_b64 v111, v[106:107]
    s_bcnt1_i32_b64 s30, s[44:45]
    s_lshl3_add_u32 s38, s30, s38
    ds_read_b64 v[92:93], v55 offset:0
    ds_read_b64 v[94:95], v55 offset:512
    ds_read_b64 v[96:97], v55 offset:1024
    v_smfmac_f32_16x16x64_bf16 v[168:171], a[44:47], v[220:227], v17
    s_waitcnt vmcnt(30)
    v_smfmac_f32_16x16x64_bf16 v[136:139], a[48:51], v[204:211], v17 abid:1
    buffer_load_dwordx4 a[160:163], v11, s[16:19], s43 offen offset:3072 sc1
    v_smfmac_f32_16x16x64_bf16 v[172:175], a[48:51], v[220:227], v17 abid:1
    s_waitcnt vmcnt(30)
    v_smfmac_f32_16x16x64_bf16 v[140:143], a[52:55], v[204:211], v18
    s_add_u32 s43, s43, 4096
    buffer_load_dwordx4 a[164:167], v11, s[16:19], s43 offen offset:0 sc1
    s_waitcnt lgkmcnt(2)
    v_bfe_u32 v110, v92, 24, 4
    v_smfmac_f32_16x16x64_bf16 v[176:179], a[52:55], v[220:227], v18
    v_lshlrev_b32 v111, 1, v92
    v_lshl_add_u32 v110, v110, 2, s49
    v_and_b32 v111, 16, v111
    s_waitcnt vmcnt(30)
    v_and_or_b32 v110, v92, 2.0, v110
    v_smfmac_f32_16x16x64_bf16 v[144:147], a[56:59], v[204:211], v18 abid:1
    buffer_load_dwordx4 a[168:171], v11, s[16:19], s43 offen offset:1024 sc1
    v_lshlrev_b32 v111, v111, 1
    v_smfmac_f32_16x16x64_bf16 v[180:183], a[56:59], v[220:227], v18 abid:1
    ds_add_rtn_u32 v98, v110, v111
    s_waitcnt lgkmcnt(2)
    v_bfe_u32 v112, v94, 24, 4
    v_lshlrev_b32 v113, 1, v94
    v_lshl_add_u32 v112, v112, 2, s49
    s_waitcnt vmcnt(30)
    v_and_b32 v113, 16, v113
    v_smfmac_f32_16x16x64_bf16 v[148:151], a[60:63], v[204:211], v19
    buffer_load_dwordx4 a[172:175], v11, s[16:19], s43 offen offset:2048 sc1
    v_and_or_b32 v112, v94, 2.0, v112
    v_smfmac_f32_16x16x64_bf16 v[184:187], a[60:63], v[220:227], v19
    s_waitcnt vmcnt(30)
    v_lshlrev_b32 v113, v113, 1
    v_smfmac_f32_16x16x64_bf16 v[152:155], a[64:67], v[204:211], v19 abid:1
    buffer_load_dwordx4 a[176:179], v11, s[16:19], s43 offen offset:3072 sc1
    ds_add_rtn_u32 v99, v112, v113
    s_waitcnt lgkmcnt(2)
    s_cmp_gt_u32 s38, s35
    s_cbranch_scc1 M_r3
M_r3r:
    ds_read_b32 v117, v121
    v_and_b32 v110, 8, v92
    v_smfmac_f32_16x16x64_bf16 v[188:191], a[64:67], v[220:227], v19 abid:1
    v_lshrrev_b32 v113, 14, v92
    v_cmp_ne_u32 s[44:45], 0, v110
    v_and_b32 v116, 0x3cf0, v113
    s_waitcnt lgkmcnt(2)
    v_lshrrev_b32 v111, 16, v98
    v_and_b32 v112, 0xffff, v98
    s_waitcnt vmcnt(30)
    v_sub_u32 v110, 15, v111
    v_smfmac_f32_16x16x64_bf16 v[156:159], a[68:71], v[204:211], v48 abid:1
    s_add_u32 s43, s43, 4096
    buffer_load_dwordx4 v[32:35], v11, s[16:19], s43 offen offset:0 sc1
    buffer_load_dwordx4 a[180:183], v11, s[16:19], s43 offen offset:1024 sc1
    v_and_b32 v98, 2.0, v92
    v_smfmac_f32_16x16x64_bf16 v[192:195], a[68:71], v[220:227], v48 abid:1
    v_add3_u32 v98, v112, v111, v98
    v_cndmask_b32 v110, v112, v110, s[44:45]
    v_cmp_gt_u32 s[44:45], 16, v98
    v_cmp_gt_u32 s[36:37], 2.0, v98
    v_lshlrev_b32 v110, 2, v110
    s_waitcnt vmcnt(30)
    v_lshrrev_b64 v[112:113], v110, s[50:51]
    v_smfmac_f32_16x16x64_bf16 v[124:127], a[72:75], v[196:203], v20
    buffer_load_dwordx4 a[184:187], v11, s[16:19], s43 offen offset:2048 sc1
    s_andn2_b64 s[36:37], s[36:37], s[44:45]
    v_lshrrev_b64 v[114:115], v110, s[52:53]
    v_smfmac_f32_16x16x64_bf16 v[160:163], a[72:75], v[228:235], v20
    ds_read_b128 v[204:207], v1 offset:3072
    ds_read_b128 v[208:211], v2 offset:3072
    v_bfe_u32 v110, v92, 24, 4
    v_mbcnt_lo_u32_b32 v111, s36, 0
    v_and_b32 v112, 15, v112
    v_mbcnt_hi_u32_b32 v111, s37, v111
    v_and_b32 v114, 15, v114
    s_waitcnt vmcnt(30)
    v_lshl_add_u32 v111, v111, 3, s40
    v_smfmac_f32_16x16x64_bf16 v[128:131], a[76:79], v[196:203], v20 abid:1
    buffer_load_dwordx4 a[188:191], v11, s[16:19], s43 offen offset:3072 sc1
    v_lshl_add_u32 v112, v110, 4, v112
    v_smfmac_f32_16x16x64_bf16 v[164:167], a[76:79], v[228:235], v20 abid:1
    ds_read_b128 v[220:223], v1 offset:21504
    ds_read_b128 v[224:227], v2 offset:21504
    v_min_u32 v111, s41, v111
    v_mul_u32_u24 v114, 68, v114
    s_waitcnt vmcnt(30)
    v_cndmask_b32 v111, v118, v111, s[36:37]
    v_smfmac_f32_16x16x64_bf16 v[132:135], a[80:83], v[196:203], v21
    s_add_u32 s43, s43, 4096
    buffer_load_dwordx4 a[192:195], v11, s[16:19], s43 offen offset:0 sc1
    ds_write_b64 v111, v[92:93]
    s_bcnt1_i32_b64 s30, s[36:37]
    s_lshl3_add_u32 s40, s30, s40
    v_lshl_add_u32 v112, v112, 2, s47
    v_smfmac_f32_16x16x64_bf16 v[168:171], a[80:83], v[228:235], v21
    v_and_b32 v114, 0x30c, v114
    v_cndmask_b32 v112, v118, v112, s[44:45]
    v_add3_u32 v113, v116, v114, s29
    v_and_b32 v114, 0x3fff, v92
    s_waitcnt vmcnt(30)
    v_cndmask_b32 v110, v118, v113, s[44:45]
    v_smfmac_f32_16x16x64_bf16 v[136:139], a[84:87], v[196:203], v21 abid:1
    buffer_load_dwordx4 a[196:199], v11, s[16:19], s43 offen offset:1024 sc1
    ds_write_b32 v112, v114
    ds_write_b32 v110, v93
    v_and_b32 v110, 8, v94
    v_smfmac_f32_16x16x64_bf16 v[172:175], a[84:87], v[228:235], v21 abid:1
    v_lshrrev_b32 v113, 14, v94
    v_cmp_ne_u32 s[44:45], 0, v110
    v_and_b32 v116, 0x3cf0, v113
    s_waitcnt lgkmcnt(8)
    s_waitcnt vmcnt(30)
    v_lshrrev_b32 v111, 16, v99
    v_smfmac_f32_16x16x64_bf16 v[140:143], a[88:91], v[196:203], v22
    buffer_load_dwordx4 a[200:203], v11, s[16:19], s43 offen offset:2048 sc1
    v_and_b32 v112, 0xffff, v99
    v_smfmac_f32_16x16x64_bf16 v[176:179], a[88:91], v[228:235], v22
    v_sub_u32 v110, 15, v111
    v_and_b32 v99, 2.0, v94
    v_add3_u32 v99, v112, v111, v99
    v_cndmask_b32 v110, v112, v110, s[44:45]
    s_waitcnt vmcnt(30)
    v_cmp_gt_u32 s[44:45], 16, v99
    v_smfmac_f32_16x16x64_bf16 v[144:147], a[92:95], v[196:203], v22 abid:1
    buffer_load_dwordx4 a[204:207], v11, s[16:19], s43 offen offset:3072 sc1
    v_cmp_gt_u32 s[36:37], 2.0, v99
    v_smfmac_f32_16x16x64_bf16 v[180:183], a[92:95], v[228:235], v22 abid:1
    v_lshlrev_b32 v110, 2, v110
    s_waitcnt vmcnt(30)
    v_lshrrev_b64 v[112:113], v110, s[50:51]
    v_smfmac_f32_16x16x64_bf16 v[148:151], a[96:99], v[196:203], v23
    s_add_u32 s43, s43, 4096
    buffer_load_dwordx4 a[208:211], v11, s[16:19], s43 offen offset:0 sc1
    s_andn2_b64 s[36:37], s[36:37], s[44:45]
    v_lshrrev_b64 v[114:115], v110, s[52:53]
    v_smfmac_f32_16x16x64_bf16 v[184:187], a[96:99], v[228:235], v23
    v_bfe_u32 v110, v94, 24, 4
    v_mbcnt_lo_u32_b32 v111, s36, 0
    v_and_b32 v112, 15, v112
    v_mbcnt_hi_u32_b32 v111, s37, v111
    v_and_b32 v114, 15, v114
    s_waitcnt vmcnt(30)
    v_lshl_add_u32 v111, v111, 3, s40
    v_smfmac_f32_16x16x64_bf16 v[152:155], a[100:103], v[196:203], v23 abid:1
    buffer_load_dwordx4 a[212:215], v11, s[16:19], s43 offen offset:1024 sc1
    v_lshl_add_u32 v112, v110, 4, v112
    v_smfmac_f32_16x16x64_bf16 v[188:191], a[100:103], v[228:235], v23 abid:1
    v_min_u32 v111, s41, v111
    v_mul_u32_u24 v114, 68, v114
    s_waitcnt vmcnt(30)
    v_cndmask_b32 v111, v118, v111, s[36:37]
    v_smfmac_f32_16x16x64_bf16 v[156:159], a[104:107], v[196:203], v49
    buffer_load_dwordx4 v[36:39], v11, s[16:19], s43 offen offset:2048 sc1
    buffer_load_dwordx4 a[216:219], v11, s[16:19], s43 offen offset:3072 sc1
    ds_write_b64 v111, v[94:95]
    s_bcnt1_i32_b64 s30, s[36:37]
    s_lshl3_add_u32 s40, s30, s40
    v_lshl_add_u32 v112, v112, 2, s47
    v_smfmac_f32_16x16x64_bf16 v[192:195], a[104:107], v[228:235], v49
    v_and_b32 v114, 0x30c, v114
    v_cndmask_b32 v112, v118, v112, s[44:45]
    v_add3_u32 v113, v116, v114, s29
    v_and_b32 v114, 0x3fff, v94
    s_waitcnt vmcnt(30)
    s_waitcnt lgkmcnt(6)
    v_cndmask_b32 v110, v118, v113, s[44:45]
    v_smfmac_f32_16x16x64_bf16 v[124:127], a[108:111], v[204:211], v24
    s_add_u32 s43, s43, 4096
    buffer_load_dwordx4 a[220:223], v11, s[16:19], s43 offen offset:0 sc1
    ds_write_b32 v112, v114
    ds_write_b32 v110, v95
    s_waitcnt lgkmcnt(6)
    v_lshrrev_b32 v110, 16, v117
    v_smfmac_f32_16x16x64_bf16 v[160:163], a[108:111], v[220:227], v24
    ds_read_b128 v[196:199], v1 offset:4096
    ds_read_b128 v[200:203], v2 offset:4096
    v_and_b32 v117, 0xffff, v117
    v_add_u32 v117, v117, v110
    s_waitcnt vmcnt(30)
    v_cmp_lt_u32 s[34:35], 16, v117
    v_smfmac_f32_16x16x64_bf16 v[128:131], a[112:115], v[204:211], v24 abid:1
    buffer_load_dwordx4 a[224:227], v11, s[16:19], s43 offen offset:1024 sc1
    s_sub_u32 s46, s40, s48
    s_add_u32 s46, s46, 56
    s_lshr_b32 s46, s46, 6
    s_mov_b32 s21, 0
    s_and_b32 s27, s34, 0x1ff
    s_cmp_gt_u32 s46, 4
    s_cselect_b32 s32, 1, s32
    s_or_b32 s32, s32, s33
    s_cbranch_scc1 M_dn
M_dnr:
    ds_read_b128 v[92:95], v9 offset:9792
    s_bcnt1_i32_b32 s30, s27
    s_cmp_gt_u32 s30, 3
    s_cselect_b32 s34, 0, s27
    s_cselect_b32 s80, 0, 1
    s_getpc_b64 s[36:37]
M_pc:
    v_bfe_u32 v110, v11, 4, 4
    v_smfmac_f32_16x16x64_bf16 v[164:167], a[112:115], v[220:227], v24 abid:1
    ds_read_b128 v[228:231], v1 offset:22528
    ds_read_b128 v[232:235], v2 offset:22528
    s_waitcnt vmcnt(30)
    v_smfmac_f32_16x16x64_bf16 v[132:135], a[116:119], v[204:211], v25
    buffer_load_dwordx4 a[228:231], v11, s[16:19], s43 offen offset:2048 sc1
    s_ff1_i32_b32 s81, s34
    s_bitset0_b32 s34, s81
    s_mul_i32 s30, s81, 20
    s_add_u32 s31, s30, M_ovc0-M_pc
    s_add_u32 s30, s30, M_ovl0-M_pc
    s_cmp_lg_u32 s34, 0
    s_cselect_b32 s30, s31, s30
    s_cmp_lt_i32 s81, 0
    s_cselect_b32 s30, M_ovn-M_pc, s30
    s_add_u32 s72, s36, s30
    s_addc_u32 s73, s37, 0
    s_ff1_i32_b32 s82, s34
    s_bitset0_b32 s34, s82
    s_mul_i32 s30, s82, 20
    s_add_u32 s31, s30, M_ovc1-M_pc
    s_add_u32 s30, s30, M_ovl1-M_pc
    s_cmp_lg_u32 s34, 0
    s_cselect_b32 s30, s31, s30
    s_cmp_lt_i32 s82, 0
    s_cselect_b32 s30, M_ovn-M_pc, s30
    v_smfmac_f32_16x16x64_bf16 v[168:171], a[116:119], v[220:227], v25
    s_waitcnt vmcnt(30)
    v_smfmac_f32_16x16x64_bf16 v[136:139], a[120:123], v[204:211], v25 abid:1
    buffer_load_dwordx4 a[232:235], v11, s[16:19], s43 offen offset:3072 sc1
    s_add_u32 s74, s36, s30
    s_addc_u32 s75, s37, 0
    s_ff1_i32_b32 s83, s34
    s_bitset0_b32 s34, s83
    s_mul_i32 s30, s83, 20
    s_add_u32 s31, s30, M_ovc1-M_pc
    s_add_u32 s30, s30, M_ovl2-M_pc
    s_cmp_lg_u32 s34, 0
    s_cselect_b32 s30, s31, s30
    s_cmp_lt_i32 s83, 0
    s_cselect_b32 s30, M_ovn-M_pc, s30
    s_add_u32 s76, s36, s30
    s_addc_u32 s77, s37, 0
    s_waitcnt lgkmcnt(2)
    v_lshrrev_b32 v112, 18, v92
    v_smfmac_f32_16x16x64_bf16 v[172:175], a[120:123], v[220:227], v25 abid:1
    s_waitcnt vmcnt(30)
    v_lshrrev_b32 v113, 18, v94
    v_smfmac_f32_16x16x64_bf16 v[140:143], a[124:127], v[204:211], v26
    s_add_u32 s43, s43, 4096
    buffer_load_dwordx4 a[236:239], v11, s[16:19], s43 offen offset:0 sc1
    v_and_b32 v114, 0x3fff, v92
    v_smfmac_f32_16x16x64_bf16 v[176:179], a[124:127], v[220:227], v26
    s_waitcnt vmcnt(30)
    v_and_b32 v115, 0x3fff, v94
    v_smfmac_f32_16x16x64_bf16 v[144:147], a[128:131], v[204:211], v26 abid:1
    buffer_load_dwordx4 a[240:243], v11, s[16:19], s43 offen offset:1024 sc1
    ds_write_b64 v9, v[114:115] offset:10056
    v_lshl_or_b32 v111, s81, 6, v110
    v_smfmac_f32_16x16x64_bf16 v[180:183], a[128:131], v[220:227], v26 abid:1
    v_cmp_eq_u32 s[44:45], v112, v111
    v_cmp_eq_u32 s[36:37], v113, v111
    s_nop 0
    v_cndmask_b32 v54, 0, v93, s[44:45]
    v_cndmask_b32 v55, 0, v95, s[36:37]
    v_lshl_or_b32 v111, s82, 6, v110
    s_waitcnt vmcnt(30)
    v_cmp_eq_u32 s[44:45], v112, v111
    v_smfmac_f32_16x16x64_bf16 v[148:151], a[132:135], v[204:211], v27
    buffer_load_dwordx4 a[244:247], v11, s[16:19], s43 offen offset:2048 sc1
    v_cmp_eq_u32 s[36:37], v113, v111
    v_smfmac_f32_16x16x64_bf16 v[184:187], a[132:135], v[220:227], v27
    v_cndmask_b32 v252, 0, v93, s[44:45]
    v_cndmask_b32 v253, 0, v95, s[36:37]
    v_lshl_or_b32 v111, s83, 6, v110
    v_cmp_eq_u32 s[44:45], v112, v111
    v_cmp_eq_u32 s[36:37], v113, v111
    s_nop 0
    s_waitcnt vmcnt(30)
    v_cndmask_b32 v254, 0, v93, s[44:45]
    v_smfmac_f32_16x16x64_bf16 v[152:155], a[136:139], v[204:211], v27 abid:1
    buffer_load_dwordx4 a[248:251], v11, s[16:19], s43 offen offset:3072 sc1
    v_cndmask_b32 v255, 0, v95, s[36:37]
    v_smfmac_f32_16x16x64_bf16 v[188:191], a[136:139], v[220:227], v27 abid:1
    ds_read_b128 v[236:239], v9 offset:9408
    ds_read_b64 v[216:217], v9 offset:10056
    s_waitcnt vmcnt(30)
    v_smfmac_f32_16x16x64_bf16 v[156:159], a[140:143], v[204:211], v49 abid:1
    s_add_u32 s43, s43, 4096
    buffer_load_dwordx4 v[40:43], v11, s[16:19], s43 offen offset:0 sc1
    buffer_load_dwordx4 a[252:255], v11, s[16:19], s43 offen offset:1024 sc1
    s_waitcnt lgkmcnt(1)
    v_xad_u32 v236, v236, v3, v4
    v_smfmac_f32_16x16x64_bf16 v[192:195], a[140:143], v[220:227], v49 abid:1
    s_waitcnt vmcnt(30)
    v_xad_u32 v237, v237, v3, v4
    v_smfmac_f32_16x16x64_bf16 v[124:127], a[144:147], v[196:203], v28
    buffer_load_dwordx4 v[56:59], v11, s[16:19], s43 offen offset:2048 sc1
    ds_read2st64_b32 v[244:245], v236 offset0:0 offset1:72
    ds_read2st64_b32 v[246:247], v237 offset0:0 offset1:72
    v_xad_u32 v238, v238, v3, v4
    v_smfmac_f32_16x16x64_bf16 v[160:163], a[144:147], v[228:235], v28
    ds_read_b128 v[204:207], v1 offset:5120
    ds_read_b128 v[208:211], v2 offset:5120
    s_waitcnt vmcnt(30)
    v_xad_u32 v239, v239, v3, v4
    v_smfmac_f32_16x16x64_bf16 v[128:131], a[148:151], v[196:203], v28 abid:1
    buffer_load_dwordx4 v[60:63], v11, s[16:19], s43 offen offset:3072 sc1
    ds_read2st64_b32 v[248:249], v238 offset0:0 offset1:72
    ds_read2st64_b32 v[250:251], v239 offset0:0 offset1:72
    ds_read_b128 v[240:243], v8 offset:3072
    ds_read_b128 v[236:239], v9 offset:9280
    s_waitcnt lgkmcnt(8)
    v_xad_u32 v212, v216, v3, v4
    v_smfmac_f32_16x16x64_bf16 v[164:167], a[148:151], v[228:235], v28 abid:1
    ds_read_b128 v[220:223], v1 offset:23552
    ds_read_b128 v[224:227], v2 offset:23552
    ds_read2st64_b32 v[212:213], v212 offset0:0 offset1:72
    s_waitcnt vmcnt(30)
    v_xad_u32 v214, v217, v3, v4
    v_smfmac_f32_16x16x64_bf16 v[132:135], a[152:155], v[196:203], v29
    s_add_u32 s43, s43, 4096
    buffer_load_dwordx4 v[64:67], v11, s[16:19], s43 offen offset:0 sc1
    ds_read2st64_b32 v[214:215], v214 offset0:0 offset1:72
    v_smfmac_f32_16x16x64_bf16 v[168:171], a[152:155], v[228:235], v29
    s_waitcnt vmcnt(30)
    v_smfmac_f32_16x16x64_bf16 v[136:139], a[156:159], v[196:203], v29 abid:1
    buffer_load_dwordx4 v[68:71], v11, s[16:19], s43 offen offset:1024 sc1
    v_smfmac_f32_16x16x64_bf16 v[172:175], a[156:159], v[228:235], v29 abid:1
    s_waitcnt vmcnt(30)
    v_smfmac_f32_16x16x64_bf16 v[140:143], a[160:163], v[196:203], v30
    buffer_load_dwordx4 v[72:75], v11, s[16:19], s43 offen offset:2048 sc1
    s_waitcnt lgkmcnt(5)
    v_smfmac_f32_16x16x64_bf16 v[136:139], v[240:243], v[244:251], v10
    v_smfmac_f32_16x16x64_bf16 v[172:175], v[240:243], v[244:251], v10 abid:1
    s_waitcnt lgkmcnt(4)
    v_xad_u32 v236, v236, v3, v4
    v_smfmac_f32_16x16x64_bf16 v[176:179], a[160:163], v[228:235], v30
    s_waitcnt vmcnt(30)
    v_xad_u32 v237, v237, v3, v4
    v_smfmac_f32_16x16x64_bf16 v[144:147], a[164:167], v[196:203], v30 abid:1
    buffer_load_dwordx4 v[76:79], v11, s[16:19], s43 offen offset:3072 sc1
    ds_read2st64_b32 v[244:245], v236 offset0:0 offset1:72
    ds_read2st64_b32 v[246:247], v237 offset0:0 offset1:72
    v_xad_u32 v238, v238, v3, v4
    v_smfmac_f32_16x16x64_bf16 v[180:183], a[164:167], v[228:235], v30 abid:1
    s_waitcnt vmcnt(30)
    v_xad_u32 v239, v239, v3, v4
    v_smfmac_f32_16x16x64_bf16 v[148:151], a[168:171], v[196:203], v31
    s_add_u32 s43, s43, 4096
    buffer_load_dwordx4 v[80:83], v11, s[16:19], s43 offen offset:0 sc1
    ds_read2st64_b32 v[248:249], v238 offset0:0 offset1:72
    ds_read2st64_b32 v[250:251], v239 offset0:0 offset1:72
    ds_read_b128 v[240:243], v8 offset:1024
    ds_read_b128 v[236:239], v9 offset:9344
    v_smfmac_f32_16x16x64_bf16 v[184:187], a[168:171], v[228:235], v31
    s_waitcnt vmcnt(30)
    v_smfmac_f32_16x16x64_bf16 v[152:155], a[172:175], v[196:203], v31 abid:1
    buffer_load_dwordx4 v[84:87], v11, s[16:19], s43 offen offset:1024 sc1
    s_waitcnt lgkmcnt(6)
    s_cmp_lt_i32 s81, 0
    s_cbranch_scc1 M_ovr0
    s_swappc_b64 s[78:79], s[72:73]
M_ovr0:
    v_smfmac_f32_16x16x64_bf16 v[188:191], a[172:175], v[228:235], v31 abid:1
    s_waitcnt vmcnt(30)
    v_smfmac_f32_16x16x64_bf16 v[156:159], a[176:179], v[196:203], v50
    buffer_load_dwordx4 v[44:47], v11, s[16:19], s43 offen offset:2048 sc1
    buffer_load_dwordx4 v[88:91], v11, s[16:19], s43 offen offset:3072 sc1
    v_smfmac_f32_16x16x64_bf16 v[192:195], a[176:179], v[228:235], v50
    s_waitcnt vmcnt(30)
    v_smfmac_f32_16x16x64_bf16 v[124:127], a[180:183], v[204:211], v32
    s_add_u32 s43, s43, 4096
    buffer_load_dwordx4 v[92:95], v11, s[16:19], s43 offen offset:0 sc1
    s_waitcnt lgkmcnt(1)
    v_smfmac_f32_16x16x64_bf16 v[128:131], v[240:243], v[244:251], v10
    v_smfmac_f32_16x16x64_bf16 v[164:167], v[240:243], v[244:251], v10 abid:1
    s_waitcnt lgkmcnt(0)
    v_xad_u32 v236, v236, v3, v4
    v_smfmac_f32_16x16x64_bf16 v[160:163], a[180:183], v[220:227], v32
    ds_read_b128 v[196:199], v1 offset:6144
    ds_read_b128 v[200:203], v2 offset:6144
    s_waitcnt vmcnt(30)
    v_xad_u32 v237, v237, v3, v4
    v_smfmac_f32_16x16x64_bf16 v[128:131], a[184:187], v[204:211], v32 abid:1
    buffer_load_dwordx4 v[96:99], v11, s[16:19], s43 offen offset:1024 sc1
    ds_read2st64_b32 v[244:245], v236 offset0:0 offset1:72
    ds_read2st64_b32 v[246:247], v237 offset0:0 offset1:72
    v_xad_u32 v238, v238, v3, v4
    v_smfmac_f32_16x16x64_bf16 v[164:167], a[184:187], v[220:227], v32 abid:1
    ds_read_b128 v[228:231], v1 offset:24576
    ds_read_b128 v[232:235], v2 offset:24576
    s_waitcnt vmcnt(30)
    v_xad_u32 v239, v239, v3, v4
    v_smfmac_f32_16x16x64_bf16 v[132:135], a[188:191], v[204:211], v33
    buffer_load_dwordx4 v[100:103], v11, s[16:19], s43 offen offset:2048 sc1
    ds_read2st64_b32 v[248:249], v238 offset0:0 offset1:72
    ds_read2st64_b32 v[250:251], v239 offset0:0 offset1:72
    ds_read_b128 v[240:243], v8 offset:2048
    ds_read_b128 v[236:239], v9 offset:9216
    v_smfmac_f32_16x16x64_bf16 v[168:171], a[188:191], v[220:227], v33
    s_waitcnt vmcnt(30)
    v_smfmac_f32_16x16x64_bf16 v[136:139], a[192:195], v[204:211], v33 abid:1
    buffer_load_dwordx4 v[104:107], v11, s[16:19], s43 offen offset:3072 sc1
    v_smfmac_f32_16x16x64_bf16 v[172:175], a[192:195], v[220:227], v33 abid:1
    s_waitcnt vmcnt(30)
    v_smfmac_f32_16x16x64_bf16 v[140:143], a[196:199], v[204:211], v34
    s_add_u32 s43, s43, 4096
    buffer_load_dwordx4 v[108:111], v11, s[16:19], s43 offen offset:0 sc1
    v_smfmac_f32_16x16x64_bf16 v[176:179], a[196:199], v[220:227], v34
    s_waitcnt vmcnt(30)
    v_smfmac_f32_16x16x64_bf16 v[144:147], a[200:203], v[204:211], v34 abid:1
    buffer_load_dwordx4 v[112:115], v11, s[16:19], s43 offen offset:1024 sc1
    s_waitcnt lgkmcnt(1)
    v_smfmac_f32_16x16x64_bf16 v[132:135], v[240:243], v[244:251], v10
    v_smfmac_f32_16x16x64_bf16 v[168:171], v[240:243], v[244:251], v10 abid:1
    s_waitcnt lgkmcnt(0)
    v_xad_u32 v236, v236, v3, v4
    v_smfmac_f32_16x16x64_bf16 v[180:183], a[200:203], v[220:227], v34 abid:1
    s_waitcnt vmcnt(30)
    v_xad_u32 v237, v237, v3, v4
    v_smfmac_f32_16x16x64_bf16 v[148:151], a[204:207], v[204:211], v35
    buffer_load_dwordx4 v[116:119], v11, s[16:19], s43 offen offset:2048 sc1
    ds_read2st64_b32 v[244:245], v236 offset0:0 offset1:72
    ds_read2st64_b32 v[246:247], v237 offset0:0 offset1:72
    v_xad_u32 v238, v238, v3, v4
    v_smfmac_f32_16x16x64_bf16 v[184:187], a[204:207], v[220:227], v35
    s_waitcnt vmcnt(30)
    v_xad_u32 v239, v239, v3, v4
    v_smfmac_f32_16x16x64_bf16 v[152:155], a[208:211], v[204:211], v35 abid:1
    buffer_load_dwordx4 v[120:123], v11, s[16:19], s43 offen offset:3072 sc1
    ds_read2st64_b32 v[248:249], v238 offset0:0 offset1:72
    ds_read2st64_b32 v[250:251], v239 offset0:0 offset1:72
    ds_read_b128 v[240:243], v8 offset:0
    ds_read_b128 v[236:239], v9 offset:9728
    v_smfmac_f32_16x16x64_bf16 v[188:191], a[208:211], v[220:227], v35 abid:1
    s_waitcnt vmcnt(30)
    v_smfmac_f32_16x16x64_bf16 v[156:159], a[212:215], v[204:211], v50 abid:1
    s_add_u32 m0, s29, 11840
    s_nop 0
    buffer_load_dword v0, s[8:11], 0 offen lds
    v_smfmac_f32_16x16x64_bf16 v[192:195], a[212:215], v[220:227], v50 abid:1
    s_waitcnt vmcnt(29)
    v_smfmac_f32_16x16x64_bf16 v[124:127], a[216:219], v[196:203], v36
    v_smfmac_f32_16x16x64_bf16 v[160:163], a[216:219], v[228:235], v36
    ds_read_b128 v[204:207], v1 offset:7168
    ds_read_b128 v[208:211], v2 offset:7168
    s_waitcnt vmcnt(28)
    v_smfmac_f32_16x16x64_bf16 v[128:131], a[220:223], v[196:203], v36 abid:1
    s_waitcnt lgkmcnt(3)
    v_smfmac_f32_16x16x64_bf16 v[124:127], v[240:243], v[244:251], v10
    v_smfmac_f32_16x16x64_bf16 v[160:163], v[240:243], v[244:251], v10 abid:1
    s_waitcnt lgkmcnt(2)
    v_xad_u32 v236, v236, v3, v4
    v_smfmac_f32_16x16x64_bf16 v[164:167], a[220:223], v[228:235], v36 abid:1
    ds_read_b128 v[220:223], v1 offset:25600
    ds_read_b128 v[224:227], v2 offset:25600
    s_waitcnt vmcnt(27)
    v_xad_u32 v237, v237, v3, v4
    v_smfmac_f32_16x16x64_bf16 v[132:135], a[224:227], v[196:203], v37
    ds_read2st64_b32 v[244:245], v236 offset0:0 offset1:72
    ds_read2st64_b32 v[246:247], v237 offset0:0 offset1:72
    v_xad_u32 v238, v238, v3, v4
    v_smfmac_f32_16x16x64_bf16 v[168:171], a[224:227], v[228:235], v37
    s_waitcnt vmcnt(26)
    v_xad_u32 v239, v239, v3, v4
    v_smfmac_f32_16x16x64_bf16 v[136:139], a[228:231], v[196:203], v37 abid:1
    ds_read2st64_b32 v[248:249], v238 offset0:0 offset1:72
    ds_read2st64_b32 v[250:251], v239 offset0:0 offset1:72
    ds_read_b128 v[240:243], v8 offset:8192
    ds_read_b128 v[236:239], v9 offset:9664
    v_smfmac_f32_16x16x64_bf16 v[172:175], a[228:231], v[228:235], v37 abid:1
    s_waitcnt vmcnt(25)
    v_smfmac_f32_16x16x64_bf16 v[140:143], a[232:235], v[196:203], v38
    v_smfmac_f32_16x16x64_bf16 v[176:179], a[232:235], v[228:235], v38
    s_waitcnt vmcnt(24)
    v_smfmac_f32_16x16x64_bf16 v[144:147], a[236:239], v[196:203], v38 abid:1
    v_smfmac_f32_16x16x64_bf16 v[180:183], a[236:239], v[228:235], v38 abid:1
    s_waitcnt vmcnt(23)
    v_smfmac_f32_16x16x64_bf16 v[148:151], a[240:243], v[196:203], v39
    s_mov_b32 m0, s42
    s_nop 0
    buffer_load_dwordx4 v5, s[8:11], s22 offen offset:0 nt lds
    s_waitcnt lgkmcnt(1)
    v_smfmac_f32_16x16x64_bf16 v[156:159], v[240:243], v[244:251], v10
    v_smfmac_f32_16x16x64_bf16 v[192:195], v[240:243], v[244:251], v10 abid:1
    s_waitcnt lgkmcnt(0)
    v_xad_u32 v236, v236, v3, v4
    v_smfmac_f32_16x16x64_bf16 v[184:187], a[240:243], v[228:235], v39
    s_waitcnt vmcnt(23)
    v_xad_u32 v237, v237, v3, v4
    v_smfmac_f32_16x16x64_bf16 v[152:155], a[244:247], v[196:203], v39 abid:1
    ds_read2st64_b32 v[244:245], v236 offset0:0 offset1:72
    ds_read2st64_b32 v[246:247], v237 offset0:0 offset1:72
    v_xad_u32 v238, v238, v3, v4
    v_smfmac_f32_16x16x64_bf16 v[188:191], a[244:247], v[228:235], v39 abid:1
    s_waitcnt vmcnt(22)
    v_xad_u32 v239, v239, v3, v4
    v_smfmac_f32_16x16x64_bf16 v[156:159], a[248:251], v[196:203], v51
    s_add_u32 m0, m0, 896
    s_nop 0
    buffer_load_dwordx4 v5, s[8:11], s22 offen offset:128 nt lds
    ds_read2st64_b32 v[248:249], v238 offset0:0 offset1:72
    ds_read2st64_b32 v[250:251], v239 offset0:0 offset1:72
    ds_read_b128 v[240:243], v8 offset:7168
    ds_read_b128 v[236:239], v9 offset:9536
    v_smfmac_f32_16x16x64_bf16 v[192:195], a[248:251], v[228:235], v51
    s_waitcnt vmcnt(21)
    v_smfmac_f32_16x16x64_bf16 v[124:127], a[252:255], v[204:211], v40
    ds_read_b128 v[196:199], v1 offset:8192
    ds_read_b128 v[200:203], v2 offset:8192
    s_waitcnt vmcnt(20)
    v_smfmac_f32_16x16x64_bf16 v[128:131], v[56:59], v[204:211], v40 abid:1
    s_add_u32 m0, m0, 896
    s_nop 0
    buffer_load_dwordx4 v5, s[8:11], s22 offen offset:256 nt lds
    ds_read_b128 v[228:231], v1 offset:26624
    ds_read_b128 v[232:235], v2 offset:26624
    s_waitcnt vmcnt(20)
    v_smfmac_f32_16x16x64_bf16 v[132:135], v[60:63], v[204:211], v41
    s_waitcnt lgkmcnt(5)
    v_smfmac_f32_16x16x64_bf16 v[152:155], v[240:243], v[244:251], v10
    v_smfmac_f32_16x16x64_bf16 v[188:191], v[240:243], v[244:251], v10 abid:1
    s_waitcnt lgkmcnt(4)
    v_xad_u32 v236, v236, v3, v4
    s_waitcnt vmcnt(19)
    v_xad_u32 v237, v237, v3, v4
    v_smfmac_f32_16x16x64_bf16 v[136:139], v[64:67], v[204:211], v41 abid:1
    s_add_u32 m0, m0, 896
    s_nop 0
    buffer_load_dwordx4 v5, s[8:11], s22 offen offset:384 nt lds
    ds_read2st64_b32 v[244:245], v236 offset0:0 offset1:72
    ds_read2st64_b32 v[246:247], v237 offset0:0 offset1:72
    v_xad_u32 v238, v238, v3, v4
    s_waitcnt vmcnt(19)
    v_xad_u32 v239, v239, v3, v4
    v_smfmac_f32_16x16x64_bf16 v[140:143], v[68:71], v[204:211], v42
    ds_read2st64_b32 v[248:249], v238 offset0:0 offset1:72
    ds_read2st64_b32 v[250:251], v239 offset0:0 offset1:72
    ds_read_b128 v[240:243], v8 offset:5120
    ds_read_b128 v[236:239], v9 offset:9600
    s_waitcnt vmcnt(18)
    v_smfmac_f32_16x16x64_bf16 v[144:147], v[72:75], v[204:211], v42 abid:1
    s_waitcnt vmcnt(17)
    v_smfmac_f32_16x16x64_bf16 v[148:151], v[76:79], v[204:211], v43
    s_waitcnt vmcnt(16)
    v_smfmac_f32_16x16x64_bf16 v[152:155], v[80:83], v[204:211], v43 abid:1
    s_waitcnt lgkmcnt(1)
    v_smfmac_f32_16x16x64_bf16 v[144:147], v[240:243], v[244:251], v10
    v_smfmac_f32_16x16x64_bf16 v[180:183], v[240:243], v[244:251], v10 abid:1
    s_waitcnt lgkmcnt(0)
    v_xad_u32 v236, v236, v3, v4
    s_waitcnt vmcnt(15)
    v_xad_u32 v237, v237, v3, v4
    v_smfmac_f32_16x16x64_bf16 v[156:159], v[84:87], v[204:211], v51 abid:1
    ds_read2st64_b32 v[244:245], v236 offset0:0 offset1:72
    ds_read2st64_b32 v[246:247], v237 offset0:0 offset1:72
    v_xad_u32 v238, v238, v3, v4
    s_waitcnt vmcnt(13)
    v_xad_u32 v239, v239, v3, v4
    v_smfmac_f32_16x16x64_bf16 v[124:127], v[88:91], v[196:203], v44
    ds_read2st64_b32 v[248:249], v238 offset0:0 offset1:72
    ds_read2st64_b32 v[250:251], v239 offset0:0 offset1:72
    ds_read_b128 v[240:243], v8 offset:6144
    ds_read_b128 v[236:239], v9 offset:9472
    s_waitcnt vmcnt(12)
    v_smfmac_f32_16x16x64_bf16 v[128:131], v[92:95], v[196:203], v44 abid:1
    s_waitcnt vmcnt(11)
    v_smfmac_f32_16x16x64_bf16 v[132:135], v[96:99], v[196:203], v45
    s_waitcnt vmcnt(10)
    v_smfmac_f32_16x16x64_bf16 v[136:139], v[100:103], v[196:203], v45 abid:1
    s_waitcnt lgkmcnt(1)
    v_smfmac_f32_16x16x64_bf16 v[148:151], v[240:243], v[244:251], v10
    v_smfmac_f32_16x16x64_bf16 v[184:187], v[240:243], v[244:251], v10 abid:1
    s_waitcnt lgkmcnt(0)
    v_xad_u32 v236, v236, v3, v4
    s_waitcnt vmcnt(9)
    v_xad_u32 v237, v237, v3, v4
    v_smfmac_f32_16x16x64_bf16 v[140:143], v[104:107], v[196:203], v46
    ds_read2st64_b32 v[244:245], v236 offset0:0 offset1:72
    ds_read2st64_b32 v[246:247], v237 offset0:0 offset1:72
    v_xad_u32 v238, v238, v3, v4
    s_waitcnt vmcnt(8)
    v_xad_u32 v239, v239, v3, v4
    v_smfmac_f32_16x16x64_bf16 v[144:147], v[108:111], v[196:203], v46 abid:1
    ds_read2st64_b32 v[248:249], v238 offset0:0 offset1:72
    ds_read2st64_b32 v[250:251], v239 offset0:0 offset1:72
    ds_read_b128 v[240:243], v8 offset:4096
    s_waitcnt vmcnt(7)
    v_smfmac_f32_16x16x64_bf16 v[148:151], v[112:115], v[196:203], v47
    s_waitcnt vmcnt(6)
    v_smfmac_f32_16x16x64_bf16 v[152:155], v[116:119], v[196:203], v47 abid:1
    s_waitcnt vmcnt(5)
    v_smfmac_f32_16x16x64_bf16 v[156:159], v[120:123], v[196:203], v52
    s_waitcnt lgkmcnt(0)
    v_smfmac_f32_16x16x64_bf16 v[140:143], v[240:243], v[244:251], v10
    v_smfmac_f32_16x16x64_bf16 v[176:179], v[240:243], v[244:251], v10 abid:1
    s_cmp_gt_u32 s46, s80
    s_cbranch_scc1 M_slow
M_slowr0:
    s_cmp_eq_u32 s20, 0
    s_mov_b32 s31, 1073903880
    s_cselect_b32 s30, 162048, s31
    v_mov_b32 v11, s31
    v_writelane_b32 v11, s30, 0
    v_cvt_pk_bf16_f32 v124, v124, v125
    v_cvt_pk_bf16_f32 v125, v126, v127
    v_cvt_pk_bf16_f32 v126, v128, v129
    v_cvt_pk_bf16_f32 v127, v130, v131
    v_cvt_pk_bf16_f32 v132, v132, v133
    v_cvt_pk_bf16_f32 v133, v134, v135
    v_cvt_pk_bf16_f32 v134, v136, v137
    v_cvt_pk_bf16_f32 v135, v138, v139
    ds_read_b128 v[136:139], v9 offset:10432
    v_cndmask_b32_dpp v128, v124, v132, vcc row_ror:8 row_mask:0xf bank_mask:0xf
    v_cndmask_b32_dpp v129, v125, v133, vcc row_ror:8 row_mask:0xf bank_mask:0xf
    v_cndmask_b32_dpp v130, v126, v134, vcc row_ror:8 row_mask:0xf bank_mask:0xf
    v_cndmask_b32_dpp v131, v127, v135, vcc row_ror:8 row_mask:0xf bank_mask:0xf
    buffer_store_dwordx4 v[128:131], v6, s[12:15], s59 offen offset:0 sc1
    v_mov_b32_dpp v124, v132 row_ror:8 row_mask:0xf bank_mask:0xc
    v_mov_b32_dpp v125, v133 row_ror:8 row_mask:0xf bank_mask:0xc
    v_mov_b32_dpp v126, v134 row_ror:8 row_mask:0xf bank_mask:0xc
    v_mov_b32_dpp v127, v135 row_ror:8 row_mask:0xf bank_mask:0xc
    buffer_store_dwordx4 v[124:127], v6, s[12:15], s24 offen offset:0 sc1
    ds_read_b128 v[128:131], v9 offset:10304
    ds_read_b128 v[132:135], v9 offset:10368
    ds_read_b128 v[124:127], v9 offset:10240
    v_cvt_pk_bf16_f32 v140, v140, v141
    v_cvt_pk_bf16_f32 v141, v142, v143
    v_cvt_pk_bf16_f32 v142, v144, v145
    v_cvt_pk_bf16_f32 v143, v146, v147
    v_cvt_pk_bf16_f32 v148, v148, v149
    v_cvt_pk_bf16_f32 v149, v150, v151
    v_cvt_pk_bf16_f32 v150, v152, v153
    v_cvt_pk_bf16_f32 v151, v154, v155
    ds_read_b128 v[152:155], v9 offset:10688
    v_cndmask_b32_dpp v144, v140, v148, vcc row_ror:8 row_mask:0xf bank_mask:0xf
    v_cndmask_b32_dpp v145, v141, v149, vcc row_ror:8 row_mask:0xf bank_mask:0xf
    v_cndmask_b32_dpp v146, v142, v150, vcc row_ror:8 row_mask:0xf bank_mask:0xf
    v_cndmask_b32_dpp v147, v143, v151, vcc row_ror:8 row_mask:0xf bank_mask:0xf
    buffer_store_dwordx4 v[144:147], v6, s[12:15], s59 offen offset:128 sc1
    v_mov_b32_dpp v140, v148 row_ror:8 row_mask:0xf bank_mask:0xc
    v_mov_b32_dpp v141, v149 row_ror:8 row_mask:0xf bank_mask:0xc
    v_mov_b32_dpp v142, v150 row_ror:8 row_mask:0xf bank_mask:0xc
    v_mov_b32_dpp v143, v151 row_ror:8 row_mask:0xf bank_mask:0xc
    buffer_store_dwordx4 v[140:143], v6, s[12:15], s24 offen offset:128 sc1
    ds_read_b128 v[144:147], v9 offset:10560
    ds_read_b128 v[148:151], v9 offset:10624
    ds_read_b128 v[140:143], v9 offset:10496
    v_cvt_pk_bf16_f32 v156, v156, v157
    v_cvt_pk_bf16_f32 v157, v158, v159
    ds_write_b64 v53, v[156:157] offset:25728
    ds_read_b128 v[156:159], v9 offset:10752
    s_mov_b32 s89, 0
    s_mov_b32 s101, 34209792
    s_mov_b32 s91, 0
    s_mov_b32 s25, 36864
    s_add_u32 s90, s24, 9437184
    s_mov_b32 s28, s26
    s_add_u32 s23, s24, 18432
    s_cmp_lt_u32 s20, 2
    s_cselect_b32 s66, s23, s24
    s_cselect_b32 s99, s14, 74612736
    s_add_u32 s66, s66, s95
    v_add_u32 v4, 36864, v4
    v_add_u32 v1, 36864, v1
    v_add_u32 v2, 36864, v2
M_top:
M_top1:
    s_add_u32 s23, s24, 18432
    s_add_u32 s58, s24, 27648
    s_mov_b32 s24, s90
    s_add_u32 s59, s90, 9216
    s_waitcnt lgkmcnt(0)
    s_barrier
    ds_read_b128 v[244:247], v8 offset:10816
    v_smfmac_f32_16x16x64_bf16 v[160:163], a[252:255], v[220:227], v40
    ds_read_b128 v[196:199], v1 offset:0
    v_smfmac_f32_16x16x64_bf16 v[160:163], v[88:91], v[228:235], v44
    ds_read_b128 v[200:203], v2 offset:0
    s_cmp_lt_u32 s22, 75497472
    s_cbranch_scc0 M_bF
    s_cmp_eq_u32 s91, 1
    s_cbranch_scc1 M_bE0
M_bL:
    v_smfmac_f32_16x16x64_bf16 v[164:167], v[56:59], v[220:227], v40 abid:1
    ds_read_b128 v[204:207], v1 offset:1024
    s_cmp_lt_u32 s22, 74612736
    s_cselect_b32 s30, 1, 0
    v_smfmac_f32_16x16x64_bf16 v[164:167], v[92:95], v[228:235], v44 abid:1
    ds_read_b128 v[208:211], v2 offset:1024
    v_mov_b32 v0, s30
    v_smfmac_f32_16x16x64_bf16 v[168:171], v[60:63], v[220:227], v41
    ds_read_b128 v[212:215], v1 offset:2048
    v_smfmac_f32_16x16x64_bf16 v[168:171], v[96:99], v[228:235], v45
    ds_read_b128 v[216:219], v2 offset:2048
    v_smfmac_f32_16x16x64_bf16 v[172:175], v[64:67], v[220:227], v41 abid:1
    s_waitcnt vmcnt(6)
    s_waitcnt lgkmcnt(6)
    buffer_store_dwordx4 v[244:247], v7, s[12:15], s66 offen sc1
    v_smfmac_f32_16x16x64_bf16 v[172:175], v[100:103], v[228:235], v45 abid:1
    ds_read_b128 v[236:239], v9 offset:9408
    v_smfmac_f32_16x16x64_bf16 v[176:179], v[68:71], v[220:227], v42
    s_waitcnt vmcnt(6)
    buffer_atomic_add v0, v11, s[16:19], s92 offen sc0 sc1
    s_mov_b32 s21, 1
    v_smfmac_f32_16x16x64_bf16 v[176:179], v[104:107], v[228:235], v46
    v_smfmac_f32_16x16x64_bf16 v[180:183], v[72:75], v[220:227], v42 abid:1
    v_cvt_pk_bf16_f32 v160, v160, v161
    v_smfmac_f32_16x16x64_bf16 v[180:183], v[108:111], v[228:235], v46 abid:1
    v_cvt_pk_bf16_f32 v161, v162, v163
    v_smfmac_f32_16x16x64_bf16 v[184:187], v[76:79], v[220:227], v43
    v_cvt_pk_bf16_f32 v162, v164, v165
    v_smfmac_f32_16x16x64_bf16 v[184:187], v[112:115], v[228:235], v47
    v_cvt_pk_bf16_f32 v163, v166, v167
    v_smfmac_f32_16x16x64_bf16 v[188:191], v[80:83], v[220:227], v43 abid:1
    s_add_u32 m0, m0, 896
    v_cvt_pk_bf16_f32 v168, v168, v169
    v_smfmac_f32_16x16x64_bf16 v[188:191], v[116:119], v[228:235], v47 abid:1
    s_waitcnt vmcnt(6)
    buffer_load_dwordx4 v5, s[8:11], s22 offen offset:512 nt lds
    v_cvt_pk_bf16_f32 v169, v170, v171
    v_smfmac_f32_16x16x64_bf16 v[192:195], v[84:87], v[220:227], v51 abid:1
    v_cvt_pk_bf16_f32 v170, v172, v173
    v_smfmac_f32_16x16x64_bf16 v[192:195], v[120:123], v[228:235], v52
    ds_read_b128 v[220:223], v1 offset:3072
    s_waitcnt lgkmcnt(6)
    v_cvt_pk_bf16_f32 v171, v174, v175
    v_smfmac_f32_16x16x64_bf16 v[124:127], a[0:3], v[196:203], v12
    ds_read_b128 v[224:227], v2 offset:3072
    ds_read_b128 v[172:175], v9 offset:10432
    s_waitcnt lgkmcnt(6)
    v_cndmask_b32_dpp v164, v160, v168, vcc row_ror:8 row_mask:0xf bank_mask:0xf
    v_smfmac_f32_16x16x64_bf16 v[124:127], a[36:39], v[204:211], v16
    ds_read_b128 v[228:231], v1 offset:4096
    s_waitcnt lgkmcnt(5)
    v_cndmask_b32_dpp v165, v161, v169, vcc row_ror:8 row_mask:0xf bank_mask:0xf
    v_smfmac_f32_16x16x64_bf16 v[124:127], a[72:75], v[212:219], v20
    ds_read_b128 v[232:235], v2 offset:4096
    v_cndmask_b32_dpp v166, v162, v170, vcc row_ror:8 row_mask:0xf bank_mask:0xf
    v_smfmac_f32_16x16x64_bf16 v[128:131], a[4:7], v[196:203], v12 abid:1
    s_barrier
    v_cndmask_b32_dpp v167, v163, v171, vcc row_ror:8 row_mask:0xf bank_mask:0xf
    v_smfmac_f32_16x16x64_bf16 v[128:131], a[40:43], v[204:211], v16 abid:1
    s_waitcnt vmcnt(6)
    buffer_store_dwordx4 v[164:167], v6, s[12:15], s58 offen offset:0 sc1
    s_waitcnt lgkmcnt(5)
    v_xad_u32 v236, v236, v3, v4
    v_smfmac_f32_16x16x64_bf16 v[128:131], a[76:79], v[212:219], v20 abid:1
    v_xad_u32 v237, v237, v3, v4
    v_smfmac_f32_16x16x64_bf16 v[132:135], a[8:11], v[196:203], v13
    ds_read2st64_b32 v[244:245], v236 offset0:0 offset1:72
    ds_read_b128 v[240:243], v8 offset:3072
    v_xad_u32 v238, v238, v3, v4
    v_smfmac_f32_16x16x64_bf16 v[132:135], a[44:47], v[204:211], v17
    ds_read2st64_b32 v[246:247], v237 offset0:0 offset1:72
    v_xad_u32 v239, v239, v3, v4
    v_smfmac_f32_16x16x64_bf16 v[132:135], a[80:83], v[212:219], v21
    ds_read2st64_b32 v[248:249], v238 offset0:0 offset1:72
    v_mov_b32_dpp v160, v168 row_ror:8 row_mask:0xf bank_mask:0xc
    v_smfmac_f32_16x16x64_bf16 v[144:147], a[20:23], v[196:203], v14 abid:1
    ds_read2st64_b32 v[250:251], v239 offset0:0 offset1:72
    ds_read_b128 v[236:239], v9 offset:9280
    v_mov_b32_dpp v161, v169 row_ror:8 row_mask:0xf bank_mask:0xc
    v_smfmac_f32_16x16x64_bf16 v[144:147], a[56:59], v[204:211], v18 abid:1
    v_mov_b32_dpp v162, v170 row_ror:8 row_mask:0xf bank_mask:0xc
    v_smfmac_f32_16x16x64_bf16 v[144:147], a[92:95], v[212:219], v22 abid:1
    v_mov_b32_dpp v163, v171 row_ror:8 row_mask:0xf bank_mask:0xc
    v_smfmac_f32_16x16x64_bf16 v[140:143], a[16:19], v[196:203], v14
    s_waitcnt vmcnt(6)
    buffer_store_dwordx4 v[160:163], v6, s[12:15], s23 offen offset:0 sc1
    ds_read_b128 v[164:167], v9 offset:10304
    v_smfmac_f32_16x16x64_bf16 v[140:143], a[52:55], v[204:211], v18
    ds_read_b128 v[168:171], v9 offset:10368
    ds_read_b128 v[160:163], v9 offset:10240
    v_smfmac_f32_16x16x64_bf16 v[140:143], a[88:91], v[212:219], v22
    v_smfmac_f32_16x16x64_bf16 v[136:139], a[12:15], v[196:203], v13 abid:1
    v_smfmac_f32_16x16x64_bf16 v[136:139], a[48:51], v[204:211], v17 abid:1
    v_smfmac_f32_16x16x64_bf16 v[136:139], a[84:87], v[212:219], v21 abid:1
    s_waitcnt lgkmcnt(3)
    v_xad_u32 v236, v236, v3, v4
    v_smfmac_f32_16x16x64_bf16 v[136:139], v[240:243], v[244:251], v10
    v_xad_u32 v237, v237, v3, v4
    v_smfmac_f32_16x16x64_bf16 v[172:175], v[240:243], v[244:251], v10 abid:1
    ds_read2st64_b32 v[244:245], v236 offset0:0 offset1:72
    ds_read_b128 v[240:243], v8 offset:1024
    v_xad_u32 v238, v238, v3, v4
    v_smfmac_f32_16x16x64_bf16 v[148:151], a[24:27], v[196:203], v15
    ds_read2st64_b32 v[246:247], v237 offset0:0 offset1:72
    v_xad_u32 v239, v239, v3, v4
    v_smfmac_f32_16x16x64_bf16 v[148:151], a[60:63], v[204:211], v19
    ds_read2st64_b32 v[248:249], v238 offset0:0 offset1:72
    v_cvt_pk_bf16_f32 v192, v192, v193
    v_smfmac_f32_16x16x64_bf16 v[148:151], a[96:99], v[212:219], v23
    ds_read2st64_b32 v[250:251], v239 offset0:0 offset1:72
    ds_read_b128 v[236:239], v9 offset:9344
    v_cvt_pk_bf16_f32 v193, v194, v195
    v_smfmac_f32_16x16x64_bf16 v[152:155], a[28:31], v[196:203], v15 abid:1
    ds_write_b64 v53, v[192:193] offset:0
    ds_read_b128 v[192:195], v9 offset:10752
    v_smfmac_f32_16x16x64_bf16 v[152:155], a[64:67], v[204:211], v19 abid:1
    s_add_u32 m0, m0, 896
    v_smfmac_f32_16x16x64_bf16 v[152:155], a[100:103], v[212:219], v23 abid:1
    s_waitcnt vmcnt(6)
    buffer_load_dwordx4 v5, s[8:11], s22 offen offset:640 nt lds
    v_smfmac_f32_16x16x64_bf16 v[156:159], a[32:35], v[196:203], v48
    v_smfmac_f32_16x16x64_bf16 v[156:159], a[68:71], v[204:211], v48 abid:1
    v_smfmac_f32_16x16x64_bf16 v[156:159], a[104:107], v[212:219], v49
    ds_read_b128 v[196:199], v1 offset:5120
    v_cvt_pk_bf16_f32 v176, v176, v177
    v_smfmac_f32_16x16x64_bf16 v[124:127], a[108:111], v[220:227], v24
    ds_read_b128 v[200:203], v2 offset:5120
    v_cvt_pk_bf16_f32 v177, v178, v179
    v_smfmac_f32_16x16x64_bf16 v[124:127], a[144:147], v[228:235], v28
    ds_read_b128 v[204:207], v1 offset:6144
    ds_read_b64 v[216:217], v9 offset:10056
    v_cvt_pk_bf16_f32 v178, v180, v181
    v_smfmac_f32_16x16x64_bf16 v[128:131], a[112:115], v[220:227], v24 abid:1
    ds_read_b128 v[208:211], v2 offset:6144
    v_cvt_pk_bf16_f32 v179, v182, v183
    v_smfmac_f32_16x16x64_bf16 v[128:131], a[148:151], v[228:235], v28 abid:1
    s_waitcnt lgkmcnt(7)
    v_xad_u32 v236, v236, v3, v4
    v_smfmac_f32_16x16x64_bf16 v[128:131], v[240:243], v[244:251], v10
    s_add_u32 m0, m0, 896
    v_xad_u32 v237, v237, v3, v4
    v_smfmac_f32_16x16x64_bf16 v[164:167], v[240:243], v[244:251], v10 abid:1
    ds_read2st64_b32 v[244:245], v236 offset0:0 offset1:72
    ds_read_b128 v[240:243], v8 offset:2048
    v_xad_u32 v238, v238, v3, v4
    v_smfmac_f32_16x16x64_bf16 v[152:155], a[136:139], v[220:227], v27 abid:1
    ds_read2st64_b32 v[246:247], v237 offset0:0 offset1:72
    s_waitcnt vmcnt(6)
    v_xad_u32 v239, v239, v3, v4
    v_smfmac_f32_16x16x64_bf16 v[152:155], a[172:175], v[228:235], v31 abid:1
    ds_read2st64_b32 v[248:249], v238 offset0:0 offset1:72
    buffer_load_dwordx4 v5, s[8:11], s22 offen offset:768 nt lds
    v_cvt_pk_bf16_f32 v184, v184, v185
    v_smfmac_f32_16x16x64_bf16 v[136:139], a[120:123], v[220:227], v25 abid:1
    ds_read2st64_b32 v[250:251], v239 offset0:0 offset1:72
    ds_read_b128 v[236:239], v9 offset:9216
    v_cvt_pk_bf16_f32 v185, v186, v187
    v_smfmac_f32_16x16x64_bf16 v[136:139], a[156:159], v[228:235], v29 abid:1
    v_cvt_pk_bf16_f32 v186, v188, v189
    v_smfmac_f32_16x16x64_bf16 v[140:143], a[124:127], v[220:227], v26
    v_cvt_pk_bf16_f32 v187, v190, v191
    v_smfmac_f32_16x16x64_bf16 v[140:143], a[160:163], v[228:235], v30
    ds_read_b128 v[188:191], v9 offset:10688
    v_cndmask_b32_dpp v180, v176, v184, vcc row_ror:8 row_mask:0xf bank_mask:0xf
    v_smfmac_f32_16x16x64_bf16 v[144:147], a[128:131], v[220:227], v26 abid:1
    v_cndmask_b32_dpp v181, v177, v185, vcc row_ror:8 row_mask:0xf bank_mask:0xf
    v_smfmac_f32_16x16x64_bf16 v[144:147], a[164:167], v[228:235], v30 abid:1
    v_cndmask_b32_dpp v182, v178, v186, vcc row_ror:8 row_mask:0xf bank_mask:0xf
    v_smfmac_f32_16x16x64_bf16 v[148:151], a[132:135], v[220:227], v27
    v_cndmask_b32_dpp v183, v179, v187, vcc row_ror:8 row_mask:0xf bank_mask:0xf
    v_smfmac_f32_16x16x64_bf16 v[148:151], a[168:171], v[228:235], v31
    s_waitcnt vmcnt(6)
    buffer_store_dwordx4 v[180:183], v6, s[12:15], s58 offen offset:128 sc1
    s_waitcnt lgkmcnt(8)
    v_xad_u32 v212, v216, v3, v4
    v_smfmac_f32_16x16x64_bf16 v[132:135], a[116:119], v[220:227], v25
    ds_read2st64_b32 v[212:213], v212 offset0:0 offset1:72
    v_xad_u32 v214, v217, v3, v4
    v_smfmac_f32_16x16x64_bf16 v[132:135], a[152:155], v[228:235], v29
    ds_read2st64_b32 v[214:215], v214 offset0:0 offset1:72
    s_waitcnt lgkmcnt(3)
    v_xad_u32 v236, v236, v3, v4
    v_smfmac_f32_16x16x64_bf16 v[132:135], v[240:243], v[244:251], v10
    v_xad_u32 v237, v237, v3, v4
    v_smfmac_f32_16x16x64_bf16 v[168:171], v[240:243], v[244:251], v10 abid:1
    ds_read2st64_b32 v[244:245], v236 offset0:0 offset1:72
    ds_read_b128 v[240:243], v8 offset:0
    v_xad_u32 v238, v238, v3, v4
    v_smfmac_f32_16x16x64_bf16 v[156:159], a[140:143], v[220:227], v49 abid:1
    ds_read2st64_b32 v[246:247], v237 offset0:0 offset1:72
    v_xad_u32 v239, v239, v3, v4
    v_smfmac_f32_16x16x64_bf16 v[156:159], a[176:179], v[228:235], v50
    ds_read2st64_b32 v[248:249], v238 offset0:0 offset1:72
    v_mov_b32_dpp v176, v184 row_ror:8 row_mask:0xf bank_mask:0xc
    v_smfmac_f32_16x16x64_bf16 v[140:143], a[196:199], v[196:203], v34
    ds_read2st64_b32 v[250:251], v239 offset0:0 offset1:72
    ds_read_b128 v[236:239], v9 offset:9728
    v_mov_b32_dpp v177, v185 row_ror:8 row_mask:0xf bank_mask:0xc
    v_smfmac_f32_16x16x64_bf16 v[140:143], a[232:235], v[204:211], v38
    v_mov_b32_dpp v178, v186 row_ror:8 row_mask:0xf bank_mask:0xc
    v_smfmac_f32_16x16x64_bf16 v[128:131], a[184:187], v[196:203], v32 abid:1
    v_mov_b32_dpp v179, v187 row_ror:8 row_mask:0xf bank_mask:0xc
    v_smfmac_f32_16x16x64_bf16 v[128:131], a[220:223], v[204:211], v36 abid:1
    s_waitcnt vmcnt(6)
    buffer_store_dwordx4 v[176:179], v6, s[12:15], s23 offen offset:128 sc1
    ds_read_b128 v[180:183], v9 offset:10560
    v_smfmac_f32_16x16x64_bf16 v[132:135], a[188:191], v[196:203], v33
    ds_read_b128 v[184:187], v9 offset:10624
    ds_read_b128 v[176:179], v9 offset:10496
    v_smfmac_f32_16x16x64_bf16 v[132:135], a[224:227], v[204:211], v37
    v_smfmac_f32_16x16x64_bf16 v[136:139], a[192:195], v[196:203], v33 abid:1
    ds_read_b128 v[220:223], v1 offset:7168
    v_smfmac_f32_16x16x64_bf16 v[136:139], a[228:231], v[204:211], v37 abid:1
    ds_read_b128 v[224:227], v2 offset:7168
    v_smfmac_f32_16x16x64_bf16 v[124:127], a[180:183], v[196:203], v32
    ds_read_b128 v[228:231], v1 offset:8192
    v_smfmac_f32_16x16x64_bf16 v[124:127], a[216:219], v[204:211], v36
    s_waitcnt vmcnt(7)
    s_waitcnt lgkmcnt(6)
    v_xad_u32 v236, v236, v3, v4
    v_smfmac_f32_16x16x64_bf16 v[124:127], v[240:243], v[244:251], v10
    ds_read_b128 v[232:235], v2 offset:8192
    v_xad_u32 v237, v237, v3, v4
    v_smfmac_f32_16x16x64_bf16 v[160:163], v[240:243], v[244:251], v10 abid:1
    ds_read2st64_b32 v[244:245], v236 offset0:0 offset1:72
    ds_read_b128 v[240:243], v8 offset:8192
    v_xad_u32 v238, v238, v3, v4
    v_smfmac_f32_16x16x64_bf16 v[144:147], a[200:203], v[196:203], v34 abid:1
    ds_read2st64_b32 v[246:247], v237 offset0:0 offset1:72
    v_xad_u32 v239, v239, v3, v4
    v_smfmac_f32_16x16x64_bf16 v[144:147], a[236:239], v[204:211], v38 abid:1
    ds_read2st64_b32 v[248:249], v238 offset0:0 offset1:72
    v_mul_u32_u24 v0, s94, v0
    v_smfmac_f32_16x16x64_bf16 v[148:151], a[204:207], v[196:203], v35
    ds_read2st64_b32 v[250:251], v239 offset0:0 offset1:72
    ds_read_b128 v[236:239], v9 offset:9664
    v_add_u32 v0, s93, v0
    v_smfmac_f32_16x16x64_bf16 v[148:151], a[240:243], v[204:211], v39
    s_waitcnt lgkmcnt(10)
    s_cmp_lt_i32 s81, 0
    s_cbranch_scc1 M_ovrL
    s_swappc_b64 s[78:79], s[72:73]
M_ovrL:
    v_smfmac_f32_16x16x64_bf16 v[152:155], a[208:211], v[196:203], v35 abid:1
    ds_write_b32 v11, v0
    v_mov_b32 v0, 162048
    v_smfmac_f32_16x16x64_bf16 v[152:155], a[244:247], v[204:211], v39 abid:1
    s_add_u32 m0, m0, 896
    v_smfmac_f32_16x16x64_bf16 v[156:159], a[212:215], v[196:203], v50 abid:1
    s_waitcnt vmcnt(6)
    buffer_load_dwordx4 v5, s[8:11], s22 offen offset:896 nt lds
    v_smfmac_f32_16x16x64_bf16 v[156:159], a[248:251], v[204:211], v51
    s_waitcnt lgkmcnt(9)
    v_smfmac_f32_16x16x64_bf16 v[124:127], a[252:255], v[220:227], v40
    ds_read_b128 v[196:199], v1 offset:18432
    s_waitcnt lgkmcnt(8)
    v_smfmac_f32_16x16x64_bf16 v[124:127], v[88:91], v[228:235], v44
    ds_read_b128 v[200:203], v2 offset:18432
    v_smfmac_f32_16x16x64_bf16 v[156:159], v[84:87], v[220:227], v51 abid:1
    ds_read_b128 v[204:207], v1 offset:19456
    v_smfmac_f32_16x16x64_bf16 v[156:159], v[120:123], v[228:235], v52
    s_waitcnt lgkmcnt(3)
    s_barrier
    v_xad_u32 v236, v236, v3, v4
    v_smfmac_f32_16x16x64_bf16 v[156:159], v[240:243], v[244:251], v10
    ds_read_b128 v[208:211], v2 offset:19456
    ds_read_b32 v0, v0
    v_xad_u32 v237, v237, v3, v4
    v_smfmac_f32_16x16x64_bf16 v[192:195], v[240:243], v[244:251], v10 abid:1
    ds_read2st64_b32 v[244:245], v236 offset0:0 offset1:72
    ds_read_b128 v[240:243], v8 offset:7168
    v_xad_u32 v238, v238, v3, v4
    v_smfmac_f32_16x16x64_bf16 v[132:135], v[60:63], v[220:227], v41
    ds_read2st64_b32 v[246:247], v237 offset0:0 offset1:72
    v_xad_u32 v239, v239, v3, v4
    v_smfmac_f32_16x16x64_bf16 v[132:135], v[96:99], v[228:235], v45
    ds_read2st64_b32 v[248:249], v238 offset0:0 offset1:72
    s_add_u32 m0, m0, 896
    v_smfmac_f32_16x16x64_bf16 v[136:139], v[64:67], v[220:227], v41 abid:1
    ds_read2st64_b32 v[250:251], v239 offset0:0 offset1:72
    ds_read_b128 v[236:239], v9 offset:9536
    s_waitcnt vmcnt(6)
    v_smfmac_f32_16x16x64_bf16 v[136:139], v[100:103], v[228:235], v45 abid:1
    buffer_load_dwordx4 v5, s[8:11], s22 offen offset:1024 nt lds
    s_waitcnt lgkmcnt(6)
    v_readfirstlane_b32 s88, v0
    v_smfmac_f32_16x16x64_bf16 v[140:143], v[68:71], v[220:227], v42
    s_add_u32 s30, s88, 74612736
    s_lshr_b32 s30, s30, 1
    s_min_u32 s88, s88, s30
    v_smfmac_f32_16x16x64_bf16 v[140:143], v[104:107], v[228:235], v46
    s_min_u32 s88, s88, s14
    v_smfmac_f32_16x16x64_bf16 v[144:147], v[72:75], v[220:227], v42 abid:1
    ds_read_b128 v[212:215], v1 offset:20480
    s_cmp_lt_u32 s22, 74612736
    s_cselect_b32 s88, s88, s14
    v_smfmac_f32_16x16x64_bf16 v[144:147], v[108:111], v[228:235], v46 abid:1
    ds_read_b128 v[216:219], v2 offset:20480
    s_cmp_lt_u32 s88, s99
    s_cselect_b32 s10, 75497472, 0
    v_smfmac_f32_16x16x64_bf16 v[148:151], v[76:79], v[220:227], v43
    s_cmp_lt_u32 s88, s14
    s_cbranch_scc0 M_q
M_nq:
    v_smfmac_f32_16x16x64_bf16 v[148:151], v[112:115], v[228:235], v47
    v_smfmac_f32_16x16x64_bf16 v[152:155], v[80:83], v[220:227], v43 abid:1
    v_smfmac_f32_16x16x64_bf16 v[152:155], v[116:119], v[228:235], v47 abid:1
    s_waitcnt lgkmcnt(2)
    v_xad_u32 v236, v236, v3, v4
    v_smfmac_f32_16x16x64_bf16 v[152:155], v[240:243], v[244:251], v10
    v_xad_u32 v237, v237, v3, v4
    v_smfmac_f32_16x16x64_bf16 v[188:191], v[240:243], v[244:251], v10 abid:1
    s_cmp_gt_u32 s46, s80
    s_cbranch_scc1 M_slow
M_slowrL:
    v_xad_u32 v238, v238, v3, v4
    v_smfmac_f32_16x16x64_bf16 v[128:131], v[56:59], v[220:227], v40 abid:1
    ds_read2st64_b32 v[244:245], v236 offset0:0 offset1:72
    ds_read_b128 v[240:243], v8 offset:5120
    v_xad_u32 v239, v239, v3, v4
    v_smfmac_f32_16x16x64_bf16 v[128:131], v[92:95], v[228:235], v44 abid:1
    ds_read2st64_b32 v[246:247], v237 offset0:0 offset1:72
    v_smfmac_f32_16x16x64_bf16 v[160:163], a[0:3], v[196:203], v12
    ds_read2st64_b32 v[248:249], v238 offset0:0 offset1:72
    v_smfmac_f32_16x16x64_bf16 v[160:163], a[36:39], v[204:211], v16
    ds_read2st64_b32 v[250:251], v239 offset0:0 offset1:72
    ds_read_b128 v[236:239], v9 offset:9600
    s_waitcnt lgkmcnt(6)
    v_smfmac_f32_16x16x64_bf16 v[160:163], a[72:75], v[212:219], v20
    v_smfmac_f32_16x16x64_bf16 v[164:167], a[4:7], v[196:203], v12 abid:1
    s_mov_b32 m0, s28
    v_cvt_pk_bf16_f32 v156, v156, v157
    v_smfmac_f32_16x16x64_bf16 v[164:167], a[40:43], v[204:211], v16 abid:1
    s_waitcnt vmcnt(6)
    buffer_load_dwordx4 v5, s[8:11], s88 offen offset:0 nt lds
    v_cvt_pk_bf16_f32 v157, v158, v159
    v_smfmac_f32_16x16x64_bf16 v[164:167], a[76:79], v[212:219], v20 abid:1
    ds_write_b64 v53, v[156:157] offset:25728
    ds_read_b128 v[156:159], v9 offset:10752
    v_smfmac_f32_16x16x64_bf16 v[180:183], a[20:23], v[196:203], v14 abid:1
    v_smfmac_f32_16x16x64_bf16 v[180:183], a[56:59], v[204:211], v18 abid:1
    ds_read_b128 v[220:223], v1 offset:21504
    v_cvt_pk_bf16_f32 v124, v124, v125
    v_smfmac_f32_16x16x64_bf16 v[180:183], a[92:95], v[212:219], v22 abid:1
    s_waitcnt lgkmcnt(3)
    v_xad_u32 v236, v236, v3, v4
    v_smfmac_f32_16x16x64_bf16 v[180:183], v[240:243], v[244:251], v10 abid:1
    v_xad_u32 v237, v237, v3, v4
    v_smfmac_f32_16x16x64_bf16 v[144:147], v[240:243], v[244:251], v10
    ds_read2st64_b32 v[244:245], v236 offset0:0 offset1:72
    ds_read_b128 v[240:243], v8 offset:6144
    v_xad_u32 v238, v238, v3, v4
    v_smfmac_f32_16x16x64_bf16 v[172:175], a[12:15], v[196:203], v13 abid:1
    ds_read2st64_b32 v[246:247], v237 offset0:0 offset1:72
    v_xad_u32 v239, v239, v3, v4
    v_smfmac_f32_16x16x64_bf16 v[172:175], a[48:51], v[204:211], v17 abid:1
    ds_read2st64_b32 v[248:249], v238 offset0:0 offset1:72
    v_cvt_pk_bf16_f32 v125, v126, v127
    v_smfmac_f32_16x16x64_bf16 v[172:175], a[84:87], v[212:219], v21 abid:1
    ds_read2st64_b32 v[250:251], v239 offset0:0 offset1:72
    ds_read_b128 v[236:239], v9 offset:9472
    v_cvt_pk_bf16_f32 v126, v128, v129
    v_smfmac_f32_16x16x64_bf16 v[176:179], a[16:19], v[196:203], v14
    v_cvt_pk_bf16_f32 v127, v130, v131
    v_smfmac_f32_16x16x64_bf16 v[176:179], a[52:55], v[204:211], v18
    v_cvt_pk_bf16_f32 v132, v132, v133
    v_smfmac_f32_16x16x64_bf16 v[176:179], a[88:91], v[212:219], v22
    v_cvt_pk_bf16_f32 v133, v134, v135
    v_smfmac_f32_16x16x64_bf16 v[168:171], a[8:11], v[196:203], v13
    s_add_u32 m0, m0, 896
    v_cvt_pk_bf16_f32 v134, v136, v137
    v_smfmac_f32_16x16x64_bf16 v[168:171], a[44:47], v[204:211], v17
    s_waitcnt vmcnt(6)
    buffer_load_dwordx4 v5, s[8:11], s88 offen offset:128 nt lds
    v_cvt_pk_bf16_f32 v135, v138, v139
    v_smfmac_f32_16x16x64_bf16 v[168:171], a[80:83], v[212:219], v21
    ds_read_b128 v[224:227], v2 offset:21504
    ds_read_b128 v[136:139], v9 offset:10432
    v_cndmask_b32_dpp v128, v124, v132, vcc row_ror:8 row_mask:0xf bank_mask:0xf
    v_smfmac_f32_16x16x64_bf16 v[184:187], a[24:27], v[196:203], v15
    ds_read_b128 v[228:231], v1 offset:22528
    v_cndmask_b32_dpp v129, v125, v133, vcc row_ror:8 row_mask:0xf bank_mask:0xf
    v_smfmac_f32_16x16x64_bf16 v[184:187], a[60:63], v[204:211], v19
    ds_read_b128 v[232:235], v2 offset:22528
    v_cndmask_b32_dpp v130, v126, v134, vcc row_ror:8 row_mask:0xf bank_mask:0xf
    v_smfmac_f32_16x16x64_bf16 v[184:187], a[96:99], v[212:219], v23
    s_waitcnt lgkmcnt(4)
    v_xad_u32 v236, v236, v3, v4
    v_smfmac_f32_16x16x64_bf16 v[184:187], v[240:243], v[244:251], v10 abid:1
    v_xad_u32 v237, v237, v3, v4
    v_smfmac_f32_16x16x64_bf16 v[148:151], v[240:243], v[244:251], v10
    ds_read2st64_b32 v[244:245], v236 offset0:0 offset1:72
    ds_read_b128 v[240:243], v8 offset:4096
    v_xad_u32 v238, v238, v3, v4
    v_smfmac_f32_16x16x64_bf16 v[188:191], a[28:31], v[196:203], v15 abid:1
    ds_read2st64_b32 v[246:247], v237 offset0:0 offset1:72
    v_xad_u32 v239, v239, v3, v4
    v_smfmac_f32_16x16x64_bf16 v[188:191], a[64:67], v[204:211], v19 abid:1
    ds_read2st64_b32 v[248:249], v238 offset0:0 offset1:72
    v_cndmask_b32_dpp v131, v127, v135, vcc row_ror:8 row_mask:0xf bank_mask:0xf
    v_smfmac_f32_16x16x64_bf16 v[188:191], a[100:103], v[212:219], v23 abid:1
    ds_read2st64_b32 v[250:251], v239 offset0:0 offset1:72
    s_waitcnt vmcnt(6)
    buffer_store_dwordx4 v[128:131], v6, s[12:15], s59 offen offset:0 sc1
    v_smfmac_f32_16x16x64_bf16 v[192:195], a[32:35], v[196:203], v48
    v_mov_b32_dpp v124, v132 row_ror:8 row_mask:0xf bank_mask:0xc
    v_smfmac_f32_16x16x64_bf16 v[192:195], a[68:71], v[204:211], v48 abid:1
    v_mov_b32_dpp v125, v133 row_ror:8 row_mask:0xf bank_mask:0xc
    v_smfmac_f32_16x16x64_bf16 v[192:195], a[104:107], v[212:219], v49
    s_waitcnt lgkmcnt(8)
    v_mov_b32_dpp v126, v134 row_ror:8 row_mask:0xf bank_mask:0xc
    v_smfmac_f32_16x16x64_bf16 v[160:163], a[108:111], v[220:227], v24
    s_waitcnt lgkmcnt(5)
    v_mov_b32_dpp v127, v135 row_ror:8 row_mask:0xf bank_mask:0xc
    v_smfmac_f32_16x16x64_bf16 v[160:163], a[144:147], v[228:235], v28
    ds_read_b128 v[196:199], v1 offset:23552
    s_waitcnt vmcnt(6)
    buffer_store_dwordx4 v[124:127], v6, s[12:15], s24 offen offset:0 sc1
    v_smfmac_f32_16x16x64_bf16 v[164:167], a[112:115], v[220:227], v24 abid:1
    ds_read_b128 v[200:203], v2 offset:23552
    ds_read_b128 v[128:131], v9 offset:10304
    ds_read_b128 v[132:135], v9 offset:10368
    v_smfmac_f32_16x16x64_bf16 v[164:167], a[148:151], v[228:235], v28 abid:1
    ds_read_b128 v[204:207], v1 offset:24576
    ds_read_b128 v[124:127], v9 offset:10240
    v_smfmac_f32_16x16x64_bf16 v[176:179], a[124:127], v[220:227], v26
    ds_read_b128 v[208:211], v2 offset:24576
    v_smfmac_f32_16x16x64_bf16 v[176:179], a[160:163], v[228:235], v30
    s_waitcnt lgkmcnt(7)
    v_smfmac_f32_16x16x64_bf16 v[176:179], v[240:243], v[244:251], v10 abid:1
    v_smfmac_f32_16x16x64_bf16 v[140:143], v[240:243], v[244:251], v10
    v_smfmac_f32_16x16x64_bf16 v[172:175], a[120:123], v[220:227], v25 abid:1
    s_add_u32 s28, s28, 36864
    s_cmp_ge_u32 s28, 110592
    s_cselect_b32 s28, s26, s28
    v_smfmac_f32_16x16x64_bf16 v[172:175], a[156:159], v[228:235], v29 abid:1
    s_add_u32 s30, s25, 36864
    s_cmp_eq_u32 s30, 110592
    s_cselect_b32 s30, 0, s30
    v_smfmac_f32_16x16x64_bf16 v[168:171], a[116:119], v[220:227], v25
    s_sub_u32 s31, s30, s25
    s_mov_b32 s25, s30
    s_mov_b32 s90, s22
    v_smfmac_f32_16x16x64_bf16 v[168:171], a[152:155], v[228:235], v29
    s_mov_b32 s22, s88
    s_add_u32 s91, s91, 1
    s_cmp_lt_u32 s20, 2
    v_smfmac_f32_16x16x64_bf16 v[180:183], a[128:131], v[220:227], v26 abid:1
    s_cselect_b32 s66, s23, s24
    s_add_u32 s66, s66, s95
    v_smfmac_f32_16x16x64_bf16 v[180:183], a[164:167], v[228:235], v30 abid:1
    v_cvt_pk_bf16_f32 v140, v140, v141
    v_smfmac_f32_16x16x64_bf16 v[184:187], a[132:135], v[220:227], v27
    s_add_u32 m0, m0, 896
    v_cvt_pk_bf16_f32 v141, v142, v143
    v_smfmac_f32_16x16x64_bf16 v[184:187], a[168:171], v[228:235], v31
    s_waitcnt vmcnt(6)
    buffer_load_dwordx4 v5, s[8:11], s88 offen offset:256 nt lds
    v_cvt_pk_bf16_f32 v142, v144, v145
    v_smfmac_f32_16x16x64_bf16 v[188:191], a[136:139], v[220:227], v27 abid:1
    v_cvt_pk_bf16_f32 v143, v146, v147
    v_smfmac_f32_16x16x64_bf16 v[188:191], a[172:175], v[228:235], v31 abid:1
    v_cvt_pk_bf16_f32 v148, v148, v149
    v_smfmac_f32_16x16x64_bf16 v[192:195], a[140:143], v[220:227], v49 abid:1
    v_cvt_pk_bf16_f32 v149, v150, v151
    v_smfmac_f32_16x16x64_bf16 v[192:195], a[176:179], v[228:235], v50
    ds_read_b128 v[220:223], v1 offset:25600
    s_waitcnt lgkmcnt(6)
    v_cvt_pk_bf16_f32 v150, v152, v153
    v_smfmac_f32_16x16x64_bf16 v[160:163], a[180:183], v[196:203], v32
    ds_read_b128 v[224:227], v2 offset:25600
    s_waitcnt lgkmcnt(2)
    v_cvt_pk_bf16_f32 v151, v154, v155
    v_smfmac_f32_16x16x64_bf16 v[160:163], a[216:219], v[204:211], v36
    ds_read_b128 v[228:231], v1 offset:26624
    ds_read_b128 v[152:155], v9 offset:10688
    v_cndmask_b32_dpp v144, v140, v148, vcc row_ror:8 row_mask:0xf bank_mask:0xf
    v_smfmac_f32_16x16x64_bf16 v[164:167], a[184:187], v[196:203], v32 abid:1
    ds_read_b128 v[232:235], v2 offset:26624
    v_cndmask_b32_dpp v145, v141, v149, vcc row_ror:8 row_mask:0xf bank_mask:0xf
    v_smfmac_f32_16x16x64_bf16 v[164:167], a[220:223], v[204:211], v36 abid:1
    s_add_u32 m0, m0, 896
    v_cndmask_b32_dpp v146, v142, v150, vcc row_ror:8 row_mask:0xf bank_mask:0xf
    v_smfmac_f32_16x16x64_bf16 v[168:171], a[188:191], v[196:203], v33
    s_waitcnt vmcnt(6)
    buffer_load_dwordx4 v5, s[8:11], s88 offen offset:384 nt lds
    v_cndmask_b32_dpp v147, v143, v151, vcc row_ror:8 row_mask:0xf bank_mask:0xf
    v_smfmac_f32_16x16x64_bf16 v[168:171], a[224:227], v[204:211], v37
    s_waitcnt vmcnt(6)
    buffer_store_dwordx4 v[144:147], v6, s[12:15], s59 offen offset:128 sc1
    v_mov_b32_dpp v140, v148 row_ror:8 row_mask:0xf bank_mask:0xc
    v_smfmac_f32_16x16x64_bf16 v[172:175], a[192:195], v[196:203], v33 abid:1
    v_mov_b32_dpp v141, v149 row_ror:8 row_mask:0xf bank_mask:0xc
    v_smfmac_f32_16x16x64_bf16 v[172:175], a[228:231], v[204:211], v37 abid:1
    v_mov_b32_dpp v142, v150 row_ror:8 row_mask:0xf bank_mask:0xc
    v_smfmac_f32_16x16x64_bf16 v[176:179], a[196:199], v[196:203], v34
    v_mov_b32_dpp v143, v151 row_ror:8 row_mask:0xf bank_mask:0xc
    v_smfmac_f32_16x16x64_bf16 v[176:179], a[232:235], v[204:211], v38
    s_waitcnt vmcnt(6)
    buffer_store_dwordx4 v[140:143], v6, s[12:15], s24 offen offset:128 sc1
    ds_read_b128 v[144:147], v9 offset:10560
    v_smfmac_f32_16x16x64_bf16 v[180:183], a[200:203], v[196:203], v34 abid:1
    ds_read_b128 v[148:151], v9 offset:10624
    ds_read_b128 v[140:143], v9 offset:10496
    v_add_u32 v4, s31, v4
    v_smfmac_f32_16x16x64_bf16 v[180:183], a[236:239], v[204:211], v38 abid:1
    v_add_u32 v1, s31, v1
    v_smfmac_f32_16x16x64_bf16 v[184:187], a[204:207], v[196:203], v35
    v_add_u32 v2, s31, v2
    v_smfmac_f32_16x16x64_bf16 v[184:187], a[240:243], v[204:211], v39
    v_smfmac_f32_16x16x64_bf16 v[188:191], a[208:211], v[196:203], v35 abid:1
    v_smfmac_f32_16x16x64_bf16 v[188:191], a[244:247], v[204:211], v39 abid:1
    v_smfmac_f32_16x16x64_bf16 v[192:195], a[212:215], v[196:203], v50 abid:1
    v_smfmac_f32_16x16x64_bf16 v[192:195], a[248:251], v[204:211], v51
    s_waitcnt vmcnt(8)
    s_branch M_top1
M_bE0:
    v_smfmac_f32_16x16x64_bf16 v[164:167], v[56:59], v[220:227], v40 abid:1
    ds_read_b128 v[204:207], v1 offset:1024
    s_cmp_lt_u32 s22, 74612736
    s_cselect_b32 s30, 1, 0
    v_smfmac_f32_16x16x64_bf16 v[164:167], v[92:95], v[228:235], v44 abid:1
    ds_read_b128 v[208:211], v2 offset:1024
    v_mov_b32 v0, s30
    v_smfmac_f32_16x16x64_bf16 v[168:171], v[60:63], v[220:227], v41
    ds_read_b128 v[212:215], v1 offset:2048
    v_smfmac_f32_16x16x64_bf16 v[168:171], v[96:99], v[228:235], v45
    ds_read_b128 v[216:219], v2 offset:2048
    v_smfmac_f32_16x16x64_bf16 v[172:175], v[64:67], v[220:227], v41 abid:1
    s_waitcnt vmcnt(5)
    s_waitcnt lgkmcnt(6)
    buffer_store_dwordx4 v[244:247], v7, s[12:15], s66 offen sc1
    v_smfmac_f32_16x16x64_bf16 v[172:175], v[100:103], v[228:235], v45 abid:1
    ds_read_b128 v[236:239], v9 offset:9408
    v_smfmac_f32_16x16x64_bf16 v[176:179], v[68:71], v[220:227], v42
    s_waitcnt vmcnt(5)
    buffer_atomic_add v0, v11, s[16:19], s92 offen sc0 sc1
    s_mov_b32 s21, 2
    v_smfmac_f32_16x16x64_bf16 v[176:179], v[104:107], v[228:235], v46
    v_smfmac_f32_16x16x64_bf16 v[180:183], v[72:75], v[220:227], v42 abid:1
    v_cvt_pk_bf16_f32 v160, v160, v161
    v_smfmac_f32_16x16x64_bf16 v[180:183], v[108:111], v[228:235], v46 abid:1
    v_cvt_pk_bf16_f32 v161, v162, v163
    v_smfmac_f32_16x16x64_bf16 v[184:187], v[76:79], v[220:227], v43
    v_cvt_pk_bf16_f32 v162, v164, v165
    v_smfmac_f32_16x16x64_bf16 v[184:187], v[112:115], v[228:235], v47
    v_cvt_pk_bf16_f32 v163, v166, v167
    v_smfmac_f32_16x16x64_bf16 v[188:191], v[80:83], v[220:227], v43 abid:1
    s_add_u32 m0, m0, 896
    v_cvt_pk_bf16_f32 v168, v168, v169
    v_smfmac_f32_16x16x64_bf16 v[188:191], v[116:119], v[228:235], v47 abid:1
    s_waitcnt vmcnt(5)
    buffer_load_dwordx4 v5, s[8:11], s22 offen offset:512 nt lds
    v_cvt_pk_bf16_f32 v169, v170, v171
    v_smfmac_f32_16x16x64_bf16 v[192:195], v[84:87], v[220:227], v51 abid:1
    v_cvt_pk_bf16_f32 v170, v172, v173
    v_smfmac_f32_16x16x64_bf16 v[192:195], v[120:123], v[228:235], v52
    ds_read_b128 v[220:223], v1 offset:3072
    s_waitcnt lgkmcnt(6)
    v_cvt_pk_bf16_f32 v171, v174, v175
    v_smfmac_f32_16x16x64_bf16 v[124:127], a[0:3], v[196:203], v12
    ds_read_b128 v[224:227], v2 offset:3072
    ds_read_b128 v[172:175], v9 offset:10432
    s_waitcnt lgkmcnt(6)
    v_cndmask_b32_dpp v164, v160, v168, vcc row_ror:8 row_mask:0xf bank_mask:0xf
    v_smfmac_f32_16x16x64_bf16 v[124:127], a[36:39], v[204:211], v16
    ds_read_b128 v[228:231], v1 offset:4096
    s_waitcnt lgkmcnt(5)
    v_cndmask_b32_dpp v165, v161, v169, vcc row_ror:8 row_mask:0xf bank_mask:0xf
    v_smfmac_f32_16x16x64_bf16 v[124:127], a[72:75], v[212:219], v20
    ds_read_b128 v[232:235], v2 offset:4096
    v_cndmask_b32_dpp v166, v162, v170, vcc row_ror:8 row_mask:0xf bank_mask:0xf
    v_smfmac_f32_16x16x64_bf16 v[128:131], a[4:7], v[196:203], v12 abid:1
    s_barrier
    v_cndmask_b32_dpp v167, v163, v171, vcc row_ror:8 row_mask:0xf bank_mask:0xf
    v_smfmac_f32_16x16x64_bf16 v[128:131], a[40:43], v[204:211], v16 abid:1
    s_waitcnt vmcnt(5)
    buffer_store_dwordx4 v[164:167], v6, s[12:15], s58 offen offset:0 sc1
    s_waitcnt lgkmcnt(5)
    v_xad_u32 v236, v236, v3, v4
    v_smfmac_f32_16x16x64_bf16 v[128:131], a[76:79], v[212:219], v20 abid:1
    v_xad_u32 v237, v237, v3, v4
    v_smfmac_f32_16x16x64_bf16 v[132:135], a[8:11], v[196:203], v13
    ds_read2st64_b32 v[244:245], v236 offset0:0 offset1:72
    ds_read_b128 v[240:243], v8 offset:3072
    v_xad_u32 v238, v238, v3, v4
    v_smfmac_f32_16x16x64_bf16 v[132:135], a[44:47], v[204:211], v17
    ds_read2st64_b32 v[246:247], v237 offset0:0 offset1:72
    v_xad_u32 v239, v239, v3, v4
    v_smfmac_f32_16x16x64_bf16 v[132:135], a[80:83], v[212:219], v21
    ds_read2st64_b32 v[248:249], v238 offset0:0 offset1:72
    v_mov_b32_dpp v160, v168 row_ror:8 row_mask:0xf bank_mask:0xc
    v_smfmac_f32_16x16x64_bf16 v[144:147], a[20:23], v[196:203], v14 abid:1
    ds_read2st64_b32 v[250:251], v239 offset0:0 offset1:72
    ds_read_b128 v[236:239], v9 offset:9280
    v_mov_b32_dpp v161, v169 row_ror:8 row_mask:0xf bank_mask:0xc
    v_smfmac_f32_16x16x64_bf16 v[144:147], a[56:59], v[204:211], v18 abid:1
    v_mov_b32_dpp v162, v170 row_ror:8 row_mask:0xf bank_mask:0xc
    v_smfmac_f32_16x16x64_bf16 v[144:147], a[92:95], v[212:219], v22 abid:1
    v_mov_b32_dpp v163, v171 row_ror:8 row_mask:0xf bank_mask:0xc
    v_smfmac_f32_16x16x64_bf16 v[140:143], a[16:19], v[196:203], v14
    s_waitcnt vmcnt(5)
    buffer_store_dwordx4 v[160:163], v6, s[12:15], s23 offen offset:0 sc1
    ds_read_b128 v[164:167], v9 offset:10304
    v_smfmac_f32_16x16x64_bf16 v[140:143], a[52:55], v[204:211], v18
    ds_read_b128 v[168:171], v9 offset:10368
    ds_read_b128 v[160:163], v9 offset:10240
    v_smfmac_f32_16x16x64_bf16 v[140:143], a[88:91], v[212:219], v22
    v_smfmac_f32_16x16x64_bf16 v[136:139], a[12:15], v[196:203], v13 abid:1
    v_smfmac_f32_16x16x64_bf16 v[136:139], a[48:51], v[204:211], v17 abid:1
    v_smfmac_f32_16x16x64_bf16 v[136:139], a[84:87], v[212:219], v21 abid:1
    s_waitcnt lgkmcnt(3)
    v_xad_u32 v236, v236, v3, v4
    v_smfmac_f32_16x16x64_bf16 v[136:139], v[240:243], v[244:251], v10
    v_xad_u32 v237, v237, v3, v4
    v_smfmac_f32_16x16x64_bf16 v[172:175], v[240:243], v[244:251], v10 abid:1
    ds_read2st64_b32 v[244:245], v236 offset0:0 offset1:72
    ds_read_b128 v[240:243], v8 offset:1024
    v_xad_u32 v238, v238, v3, v4
    v_smfmac_f32_16x16x64_bf16 v[148:151], a[24:27], v[196:203], v15
    ds_read2st64_b32 v[246:247], v237 offset0:0 offset1:72
    v_xad_u32 v239, v239, v3, v4
    v_smfmac_f32_16x16x64_bf16 v[148:151], a[60:63], v[204:211], v19
    ds_read2st64_b32 v[248:249], v238 offset0:0 offset1:72
    v_cvt_pk_bf16_f32 v192, v192, v193
    v_smfmac_f32_16x16x64_bf16 v[148:151], a[96:99], v[212:219], v23
    ds_read2st64_b32 v[250:251], v239 offset0:0 offset1:72
    ds_read_b128 v[236:239], v9 offset:9344
    v_cvt_pk_bf16_f32 v193, v194, v195
    v_smfmac_f32_16x16x64_bf16 v[152:155], a[28:31], v[196:203], v15 abid:1
    ds_write_b64 v53, v[192:193] offset:0
    ds_read_b128 v[192:195], v9 offset:10752
    v_smfmac_f32_16x16x64_bf16 v[152:155], a[64:67], v[204:211], v19 abid:1
    s_add_u32 m0, m0, 896
    v_smfmac_f32_16x16x64_bf16 v[152:155], a[100:103], v[212:219], v23 abid:1
    s_waitcnt vmcnt(5)
    buffer_load_dwordx4 v5, s[8:11], s22 offen offset:640 nt lds
    v_smfmac_f32_16x16x64_bf16 v[156:159], a[32:35], v[196:203], v48
    v_smfmac_f32_16x16x64_bf16 v[156:159], a[68:71], v[204:211], v48 abid:1
    v_smfmac_f32_16x16x64_bf16 v[156:159], a[104:107], v[212:219], v49
    ds_read_b128 v[196:199], v1 offset:5120
    v_cvt_pk_bf16_f32 v176, v176, v177
    v_smfmac_f32_16x16x64_bf16 v[124:127], a[108:111], v[220:227], v24
    ds_read_b128 v[200:203], v2 offset:5120
    v_cvt_pk_bf16_f32 v177, v178, v179
    v_smfmac_f32_16x16x64_bf16 v[124:127], a[144:147], v[228:235], v28
    ds_read_b128 v[204:207], v1 offset:6144
    ds_read_b64 v[216:217], v9 offset:10056
    v_cvt_pk_bf16_f32 v178, v180, v181
    v_smfmac_f32_16x16x64_bf16 v[128:131], a[112:115], v[220:227], v24 abid:1
    ds_read_b128 v[208:211], v2 offset:6144
    v_cvt_pk_bf16_f32 v179, v182, v183
    v_smfmac_f32_16x16x64_bf16 v[128:131], a[148:151], v[228:235], v28 abid:1
    s_waitcnt lgkmcnt(7)
    v_xad_u32 v236, v236, v3, v4
    v_smfmac_f32_16x16x64_bf16 v[128:131], v[240:243], v[244:251], v10
    s_add_u32 m0, m0, 896
    v_xad_u32 v237, v237, v3, v4
    v_smfmac_f32_16x16x64_bf16 v[164:167], v[240:243], v[244:251], v10 abid:1
    ds_read2st64_b32 v[244:245], v236 offset0:0 offset1:72
    ds_read_b128 v[240:243], v8 offset:2048
    v_xad_u32 v238, v238, v3, v4
    v_smfmac_f32_16x16x64_bf16 v[152:155], a[136:139], v[220:227], v27 abid:1
    ds_read2st64_b32 v[246:247], v237 offset0:0 offset1:72
    s_waitcnt vmcnt(5)
    v_xad_u32 v239, v239, v3, v4
    v_smfmac_f32_16x16x64_bf16 v[152:155], a[172:175], v[228:235], v31 abid:1
    ds_read2st64_b32 v[248:249], v238 offset0:0 offset1:72
    buffer_load_dwordx4 v5, s[8:11], s22 offen offset:768 nt lds
    v_cvt_pk_bf16_f32 v184, v184, v185
    v_smfmac_f32_16x16x64_bf16 v[136:139], a[120:123], v[220:227], v25 abid:1
    ds_read2st64_b32 v[250:251], v239 offset0:0 offset1:72
    ds_read_b128 v[236:239], v9 offset:9216
    v_cvt_pk_bf16_f32 v185, v186, v187
    v_smfmac_f32_16x16x64_bf16 v[136:139], a[156:159], v[228:235], v29 abid:1
    v_cvt_pk_bf16_f32 v186, v188, v189
    v_smfmac_f32_16x16x64_bf16 v[140:143], a[124:127], v[220:227], v26
    v_cvt_pk_bf16_f32 v187, v190, v191
    v_smfmac_f32_16x16x64_bf16 v[140:143], a[160:163], v[228:235], v30
    ds_read_b128 v[188:191], v9 offset:10688
    v_cndmask_b32_dpp v180, v176, v184, vcc row_ror:8 row_mask:0xf bank_mask:0xf
    v_smfmac_f32_16x16x64_bf16 v[144:147], a[128:131], v[220:227], v26 abid:1
    v_cndmask_b32_dpp v181, v177, v185, vcc row_ror:8 row_mask:0xf bank_mask:0xf
    v_smfmac_f32_16x16x64_bf16 v[144:147], a[164:167], v[228:235], v30 abid:1
    v_cndmask_b32_dpp v182, v178, v186, vcc row_ror:8 row_mask:0xf bank_mask:0xf
    v_smfmac_f32_16x16x64_bf16 v[148:151], a[132:135], v[220:227], v27
    v_cndmask_b32_dpp v183, v179, v187, vcc row_ror:8 row_mask:0xf bank_mask:0xf
    v_smfmac_f32_16x16x64_bf16 v[148:151], a[168:171], v[228:235], v31
    s_waitcnt vmcnt(5)
    buffer_store_dwordx4 v[180:183], v6, s[12:15], s58 offen offset:128 sc1
    s_waitcnt lgkmcnt(8)
    v_xad_u32 v212, v216, v3, v4
    v_smfmac_f32_16x16x64_bf16 v[132:135], a[116:119], v[220:227], v25
    ds_read2st64_b32 v[212:213], v212 offset0:0 offset1:72
    v_xad_u32 v214, v217, v3, v4
    v_smfmac_f32_16x16x64_bf16 v[132:135], a[152:155], v[228:235], v29
    ds_read2st64_b32 v[214:215], v214 offset0:0 offset1:72
    s_waitcnt lgkmcnt(3)
    v_xad_u32 v236, v236, v3, v4
    v_smfmac_f32_16x16x64_bf16 v[132:135], v[240:243], v[244:251], v10
    v_xad_u32 v237, v237, v3, v4
    v_smfmac_f32_16x16x64_bf16 v[168:171], v[240:243], v[244:251], v10 abid:1
    ds_read2st64_b32 v[244:245], v236 offset0:0 offset1:72
    ds_read_b128 v[240:243], v8 offset:0
    v_xad_u32 v238, v238, v3, v4
    v_smfmac_f32_16x16x64_bf16 v[156:159], a[140:143], v[220:227], v49 abid:1
    ds_read2st64_b32 v[246:247], v237 offset0:0 offset1:72
    v_xad_u32 v239, v239, v3, v4
    v_smfmac_f32_16x16x64_bf16 v[156:159], a[176:179], v[228:235], v50
    ds_read2st64_b32 v[248:249], v238 offset0:0 offset1:72
    v_mov_b32_dpp v176, v184 row_ror:8 row_mask:0xf bank_mask:0xc
    v_smfmac_f32_16x16x64_bf16 v[140:143], a[196:199], v[196:203], v34
    ds_read2st64_b32 v[250:251], v239 offset0:0 offset1:72
    ds_read_b128 v[236:239], v9 offset:9728
    v_mov_b32_dpp v177, v185 row_ror:8 row_mask:0xf bank_mask:0xc
    v_smfmac_f32_16x16x64_bf16 v[140:143], a[232:235], v[204:211], v38
    v_mov_b32_dpp v178, v186 row_ror:8 row_mask:0xf bank_mask:0xc
    v_smfmac_f32_16x16x64_bf16 v[128:131], a[184:187], v[196:203], v32 abid:1
    v_mov_b32_dpp v179, v187 row_ror:8 row_mask:0xf bank_mask:0xc
    v_smfmac_f32_16x16x64_bf16 v[128:131], a[220:223], v[204:211], v36 abid:1
    s_waitcnt vmcnt(5)
    buffer_store_dwordx4 v[176:179], v6, s[12:15], s23 offen offset:128 sc1
    ds_read_b128 v[180:183], v9 offset:10560
    v_smfmac_f32_16x16x64_bf16 v[132:135], a[188:191], v[196:203], v33
    ds_read_b128 v[184:187], v9 offset:10624
    ds_read_b128 v[176:179], v9 offset:10496
    v_smfmac_f32_16x16x64_bf16 v[132:135], a[224:227], v[204:211], v37
    v_smfmac_f32_16x16x64_bf16 v[136:139], a[192:195], v[196:203], v33 abid:1
    ds_read_b128 v[220:223], v1 offset:7168
    v_smfmac_f32_16x16x64_bf16 v[136:139], a[228:231], v[204:211], v37 abid:1
    ds_read_b128 v[224:227], v2 offset:7168
    v_smfmac_f32_16x16x64_bf16 v[124:127], a[180:183], v[196:203], v32
    ds_read_b128 v[228:231], v1 offset:8192
    v_smfmac_f32_16x16x64_bf16 v[124:127], a[216:219], v[204:211], v36
    s_waitcnt vmcnt(7)
    s_waitcnt lgkmcnt(6)
    v_xad_u32 v236, v236, v3, v4
    v_smfmac_f32_16x16x64_bf16 v[124:127], v[240:243], v[244:251], v10
    ds_read_b128 v[232:235], v2 offset:8192
    v_xad_u32 v237, v237, v3, v4
    v_smfmac_f32_16x16x64_bf16 v[160:163], v[240:243], v[244:251], v10 abid:1
    ds_read2st64_b32 v[244:245], v236 offset0:0 offset1:72
    ds_read_b128 v[240:243], v8 offset:8192
    v_xad_u32 v238, v238, v3, v4
    v_smfmac_f32_16x16x64_bf16 v[144:147], a[200:203], v[196:203], v34 abid:1
    ds_read2st64_b32 v[246:247], v237 offset0:0 offset1:72
    v_xad_u32 v239, v239, v3, v4
    v_smfmac_f32_16x16x64_bf16 v[144:147], a[236:239], v[204:211], v38 abid:1
    ds_read2st64_b32 v[248:249], v238 offset0:0 offset1:72
    v_mul_u32_u24 v0, s94, v0
    v_smfmac_f32_16x16x64_bf16 v[148:151], a[204:207], v[196:203], v35
    ds_read2st64_b32 v[250:251], v239 offset0:0 offset1:72
    ds_read_b128 v[236:239], v9 offset:9664
    v_add_u32 v0, s93, v0
    v_smfmac_f32_16x16x64_bf16 v[148:151], a[240:243], v[204:211], v39
    s_waitcnt lgkmcnt(10)
    s_cmp_lt_i32 s81, 0
    s_cbranch_scc1 M_ovrE0
    s_swappc_b64 s[78:79], s[72:73]
M_ovrE0:
    v_smfmac_f32_16x16x64_bf16 v[152:155], a[208:211], v[196:203], v35 abid:1
    ds_write_b32 v11, v0
    v_mov_b32 v0, 162048
    v_smfmac_f32_16x16x64_bf16 v[152:155], a[244:247], v[204:211], v39 abid:1
    s_add_u32 m0, m0, 896
    v_smfmac_f32_16x16x64_bf16 v[156:159], a[212:215], v[196:203], v50 abid:1
    s_waitcnt vmcnt(5)
    buffer_load_dwordx4 v5, s[8:11], s22 offen offset:896 nt lds
    v_smfmac_f32_16x16x64_bf16 v[156:159], a[248:251], v[204:211], v51
    s_waitcnt lgkmcnt(9)
    v_smfmac_f32_16x16x64_bf16 v[124:127], a[252:255], v[220:227], v40
    ds_read_b128 v[196:199], v1 offset:18432
    s_waitcnt lgkmcnt(8)
    v_smfmac_f32_16x16x64_bf16 v[124:127], v[88:91], v[228:235], v44
    ds_read_b128 v[200:203], v2 offset:18432
    v_smfmac_f32_16x16x64_bf16 v[156:159], v[84:87], v[220:227], v51 abid:1
    ds_read_b128 v[204:207], v1 offset:19456
    v_smfmac_f32_16x16x64_bf16 v[156:159], v[120:123], v[228:235], v52
    s_waitcnt lgkmcnt(3)
    s_barrier
    v_xad_u32 v236, v236, v3, v4
    v_smfmac_f32_16x16x64_bf16 v[156:159], v[240:243], v[244:251], v10
    ds_read_b128 v[208:211], v2 offset:19456
    ds_read_b32 v0, v0
    v_xad_u32 v237, v237, v3, v4
    v_smfmac_f32_16x16x64_bf16 v[192:195], v[240:243], v[244:251], v10 abid:1
    ds_read2st64_b32 v[244:245], v236 offset0:0 offset1:72
    ds_read_b128 v[240:243], v8 offset:7168
    v_xad_u32 v238, v238, v3, v4
    v_smfmac_f32_16x16x64_bf16 v[132:135], v[60:63], v[220:227], v41
    ds_read2st64_b32 v[246:247], v237 offset0:0 offset1:72
    v_xad_u32 v239, v239, v3, v4
    v_smfmac_f32_16x16x64_bf16 v[132:135], v[96:99], v[228:235], v45
    ds_read2st64_b32 v[248:249], v238 offset0:0 offset1:72
    s_add_u32 m0, m0, 896
    v_smfmac_f32_16x16x64_bf16 v[136:139], v[64:67], v[220:227], v41 abid:1
    ds_read2st64_b32 v[250:251], v239 offset0:0 offset1:72
    ds_read_b128 v[236:239], v9 offset:9536
    s_waitcnt vmcnt(5)
    v_smfmac_f32_16x16x64_bf16 v[136:139], v[100:103], v[228:235], v45 abid:1
    buffer_load_dwordx4 v5, s[8:11], s22 offen offset:1024 nt lds
    s_waitcnt lgkmcnt(6)
    v_readfirstlane_b32 s88, v0
    v_smfmac_f32_16x16x64_bf16 v[140:143], v[68:71], v[220:227], v42
    s_add_u32 s30, s88, 74612736
    s_lshr_b32 s30, s30, 1
    s_min_u32 s88, s88, s30
    v_smfmac_f32_16x16x64_bf16 v[140:143], v[104:107], v[228:235], v46
    s_min_u32 s88, s88, s14
    v_smfmac_f32_16x16x64_bf16 v[144:147], v[72:75], v[220:227], v42 abid:1
    ds_read_b128 v[212:215], v1 offset:20480
    s_cmp_lt_u32 s22, 74612736
    s_cselect_b32 s88, s88, s14
    v_smfmac_f32_16x16x64_bf16 v[144:147], v[108:111], v[228:235], v46 abid:1
    ds_read_b128 v[216:219], v2 offset:20480
    s_cmp_lt_u32 s88, s99
    s_cselect_b32 s10, 75497472, 0
    v_smfmac_f32_16x16x64_bf16 v[148:151], v[76:79], v[220:227], v43
    v_smfmac_f32_16x16x64_bf16 v[148:151], v[112:115], v[228:235], v47
    v_smfmac_f32_16x16x64_bf16 v[152:155], v[80:83], v[220:227], v43 abid:1
    v_smfmac_f32_16x16x64_bf16 v[152:155], v[116:119], v[228:235], v47 abid:1
    s_waitcnt lgkmcnt(2)
    v_xad_u32 v236, v236, v3, v4
    v_smfmac_f32_16x16x64_bf16 v[152:155], v[240:243], v[244:251], v10
    v_xad_u32 v237, v237, v3, v4
    v_smfmac_f32_16x16x64_bf16 v[188:191], v[240:243], v[244:251], v10 abid:1
    s_cmp_gt_u32 s46, s80
    s_cbranch_scc1 M_slow
M_slowrE0:
    v_xad_u32 v238, v238, v3, v4
    v_smfmac_f32_16x16x64_bf16 v[128:131], v[56:59], v[220:227], v40 abid:1
    ds_read2st64_b32 v[244:245], v236 offset0:0 offset1:72
    ds_read_b128 v[240:243], v8 offset:5120
    v_xad_u32 v239, v239, v3, v4
    v_smfmac_f32_16x16x64_bf16 v[128:131], v[92:95], v[228:235], v44 abid:1
    ds_read2st64_b32 v[246:247], v237 offset0:0 offset1:72
    v_smfmac_f32_16x16x64_bf16 v[160:163], a[0:3], v[196:203], v12
    ds_read2st64_b32 v[248:249], v238 offset0:0 offset1:72
    v_smfmac_f32_16x16x64_bf16 v[160:163], a[36:39], v[204:211], v16
    ds_read2st64_b32 v[250:251], v239 offset0:0 offset1:72
    ds_read_b128 v[236:239], v9 offset:9600
    s_waitcnt lgkmcnt(6)
    v_smfmac_f32_16x16x64_bf16 v[160:163], a[72:75], v[212:219], v20
    v_smfmac_f32_16x16x64_bf16 v[164:167], a[4:7], v[196:203], v12 abid:1
    s_mov_b32 m0, s28
    v_cvt_pk_bf16_f32 v156, v156, v157
    v_smfmac_f32_16x16x64_bf16 v[164:167], a[40:43], v[204:211], v16 abid:1
    s_waitcnt vmcnt(5)
    buffer_load_dwordx4 v5, s[8:11], s88 offen offset:0 nt lds
    v_cvt_pk_bf16_f32 v157, v158, v159
    v_smfmac_f32_16x16x64_bf16 v[164:167], a[76:79], v[212:219], v20 abid:1
    ds_write_b64 v53, v[156:157] offset:25728
    ds_read_b128 v[156:159], v9 offset:10752
    v_smfmac_f32_16x16x64_bf16 v[180:183], a[20:23], v[196:203], v14 abid:1
    v_smfmac_f32_16x16x64_bf16 v[180:183], a[56:59], v[204:211], v18 abid:1
    ds_read_b128 v[220:223], v1 offset:21504
    v_cvt_pk_bf16_f32 v124, v124, v125
    v_smfmac_f32_16x16x64_bf16 v[180:183], a[92:95], v[212:219], v22 abid:1
    s_waitcnt lgkmcnt(3)
    v_xad_u32 v236, v236, v3, v4
    v_smfmac_f32_16x16x64_bf16 v[180:183], v[240:243], v[244:251], v10 abid:1
    v_xad_u32 v237, v237, v3, v4
    v_smfmac_f32_16x16x64_bf16 v[144:147], v[240:243], v[244:251], v10
    ds_read2st64_b32 v[244:245], v236 offset0:0 offset1:72
    ds_read_b128 v[240:243], v8 offset:6144
    v_xad_u32 v238, v238, v3, v4
    v_smfmac_f32_16x16x64_bf16 v[172:175], a[12:15], v[196:203], v13 abid:1
    ds_read2st64_b32 v[246:247], v237 offset0:0 offset1:72
    v_xad_u32 v239, v239, v3, v4
    v_smfmac_f32_16x16x64_bf16 v[172:175], a[48:51], v[204:211], v17 abid:1
    ds_read2st64_b32 v[248:249], v238 offset0:0 offset1:72
    v_cvt_pk_bf16_f32 v125, v126, v127
    v_smfmac_f32_16x16x64_bf16 v[172:175], a[84:87], v[212:219], v21 abid:1
    ds_read2st64_b32 v[250:251], v239 offset0:0 offset1:72
    ds_read_b128 v[236:239], v9 offset:9472
    v_cvt_pk_bf16_f32 v126, v128, v129
    v_smfmac_f32_16x16x64_bf16 v[176:179], a[16:19], v[196:203], v14
    v_cvt_pk_bf16_f32 v127, v130, v131
    v_smfmac_f32_16x16x64_bf16 v[176:179], a[52:55], v[204:211], v18
    v_cvt_pk_bf16_f32 v132, v132, v133
    v_smfmac_f32_16x16x64_bf16 v[176:179], a[88:91], v[212:219], v22
    v_cvt_pk_bf16_f32 v133, v134, v135
    v_smfmac_f32_16x16x64_bf16 v[168:171], a[8:11], v[196:203], v13
    s_add_u32 m0, m0, 896
    v_cvt_pk_bf16_f32 v134, v136, v137
    v_smfmac_f32_16x16x64_bf16 v[168:171], a[44:47], v[204:211], v17
    s_waitcnt vmcnt(5)
    buffer_load_dwordx4 v5, s[8:11], s88 offen offset:128 nt lds
    v_cvt_pk_bf16_f32 v135, v138, v139
    v_smfmac_f32_16x16x64_bf16 v[168:171], a[80:83], v[212:219], v21
    ds_read_b128 v[224:227], v2 offset:21504
    ds_read_b128 v[136:139], v9 offset:10432
    v_cndmask_b32_dpp v128, v124, v132, vcc row_ror:8 row_mask:0xf bank_mask:0xf
    v_smfmac_f32_16x16x64_bf16 v[184:187], a[24:27], v[196:203], v15
    ds_read_b128 v[228:231], v1 offset:22528
    v_cndmask_b32_dpp v129, v125, v133, vcc row_ror:8 row_mask:0xf bank_mask:0xf
    v_smfmac_f32_16x16x64_bf16 v[184:187], a[60:63], v[204:211], v19
    ds_read_b128 v[232:235], v2 offset:22528
    v_cndmask_b32_dpp v130, v126, v134, vcc row_ror:8 row_mask:0xf bank_mask:0xf
    v_smfmac_f32_16x16x64_bf16 v[184:187], a[96:99], v[212:219], v23
    s_waitcnt lgkmcnt(4)
    v_xad_u32 v236, v236, v3, v4
    v_smfmac_f32_16x16x64_bf16 v[184:187], v[240:243], v[244:251], v10 abid:1
    v_xad_u32 v237, v237, v3, v4
    v_smfmac_f32_16x16x64_bf16 v[148:151], v[240:243], v[244:251], v10
    ds_read2st64_b32 v[244:245], v236 offset0:0 offset1:72
    ds_read_b128 v[240:243], v8 offset:4096
    v_xad_u32 v238, v238, v3, v4
    v_smfmac_f32_16x16x64_bf16 v[188:191], a[28:31], v[196:203], v15 abid:1
    ds_read2st64_b32 v[246:247], v237 offset0:0 offset1:72
    v_xad_u32 v239, v239, v3, v4
    v_smfmac_f32_16x16x64_bf16 v[188:191], a[64:67], v[204:211], v19 abid:1
    ds_read2st64_b32 v[248:249], v238 offset0:0 offset1:72
    v_cndmask_b32_dpp v131, v127, v135, vcc row_ror:8 row_mask:0xf bank_mask:0xf
    v_smfmac_f32_16x16x64_bf16 v[188:191], a[100:103], v[212:219], v23 abid:1
    ds_read2st64_b32 v[250:251], v239 offset0:0 offset1:72
    s_waitcnt vmcnt(5)
    buffer_store_dwordx4 v[128:131], v6, s[12:15], s59 offen offset:0 sc1
    v_smfmac_f32_16x16x64_bf16 v[192:195], a[32:35], v[196:203], v48
    v_mov_b32_dpp v124, v132 row_ror:8 row_mask:0xf bank_mask:0xc
    v_smfmac_f32_16x16x64_bf16 v[192:195], a[68:71], v[204:211], v48 abid:1
    v_mov_b32_dpp v125, v133 row_ror:8 row_mask:0xf bank_mask:0xc
    v_smfmac_f32_16x16x64_bf16 v[192:195], a[104:107], v[212:219], v49
    s_waitcnt lgkmcnt(8)
    v_mov_b32_dpp v126, v134 row_ror:8 row_mask:0xf bank_mask:0xc
    v_smfmac_f32_16x16x64_bf16 v[160:163], a[108:111], v[220:227], v24
    s_waitcnt lgkmcnt(5)
    v_mov_b32_dpp v127, v135 row_ror:8 row_mask:0xf bank_mask:0xc
    v_smfmac_f32_16x16x64_bf16 v[160:163], a[144:147], v[228:235], v28
    ds_read_b128 v[196:199], v1 offset:23552
    s_waitcnt vmcnt(5)
    buffer_store_dwordx4 v[124:127], v6, s[12:15], s24 offen offset:0 sc1
    v_smfmac_f32_16x16x64_bf16 v[164:167], a[112:115], v[220:227], v24 abid:1
    ds_read_b128 v[200:203], v2 offset:23552
    ds_read_b128 v[128:131], v9 offset:10304
    ds_read_b128 v[132:135], v9 offset:10368
    v_smfmac_f32_16x16x64_bf16 v[164:167], a[148:151], v[228:235], v28 abid:1
    ds_read_b128 v[204:207], v1 offset:24576
    ds_read_b128 v[124:127], v9 offset:10240
    v_smfmac_f32_16x16x64_bf16 v[176:179], a[124:127], v[220:227], v26
    ds_read_b128 v[208:211], v2 offset:24576
    v_smfmac_f32_16x16x64_bf16 v[176:179], a[160:163], v[228:235], v30
    s_waitcnt lgkmcnt(7)
    v_smfmac_f32_16x16x64_bf16 v[176:179], v[240:243], v[244:251], v10 abid:1
    v_smfmac_f32_16x16x64_bf16 v[140:143], v[240:243], v[244:251], v10
    v_smfmac_f32_16x16x64_bf16 v[172:175], a[120:123], v[220:227], v25 abid:1
    s_add_u32 s28, s28, 36864
    s_cmp_ge_u32 s28, 110592
    s_cselect_b32 s28, s26, s28
    v_smfmac_f32_16x16x64_bf16 v[172:175], a[156:159], v[228:235], v29 abid:1
    s_add_u32 s30, s25, 36864
    s_cmp_eq_u32 s30, 110592
    s_cselect_b32 s30, 0, s30
    v_smfmac_f32_16x16x64_bf16 v[168:171], a[116:119], v[220:227], v25
    s_sub_u32 s31, s30, s25
    s_mov_b32 s25, s30
    s_mov_b32 s90, s22
    v_smfmac_f32_16x16x64_bf16 v[168:171], a[152:155], v[228:235], v29
    s_mov_b32 s22, s88
    s_add_u32 s91, s91, 1
    s_cmp_lt_u32 s20, 2
    v_smfmac_f32_16x16x64_bf16 v[180:183], a[128:131], v[220:227], v26 abid:1
    s_cselect_b32 s66, s23, s24
    s_add_u32 s66, s66, s95
    v_smfmac_f32_16x16x64_bf16 v[180:183], a[164:167], v[228:235], v30 abid:1
    v_cvt_pk_bf16_f32 v140, v140, v141
    v_smfmac_f32_16x16x64_bf16 v[184:187], a[132:135], v[220:227], v27
    s_add_u32 m0, m0, 896
    v_cvt_pk_bf16_f32 v141, v142, v143
    v_smfmac_f32_16x16x64_bf16 v[184:187], a[168:171], v[228:235], v31
    s_waitcnt vmcnt(5)
    buffer_load_dwordx4 v5, s[8:11], s88 offen offset:256 nt lds
    v_cvt_pk_bf16_f32 v142, v144, v145
    v_smfmac_f32_16x16x64_bf16 v[188:191], a[136:139], v[220:227], v27 abid:1
    v_cvt_pk_bf16_f32 v143, v146, v147
    v_smfmac_f32_16x16x64_bf16 v[188:191], a[172:175], v[228:235], v31 abid:1
    v_cvt_pk_bf16_f32 v148, v148, v149
    v_smfmac_f32_16x16x64_bf16 v[192:195], a[140:143], v[220:227], v49 abid:1
    v_cvt_pk_bf16_f32 v149, v150, v151
    v_smfmac_f32_16x16x64_bf16 v[192:195], a[176:179], v[228:235], v50
    ds_read_b128 v[220:223], v1 offset:25600
    s_waitcnt lgkmcnt(6)
    v_cvt_pk_bf16_f32 v150, v152, v153
    v_smfmac_f32_16x16x64_bf16 v[160:163], a[180:183], v[196:203], v32
    ds_read_b128 v[224:227], v2 offset:25600
    s_waitcnt lgkmcnt(2)
    v_cvt_pk_bf16_f32 v151, v154, v155
    v_smfmac_f32_16x16x64_bf16 v[160:163], a[216:219], v[204:211], v36
    ds_read_b128 v[228:231], v1 offset:26624
    ds_read_b128 v[152:155], v9 offset:10688
    v_cndmask_b32_dpp v144, v140, v148, vcc row_ror:8 row_mask:0xf bank_mask:0xf
    v_smfmac_f32_16x16x64_bf16 v[164:167], a[184:187], v[196:203], v32 abid:1
    ds_read_b128 v[232:235], v2 offset:26624
    v_cndmask_b32_dpp v145, v141, v149, vcc row_ror:8 row_mask:0xf bank_mask:0xf
    v_smfmac_f32_16x16x64_bf16 v[164:167], a[220:223], v[204:211], v36 abid:1
    s_add_u32 m0, m0, 896
    v_cndmask_b32_dpp v146, v142, v150, vcc row_ror:8 row_mask:0xf bank_mask:0xf
    v_smfmac_f32_16x16x64_bf16 v[168:171], a[188:191], v[196:203], v33
    s_waitcnt vmcnt(5)
    buffer_load_dwordx4 v5, s[8:11], s88 offen offset:384 nt lds
    v_cndmask_b32_dpp v147, v143, v151, vcc row_ror:8 row_mask:0xf bank_mask:0xf
    v_smfmac_f32_16x16x64_bf16 v[168:171], a[224:227], v[204:211], v37
    s_waitcnt vmcnt(5)
    buffer_store_dwordx4 v[144:147], v6, s[12:15], s59 offen offset:128 sc1
    v_mov_b32_dpp v140, v148 row_ror:8 row_mask:0xf bank_mask:0xc
    v_smfmac_f32_16x16x64_bf16 v[172:175], a[192:195], v[196:203], v33 abid:1
    v_mov_b32_dpp v141, v149 row_ror:8 row_mask:0xf bank_mask:0xc
    v_smfmac_f32_16x16x64_bf16 v[172:175], a[228:231], v[204:211], v37 abid:1
    v_mov_b32_dpp v142, v150 row_ror:8 row_mask:0xf bank_mask:0xc
    v_smfmac_f32_16x16x64_bf16 v[176:179], a[196:199], v[196:203], v34
    v_mov_b32_dpp v143, v151 row_ror:8 row_mask:0xf bank_mask:0xc
    v_smfmac_f32_16x16x64_bf16 v[176:179], a[232:235], v[204:211], v38
    s_waitcnt vmcnt(5)
    buffer_store_dwordx4 v[140:143], v6, s[12:15], s24 offen offset:128 sc1
    ds_read_b128 v[144:147], v9 offset:10560
    v_smfmac_f32_16x16x64_bf16 v[180:183], a[200:203], v[196:203], v34 abid:1
    ds_read_b128 v[148:151], v9 offset:10624
    ds_read_b128 v[140:143], v9 offset:10496
    v_add_u32 v4, s31, v4
    v_smfmac_f32_16x16x64_bf16 v[180:183], a[236:239], v[204:211], v38 abid:1
    v_add_u32 v1, s31, v1
    v_smfmac_f32_16x16x64_bf16 v[184:187], a[204:207], v[196:203], v35
    v_add_u32 v2, s31, v2
    v_smfmac_f32_16x16x64_bf16 v[184:187], a[240:243], v[204:211], v39
    v_smfmac_f32_16x16x64_bf16 v[188:191], a[208:211], v[196:203], v35 abid:1
    v_smfmac_f32_16x16x64_bf16 v[188:191], a[244:247], v[204:211], v39 abid:1
    v_smfmac_f32_16x16x64_bf16 v[192:195], a[212:215], v[196:203], v50 abid:1
    v_smfmac_f32_16x16x64_bf16 v[192:195], a[248:251], v[204:211], v51
    s_waitcnt vmcnt(8)
    s_branch M_top1
M_q:
    s_mov_b32 s21, 3
    v_smfmac_f32_16x16x64_bf16 v[148:151], v[112:115], v[228:235], v47
    v_smfmac_f32_16x16x64_bf16 v[152:155], v[80:83], v[220:227], v43 abid:1
    v_smfmac_f32_16x16x64_bf16 v[152:155], v[116:119], v[228:235], v47 abid:1
    s_waitcnt lgkmcnt(2)
    v_xad_u32 v236, v236, v3, v4
    v_smfmac_f32_16x16x64_bf16 v[152:155], v[240:243], v[244:251], v10
    v_xad_u32 v237, v237, v3, v4
    v_smfmac_f32_16x16x64_bf16 v[188:191], v[240:243], v[244:251], v10 abid:1
    s_cmp_gt_u32 s46, s80
    s_cbranch_scc1 M_slow
M_slowrQ:
    v_xad_u32 v238, v238, v3, v4
    v_smfmac_f32_16x16x64_bf16 v[128:131], v[56:59], v[220:227], v40 abid:1
    ds_read2st64_b32 v[244:245], v236 offset0:0 offset1:72
    ds_read_b128 v[240:243], v8 offset:5120
    v_xad_u32 v239, v239, v3, v4
    v_smfmac_f32_16x16x64_bf16 v[128:131], v[92:95], v[228:235], v44 abid:1
    ds_read2st64_b32 v[246:247], v237 offset0:0 offset1:72
    v_smfmac_f32_16x16x64_bf16 v[160:163], a[0:3], v[196:203], v12
    ds_read2st64_b32 v[248:249], v238 offset0:0 offset1:72
    v_smfmac_f32_16x16x64_bf16 v[160:163], a[36:39], v[204:211], v16
    ds_read2st64_b32 v[250:251], v239 offset0:0 offset1:72
    ds_read_b128 v[236:239], v9 offset:9600
    s_waitcnt lgkmcnt(6)
    v_smfmac_f32_16x16x64_bf16 v[160:163], a[72:75], v[212:219], v20
    v_smfmac_f32_16x16x64_bf16 v[164:167], a[4:7], v[196:203], v12 abid:1
    v_cvt_pk_bf16_f32 v156, v156, v157
    v_smfmac_f32_16x16x64_bf16 v[164:167], a[40:43], v[204:211], v16 abid:1
    v_cvt_pk_bf16_f32 v157, v158, v159
    v_smfmac_f32_16x16x64_bf16 v[164:167], a[76:79], v[212:219], v20 abid:1
    ds_write_b64 v53, v[156:157] offset:25728
    ds_read_b128 v[156:159], v9 offset:10752
    v_smfmac_f32_16x16x64_bf16 v[180:183], a[20:23], v[196:203], v14 abid:1
    v_smfmac_f32_16x16x64_bf16 v[180:183], a[56:59], v[204:211], v18 abid:1
    ds_read_b128 v[220:223], v1 offset:21504
    v_cvt_pk_bf16_f32 v124, v124, v125
    v_smfmac_f32_16x16x64_bf16 v[180:183], a[92:95], v[212:219], v22 abid:1
    s_waitcnt lgkmcnt(3)
    v_xad_u32 v236, v236, v3, v4
    v_smfmac_f32_16x16x64_bf16 v[180:183], v[240:243], v[244:251], v10 abid:1
    v_xad_u32 v237, v237, v3, v4
    v_smfmac_f32_16x16x64_bf16 v[144:147], v[240:243], v[244:251], v10
    ds_read2st64_b32 v[244:245], v236 offset0:0 offset1:72
    ds_read_b128 v[240:243], v8 offset:6144
    v_xad_u32 v238, v238, v3, v4
    v_smfmac_f32_16x16x64_bf16 v[172:175], a[12:15], v[196:203], v13 abid:1
    ds_read2st64_b32 v[246:247], v237 offset0:0 offset1:72
    v_xad_u32 v239, v239, v3, v4
    v_smfmac_f32_16x16x64_bf16 v[172:175], a[48:51], v[204:211], v17 abid:1
    ds_read2st64_b32 v[248:249], v238 offset0:0 offset1:72
    v_cvt_pk_bf16_f32 v125, v126, v127
    v_smfmac_f32_16x16x64_bf16 v[172:175], a[84:87], v[212:219], v21 abid:1
    ds_read2st64_b32 v[250:251], v239 offset0:0 offset1:72
    ds_read_b128 v[236:239], v9 offset:9472
    v_cvt_pk_bf16_f32 v126, v128, v129
    v_smfmac_f32_16x16x64_bf16 v[176:179], a[16:19], v[196:203], v14
    v_cvt_pk_bf16_f32 v127, v130, v131
    v_smfmac_f32_16x16x64_bf16 v[176:179], a[52:55], v[204:211], v18
    v_cvt_pk_bf16_f32 v132, v132, v133
    v_smfmac_f32_16x16x64_bf16 v[176:179], a[88:91], v[212:219], v22
    v_cvt_pk_bf16_f32 v133, v134, v135
    v_smfmac_f32_16x16x64_bf16 v[168:171], a[8:11], v[196:203], v13
    v_cvt_pk_bf16_f32 v134, v136, v137
    v_smfmac_f32_16x16x64_bf16 v[168:171], a[44:47], v[204:211], v17
    v_cvt_pk_bf16_f32 v135, v138, v139
    v_smfmac_f32_16x16x64_bf16 v[168:171], a[80:83], v[212:219], v21
    ds_read_b128 v[224:227], v2 offset:21504
    ds_read_b128 v[136:139], v9 offset:10432
    v_cndmask_b32_dpp v128, v124, v132, vcc row_ror:8 row_mask:0xf bank_mask:0xf
    v_smfmac_f32_16x16x64_bf16 v[184:187], a[24:27], v[196:203], v15
    ds_read_b128 v[228:231], v1 offset:22528
    v_cndmask_b32_dpp v129, v125, v133, vcc row_ror:8 row_mask:0xf bank_mask:0xf
    v_smfmac_f32_16x16x64_bf16 v[184:187], a[60:63], v[204:211], v19
    ds_read_b128 v[232:235], v2 offset:22528
    v_cndmask_b32_dpp v130, v126, v134, vcc row_ror:8 row_mask:0xf bank_mask:0xf
    v_smfmac_f32_16x16x64_bf16 v[184:187], a[96:99], v[212:219], v23
    s_waitcnt lgkmcnt(4)
    v_xad_u32 v236, v236, v3, v4
    v_smfmac_f32_16x16x64_bf16 v[184:187], v[240:243], v[244:251], v10 abid:1
    v_xad_u32 v237, v237, v3, v4
    v_smfmac_f32_16x16x64_bf16 v[148:151], v[240:243], v[244:251], v10
    ds_read2st64_b32 v[244:245], v236 offset0:0 offset1:72
    ds_read_b128 v[240:243], v8 offset:4096
    v_xad_u32 v238, v238, v3, v4
    v_smfmac_f32_16x16x64_bf16 v[188:191], a[28:31], v[196:203], v15 abid:1
    ds_read2st64_b32 v[246:247], v237 offset0:0 offset1:72
    v_xad_u32 v239, v239, v3, v4
    v_smfmac_f32_16x16x64_bf16 v[188:191], a[64:67], v[204:211], v19 abid:1
    ds_read2st64_b32 v[248:249], v238 offset0:0 offset1:72
    v_cndmask_b32_dpp v131, v127, v135, vcc row_ror:8 row_mask:0xf bank_mask:0xf
    v_smfmac_f32_16x16x64_bf16 v[188:191], a[100:103], v[212:219], v23 abid:1
    ds_read2st64_b32 v[250:251], v239 offset0:0 offset1:72
    buffer_store_dwordx4 v[128:131], v6, s[12:15], s59 offen offset:0 sc1
    v_smfmac_f32_16x16x64_bf16 v[192:195], a[32:35], v[196:203], v48
    v_mov_b32_dpp v124, v132 row_ror:8 row_mask:0xf bank_mask:0xc
    v_smfmac_f32_16x16x64_bf16 v[192:195], a[68:71], v[204:211], v48 abid:1
    v_mov_b32_dpp v125, v133 row_ror:8 row_mask:0xf bank_mask:0xc
    v_smfmac_f32_16x16x64_bf16 v[192:195], a[104:107], v[212:219], v49
    s_waitcnt lgkmcnt(8)
    v_mov_b32_dpp v126, v134 row_ror:8 row_mask:0xf bank_mask:0xc
    v_smfmac_f32_16x16x64_bf16 v[160:163], a[108:111], v[220:227], v24
    s_waitcnt lgkmcnt(5)
    v_mov_b32_dpp v127, v135 row_ror:8 row_mask:0xf bank_mask:0xc
    v_smfmac_f32_16x16x64_bf16 v[160:163], a[144:147], v[228:235], v28
    ds_read_b128 v[196:199], v1 offset:23552
    buffer_store_dwordx4 v[124:127], v6, s[12:15], s24 offen offset:0 sc1
    v_smfmac_f32_16x16x64_bf16 v[164:167], a[112:115], v[220:227], v24 abid:1
    ds_read_b128 v[200:203], v2 offset:23552
    ds_read_b128 v[128:131], v9 offset:10304
    ds_read_b128 v[132:135], v9 offset:10368
    v_smfmac_f32_16x16x64_bf16 v[164:167], a[148:151], v[228:235], v28 abid:1
    ds_read_b128 v[204:207], v1 offset:24576
    ds_read_b128 v[124:127], v9 offset:10240
    v_smfmac_f32_16x16x64_bf16 v[176:179], a[124:127], v[220:227], v26
    ds_read_b128 v[208:211], v2 offset:24576
    v_smfmac_f32_16x16x64_bf16 v[176:179], a[160:163], v[228:235], v30
    s_waitcnt lgkmcnt(7)
    v_smfmac_f32_16x16x64_bf16 v[176:179], v[240:243], v[244:251], v10 abid:1
    v_smfmac_f32_16x16x64_bf16 v[140:143], v[240:243], v[244:251], v10
    v_smfmac_f32_16x16x64_bf16 v[172:175], a[120:123], v[220:227], v25 abid:1
    s_add_u32 s28, s28, 36864
    s_cmp_ge_u32 s28, 110592
    s_cselect_b32 s28, s26, s28
    v_smfmac_f32_16x16x64_bf16 v[172:175], a[156:159], v[228:235], v29 abid:1
    s_add_u32 s30, s25, 36864
    s_cmp_eq_u32 s30, 110592
    s_cselect_b32 s30, 0, s30
    v_smfmac_f32_16x16x64_bf16 v[168:171], a[116:119], v[220:227], v25
    s_sub_u32 s31, s30, s25
    s_mov_b32 s25, s30
    s_mov_b32 s90, s22
    v_smfmac_f32_16x16x64_bf16 v[168:171], a[152:155], v[228:235], v29
    s_mov_b32 s22, s88
    s_add_u32 s91, s91, 1
    s_cmp_lt_u32 s20, 2
    v_smfmac_f32_16x16x64_bf16 v[180:183], a[128:131], v[220:227], v26 abid:1
    s_cselect_b32 s66, s23, s24
    s_add_u32 s66, s66, s95
    v_smfmac_f32_16x16x64_bf16 v[180:183], a[164:167], v[228:235], v30 abid:1
    v_cvt_pk_bf16_f32 v140, v140, v141
    v_smfmac_f32_16x16x64_bf16 v[184:187], a[132:135], v[220:227], v27
    v_cvt_pk_bf16_f32 v141, v142, v143
    v_smfmac_f32_16x16x64_bf16 v[184:187], a[168:171], v[228:235], v31
    v_cvt_pk_bf16_f32 v142, v144, v145
    v_smfmac_f32_16x16x64_bf16 v[188:191], a[136:139], v[220:227], v27 abid:1
    v_cvt_pk_bf16_f32 v143, v146, v147
    v_smfmac_f32_16x16x64_bf16 v[188:191], a[172:175], v[228:235], v31 abid:1
    v_cvt_pk_bf16_f32 v148, v148, v149
    v_smfmac_f32_16x16x64_bf16 v[192:195], a[140:143], v[220:227], v49 abid:1
    v_cvt_pk_bf16_f32 v149, v150, v151
    v_smfmac_f32_16x16x64_bf16 v[192:195], a[176:179], v[228:235], v50
    ds_read_b128 v[220:223], v1 offset:25600
    s_waitcnt lgkmcnt(6)
    v_cvt_pk_bf16_f32 v150, v152, v153
    v_smfmac_f32_16x16x64_bf16 v[160:163], a[180:183], v[196:203], v32
    ds_read_b128 v[224:227], v2 offset:25600
    s_waitcnt lgkmcnt(2)
    v_cvt_pk_bf16_f32 v151, v154, v155
    v_smfmac_f32_16x16x64_bf16 v[160:163], a[216:219], v[204:211], v36
    ds_read_b128 v[228:231], v1 offset:26624
    ds_read_b128 v[152:155], v9 offset:10688
    v_cndmask_b32_dpp v144, v140, v148, vcc row_ror:8 row_mask:0xf bank_mask:0xf
    v_smfmac_f32_16x16x64_bf16 v[164:167], a[184:187], v[196:203], v32 abid:1
    ds_read_b128 v[232:235], v2 offset:26624
    v_cndmask_b32_dpp v145, v141, v149, vcc row_ror:8 row_mask:0xf bank_mask:0xf
    v_smfmac_f32_16x16x64_bf16 v[164:167], a[220:223], v[204:211], v36 abid:1
    v_cndmask_b32_dpp v146, v142, v150, vcc row_ror:8 row_mask:0xf bank_mask:0xf
    v_smfmac_f32_16x16x64_bf16 v[168:171], a[188:191], v[196:203], v33
    v_cndmask_b32_dpp v147, v143, v151, vcc row_ror:8 row_mask:0xf bank_mask:0xf
    v_smfmac_f32_16x16x64_bf16 v[168:171], a[224:227], v[204:211], v37
    buffer_store_dwordx4 v[144:147], v6, s[12:15], s59 offen offset:128 sc1
    v_mov_b32_dpp v140, v148 row_ror:8 row_mask:0xf bank_mask:0xc
    v_smfmac_f32_16x16x64_bf16 v[172:175], a[192:195], v[196:203], v33 abid:1
    v_mov_b32_dpp v141, v149 row_ror:8 row_mask:0xf bank_mask:0xc
    v_smfmac_f32_16x16x64_bf16 v[172:175], a[228:231], v[204:211], v37 abid:1
    v_mov_b32_dpp v142, v150 row_ror:8 row_mask:0xf bank_mask:0xc
    v_smfmac_f32_16x16x64_bf16 v[176:179], a[196:199], v[196:203], v34
    v_mov_b32_dpp v143, v151 row_ror:8 row_mask:0xf bank_mask:0xc
    v_smfmac_f32_16x16x64_bf16 v[176:179], a[232:235], v[204:211], v38
    buffer_store_dwordx4 v[140:143], v6, s[12:15], s24 offen offset:128 sc1
    ds_read_b128 v[144:147], v9 offset:10560
    v_smfmac_f32_16x16x64_bf16 v[180:183], a[200:203], v[196:203], v34 abid:1
    ds_read_b128 v[148:151], v9 offset:10624
    ds_read_b128 v[140:143], v9 offset:10496
    v_add_u32 v4, s31, v4
    v_smfmac_f32_16x16x64_bf16 v[180:183], a[236:239], v[204:211], v38 abid:1
    v_add_u32 v1, s31, v1
    v_smfmac_f32_16x16x64_bf16 v[184:187], a[204:207], v[196:203], v35
    v_add_u32 v2, s31, v2
    v_smfmac_f32_16x16x64_bf16 v[184:187], a[240:243], v[204:211], v39
    v_smfmac_f32_16x16x64_bf16 v[188:191], a[208:211], v[196:203], v35 abid:1
    v_smfmac_f32_16x16x64_bf16 v[188:191], a[244:247], v[204:211], v39 abid:1
    v_smfmac_f32_16x16x64_bf16 v[192:195], a[212:215], v[196:203], v50 abid:1
    v_smfmac_f32_16x16x64_bf16 v[192:195], a[248:251], v[204:211], v51
    s_waitcnt vmcnt(4)
    s_branch M_top1
M_bH:
    v_smfmac_f32_16x16x64_bf16 v[164:167], v[56:59], v[220:227], v40 abid:1
    ds_read_b128 v[204:207], v1 offset:1024
    ds_read_b128 v[236:239], v9 offset:9728
    v_smfmac_f32_16x16x64_bf16 v[164:167], v[92:95], v[228:235], v44 abid:1
    ds_read_b128 v[208:211], v2 offset:1024
    v_smfmac_f32_16x16x64_bf16 v[168:171], v[60:63], v[220:227], v41
    ds_read_b128 v[212:215], v1 offset:2048
    v_smfmac_f32_16x16x64_bf16 v[168:171], v[96:99], v[228:235], v45
    ds_read_b128 v[216:219], v2 offset:2048
    s_waitcnt lgkmcnt(7)
    buffer_store_dwordx4 v[244:247], v7, s[12:15], s66 offen sc1
    v_smfmac_f32_16x16x64_bf16 v[172:175], v[64:67], v[220:227], v41 abid:1
    s_mov_b32 s21, 5
    s_barrier
    v_smfmac_f32_16x16x64_bf16 v[172:175], v[100:103], v[228:235], v45 abid:1
    s_cmp_lt_u32 s20, 2
    s_cselect_b32 s66, s23, s24
    s_add_u32 s66, s66, s95
    s_waitcnt lgkmcnt(3)
    v_xad_u32 v236, v236, v3, v4
    v_smfmac_f32_16x16x64_bf16 v[176:179], v[68:71], v[220:227], v42
    ds_read_b32 v244, v236
    ds_read_b128 v[240:243], v8 offset:8192
    v_xad_u32 v237, v237, v3, v4
    v_smfmac_f32_16x16x64_bf16 v[176:179], v[104:107], v[228:235], v46
    ds_read_b32 v246, v237
    v_xad_u32 v238, v238, v3, v4
    v_smfmac_f32_16x16x64_bf16 v[180:183], v[72:75], v[220:227], v42 abid:1
    ds_read_b32 v248, v238
    v_xad_u32 v239, v239, v3, v4
    v_smfmac_f32_16x16x64_bf16 v[180:183], v[108:111], v[228:235], v46 abid:1
    ds_read_b32 v250, v239
    ds_read_b128 v[236:239], v9 offset:9216
    v_cvt_pk_bf16_f32 v160, v160, v161
    v_smfmac_f32_16x16x64_bf16 v[184:187], v[76:79], v[220:227], v43
    v_cvt_pk_bf16_f32 v161, v162, v163
    v_smfmac_f32_16x16x64_bf16 v[184:187], v[112:115], v[228:235], v47
    v_cvt_pk_bf16_f32 v162, v164, v165
    v_smfmac_f32_16x16x64_bf16 v[188:191], v[80:83], v[220:227], v43 abid:1
    v_cvt_pk_bf16_f32 v163, v166, v167
    v_smfmac_f32_16x16x64_bf16 v[188:191], v[116:119], v[228:235], v47 abid:1
    v_cvt_pk_bf16_f32 v168, v168, v169
    v_smfmac_f32_16x16x64_bf16 v[192:195], v[84:87], v[220:227], v51 abid:1
    v_cvt_pk_bf16_f32 v169, v170, v171
    v_smfmac_f32_16x16x64_bf16 v[192:195], v[120:123], v[228:235], v52
    ds_read_b128 v[220:223], v1 offset:3072
    s_waitcnt lgkmcnt(1)
    v_xad_u32 v236, v236, v3, v4
    v_smfmac_f32_16x16x64_bf16 v[156:159], v[240:243], v[244:251], v10
    ds_read_b32 v244, v236
    ds_read_b128 v[240:243], v8 offset:0
    v_xad_u32 v237, v237, v3, v4
    v_smfmac_f32_16x16x64_bf16 v[156:159], a[32:35], v[196:203], v48
    ds_read_b32 v246, v237
    ds_read_b128 v[224:227], v2 offset:3072
    v_xad_u32 v238, v238, v3, v4
    v_smfmac_f32_16x16x64_bf16 v[156:159], a[68:71], v[204:211], v48 abid:1
    ds_read_b32 v248, v238
    ds_read_b128 v[228:231], v1 offset:4096
    v_xad_u32 v239, v239, v3, v4
    v_smfmac_f32_16x16x64_bf16 v[156:159], a[104:107], v[212:219], v49
    ds_read_b32 v250, v239
    ds_read_b128 v[236:239], v9 offset:9280
    ds_read_b128 v[232:235], v2 offset:4096
    v_smfmac_f32_16x16x64_bf16 v[124:127], a[0:3], v[196:203], v12
    v_cvt_pk_bf16_f32 v170, v172, v173
    v_smfmac_f32_16x16x64_bf16 v[124:127], a[36:39], v[204:211], v16
    v_cvt_pk_bf16_f32 v192, v192, v193
    v_smfmac_f32_16x16x64_bf16 v[124:127], a[72:75], v[212:219], v20
    v_cvt_pk_bf16_f32 v193, v194, v195
    v_smfmac_f32_16x16x64_bf16 v[128:131], a[4:7], v[196:203], v12 abid:1
    ds_write_b64 v53, v[192:193] offset:0
    v_cvt_pk_bf16_f32 v171, v174, v175
    v_smfmac_f32_16x16x64_bf16 v[128:131], a[40:43], v[204:211], v16 abid:1
    v_cndmask_b32_dpp v164, v160, v168, vcc row_ror:8 row_mask:0xf bank_mask:0xf
    v_smfmac_f32_16x16x64_bf16 v[128:131], a[76:79], v[212:219], v20 abid:1
    s_waitcnt lgkmcnt(2)
    v_xad_u32 v236, v236, v3, v4
    v_smfmac_f32_16x16x64_bf16 v[124:127], v[240:243], v[244:251], v10
    ds_read_b32 v244, v236
    ds_read_b128 v[240:243], v8 offset:1024
    v_xad_u32 v237, v237, v3, v4
    v_smfmac_f32_16x16x64_bf16 v[132:135], a[8:11], v[196:203], v13
    ds_read_b32 v246, v237
    v_xad_u32 v238, v238, v3, v4
    v_smfmac_f32_16x16x64_bf16 v[132:135], a[44:47], v[204:211], v17
    ds_read_b32 v248, v238
    v_xad_u32 v239, v239, v3, v4
    v_smfmac_f32_16x16x64_bf16 v[132:135], a[80:83], v[212:219], v21
    ds_read_b32 v250, v239
    ds_read_b128 v[236:239], v9 offset:9344
    v_cndmask_b32_dpp v165, v161, v169, vcc row_ror:8 row_mask:0xf bank_mask:0xf
    v_smfmac_f32_16x16x64_bf16 v[136:139], a[12:15], v[196:203], v13 abid:1
    v_cndmask_b32_dpp v166, v162, v170, vcc row_ror:8 row_mask:0xf bank_mask:0xf
    v_smfmac_f32_16x16x64_bf16 v[136:139], a[48:51], v[204:211], v17 abid:1
    v_cndmask_b32_dpp v167, v163, v171, vcc row_ror:8 row_mask:0xf bank_mask:0xf
    v_smfmac_f32_16x16x64_bf16 v[136:139], a[84:87], v[212:219], v21 abid:1
    ds_read_b128 v[196:199], v1 offset:5120
    buffer_store_dwordx4 v[164:167], v6, s[12:15], s58 offen offset:0 sc1
    v_mov_b32_dpp v160, v168 row_ror:8 row_mask:0xf bank_mask:0xc
    v_smfmac_f32_16x16x64_bf16 v[156:159], a[140:143], v[220:227], v49 abid:1
    ds_read_b128 v[200:203], v2 offset:5120
    ds_read_b64 v[216:217], v9 offset:10056
    s_waitcnt lgkmcnt(10)
    v_mov_b32_dpp v161, v169 row_ror:8 row_mask:0xf bank_mask:0xc
    v_smfmac_f32_16x16x64_bf16 v[156:159], a[176:179], v[228:235], v50
    ds_read_b128 v[204:207], v1 offset:6144
    s_waitcnt lgkmcnt(4)
    v_xad_u32 v236, v236, v3, v4
    v_smfmac_f32_16x16x64_bf16 v[128:131], v[240:243], v[244:251], v10
    ds_read_b32 v244, v236
    ds_read_b128 v[240:243], v8 offset:2048
    v_xad_u32 v237, v237, v3, v4
    v_smfmac_f32_16x16x64_bf16 v[124:127], a[108:111], v[220:227], v24
    ds_read_b32 v246, v237
    ds_read_b128 v[208:211], v2 offset:6144
    v_xad_u32 v238, v238, v3, v4
    v_smfmac_f32_16x16x64_bf16 v[124:127], a[144:147], v[228:235], v28
    ds_read_b32 v248, v238
    v_xad_u32 v239, v239, v3, v4
    v_smfmac_f32_16x16x64_bf16 v[128:131], a[112:115], v[220:227], v24 abid:1
    ds_read_b32 v250, v239
    ds_read_b128 v[236:239], v9 offset:9408
    s_waitcnt lgkmcnt(8)
    v_xad_u32 v212, v216, v3, v4
    v_smfmac_f32_16x16x64_bf16 v[128:131], a[148:151], v[228:235], v28 abid:1
    ds_read2st64_b32 v[212:213], v212 offset0:0 offset1:72
    v_xad_u32 v214, v217, v3, v4
    v_smfmac_f32_16x16x64_bf16 v[132:135], a[116:119], v[220:227], v25
    ds_read2st64_b32 v[214:215], v214 offset0:0 offset1:72
    v_mov_b32_dpp v162, v170 row_ror:8 row_mask:0xf bank_mask:0xc
    v_smfmac_f32_16x16x64_bf16 v[132:135], a[152:155], v[228:235], v29
    v_mov_b32_dpp v163, v171 row_ror:8 row_mask:0xf bank_mask:0xc
    v_smfmac_f32_16x16x64_bf16 v[136:139], a[120:123], v[220:227], v25 abid:1
    buffer_store_dwordx4 v[160:163], v6, s[12:15], s23 offen offset:0 sc1
    v_cvt_pk_bf16_f32 v176, v176, v177
    v_smfmac_f32_16x16x64_bf16 v[136:139], a[156:159], v[228:235], v29 abid:1
    ds_read_b128 v[220:223], v1 offset:7168
    v_cvt_pk_bf16_f32 v177, v178, v179
    v_smfmac_f32_16x16x64_bf16 v[156:159], a[212:215], v[196:203], v50 abid:1
    ds_read_b128 v[224:227], v2 offset:7168
    s_waitcnt lgkmcnt(7)
    v_cvt_pk_bf16_f32 v178, v180, v181
    v_smfmac_f32_16x16x64_bf16 v[156:159], a[248:251], v[204:211], v51
    ds_read_b128 v[228:231], v1 offset:8192
    s_waitcnt lgkmcnt(5)
    v_xad_u32 v236, v236, v3, v4
    v_smfmac_f32_16x16x64_bf16 v[132:135], v[240:243], v[244:251], v10
    ds_read_b32 v244, v236
    ds_read_b128 v[240:243], v8 offset:3072
    v_xad_u32 v237, v237, v3, v4
    v_smfmac_f32_16x16x64_bf16 v[124:127], a[180:183], v[196:203], v32
    ds_read_b32 v246, v237
    ds_read_b128 v[232:235], v2 offset:8192
    v_xad_u32 v238, v238, v3, v4
    v_smfmac_f32_16x16x64_bf16 v[124:127], a[216:219], v[204:211], v36
    ds_read_b32 v248, v238
    v_xad_u32 v239, v239, v3, v4
    v_smfmac_f32_16x16x64_bf16 v[128:131], a[184:187], v[196:203], v32 abid:1
    ds_read_b32 v250, v239
    ds_read_b128 v[236:239], v9 offset:9472
    v_cvt_pk_bf16_f32 v179, v182, v183
    v_smfmac_f32_16x16x64_bf16 v[128:131], a[220:223], v[204:211], v36 abid:1
    v_cvt_pk_bf16_f32 v184, v184, v185
    v_smfmac_f32_16x16x64_bf16 v[132:135], a[188:191], v[196:203], v33
    v_cvt_pk_bf16_f32 v185, v186, v187
    v_smfmac_f32_16x16x64_bf16 v[132:135], a[224:227], v[204:211], v37
    v_cvt_pk_bf16_f32 v186, v188, v189
    v_smfmac_f32_16x16x64_bf16 v[136:139], a[192:195], v[196:203], v33 abid:1
    v_cvt_pk_bf16_f32 v187, v190, v191
    v_smfmac_f32_16x16x64_bf16 v[136:139], a[228:231], v[204:211], v37 abid:1
    ds_read_b128 v[196:199], v1 offset:0
    s_waitcnt lgkmcnt(1)
    v_xad_u32 v236, v236, v3, v4
    v_smfmac_f32_16x16x64_bf16 v[136:139], v[240:243], v[244:251], v10
    ds_read_b32 v244, v236
    ds_read_b128 v[240:243], v8 offset:4096
    v_xad_u32 v237, v237, v3, v4
    v_smfmac_f32_16x16x64_bf16 v[156:159], v[84:87], v[220:227], v51 abid:1
    ds_read_b32 v246, v237
    ds_read_b128 v[200:203], v2 offset:0
    v_xad_u32 v238, v238, v3, v4
    v_smfmac_f32_16x16x64_bf16 v[156:159], v[120:123], v[228:235], v52
    ds_read_b32 v248, v238
    ds_read_b128 v[204:207], v1 offset:1024
    v_xad_u32 v239, v239, v3, v4
    v_smfmac_f32_16x16x64_bf16 v[124:127], a[252:255], v[220:227], v40
    ds_read_b32 v250, v239
    ds_read_b128 v[236:239], v9 offset:9536
    ds_read_b128 v[208:211], v2 offset:1024
    v_smfmac_f32_16x16x64_bf16 v[124:127], v[88:91], v[228:235], v44
    v_cndmask_b32_dpp v180, v176, v184, vcc row_ror:8 row_mask:0xf bank_mask:0xf
    v_smfmac_f32_16x16x64_bf16 v[128:131], v[56:59], v[220:227], v40 abid:1
    v_cndmask_b32_dpp v181, v177, v185, vcc row_ror:8 row_mask:0xf bank_mask:0xf
    v_smfmac_f32_16x16x64_bf16 v[128:131], v[92:95], v[228:235], v44 abid:1
    v_cndmask_b32_dpp v182, v178, v186, vcc row_ror:8 row_mask:0xf bank_mask:0xf
    v_smfmac_f32_16x16x64_bf16 v[132:135], v[60:63], v[220:227], v41
    v_cndmask_b32_dpp v183, v179, v187, vcc row_ror:8 row_mask:0xf bank_mask:0xf
    v_smfmac_f32_16x16x64_bf16 v[132:135], v[96:99], v[228:235], v45
    buffer_store_dwordx4 v[180:183], v6, s[12:15], s58 offen offset:128 sc1
    v_mov_b32_dpp v176, v184 row_ror:8 row_mask:0xf bank_mask:0xc
    v_smfmac_f32_16x16x64_bf16 v[136:139], v[64:67], v[220:227], v41 abid:1
    v_mov_b32_dpp v177, v185 row_ror:8 row_mask:0xf bank_mask:0xc
    v_smfmac_f32_16x16x64_bf16 v[136:139], v[100:103], v[228:235], v45 abid:1
    ds_read_b128 v[220:223], v1 offset:2048
    s_waitcnt lgkmcnt(2)
    v_xad_u32 v236, v236, v3, v4
    v_smfmac_f32_16x16x64_bf16 v[140:143], v[240:243], v[244:251], v10
    ds_read_b32 v244, v236
    ds_read_b128 v[240:243], v8 offset:5120
    v_xad_u32 v237, v237, v3, v4
    v_smfmac_f32_16x16x64_bf16 v[140:143], a[16:19], v[196:203], v14
    ds_read_b32 v246, v237
    ds_read_b128 v[224:227], v2 offset:2048
    s_waitcnt lgkmcnt(5)
    v_xad_u32 v238, v238, v3, v4
    v_smfmac_f32_16x16x64_bf16 v[140:143], a[52:55], v[204:211], v18
    ds_read_b32 v248, v238
    ds_read_b128 v[228:231], v1 offset:3072
    v_xad_u32 v239, v239, v3, v4
    v_smfmac_f32_16x16x64_bf16 v[144:147], a[20:23], v[196:203], v14 abid:1
    ds_read_b32 v250, v239
    ds_read_b128 v[236:239], v9 offset:9600
    ds_read_b128 v[232:235], v2 offset:3072
    v_smfmac_f32_16x16x64_bf16 v[144:147], a[56:59], v[204:211], v18 abid:1
    v_mov_b32_dpp v178, v186 row_ror:8 row_mask:0xf bank_mask:0xc
    v_smfmac_f32_16x16x64_bf16 v[148:151], a[24:27], v[196:203], v15
    v_mov_b32_dpp v179, v187 row_ror:8 row_mask:0xf bank_mask:0xc
    v_smfmac_f32_16x16x64_bf16 v[148:151], a[60:63], v[204:211], v19
    buffer_store_dwordx4 v[176:179], v6, s[12:15], s23 offen offset:128 sc1
    v_smfmac_f32_16x16x64_bf16 v[152:155], a[28:31], v[196:203], v15 abid:1
    s_cmp_lt_i32 s81, 0
    s_cbranch_scc1 M_ovrH
    s_swappc_b64 s[78:79], s[72:73]
M_ovrH:
    v_smfmac_f32_16x16x64_bf16 v[152:155], a[64:67], v[204:211], v19 abid:1
    ds_read_b128 v[196:199], v1 offset:4096
    s_waitcnt lgkmcnt(2)
    v_xad_u32 v236, v236, v3, v4
    v_smfmac_f32_16x16x64_bf16 v[144:147], v[240:243], v[244:251], v10
    s_cmp_gt_u32 s46, s80
    s_cbranch_scc1 M_slow
M_slowrH:
    ds_read_b32 v244, v236
    v_smfmac_f32_16x16x64_bf16 v[140:143], a[88:91], v[220:227], v22
    ds_read_b128 v[240:243], v8 offset:6144
    ds_read_b128 v[200:203], v2 offset:4096
    s_waitcnt lgkmcnt(4)
    v_xad_u32 v237, v237, v3, v4
    v_smfmac_f32_16x16x64_bf16 v[140:143], a[124:127], v[228:235], v26
    ds_read_b32 v246, v237
    ds_read_b128 v[204:207], v1 offset:5120
    v_xad_u32 v238, v238, v3, v4
    v_smfmac_f32_16x16x64_bf16 v[144:147], a[92:95], v[220:227], v22 abid:1
    ds_read_b32 v248, v238
    ds_read_b128 v[208:211], v2 offset:5120
    v_xad_u32 v239, v239, v3, v4
    v_smfmac_f32_16x16x64_bf16 v[144:147], a[128:131], v[228:235], v26 abid:1
    ds_read_b32 v250, v239
    ds_read_b128 v[236:239], v9 offset:9664
    ds_read_b128 v[212:215], v1 offset:8192
    v_smfmac_f32_16x16x64_bf16 v[148:151], a[96:99], v[220:227], v23
    ds_read_b128 v[216:219], v2 offset:8192
    v_cvt_pk_bf16_f32 v156, v156, v157
    v_smfmac_f32_16x16x64_bf16 v[148:151], a[132:135], v[228:235], v27
    v_cvt_pk_bf16_f32 v157, v158, v159
    v_smfmac_f32_16x16x64_bf16 v[152:155], a[100:103], v[220:227], v23 abid:1
    ds_write_b64 v53, v[156:157] offset:25728
    v_cvt_pk_bf16_f32 v124, v124, v125
    v_smfmac_f32_16x16x64_bf16 v[152:155], a[136:139], v[228:235], v27 abid:1
    ds_read_b128 v[220:223], v1 offset:6144
    s_waitcnt lgkmcnt(10)
    v_cvt_pk_bf16_f32 v125, v126, v127
    v_smfmac_f32_16x16x64_bf16 v[140:143], a[160:163], v[196:203], v30
    ds_read_b128 v[224:227], v2 offset:6144
    s_waitcnt lgkmcnt(7)
    v_cvt_pk_bf16_f32 v126, v128, v129
    v_smfmac_f32_16x16x64_bf16 v[140:143], a[196:199], v[204:211], v34
    ds_read_b128 v[228:231], v1 offset:7168
    s_waitcnt lgkmcnt(6)
    v_xad_u32 v236, v236, v3, v4
    v_smfmac_f32_16x16x64_bf16 v[148:151], v[240:243], v[244:251], v10
    ds_read_b32 v244, v236
    ds_read_b128 v[240:243], v8 offset:7168
    v_xad_u32 v237, v237, v3, v4
    v_smfmac_f32_16x16x64_bf16 v[144:147], a[164:167], v[196:203], v30 abid:1
    ds_read_b32 v246, v237
    ds_read_b128 v[232:235], v2 offset:7168
    v_xad_u32 v238, v238, v3, v4
    v_smfmac_f32_16x16x64_bf16 v[144:147], a[200:203], v[204:211], v34 abid:1
    ds_read_b32 v248, v238
    s_waitcnt lgkmcnt(8)
    s_barrier
    v_xad_u32 v239, v239, v3, v4
    v_smfmac_f32_16x16x64_bf16 v[148:151], a[168:171], v[196:203], v31
    ds_read_b32 v250, v239
    ds_read_b128 v[160:163], v8 offset:10816
    v_cvt_pk_bf16_f32 v127, v130, v131
    v_smfmac_f32_16x16x64_bf16 v[148:151], a[204:207], v[204:211], v35
    v_cvt_pk_bf16_f32 v132, v132, v133
    v_smfmac_f32_16x16x64_bf16 v[152:155], a[172:175], v[196:203], v31 abid:1
    v_cvt_pk_bf16_f32 v133, v134, v135
    v_smfmac_f32_16x16x64_bf16 v[152:155], a[208:211], v[204:211], v35 abid:1
    s_waitcnt lgkmcnt(8)
    v_cvt_pk_bf16_f32 v134, v136, v137
    v_smfmac_f32_16x16x64_bf16 v[140:143], a[232:235], v[220:227], v38
    s_waitcnt lgkmcnt(3)
    v_cvt_pk_bf16_f32 v135, v138, v139
    v_smfmac_f32_16x16x64_bf16 v[140:143], v[68:71], v[228:235], v42
    v_cndmask_b32_dpp v128, v124, v132, vcc row_ror:8 row_mask:0xf bank_mask:0xf
    v_smfmac_f32_16x16x64_bf16 v[140:143], v[104:107], v[212:219], v46
    s_waitcnt lgkmcnt(0)
    buffer_store_dwordx4 v[160:163], v7, s[12:15], s66 offen sc1
    v_cndmask_b32_dpp v129, v125, v133, vcc row_ror:8 row_mask:0xf bank_mask:0xf
    v_smfmac_f32_16x16x64_bf16 v[152:155], v[240:243], v[244:251], v10
    v_cndmask_b32_dpp v130, v126, v134, vcc row_ror:8 row_mask:0xf bank_mask:0xf
    v_smfmac_f32_16x16x64_bf16 v[144:147], a[236:239], v[220:227], v38 abid:1
    v_cndmask_b32_dpp v131, v127, v135, vcc row_ror:8 row_mask:0xf bank_mask:0xf
    v_smfmac_f32_16x16x64_bf16 v[144:147], v[72:75], v[228:235], v42 abid:1
    buffer_store_dwordx4 v[128:131], v6, s[12:15], s59 offen offset:0 sc1
    v_mov_b32_dpp v124, v132 row_ror:8 row_mask:0xf bank_mask:0xc
    v_smfmac_f32_16x16x64_bf16 v[144:147], v[108:111], v[212:219], v46 abid:1
    v_mov_b32_dpp v125, v133 row_ror:8 row_mask:0xf bank_mask:0xc
    v_smfmac_f32_16x16x64_bf16 v[148:151], a[240:243], v[220:227], v39
    v_mov_b32_dpp v126, v134 row_ror:8 row_mask:0xf bank_mask:0xc
    v_smfmac_f32_16x16x64_bf16 v[148:151], v[76:79], v[228:235], v43
    v_mov_b32_dpp v127, v135 row_ror:8 row_mask:0xf bank_mask:0xc
    v_smfmac_f32_16x16x64_bf16 v[148:151], v[112:115], v[212:219], v47
    buffer_store_dwordx4 v[124:127], v6, s[12:15], s24 offen offset:0 sc1
    v_smfmac_f32_16x16x64_bf16 v[152:155], a[244:247], v[220:227], v39 abid:1
    v_cvt_pk_bf16_f32 v140, v140, v141
    v_smfmac_f32_16x16x64_bf16 v[152:155], v[80:83], v[228:235], v43 abid:1
    v_cvt_pk_bf16_f32 v141, v142, v143
    v_smfmac_f32_16x16x64_bf16 v[152:155], v[116:119], v[212:219], v47 abid:1
    v_cvt_pk_bf16_f32 v142, v144, v145
    v_cvt_pk_bf16_f32 v143, v146, v147
    v_cvt_pk_bf16_f32 v148, v148, v149
    v_cvt_pk_bf16_f32 v149, v150, v151
    s_nop 3
    v_cvt_pk_bf16_f32 v150, v152, v153
    v_cvt_pk_bf16_f32 v151, v154, v155
    v_cndmask_b32_dpp v144, v140, v148, vcc row_ror:8 row_mask:0xf bank_mask:0xf
    v_cndmask_b32_dpp v145, v141, v149, vcc row_ror:8 row_mask:0xf bank_mask:0xf
    v_cndmask_b32_dpp v146, v142, v150, vcc row_ror:8 row_mask:0xf bank_mask:0xf
    v_cndmask_b32_dpp v147, v143, v151, vcc row_ror:8 row_mask:0xf bank_mask:0xf
    buffer_store_dwordx4 v[144:147], v6, s[12:15], s59 offen offset:128 sc1
    v_mov_b32_dpp v140, v148 row_ror:8 row_mask:0xf bank_mask:0xc
    v_mov_b32_dpp v141, v149 row_ror:8 row_mask:0xf bank_mask:0xc
    v_mov_b32_dpp v142, v150 row_ror:8 row_mask:0xf bank_mask:0xc
    v_mov_b32_dpp v143, v151 row_ror:8 row_mask:0xf bank_mask:0xc
    buffer_store_dwordx4 v[140:143], v6, s[12:15], s24 offen offset:128 sc1
    s_branch M_done
M_bF:
    s_cmp_ge_u32 s24, 74612736
    s_cbranch_scc1 M_bH
    v_smfmac_f32_16x16x64_bf16 v[164:167], v[56:59], v[220:227], v40 abid:1
    ds_read_b128 v[204:207], v1 offset:1024
    v_smfmac_f32_16x16x64_bf16 v[164:167], v[92:95], v[228:235], v44 abid:1
    ds_read_b128 v[208:211], v2 offset:1024
    v_smfmac_f32_16x16x64_bf16 v[168:171], v[60:63], v[220:227], v41
    ds_read_b128 v[212:215], v1 offset:2048
    v_smfmac_f32_16x16x64_bf16 v[168:171], v[96:99], v[228:235], v45
    ds_read_b128 v[216:219], v2 offset:2048
    v_smfmac_f32_16x16x64_bf16 v[172:175], v[64:67], v[220:227], v41 abid:1
    s_waitcnt lgkmcnt(6)
    buffer_store_dwordx4 v[244:247], v7, s[12:15], s66 offen sc1
    v_smfmac_f32_16x16x64_bf16 v[172:175], v[100:103], v[228:235], v45 abid:1
    ds_read_b128 v[236:239], v9 offset:9408
    v_smfmac_f32_16x16x64_bf16 v[176:179], v[68:71], v[220:227], v42
    s_mov_b32 s21, 4
    v_smfmac_f32_16x16x64_bf16 v[176:179], v[104:107], v[228:235], v46
    v_smfmac_f32_16x16x64_bf16 v[180:183], v[72:75], v[220:227], v42 abid:1
    v_cvt_pk_bf16_f32 v160, v160, v161
    v_smfmac_f32_16x16x64_bf16 v[180:183], v[108:111], v[228:235], v46 abid:1
    v_cvt_pk_bf16_f32 v161, v162, v163
    v_smfmac_f32_16x16x64_bf16 v[184:187], v[76:79], v[220:227], v43
    v_cvt_pk_bf16_f32 v162, v164, v165
    v_smfmac_f32_16x16x64_bf16 v[184:187], v[112:115], v[228:235], v47
    v_cvt_pk_bf16_f32 v163, v166, v167
    v_smfmac_f32_16x16x64_bf16 v[188:191], v[80:83], v[220:227], v43 abid:1
    v_cvt_pk_bf16_f32 v168, v168, v169
    v_smfmac_f32_16x16x64_bf16 v[188:191], v[116:119], v[228:235], v47 abid:1
    v_cvt_pk_bf16_f32 v169, v170, v171
    v_smfmac_f32_16x16x64_bf16 v[192:195], v[84:87], v[220:227], v51 abid:1
    v_cvt_pk_bf16_f32 v170, v172, v173
    v_smfmac_f32_16x16x64_bf16 v[192:195], v[120:123], v[228:235], v52
    ds_read_b128 v[220:223], v1 offset:3072
    s_waitcnt lgkmcnt(6)
    v_cvt_pk_bf16_f32 v171, v174, v175
    v_smfmac_f32_16x16x64_bf16 v[124:127], a[0:3], v[196:203], v12
    ds_read_b128 v[224:227], v2 offset:3072
    ds_read_b128 v[172:175], v9 offset:10432
    s_waitcnt lgkmcnt(6)
    v_cndmask_b32_dpp v164, v160, v168, vcc row_ror:8 row_mask:0xf bank_mask:0xf
    v_smfmac_f32_16x16x64_bf16 v[124:127], a[36:39], v[204:211], v16
    ds_read_b128 v[228:231], v1 offset:4096
    s_waitcnt lgkmcnt(5)
    v_cndmask_b32_dpp v165, v161, v169, vcc row_ror:8 row_mask:0xf bank_mask:0xf
    v_smfmac_f32_16x16x64_bf16 v[124:127], a[72:75], v[212:219], v20
    ds_read_b128 v[232:235], v2 offset:4096
    s_waitcnt lgkmcnt(5)
    v_xad_u32 v236, v236, v3, v4
    v_smfmac_f32_16x16x64_bf16 v[156:159], a[32:35], v[196:203], v48
    s_barrier
    v_xad_u32 v237, v237, v3, v4
    v_smfmac_f32_16x16x64_bf16 v[156:159], a[68:71], v[204:211], v48 abid:1
    ds_read2st64_b32 v[244:245], v236 offset0:0 offset1:72
    ds_read_b128 v[240:243], v8 offset:3072
    v_xad_u32 v238, v238, v3, v4
    v_smfmac_f32_16x16x64_bf16 v[156:159], a[104:107], v[212:219], v49
    ds_read2st64_b32 v[246:247], v237 offset0:0 offset1:72
    v_xad_u32 v239, v239, v3, v4
    v_smfmac_f32_16x16x64_bf16 v[132:135], a[8:11], v[196:203], v13
    ds_read2st64_b32 v[248:249], v238 offset0:0 offset1:72
    v_cndmask_b32_dpp v166, v162, v170, vcc row_ror:8 row_mask:0xf bank_mask:0xf
    v_smfmac_f32_16x16x64_bf16 v[132:135], a[44:47], v[204:211], v17
    ds_read2st64_b32 v[250:251], v239 offset0:0 offset1:72
    ds_read_b128 v[236:239], v9 offset:9280
    v_cndmask_b32_dpp v167, v163, v171, vcc row_ror:8 row_mask:0xf bank_mask:0xf
    v_smfmac_f32_16x16x64_bf16 v[132:135], a[80:83], v[212:219], v21
    buffer_store_dwordx4 v[164:167], v6, s[12:15], s58 offen offset:0 sc1
    v_mov_b32_dpp v160, v168 row_ror:8 row_mask:0xf bank_mask:0xc
    v_smfmac_f32_16x16x64_bf16 v[140:143], a[16:19], v[196:203], v14
    v_mov_b32_dpp v161, v169 row_ror:8 row_mask:0xf bank_mask:0xc
    v_smfmac_f32_16x16x64_bf16 v[140:143], a[52:55], v[204:211], v18
    v_mov_b32_dpp v162, v170 row_ror:8 row_mask:0xf bank_mask:0xc
    v_smfmac_f32_16x16x64_bf16 v[140:143], a[88:91], v[212:219], v22
    v_mov_b32_dpp v163, v171 row_ror:8 row_mask:0xf bank_mask:0xc
    v_smfmac_f32_16x16x64_bf16 v[136:139], a[12:15], v[196:203], v13 abid:1
    buffer_store_dwordx4 v[160:163], v6, s[12:15], s23 offen offset:0 sc1
    ds_read_b128 v[164:167], v9 offset:10304
    ds_read_b128 v[168:171], v9 offset:10368
    v_smfmac_f32_16x16x64_bf16 v[136:139], a[48:51], v[204:211], v17 abid:1
    ds_read_b128 v[160:163], v9 offset:10240
    v_smfmac_f32_16x16x64_bf16 v[136:139], a[84:87], v[212:219], v21 abid:1
    s_waitcnt lgkmcnt(3)
    v_xad_u32 v236, v236, v3, v4
    v_smfmac_f32_16x16x64_bf16 v[136:139], v[240:243], v[244:251], v10
    v_xad_u32 v237, v237, v3, v4
    v_smfmac_f32_16x16x64_bf16 v[172:175], v[240:243], v[244:251], v10 abid:1
    ds_read2st64_b32 v[244:245], v236 offset0:0 offset1:72
    ds_read_b128 v[240:243], v8 offset:1024
    v_xad_u32 v238, v238, v3, v4
    v_smfmac_f32_16x16x64_bf16 v[144:147], a[20:23], v[196:203], v14 abid:1
    ds_read2st64_b32 v[246:247], v237 offset0:0 offset1:72
    v_xad_u32 v239, v239, v3, v4
    v_smfmac_f32_16x16x64_bf16 v[144:147], a[56:59], v[204:211], v18 abid:1
    ds_read2st64_b32 v[248:249], v238 offset0:0 offset1:72
    v_smfmac_f32_16x16x64_bf16 v[144:147], a[92:95], v[212:219], v22 abid:1
    ds_read2st64_b32 v[250:251], v239 offset0:0 offset1:72
    ds_read_b128 v[236:239], v9 offset:9344
    v_smfmac_f32_16x16x64_bf16 v[148:151], a[24:27], v[196:203], v15
    v_cvt_pk_bf16_f32 v192, v192, v193
    v_smfmac_f32_16x16x64_bf16 v[148:151], a[60:63], v[204:211], v19
    v_cvt_pk_bf16_f32 v193, v194, v195
    v_smfmac_f32_16x16x64_bf16 v[148:151], a[96:99], v[212:219], v23
    ds_write_b64 v53, v[192:193] offset:0
    ds_read_b128 v[192:195], v9 offset:10752
    v_smfmac_f32_16x16x64_bf16 v[152:155], a[28:31], v[196:203], v15 abid:1
    v_smfmac_f32_16x16x64_bf16 v[152:155], a[64:67], v[204:211], v19 abid:1
    v_smfmac_f32_16x16x64_bf16 v[152:155], a[100:103], v[212:219], v23 abid:1
    v_smfmac_f32_16x16x64_bf16 v[128:131], a[4:7], v[196:203], v12 abid:1
    v_smfmac_f32_16x16x64_bf16 v[128:131], a[40:43], v[204:211], v16 abid:1
    v_smfmac_f32_16x16x64_bf16 v[128:131], a[76:79], v[212:219], v20 abid:1
    s_waitcnt lgkmcnt(2)
    v_xad_u32 v236, v236, v3, v4
    v_smfmac_f32_16x16x64_bf16 v[128:131], v[240:243], v[244:251], v10
    v_xad_u32 v237, v237, v3, v4
    v_smfmac_f32_16x16x64_bf16 v[164:167], v[240:243], v[244:251], v10 abid:1
    ds_read2st64_b32 v[244:245], v236 offset0:0 offset1:72
    ds_read_b128 v[240:243], v8 offset:2048
    v_xad_u32 v238, v238, v3, v4
    v_smfmac_f32_16x16x64_bf16 v[124:127], a[108:111], v[220:227], v24
    ds_read2st64_b32 v[246:247], v237 offset0:0 offset1:72
    v_xad_u32 v239, v239, v3, v4
    v_smfmac_f32_16x16x64_bf16 v[124:127], a[144:147], v[228:235], v28
    ds_read2st64_b32 v[248:249], v238 offset0:0 offset1:72
    ds_read_b64 v[216:217], v9 offset:10056
    v_cvt_pk_bf16_f32 v176, v176, v177
    v_smfmac_f32_16x16x64_bf16 v[128:131], a[112:115], v[220:227], v24 abid:1
    ds_read2st64_b32 v[250:251], v239 offset0:0 offset1:72
    ds_read_b128 v[236:239], v9 offset:9216
    v_cvt_pk_bf16_f32 v177, v178, v179
    v_smfmac_f32_16x16x64_bf16 v[128:131], a[148:151], v[228:235], v28 abid:1
    v_cvt_pk_bf16_f32 v178, v180, v181
    v_smfmac_f32_16x16x64_bf16 v[140:143], a[124:127], v[220:227], v26
    v_cvt_pk_bf16_f32 v179, v182, v183
    v_smfmac_f32_16x16x64_bf16 v[140:143], a[160:163], v[228:235], v30
    v_cvt_pk_bf16_f32 v184, v184, v185
    v_smfmac_f32_16x16x64_bf16 v[136:139], a[120:123], v[220:227], v25 abid:1
    v_cvt_pk_bf16_f32 v185, v186, v187
    v_smfmac_f32_16x16x64_bf16 v[136:139], a[156:159], v[228:235], v29 abid:1
    ds_read_b128 v[196:199], v1 offset:5120
    v_cvt_pk_bf16_f32 v186, v188, v189
    v_smfmac_f32_16x16x64_bf16 v[132:135], a[116:119], v[220:227], v25
    ds_read_b128 v[200:203], v2 offset:5120
    v_cvt_pk_bf16_f32 v187, v190, v191
    v_smfmac_f32_16x16x64_bf16 v[132:135], a[152:155], v[228:235], v29
    ds_read_b128 v[188:191], v9 offset:10688
    s_waitcnt lgkmcnt(3)
    v_xad_u32 v236, v236, v3, v4
    v_smfmac_f32_16x16x64_bf16 v[132:135], v[240:243], v[244:251], v10
    ds_read_b128 v[204:207], v1 offset:6144
    v_xad_u32 v237, v237, v3, v4
    v_smfmac_f32_16x16x64_bf16 v[168:171], v[240:243], v[244:251], v10 abid:1
    ds_read2st64_b32 v[244:245], v236 offset0:0 offset1:72
    ds_read_b128 v[240:243], v8 offset:0
    v_xad_u32 v238, v238, v3, v4
    v_smfmac_f32_16x16x64_bf16 v[144:147], a[128:131], v[220:227], v26 abid:1
    ds_read2st64_b32 v[246:247], v237 offset0:0 offset1:72
    v_xad_u32 v239, v239, v3, v4
    v_smfmac_f32_16x16x64_bf16 v[144:147], a[164:167], v[228:235], v30 abid:1
    ds_read2st64_b32 v[248:249], v238 offset0:0 offset1:72
    ds_read_b128 v[208:211], v2 offset:6144
    v_cndmask_b32_dpp v180, v176, v184, vcc row_ror:8 row_mask:0xf bank_mask:0xf
    v_smfmac_f32_16x16x64_bf16 v[148:151], a[132:135], v[220:227], v27
    ds_read2st64_b32 v[250:251], v239 offset0:0 offset1:72
    ds_read_b128 v[236:239], v9 offset:9728
    v_cndmask_b32_dpp v181, v177, v185, vcc row_ror:8 row_mask:0xf bank_mask:0xf
    v_smfmac_f32_16x16x64_bf16 v[148:151], a[168:171], v[228:235], v31
    v_xad_u32 v212, v216, v3, v4
    v_smfmac_f32_16x16x64_bf16 v[152:155], a[136:139], v[220:227], v27 abid:1
    ds_read2st64_b32 v[212:213], v212 offset0:0 offset1:72
    v_xad_u32 v214, v217, v3, v4
    v_smfmac_f32_16x16x64_bf16 v[152:155], a[172:175], v[228:235], v31 abid:1
    ds_read2st64_b32 v[214:215], v214 offset0:0 offset1:72
    v_cndmask_b32_dpp v182, v178, v186, vcc row_ror:8 row_mask:0xf bank_mask:0xf
    v_smfmac_f32_16x16x64_bf16 v[156:159], a[140:143], v[220:227], v49 abid:1
    v_cndmask_b32_dpp v183, v179, v187, vcc row_ror:8 row_mask:0xf bank_mask:0xf
    v_smfmac_f32_16x16x64_bf16 v[156:159], a[176:179], v[228:235], v50
    buffer_store_dwordx4 v[180:183], v6, s[12:15], s58 offen offset:128 sc1
    s_waitcnt lgkmcnt(11)
    v_mov_b32_dpp v176, v184 row_ror:8 row_mask:0xf bank_mask:0xc
    v_smfmac_f32_16x16x64_bf16 v[128:131], a[184:187], v[196:203], v32 abid:1
    s_waitcnt lgkmcnt(4)
    v_mov_b32_dpp v177, v185 row_ror:8 row_mask:0xf bank_mask:0xc
    v_smfmac_f32_16x16x64_bf16 v[128:131], a[220:223], v[204:211], v36 abid:1
    v_mov_b32_dpp v178, v186 row_ror:8 row_mask:0xf bank_mask:0xc
    v_smfmac_f32_16x16x64_bf16 v[124:127], a[180:183], v[196:203], v32
    ds_read_b128 v[220:223], v1 offset:7168
    v_mov_b32_dpp v179, v187 row_ror:8 row_mask:0xf bank_mask:0xc
    v_smfmac_f32_16x16x64_bf16 v[124:127], a[216:219], v[204:211], v36
    buffer_store_dwordx4 v[176:179], v6, s[12:15], s23 offen offset:128 sc1
    s_waitcnt lgkmcnt(3)
    v_xad_u32 v236, v236, v3, v4
    v_smfmac_f32_16x16x64_bf16 v[124:127], v[240:243], v[244:251], v10
    ds_read_b128 v[224:227], v2 offset:7168
    ds_read_b128 v[180:183], v9 offset:10560
    v_xad_u32 v237, v237, v3, v4
    v_smfmac_f32_16x16x64_bf16 v[160:163], v[240:243], v[244:251], v10 abid:1
    ds_read2st64_b32 v[244:245], v236 offset0:0 offset1:72
    ds_read_b128 v[240:243], v8 offset:8192
    v_xad_u32 v238, v238, v3, v4
    v_smfmac_f32_16x16x64_bf16 v[132:135], a[188:191], v[196:203], v33
    ds_read2st64_b32 v[246:247], v237 offset0:0 offset1:72
    ds_read_b128 v[184:187], v9 offset:10624
    v_xad_u32 v239, v239, v3, v4
    v_smfmac_f32_16x16x64_bf16 v[132:135], a[224:227], v[204:211], v37
    ds_read2st64_b32 v[248:249], v238 offset0:0 offset1:72
    ds_read_b128 v[176:179], v9 offset:10496
    v_smfmac_f32_16x16x64_bf16 v[136:139], a[192:195], v[196:203], v33 abid:1
    ds_read2st64_b32 v[250:251], v239 offset0:0 offset1:72
    ds_read_b128 v[236:239], v9 offset:9664
    v_smfmac_f32_16x16x64_bf16 v[136:139], a[228:231], v[204:211], v37 abid:1
    v_smfmac_f32_16x16x64_bf16 v[140:143], a[196:199], v[196:203], v34
    v_smfmac_f32_16x16x64_bf16 v[140:143], a[232:235], v[204:211], v38
    ds_read_b128 v[228:231], v1 offset:8192
    v_smfmac_f32_16x16x64_bf16 v[144:147], a[200:203], v[196:203], v34 abid:1
    ds_read_b128 v[232:235], v2 offset:8192
    v_smfmac_f32_16x16x64_bf16 v[144:147], a[236:239], v[204:211], v38 abid:1
    s_waitcnt lgkmcnt(4)
    s_cmp_lt_i32 s81, 0
    s_cbranch_scc1 M_ovrF
    s_swappc_b64 s[78:79], s[72:73]
M_ovrF:
    v_smfmac_f32_16x16x64_bf16 v[156:159], a[212:215], v[196:203], v50 abid:1
    v_smfmac_f32_16x16x64_bf16 v[156:159], a[248:251], v[204:211], v51
    s_waitcnt lgkmcnt(2)
    v_xad_u32 v236, v236, v3, v4
    v_smfmac_f32_16x16x64_bf16 v[156:159], v[240:243], v[244:251], v10
    v_xad_u32 v237, v237, v3, v4
    v_smfmac_f32_16x16x64_bf16 v[192:195], v[240:243], v[244:251], v10 abid:1
    ds_read2st64_b32 v[244:245], v236 offset0:0 offset1:72
    ds_read_b128 v[240:243], v8 offset:7168
    v_xad_u32 v238, v238, v3, v4
    v_smfmac_f32_16x16x64_bf16 v[152:155], a[208:211], v[196:203], v35 abid:1
    ds_read2st64_b32 v[246:247], v237 offset0:0 offset1:72
    v_xad_u32 v239, v239, v3, v4
    v_smfmac_f32_16x16x64_bf16 v[152:155], a[244:247], v[204:211], v39 abid:1
    ds_read2st64_b32 v[248:249], v238 offset0:0 offset1:72
    v_smfmac_f32_16x16x64_bf16 v[148:151], a[204:207], v[196:203], v35
    ds_read2st64_b32 v[250:251], v239 offset0:0 offset1:72
    ds_read_b128 v[236:239], v9 offset:9536
    v_smfmac_f32_16x16x64_bf16 v[148:151], a[240:243], v[204:211], v39
    v_smfmac_f32_16x16x64_bf16 v[124:127], a[252:255], v[220:227], v40
    s_waitcnt lgkmcnt(6)
    v_smfmac_f32_16x16x64_bf16 v[124:127], v[88:91], v[228:235], v44
    v_smfmac_f32_16x16x64_bf16 v[128:131], v[56:59], v[220:227], v40 abid:1
    v_smfmac_f32_16x16x64_bf16 v[128:131], v[92:95], v[228:235], v44 abid:1
    s_cmp_lt_u32 s20, 2
    s_cselect_b32 s66, s23, s24
    s_add_u32 s66, s66, s95
    v_smfmac_f32_16x16x64_bf16 v[132:135], v[60:63], v[220:227], v41
    ds_read_b128 v[196:199], v1 offset:18432
    s_add_u32 s23, s24, 18432
    s_add_u32 s58, s24, 27648
    v_smfmac_f32_16x16x64_bf16 v[132:135], v[96:99], v[228:235], v45
    ds_read_b128 v[200:203], v2 offset:18432
    s_add_u32 s67, s23, s95
    v_smfmac_f32_16x16x64_bf16 v[152:155], v[80:83], v[220:227], v43 abid:1
    ds_read_b128 v[204:207], v1 offset:19456
    v_smfmac_f32_16x16x64_bf16 v[152:155], v[116:119], v[228:235], v47 abid:1
    s_waitcnt lgkmcnt(3)
    v_xad_u32 v236, v236, v3, v4
    v_smfmac_f32_16x16x64_bf16 v[152:155], v[240:243], v[244:251], v10
    ds_read_b128 v[208:211], v2 offset:19456
    v_xad_u32 v237, v237, v3, v4
    v_smfmac_f32_16x16x64_bf16 v[188:191], v[240:243], v[244:251], v10 abid:1
    s_cmp_gt_u32 s46, s80
    s_cbranch_scc1 M_slow
M_slowrF:
    v_xad_u32 v238, v238, v3, v4
    v_smfmac_f32_16x16x64_bf16 v[140:143], v[68:71], v[220:227], v42
    ds_read2st64_b32 v[244:245], v236 offset0:0 offset1:72
    ds_read_b128 v[240:243], v8 offset:5120
    v_xad_u32 v239, v239, v3, v4
    v_smfmac_f32_16x16x64_bf16 v[140:143], v[104:107], v[228:235], v46
    ds_read2st64_b32 v[246:247], v237 offset0:0 offset1:72
    v_smfmac_f32_16x16x64_bf16 v[156:159], v[84:87], v[220:227], v51 abid:1
    ds_read2st64_b32 v[248:249], v238 offset0:0 offset1:72
    ds_read_b128 v[212:215], v1 offset:20480
    v_smfmac_f32_16x16x64_bf16 v[156:159], v[120:123], v[228:235], v52
    ds_read2st64_b32 v[250:251], v239 offset0:0 offset1:72
    ds_read_b128 v[236:239], v9 offset:9600
    v_smfmac_f32_16x16x64_bf16 v[148:151], v[76:79], v[220:227], v43
    ds_read_b128 v[216:219], v2 offset:20480
    v_smfmac_f32_16x16x64_bf16 v[148:151], v[112:115], v[228:235], v47
    v_smfmac_f32_16x16x64_bf16 v[136:139], v[64:67], v[220:227], v41 abid:1
    v_smfmac_f32_16x16x64_bf16 v[136:139], v[100:103], v[228:235], v45 abid:1
    v_smfmac_f32_16x16x64_bf16 v[144:147], v[72:75], v[220:227], v42 abid:1
    v_smfmac_f32_16x16x64_bf16 v[144:147], v[108:111], v[228:235], v46 abid:1
    ds_read_b128 v[220:223], v1 offset:21504
    s_waitcnt lgkmcnt(2)
    v_xad_u32 v236, v236, v3, v4
    v_smfmac_f32_16x16x64_bf16 v[144:147], v[240:243], v[244:251], v10
    ds_read_b128 v[224:227], v2 offset:21504
    v_xad_u32 v237, v237, v3, v4
    v_smfmac_f32_16x16x64_bf16 v[180:183], v[240:243], v[244:251], v10 abid:1
    ds_read2st64_b32 v[244:245], v236 offset0:0 offset1:72
    ds_read_b128 v[240:243], v8 offset:6144
    v_xad_u32 v238, v238, v3, v4
    v_smfmac_f32_16x16x64_bf16 v[192:195], a[32:35], v[196:203], v48
    ds_read2st64_b32 v[246:247], v237 offset0:0 offset1:72
    ds_read_b128 v[228:231], v1 offset:22528
    v_xad_u32 v239, v239, v3, v4
    v_smfmac_f32_16x16x64_bf16 v[192:195], a[68:71], v[204:211], v48 abid:1
    ds_read2st64_b32 v[248:249], v238 offset0:0 offset1:72
    ds_read_b128 v[232:235], v2 offset:22528
    s_waitcnt lgkmcnt(8)
    v_cvt_pk_bf16_f32 v124, v124, v125
    v_smfmac_f32_16x16x64_bf16 v[192:195], a[104:107], v[212:219], v49
    ds_read2st64_b32 v[250:251], v239 offset0:0 offset1:72
    ds_read_b128 v[236:239], v9 offset:9472
    v_cvt_pk_bf16_f32 v125, v126, v127
    v_smfmac_f32_16x16x64_bf16 v[160:163], a[0:3], v[196:203], v12
    v_cvt_pk_bf16_f32 v126, v128, v129
    v_smfmac_f32_16x16x64_bf16 v[160:163], a[36:39], v[204:211], v16
    v_cvt_pk_bf16_f32 v127, v130, v131
    v_smfmac_f32_16x16x64_bf16 v[160:163], a[72:75], v[212:219], v20
    v_cvt_pk_bf16_f32 v156, v156, v157
    v_smfmac_f32_16x16x64_bf16 v[164:167], a[4:7], v[196:203], v12 abid:1
    v_cvt_pk_bf16_f32 v157, v158, v159
    v_smfmac_f32_16x16x64_bf16 v[164:167], a[40:43], v[204:211], v16 abid:1
    ds_write_b64 v53, v[156:157] offset:25728
    v_cvt_pk_bf16_f32 v132, v132, v133
    v_smfmac_f32_16x16x64_bf16 v[164:167], a[76:79], v[212:219], v20 abid:1
    v_cvt_pk_bf16_f32 v133, v134, v135
    v_smfmac_f32_16x16x64_bf16 v[168:171], a[8:11], v[196:203], v13
    v_cvt_pk_bf16_f32 v134, v136, v137
    v_smfmac_f32_16x16x64_bf16 v[168:171], a[44:47], v[204:211], v17
    v_cvt_pk_bf16_f32 v135, v138, v139
    v_smfmac_f32_16x16x64_bf16 v[168:171], a[80:83], v[212:219], v21
    s_waitcnt lgkmcnt(1)
    v_xad_u32 v236, v236, v3, v4
    v_smfmac_f32_16x16x64_bf16 v[184:187], v[240:243], v[244:251], v10 abid:1
    v_xad_u32 v237, v237, v3, v4
    v_smfmac_f32_16x16x64_bf16 v[148:151], v[240:243], v[244:251], v10
    ds_read2st64_b32 v[244:245], v236 offset0:0 offset1:72
    ds_read_b128 v[240:243], v8 offset:4096
    v_xad_u32 v238, v238, v3, v4
    v_smfmac_f32_16x16x64_bf16 v[172:175], a[12:15], v[196:203], v13 abid:1
    ds_read2st64_b32 v[246:247], v237 offset0:0 offset1:72
    v_xad_u32 v239, v239, v3, v4
    v_smfmac_f32_16x16x64_bf16 v[172:175], a[48:51], v[204:211], v17 abid:1
    ds_read2st64_b32 v[248:249], v238 offset0:0 offset1:72
    v_cndmask_b32_dpp v128, v124, v132, vcc row_ror:8 row_mask:0xf bank_mask:0xf
    v_smfmac_f32_16x16x64_bf16 v[172:175], a[84:87], v[212:219], v21 abid:1
    ds_read2st64_b32 v[250:251], v239 offset0:0 offset1:72
    ds_read_b128 v[196:199], v1 offset:23552
    v_cndmask_b32_dpp v129, v125, v133, vcc row_ror:8 row_mask:0xf bank_mask:0xf
    v_smfmac_f32_16x16x64_bf16 v[192:195], a[140:143], v[220:227], v49 abid:1
    ds_read_b128 v[200:203], v2 offset:23552
    v_cndmask_b32_dpp v130, v126, v134, vcc row_ror:8 row_mask:0xf bank_mask:0xf
    v_smfmac_f32_16x16x64_bf16 v[192:195], a[176:179], v[228:235], v50
    ds_read_b128 v[204:207], v1 offset:24576
    v_cndmask_b32_dpp v131, v127, v135, vcc row_ror:8 row_mask:0xf bank_mask:0xf
    v_smfmac_f32_16x16x64_bf16 v[160:163], a[108:111], v[220:227], v24
    ds_read_b128 v[208:211], v2 offset:24576
    buffer_store_dwordx4 v[128:131], v6, s[12:15], s59 offen offset:0 sc1
    v_mov_b32_dpp v124, v132 row_ror:8 row_mask:0xf bank_mask:0xc
    v_smfmac_f32_16x16x64_bf16 v[160:163], a[144:147], v[228:235], v28
    s_waitcnt lgkmcnt(9)
    s_barrier
    ds_read_b128 v[236:239], v8 offset:10816
    v_mov_b32_dpp v125, v133 row_ror:8 row_mask:0xf bank_mask:0xc
    v_smfmac_f32_16x16x64_bf16 v[164:167], a[112:115], v[220:227], v24 abid:1
    ds_read_b128 v[212:215], v1 offset:20480
    v_mov_b32_dpp v126, v134 row_ror:8 row_mask:0xf bank_mask:0xc
    v_smfmac_f32_16x16x64_bf16 v[164:167], a[148:151], v[228:235], v28 abid:1
    ds_read_b128 v[216:219], v2 offset:20480
    v_mov_b32_dpp v127, v135 row_ror:8 row_mask:0xf bank_mask:0xc
    v_smfmac_f32_16x16x64_bf16 v[168:171], a[116:119], v[220:227], v25
    buffer_store_dwordx4 v[124:127], v6, s[12:15], s24 offen offset:0 sc1
    v_smfmac_f32_16x16x64_bf16 v[168:171], a[152:155], v[228:235], v29
    s_waitcnt lgkmcnt(7)
    v_smfmac_f32_16x16x64_bf16 v[176:179], v[240:243], v[244:251], v10 abid:1
    v_smfmac_f32_16x16x64_bf16 v[140:143], v[240:243], v[244:251], v10
    s_waitcnt lgkmcnt(2)
    buffer_store_dwordx4 v[236:239], v7, s[12:15], s66 offen sc1
    v_smfmac_f32_16x16x64_bf16 v[172:175], a[120:123], v[220:227], v25 abid:1
    v_smfmac_f32_16x16x64_bf16 v[172:175], a[156:159], v[228:235], v29 abid:1
    ds_read_b128 v[220:223], v1 offset:25600
    v_smfmac_f32_16x16x64_bf16 v[192:195], a[212:215], v[196:203], v50 abid:1
    ds_read_b128 v[224:227], v2 offset:25600
    s_nop 0
    v_cvt_pk_bf16_f32 v140, v140, v141
    v_smfmac_f32_16x16x64_bf16 v[192:195], a[248:251], v[204:211], v51
    ds_read_b128 v[228:231], v1 offset:26624
    v_cvt_pk_bf16_f32 v141, v142, v143
    v_smfmac_f32_16x16x64_bf16 v[160:163], a[180:183], v[196:203], v32
    ds_read_b128 v[232:235], v2 offset:26624
    v_cvt_pk_bf16_f32 v142, v144, v145
    v_smfmac_f32_16x16x64_bf16 v[160:163], a[216:219], v[204:211], v36
    v_cvt_pk_bf16_f32 v143, v146, v147
    v_smfmac_f32_16x16x64_bf16 v[164:167], a[184:187], v[196:203], v32 abid:1
    v_cvt_pk_bf16_f32 v148, v148, v149
    v_smfmac_f32_16x16x64_bf16 v[164:167], a[220:223], v[204:211], v36 abid:1
    v_cvt_pk_bf16_f32 v149, v150, v151
    v_smfmac_f32_16x16x64_bf16 v[168:171], a[188:191], v[196:203], v33
    v_cvt_pk_bf16_f32 v150, v152, v153
    v_smfmac_f32_16x16x64_bf16 v[168:171], a[224:227], v[204:211], v37
    v_cvt_pk_bf16_f32 v151, v154, v155
    v_smfmac_f32_16x16x64_bf16 v[172:175], a[192:195], v[196:203], v33 abid:1
    v_cndmask_b32_dpp v144, v140, v148, vcc row_ror:8 row_mask:0xf bank_mask:0xf
    v_smfmac_f32_16x16x64_bf16 v[172:175], a[228:231], v[204:211], v37 abid:1
    ds_read_b128 v[196:199], v1 offset:18432
    s_waitcnt lgkmcnt(3)
    v_cndmask_b32_dpp v145, v141, v149, vcc row_ror:8 row_mask:0xf bank_mask:0xf
    v_smfmac_f32_16x16x64_bf16 v[192:195], v[84:87], v[220:227], v51 abid:1
    ds_read_b128 v[200:203], v2 offset:18432
    s_waitcnt lgkmcnt(2)
    v_cndmask_b32_dpp v146, v142, v150, vcc row_ror:8 row_mask:0xf bank_mask:0xf
    v_smfmac_f32_16x16x64_bf16 v[192:195], v[120:123], v[228:235], v52
    ds_read_b128 v[204:207], v1 offset:19456
    v_cndmask_b32_dpp v147, v143, v151, vcc row_ror:8 row_mask:0xf bank_mask:0xf
    v_smfmac_f32_16x16x64_bf16 v[160:163], a[252:255], v[220:227], v40
    ds_read_b128 v[208:211], v2 offset:19456
    buffer_store_dwordx4 v[144:147], v6, s[12:15], s59 offen offset:128 sc1
    v_mov_b32_dpp v140, v148 row_ror:8 row_mask:0xf bank_mask:0xc
    v_smfmac_f32_16x16x64_bf16 v[160:163], v[88:91], v[228:235], v44
    v_mov_b32_dpp v141, v149 row_ror:8 row_mask:0xf bank_mask:0xc
    v_smfmac_f32_16x16x64_bf16 v[164:167], v[56:59], v[220:227], v40 abid:1
    v_mov_b32_dpp v142, v150 row_ror:8 row_mask:0xf bank_mask:0xc
    v_smfmac_f32_16x16x64_bf16 v[164:167], v[92:95], v[228:235], v44 abid:1
    v_mov_b32_dpp v143, v151 row_ror:8 row_mask:0xf bank_mask:0xc
    v_smfmac_f32_16x16x64_bf16 v[168:171], v[60:63], v[220:227], v41
    buffer_store_dwordx4 v[140:143], v6, s[12:15], s24 offen offset:128 sc1
    v_cvt_pk_bf16_f32 v192, v192, v193
    v_smfmac_f32_16x16x64_bf16 v[168:171], v[96:99], v[228:235], v45
    v_cvt_pk_bf16_f32 v193, v194, v195
    v_smfmac_f32_16x16x64_bf16 v[172:175], v[64:67], v[220:227], v41 abid:1
    ds_write_b64 v53, v[192:193] offset:1024
    v_smfmac_f32_16x16x64_bf16 v[172:175], v[100:103], v[228:235], v45 abid:1
    ds_read_b128 v[220:223], v1 offset:21504
    s_waitcnt lgkmcnt(4)
    v_smfmac_f32_16x16x64_bf16 v[176:179], a[16:19], v[196:203], v14
    ds_read_b128 v[224:227], v2 offset:21504
    s_waitcnt lgkmcnt(3)
    v_smfmac_f32_16x16x64_bf16 v[176:179], a[52:55], v[204:211], v18
    ds_read_b128 v[228:231], v1 offset:22528
    v_smfmac_f32_16x16x64_bf16 v[176:179], a[88:91], v[212:219], v22
    ds_read_b128 v[232:235], v2 offset:22528
    s_waitcnt lgkmcnt(4)
    s_barrier
    ds_read_b128 v[236:239], v8 offset:11840
    v_smfmac_f32_16x16x64_bf16 v[180:183], a[20:23], v[196:203], v14 abid:1
    v_cvt_pk_bf16_f32 v160, v160, v161
    v_smfmac_f32_16x16x64_bf16 v[180:183], a[56:59], v[204:211], v18 abid:1
    v_cvt_pk_bf16_f32 v161, v162, v163
    v_smfmac_f32_16x16x64_bf16 v[180:183], a[92:95], v[212:219], v22 abid:1
    v_cvt_pk_bf16_f32 v162, v164, v165
    v_smfmac_f32_16x16x64_bf16 v[184:187], a[24:27], v[196:203], v15
    v_cvt_pk_bf16_f32 v163, v166, v167
    v_smfmac_f32_16x16x64_bf16 v[184:187], a[60:63], v[204:211], v19
    v_cvt_pk_bf16_f32 v168, v168, v169
    v_smfmac_f32_16x16x64_bf16 v[184:187], a[96:99], v[212:219], v23
    s_cmp_lt_u32 s20, 2
    s_waitcnt lgkmcnt(0)
    s_cbranch_scc0 M_fx
    buffer_store_dwordx4 v[236:239], v7, s[12:15], s67 offen sc1
M_fx:
    v_smfmac_f32_16x16x64_bf16 v[188:191], a[28:31], v[196:203], v15 abid:1
    v_cvt_pk_bf16_f32 v169, v170, v171
    v_smfmac_f32_16x16x64_bf16 v[188:191], a[64:67], v[204:211], v19 abid:1
    v_cvt_pk_bf16_f32 v170, v172, v173
    v_smfmac_f32_16x16x64_bf16 v[188:191], a[100:103], v[212:219], v23 abid:1
    ds_read_b128 v[196:199], v1 offset:23552
    v_cvt_pk_bf16_f32 v171, v174, v175
    v_smfmac_f32_16x16x64_bf16 v[176:179], a[124:127], v[220:227], v26
    ds_read_b128 v[200:203], v2 offset:23552
    v_cndmask_b32_dpp v164, v160, v168, vcc row_ror:8 row_mask:0xf bank_mask:0xf
    v_smfmac_f32_16x16x64_bf16 v[176:179], a[160:163], v[228:235], v30
    ds_read_b128 v[204:207], v1 offset:24576
    v_cndmask_b32_dpp v165, v161, v169, vcc row_ror:8 row_mask:0xf bank_mask:0xf
    v_smfmac_f32_16x16x64_bf16 v[180:183], a[128:131], v[220:227], v26 abid:1
    ds_read_b128 v[208:211], v2 offset:24576
    v_cndmask_b32_dpp v166, v162, v170, vcc row_ror:8 row_mask:0xf bank_mask:0xf
    v_smfmac_f32_16x16x64_bf16 v[180:183], a[164:167], v[228:235], v30 abid:1
    v_cndmask_b32_dpp v167, v163, v171, vcc row_ror:8 row_mask:0xf bank_mask:0xf
    v_smfmac_f32_16x16x64_bf16 v[184:187], a[132:135], v[220:227], v27
    buffer_store_dwordx4 v[164:167], v6, s[12:15], s58 offen offset:0 sc1
    v_mov_b32_dpp v160, v168 row_ror:8 row_mask:0xf bank_mask:0xc
    v_smfmac_f32_16x16x64_bf16 v[184:187], a[168:171], v[228:235], v31
    v_mov_b32_dpp v161, v169 row_ror:8 row_mask:0xf bank_mask:0xc
    v_smfmac_f32_16x16x64_bf16 v[188:191], a[136:139], v[220:227], v27 abid:1
    v_mov_b32_dpp v162, v170 row_ror:8 row_mask:0xf bank_mask:0xc
    v_smfmac_f32_16x16x64_bf16 v[188:191], a[172:175], v[228:235], v31 abid:1
    ds_read_b128 v[220:223], v1 offset:25600
    s_waitcnt lgkmcnt(3)
    v_mov_b32_dpp v163, v171 row_ror:8 row_mask:0xf bank_mask:0xc
    v_smfmac_f32_16x16x64_bf16 v[176:179], a[196:199], v[196:203], v34
    ds_read_b128 v[224:227], v2 offset:25600
    buffer_store_dwordx4 v[160:163], v6, s[12:15], s23 offen offset:0 sc1
    s_waitcnt lgkmcnt(2)
    v_smfmac_f32_16x16x64_bf16 v[176:179], a[232:235], v[204:211], v38
    ds_read_b128 v[228:231], v1 offset:26624
    v_smfmac_f32_16x16x64_bf16 v[180:183], a[200:203], v[196:203], v34 abid:1
    ds_read_b128 v[232:235], v2 offset:26624
    v_smfmac_f32_16x16x64_bf16 v[180:183], a[236:239], v[204:211], v38 abid:1
    v_smfmac_f32_16x16x64_bf16 v[184:187], a[204:207], v[196:203], v35
    v_smfmac_f32_16x16x64_bf16 v[184:187], a[240:243], v[204:211], v39
    v_smfmac_f32_16x16x64_bf16 v[188:191], a[208:211], v[196:203], v35 abid:1
    v_smfmac_f32_16x16x64_bf16 v[188:191], a[244:247], v[204:211], v39 abid:1
    s_waitcnt lgkmcnt(2)
    v_smfmac_f32_16x16x64_bf16 v[176:179], v[68:71], v[220:227], v42
    s_waitcnt lgkmcnt(0)
    v_smfmac_f32_16x16x64_bf16 v[176:179], v[104:107], v[228:235], v46
    v_smfmac_f32_16x16x64_bf16 v[180:183], v[72:75], v[220:227], v42 abid:1
    v_smfmac_f32_16x16x64_bf16 v[180:183], v[108:111], v[228:235], v46 abid:1
    v_smfmac_f32_16x16x64_bf16 v[184:187], v[76:79], v[220:227], v43
    v_smfmac_f32_16x16x64_bf16 v[184:187], v[112:115], v[228:235], v47
    v_smfmac_f32_16x16x64_bf16 v[188:191], v[80:83], v[220:227], v43 abid:1
    v_smfmac_f32_16x16x64_bf16 v[188:191], v[116:119], v[228:235], v47 abid:1
    s_nop 1
    v_cvt_pk_bf16_f32 v176, v176, v177
    v_cvt_pk_bf16_f32 v177, v178, v179
    v_cvt_pk_bf16_f32 v178, v180, v181
    v_cvt_pk_bf16_f32 v179, v182, v183
    v_cvt_pk_bf16_f32 v184, v184, v185
    v_cvt_pk_bf16_f32 v185, v186, v187
    v_cvt_pk_bf16_f32 v186, v188, v189
    v_cvt_pk_bf16_f32 v187, v190, v191
    v_cndmask_b32_dpp v180, v176, v184, vcc row_ror:8 row_mask:0xf bank_mask:0xf
    v_cndmask_b32_dpp v181, v177, v185, vcc row_ror:8 row_mask:0xf bank_mask:0xf
    v_cndmask_b32_dpp v182, v178, v186, vcc row_ror:8 row_mask:0xf bank_mask:0xf
    v_cndmask_b32_dpp v183, v179, v187, vcc row_ror:8 row_mask:0xf bank_mask:0xf
    buffer_store_dwordx4 v[180:183], v6, s[12:15], s58 offen offset:128 sc1
    v_mov_b32_dpp v176, v184 row_ror:8 row_mask:0xf bank_mask:0xc
    v_mov_b32_dpp v177, v185 row_ror:8 row_mask:0xf bank_mask:0xc
    v_mov_b32_dpp v178, v186 row_ror:8 row_mask:0xf bank_mask:0xc
    v_mov_b32_dpp v179, v187 row_ror:8 row_mask:0xf bank_mask:0xc
    buffer_store_dwordx4 v[176:179], v6, s[12:15], s23 offen offset:128 sc1
M_done:
M_end:
    s_endpgm
M_pf_spin:
    s_sleep 4
    v_mov_b32 v0, 0
    s_mov_b64 exec, 1
    buffer_atomic_add v0, off, s[16:19], s96 sc0 sc1
    s_mov_b64 exec, -1
    s_add_u32 s31, s31, 1
    s_waitcnt vmcnt(0)
    v_readfirstlane_b32 s30, v0
    s_nop 0
    s_sub_u32 s30, s30, s100
    s_cmp_eq_u32 s30, 27
    s_cbranch_scc1 M_pf_ok
    s_cmp_lt_u32 s31, 6
    s_cbranch_scc1 M_pf_spin
    s_cmp_eq_u32 s98, 0
    s_cbranch_scc1 M_pf_spin2
    s_mov_b32 s98, 0
    v_mov_b32 v250, 1
    s_mov_b64 exec, 1
    buffer_atomic_add v250, off, s[68:71], 0 offset:0 sc1
    s_mov_b64 exec, -1
    s_nop 3
M_pf_spin2:
    buffer_load_dword v0, off, s[68:71], 0 offset:0 sc1
    s_cmp_ge_u32 s31, 131072
    s_cbranch_scc1 M_end
    s_waitcnt vmcnt(0)
    v_readfirstlane_b32 s30, v0
    s_nop 0
    s_cmp_eq_u32 s30, 81
    s_cbranch_scc0 M_pf_spin
    s_branch M_pf_ok
M_r3:
    v_bfe_u32 v110, v96, 24, 4
    v_lshlrev_b32 v111, 1, v96
    v_lshl_add_u32 v110, v110, 2, s49
    v_and_b32 v111, 16, v111
    v_and_or_b32 v110, v96, 2.0, v110
    v_lshlrev_b32 v111, v111, 1
    ds_add_rtn_u32 v100, v110, v111
    v_and_b32 v110, 8, v96
    v_lshrrev_b32 v113, 14, v96
    v_cmp_ne_u32 s[44:45], 0, v110
    v_and_b32 v116, 0x3cf0, v113
    s_waitcnt lgkmcnt(0)
    v_lshrrev_b32 v111, 16, v100
    v_and_b32 v112, 0xffff, v100
    v_sub_u32 v110, 15, v111
    v_and_b32 v100, 2.0, v96
    v_add3_u32 v100, v112, v111, v100
    v_cndmask_b32 v110, v112, v110, s[44:45]
    v_cmp_gt_u32 s[44:45], 16, v100
    v_cmp_gt_u32 s[36:37], 2.0, v100
    v_lshlrev_b32 v110, 2, v110
    v_lshrrev_b64 v[112:113], v110, s[50:51]
    s_andn2_b64 s[36:37], s[36:37], s[44:45]
    v_lshrrev_b64 v[114:115], v110, s[52:53]
    v_bfe_u32 v110, v96, 24, 4
    v_mbcnt_lo_u32_b32 v111, s36, 0
    v_and_b32 v112, 15, v112
    v_mbcnt_hi_u32_b32 v111, s37, v111
    v_and_b32 v114, 15, v114
    v_lshl_add_u32 v111, v111, 3, s40
    v_lshl_add_u32 v112, v110, 4, v112
    v_min_u32 v111, s41, v111
    v_mul_u32_u24 v114, 68, v114
    v_cndmask_b32 v111, v118, v111, s[36:37]
    ds_write_b64 v111, v[96:97]
    s_bcnt1_i32_b64 s30, s[36:37]
    s_lshl3_add_u32 s40, s30, s40
    v_lshl_add_u32 v112, v112, 2, s47
    v_and_b32 v114, 0x30c, v114
    v_cndmask_b32 v112, v118, v112, s[44:45]
    v_add3_u32 v113, v116, v114, s29
    v_and_b32 v114, 0x3fff, v96
    v_cndmask_b32 v110, v118, v113, s[44:45]
    ds_write_b32 v112, v114
    ds_write_b32 v110, v97
    s_cmp_gt_u32 s38, s39
    s_cselect_b32 s32, 1, s32
    s_branch M_r3r
M_dn:
    s_mov_b32 s27, 0
    s_mov_b32 s46, 0x80000000
    v_mov_b32 v244, 0
    v_mov_b32 v245, 0
    v_mov_b32 v246, 0
    v_mov_b32 v247, 0
    ds_write_b128 v8, v[244:247] offset:0
    ds_write_b128 v8, v[244:247] offset:1024
    ds_write_b128 v8, v[244:247] offset:2048
    ds_write_b128 v8, v[244:247] offset:3072
    ds_write_b128 v8, v[244:247] offset:4096
    ds_write_b128 v8, v[244:247] offset:5120
    ds_write_b128 v8, v[244:247] offset:6144
    ds_write_b128 v8, v[244:247] offset:7168
    ds_write_b128 v8, v[244:247] offset:8192
    s_waitcnt lgkmcnt(0)
    s_branch M_dnr
M_ovc0:
    v_smfmac_f32_16x16x32_bf16 v[124:127], v[54:55], v[212:215], v10
    v_smfmac_f32_16x16x32_bf16 v[160:163], v[54:55], v[212:215], v10 abid:2
    s_setpc_b64 s[74:75]
    v_smfmac_f32_16x16x32_bf16 v[128:131], v[54:55], v[212:215], v10
    v_smfmac_f32_16x16x32_bf16 v[164:167], v[54:55], v[212:215], v10 abid:2
    s_setpc_b64 s[74:75]
    v_smfmac_f32_16x16x32_bf16 v[132:135], v[54:55], v[212:215], v10
    v_smfmac_f32_16x16x32_bf16 v[168:171], v[54:55], v[212:215], v10 abid:2
    s_setpc_b64 s[74:75]
    v_smfmac_f32_16x16x32_bf16 v[136:139], v[54:55], v[212:215], v10
    v_smfmac_f32_16x16x32_bf16 v[172:175], v[54:55], v[212:215], v10 abid:2
    s_setpc_b64 s[74:75]
    v_smfmac_f32_16x16x32_bf16 v[140:143], v[54:55], v[212:215], v10
    v_smfmac_f32_16x16x32_bf16 v[176:179], v[54:55], v[212:215], v10 abid:2
    s_setpc_b64 s[74:75]
    v_smfmac_f32_16x16x32_bf16 v[144:147], v[54:55], v[212:215], v10
    v_smfmac_f32_16x16x32_bf16 v[180:183], v[54:55], v[212:215], v10 abid:2
    s_setpc_b64 s[74:75]
    v_smfmac_f32_16x16x32_bf16 v[148:151], v[54:55], v[212:215], v10
    v_smfmac_f32_16x16x32_bf16 v[184:187], v[54:55], v[212:215], v10 abid:2
    s_setpc_b64 s[74:75]
    v_smfmac_f32_16x16x32_bf16 v[152:155], v[54:55], v[212:215], v10
    v_smfmac_f32_16x16x32_bf16 v[188:191], v[54:55], v[212:215], v10 abid:2
    s_setpc_b64 s[74:75]
    v_smfmac_f32_16x16x32_bf16 v[156:159], v[54:55], v[212:215], v10
    v_smfmac_f32_16x16x32_bf16 v[192:195], v[54:55], v[212:215], v10 abid:2
    s_setpc_b64 s[74:75]
M_ovl0:
    v_smfmac_f32_16x16x32_bf16 v[124:127], v[54:55], v[212:215], v10
    v_smfmac_f32_16x16x32_bf16 v[160:163], v[54:55], v[212:215], v10 abid:2
    s_setpc_b64 s[78:79]
    v_smfmac_f32_16x16x32_bf16 v[128:131], v[54:55], v[212:215], v10
    v_smfmac_f32_16x16x32_bf16 v[164:167], v[54:55], v[212:215], v10 abid:2
    s_setpc_b64 s[78:79]
    v_smfmac_f32_16x16x32_bf16 v[132:135], v[54:55], v[212:215], v10
    v_smfmac_f32_16x16x32_bf16 v[168:171], v[54:55], v[212:215], v10 abid:2
    s_setpc_b64 s[78:79]
    v_smfmac_f32_16x16x32_bf16 v[136:139], v[54:55], v[212:215], v10
    v_smfmac_f32_16x16x32_bf16 v[172:175], v[54:55], v[212:215], v10 abid:2
    s_setpc_b64 s[78:79]
    v_smfmac_f32_16x16x32_bf16 v[140:143], v[54:55], v[212:215], v10
    v_smfmac_f32_16x16x32_bf16 v[176:179], v[54:55], v[212:215], v10 abid:2
    s_setpc_b64 s[78:79]
    v_smfmac_f32_16x16x32_bf16 v[144:147], v[54:55], v[212:215], v10
    v_smfmac_f32_16x16x32_bf16 v[180:183], v[54:55], v[212:215], v10 abid:2
    s_setpc_b64 s[78:79]
    v_smfmac_f32_16x16x32_bf16 v[148:151], v[54:55], v[212:215], v10
    v_smfmac_f32_16x16x32_bf16 v[184:187], v[54:55], v[212:215], v10 abid:2
    s_setpc_b64 s[78:79]
    v_smfmac_f32_16x16x32_bf16 v[152:155], v[54:55], v[212:215], v10
    v_smfmac_f32_16x16x32_bf16 v[188:191], v[54:55], v[212:215], v10 abid:2
    s_setpc_b64 s[78:79]
    v_smfmac_f32_16x16x32_bf16 v[156:159], v[54:55], v[212:215], v10
    v_smfmac_f32_16x16x32_bf16 v[192:195], v[54:55], v[212:215], v10 abid:2
    s_setpc_b64 s[78:79]
M_ovc1:
    v_smfmac_f32_16x16x32_bf16 v[124:127], v[252:253], v[212:215], v10
    v_smfmac_f32_16x16x32_bf16 v[160:163], v[252:253], v[212:215], v10 abid:2
    s_setpc_b64 s[76:77]
    v_smfmac_f32_16x16x32_bf16 v[128:131], v[252:253], v[212:215], v10
    v_smfmac_f32_16x16x32_bf16 v[164:167], v[252:253], v[212:215], v10 abid:2
    s_setpc_b64 s[76:77]
    v_smfmac_f32_16x16x32_bf16 v[132:135], v[252:253], v[212:215], v10
    v_smfmac_f32_16x16x32_bf16 v[168:171], v[252:253], v[212:215], v10 abid:2
    s_setpc_b64 s[76:77]
    v_smfmac_f32_16x16x32_bf16 v[136:139], v[252:253], v[212:215], v10
    v_smfmac_f32_16x16x32_bf16 v[172:175], v[252:253], v[212:215], v10 abid:2
    s_setpc_b64 s[76:77]
    v_smfmac_f32_16x16x32_bf16 v[140:143], v[252:253], v[212:215], v10
    v_smfmac_f32_16x16x32_bf16 v[176:179], v[252:253], v[212:215], v10 abid:2
    s_setpc_b64 s[76:77]
    v_smfmac_f32_16x16x32_bf16 v[144:147], v[252:253], v[212:215], v10
    v_smfmac_f32_16x16x32_bf16 v[180:183], v[252:253], v[212:215], v10 abid:2
    s_setpc_b64 s[76:77]
    v_smfmac_f32_16x16x32_bf16 v[148:151], v[252:253], v[212:215], v10
    v_smfmac_f32_16x16x32_bf16 v[184:187], v[252:253], v[212:215], v10 abid:2
    s_setpc_b64 s[76:77]
    v_smfmac_f32_16x16x32_bf16 v[152:155], v[252:253], v[212:215], v10
    v_smfmac_f32_16x16x32_bf16 v[188:191], v[252:253], v[212:215], v10 abid:2
    s_setpc_b64 s[76:77]
    v_smfmac_f32_16x16x32_bf16 v[156:159], v[252:253], v[212:215], v10
    v_smfmac_f32_16x16x32_bf16 v[192:195], v[252:253], v[212:215], v10 abid:2
    s_setpc_b64 s[76:77]
M_ovl1:
    v_smfmac_f32_16x16x32_bf16 v[124:127], v[252:253], v[212:215], v10
    v_smfmac_f32_16x16x32_bf16 v[160:163], v[252:253], v[212:215], v10 abid:2
    s_setpc_b64 s[78:79]
    v_smfmac_f32_16x16x32_bf16 v[128:131], v[252:253], v[212:215], v10
    v_smfmac_f32_16x16x32_bf16 v[164:167], v[252:253], v[212:215], v10 abid:2
    s_setpc_b64 s[78:79]
    v_smfmac_f32_16x16x32_bf16 v[132:135], v[252:253], v[212:215], v10
    v_smfmac_f32_16x16x32_bf16 v[168:171], v[252:253], v[212:215], v10 abid:2
    s_setpc_b64 s[78:79]
    v_smfmac_f32_16x16x32_bf16 v[136:139], v[252:253], v[212:215], v10
    v_smfmac_f32_16x16x32_bf16 v[172:175], v[252:253], v[212:215], v10 abid:2
    s_setpc_b64 s[78:79]
    v_smfmac_f32_16x16x32_bf16 v[140:143], v[252:253], v[212:215], v10
    v_smfmac_f32_16x16x32_bf16 v[176:179], v[252:253], v[212:215], v10 abid:2
    s_setpc_b64 s[78:79]
    v_smfmac_f32_16x16x32_bf16 v[144:147], v[252:253], v[212:215], v10
    v_smfmac_f32_16x16x32_bf16 v[180:183], v[252:253], v[212:215], v10 abid:2
    s_setpc_b64 s[78:79]
    v_smfmac_f32_16x16x32_bf16 v[148:151], v[252:253], v[212:215], v10
    v_smfmac_f32_16x16x32_bf16 v[184:187], v[252:253], v[212:215], v10 abid:2
    s_setpc_b64 s[78:79]
    v_smfmac_f32_16x16x32_bf16 v[152:155], v[252:253], v[212:215], v10
    v_smfmac_f32_16x16x32_bf16 v[188:191], v[252:253], v[212:215], v10 abid:2
    s_setpc_b64 s[78:79]
    v_smfmac_f32_16x16x32_bf16 v[156:159], v[252:253], v[212:215], v10
    v_smfmac_f32_16x16x32_bf16 v[192:195], v[252:253], v[212:215], v10 abid:2
    s_setpc_b64 s[78:79]
M_ovl2:
    v_smfmac_f32_16x16x32_bf16 v[124:127], v[254:255], v[212:215], v10
    v_smfmac_f32_16x16x32_bf16 v[160:163], v[254:255], v[212:215], v10 abid:2
    s_setpc_b64 s[78:79]
    v_smfmac_f32_16x16x32_bf16 v[128:131], v[254:255], v[212:215], v10
    v_smfmac_f32_16x16x32_bf16 v[164:167], v[254:255], v[212:215], v10 abid:2
    s_setpc_b64 s[78:79]
    v_smfmac_f32_16x16x32_bf16 v[132:135], v[254:255], v[212:215], v10
    v_smfmac_f32_16x16x32_bf16 v[168:171], v[254:255], v[212:215], v10 abid:2
    s_setpc_b64 s[78:79]
    v_smfmac_f32_16x16x32_bf16 v[136:139], v[254:255], v[212:215], v10
    v_smfmac_f32_16x16x32_bf16 v[172:175], v[254:255], v[212:215], v10 abid:2
    s_setpc_b64 s[78:79]
    v_smfmac_f32_16x16x32_bf16 v[140:143], v[254:255], v[212:215], v10
    v_smfmac_f32_16x16x32_bf16 v[176:179], v[254:255], v[212:215], v10 abid:2
    s_setpc_b64 s[78:79]
    v_smfmac_f32_16x16x32_bf16 v[144:147], v[254:255], v[212:215], v10
    v_smfmac_f32_16x16x32_bf16 v[180:183], v[254:255], v[212:215], v10 abid:2
    s_setpc_b64 s[78:79]
    v_smfmac_f32_16x16x32_bf16 v[148:151], v[254:255], v[212:215], v10
    v_smfmac_f32_16x16x32_bf16 v[184:187], v[254:255], v[212:215], v10 abid:2
    s_setpc_b64 s[78:79]
    v_smfmac_f32_16x16x32_bf16 v[152:155], v[254:255], v[212:215], v10
    v_smfmac_f32_16x16x32_bf16 v[188:191], v[254:255], v[212:215], v10 abid:2
    s_setpc_b64 s[78:79]
    v_smfmac_f32_16x16x32_bf16 v[156:159], v[254:255], v[212:215], v10
    v_smfmac_f32_16x16x32_bf16 v[192:195], v[254:255], v[212:215], v10 abid:2
    s_setpc_b64 s[78:79]
M_ovn:
    s_setpc_b64 s[78:79]
M_slow:
    s_bitcmp1_b32 s46, 31
    s_cbranch_scc1 M_dense
    s_mov_b32 s56, s80
M_sl:
    s_lshl_b32 s57, s56, 6
    v_add_u32 v240, s57, v9
    ds_read_b128 v[248:251], v240 offset:9792
    s_waitcnt lgkmcnt(0)
    v_and_b32 v240, 0x3fff, v248
    v_and_b32 v241, 0x3fff, v250
    v_xad_u32 v240, v240, v3, v4
    v_xad_u32 v241, v241, v3, v4
    ds_read2st64_b32 v[244:245], v240 offset0:0 offset1:72
    ds_read2st64_b32 v[246:247], v241 offset0:0 offset1:72
    v_subrev_u32 v240, s29, v8
    v_bfe_u32 v240, v240, 4, 4
    s_waitcnt lgkmcnt(0)
    s_bitcmp1_b32 s27, 0
    s_cbranch_scc0 M_sle0
    v_lshrrev_b32 v242, 18, v248
    v_lshrrev_b32 v243, 18, v250
    v_or_b32 v241, 0, v240
    v_cmp_eq_u32 s[44:45], v242, v241
    v_cmp_eq_u32 s[54:55], v243, v241
    s_nop 0
    v_cndmask_b32 v242, 0, v249, s[44:45]
    v_cndmask_b32 v243, 0, v251, s[54:55]
    s_nop 1
    v_smfmac_f32_16x16x32_bf16 v[124:127], v[242:243], v[244:247], v10
    v_smfmac_f32_16x16x32_bf16 v[160:163], v[242:243], v[244:247], v10 abid:2
M_sle0:
    s_bitcmp1_b32 s27, 1
    s_cbranch_scc0 M_sle1
    v_lshrrev_b32 v242, 18, v248
    v_lshrrev_b32 v243, 18, v250
    v_or_b32 v241, 64, v240
    v_cmp_eq_u32 s[44:45], v242, v241
    v_cmp_eq_u32 s[54:55], v243, v241
    s_nop 0
    v_cndmask_b32 v242, 0, v249, s[44:45]
    v_cndmask_b32 v243, 0, v251, s[54:55]
    s_nop 1
    v_smfmac_f32_16x16x32_bf16 v[128:131], v[242:243], v[244:247], v10
    v_smfmac_f32_16x16x32_bf16 v[164:167], v[242:243], v[244:247], v10 abid:2
M_sle1:
    s_bitcmp1_b32 s27, 2
    s_cbranch_scc0 M_sle2
    v_lshrrev_b32 v242, 18, v248
    v_lshrrev_b32 v243, 18, v250
    v_or_b32 v241, 128, v240
    v_cmp_eq_u32 s[44:45], v242, v241
    v_cmp_eq_u32 s[54:55], v243, v241
    s_nop 0
    v_cndmask_b32 v242, 0, v249, s[44:45]
    v_cndmask_b32 v243, 0, v251, s[54:55]
    s_nop 1
    v_smfmac_f32_16x16x32_bf16 v[132:135], v[242:243], v[244:247], v10
    v_smfmac_f32_16x16x32_bf16 v[168:171], v[242:243], v[244:247], v10 abid:2
M_sle2:
    s_bitcmp1_b32 s27, 3
    s_cbranch_scc0 M_sle3
    v_lshrrev_b32 v242, 18, v248
    v_lshrrev_b32 v243, 18, v250
    v_or_b32 v241, 192, v240
    v_cmp_eq_u32 s[44:45], v242, v241
    v_cmp_eq_u32 s[54:55], v243, v241
    s_nop 0
    v_cndmask_b32 v242, 0, v249, s[44:45]
    v_cndmask_b32 v243, 0, v251, s[54:55]
    s_nop 1
    v_smfmac_f32_16x16x32_bf16 v[136:139], v[242:243], v[244:247], v10
    v_smfmac_f32_16x16x32_bf16 v[172:175], v[242:243], v[244:247], v10 abid:2
M_sle3:
    s_bitcmp1_b32 s27, 4
    s_cbranch_scc0 M_sle4
    v_lshrrev_b32 v242, 18, v248
    v_lshrrev_b32 v243, 18, v250
    v_or_b32 v241, 256, v240
    v_cmp_eq_u32 s[44:45], v242, v241
    v_cmp_eq_u32 s[54:55], v243, v241
    s_nop 0
    v_cndmask_b32 v242, 0, v249, s[44:45]
    v_cndmask_b32 v243, 0, v251, s[54:55]
    s_nop 1
    v_smfmac_f32_16x16x32_bf16 v[140:143], v[242:243], v[244:247], v10
    v_smfmac_f32_16x16x32_bf16 v[176:179], v[242:243], v[244:247], v10 abid:2
M_sle4:
    s_bitcmp1_b32 s27, 5
    s_cbranch_scc0 M_sle5
    v_lshrrev_b32 v242, 18, v248
    v_lshrrev_b32 v243, 18, v250
    v_or_b32 v241, 320, v240
    v_cmp_eq_u32 s[44:45], v242, v241
    v_cmp_eq_u32 s[54:55], v243, v241
    s_nop 0
    v_cndmask_b32 v242, 0, v249, s[44:45]
    v_cndmask_b32 v243, 0, v251, s[54:55]
    s_nop 1
    v_smfmac_f32_16x16x32_bf16 v[144:147], v[242:243], v[244:247], v10
    v_smfmac_f32_16x16x32_bf16 v[180:183], v[242:243], v[244:247], v10 abid:2
M_sle5:
    s_bitcmp1_b32 s27, 6
    s_cbranch_scc0 M_sle6
    v_lshrrev_b32 v242, 18, v248
    v_lshrrev_b32 v243, 18, v250
    v_or_b32 v241, 384, v240
    v_cmp_eq_u32 s[44:45], v242, v241
    v_cmp_eq_u32 s[54:55], v243, v241
    s_nop 0
    v_cndmask_b32 v242, 0, v249, s[44:45]
    v_cndmask_b32 v243, 0, v251, s[54:55]
    s_nop 1
    v_smfmac_f32_16x16x32_bf16 v[148:151], v[242:243], v[244:247], v10
    v_smfmac_f32_16x16x32_bf16 v[184:187], v[242:243], v[244:247], v10 abid:2
M_sle6:
    s_bitcmp1_b32 s27, 7
    s_cbranch_scc0 M_sle7
    v_lshrrev_b32 v242, 18, v248
    v_lshrrev_b32 v243, 18, v250
    v_or_b32 v241, 448, v240
    v_cmp_eq_u32 s[44:45], v242, v241
    v_cmp_eq_u32 s[54:55], v243, v241
    s_nop 0
    v_cndmask_b32 v242, 0, v249, s[44:45]
    v_cndmask_b32 v243, 0, v251, s[54:55]
    s_nop 1
    v_smfmac_f32_16x16x32_bf16 v[152:155], v[242:243], v[244:247], v10
    v_smfmac_f32_16x16x32_bf16 v[188:191], v[242:243], v[244:247], v10 abid:2
M_sle7:
    s_bitcmp1_b32 s27, 8
    s_cbranch_scc0 M_sle8
    v_lshrrev_b32 v242, 18, v248
    v_lshrrev_b32 v243, 18, v250
    v_or_b32 v241, 512, v240
    v_cmp_eq_u32 s[44:45], v242, v241
    v_cmp_eq_u32 s[54:55], v243, v241
    s_nop 0
    v_cndmask_b32 v242, 0, v249, s[44:45]
    v_cndmask_b32 v243, 0, v251, s[54:55]
    s_nop 1
    v_smfmac_f32_16x16x32_bf16 v[156:159], v[242:243], v[244:247], v10
    v_smfmac_f32_16x16x32_bf16 v[192:195], v[242:243], v[244:247], v10 abid:2
M_sle8:
    s_add_u32 s56, s56, 1
    s_cmp_lt_u32 s56, s46
    s_cbranch_scc1 M_sl
M_slx:
    s_nop 7
    s_cmp_eq_u32 s21, 1
    s_cbranch_scc1 M_slowrL
    s_cmp_eq_u32 s21, 2
    s_cbranch_scc1 M_slowrE0
    s_cmp_eq_u32 s21, 3
    s_cbranch_scc1 M_slowrQ
    s_cmp_eq_u32 s21, 4
    s_cbranch_scc1 M_slowrF
    s_cmp_eq_u32 s21, 5
    s_cbranch_scc1 M_slowrH
    s_branch M_slowr0
M_dense:
    s_mul_i32 s57, s20, 82944
    s_add_u32 s57, s57, 393216
    s_mov_b32 s56, 0
    v_mov_b32 v54, v1
    v_mov_b32 v55, v2
    v_subrev_u32 v252, s29, v8
M_dn0:
    ds_read_b128 v[244:247], v54 offset:0
    ds_read_b128 v[248:251], v55 offset:0
    v_add_u32 v54, 1024, v54
    v_add_u32 v55, 1024, v55
    buffer_load_dwordx4 v[240:243], v252, s[16:19], s57 offen sc1
    s_add_u32 s57, s57, 1024
    s_waitcnt vmcnt(0) lgkmcnt(0)
    v_smfmac_f32_16x16x64_bf16 v[124:127], v[240:243], v[244:251], v10
    buffer_load_dwordx4 v[240:243], v252, s[16:19], s57 offen sc1
    s_add_u32 s57, s57, 1024
    s_waitcnt vmcnt(0) lgkmcnt(0)
    v_smfmac_f32_16x16x64_bf16 v[128:131], v[240:243], v[244:251], v10
    buffer_load_dwordx4 v[240:243], v252, s[16:19], s57 offen sc1
    s_add_u32 s57, s57, 1024
    s_waitcnt vmcnt(0) lgkmcnt(0)
    v_smfmac_f32_16x16x64_bf16 v[132:135], v[240:243], v[244:251], v10
    buffer_load_dwordx4 v[240:243], v252, s[16:19], s57 offen sc1
    s_add_u32 s57, s57, 1024
    s_waitcnt vmcnt(0) lgkmcnt(0)
    v_smfmac_f32_16x16x64_bf16 v[136:139], v[240:243], v[244:251], v10
    buffer_load_dwordx4 v[240:243], v252, s[16:19], s57 offen sc1
    s_add_u32 s57, s57, 1024
    s_waitcnt vmcnt(0) lgkmcnt(0)
    v_smfmac_f32_16x16x64_bf16 v[140:143], v[240:243], v[244:251], v10
    buffer_load_dwordx4 v[240:243], v252, s[16:19], s57 offen sc1
    s_add_u32 s57, s57, 1024
    s_waitcnt vmcnt(0) lgkmcnt(0)
    v_smfmac_f32_16x16x64_bf16 v[144:147], v[240:243], v[244:251], v10
    buffer_load_dwordx4 v[240:243], v252, s[16:19], s57 offen sc1
    s_add_u32 s57, s57, 1024
    s_waitcnt vmcnt(0) lgkmcnt(0)
    v_smfmac_f32_16x16x64_bf16 v[148:151], v[240:243], v[244:251], v10
    buffer_load_dwordx4 v[240:243], v252, s[16:19], s57 offen sc1
    s_add_u32 s57, s57, 1024
    s_waitcnt vmcnt(0) lgkmcnt(0)
    v_smfmac_f32_16x16x64_bf16 v[152:155], v[240:243], v[244:251], v10
    buffer_load_dwordx4 v[240:243], v252, s[16:19], s57 offen sc1
    s_add_u32 s57, s57, 1024
    s_waitcnt vmcnt(0) lgkmcnt(0)
    v_smfmac_f32_16x16x64_bf16 v[156:159], v[240:243], v[244:251], v10
    s_add_u32 s56, s56, 1
    s_cmp_lt_u32 s56, 9
    s_cbranch_scc1 M_dn0
    s_mul_i32 s57, s20, 82944
    s_add_u32 s57, s57, 393216
    s_mov_b32 s56, 0
    v_mov_b32 v54, v1
    v_mov_b32 v55, v2
    v_subrev_u32 v252, s29, v8
M_dn1:
    ds_read_b128 v[244:247], v54 offset:18432
    ds_read_b128 v[248:251], v55 offset:18432
    v_add_u32 v54, 1024, v54
    v_add_u32 v55, 1024, v55
    buffer_load_dwordx4 v[240:243], v252, s[16:19], s57 offen sc1
    s_add_u32 s57, s57, 1024
    s_waitcnt vmcnt(0) lgkmcnt(0)
    v_smfmac_f32_16x16x64_bf16 v[160:163], v[240:243], v[244:251], v10
    buffer_load_dwordx4 v[240:243], v252, s[16:19], s57 offen sc1
    s_add_u32 s57, s57, 1024
    s_waitcnt vmcnt(0) lgkmcnt(0)
    v_smfmac_f32_16x16x64_bf16 v[164:167], v[240:243], v[244:251], v10
    buffer_load_dwordx4 v[240:243], v252, s[16:19], s57 offen sc1
    s_add_u32 s57, s57, 1024
    s_waitcnt vmcnt(0) lgkmcnt(0)
    v_smfmac_f32_16x16x64_bf16 v[168:171], v[240:243], v[244:251], v10
    buffer_load_dwordx4 v[240:243], v252, s[16:19], s57 offen sc1
    s_add_u32 s57, s57, 1024
    s_waitcnt vmcnt(0) lgkmcnt(0)
    v_smfmac_f32_16x16x64_bf16 v[172:175], v[240:243], v[244:251], v10
    buffer_load_dwordx4 v[240:243], v252, s[16:19], s57 offen sc1
    s_add_u32 s57, s57, 1024
    s_waitcnt vmcnt(0) lgkmcnt(0)
    v_smfmac_f32_16x16x64_bf16 v[176:179], v[240:243], v[244:251], v10
    buffer_load_dwordx4 v[240:243], v252, s[16:19], s57 offen sc1
    s_add_u32 s57, s57, 1024
    s_waitcnt vmcnt(0) lgkmcnt(0)
    v_smfmac_f32_16x16x64_bf16 v[180:183], v[240:243], v[244:251], v10
    buffer_load_dwordx4 v[240:243], v252, s[16:19], s57 offen sc1
    s_add_u32 s57, s57, 1024
    s_waitcnt vmcnt(0) lgkmcnt(0)
    v_smfmac_f32_16x16x64_bf16 v[184:187], v[240:243], v[244:251], v10
    buffer_load_dwordx4 v[240:243], v252, s[16:19], s57 offen sc1
    s_add_u32 s57, s57, 1024
    s_waitcnt vmcnt(0) lgkmcnt(0)
    v_smfmac_f32_16x16x64_bf16 v[188:191], v[240:243], v[244:251], v10
    buffer_load_dwordx4 v[240:243], v252, s[16:19], s57 offen sc1
    s_add_u32 s57, s57, 1024
    s_waitcnt vmcnt(0) lgkmcnt(0)
    v_smfmac_f32_16x16x64_bf16 v[192:195], v[240:243], v[244:251], v10
    s_add_u32 s56, s56, 1
    s_cmp_lt_u32 s56, 9
    s_cbranch_scc1 M_dn1
    s_branch M_slx
M_codeend:
.section .rodata,"a"
.p2align 6
.amdhsa_kernel standalone__structured_sparse_n_m__ragged_kernel
  .amdhsa_next_free_vgpr 512
  .amdhsa_next_free_sgpr 102
  .amdhsa_accum_offset 256
  .amdhsa_group_segment_fixed_size 0
  .amdhsa_kernarg_size 48
  .amdhsa_user_sgpr_count 2
  .amdhsa_user_sgpr_kernarg_segment_ptr 1
  .amdhsa_system_sgpr_workgroup_id_x 1
  .amdhsa_float_denorm_mode_32 3
.end_amdhsa_kernel
```

```asm
; @launch grid=(256,1,1) block=(256,1,1) lds=162064
.amdgcn_target "amdgcn-amd-amdhsa--gfx950"
.text
.globl standalone__structured_sparse_n_m__ragged_kernel
.p2align 8
.type standalone__structured_sparse_n_m__ragged_kernel,@function
standalone__structured_sparse_n_m__ragged_kernel:
    s_cmp_ge_u32 s2, 256
    s_cbranch_scc1 M_end
    s_load_dwordx8 s[72:79], s[0:1], 0
    s_load_dwordx4 s[80:83], s[0:1], 32
    s_getpc_b64 s[84:85]
    s_lshr_b32 s30, s2, 3
    s_and_b32 s30, s30, 15
    s_lshl_b32 s30, s30, 11
    s_and_b32 s84, s84, 0xffffff00
    s_cmp_ge_u32 s2, 88
    s_cselect_b32 s86, M_codeend-standalone__structured_sparse_n_m__ragged_kernel, 0
    s_mov_b32 s87, 0x20000
    v_lshlrev_b32 v254, 3, v0
    s_mov_b32 exec_lo, 0x00010001
    s_mov_b32 exec_hi, 0x00010001
    buffer_load_dword v254, v254, s[84:87], s30 offen
    s_mov_b64 exec, -1
    v_lshrrev_b32 v20, 6, v0
    v_and_b32 v12, 63, v0
    v_readfirstlane_b32 s20, v20
    v_lshrrev_b32 v22, 3, v0
    v_mul_u32_u24 v22, 1152, v22
    v_lshrrev_b32 v23, 4, v0
    v_xor_b32 v23, v23, v0
    v_and_b32 v23, 7, v23
    v_lshl_add_u32 v5, v23, 4, v22
    v_lshrrev_b32 v13, 4, v12
    v_and_b32 v14, 15, v12
    v_lshlrev_b32 v11, 4, v12
    v_lshlrev_b32 v54, 3, v12
    v_lshlrev_b32 v25, 4, v13
    v_lshlrev_b32 v26, 3, v13
    s_mov_b32 s6, 663552
    s_mov_b32 s7, 0x20000
    s_mov_b32 s10, 75497472
    s_mov_b32 s11, s7
    s_mov_b32 s18, 791552
    s_mov_b32 s19, s7
    s_movk_i32 s70, 256
    s_mov_b32 s71, s7
    s_movk_i32 s86, 1152
    s_mov_b32 s87, s7
    s_mov_b32 s98, 0
    s_mul_i32 s96, s20, 16
    s_and_b32 s97, s2, 15
    s_add_u32 s96, s96, s97
    s_lshl_b32 s96, s96, 8
    s_add_u32 s96, s96, 726016
    s_mul_i32 s22, s2, 36864
    s_mul_i32 s26, s20, 9216
    s_mov_b32 s24, s22
    s_mov_b32 s42, s26
    s_lshl_b32 s28, s20, 8
    s_lshl_b32 s97, s20, 5
    s_cmp_lt_u32 s2, 81
    s_cbranch_scc0 M_x1
    s_mul_i32 s32, s2, 57
    s_lshr_b32 s32, s32, 9
    s_mul_i32 s33, s32, 9
    s_sub_u32 s33, s2, s33
    s_mul_i32 s54, s32, 73728
    s_lshl_b32 s35, s33, 7
    s_add_u32 s54, s54, s35
    s_add_u32 s55, s54, 36864
    s_lshl_b32 s36, s20, 10
    s_add_u32 m0, s36, 73728
    s_lshr_b32 s30, s33, 1
    s_and_b32 s31, s33, 1
    s_lshl1_add_u32 s37, s32, s31
    s_mul_i32 s37, s37, 176
    s_mul_i32 s38, s32, 96
    s_add_u32 s38, s38, 3168
    s_cmp_lt_u32 s33, 8
    s_cselect_b32 s30, s30, s20
    s_cselect_b32 s37, s37, s38
    s_cselect_b32 s44, 2047, 63
    s_cselect_b32 s45, s20, 3
    s_cmp_eq_u32 s45, 3
    s_cselect_b32 s99, 791552, 0
    s_mul_i32 s48, s30, 98304
    s_add_u32 s37, s37, s48
    v_mov_b32 v44, 2.0
    v_mov_b32 v45, 0
    v_mov_b32 v46, 2.0
    v_mov_b32 v47, 0
    s_waitcnt lgkmcnt(0)
    s_mov_b64 s[4:5], s[74:75]
    buffer_load_dwordx4 v5, s[4:7], s54 offen lds
    s_add_u32 m0, m0, 4096
    s_mov_b32 s45, 0
    buffer_load_dwordx4 v5, s[4:7], s55 offen lds
    s_mov_b64 s[16:17], s[82:83]
    s_mov_b64 s[8:9], s[72:73]
    s_mov_b64 s[84:85], s[76:77]
    s_mov_b64 s[68:69], s[80:81]
    v_mov_b32 v10, 0
    s_mov_b64 exec, 1
    buffer_atomic_add v10, off, s[16:19], s96 sc0 sc1
    s_mov_b64 exec, -1
    s_mov_b64 exec, s[44:45]
    s_mov_b32 s18, s99
    buffer_store_dwordx4 v[44:47], v11, s[16:19], s37 offen sc1
    s_mov_b32 s18, 791552
    s_mov_b64 exec, -1
    s_mov_b32 m0, s42
    s_nop 0
    buffer_load_dwordx4 v5, s[8:11], s22 offen offset:0 nt lds
    s_add_u32 m0, m0, 896
    s_nop 0
    buffer_load_dwordx4 v5, s[8:11], s22 offen offset:128 nt lds
    s_add_u32 m0, m0, 896
    s_nop 0
    buffer_load_dwordx4 v5, s[8:11], s22 offen offset:256 nt lds
    s_lshl_b32 s34, s31, 2
    s_add_u32 s34, s34, s20
    s_lshr_b32 s35, s20, 1
    s_lshl_b32 s35, s35, 6
    s_and_b32 s36, s20, 1
    s_lshl_b32 s36, s36, 3
    s_add_u32 s35, s35, s36
    s_lshl_b32 s36, s20, 5
    s_mul_i32 s39, s32, 10240
    s_add_u32 s39, s39, 6144
    s_lshl_b32 s40, s34, 1
    s_add_u32 s40, s40, s39
    s_lshl_b32 s38, s32, 1
    s_cmp_eq_u32 s32, 8
    s_cselect_b32 s38, 1024, s38
    s_add_u32 s38, s38, 4096
    s_cmp_lt_u32 s33, 8
    s_cselect_b32 s34, s34, 8
    s_cselect_b32 s35, s35, s36
    s_cselect_b32 s36, 4, 3
    s_cselect_b32 s40, s40, s38
    s_cselect_b32 s46, 0, s20
    s_cselect_b32 s47, 22, 12
    s_add_u32 s40, s40, s48
    s_lshl_b32 s38, s34, 10
    s_add_u32 s39, s39, s38
    s_add_u32 s39, s39, s48
    s_add_u32 s39, s39, 1024
    v_and_b32 v15, 3, v14
    v_lshlrev_b32 v15, s36, v15
    v_add_u32 v15, s35, v15
    v_lshrrev_b32 v16, 3, v14
    v_lshlrev_b32 v16, 4, v16
    v_xor_b32 v15, v15, v16
    v_lshrrev_b32 v16, 2, v14
    v_lshl_add_u32 v16, v13, 4, v16
    v_lshl_add_u32 v15, v16, 7, v15
    v_add_u32 v24, 73728, v15
    v_xor_b32 v27, 32, v24
    v_xor_b32 v28, 64, v24
    v_xor_b32 v29, 0x60, v24
    s_lshl_b32 s31, s46, 2
    s_add_u32 s31, s31, 81920
    v_mov_b32 v60, s31
    v_mov_b32 v61, 1
    ds_write_b32 v60, v61
    s_mul_i32 s49, s30, 81
    s_mul_i32 s31, s32, 9
    s_add_u32 s49, s49, s31
    s_add_u32 s49, s49, s34
    s_lshl_b32 s49, s49, 10
    s_add_u32 s49, s49, 393216
    s_lshl_b32 s31, s34, 24
    s_lshl_b32 s38, s32, 10
    s_add_u32 s31, s31, s38
    v_lshlrev_b32 v31, 18, v14
    v_lshl_add_u32 v31, v13, 5, v31
    v_add_u32 v31, s31, v31
    s_mov_b32 s50, 3437096686
    s_mov_b32 s51, 1150609561
    s_mov_b32 s52, 0x00010001
    s_mov_b32 s53, 0x00200010
    s_mov_b32 s38, 0x0202
    s_mul_i32 s57, s30, 4096
    s_add_u32 s57, s57, 726016
    s_cmp_eq_u32 s33, 8
    s_cselect_b32 s56, 0, s20
    s_cmp_eq_u32 s20, 0
    s_cselect_b32 s98, 1, 0
    v_add_u32 v74, 81984, v54
    v_lshl_add_u32 v73, s20, 1, v74
    v_mov_b32 v41, 0x01000100
    v_mov_b32 v40, 0
    v_mov_b32 v63, -2.0
    s_waitcnt vmcnt(5) lgkmcnt(0)
    s_barrier
    ds_read_b64_tr_b16 v[16:17], v24
    ds_read_b64_tr_b16 v[18:19], v27 offset:512
    ds_read_b64_tr_b16 v[20:21], v28 offset:1024
    ds_read_b64_tr_b16 v[22:23], v29 offset:1536
    s_waitcnt lgkmcnt(3)
    v_and_b32 v44, 0x7fff7fff, v16
    v_and_b32 v45, 0x7fff7fff, v17
    v_pk_max_u16 v46, v44, v45
    v_pk_min_u16 v47, v44, v45
    v_pk_min_u16 v46, v46, v46 op_sel:[0,1] op_sel_hi:[1,0]
    v_pk_max_u16 v47, v47, v47 op_sel:[0,1] op_sel_hi:[1,0]
    v_pk_max_u16 v46, v46, s52
    v_pk_max_u16 v46, v46, v47
    v_pk_sub_i16 v44, v44, v46
    v_pk_sub_i16 v45, v45, v46
    v_pk_ashrrev_i16 v44, 15, v44 op_sel_hi:[0,1]
    v_pk_ashrrev_i16 v45, 15, v45 op_sel_hi:[0,1]
    v_alignbit_b32 v47, -1, v44, 16
    v_alignbit_b32 v46, v45, v45, 16
    v_and_b32 v48, 0x00080004, v44
    v_bitop3_b32 v46, v45, v46, v47 bitop3:0xe8
    v_and_or_b32 v64, v45, s53, v48
    v_bitop3_b32 v36, v16, v44, v46 bitop3:0x10
    v_min_u32 v68, 1, v36
    s_waitcnt lgkmcnt(2)
    v_and_b32 v44, 0x7fff7fff, v18
    v_and_b32 v45, 0x7fff7fff, v19
    v_pk_max_u16 v46, v44, v45
    v_pk_min_u16 v47, v44, v45
    v_pk_min_u16 v46, v46, v46 op_sel:[0,1] op_sel_hi:[1,0]
    v_pk_max_u16 v47, v47, v47 op_sel:[0,1] op_sel_hi:[1,0]
    v_pk_max_u16 v46, v46, s52
    v_pk_max_u16 v46, v46, v47
    v_pk_sub_i16 v44, v44, v46
    v_pk_sub_i16 v45, v45, v46
    v_pk_ashrrev_i16 v44, 15, v44 op_sel_hi:[0,1]
    v_pk_ashrrev_i16 v45, 15, v45 op_sel_hi:[0,1]
    v_alignbit_b32 v47, -1, v44, 16
    v_alignbit_b32 v46, v45, v45, 16
    v_and_b32 v48, 0x00080004, v44
    v_bitop3_b32 v46, v45, v46, v47 bitop3:0xe8
    v_and_or_b32 v65, v45, s53, v48
    v_bitop3_b32 v37, v18, v44, v46 bitop3:0x10
    v_min_u32 v69, 1, v37
    s_waitcnt lgkmcnt(1)
    v_and_b32 v44, 0x7fff7fff, v20
    v_and_b32 v45, 0x7fff7fff, v21
    v_pk_max_u16 v46, v44, v45
    v_pk_min_u16 v47, v44, v45
    v_pk_min_u16 v46, v46, v46 op_sel:[0,1] op_sel_hi:[1,0]
    v_pk_max_u16 v47, v47, v47 op_sel:[0,1] op_sel_hi:[1,0]
    v_pk_max_u16 v46, v46, s52
    v_pk_max_u16 v46, v46, v47
    v_pk_sub_i16 v44, v44, v46
    v_pk_sub_i16 v45, v45, v46
    v_pk_ashrrev_i16 v44, 15, v44 op_sel_hi:[0,1]
    v_pk_ashrrev_i16 v45, 15, v45 op_sel_hi:[0,1]
    v_alignbit_b32 v47, -1, v44, 16
    v_alignbit_b32 v46, v45, v45, 16
    v_and_b32 v48, 0x00080004, v44
    v_bitop3_b32 v46, v45, v46, v47 bitop3:0xe8
    v_and_or_b32 v66, v45, s53, v48
    v_bitop3_b32 v38, v20, v44, v46 bitop3:0x10
    v_min_u32 v70, 1, v38
    s_waitcnt lgkmcnt(0)
    v_and_b32 v44, 0x7fff7fff, v22
    v_and_b32 v45, 0x7fff7fff, v23
    v_pk_max_u16 v46, v44, v45
    v_pk_min_u16 v47, v44, v45
    v_pk_min_u16 v46, v46, v46 op_sel:[0,1] op_sel_hi:[1,0]
    v_pk_max_u16 v47, v47, v47 op_sel:[0,1] op_sel_hi:[1,0]
    v_pk_max_u16 v46, v46, s52
    v_pk_max_u16 v46, v46, v47
    v_pk_sub_i16 v44, v44, v46
    v_pk_sub_i16 v45, v45, v46
    v_pk_ashrrev_i16 v44, 15, v44 op_sel_hi:[0,1]
    v_pk_ashrrev_i16 v45, 15, v45 op_sel_hi:[0,1]
    v_alignbit_b32 v47, -1, v44, 16
    v_alignbit_b32 v46, v45, v45, 16
    v_and_b32 v48, 0x00080004, v44
    v_bitop3_b32 v46, v45, v46, v47 bitop3:0xe8
    v_and_or_b32 v67, v45, s53, v48
    v_bitop3_b32 v39, v22, v44, v46 bitop3:0x10
    v_min_u32 v71, 1, v39
    v_add_u32 v72, v68, v69
    v_add3_u32 v72, v72, v70, v71
    buffer_store_dwordx4 v[36:39], v11, s[16:19], s49 offen sc1
    v_cmp_ne_u32 vcc, 0, v72
    s_and_saveexec_b64 s[44:45], vcc
    ds_add_rtn_u32 v62, v60, v72
    s_mov_b64 exec, -1
    v_lshrrev_b32 v48, 16, v64
    v_or_b32 v48, v48, v64
    v_lshrrev_b64 v[52:53], v48, s[50:51]
    v_and_b32 v64, 15, v52
    v_lshl_or_b32 v40, v64, 0, v40
    v_lshrrev_b32 v48, 16, v65
    v_or_b32 v48, v48, v65
    v_lshrrev_b64 v[52:53], v48, s[50:51]
    v_and_b32 v65, 15, v52
    v_lshl_or_b32 v40, v65, 4, v40
    v_lshrrev_b32 v48, 16, v66
    v_or_b32 v48, v48, v66
    v_lshrrev_b64 v[52:53], v48, s[50:51]
    v_and_b32 v66, 15, v52
    v_lshl_or_b32 v40, v66, 8, v40
    v_lshrrev_b32 v48, 16, v67
    v_or_b32 v48, v48, v67
    v_lshrrev_b64 v[52:53], v48, s[50:51]
    v_and_b32 v67, 15, v52
    v_lshl_or_b32 v40, v67, 12, v40
    v_lshrrev_b32 v44, 2, v40
    v_lshlrev_b32 v45, 2, v40
    s_movk_i32 s31, 0x3333
    v_not_b32 v47, v40
    v_bfi_b32 v44, s31, v44, v45
    s_movk_i32 s31, 0x1111
    s_nop 0
    v_mov_b32_dpp v47, v44 row_shr:4 row_mask:0xf bank_mask:0xf
    v_xor_b32 v47, v47, v40
    v_lshrrev_b32 v45, 1, v47
    v_or_b32 v47, v47, v45
    v_lshrrev_b32 v45, 2, v47
    v_bitop3_b32 v47, v47, v45, s31 bitop3:0x2a
    s_nop 1
    v_xor_b32_dpp v47, v47, v47 row_shr:4 row_mask:0xf bank_mask:0xe
    s_nop 1
    v_xor_b32_dpp v47, v47, v47 row_shr:8 row_mask:0xf bank_mask:0xc
    v_mul_u32_u24 v47, 15, v47
    v_bfi_b32 v40, v47, v44, v40
    ds_write_b16 v73, v40
    v_bfe_u32 v64, v40, 0, 4
    v_mul_u32_u24 v46, 0x4001, v64
    v_and_b32 v46, 0x30003, v46
    v_mad_u32_u24 v46, v46, s38, v41
    v_perm_b32 v32, v17, v16, v46
    v_bfe_u32 v65, v40, 4, 4
    v_mul_u32_u24 v46, 0x4001, v65
    v_and_b32 v46, 0x30003, v46
    v_mad_u32_u24 v46, v46, s38, v41
    v_perm_b32 v33, v19, v18, v46
    s_waitcnt vmcnt(4) lgkmcnt(0)
    s_barrier
    ds_read_b64 v[50:51], v74
    v_bfe_u32 v66, v40, 8, 4
    v_mul_u32_u24 v46, 0x4001, v66
    v_and_b32 v46, 0x30003, v46
    v_mad_u32_u24 v46, v46, s38, v41
    v_perm_b32 v34, v21, v20, v46
    v_bfe_u32 v67, v40, 12, 4
    v_mul_u32_u24 v46, 0x4001, v67
    v_and_b32 v46, 0x30003, v46
    v_mad_u32_u24 v46, v46, s38, v41
    v_perm_b32 v35, v23, v22, v46
    buffer_store_dwordx4 v[32:35], v11, s[16:19], s39 offen sc1
    s_cmp_eq_u32 s33, 8
    s_cbranch_scc0 F_i1
    buffer_store_short v40, v11, s[16:19], s40 offen sc1
    s_branch F_i2
F_i1:
    s_cmp_eq_u32 s20, 0
    s_cbranch_scc0 F_i2
    s_waitcnt lgkmcnt(0)
    buffer_store_dwordx2 v[50:51], v11, s[16:19], s40 offen sc1
F_i2:
    s_cbranch_vccz F_z
    v_cmp_ne_u32 vcc, 0, v36
    s_and_saveexec_b64 s[44:45], vcc
    s_cbranch_execz F_e0
    v_cmp_gt_u32 vcc, s47, v62
    v_add_u32 v42, 0, v31
    v_lshlrev_b32 v44, 3, v62
    v_add_u32 v62, 1, v62
    v_cndmask_b32 v42, v63, v42, vcc
    v_cndmask_b32 v43, 0, v36, vcc
    v_cndmask_b32 v44, 0, v44, vcc
    buffer_store_dwordx2 v[42:43], v44, s[16:19], s37 offen sc1
F_e0:
    s_mov_b64 exec, -1
    v_cmp_ne_u32 vcc, 0, v37
    s_and_saveexec_b64 s[44:45], vcc
    s_cbranch_execz F_e1
    v_cmp_gt_u32 vcc, s47, v62
    v_add_u32 v42, 8, v31
    v_lshlrev_b32 v44, 3, v62
    v_add_u32 v62, 1, v62
    v_cndmask_b32 v42, v63, v42, vcc
    v_cndmask_b32 v43, 0, v37, vcc
    v_cndmask_b32 v44, 0, v44, vcc
    buffer_store_dwordx2 v[42:43], v44, s[16:19], s37 offen sc1
F_e1:
    s_mov_b64 exec, -1
    v_cmp_ne_u32 vcc, 0, v38
    s_and_saveexec_b64 s[44:45], vcc
    s_cbranch_execz F_e2
    v_cmp_gt_u32 vcc, s47, v62
    v_add_u32 v42, 16, v31
    v_lshlrev_b32 v44, 3, v62
    v_add_u32 v62, 1, v62
    v_cndmask_b32 v42, v63, v42, vcc
    v_cndmask_b32 v43, 0, v38, vcc
    v_cndmask_b32 v44, 0, v44, vcc
    buffer_store_dwordx2 v[42:43], v44, s[16:19], s37 offen sc1
F_e2:
    s_mov_b64 exec, -1
    v_cmp_ne_u32 vcc, 0, v39
    s_and_saveexec_b64 s[44:45], vcc
    s_cbranch_execz F_e3
    v_cmp_gt_u32 vcc, s47, v62
    v_add_u32 v42, 24, v31
    v_lshlrev_b32 v44, 3, v62
    v_add_u32 v62, 1, v62
    v_cndmask_b32 v42, v63, v42, vcc
    v_cndmask_b32 v43, 0, v39, vcc
    v_cndmask_b32 v44, 0, v44, vcc
    buffer_store_dwordx2 v[42:43], v44, s[16:19], s37 offen sc1
F_e3:
    s_mov_b64 exec, -1
F_z:
    s_cmp_lg_u32 s2, 0
    s_cbranch_scc1 M_set
    v_mov_b32 v64, 0
    v_mov_b32 v65, 0
    v_mov_b32 v66, 0
    v_mov_b32 v67, 0
    s_mov_b32 s40, 724992
    buffer_store_dwordx4 v[64:67], v11, s[16:19], s40 offen sc1
    s_branch M_set
F_sig:
    v_lshlrev_b32 v30, 8, v12
    s_waitcnt vmcnt(0)
    s_barrier
    s_cmp_lg_u32 s56, 0
    s_cbranch_scc1 F_end
    s_bfm_b64 exec, 16, 0
    buffer_atomic_add v61, v30, s[16:19], s57 offen sc1
    s_mov_b64 exec, -1
F_end:
    s_add_u32 m0, m0, 896
    s_nop 0
    buffer_load_dwordx4 v5, s[8:11], s22 offen offset:384 nt lds
    s_add_u32 m0, m0, 896
    s_nop 0
    buffer_load_dwordx4 v5, s[8:11], s22 offen offset:512 nt lds
    s_branch M_x2
M_x1:
    s_waitcnt lgkmcnt(0)
    s_mov_b64 s[4:5], s[74:75]
    s_mov_b64 s[16:17], s[82:83]
    s_mov_b64 s[8:9], s[72:73]
    s_mov_b64 s[84:85], s[76:77]
    s_mov_b64 s[68:69], s[80:81]
    v_mov_b32 v10, 0
    s_mov_b64 exec, 1
    buffer_atomic_add v10, off, s[16:19], s96 sc0 sc1
    s_mov_b64 exec, -1
    s_mov_b32 m0, s42
    s_nop 0
    buffer_load_dwordx4 v5, s[8:11], s22 offen offset:0 nt lds
    s_add_u32 m0, m0, 896
    s_nop 0
    buffer_load_dwordx4 v5, s[8:11], s22 offen offset:128 nt lds
    s_add_u32 m0, m0, 896
    s_nop 0
    buffer_load_dwordx4 v5, s[8:11], s22 offen offset:256 nt lds
    s_add_u32 m0, m0, 896
    s_nop 0
    buffer_load_dwordx4 v5, s[8:11], s22 offen offset:384 nt lds
    s_add_u32 m0, m0, 896
    s_nop 0
    buffer_load_dwordx4 v5, s[8:11], s22 offen offset:512 nt lds
M_set:
    s_mov_b32 s12, s78
    s_mov_b32 s13, s79
    s_mov_b32 s14, 75497472
    s_mov_b32 s15, 0x20000
    s_mul_i32 s29, s20, 12864
    s_add_u32 s29, s29, 110592
    v_lshrrev_b32 v24, 1, v14
    v_and_b32 v27, 7, v14
    v_lshlrev_b32 v22, 7, v27
    v_lshl_or_b32 v3, v24, 4, v22
    v_lshrrev_b32 v23, 3, v14
    v_mul_u32_u24 v4, 9216, v23
    v_xad_u32 v1, v25, v3, v4
    v_xor_b32 v2, 64, v1
    v_add_u32 v9, s29, v25
    v_add_u32 v8, s29, v11
    v_mul_u32_u24 v24, 1152, v27
    v_lshl_add_u32 v24, v23, 6, v24
    v_add3_u32 v6, v24, v25, s28
    v_lshrrev_b32 v24, 3, v12
    v_xor_b32 v28, v24, v12
    v_and_b32 v28, 7, v28
    v_mul_u32_u24 v24, 1152, v24
    v_lshl_add_u32 v24, v28, 4, v24
    v_add_u32 v7, 1024, v24
    s_lshl_b32 s30, s20, 1
    v_lshrrev_b32 v24, 1, v13
    v_add_u32 v24, s30, v24
    v_xor_b32 v24, v24, v27
    v_lshl_add_u32 v24, v24, 4, v22
    v_and_b32 v28, 8, v26
    v_mul_u32_u24 v29, 12864, v23
    v_add3_u32 v24, v24, v28, v29
    v_add_u32 v53, 121408, v24
    s_lshr_b32 s30, s2, 3
    s_and_b32 s30, s30, 1
    s_mul_i32 s92, s30, 256
    s_add_u32 s92, s92, 562944
    s_add_u32 s30, s30, 768
    s_mul_i32 s93, s30, 36864
    s_mov_b32 s94, 73728
    s_and_b32 s95, s20, 1
    s_mul_i32 s95, s95, 9216
    s_add_u32 s59, s24, 9216
    s_mul_i32 s43, s20, 98304
    s_add_u32 s47, s29, 9216
    s_add_u32 s48, s29, 9792
    s_add_u32 s49, s29, 10112
    s_add_u32 s54, s29, 1073751872
    s_add_u32 s38, s26, 73728
    s_add_u32 s35, s38, 1024
    s_add_u32 s39, s38, 1536
    s_mov_b32 s40, s48
    s_add_u32 s41, s48, 256
    s_mov_b32 s50, 3130536464
    s_mov_b32 s51, 1164430831
    s_mov_b32 s52, 3696531472
    s_mov_b32 s53, 598435823
    v_mov_b32 v16, 0
    v_mov_b32 v17, 0
    v_mov_b32 v18, 0
    v_mov_b32 v19, 0
    v_cmp_gt_u32 s[44:45], 36, v12
    v_mov_b32 v20, 2.0
    s_nop 0
    v_cndmask_b32 v20, 0, v20, s[44:45]
    v_mov_b32 v21, v20
    v_mov_b32 v22, v20
    v_mov_b32 v23, v20
    v_mov_b32 v104, 1073741824
    v_mov_b32 v105, 0
    v_mov_b32 v106, 1073741824
    v_mov_b32 v107, 0
    v_lshl_add_u32 v121, v12, 2, s49
    v_add_u32 v55, s38, v54
    v_add_u32 v24, s38, v11
    ds_write_b128 v8, v[16:19] offset:0
    ds_write_b128 v8, v[16:19] offset:1024
    ds_write_b128 v8, v[16:19] offset:2048
    ds_write_b128 v8, v[16:19] offset:3072
    ds_write_b128 v8, v[16:19] offset:4096
    ds_write_b128 v8, v[16:19] offset:5120
    ds_write_b128 v8, v[16:19] offset:6144
    ds_write_b128 v8, v[16:19] offset:7168
    ds_write_b128 v8, v[16:19] offset:8192
    ds_write_b128 v24, v[104:107]
    ds_write_b128 v24, v[104:107] offset:1024
    ds_write_b128 v8, v[20:23] offset:9216
    s_cmp_lt_u32 s2, 81
    s_cbranch_scc1 F_sig
M_x2:
    s_add_u32 m0, m0, 896
    s_nop 0
    buffer_load_dwordx4 v5, s[8:11], s22 offen offset:640 nt lds
    s_add_u32 m0, m0, 896
    s_nop 0
    buffer_load_dwordx4 v5, s[8:11], s22 offen offset:768 nt lds
    s_add_u32 m0, m0, 896
    s_nop 0
    buffer_load_dwordx4 v5, s[8:11], s22 offen offset:896 nt lds
    s_add_u32 m0, m0, 896
    s_nop 0
    buffer_load_dwordx4 v5, s[8:11], s22 offen offset:1024 nt lds
    s_add_u32 s22, s22, 9437184
    s_add_u32 s42, s42, 36864
    buffer_load_dwordx4 v[196:199], v25, s[84:87], s28 offen offset:0
    buffer_load_dwordx4 v[200:203], v25, s[84:87], s28 offen offset:64
    buffer_load_dwordx4 v[204:207], v25, s[84:87], s28 offen offset:128
    buffer_load_dwordx4 v[208:211], v25, s[84:87], s28 offen offset:192
    buffer_load_dwordx2 v[212:213], v26, s[84:87], s97 offen offset:1024
    s_mov_b32 m0, s42
    s_nop 0
    buffer_load_dwordx4 v5, s[8:11], s22 offen offset:0 nt lds
    s_add_u32 m0, m0, 896
    s_nop 0
    buffer_load_dwordx4 v5, s[8:11], s22 offen offset:128 nt lds
    s_add_u32 m0, m0, 896
    s_nop 0
    buffer_load_dwordx4 v5, s[8:11], s22 offen offset:256 nt lds
    s_add_u32 m0, m0, 896
    s_nop 0
    buffer_load_dwordx4 v5, s[8:11], s22 offen offset:384 nt lds
    s_add_u32 m0, m0, 896
    s_nop 0
    buffer_load_dwordx4 v5, s[8:11], s22 offen offset:512 nt lds
    s_add_u32 m0, m0, 896
    s_nop 0
    buffer_load_dwordx4 v5, s[8:11], s22 offen offset:640 nt lds
    s_add_u32 m0, m0, 896
    s_nop 0
    buffer_load_dwordx4 v5, s[8:11], s22 offen offset:768 nt lds
    s_add_u32 m0, m0, 896
    s_nop 0
    buffer_load_dwordx4 v5, s[8:11], s22 offen offset:896 nt lds
    s_add_u32 m0, m0, 896
    s_nop 0
    buffer_load_dwordx4 v5, s[8:11], s22 offen offset:1024 nt lds
    s_add_u32 s22, s22, 9437184
    s_add_u32 s42, s42, 36864
    s_waitcnt vmcnt(3)
    v_mov_b32 v0, 0
    s_mov_b64 exec, 1
    buffer_atomic_add v0, off, s[16:19], s96 sc0 sc1
    s_mov_b64 exec, -1
    v_readlane_b32 s100, v10, 0
    v_mov_b32 v10, 0xeeee4444
    v_lshlrev_b32 v124, 16, v196
    v_and_b32 v125, 0xffff0000, v196
    v_lshlrev_b32 v126, 16, v197
    v_and_b32 v127, 0xffff0000, v197
    v_lshlrev_b32 v128, 16, v198
    v_and_b32 v129, 0xffff0000, v198
    v_lshlrev_b32 v130, 16, v199
    v_and_b32 v131, 0xffff0000, v199
    v_lshlrev_b32 v132, 16, v200
    v_and_b32 v133, 0xffff0000, v200
    v_lshlrev_b32 v134, 16, v201
    v_and_b32 v135, 0xffff0000, v201
    v_lshlrev_b32 v136, 16, v202
    v_and_b32 v137, 0xffff0000, v202
    v_lshlrev_b32 v138, 16, v203
    v_and_b32 v139, 0xffff0000, v203
    v_lshlrev_b32 v140, 16, v204
    v_and_b32 v141, 0xffff0000, v204
    v_lshlrev_b32 v142, 16, v205
    v_and_b32 v143, 0xffff0000, v205
    v_lshlrev_b32 v144, 16, v206
    v_and_b32 v145, 0xffff0000, v206
    v_lshlrev_b32 v146, 16, v207
    v_and_b32 v147, 0xffff0000, v207
    v_lshlrev_b32 v148, 16, v208
    v_and_b32 v149, 0xffff0000, v208
    v_lshlrev_b32 v150, 16, v209
    v_and_b32 v151, 0xffff0000, v209
    v_lshlrev_b32 v152, 16, v210
    v_and_b32 v153, 0xffff0000, v210
    v_lshlrev_b32 v154, 16, v211
    v_and_b32 v155, 0xffff0000, v211
    v_lshlrev_b32 v156, 16, v212
    v_and_b32 v157, 0xffff0000, v212
    v_lshlrev_b32 v158, 16, v213
    v_and_b32 v159, 0xffff0000, v213
    s_mov_b32 exec_lo, 0x00010001
    s_mov_b32 exec_hi, 0x00010001
    ds_write_b128 v9, v[124:127] offset:10240
    ds_write_b128 v9, v[128:131] offset:10304
    ds_write_b128 v9, v[132:135] offset:10368
    ds_write_b128 v9, v[136:139] offset:10432
    ds_write_b128 v9, v[140:143] offset:10496
    ds_write_b128 v9, v[144:147] offset:10560
    ds_write_b128 v9, v[148:151] offset:10624
    ds_write_b128 v9, v[152:155] offset:10688
    ds_write_b128 v9, v[156:159] offset:10752
    s_mov_b64 exec, -1
    s_mul_i32 s30, s20, 256
    s_xor_b32 s31, s2, 0
    s_add_u32 s30, s30, s31
    s_sub_u32 s30, s30, 0
    s_cmp_lt_u32 s2, 0
    s_cselect_b32 s30, 1023, s30
    s_lshl_b32 s30, s30, 1
    v_lshrrev_b32 v244, 5, v12
    v_add_u32 v248, s30, v244
    v_mov_b32 v244, -1
    v_mov_b32 v245, 0
    v_subrev_u32 v246, 664, v248
    v_cmp_gt_u32 vcc, 12, v246
    v_mov_b32 v247, 0
    s_nop 0
    v_cndmask_b32 v244, v244, v246, vcc
    v_cndmask_b32 v245, v245, v247, vcc
    v_subrev_u32 v246, 638, v248
    v_cmp_gt_u32 vcc, 26, v246
    v_mov_b32 v247, 1
    s_nop 0
    v_cndmask_b32 v244, v244, v246, vcc
    v_cndmask_b32 v245, v245, v247, vcc
    v_subrev_u32 v246, 598, v248
    v_cmp_gt_u32 vcc, 40, v246
    v_mov_b32 v247, 2
    s_nop 0
    v_cndmask_b32 v244, v244, v246, vcc
    v_cndmask_b32 v245, v245, v247, vcc
    v_subrev_u32 v246, 542, v248
    v_cmp_gt_u32 vcc, 56, v246
    v_mov_b32 v247, 3
    s_nop 0
    v_cndmask_b32 v244, v244, v246, vcc
    v_cndmask_b32 v245, v245, v247, vcc
    v_subrev_u32 v246, 468, v248
    v_cmp_gt_u32 vcc, 74, v246
    v_mov_b32 v247, 4
    s_nop 0
    v_cndmask_b32 v244, v244, v246, vcc
    v_cndmask_b32 v245, v245, v247, vcc
    v_subrev_u32 v246, 376, v248
    v_cmp_gt_u32 vcc, 92, v246
    v_mov_b32 v247, 5
    s_nop 0
    v_cndmask_b32 v244, v244, v246, vcc
    v_cndmask_b32 v245, v245, v247, vcc
    v_subrev_u32 v246, 268, v248
    v_cmp_gt_u32 vcc, 108, v246
    v_mov_b32 v247, 6
    s_nop 0
    v_cndmask_b32 v244, v244, v246, vcc
    v_cndmask_b32 v245, v245, v247, vcc
    v_subrev_u32 v246, 142, v248
    v_cmp_gt_u32 vcc, 126, v246
    v_mov_b32 v247, 7
    s_nop 0
    v_cndmask_b32 v244, v244, v246, vcc
    v_cndmask_b32 v245, v245, v247, vcc
    v_subrev_u32 v246, 0, v248
    v_cmp_gt_u32 vcc, 142, v246
    v_mov_b32 v247, 8
    s_nop 0
    v_cndmask_b32 v244, v244, v246, vcc
    v_cndmask_b32 v245, v245, v247, vcc
    v_sub_u32 v244, 2047, v244
    v_mul_u32_u24 v244, 36864, v244
    v_lshl_add_u32 v244, v245, 7, v244
    v_and_b32 v245, 31, v12
    v_mul_u32_u24 v245, 1152, v245
    v_add_u32 v249, v244, v245
    s_mov_b32 vcc_lo, 0xff00ff00
    s_mov_b32 vcc_hi, 0xff00ff00
    s_waitcnt vmcnt(0)
    v_readfirstlane_b32 s30, v0
    s_mov_b32 s31, 0
    s_sub_u32 s30, s30, s100
    s_cmp_eq_u32 s30, 27
    s_cbranch_scc0 M_pf_spin
M_pf_ok:
    s_lshr_b32 s30, s2, 3
    s_sub_u32 s31, s30, 11
    s_cselect_b32 s30, s30, s31
    s_mul_i32 s30, s30, 3072
    s_add_u32 s30, s30, s43
    s_add_u32 s30, s30, 33792
    v_lshlrev_b32 v244, 3, v11
    v_mov_b32 v0, v249
    buffer_load_dwordx4 v[92:95], v11, s[16:19], s43 offen offset:0 sc1
    buffer_load_dwordx4 v[96:99], v11, s[16:19], s43 offen offset:1024 sc1
    buffer_load_dwordx4 v[100:103], v11, s[16:19], s43 offen offset:2048 sc1
    s_mov_b32 exec_hi, 268435455
    buffer_load_dwordx4 v[104:107], v11, s[16:19], s43 offen offset:3072 sc1
    s_mov_b32 exec_hi, -1
    s_add_u32 s43, s43, 4096
    buffer_load_dwordx4 v[48:51], v11, s[16:19], s43 offen offset:0 sc1
    buffer_load_dword v52, v11, s[16:19], s43 offen offset:1024 sc1
    buffer_load_dwordx4 v[12:15], v11, s[16:19], s43 offen offset:2048 sc1
    buffer_load_dwordx4 a[0:3], v11, s[16:19], s43 offen offset:3072 sc1
    s_add_u32 s43, s43, 4096
    buffer_load_dwordx4 a[4:7], v11, s[16:19], s43 offen offset:0 sc1
    buffer_load_dwordx4 a[8:11], v11, s[16:19], s43 offen offset:1024 sc1
    buffer_load_dwordx4 a[12:15], v11, s[16:19], s43 offen offset:2048 sc1
    buffer_load_dwordx4 a[16:19], v11, s[16:19], s43 offen offset:3072 sc1
    s_add_u32 s43, s43, 4096
    s_bfm_b64 exec, 24, 0
    buffer_load_dword v244, v244, s[16:19], s30 offen sc1
    s_mov_b64 exec, -1
    buffer_load_dwordx4 a[20:23], v11, s[16:19], s43 offen offset:0 sc1
    buffer_load_dwordx4 a[24:27], v11, s[16:19], s43 offen offset:1024 sc1
    buffer_load_dwordx4 a[28:31], v11, s[16:19], s43 offen offset:2048 sc1
    buffer_load_dwordx4 a[32:35], v11, s[16:19], s43 offen offset:3072 sc1
    s_add_u32 s43, s43, 4096
    buffer_load_dwordx4 v[16:19], v11, s[16:19], s43 offen offset:0 sc1
    buffer_load_dwordx4 a[36:39], v11, s[16:19], s43 offen offset:1024 sc1
    buffer_load_dwordx4 a[40:43], v11, s[16:19], s43 offen offset:2048 sc1
    buffer_load_dwordx4 a[44:47], v11, s[16:19], s43 offen offset:3072 sc1
    s_add_u32 s43, s43, 4096
    buffer_load_dwordx4 a[48:51], v11, s[16:19], s43 offen offset:0 sc1
    buffer_load_dwordx4 a[52:55], v11, s[16:19], s43 offen offset:1024 sc1
    buffer_load_dwordx4 a[56:59], v11, s[16:19], s43 offen offset:2048 sc1
    buffer_load_dwordx4 a[60:63], v11, s[16:19], s43 offen offset:3072 sc1
    s_add_u32 s43, s43, 4096
    buffer_load_dwordx4 a[64:67], v11, s[16:19], s43 offen offset:0 sc1
    buffer_load_dwordx4 a[68:71], v11, s[16:19], s43 offen offset:1024 sc1
    buffer_load_dwordx4 v[20:23], v11, s[16:19], s43 offen offset:2048 sc1
    buffer_load_dwordx4 a[72:75], v11, s[16:19], s43 offen offset:3072 sc1
    s_add_u32 s43, s43, 4096
    buffer_load_dwordx4 a[76:79], v11, s[16:19], s43 offen offset:0 sc1
    buffer_load_dwordx4 a[80:83], v11, s[16:19], s43 offen offset:1024 sc1
    buffer_load_dwordx4 a[84:87], v11, s[16:19], s43 offen offset:2048 sc1
    buffer_load_dwordx4 a[88:91], v11, s[16:19], s43 offen offset:3072 sc1
    s_add_u32 s43, s43, 4096
    buffer_load_dwordx4 a[92:95], v11, s[16:19], s43 offen offset:0 sc1
    buffer_load_dwordx4 a[96:99], v11, s[16:19], s43 offen offset:1024 sc1
    buffer_load_dwordx4 a[100:103], v11, s[16:19], s43 offen offset:2048 sc1
    buffer_load_dwordx4 a[104:107], v11, s[16:19], s43 offen offset:3072 sc1
    s_add_u32 s43, s43, 4096
    buffer_load_dwordx4 v[24:27], v11, s[16:19], s43 offen offset:0 sc1
    buffer_load_dwordx4 a[108:111], v11, s[16:19], s43 offen offset:1024 sc1
    ds_read_b128 v[160:163], v9 offset:10240
    ds_read_b128 v[164:167], v9 offset:10304
    ds_read_b128 v[168:171], v9 offset:10368
    ds_read_b128 v[172:175], v9 offset:10432
    ds_read_b128 v[176:179], v9 offset:10496
    ds_read_b128 v[180:183], v9 offset:10560
    ds_read_b128 v[184:187], v9 offset:10624
    ds_read_b128 v[188:191], v9 offset:10688
    ds_read_b128 v[192:195], v9 offset:10752
    s_cmp_eq_u32 s98, 0
    s_cbranch_scc1 M_cnt
    s_mov_b32 s98, 0
    v_mov_b32 v250, 1
    s_mov_b64 exec, 1
    buffer_atomic_add v250, off, s[68:71], 0 offset:0 sc1
    s_mov_b64 exec, -1
    s_nop 3
M_cnt:
    s_waitcnt vmcnt(31)
    s_barrier
    ds_read_b128 v[196:199], v1 offset:0
    ds_read_b128 v[200:203], v2 offset:0
    ds_read_b128 v[228:231], v1 offset:18432
    ds_read_b128 v[232:235], v2 offset:18432
    s_waitcnt lgkmcnt(2)
    v_smfmac_f32_16x16x64_bf16 v[124:127], a[0:3], v[196:203], v12
    buffer_load_dwordx4 a[112:115], v11, s[16:19], s43 offen offset:2048 sc1
    s_waitcnt lgkmcnt(0)
    v_mov_b32 v118, s54
    v_smfmac_f32_16x16x64_bf16 v[160:163], a[0:3], v[228:235], v12
    ds_read_b128 v[204:207], v1 offset:1024
    ds_read_b128 v[208:211], v2 offset:1024
    v_or3_b32 v114, v92, v96, v100
    v_or_b32 v114, v114, v104
    v_cmp_gt_i32 s[32:33], 0, v114
    v_cmp_gt_u32 s[36:37], 2.0, v92
    s_nop 1
    v_mbcnt_lo_u32_b32 v110, s36, 0
    s_waitcnt vmcnt(31)
    v_mbcnt_hi_u32_b32 v110, s37, v110
    v_smfmac_f32_16x16x64_bf16 v[128:131], a[4:7], v[196:203], v12 abid:1
    buffer_load_dwordx4 a[116:119], v11, s[16:19], s43 offen offset:3072 sc1
    v_lshl_add_u32 v110, v110, 3, s38
    v_smfmac_f32_16x16x64_bf16 v[164:167], a[4:7], v[228:235], v12 abid:1
    ds_read_b128 v[220:223], v1 offset:19456
    ds_read_b128 v[224:227], v2 offset:19456
    v_min_u32 v110, s39, v110
    s_waitcnt vmcnt(31)
    v_cndmask_b32 v110, v118, v110, s[36:37]
    v_smfmac_f32_16x16x64_bf16 v[132:135], a[8:11], v[196:203], v13
    s_add_u32 s43, s43, 4096
    buffer_load_dwordx4 a[120:123], v11, s[16:19], s43 offen offset:0 sc1
    ds_write_b64 v110, v[92:93]
    s_bcnt1_i32_b64 s30, s[36:37]
    s_lshl3_add_u32 s38, s30, s38
    v_cmp_gt_u32 s[44:45], 2.0, v94
    v_smfmac_f32_16x16x64_bf16 v[168:171], a[8:11], v[228:235], v13
    s_nop 0
    v_mbcnt_lo_u32_b32 v111, s44, 0
    v_mbcnt_hi_u32_b32 v111, s45, v111
    v_lshl_add_u32 v111, v111, 3, s38
    v_min_u32 v111, s39, v111
    s_waitcnt vmcnt(31)
    v_cndmask_b32 v111, v118, v111, s[44:45]
    v_smfmac_f32_16x16x64_bf16 v[136:139], a[12:15], v[196:203], v13 abid:1
    buffer_load_dwordx4 a[124:127], v11, s[16:19], s43 offen offset:1024 sc1
    ds_write_b64 v111, v[94:95]
    s_bcnt1_i32_b64 s30, s[44:45]
    s_lshl3_add_u32 s38, s30, s38
    v_cmp_gt_u32 s[36:37], 2.0, v96
    v_smfmac_f32_16x16x64_bf16 v[172:175], a[12:15], v[228:235], v13 abid:1
    s_nop 0
    v_mbcnt_lo_u32_b32 v110, s36, 0
    v_mbcnt_hi_u32_b32 v110, s37, v110
    v_lshl_add_u32 v110, v110, 3, s38
    s_waitcnt vmcnt(31)
    v_min_u32 v110, s39, v110
    v_smfmac_f32_16x16x64_bf16 v[140:143], a[16:19], v[196:203], v14
    buffer_load_dwordx4 a[128:131], v11, s[16:19], s43 offen offset:2048 sc1
    v_cndmask_b32 v110, v118, v110, s[36:37]
    v_smfmac_f32_16x16x64_bf16 v[176:179], a[16:19], v[228:235], v14
    ds_write_b64 v110, v[96:97]
    s_bcnt1_i32_b64 s30, s[36:37]
    s_lshl3_add_u32 s38, s30, s38
    v_cmp_gt_u32 s[44:45], 2.0, v98
    s_nop 1
    v_mbcnt_lo_u32_b32 v111, s44, 0
    s_waitcnt vmcnt(30)
    v_mbcnt_hi_u32_b32 v111, s45, v111
    v_smfmac_f32_16x16x64_bf16 v[144:147], a[20:23], v[196:203], v14 abid:1
    buffer_load_dwordx4 a[132:135], v11, s[16:19], s43 offen offset:3072 sc1
    v_lshl_add_u32 v111, v111, 3, s38
    v_smfmac_f32_16x16x64_bf16 v[180:183], a[20:23], v[228:235], v14 abid:1
    v_min_u32 v111, s39, v111
    s_waitcnt vmcnt(30)
    v_cndmask_b32 v111, v118, v111, s[44:45]
    v_smfmac_f32_16x16x64_bf16 v[148:151], a[24:27], v[196:203], v15
    s_add_u32 s43, s43, 4096
    buffer_load_dwordx4 a[136:139], v11, s[16:19], s43 offen offset:0 sc1
    ds_write_b64 v111, v[98:99]
    s_bcnt1_i32_b64 s30, s[44:45]
    s_lshl3_add_u32 s38, s30, s38
    v_cmp_gt_u32 s[36:37], 2.0, v100
    v_smfmac_f32_16x16x64_bf16 v[184:187], a[24:27], v[228:235], v15
    s_nop 0
    v_mbcnt_lo_u32_b32 v110, s36, 0
    v_mbcnt_hi_u32_b32 v110, s37, v110
    v_lshl_add_u32 v110, v110, 3, s38
    v_min_u32 v110, s39, v110
    s_waitcnt vmcnt(30)
    v_cndmask_b32 v110, v118, v110, s[36:37]
    v_smfmac_f32_16x16x64_bf16 v[152:155], a[28:31], v[196:203], v15 abid:1
    buffer_load_dwordx4 a[140:143], v11, s[16:19], s43 offen offset:1024 sc1
    ds_write_b64 v110, v[100:101]
    s_bcnt1_i32_b64 s30, s[36:37]
    s_lshl3_add_u32 s38, s30, s38
    v_cmp_gt_u32 s[44:45], 2.0, v102
    v_smfmac_f32_16x16x64_bf16 v[188:191], a[28:31], v[228:235], v15 abid:1
    s_nop 0
    v_mbcnt_lo_u32_b32 v111, s44, 0
    v_mbcnt_hi_u32_b32 v111, s45, v111
    v_lshl_add_u32 v111, v111, 3, s38
    s_waitcnt vmcnt(30)
    v_min_u32 v111, s39, v111
    v_smfmac_f32_16x16x64_bf16 v[156:159], a[32:35], v[196:203], v48
    buffer_load_dwordx4 v[28:31], v11, s[16:19], s43 offen offset:2048 sc1
    buffer_load_dwordx4 a[144:147], v11, s[16:19], s43 offen offset:3072 sc1
    v_cndmask_b32 v111, v118, v111, s[44:45]
    v_smfmac_f32_16x16x64_bf16 v[192:195], a[32:35], v[228:235], v48
    ds_write_b64 v111, v[102:103]
    s_bcnt1_i32_b64 s30, s[44:45]
    s_lshl3_add_u32 s38, s30, s38
    v_cmp_gt_u32 s[36:37], 2.0, v104
    s_nop 1
    s_waitcnt vmcnt(30)
    s_waitcnt lgkmcnt(8)
    v_mbcnt_lo_u32_b32 v110, s36, 0
    v_smfmac_f32_16x16x64_bf16 v[124:127], a[36:39], v[204:211], v16
    s_add_u32 s43, s43, 4096
    buffer_load_dwordx4 a[148:151], v11, s[16:19], s43 offen offset:0 sc1
    s_waitcnt lgkmcnt(6)
    v_mbcnt_hi_u32_b32 v110, s37, v110
    v_smfmac_f32_16x16x64_bf16 v[160:163], a[36:39], v[220:227], v16
    ds_read_b128 v[196:199], v1 offset:2048
    ds_read_b128 v[200:203], v2 offset:2048
    v_lshl_add_u32 v110, v110, 3, s38
    v_min_u32 v110, s39, v110
    s_waitcnt vmcnt(30)
    v_cndmask_b32 v110, v118, v110, s[36:37]
    v_smfmac_f32_16x16x64_bf16 v[128:131], a[40:43], v[204:211], v16 abid:1
    buffer_load_dwordx4 a[152:155], v11, s[16:19], s43 offen offset:1024 sc1
    ds_write_b64 v110, v[104:105]
    s_bcnt1_i32_b64 s30, s[36:37]
    s_lshl3_add_u32 s38, s30, s38
    v_cmp_gt_u32 s[44:45], 2.0, v106
    v_smfmac_f32_16x16x64_bf16 v[164:167], a[40:43], v[220:227], v16 abid:1
    ds_read_b128 v[228:231], v1 offset:20480
    ds_read_b128 v[232:235], v2 offset:20480
    v_mbcnt_lo_u32_b32 v111, s44, 0
    v_mbcnt_hi_u32_b32 v111, s45, v111
    v_lshl_add_u32 v111, v111, 3, s38
    v_min_u32 v111, s39, v111
    s_waitcnt vmcnt(30)
    v_cndmask_b32 v111, v118, v111, s[44:45]
    v_smfmac_f32_16x16x64_bf16 v[132:135], a[44:47], v[204:211], v17
    buffer_load_dwordx4 a[156:159], v11, s[16:19], s43 offen offset:2048 sc1
    ds_write_b64 v111, v[106:107]
    s_bcnt1_i32_b64 s30, s[44:45]
    s_lshl3_add_u32 s38, s30, s38
    ds_read_b64 v[92:93], v55 offset:0
    ds_read_b64 v[94:95], v55 offset:512
    ds_read_b64 v[96:97], v55 offset:1024
    v_smfmac_f32_16x16x64_bf16 v[168:171], a[44:47], v[220:227], v17
    s_waitcnt vmcnt(30)
    v_smfmac_f32_16x16x64_bf16 v[136:139], a[48:51], v[204:211], v17 abid:1
    buffer_load_dwordx4 a[160:163], v11, s[16:19], s43 offen offset:3072 sc1
    v_smfmac_f32_16x16x64_bf16 v[172:175], a[48:51], v[220:227], v17 abid:1
    s_waitcnt vmcnt(30)
    v_smfmac_f32_16x16x64_bf16 v[140:143], a[52:55], v[204:211], v18
    s_add_u32 s43, s43, 4096
    buffer_load_dwordx4 a[164:167], v11, s[16:19], s43 offen offset:0 sc1
    s_waitcnt lgkmcnt(2)
    v_bfe_u32 v110, v92, 24, 4
    v_smfmac_f32_16x16x64_bf16 v[176:179], a[52:55], v[220:227], v18
    v_lshlrev_b32 v111, 1, v92
    v_lshl_add_u32 v110, v110, 2, s49
    v_and_b32 v111, 16, v111
    s_waitcnt vmcnt(30)
    v_and_or_b32 v110, v92, 2.0, v110
    v_smfmac_f32_16x16x64_bf16 v[144:147], a[56:59], v[204:211], v18 abid:1
    buffer_load_dwordx4 a[168:171], v11, s[16:19], s43 offen offset:1024 sc1
    v_lshlrev_b32 v111, v111, 1
    v_smfmac_f32_16x16x64_bf16 v[180:183], a[56:59], v[220:227], v18 abid:1
    ds_add_rtn_u32 v98, v110, v111
    s_waitcnt lgkmcnt(2)
    v_bfe_u32 v112, v94, 24, 4
    v_lshlrev_b32 v113, 1, v94
    v_lshl_add_u32 v112, v112, 2, s49
    s_waitcnt vmcnt(30)
    v_and_b32 v113, 16, v113
    v_smfmac_f32_16x16x64_bf16 v[148:151], a[60:63], v[204:211], v19
    buffer_load_dwordx4 a[172:175], v11, s[16:19], s43 offen offset:2048 sc1
    v_and_or_b32 v112, v94, 2.0, v112
    v_smfmac_f32_16x16x64_bf16 v[184:187], a[60:63], v[220:227], v19
    s_waitcnt vmcnt(30)
    v_lshlrev_b32 v113, v113, 1
    v_smfmac_f32_16x16x64_bf16 v[152:155], a[64:67], v[204:211], v19 abid:1
    buffer_load_dwordx4 a[176:179], v11, s[16:19], s43 offen offset:3072 sc1
    ds_add_rtn_u32 v99, v112, v113
    s_waitcnt lgkmcnt(2)
    s_cmp_gt_u32 s38, s35
    s_cbranch_scc1 M_r3
M_r3r:
    ds_read_b32 v117, v121
    v_and_b32 v110, 8, v92
    v_smfmac_f32_16x16x64_bf16 v[188:191], a[64:67], v[220:227], v19 abid:1
    v_lshrrev_b32 v113, 14, v92
    v_cmp_ne_u32 s[44:45], 0, v110
    v_and_b32 v116, 0x3cf0, v113
    s_waitcnt lgkmcnt(2)
    v_lshrrev_b32 v111, 16, v98
    v_and_b32 v112, 0xffff, v98
    s_waitcnt vmcnt(30)
    v_sub_u32 v110, 15, v111
    v_smfmac_f32_16x16x64_bf16 v[156:159], a[68:71], v[204:211], v48 abid:1
    s_add_u32 s43, s43, 4096
    buffer_load_dwordx4 v[32:35], v11, s[16:19], s43 offen offset:0 sc1
    buffer_load_dwordx4 a[180:183], v11, s[16:19], s43 offen offset:1024 sc1
    v_and_b32 v98, 2.0, v92
    v_smfmac_f32_16x16x64_bf16 v[192:195], a[68:71], v[220:227], v48 abid:1
    v_add3_u32 v98, v112, v111, v98
    v_cndmask_b32 v110, v112, v110, s[44:45]
    v_cmp_gt_u32 s[44:45], 16, v98
    v_cmp_gt_u32 s[36:37], 2.0, v98
    v_lshlrev_b32 v110, 2, v110
    s_waitcnt vmcnt(30)
    v_lshrrev_b64 v[112:113], v110, s[50:51]
    v_smfmac_f32_16x16x64_bf16 v[124:127], a[72:75], v[196:203], v20
    buffer_load_dwordx4 a[184:187], v11, s[16:19], s43 offen offset:2048 sc1
    s_andn2_b64 s[36:37], s[36:37], s[44:45]
    v_lshrrev_b64 v[114:115], v110, s[52:53]
    v_smfmac_f32_16x16x64_bf16 v[160:163], a[72:75], v[228:235], v20
    ds_read_b128 v[204:207], v1 offset:3072
    ds_read_b128 v[208:211], v2 offset:3072
    v_bfe_u32 v110, v92, 24, 4
    v_mbcnt_lo_u32_b32 v111, s36, 0
    v_and_b32 v112, 15, v112
    v_mbcnt_hi_u32_b32 v111, s37, v111
    v_and_b32 v114, 15, v114
    s_waitcnt vmcnt(30)
    v_lshl_add_u32 v111, v111, 3, s40
    v_smfmac_f32_16x16x64_bf16 v[128:131], a[76:79], v[196:203], v20 abid:1
    buffer_load_dwordx4 a[188:191], v11, s[16:19], s43 offen offset:3072 sc1
    v_lshl_add_u32 v112, v110, 4, v112
    v_smfmac_f32_16x16x64_bf16 v[164:167], a[76:79], v[228:235], v20 abid:1
    ds_read_b128 v[220:223], v1 offset:21504
    ds_read_b128 v[224:227], v2 offset:21504
    v_min_u32 v111, s41, v111
    v_mul_u32_u24 v114, 68, v114
    s_waitcnt vmcnt(30)
    v_cndmask_b32 v111, v118, v111, s[36:37]
    v_smfmac_f32_16x16x64_bf16 v[132:135], a[80:83], v[196:203], v21
    s_add_u32 s43, s43, 4096
    buffer_load_dwordx4 a[192:195], v11, s[16:19], s43 offen offset:0 sc1
    ds_write_b64 v111, v[92:93]
    s_bcnt1_i32_b64 s30, s[36:37]
    s_lshl3_add_u32 s40, s30, s40
    v_lshl_add_u32 v112, v112, 2, s47
    v_smfmac_f32_16x16x64_bf16 v[168:171], a[80:83], v[228:235], v21
    v_and_b32 v114, 0x30c, v114
    v_cndmask_b32 v112, v118, v112, s[44:45]
    v_add3_u32 v113, v116, v114, s29
    v_and_b32 v114, 0x3fff, v92
    s_waitcnt vmcnt(30)
    v_cndmask_b32 v110, v118, v113, s[44:45]
    v_smfmac_f32_16x16x64_bf16 v[136:139], a[84:87], v[196:203], v21 abid:1
    buffer_load_dwordx4 a[196:199], v11, s[16:19], s43 offen offset:1024 sc1
    ds_write_b32 v112, v114
    ds_write_b32 v110, v93
    v_and_b32 v110, 8, v94
    v_smfmac_f32_16x16x64_bf16 v[172:175], a[84:87], v[228:235], v21 abid:1
    v_lshrrev_b32 v113, 14, v94
    v_cmp_ne_u32 s[44:45], 0, v110
    v_and_b32 v116, 0x3cf0, v113
    s_waitcnt lgkmcnt(8)
    s_waitcnt vmcnt(30)
    v_lshrrev_b32 v111, 16, v99
    v_smfmac_f32_16x16x64_bf16 v[140:143], a[88:91], v[196:203], v22
    buffer_load_dwordx4 a[200:203], v11, s[16:19], s43 offen offset:2048 sc1
    v_and_b32 v112, 0xffff, v99
    v_smfmac_f32_16x16x64_bf16 v[176:179], a[88:91], v[228:235], v22
    v_sub_u32 v110, 15, v111
    v_and_b32 v99, 2.0, v94
    v_add3_u32 v99, v112, v111, v99
    v_cndmask_b32 v110, v112, v110, s[44:45]
    s_waitcnt vmcnt(30)
    v_cmp_gt_u32 s[44:45], 16, v99
    v_smfmac_f32_16x16x64_bf16 v[144:147], a[92:95], v[196:203], v22 abid:1
    buffer_load_dwordx4 a[204:207], v11, s[16:19], s43 offen offset:3072 sc1
    v_cmp_gt_u32 s[36:37], 2.0, v99
    v_smfmac_f32_16x16x64_bf16 v[180:183], a[92:95], v[228:235], v22 abid:1
    v_lshlrev_b32 v110, 2, v110
    s_waitcnt vmcnt(30)
    v_lshrrev_b64 v[112:113], v110, s[50:51]
    v_smfmac_f32_16x16x64_bf16 v[148:151], a[96:99], v[196:203], v23
    s_add_u32 s43, s43, 4096
    buffer_load_dwordx4 a[208:211], v11, s[16:19], s43 offen offset:0 sc1
    s_andn2_b64 s[36:37], s[36:37], s[44:45]
    v_lshrrev_b64 v[114:115], v110, s[52:53]
    v_smfmac_f32_16x16x64_bf16 v[184:187], a[96:99], v[228:235], v23
    v_bfe_u32 v110, v94, 24, 4
    v_mbcnt_lo_u32_b32 v111, s36, 0
    v_and_b32 v112, 15, v112
    v_mbcnt_hi_u32_b32 v111, s37, v111
    v_and_b32 v114, 15, v114
    s_waitcnt vmcnt(30)
    v_lshl_add_u32 v111, v111, 3, s40
    v_smfmac_f32_16x16x64_bf16 v[152:155], a[100:103], v[196:203], v23 abid:1
    buffer_load_dwordx4 a[212:215], v11, s[16:19], s43 offen offset:1024 sc1
    v_lshl_add_u32 v112, v110, 4, v112
    v_smfmac_f32_16x16x64_bf16 v[188:191], a[100:103], v[228:235], v23 abid:1
    v_min_u32 v111, s41, v111
    v_mul_u32_u24 v114, 68, v114
    s_waitcnt vmcnt(30)
    v_cndmask_b32 v111, v118, v111, s[36:37]
    v_smfmac_f32_16x16x64_bf16 v[156:159], a[104:107], v[196:203], v49
    buffer_load_dwordx4 v[36:39], v11, s[16:19], s43 offen offset:2048 sc1
    buffer_load_dwordx4 a[216:219], v11, s[16:19], s43 offen offset:3072 sc1
    ds_write_b64 v111, v[94:95]
    s_bcnt1_i32_b64 s30, s[36:37]
    s_lshl3_add_u32 s40, s30, s40
    v_lshl_add_u32 v112, v112, 2, s47
    v_smfmac_f32_16x16x64_bf16 v[192:195], a[104:107], v[228:235], v49
    v_and_b32 v114, 0x30c, v114
    v_cndmask_b32 v112, v118, v112, s[44:45]
    v_add3_u32 v113, v116, v114, s29
    v_and_b32 v114, 0x3fff, v94
    s_waitcnt vmcnt(30)
    s_waitcnt lgkmcnt(6)
    v_cndmask_b32 v110, v118, v113, s[44:45]
    v_smfmac_f32_16x16x64_bf16 v[124:127], a[108:111], v[204:211], v24
    s_add_u32 s43, s43, 4096
    buffer_load_dwordx4 a[220:223], v11, s[16:19], s43 offen offset:0 sc1
    ds_write_b32 v112, v114
    ds_write_b32 v110, v95
    s_waitcnt lgkmcnt(6)
    v_lshrrev_b32 v110, 16, v117
    v_smfmac_f32_16x16x64_bf16 v[160:163], a[108:111], v[220:227], v24
    ds_read_b128 v[196:199], v1 offset:4096
    ds_read_b128 v[200:203], v2 offset:4096
    v_and_b32 v117, 0xffff, v117
    v_add_u32 v117, v117, v110
    s_waitcnt vmcnt(30)
    v_cmp_lt_u32 s[34:35], 16, v117
    v_smfmac_f32_16x16x64_bf16 v[128:131], a[112:115], v[204:211], v24 abid:1
    buffer_load_dwordx4 a[224:227], v11, s[16:19], s43 offen offset:1024 sc1
    s_sub_u32 s46, s40, s48
    s_add_u32 s46, s46, 56
    s_lshr_b32 s46, s46, 6
    s_mov_b32 s21, 0
    s_and_b32 s27, s34, 0x1ff
    s_cmp_gt_u32 s46, 4
    s_cselect_b32 s32, 1, s32
    s_or_b32 s32, s32, s33
    s_cbranch_scc1 M_dn
M_dnr:
    ds_read_b128 v[92:95], v9 offset:9792
    s_bcnt1_i32_b32 s30, s27
    s_cmp_gt_u32 s30, 3
    s_cselect_b32 s34, 0, s27
    s_cselect_b32 s80, 0, 1
    s_getpc_b64 s[36:37]
M_pc:
    v_bfe_u32 v110, v11, 4, 4
    v_smfmac_f32_16x16x64_bf16 v[164:167], a[112:115], v[220:227], v24 abid:1
    ds_read_b128 v[228:231], v1 offset:22528
    ds_read_b128 v[232:235], v2 offset:22528
    s_waitcnt vmcnt(30)
    v_smfmac_f32_16x16x64_bf16 v[132:135], a[116:119], v[204:211], v25
    buffer_load_dwordx4 a[228:231], v11, s[16:19], s43 offen offset:2048 sc1
    s_ff1_i32_b32 s81, s34
    s_bitset0_b32 s34, s81
    s_mul_i32 s30, s81, 20
    s_add_u32 s31, s30, M_ovc0-M_pc
    s_add_u32 s30, s30, M_ovl0-M_pc
    s_cmp_lg_u32 s34, 0
    s_cselect_b32 s30, s31, s30
    s_cmp_lt_i32 s81, 0
    s_cselect_b32 s30, M_ovn-M_pc, s30
    s_add_u32 s72, s36, s30
    s_addc_u32 s73, s37, 0
    s_ff1_i32_b32 s82, s34
    s_bitset0_b32 s34, s82
    s_mul_i32 s30, s82, 20
    s_add_u32 s31, s30, M_ovc1-M_pc
    s_add_u32 s30, s30, M_ovl1-M_pc
    s_cmp_lg_u32 s34, 0
    s_cselect_b32 s30, s31, s30
    s_cmp_lt_i32 s82, 0
    s_cselect_b32 s30, M_ovn-M_pc, s30
    v_smfmac_f32_16x16x64_bf16 v[168:171], a[116:119], v[220:227], v25
    s_waitcnt vmcnt(30)
    v_smfmac_f32_16x16x64_bf16 v[136:139], a[120:123], v[204:211], v25 abid:1
    buffer_load_dwordx4 a[232:235], v11, s[16:19], s43 offen offset:3072 sc1
    s_add_u32 s74, s36, s30
    s_addc_u32 s75, s37, 0
    s_ff1_i32_b32 s83, s34
    s_bitset0_b32 s34, s83
    s_mul_i32 s30, s83, 20
    s_add_u32 s31, s30, M_ovc1-M_pc
    s_add_u32 s30, s30, M_ovl2-M_pc
    s_cmp_lg_u32 s34, 0
    s_cselect_b32 s30, s31, s30
    s_cmp_lt_i32 s83, 0
    s_cselect_b32 s30, M_ovn-M_pc, s30
    s_add_u32 s76, s36, s30
    s_addc_u32 s77, s37, 0
    s_waitcnt lgkmcnt(2)
    v_lshrrev_b32 v112, 18, v92
    v_smfmac_f32_16x16x64_bf16 v[172:175], a[120:123], v[220:227], v25 abid:1
    s_waitcnt vmcnt(30)
    v_lshrrev_b32 v113, 18, v94
    v_smfmac_f32_16x16x64_bf16 v[140:143], a[124:127], v[204:211], v26
    s_add_u32 s43, s43, 4096
    buffer_load_dwordx4 a[236:239], v11, s[16:19], s43 offen offset:0 sc1
    v_and_b32 v114, 0x3fff, v92
    v_smfmac_f32_16x16x64_bf16 v[176:179], a[124:127], v[220:227], v26
    s_waitcnt vmcnt(30)
    v_and_b32 v115, 0x3fff, v94
    v_smfmac_f32_16x16x64_bf16 v[144:147], a[128:131], v[204:211], v26 abid:1
    buffer_load_dwordx4 a[240:243], v11, s[16:19], s43 offen offset:1024 sc1
    ds_write_b64 v9, v[114:115] offset:10056
    v_lshl_or_b32 v111, s81, 6, v110
    v_smfmac_f32_16x16x64_bf16 v[180:183], a[128:131], v[220:227], v26 abid:1
    v_cmp_eq_u32 s[44:45], v112, v111
    v_cmp_eq_u32 s[36:37], v113, v111
    s_nop 0
    v_cndmask_b32 v54, 0, v93, s[44:45]
    v_cndmask_b32 v55, 0, v95, s[36:37]
    v_lshl_or_b32 v111, s82, 6, v110
    s_waitcnt vmcnt(30)
    v_cmp_eq_u32 s[44:45], v112, v111
    v_smfmac_f32_16x16x64_bf16 v[148:151], a[132:135], v[204:211], v27
    buffer_load_dwordx4 a[244:247], v11, s[16:19], s43 offen offset:2048 sc1
    v_cmp_eq_u32 s[36:37], v113, v111
    v_smfmac_f32_16x16x64_bf16 v[184:187], a[132:135], v[220:227], v27
    v_cndmask_b32 v252, 0, v93, s[44:45]
    v_cndmask_b32 v253, 0, v95, s[36:37]
    v_lshl_or_b32 v111, s83, 6, v110
    v_cmp_eq_u32 s[44:45], v112, v111
    v_cmp_eq_u32 s[36:37], v113, v111
    s_nop 0
    s_waitcnt vmcnt(30)
    v_cndmask_b32 v254, 0, v93, s[44:45]
    v_smfmac_f32_16x16x64_bf16 v[152:155], a[136:139], v[204:211], v27 abid:1
    buffer_load_dwordx4 a[248:251], v11, s[16:19], s43 offen offset:3072 sc1
    v_cndmask_b32 v255, 0, v95, s[36:37]
    v_smfmac_f32_16x16x64_bf16 v[188:191], a[136:139], v[220:227], v27 abid:1
    ds_read_b128 v[236:239], v9 offset:9408
    ds_read_b64 v[216:217], v9 offset:10056
    s_waitcnt vmcnt(30)
    v_smfmac_f32_16x16x64_bf16 v[156:159], a[140:143], v[204:211], v49 abid:1
    s_add_u32 s43, s43, 4096
    buffer_load_dwordx4 v[40:43], v11, s[16:19], s43 offen offset:0 sc1
    buffer_load_dwordx4 a[252:255], v11, s[16:19], s43 offen offset:1024 sc1
    s_waitcnt lgkmcnt(1)
    v_xad_u32 v236, v236, v3, v4
    v_smfmac_f32_16x16x64_bf16 v[192:195], a[140:143], v[220:227], v49 abid:1
    s_waitcnt vmcnt(30)
    v_xad_u32 v237, v237, v3, v4
    v_smfmac_f32_16x16x64_bf16 v[124:127], a[144:147], v[196:203], v28
    buffer_load_dwordx4 v[56:59], v11, s[16:19], s43 offen offset:2048 sc1
    ds_read2st64_b32 v[244:245], v236 offset0:0 offset1:72
    ds_read2st64_b32 v[246:247], v237 offset0:0 offset1:72
    v_xad_u32 v238, v238, v3, v4
    v_smfmac_f32_16x16x64_bf16 v[160:163], a[144:147], v[228:235], v28
    ds_read_b128 v[204:207], v1 offset:5120
    ds_read_b128 v[208:211], v2 offset:5120
    s_waitcnt vmcnt(30)
    v_xad_u32 v239, v239, v3, v4
    v_smfmac_f32_16x16x64_bf16 v[128:131], a[148:151], v[196:203], v28 abid:1
    buffer_load_dwordx4 v[60:63], v11, s[16:19], s43 offen offset:3072 sc1
    ds_read2st64_b32 v[248:249], v238 offset0:0 offset1:72
    ds_read2st64_b32 v[250:251], v239 offset0:0 offset1:72
    ds_read_b128 v[240:243], v8 offset:3072
    ds_read_b128 v[236:239], v9 offset:9280
    s_waitcnt lgkmcnt(8)
    v_xad_u32 v212, v216, v3, v4
    v_smfmac_f32_16x16x64_bf16 v[164:167], a[148:151], v[228:235], v28 abid:1
    ds_read_b128 v[220:223], v1 offset:23552
    ds_read_b128 v[224:227], v2 offset:23552
    ds_read2st64_b32 v[212:213], v212 offset0:0 offset1:72
    s_waitcnt vmcnt(30)
    v_xad_u32 v214, v217, v3, v4
    v_smfmac_f32_16x16x64_bf16 v[132:135], a[152:155], v[196:203], v29
    s_add_u32 s43, s43, 4096
    buffer_load_dwordx4 v[64:67], v11, s[16:19], s43 offen offset:0 sc1
    ds_read2st64_b32 v[214:215], v214 offset0:0 offset1:72
    v_smfmac_f32_16x16x64_bf16 v[168:171], a[152:155], v[228:235], v29
    s_waitcnt vmcnt(30)
    v_smfmac_f32_16x16x64_bf16 v[136:139], a[156:159], v[196:203], v29 abid:1
    buffer_load_dwordx4 v[68:71], v11, s[16:19], s43 offen offset:1024 sc1
    v_smfmac_f32_16x16x64_bf16 v[172:175], a[156:159], v[228:235], v29 abid:1
    s_waitcnt vmcnt(30)
    v_smfmac_f32_16x16x64_bf16 v[140:143], a[160:163], v[196:203], v30
    buffer_load_dwordx4 v[72:75], v11, s[16:19], s43 offen offset:2048 sc1
    s_waitcnt lgkmcnt(5)
    v_smfmac_f32_16x16x64_bf16 v[136:139], v[240:243], v[244:251], v10
    v_smfmac_f32_16x16x64_bf16 v[172:175], v[240:243], v[244:251], v10 abid:1
    s_waitcnt lgkmcnt(4)
    v_xad_u32 v236, v236, v3, v4
    v_smfmac_f32_16x16x64_bf16 v[176:179], a[160:163], v[228:235], v30
    s_waitcnt vmcnt(30)
    v_xad_u32 v237, v237, v3, v4
    v_smfmac_f32_16x16x64_bf16 v[144:147], a[164:167], v[196:203], v30 abid:1
    buffer_load_dwordx4 v[76:79], v11, s[16:19], s43 offen offset:3072 sc1
    ds_read2st64_b32 v[244:245], v236 offset0:0 offset1:72
    ds_read2st64_b32 v[246:247], v237 offset0:0 offset1:72
    v_xad_u32 v238, v238, v3, v4
    v_smfmac_f32_16x16x64_bf16 v[180:183], a[164:167], v[228:235], v30 abid:1
    s_waitcnt vmcnt(30)
    v_xad_u32 v239, v239, v3, v4
    v_smfmac_f32_16x16x64_bf16 v[148:151], a[168:171], v[196:203], v31
    s_add_u32 s43, s43, 4096
    buffer_load_dwordx4 v[80:83], v11, s[16:19], s43 offen offset:0 sc1
    ds_read2st64_b32 v[248:249], v238 offset0:0 offset1:72
    ds_read2st64_b32 v[250:251], v239 offset0:0 offset1:72
    ds_read_b128 v[240:243], v8 offset:1024
    ds_read_b128 v[236:239], v9 offset:9344
    v_smfmac_f32_16x16x64_bf16 v[184:187], a[168:171], v[228:235], v31
    s_waitcnt vmcnt(30)
    v_smfmac_f32_16x16x64_bf16 v[152:155], a[172:175], v[196:203], v31 abid:1
    buffer_load_dwordx4 v[84:87], v11, s[16:19], s43 offen offset:1024 sc1
    s_waitcnt lgkmcnt(6)
    s_cmp_lt_i32 s81, 0
    s_cbranch_scc1 M_ovr0
    s_swappc_b64 s[78:79], s[72:73]
M_ovr0:
    v_smfmac_f32_16x16x64_bf16 v[188:191], a[172:175], v[228:235], v31 abid:1
    s_waitcnt vmcnt(30)
    v_smfmac_f32_16x16x64_bf16 v[156:159], a[176:179], v[196:203], v50
    buffer_load_dwordx4 v[44:47], v11, s[16:19], s43 offen offset:2048 sc1
    buffer_load_dwordx4 v[88:91], v11, s[16:19], s43 offen offset:3072 sc1
    v_smfmac_f32_16x16x64_bf16 v[192:195], a[176:179], v[228:235], v50
    s_waitcnt vmcnt(30)
    v_smfmac_f32_16x16x64_bf16 v[124:127], a[180:183], v[204:211], v32
    s_add_u32 s43, s43, 4096
    buffer_load_dwordx4 v[92:95], v11, s[16:19], s43 offen offset:0 sc1
    s_waitcnt lgkmcnt(1)
    v_smfmac_f32_16x16x64_bf16 v[128:131], v[240:243], v[244:251], v10
    v_smfmac_f32_16x16x64_bf16 v[164:167], v[240:243], v[244:251], v10 abid:1
    s_waitcnt lgkmcnt(0)
    v_xad_u32 v236, v236, v3, v4
    v_smfmac_f32_16x16x64_bf16 v[160:163], a[180:183], v[220:227], v32
    ds_read_b128 v[196:199], v1 offset:6144
    ds_read_b128 v[200:203], v2 offset:6144
    s_waitcnt vmcnt(30)
    v_xad_u32 v237, v237, v3, v4
    v_smfmac_f32_16x16x64_bf16 v[128:131], a[184:187], v[204:211], v32 abid:1
    buffer_load_dwordx4 v[96:99], v11, s[16:19], s43 offen offset:1024 sc1
    ds_read2st64_b32 v[244:245], v236 offset0:0 offset1:72
    ds_read2st64_b32 v[246:247], v237 offset0:0 offset1:72
    v_xad_u32 v238, v238, v3, v4
    v_smfmac_f32_16x16x64_bf16 v[164:167], a[184:187], v[220:227], v32 abid:1
    ds_read_b128 v[228:231], v1 offset:24576
    ds_read_b128 v[232:235], v2 offset:24576
    s_waitcnt vmcnt(30)
    v_xad_u32 v239, v239, v3, v4
    v_smfmac_f32_16x16x64_bf16 v[132:135], a[188:191], v[204:211], v33
    buffer_load_dwordx4 v[100:103], v11, s[16:19], s43 offen offset:2048 sc1
    ds_read2st64_b32 v[248:249], v238 offset0:0 offset1:72
    ds_read2st64_b32 v[250:251], v239 offset0:0 offset1:72
    ds_read_b128 v[240:243], v8 offset:2048
    ds_read_b128 v[236:239], v9 offset:9216
    v_smfmac_f32_16x16x64_bf16 v[168:171], a[188:191], v[220:227], v33
    s_waitcnt vmcnt(30)
    v_smfmac_f32_16x16x64_bf16 v[136:139], a[192:195], v[204:211], v33 abid:1
    buffer_load_dwordx4 v[104:107], v11, s[16:19], s43 offen offset:3072 sc1
    v_smfmac_f32_16x16x64_bf16 v[172:175], a[192:195], v[220:227], v33 abid:1
    s_waitcnt vmcnt(30)
    v_smfmac_f32_16x16x64_bf16 v[140:143], a[196:199], v[204:211], v34
    s_add_u32 s43, s43, 4096
    buffer_load_dwordx4 v[108:111], v11, s[16:19], s43 offen offset:0 sc1
    v_smfmac_f32_16x16x64_bf16 v[176:179], a[196:199], v[220:227], v34
    s_waitcnt vmcnt(30)
    v_smfmac_f32_16x16x64_bf16 v[144:147], a[200:203], v[204:211], v34 abid:1
    buffer_load_dwordx4 v[112:115], v11, s[16:19], s43 offen offset:1024 sc1
    s_waitcnt lgkmcnt(1)
    v_smfmac_f32_16x16x64_bf16 v[132:135], v[240:243], v[244:251], v10
    v_smfmac_f32_16x16x64_bf16 v[168:171], v[240:243], v[244:251], v10 abid:1
    s_waitcnt lgkmcnt(0)
    v_xad_u32 v236, v236, v3, v4
    v_smfmac_f32_16x16x64_bf16 v[180:183], a[200:203], v[220:227], v34 abid:1
    s_waitcnt vmcnt(30)
    v_xad_u32 v237, v237, v3, v4
    v_smfmac_f32_16x16x64_bf16 v[148:151], a[204:207], v[204:211], v35
    buffer_load_dwordx4 v[116:119], v11, s[16:19], s43 offen offset:2048 sc1
    ds_read2st64_b32 v[244:245], v236 offset0:0 offset1:72
    ds_read2st64_b32 v[246:247], v237 offset0:0 offset1:72
    v_xad_u32 v238, v238, v3, v4
    v_smfmac_f32_16x16x64_bf16 v[184:187], a[204:207], v[220:227], v35
    s_waitcnt vmcnt(30)
    v_xad_u32 v239, v239, v3, v4
    v_smfmac_f32_16x16x64_bf16 v[152:155], a[208:211], v[204:211], v35 abid:1
    buffer_load_dwordx4 v[120:123], v11, s[16:19], s43 offen offset:3072 sc1
    ds_read2st64_b32 v[248:249], v238 offset0:0 offset1:72
    ds_read2st64_b32 v[250:251], v239 offset0:0 offset1:72
    ds_read_b128 v[240:243], v8 offset:0
    ds_read_b128 v[236:239], v9 offset:9728
    v_smfmac_f32_16x16x64_bf16 v[188:191], a[208:211], v[220:227], v35 abid:1
    s_waitcnt vmcnt(30)
    v_smfmac_f32_16x16x64_bf16 v[156:159], a[212:215], v[204:211], v50 abid:1
    s_add_u32 m0, s29, 11840
    s_nop 0
    buffer_load_dword v0, s[8:11], 0 offen lds
    v_smfmac_f32_16x16x64_bf16 v[192:195], a[212:215], v[220:227], v50 abid:1
    s_waitcnt vmcnt(29)
    v_smfmac_f32_16x16x64_bf16 v[124:127], a[216:219], v[196:203], v36
    v_smfmac_f32_16x16x64_bf16 v[160:163], a[216:219], v[228:235], v36
    ds_read_b128 v[204:207], v1 offset:7168
    ds_read_b128 v[208:211], v2 offset:7168
    s_waitcnt vmcnt(28)
    v_smfmac_f32_16x16x64_bf16 v[128:131], a[220:223], v[196:203], v36 abid:1
    s_waitcnt lgkmcnt(3)
    v_smfmac_f32_16x16x64_bf16 v[124:127], v[240:243], v[244:251], v10
    v_smfmac_f32_16x16x64_bf16 v[160:163], v[240:243], v[244:251], v10 abid:1
    s_waitcnt lgkmcnt(2)
    v_xad_u32 v236, v236, v3, v4
    v_smfmac_f32_16x16x64_bf16 v[164:167], a[220:223], v[228:235], v36 abid:1
    ds_read_b128 v[220:223], v1 offset:25600
    ds_read_b128 v[224:227], v2 offset:25600
    s_waitcnt vmcnt(27)
    v_xad_u32 v237, v237, v3, v4
    v_smfmac_f32_16x16x64_bf16 v[132:135], a[224:227], v[196:203], v37
    ds_read2st64_b32 v[244:245], v236 offset0:0 offset1:72
    ds_read2st64_b32 v[246:247], v237 offset0:0 offset1:72
    v_xad_u32 v238, v238, v3, v4
    v_smfmac_f32_16x16x64_bf16 v[168:171], a[224:227], v[228:235], v37
    s_waitcnt vmcnt(26)
    v_xad_u32 v239, v239, v3, v4
    v_smfmac_f32_16x16x64_bf16 v[136:139], a[228:231], v[196:203], v37 abid:1
    ds_read2st64_b32 v[248:249], v238 offset0:0 offset1:72
    ds_read2st64_b32 v[250:251], v239 offset0:0 offset1:72
    ds_read_b128 v[240:243], v8 offset:8192
    ds_read_b128 v[236:239], v9 offset:9664
    v_smfmac_f32_16x16x64_bf16 v[172:175], a[228:231], v[228:235], v37 abid:1
    s_waitcnt vmcnt(25)
    v_smfmac_f32_16x16x64_bf16 v[140:143], a[232:235], v[196:203], v38
    v_smfmac_f32_16x16x64_bf16 v[176:179], a[232:235], v[228:235], v38
    s_waitcnt vmcnt(24)
    v_smfmac_f32_16x16x64_bf16 v[144:147], a[236:239], v[196:203], v38 abid:1
    v_smfmac_f32_16x16x64_bf16 v[180:183], a[236:239], v[228:235], v38 abid:1
    s_waitcnt vmcnt(23)
    v_smfmac_f32_16x16x64_bf16 v[148:151], a[240:243], v[196:203], v39
    s_mov_b32 m0, s42
    s_nop 0
    buffer_load_dwordx4 v5, s[8:11], s22 offen offset:0 nt lds
    s_waitcnt lgkmcnt(1)
    v_smfmac_f32_16x16x64_bf16 v[156:159], v[240:243], v[244:251], v10
    v_smfmac_f32_16x16x64_bf16 v[192:195], v[240:243], v[244:251], v10 abid:1
    s_waitcnt lgkmcnt(0)
    v_xad_u32 v236, v236, v3, v4
    v_smfmac_f32_16x16x64_bf16 v[184:187], a[240:243], v[228:235], v39
    s_waitcnt vmcnt(23)
    v_xad_u32 v237, v237, v3, v4
    v_smfmac_f32_16x16x64_bf16 v[152:155], a[244:247], v[196:203], v39 abid:1
    ds_read2st64_b32 v[244:245], v236 offset0:0 offset1:72
    ds_read2st64_b32 v[246:247], v237 offset0:0 offset1:72
    v_xad_u32 v238, v238, v3, v4
    v_smfmac_f32_16x16x64_bf16 v[188:191], a[244:247], v[228:235], v39 abid:1
    s_waitcnt vmcnt(22)
    v_xad_u32 v239, v239, v3, v4
    v_smfmac_f32_16x16x64_bf16 v[156:159], a[248:251], v[196:203], v51
    s_add_u32 m0, m0, 896
    s_nop 0
    buffer_load_dwordx4 v5, s[8:11], s22 offen offset:128 nt lds
    ds_read2st64_b32 v[248:249], v238 offset0:0 offset1:72
    ds_read2st64_b32 v[250:251], v239 offset0:0 offset1:72
    ds_read_b128 v[240:243], v8 offset:7168
    ds_read_b128 v[236:239], v9 offset:9536
    v_smfmac_f32_16x16x64_bf16 v[192:195], a[248:251], v[228:235], v51
    s_waitcnt vmcnt(21)
    v_smfmac_f32_16x16x64_bf16 v[124:127], a[252:255], v[204:211], v40
    ds_read_b128 v[196:199], v1 offset:8192
    ds_read_b128 v[200:203], v2 offset:8192
    s_waitcnt vmcnt(20)
    v_smfmac_f32_16x16x64_bf16 v[128:131], v[56:59], v[204:211], v40 abid:1
    s_add_u32 m0, m0, 896
    s_nop 0
    buffer_load_dwordx4 v5, s[8:11], s22 offen offset:256 nt lds
    ds_read_b128 v[228:231], v1 offset:26624
    ds_read_b128 v[232:235], v2 offset:26624
    s_waitcnt vmcnt(20)
    v_smfmac_f32_16x16x64_bf16 v[132:135], v[60:63], v[204:211], v41
    s_waitcnt lgkmcnt(5)
    v_smfmac_f32_16x16x64_bf16 v[152:155], v[240:243], v[244:251], v10
    v_smfmac_f32_16x16x64_bf16 v[188:191], v[240:243], v[244:251], v10 abid:1
    s_waitcnt lgkmcnt(4)
    v_xad_u32 v236, v236, v3, v4
    s_waitcnt vmcnt(19)
    v_xad_u32 v237, v237, v3, v4
    v_smfmac_f32_16x16x64_bf16 v[136:139], v[64:67], v[204:211], v41 abid:1
    s_add_u32 m0, m0, 896
    s_nop 0
    buffer_load_dwordx4 v5, s[8:11], s22 offen offset:384 nt lds
    ds_read2st64_b32 v[244:245], v236 offset0:0 offset1:72
    ds_read2st64_b32 v[246:247], v237 offset0:0 offset1:72
    v_xad_u32 v238, v238, v3, v4
    s_waitcnt vmcnt(19)
    v_xad_u32 v239, v239, v3, v4
    v_smfmac_f32_16x16x64_bf16 v[140:143], v[68:71], v[204:211], v42
    ds_read2st64_b32 v[248:249], v238 offset0:0 offset1:72
    ds_read2st64_b32 v[250:251], v239 offset0:0 offset1:72
    ds_read_b128 v[240:243], v8 offset:5120
    ds_read_b128 v[236:239], v9 offset:9600
    s_waitcnt vmcnt(18)
    v_smfmac_f32_16x16x64_bf16 v[144:147], v[72:75], v[204:211], v42 abid:1
    s_waitcnt vmcnt(17)
    v_smfmac_f32_16x16x64_bf16 v[148:151], v[76:79], v[204:211], v43
    s_waitcnt vmcnt(16)
    v_smfmac_f32_16x16x64_bf16 v[152:155], v[80:83], v[204:211], v43 abid:1
    s_waitcnt lgkmcnt(1)
    v_smfmac_f32_16x16x64_bf16 v[144:147], v[240:243], v[244:251], v10
    v_smfmac_f32_16x16x64_bf16 v[180:183], v[240:243], v[244:251], v10 abid:1
    s_waitcnt lgkmcnt(0)
    v_xad_u32 v236, v236, v3, v4
    s_waitcnt vmcnt(15)
    v_xad_u32 v237, v237, v3, v4
    v_smfmac_f32_16x16x64_bf16 v[156:159], v[84:87], v[204:211], v51 abid:1
    ds_read2st64_b32 v[244:245], v236 offset0:0 offset1:72
    ds_read2st64_b32 v[246:247], v237 offset0:0 offset1:72
    v_xad_u32 v238, v238, v3, v4
    s_waitcnt vmcnt(13)
    v_xad_u32 v239, v239, v3, v4
    v_smfmac_f32_16x16x64_bf16 v[124:127], v[88:91], v[196:203], v44
    ds_read2st64_b32 v[248:249], v238 offset0:0 offset1:72
    ds_read2st64_b32 v[250:251], v239 offset0:0 offset1:72
    ds_read_b128 v[240:243], v8 offset:6144
    ds_read_b128 v[236:239], v9 offset:9472
    s_waitcnt vmcnt(12)
    v_smfmac_f32_16x16x64_bf16 v[128:131], v[92:95], v[196:203], v44 abid:1
    s_waitcnt vmcnt(11)
    v_smfmac_f32_16x16x64_bf16 v[132:135], v[96:99], v[196:203], v45
    s_waitcnt vmcnt(10)
    v_smfmac_f32_16x16x64_bf16 v[136:139], v[100:103], v[196:203], v45 abid:1
    s_waitcnt lgkmcnt(1)
    v_smfmac_f32_16x16x64_bf16 v[148:151], v[240:243], v[244:251], v10
    v_smfmac_f32_16x16x64_bf16 v[184:187], v[240:243], v[244:251], v10 abid:1
    s_waitcnt lgkmcnt(0)
    v_xad_u32 v236, v236, v3, v4
    s_waitcnt vmcnt(9)
    v_xad_u32 v237, v237, v3, v4
    v_smfmac_f32_16x16x64_bf16 v[140:143], v[104:107], v[196:203], v46
    ds_read2st64_b32 v[244:245], v236 offset0:0 offset1:72
    ds_read2st64_b32 v[246:247], v237 offset0:0 offset1:72
    v_xad_u32 v238, v238, v3, v4
    s_waitcnt vmcnt(8)
    v_xad_u32 v239, v239, v3, v4
    v_smfmac_f32_16x16x64_bf16 v[144:147], v[108:111], v[196:203], v46 abid:1
    ds_read2st64_b32 v[248:249], v238 offset0:0 offset1:72
    ds_read2st64_b32 v[250:251], v239 offset0:0 offset1:72
    ds_read_b128 v[240:243], v8 offset:4096
    s_waitcnt vmcnt(7)
    v_smfmac_f32_16x16x64_bf16 v[148:151], v[112:115], v[196:203], v47
    s_waitcnt vmcnt(6)
    v_smfmac_f32_16x16x64_bf16 v[152:155], v[116:119], v[196:203], v47 abid:1
    s_waitcnt vmcnt(5)
    v_smfmac_f32_16x16x64_bf16 v[156:159], v[120:123], v[196:203], v52
    s_waitcnt lgkmcnt(0)
    v_smfmac_f32_16x16x64_bf16 v[140:143], v[240:243], v[244:251], v10
    v_smfmac_f32_16x16x64_bf16 v[176:179], v[240:243], v[244:251], v10 abid:1
    s_cmp_gt_u32 s46, s80
    s_cbranch_scc1 M_slow
M_slowr0:
    s_cmp_eq_u32 s20, 0
    s_mov_b32 s31, 1073903880
    s_cselect_b32 s30, 162048, s31
    v_mov_b32 v11, s31
    v_writelane_b32 v11, s30, 0
    v_cvt_pk_bf16_f32 v124, v124, v125
    v_cvt_pk_bf16_f32 v125, v126, v127
    v_cvt_pk_bf16_f32 v126, v128, v129
    v_cvt_pk_bf16_f32 v127, v130, v131
    v_cvt_pk_bf16_f32 v132, v132, v133
    v_cvt_pk_bf16_f32 v133, v134, v135
    v_cvt_pk_bf16_f32 v134, v136, v137
    v_cvt_pk_bf16_f32 v135, v138, v139
    ds_read_b128 v[136:139], v9 offset:10432
    v_cndmask_b32_dpp v128, v124, v132, vcc row_ror:8 row_mask:0xf bank_mask:0xf
    v_cndmask_b32_dpp v129, v125, v133, vcc row_ror:8 row_mask:0xf bank_mask:0xf
    v_cndmask_b32_dpp v130, v126, v134, vcc row_ror:8 row_mask:0xf bank_mask:0xf
    v_cndmask_b32_dpp v131, v127, v135, vcc row_ror:8 row_mask:0xf bank_mask:0xf
    buffer_store_dwordx4 v[128:131], v6, s[12:15], s59 offen offset:0 sc1
    v_mov_b32_dpp v124, v132 row_ror:8 row_mask:0xf bank_mask:0xc
    v_mov_b32_dpp v125, v133 row_ror:8 row_mask:0xf bank_mask:0xc
    v_mov_b32_dpp v126, v134 row_ror:8 row_mask:0xf bank_mask:0xc
    v_mov_b32_dpp v127, v135 row_ror:8 row_mask:0xf bank_mask:0xc
    buffer_store_dwordx4 v[124:127], v6, s[12:15], s24 offen offset:0 sc1
    ds_read_b128 v[128:131], v9 offset:10304
    ds_read_b128 v[132:135], v9 offset:10368
    ds_read_b128 v[124:127], v9 offset:10240
    v_cvt_pk_bf16_f32 v140, v140, v141
    v_cvt_pk_bf16_f32 v141, v142, v143
    v_cvt_pk_bf16_f32 v142, v144, v145
    v_cvt_pk_bf16_f32 v143, v146, v147
    v_cvt_pk_bf16_f32 v148, v148, v149
    v_cvt_pk_bf16_f32 v149, v150, v151
    v_cvt_pk_bf16_f32 v150, v152, v153
    v_cvt_pk_bf16_f32 v151, v154, v155
    ds_read_b128 v[152:155], v9 offset:10688
    v_cndmask_b32_dpp v144, v140, v148, vcc row_ror:8 row_mask:0xf bank_mask:0xf
    v_cndmask_b32_dpp v145, v141, v149, vcc row_ror:8 row_mask:0xf bank_mask:0xf
    v_cndmask_b32_dpp v146, v142, v150, vcc row_ror:8 row_mask:0xf bank_mask:0xf
    v_cndmask_b32_dpp v147, v143, v151, vcc row_ror:8 row_mask:0xf bank_mask:0xf
    buffer_store_dwordx4 v[144:147], v6, s[12:15], s59 offen offset:128 sc1
    v_mov_b32_dpp v140, v148 row_ror:8 row_mask:0xf bank_mask:0xc
    v_mov_b32_dpp v141, v149 row_ror:8 row_mask:0xf bank_mask:0xc
    v_mov_b32_dpp v142, v150 row_ror:8 row_mask:0xf bank_mask:0xc
    v_mov_b32_dpp v143, v151 row_ror:8 row_mask:0xf bank_mask:0xc
    buffer_store_dwordx4 v[140:143], v6, s[12:15], s24 offen offset:128 sc1
    ds_read_b128 v[144:147], v9 offset:10560
    ds_read_b128 v[148:151], v9 offset:10624
    ds_read_b128 v[140:143], v9 offset:10496
    v_cvt_pk_bf16_f32 v156, v156, v157
    v_cvt_pk_bf16_f32 v157, v158, v159
    ds_write_b64 v53, v[156:157] offset:25728
    ds_read_b128 v[156:159], v9 offset:10752
    s_mov_b32 s89, 0
    s_mov_b32 s101, 34209792
    s_mov_b32 s91, 0
    s_mov_b32 s25, 36864
    s_add_u32 s90, s24, 9437184
    s_mov_b32 s28, s26
    s_add_u32 s23, s24, 18432
    s_cmp_lt_u32 s20, 2
    s_cselect_b32 s66, s23, s24
    s_cselect_b32 s99, s14, 74612736
    s_add_u32 s66, s66, s95
    v_add_u32 v4, 36864, v4
    v_add_u32 v1, 36864, v1
    v_add_u32 v2, 36864, v2
M_top:
M_top1:
    s_add_u32 s23, s24, 18432
    s_add_u32 s58, s24, 27648
    s_mov_b32 s24, s90
    s_add_u32 s59, s90, 9216
    s_waitcnt lgkmcnt(0)
    s_barrier
    ds_read_b128 v[244:247], v8 offset:10816
    v_smfmac_f32_16x16x64_bf16 v[160:163], a[252:255], v[220:227], v40
    ds_read_b128 v[196:199], v1 offset:0
    v_smfmac_f32_16x16x64_bf16 v[160:163], v[88:91], v[228:235], v44
    ds_read_b128 v[200:203], v2 offset:0
    s_cmp_lt_u32 s22, 75497472
    s_cbranch_scc0 M_bF
    s_cmp_eq_u32 s91, 1
    s_cbranch_scc1 M_bE0
M_bL:
    v_smfmac_f32_16x16x64_bf16 v[164:167], v[56:59], v[220:227], v40 abid:1
    ds_read_b128 v[204:207], v1 offset:1024
    s_cmp_lt_u32 s22, 74612736
    s_cselect_b32 s30, 1, 0
    v_smfmac_f32_16x16x64_bf16 v[164:167], v[92:95], v[228:235], v44 abid:1
    ds_read_b128 v[208:211], v2 offset:1024
    v_mov_b32 v0, s30
    v_smfmac_f32_16x16x64_bf16 v[168:171], v[60:63], v[220:227], v41
    ds_read_b128 v[212:215], v1 offset:2048
    v_smfmac_f32_16x16x64_bf16 v[168:171], v[96:99], v[228:235], v45
    ds_read_b128 v[216:219], v2 offset:2048
    v_smfmac_f32_16x16x64_bf16 v[172:175], v[64:67], v[220:227], v41 abid:1
    s_waitcnt vmcnt(6)
    s_waitcnt lgkmcnt(6)
    buffer_store_dwordx4 v[244:247], v7, s[12:15], s66 offen sc1
    v_smfmac_f32_16x16x64_bf16 v[172:175], v[100:103], v[228:235], v45 abid:1
    ds_read_b128 v[236:239], v9 offset:9408
    v_smfmac_f32_16x16x64_bf16 v[176:179], v[68:71], v[220:227], v42
    s_waitcnt vmcnt(6)
    buffer_atomic_add v0, v11, s[16:19], s92 offen sc0 sc1
    s_mov_b32 s21, 1
    v_smfmac_f32_16x16x64_bf16 v[176:179], v[104:107], v[228:235], v46
    v_smfmac_f32_16x16x64_bf16 v[180:183], v[72:75], v[220:227], v42 abid:1
    v_cvt_pk_bf16_f32 v160, v160, v161
    v_smfmac_f32_16x16x64_bf16 v[180:183], v[108:111], v[228:235], v46 abid:1
    v_cvt_pk_bf16_f32 v161, v162, v163
    v_smfmac_f32_16x16x64_bf16 v[184:187], v[76:79], v[220:227], v43
    v_cvt_pk_bf16_f32 v162, v164, v165
    v_smfmac_f32_16x16x64_bf16 v[184:187], v[112:115], v[228:235], v47
    v_cvt_pk_bf16_f32 v163, v166, v167
    v_smfmac_f32_16x16x64_bf16 v[188:191], v[80:83], v[220:227], v43 abid:1
    s_add_u32 m0, m0, 896
    v_cvt_pk_bf16_f32 v168, v168, v169
    v_smfmac_f32_16x16x64_bf16 v[188:191], v[116:119], v[228:235], v47 abid:1
    s_waitcnt vmcnt(6)
    buffer_load_dwordx4 v5, s[8:11], s22 offen offset:512 nt lds
    v_cvt_pk_bf16_f32 v169, v170, v171
    v_smfmac_f32_16x16x64_bf16 v[192:195], v[84:87], v[220:227], v51 abid:1
    v_cvt_pk_bf16_f32 v170, v172, v173
    v_smfmac_f32_16x16x64_bf16 v[192:195], v[120:123], v[228:235], v52
    ds_read_b128 v[220:223], v1 offset:3072
    s_waitcnt lgkmcnt(6)
    v_cvt_pk_bf16_f32 v171, v174, v175
    v_smfmac_f32_16x16x64_bf16 v[124:127], a[0:3], v[196:203], v12
    ds_read_b128 v[224:227], v2 offset:3072
    ds_read_b128 v[172:175], v9 offset:10432
    s_waitcnt lgkmcnt(6)
    v_cndmask_b32_dpp v164, v160, v168, vcc row_ror:8 row_mask:0xf bank_mask:0xf
    v_smfmac_f32_16x16x64_bf16 v[124:127], a[36:39], v[204:211], v16
    ds_read_b128 v[228:231], v1 offset:4096
    s_waitcnt lgkmcnt(5)
    v_cndmask_b32_dpp v165, v161, v169, vcc row_ror:8 row_mask:0xf bank_mask:0xf
    v_smfmac_f32_16x16x64_bf16 v[124:127], a[72:75], v[212:219], v20
    ds_read_b128 v[232:235], v2 offset:4096
    v_cndmask_b32_dpp v166, v162, v170, vcc row_ror:8 row_mask:0xf bank_mask:0xf
    v_smfmac_f32_16x16x64_bf16 v[128:131], a[4:7], v[196:203], v12 abid:1
    s_barrier
    v_cndmask_b32_dpp v167, v163, v171, vcc row_ror:8 row_mask:0xf bank_mask:0xf
    v_smfmac_f32_16x16x64_bf16 v[128:131], a[40:43], v[204:211], v16 abid:1
    s_waitcnt vmcnt(6)
    buffer_store_dwordx4 v[164:167], v6, s[12:15], s58 offen offset:0 sc1
    s_waitcnt lgkmcnt(5)
    v_xad_u32 v236, v236, v3, v4
    v_smfmac_f32_16x16x64_bf16 v[128:131], a[76:79], v[212:219], v20 abid:1
    v_xad_u32 v237, v237, v3, v4
    v_smfmac_f32_16x16x64_bf16 v[132:135], a[8:11], v[196:203], v13
    ds_read2st64_b32 v[244:245], v236 offset0:0 offset1:72
    ds_read_b128 v[240:243], v8 offset:3072
    v_xad_u32 v238, v238, v3, v4
    v_smfmac_f32_16x16x64_bf16 v[132:135], a[44:47], v[204:211], v17
    ds_read2st64_b32 v[246:247], v237 offset0:0 offset1:72
    v_xad_u32 v239, v239, v3, v4
    v_smfmac_f32_16x16x64_bf16 v[132:135], a[80:83], v[212:219], v21
    ds_read2st64_b32 v[248:249], v238 offset0:0 offset1:72
    v_mov_b32_dpp v160, v168 row_ror:8 row_mask:0xf bank_mask:0xc
    v_smfmac_f32_16x16x64_bf16 v[144:147], a[20:23], v[196:203], v14 abid:1
    ds_read2st64_b32 v[250:251], v239 offset0:0 offset1:72
    ds_read_b128 v[236:239], v9 offset:9280
    v_mov_b32_dpp v161, v169 row_ror:8 row_mask:0xf bank_mask:0xc
    v_smfmac_f32_16x16x64_bf16 v[144:147], a[56:59], v[204:211], v18 abid:1
    v_mov_b32_dpp v162, v170 row_ror:8 row_mask:0xf bank_mask:0xc
    v_smfmac_f32_16x16x64_bf16 v[144:147], a[92:95], v[212:219], v22 abid:1
    v_mov_b32_dpp v163, v171 row_ror:8 row_mask:0xf bank_mask:0xc
    v_smfmac_f32_16x16x64_bf16 v[140:143], a[16:19], v[196:203], v14
    s_waitcnt vmcnt(6)
    buffer_store_dwordx4 v[160:163], v6, s[12:15], s23 offen offset:0 sc1
    ds_read_b128 v[164:167], v9 offset:10304
    v_smfmac_f32_16x16x64_bf16 v[140:143], a[52:55], v[204:211], v18
    ds_read_b128 v[168:171], v9 offset:10368
    ds_read_b128 v[160:163], v9 offset:10240
    v_smfmac_f32_16x16x64_bf16 v[140:143], a[88:91], v[212:219], v22
    v_smfmac_f32_16x16x64_bf16 v[136:139], a[12:15], v[196:203], v13 abid:1
    v_smfmac_f32_16x16x64_bf16 v[136:139], a[48:51], v[204:211], v17 abid:1
    v_smfmac_f32_16x16x64_bf16 v[136:139], a[84:87], v[212:219], v21 abid:1
    s_waitcnt lgkmcnt(3)
    v_xad_u32 v236, v236, v3, v4
    v_smfmac_f32_16x16x64_bf16 v[136:139], v[240:243], v[244:251], v10
    v_xad_u32 v237, v237, v3, v4
    v_smfmac_f32_16x16x64_bf16 v[172:175], v[240:243], v[244:251], v10 abid:1
    ds_read2st64_b32 v[244:245], v236 offset0:0 offset1:72
    ds_read_b128 v[240:243], v8 offset:1024
    v_xad_u32 v238, v238, v3, v4
    v_smfmac_f32_16x16x64_bf16 v[148:151], a[24:27], v[196:203], v15
    ds_read2st64_b32 v[246:247], v237 offset0:0 offset1:72
    v_xad_u32 v239, v239, v3, v4
    v_smfmac_f32_16x16x64_bf16 v[148:151], a[60:63], v[204:211], v19
    ds_read2st64_b32 v[248:249], v238 offset0:0 offset1:72
    v_cvt_pk_bf16_f32 v192, v192, v193
    v_smfmac_f32_16x16x64_bf16 v[148:151], a[96:99], v[212:219], v23
    ds_read2st64_b32 v[250:251], v239 offset0:0 offset1:72
    ds_read_b128 v[236:239], v9 offset:9344
    v_cvt_pk_bf16_f32 v193, v194, v195
    v_smfmac_f32_16x16x64_bf16 v[152:155], a[28:31], v[196:203], v15 abid:1
    ds_write_b64 v53, v[192:193] offset:0
    ds_read_b128 v[192:195], v9 offset:10752
    v_smfmac_f32_16x16x64_bf16 v[152:155], a[64:67], v[204:211], v19 abid:1
    s_add_u32 m0, m0, 896
    v_smfmac_f32_16x16x64_bf16 v[152:155], a[100:103], v[212:219], v23 abid:1
    s_waitcnt vmcnt(6)
    buffer_load_dwordx4 v5, s[8:11], s22 offen offset:640 nt lds
    v_smfmac_f32_16x16x64_bf16 v[156:159], a[32:35], v[196:203], v48
    v_smfmac_f32_16x16x64_bf16 v[156:159], a[68:71], v[204:211], v48 abid:1
    v_smfmac_f32_16x16x64_bf16 v[156:159], a[104:107], v[212:219], v49
    ds_read_b128 v[196:199], v1 offset:5120
    v_cvt_pk_bf16_f32 v176, v176, v177
    v_smfmac_f32_16x16x64_bf16 v[124:127], a[108:111], v[220:227], v24
    ds_read_b128 v[200:203], v2 offset:5120
    v_cvt_pk_bf16_f32 v177, v178, v179
    v_smfmac_f32_16x16x64_bf16 v[124:127], a[144:147], v[228:235], v28
    ds_read_b128 v[204:207], v1 offset:6144
    ds_read_b64 v[216:217], v9 offset:10056
    v_cvt_pk_bf16_f32 v178, v180, v181
    v_smfmac_f32_16x16x64_bf16 v[128:131], a[112:115], v[220:227], v24 abid:1
    ds_read_b128 v[208:211], v2 offset:6144
    v_cvt_pk_bf16_f32 v179, v182, v183
    v_smfmac_f32_16x16x64_bf16 v[128:131], a[148:151], v[228:235], v28 abid:1
    s_waitcnt lgkmcnt(7)
    v_xad_u32 v236, v236, v3, v4
    v_smfmac_f32_16x16x64_bf16 v[128:131], v[240:243], v[244:251], v10
    s_add_u32 m0, m0, 896
    v_xad_u32 v237, v237, v3, v4
    v_smfmac_f32_16x16x64_bf16 v[164:167], v[240:243], v[244:251], v10 abid:1
    ds_read2st64_b32 v[244:245], v236 offset0:0 offset1:72
    ds_read_b128 v[240:243], v8 offset:2048
    v_xad_u32 v238, v238, v3, v4
    v_smfmac_f32_16x16x64_bf16 v[152:155], a[136:139], v[220:227], v27 abid:1
    ds_read2st64_b32 v[246:247], v237 offset0:0 offset1:72
    s_waitcnt vmcnt(6)
    v_xad_u32 v239, v239, v3, v4
    v_smfmac_f32_16x16x64_bf16 v[152:155], a[172:175], v[228:235], v31 abid:1
    ds_read2st64_b32 v[248:249], v238 offset0:0 offset1:72
    buffer_load_dwordx4 v5, s[8:11], s22 offen offset:768 nt lds
    v_cvt_pk_bf16_f32 v184, v184, v185
    v_smfmac_f32_16x16x64_bf16 v[136:139], a[120:123], v[220:227], v25 abid:1
    ds_read2st64_b32 v[250:251], v239 offset0:0 offset1:72
    ds_read_b128 v[236:239], v9 offset:9216
    v_cvt_pk_bf16_f32 v185, v186, v187
    v_smfmac_f32_16x16x64_bf16 v[136:139], a[156:159], v[228:235], v29 abid:1
    v_cvt_pk_bf16_f32 v186, v188, v189
    v_smfmac_f32_16x16x64_bf16 v[140:143], a[124:127], v[220:227], v26
    v_cvt_pk_bf16_f32 v187, v190, v191
    v_smfmac_f32_16x16x64_bf16 v[140:143], a[160:163], v[228:235], v30
    ds_read_b128 v[188:191], v9 offset:10688
    v_cndmask_b32_dpp v180, v176, v184, vcc row_ror:8 row_mask:0xf bank_mask:0xf
    v_smfmac_f32_16x16x64_bf16 v[144:147], a[128:131], v[220:227], v26 abid:1
    v_cndmask_b32_dpp v181, v177, v185, vcc row_ror:8 row_mask:0xf bank_mask:0xf
    v_smfmac_f32_16x16x64_bf16 v[144:147], a[164:167], v[228:235], v30 abid:1
    v_cndmask_b32_dpp v182, v178, v186, vcc row_ror:8 row_mask:0xf bank_mask:0xf
    v_smfmac_f32_16x16x64_bf16 v[148:151], a[132:135], v[220:227], v27
    v_cndmask_b32_dpp v183, v179, v187, vcc row_ror:8 row_mask:0xf bank_mask:0xf
    v_smfmac_f32_16x16x64_bf16 v[148:151], a[168:171], v[228:235], v31
    s_waitcnt vmcnt(6)
    buffer_store_dwordx4 v[180:183], v6, s[12:15], s58 offen offset:128 sc1
    s_waitcnt lgkmcnt(8)
    v_xad_u32 v212, v216, v3, v4
    v_smfmac_f32_16x16x64_bf16 v[132:135], a[116:119], v[220:227], v25
    ds_read2st64_b32 v[212:213], v212 offset0:0 offset1:72
    v_xad_u32 v214, v217, v3, v4
    v_smfmac_f32_16x16x64_bf16 v[132:135], a[152:155], v[228:235], v29
    ds_read2st64_b32 v[214:215], v214 offset0:0 offset1:72
    s_waitcnt lgkmcnt(3)
    v_xad_u32 v236, v236, v3, v4
    v_smfmac_f32_16x16x64_bf16 v[132:135], v[240:243], v[244:251], v10
    v_xad_u32 v237, v237, v3, v4
    v_smfmac_f32_16x16x64_bf16 v[168:171], v[240:243], v[244:251], v10 abid:1
    ds_read2st64_b32 v[244:245], v236 offset0:0 offset1:72
    ds_read_b128 v[240:243], v8 offset:0
    v_xad_u32 v238, v238, v3, v4
    v_smfmac_f32_16x16x64_bf16 v[156:159], a[140:143], v[220:227], v49 abid:1
    ds_read2st64_b32 v[246:247], v237 offset0:0 offset1:72
    v_xad_u32 v239, v239, v3, v4
    v_smfmac_f32_16x16x64_bf16 v[156:159], a[176:179], v[228:235], v50
    ds_read2st64_b32 v[248:249], v238 offset0:0 offset1:72
    v_mov_b32_dpp v176, v184 row_ror:8 row_mask:0xf bank_mask:0xc
    v_smfmac_f32_16x16x64_bf16 v[140:143], a[196:199], v[196:203], v34
    ds_read2st64_b32 v[250:251], v239 offset0:0 offset1:72
    ds_read_b128 v[236:239], v9 offset:9728
    v_mov_b32_dpp v177, v185 row_ror:8 row_mask:0xf bank_mask:0xc
    v_smfmac_f32_16x16x64_bf16 v[140:143], a[232:235], v[204:211], v38
    v_mov_b32_dpp v178, v186 row_ror:8 row_mask:0xf bank_mask:0xc
    v_smfmac_f32_16x16x64_bf16 v[128:131], a[184:187], v[196:203], v32 abid:1
    v_mov_b32_dpp v179, v187 row_ror:8 row_mask:0xf bank_mask:0xc
    v_smfmac_f32_16x16x64_bf16 v[128:131], a[220:223], v[204:211], v36 abid:1
    s_waitcnt vmcnt(6)
    buffer_store_dwordx4 v[176:179], v6, s[12:15], s23 offen offset:128 sc1
    ds_read_b128 v[180:183], v9 offset:10560
    v_smfmac_f32_16x16x64_bf16 v[132:135], a[188:191], v[196:203], v33
    ds_read_b128 v[184:187], v9 offset:10624
    ds_read_b128 v[176:179], v9 offset:10496
    v_smfmac_f32_16x16x64_bf16 v[132:135], a[224:227], v[204:211], v37
    v_smfmac_f32_16x16x64_bf16 v[136:139], a[192:195], v[196:203], v33 abid:1
    ds_read_b128 v[220:223], v1 offset:7168
    v_smfmac_f32_16x16x64_bf16 v[136:139], a[228:231], v[204:211], v37 abid:1
    ds_read_b128 v[224:227], v2 offset:7168
    v_smfmac_f32_16x16x64_bf16 v[124:127], a[180:183], v[196:203], v32
    ds_read_b128 v[228:231], v1 offset:8192
    v_smfmac_f32_16x16x64_bf16 v[124:127], a[216:219], v[204:211], v36
    s_waitcnt vmcnt(7)
    s_waitcnt lgkmcnt(6)
    v_xad_u32 v236, v236, v3, v4
    v_smfmac_f32_16x16x64_bf16 v[124:127], v[240:243], v[244:251], v10
    ds_read_b128 v[232:235], v2 offset:8192
    v_xad_u32 v237, v237, v3, v4
    v_smfmac_f32_16x16x64_bf16 v[160:163], v[240:243], v[244:251], v10 abid:1
    ds_read2st64_b32 v[244:245], v236 offset0:0 offset1:72
    ds_read_b128 v[240:243], v8 offset:8192
    v_xad_u32 v238, v238, v3, v4
    v_smfmac_f32_16x16x64_bf16 v[144:147], a[200:203], v[196:203], v34 abid:1
    ds_read2st64_b32 v[246:247], v237 offset0:0 offset1:72
    v_xad_u32 v239, v239, v3, v4
    v_smfmac_f32_16x16x64_bf16 v[144:147], a[236:239], v[204:211], v38 abid:1
    ds_read2st64_b32 v[248:249], v238 offset0:0 offset1:72
    v_mul_u32_u24 v0, s94, v0
    v_smfmac_f32_16x16x64_bf16 v[148:151], a[204:207], v[196:203], v35
    ds_read2st64_b32 v[250:251], v239 offset0:0 offset1:72
    ds_read_b128 v[236:239], v9 offset:9664
    v_add_u32 v0, s93, v0
    v_smfmac_f32_16x16x64_bf16 v[148:151], a[240:243], v[204:211], v39
    s_waitcnt lgkmcnt(10)
    s_cmp_lt_i32 s81, 0
    s_cbranch_scc1 M_ovrL
    s_swappc_b64 s[78:79], s[72:73]
M_ovrL:
    v_smfmac_f32_16x16x64_bf16 v[152:155], a[208:211], v[196:203], v35 abid:1
    ds_write_b32 v11, v0
    v_mov_b32 v0, 162048
    v_smfmac_f32_16x16x64_bf16 v[152:155], a[244:247], v[204:211], v39 abid:1
    s_add_u32 m0, m0, 896
    v_smfmac_f32_16x16x64_bf16 v[156:159], a[212:215], v[196:203], v50 abid:1
    s_waitcnt vmcnt(6)
    buffer_load_dwordx4 v5, s[8:11], s22 offen offset:896 nt lds
    v_smfmac_f32_16x16x64_bf16 v[156:159], a[248:251], v[204:211], v51
    s_waitcnt lgkmcnt(9)
    v_smfmac_f32_16x16x64_bf16 v[124:127], a[252:255], v[220:227], v40
    ds_read_b128 v[196:199], v1 offset:18432
    s_waitcnt lgkmcnt(8)
    v_smfmac_f32_16x16x64_bf16 v[124:127], v[88:91], v[228:235], v44
    ds_read_b128 v[200:203], v2 offset:18432
    v_smfmac_f32_16x16x64_bf16 v[156:159], v[84:87], v[220:227], v51 abid:1
    ds_read_b128 v[204:207], v1 offset:19456
    v_smfmac_f32_16x16x64_bf16 v[156:159], v[120:123], v[228:235], v52
    s_waitcnt lgkmcnt(3)
    s_barrier
    v_xad_u32 v236, v236, v3, v4
    v_smfmac_f32_16x16x64_bf16 v[156:159], v[240:243], v[244:251], v10
    ds_read_b128 v[208:211], v2 offset:19456
    ds_read_b32 v0, v0
    v_xad_u32 v237, v237, v3, v4
    v_smfmac_f32_16x16x64_bf16 v[192:195], v[240:243], v[244:251], v10 abid:1
    ds_read2st64_b32 v[244:245], v236 offset0:0 offset1:72
    ds_read_b128 v[240:243], v8 offset:7168
    v_xad_u32 v238, v238, v3, v4
    v_smfmac_f32_16x16x64_bf16 v[132:135], v[60:63], v[220:227], v41
    ds_read2st64_b32 v[246:247], v237 offset0:0 offset1:72
    v_xad_u32 v239, v239, v3, v4
    v_smfmac_f32_16x16x64_bf16 v[132:135], v[96:99], v[228:235], v45
    ds_read2st64_b32 v[248:249], v238 offset0:0 offset1:72
    s_add_u32 m0, m0, 896
    v_smfmac_f32_16x16x64_bf16 v[136:139], v[64:67], v[220:227], v41 abid:1
    ds_read2st64_b32 v[250:251], v239 offset0:0 offset1:72
    ds_read_b128 v[236:239], v9 offset:9536
    s_waitcnt vmcnt(6)
    v_smfmac_f32_16x16x64_bf16 v[136:139], v[100:103], v[228:235], v45 abid:1
    buffer_load_dwordx4 v5, s[8:11], s22 offen offset:1024 nt lds
    s_waitcnt lgkmcnt(6)
    v_readfirstlane_b32 s88, v0
    v_smfmac_f32_16x16x64_bf16 v[140:143], v[68:71], v[220:227], v42
    s_add_u32 s30, s88, 74612736
    s_lshr_b32 s30, s30, 1
    s_min_u32 s88, s88, s30
    v_smfmac_f32_16x16x64_bf16 v[140:143], v[104:107], v[228:235], v46
    s_min_u32 s88, s88, s14
    v_smfmac_f32_16x16x64_bf16 v[144:147], v[72:75], v[220:227], v42 abid:1
    ds_read_b128 v[212:215], v1 offset:20480
    s_cmp_lt_u32 s22, 74612736
    s_cselect_b32 s88, s88, s14
    v_smfmac_f32_16x16x64_bf16 v[144:147], v[108:111], v[228:235], v46 abid:1
    ds_read_b128 v[216:219], v2 offset:20480
    s_cmp_lt_u32 s88, s99
    s_cselect_b32 s10, 75497472, 0
    v_smfmac_f32_16x16x64_bf16 v[148:151], v[76:79], v[220:227], v43
    s_cmp_lt_u32 s88, s14
    s_cbranch_scc0 M_q
M_nq:
    v_smfmac_f32_16x16x64_bf16 v[148:151], v[112:115], v[228:235], v47
    v_smfmac_f32_16x16x64_bf16 v[152:155], v[80:83], v[220:227], v43 abid:1
    v_smfmac_f32_16x16x64_bf16 v[152:155], v[116:119], v[228:235], v47 abid:1
    s_waitcnt lgkmcnt(2)
    v_xad_u32 v236, v236, v3, v4
    v_smfmac_f32_16x16x64_bf16 v[152:155], v[240:243], v[244:251], v10
    v_xad_u32 v237, v237, v3, v4
    v_smfmac_f32_16x16x64_bf16 v[188:191], v[240:243], v[244:251], v10 abid:1
    s_cmp_gt_u32 s46, s80
    s_cbranch_scc1 M_slow
M_slowrL:
    v_xad_u32 v238, v238, v3, v4
    v_smfmac_f32_16x16x64_bf16 v[128:131], v[56:59], v[220:227], v40 abid:1
    ds_read2st64_b32 v[244:245], v236 offset0:0 offset1:72
    ds_read_b128 v[240:243], v8 offset:5120
    v_xad_u32 v239, v239, v3, v4
    v_smfmac_f32_16x16x64_bf16 v[128:131], v[92:95], v[228:235], v44 abid:1
    ds_read2st64_b32 v[246:247], v237 offset0:0 offset1:72
    v_smfmac_f32_16x16x64_bf16 v[160:163], a[0:3], v[196:203], v12
    ds_read2st64_b32 v[248:249], v238 offset0:0 offset1:72
    v_smfmac_f32_16x16x64_bf16 v[160:163], a[36:39], v[204:211], v16
    ds_read2st64_b32 v[250:251], v239 offset0:0 offset1:72
    ds_read_b128 v[236:239], v9 offset:9600
    s_waitcnt lgkmcnt(6)
    v_smfmac_f32_16x16x64_bf16 v[160:163], a[72:75], v[212:219], v20
    v_smfmac_f32_16x16x64_bf16 v[164:167], a[4:7], v[196:203], v12 abid:1
    s_mov_b32 m0, s28
    v_cvt_pk_bf16_f32 v156, v156, v157
    v_smfmac_f32_16x16x64_bf16 v[164:167], a[40:43], v[204:211], v16 abid:1
    s_waitcnt vmcnt(6)
    buffer_load_dwordx4 v5, s[8:11], s88 offen offset:0 nt lds
    v_cvt_pk_bf16_f32 v157, v158, v159
    v_smfmac_f32_16x16x64_bf16 v[164:167], a[76:79], v[212:219], v20 abid:1
    ds_write_b64 v53, v[156:157] offset:25728
    ds_read_b128 v[156:159], v9 offset:10752
    v_smfmac_f32_16x16x64_bf16 v[180:183], a[20:23], v[196:203], v14 abid:1
    v_smfmac_f32_16x16x64_bf16 v[180:183], a[56:59], v[204:211], v18 abid:1
    ds_read_b128 v[220:223], v1 offset:21504
    v_cvt_pk_bf16_f32 v124, v124, v125
    v_smfmac_f32_16x16x64_bf16 v[180:183], a[92:95], v[212:219], v22 abid:1
    s_waitcnt lgkmcnt(3)
    v_xad_u32 v236, v236, v3, v4
    v_smfmac_f32_16x16x64_bf16 v[180:183], v[240:243], v[244:251], v10 abid:1
    v_xad_u32 v237, v237, v3, v4
    v_smfmac_f32_16x16x64_bf16 v[144:147], v[240:243], v[244:251], v10
    ds_read2st64_b32 v[244:245], v236 offset0:0 offset1:72
    ds_read_b128 v[240:243], v8 offset:6144
    v_xad_u32 v238, v238, v3, v4
    v_smfmac_f32_16x16x64_bf16 v[172:175], a[12:15], v[196:203], v13 abid:1
    ds_read2st64_b32 v[246:247], v237 offset0:0 offset1:72
    v_xad_u32 v239, v239, v3, v4
    v_smfmac_f32_16x16x64_bf16 v[172:175], a[48:51], v[204:211], v17 abid:1
    ds_read2st64_b32 v[248:249], v238 offset0:0 offset1:72
    v_cvt_pk_bf16_f32 v125, v126, v127
    v_smfmac_f32_16x16x64_bf16 v[172:175], a[84:87], v[212:219], v21 abid:1
    ds_read2st64_b32 v[250:251], v239 offset0:0 offset1:72
    ds_read_b128 v[236:239], v9 offset:9472
    v_cvt_pk_bf16_f32 v126, v128, v129
    v_smfmac_f32_16x16x64_bf16 v[176:179], a[16:19], v[196:203], v14
    v_cvt_pk_bf16_f32 v127, v130, v131
    v_smfmac_f32_16x16x64_bf16 v[176:179], a[52:55], v[204:211], v18
    v_cvt_pk_bf16_f32 v132, v132, v133
    v_smfmac_f32_16x16x64_bf16 v[176:179], a[88:91], v[212:219], v22
    v_cvt_pk_bf16_f32 v133, v134, v135
    v_smfmac_f32_16x16x64_bf16 v[168:171], a[8:11], v[196:203], v13
    s_add_u32 m0, m0, 896
    v_cvt_pk_bf16_f32 v134, v136, v137
    v_smfmac_f32_16x16x64_bf16 v[168:171], a[44:47], v[204:211], v17
    s_waitcnt vmcnt(6)
    buffer_load_dwordx4 v5, s[8:11], s88 offen offset:128 nt lds
    v_cvt_pk_bf16_f32 v135, v138, v139
    v_smfmac_f32_16x16x64_bf16 v[168:171], a[80:83], v[212:219], v21
    ds_read_b128 v[224:227], v2 offset:21504
    ds_read_b128 v[136:139], v9 offset:10432
    v_cndmask_b32_dpp v128, v124, v132, vcc row_ror:8 row_mask:0xf bank_mask:0xf
    v_smfmac_f32_16x16x64_bf16 v[184:187], a[24:27], v[196:203], v15
    ds_read_b128 v[228:231], v1 offset:22528
    v_cndmask_b32_dpp v129, v125, v133, vcc row_ror:8 row_mask:0xf bank_mask:0xf
    v_smfmac_f32_16x16x64_bf16 v[184:187], a[60:63], v[204:211], v19
    ds_read_b128 v[232:235], v2 offset:22528
    v_cndmask_b32_dpp v130, v126, v134, vcc row_ror:8 row_mask:0xf bank_mask:0xf
    v_smfmac_f32_16x16x64_bf16 v[184:187], a[96:99], v[212:219], v23
    s_waitcnt lgkmcnt(4)
    v_xad_u32 v236, v236, v3, v4
    v_smfmac_f32_16x16x64_bf16 v[184:187], v[240:243], v[244:251], v10 abid:1
    v_xad_u32 v237, v237, v3, v4
    v_smfmac_f32_16x16x64_bf16 v[148:151], v[240:243], v[244:251], v10
    ds_read2st64_b32 v[244:245], v236 offset0:0 offset1:72
    ds_read_b128 v[240:243], v8 offset:4096
    v_xad_u32 v238, v238, v3, v4
    v_smfmac_f32_16x16x64_bf16 v[188:191], a[28:31], v[196:203], v15 abid:1
    ds_read2st64_b32 v[246:247], v237 offset0:0 offset1:72
    v_xad_u32 v239, v239, v3, v4
    v_smfmac_f32_16x16x64_bf16 v[188:191], a[64:67], v[204:211], v19 abid:1
    ds_read2st64_b32 v[248:249], v238 offset0:0 offset1:72
    v_cndmask_b32_dpp v131, v127, v135, vcc row_ror:8 row_mask:0xf bank_mask:0xf
    v_smfmac_f32_16x16x64_bf16 v[188:191], a[100:103], v[212:219], v23 abid:1
    ds_read2st64_b32 v[250:251], v239 offset0:0 offset1:72
    s_waitcnt vmcnt(6)
    buffer_store_dwordx4 v[128:131], v6, s[12:15], s59 offen offset:0 sc1
    v_smfmac_f32_16x16x64_bf16 v[192:195], a[32:35], v[196:203], v48
    v_mov_b32_dpp v124, v132 row_ror:8 row_mask:0xf bank_mask:0xc
    v_smfmac_f32_16x16x64_bf16 v[192:195], a[68:71], v[204:211], v48 abid:1
    v_mov_b32_dpp v125, v133 row_ror:8 row_mask:0xf bank_mask:0xc
    v_smfmac_f32_16x16x64_bf16 v[192:195], a[104:107], v[212:219], v49
    s_waitcnt lgkmcnt(8)
    v_mov_b32_dpp v126, v134 row_ror:8 row_mask:0xf bank_mask:0xc
    v_smfmac_f32_16x16x64_bf16 v[160:163], a[108:111], v[220:227], v24
    s_waitcnt lgkmcnt(5)
    v_mov_b32_dpp v127, v135 row_ror:8 row_mask:0xf bank_mask:0xc
    v_smfmac_f32_16x16x64_bf16 v[160:163], a[144:147], v[228:235], v28
    ds_read_b128 v[196:199], v1 offset:23552
    s_waitcnt vmcnt(6)
    buffer_store_dwordx4 v[124:127], v6, s[12:15], s24 offen offset:0 sc1
    v_smfmac_f32_16x16x64_bf16 v[164:167], a[112:115], v[220:227], v24 abid:1
    ds_read_b128 v[200:203], v2 offset:23552
    ds_read_b128 v[128:131], v9 offset:10304
    ds_read_b128 v[132:135], v9 offset:10368
    v_smfmac_f32_16x16x64_bf16 v[164:167], a[148:151], v[228:235], v28 abid:1
    ds_read_b128 v[204:207], v1 offset:24576
    ds_read_b128 v[124:127], v9 offset:10240
    v_smfmac_f32_16x16x64_bf16 v[176:179], a[124:127], v[220:227], v26
    ds_read_b128 v[208:211], v2 offset:24576
    v_smfmac_f32_16x16x64_bf16 v[176:179], a[160:163], v[228:235], v30
    s_waitcnt lgkmcnt(7)
    v_smfmac_f32_16x16x64_bf16 v[176:179], v[240:243], v[244:251], v10 abid:1
    v_smfmac_f32_16x16x64_bf16 v[140:143], v[240:243], v[244:251], v10
    v_smfmac_f32_16x16x64_bf16 v[172:175], a[120:123], v[220:227], v25 abid:1
    s_add_u32 s28, s28, 36864
    s_cmp_ge_u32 s28, 110592
    s_cselect_b32 s28, s26, s28
    v_smfmac_f32_16x16x64_bf16 v[172:175], a[156:159], v[228:235], v29 abid:1
    s_add_u32 s30, s25, 36864
    s_cmp_eq_u32 s30, 110592
    s_cselect_b32 s30, 0, s30
    v_smfmac_f32_16x16x64_bf16 v[168:171], a[116:119], v[220:227], v25
    s_sub_u32 s31, s30, s25
    s_mov_b32 s25, s30
    s_mov_b32 s90, s22
    v_smfmac_f32_16x16x64_bf16 v[168:171], a[152:155], v[228:235], v29
    s_mov_b32 s22, s88
    s_add_u32 s91, s91, 1
    s_cmp_lt_u32 s20, 2
    v_smfmac_f32_16x16x64_bf16 v[180:183], a[128:131], v[220:227], v26 abid:1
    s_cselect_b32 s66, s23, s24
    s_add_u32 s66, s66, s95
    v_smfmac_f32_16x16x64_bf16 v[180:183], a[164:167], v[228:235], v30 abid:1
    v_cvt_pk_bf16_f32 v140, v140, v141
    v_smfmac_f32_16x16x64_bf16 v[184:187], a[132:135], v[220:227], v27
    s_add_u32 m0, m0, 896
    v_cvt_pk_bf16_f32 v141, v142, v143
    v_smfmac_f32_16x16x64_bf16 v[184:187], a[168:171], v[228:235], v31
    s_waitcnt vmcnt(6)
    buffer_load_dwordx4 v5, s[8:11], s88 offen offset:256 nt lds
    v_cvt_pk_bf16_f32 v142, v144, v145
    v_smfmac_f32_16x16x64_bf16 v[188:191], a[136:139], v[220:227], v27 abid:1
    v_cvt_pk_bf16_f32 v143, v146, v147
    v_smfmac_f32_16x16x64_bf16 v[188:191], a[172:175], v[228:235], v31 abid:1
    v_cvt_pk_bf16_f32 v148, v148, v149
    v_smfmac_f32_16x16x64_bf16 v[192:195], a[140:143], v[220:227], v49 abid:1
    v_cvt_pk_bf16_f32 v149, v150, v151
    v_smfmac_f32_16x16x64_bf16 v[192:195], a[176:179], v[228:235], v50
    ds_read_b128 v[220:223], v1 offset:25600
    s_waitcnt lgkmcnt(6)
    v_cvt_pk_bf16_f32 v150, v152, v153
    v_smfmac_f32_16x16x64_bf16 v[160:163], a[180:183], v[196:203], v32
    ds_read_b128 v[224:227], v2 offset:25600
    s_waitcnt lgkmcnt(2)
    v_cvt_pk_bf16_f32 v151, v154, v155
    v_smfmac_f32_16x16x64_bf16 v[160:163], a[216:219], v[204:211], v36
    ds_read_b128 v[228:231], v1 offset:26624
    ds_read_b128 v[152:155], v9 offset:10688
    v_cndmask_b32_dpp v144, v140, v148, vcc row_ror:8 row_mask:0xf bank_mask:0xf
    v_smfmac_f32_16x16x64_bf16 v[164:167], a[184:187], v[196:203], v32 abid:1
    ds_read_b128 v[232:235], v2 offset:26624
    v_cndmask_b32_dpp v145, v141, v149, vcc row_ror:8 row_mask:0xf bank_mask:0xf
    v_smfmac_f32_16x16x64_bf16 v[164:167], a[220:223], v[204:211], v36 abid:1
    s_add_u32 m0, m0, 896
    v_cndmask_b32_dpp v146, v142, v150, vcc row_ror:8 row_mask:0xf bank_mask:0xf
    v_smfmac_f32_16x16x64_bf16 v[168:171], a[188:191], v[196:203], v33
    s_waitcnt vmcnt(6)
    buffer_load_dwordx4 v5, s[8:11], s88 offen offset:384 nt lds
    v_cndmask_b32_dpp v147, v143, v151, vcc row_ror:8 row_mask:0xf bank_mask:0xf
    v_smfmac_f32_16x16x64_bf16 v[168:171], a[224:227], v[204:211], v37
    s_waitcnt vmcnt(6)
    buffer_store_dwordx4 v[144:147], v6, s[12:15], s59 offen offset:128 sc1
    v_mov_b32_dpp v140, v148 row_ror:8 row_mask:0xf bank_mask:0xc
    v_smfmac_f32_16x16x64_bf16 v[172:175], a[192:195], v[196:203], v33 abid:1
    v_mov_b32_dpp v141, v149 row_ror:8 row_mask:0xf bank_mask:0xc
    v_smfmac_f32_16x16x64_bf16 v[172:175], a[228:231], v[204:211], v37 abid:1
    v_mov_b32_dpp v142, v150 row_ror:8 row_mask:0xf bank_mask:0xc
    v_smfmac_f32_16x16x64_bf16 v[176:179], a[196:199], v[196:203], v34
    v_mov_b32_dpp v143, v151 row_ror:8 row_mask:0xf bank_mask:0xc
    v_smfmac_f32_16x16x64_bf16 v[176:179], a[232:235], v[204:211], v38
    s_waitcnt vmcnt(6)
    buffer_store_dwordx4 v[140:143], v6, s[12:15], s24 offen offset:128 sc1
    ds_read_b128 v[144:147], v9 offset:10560
    v_smfmac_f32_16x16x64_bf16 v[180:183], a[200:203], v[196:203], v34 abid:1
    ds_read_b128 v[148:151], v9 offset:10624
    ds_read_b128 v[140:143], v9 offset:10496
    v_add_u32 v4, s31, v4
    v_smfmac_f32_16x16x64_bf16 v[180:183], a[236:239], v[204:211], v38 abid:1
    v_add_u32 v1, s31, v1
    v_smfmac_f32_16x16x64_bf16 v[184:187], a[204:207], v[196:203], v35
    v_add_u32 v2, s31, v2
    v_smfmac_f32_16x16x64_bf16 v[184:187], a[240:243], v[204:211], v39
    v_smfmac_f32_16x16x64_bf16 v[188:191], a[208:211], v[196:203], v35 abid:1
    v_smfmac_f32_16x16x64_bf16 v[188:191], a[244:247], v[204:211], v39 abid:1
    v_smfmac_f32_16x16x64_bf16 v[192:195], a[212:215], v[196:203], v50 abid:1
    v_smfmac_f32_16x16x64_bf16 v[192:195], a[248:251], v[204:211], v51
    s_waitcnt vmcnt(8)
    s_branch M_top1
M_bE0:
    v_smfmac_f32_16x16x64_bf16 v[164:167], v[56:59], v[220:227], v40 abid:1
    ds_read_b128 v[204:207], v1 offset:1024
    s_cmp_lt_u32 s22, 74612736
    s_cselect_b32 s30, 1, 0
    v_smfmac_f32_16x16x64_bf16 v[164:167], v[92:95], v[228:235], v44 abid:1
    ds_read_b128 v[208:211], v2 offset:1024
    v_mov_b32 v0, s30
    v_smfmac_f32_16x16x64_bf16 v[168:171], v[60:63], v[220:227], v41
    ds_read_b128 v[212:215], v1 offset:2048
    v_smfmac_f32_16x16x64_bf16 v[168:171], v[96:99], v[228:235], v45
    ds_read_b128 v[216:219], v2 offset:2048
    v_smfmac_f32_16x16x64_bf16 v[172:175], v[64:67], v[220:227], v41 abid:1
    s_waitcnt vmcnt(5)
    s_waitcnt lgkmcnt(6)
    buffer_store_dwordx4 v[244:247], v7, s[12:15], s66 offen sc1
    v_smfmac_f32_16x16x64_bf16 v[172:175], v[100:103], v[228:235], v45 abid:1
    ds_read_b128 v[236:239], v9 offset:9408
    v_smfmac_f32_16x16x64_bf16 v[176:179], v[68:71], v[220:227], v42
    s_waitcnt vmcnt(6)
    buffer_atomic_add v0, v11, s[16:19], s92 offen sc0 sc1
    s_mov_b32 s21, 2
    v_smfmac_f32_16x16x64_bf16 v[176:179], v[104:107], v[228:235], v46
    v_smfmac_f32_16x16x64_bf16 v[180:183], v[72:75], v[220:227], v42 abid:1
    v_cvt_pk_bf16_f32 v160, v160, v161
    v_smfmac_f32_16x16x64_bf16 v[180:183], v[108:111], v[228:235], v46 abid:1
    v_cvt_pk_bf16_f32 v161, v162, v163
    v_smfmac_f32_16x16x64_bf16 v[184:187], v[76:79], v[220:227], v43
    v_cvt_pk_bf16_f32 v162, v164, v165
    v_smfmac_f32_16x16x64_bf16 v[184:187], v[112:115], v[228:235], v47
    v_cvt_pk_bf16_f32 v163, v166, v167
    v_smfmac_f32_16x16x64_bf16 v[188:191], v[80:83], v[220:227], v43 abid:1
    s_add_u32 m0, m0, 896
    v_cvt_pk_bf16_f32 v168, v168, v169
    v_smfmac_f32_16x16x64_bf16 v[188:191], v[116:119], v[228:235], v47 abid:1
    s_waitcnt vmcnt(5)
    buffer_load_dwordx4 v5, s[8:11], s22 offen offset:512 nt lds
    v_cvt_pk_bf16_f32 v169, v170, v171
    v_smfmac_f32_16x16x64_bf16 v[192:195], v[84:87], v[220:227], v51 abid:1
    v_cvt_pk_bf16_f32 v170, v172, v173
    v_smfmac_f32_16x16x64_bf16 v[192:195], v[120:123], v[228:235], v52
    ds_read_b128 v[220:223], v1 offset:3072
    s_waitcnt lgkmcnt(6)
    v_cvt_pk_bf16_f32 v171, v174, v175
    v_smfmac_f32_16x16x64_bf16 v[124:127], a[0:3], v[196:203], v12
    ds_read_b128 v[224:227], v2 offset:3072
    ds_read_b128 v[172:175], v9 offset:10432
    s_waitcnt lgkmcnt(6)
    v_cndmask_b32_dpp v164, v160, v168, vcc row_ror:8 row_mask:0xf bank_mask:0xf
    v_smfmac_f32_16x16x64_bf16 v[124:127], a[36:39], v[204:211], v16
    ds_read_b128 v[228:231], v1 offset:4096
    s_waitcnt lgkmcnt(5)
    v_cndmask_b32_dpp v165, v161, v169, vcc row_ror:8 row_mask:0xf bank_mask:0xf
    v_smfmac_f32_16x16x64_bf16 v[124:127], a[72:75], v[212:219], v20
    ds_read_b128 v[232:235], v2 offset:4096
    v_cndmask_b32_dpp v166, v162, v170, vcc row_ror:8 row_mask:0xf bank_mask:0xf
    v_smfmac_f32_16x16x64_bf16 v[128:131], a[4:7], v[196:203], v12 abid:1
    s_barrier
    v_cndmask_b32_dpp v167, v163, v171, vcc row_ror:8 row_mask:0xf bank_mask:0xf
    v_smfmac_f32_16x16x64_bf16 v[128:131], a[40:43], v[204:211], v16 abid:1
    s_waitcnt vmcnt(6)
    buffer_store_dwordx4 v[164:167], v6, s[12:15], s58 offen offset:0 sc1
    s_waitcnt lgkmcnt(5)
    v_xad_u32 v236, v236, v3, v4
    v_smfmac_f32_16x16x64_bf16 v[128:131], a[76:79], v[212:219], v20 abid:1
    v_xad_u32 v237, v237, v3, v4
    v_smfmac_f32_16x16x64_bf16 v[132:135], a[8:11], v[196:203], v13
    ds_read2st64_b32 v[244:245], v236 offset0:0 offset1:72
    ds_read_b128 v[240:243], v8 offset:3072
    v_xad_u32 v238, v238, v3, v4
    v_smfmac_f32_16x16x64_bf16 v[132:135], a[44:47], v[204:211], v17
    ds_read2st64_b32 v[246:247], v237 offset0:0 offset1:72
    v_xad_u32 v239, v239, v3, v4
    v_smfmac_f32_16x16x64_bf16 v[132:135], a[80:83], v[212:219], v21
    ds_read2st64_b32 v[248:249], v238 offset0:0 offset1:72
    v_mov_b32_dpp v160, v168 row_ror:8 row_mask:0xf bank_mask:0xc
    v_smfmac_f32_16x16x64_bf16 v[144:147], a[20:23], v[196:203], v14 abid:1
    ds_read2st64_b32 v[250:251], v239 offset0:0 offset1:72
    ds_read_b128 v[236:239], v9 offset:9280
    v_mov_b32_dpp v161, v169 row_ror:8 row_mask:0xf bank_mask:0xc
    v_smfmac_f32_16x16x64_bf16 v[144:147], a[56:59], v[204:211], v18 abid:1
    v_mov_b32_dpp v162, v170 row_ror:8 row_mask:0xf bank_mask:0xc
    v_smfmac_f32_16x16x64_bf16 v[144:147], a[92:95], v[212:219], v22 abid:1
    v_mov_b32_dpp v163, v171 row_ror:8 row_mask:0xf bank_mask:0xc
    v_smfmac_f32_16x16x64_bf16 v[140:143], a[16:19], v[196:203], v14
    s_waitcnt vmcnt(5)
    buffer_store_dwordx4 v[160:163], v6, s[12:15], s23 offen offset:0 sc1
    ds_read_b128 v[164:167], v9 offset:10304
    v_smfmac_f32_16x16x64_bf16 v[140:143], a[52:55], v[204:211], v18
    ds_read_b128 v[168:171], v9 offset:10368
    ds_read_b128 v[160:163], v9 offset:10240
    v_smfmac_f32_16x16x64_bf16 v[140:143], a[88:91], v[212:219], v22
    v_smfmac_f32_16x16x64_bf16 v[136:139], a[12:15], v[196:203], v13 abid:1
    v_smfmac_f32_16x16x64_bf16 v[136:139], a[48:51], v[204:211], v17 abid:1
    v_smfmac_f32_16x16x64_bf16 v[136:139], a[84:87], v[212:219], v21 abid:1
    s_waitcnt lgkmcnt(3)
    v_xad_u32 v236, v236, v3, v4
    v_smfmac_f32_16x16x64_bf16 v[136:139], v[240:243], v[244:251], v10
    v_xad_u32 v237, v237, v3, v4
    v_smfmac_f32_16x16x64_bf16 v[172:175], v[240:243], v[244:251], v10 abid:1
    ds_read2st64_b32 v[244:245], v236 offset0:0 offset1:72
    ds_read_b128 v[240:243], v8 offset:1024
    v_xad_u32 v238, v238, v3, v4
    v_smfmac_f32_16x16x64_bf16 v[148:151], a[24:27], v[196:203], v15
    ds_read2st64_b32 v[246:247], v237 offset0:0 offset1:72
    v_xad_u32 v239, v239, v3, v4
    v_smfmac_f32_16x16x64_bf16 v[148:151], a[60:63], v[204:211], v19
    ds_read2st64_b32 v[248:249], v238 offset0:0 offset1:72
    v_cvt_pk_bf16_f32 v192, v192, v193
    v_smfmac_f32_16x16x64_bf16 v[148:151], a[96:99], v[212:219], v23
    ds_read2st64_b32 v[250:251], v239 offset0:0 offset1:72
    ds_read_b128 v[236:239], v9 offset:9344
    v_cvt_pk_bf16_f32 v193, v194, v195
    v_smfmac_f32_16x16x64_bf16 v[152:155], a[28:31], v[196:203], v15 abid:1
    ds_write_b64 v53, v[192:193] offset:0
    ds_read_b128 v[192:195], v9 offset:10752
    v_smfmac_f32_16x16x64_bf16 v[152:155], a[64:67], v[204:211], v19 abid:1
    s_add_u32 m0, m0, 896
    v_smfmac_f32_16x16x64_bf16 v[152:155], a[100:103], v[212:219], v23 abid:1
    s_waitcnt vmcnt(6)
    buffer_load_dwordx4 v5, s[8:11], s22 offen offset:640 nt lds
    v_smfmac_f32_16x16x64_bf16 v[156:159], a[32:35], v[196:203], v48
    v_smfmac_f32_16x16x64_bf16 v[156:159], a[68:71], v[204:211], v48 abid:1
    v_smfmac_f32_16x16x64_bf16 v[156:159], a[104:107], v[212:219], v49
    ds_read_b128 v[196:199], v1 offset:5120
    v_cvt_pk_bf16_f32 v176, v176, v177
    v_smfmac_f32_16x16x64_bf16 v[124:127], a[108:111], v[220:227], v24
    ds_read_b128 v[200:203], v2 offset:5120
    v_cvt_pk_bf16_f32 v177, v178, v179
    v_smfmac_f32_16x16x64_bf16 v[124:127], a[144:147], v[228:235], v28
    ds_read_b128 v[204:207], v1 offset:6144
    ds_read_b64 v[216:217], v9 offset:10056
    v_cvt_pk_bf16_f32 v178, v180, v181
    v_smfmac_f32_16x16x64_bf16 v[128:131], a[112:115], v[220:227], v24 abid:1
    ds_read_b128 v[208:211], v2 offset:6144
    v_cvt_pk_bf16_f32 v179, v182, v183
    v_smfmac_f32_16x16x64_bf16 v[128:131], a[148:151], v[228:235], v28 abid:1
    s_waitcnt lgkmcnt(7)
    v_xad_u32 v236, v236, v3, v4
    v_smfmac_f32_16x16x64_bf16 v[128:131], v[240:243], v[244:251], v10
    s_add_u32 m0, m0, 896
    v_xad_u32 v237, v237, v3, v4
    v_smfmac_f32_16x16x64_bf16 v[164:167], v[240:243], v[244:251], v10 abid:1
    ds_read2st64_b32 v[244:245], v236 offset0:0 offset1:72
    ds_read_b128 v[240:243], v8 offset:2048
    v_xad_u32 v238, v238, v3, v4
    v_smfmac_f32_16x16x64_bf16 v[152:155], a[136:139], v[220:227], v27 abid:1
    ds_read2st64_b32 v[246:247], v237 offset0:0 offset1:72
    s_waitcnt vmcnt(5)
    v_xad_u32 v239, v239, v3, v4
    v_smfmac_f32_16x16x64_bf16 v[152:155], a[172:175], v[228:235], v31 abid:1
    ds_read2st64_b32 v[248:249], v238 offset0:0 offset1:72
    buffer_load_dwordx4 v5, s[8:11], s22 offen offset:768 nt lds
    v_cvt_pk_bf16_f32 v184, v184, v185
    v_smfmac_f32_16x16x64_bf16 v[136:139], a[120:123], v[220:227], v25 abid:1
    ds_read2st64_b32 v[250:251], v239 offset0:0 offset1:72
    ds_read_b128 v[236:239], v9 offset:9216
    v_cvt_pk_bf16_f32 v185, v186, v187
    v_smfmac_f32_16x16x64_bf16 v[136:139], a[156:159], v[228:235], v29 abid:1
    v_cvt_pk_bf16_f32 v186, v188, v189
    v_smfmac_f32_16x16x64_bf16 v[140:143], a[124:127], v[220:227], v26
    v_cvt_pk_bf16_f32 v187, v190, v191
    v_smfmac_f32_16x16x64_bf16 v[140:143], a[160:163], v[228:235], v30
    ds_read_b128 v[188:191], v9 offset:10688
    v_cndmask_b32_dpp v180, v176, v184, vcc row_ror:8 row_mask:0xf bank_mask:0xf
    v_smfmac_f32_16x16x64_bf16 v[144:147], a[128:131], v[220:227], v26 abid:1
    v_cndmask_b32_dpp v181, v177, v185, vcc row_ror:8 row_mask:0xf bank_mask:0xf
    v_smfmac_f32_16x16x64_bf16 v[144:147], a[164:167], v[228:235], v30 abid:1
    v_cndmask_b32_dpp v182, v178, v186, vcc row_ror:8 row_mask:0xf bank_mask:0xf
    v_smfmac_f32_16x16x64_bf16 v[148:151], a[132:135], v[220:227], v27
    v_cndmask_b32_dpp v183, v179, v187, vcc row_ror:8 row_mask:0xf bank_mask:0xf
    v_smfmac_f32_16x16x64_bf16 v[148:151], a[168:171], v[228:235], v31
    s_waitcnt vmcnt(6)
    buffer_store_dwordx4 v[180:183], v6, s[12:15], s58 offen offset:128 sc1
    s_waitcnt lgkmcnt(8)
    v_xad_u32 v212, v216, v3, v4
    v_smfmac_f32_16x16x64_bf16 v[132:135], a[116:119], v[220:227], v25
    ds_read2st64_b32 v[212:213], v212 offset0:0 offset1:72
    v_xad_u32 v214, v217, v3, v4
    v_smfmac_f32_16x16x64_bf16 v[132:135], a[152:155], v[228:235], v29
    ds_read2st64_b32 v[214:215], v214 offset0:0 offset1:72
    s_waitcnt lgkmcnt(3)
    v_xad_u32 v236, v236, v3, v4
    v_smfmac_f32_16x16x64_bf16 v[132:135], v[240:243], v[244:251], v10
    v_xad_u32 v237, v237, v3, v4
    v_smfmac_f32_16x16x64_bf16 v[168:171], v[240:243], v[244:251], v10 abid:1
    ds_read2st64_b32 v[244:245], v236 offset0:0 offset1:72
    ds_read_b128 v[240:243], v8 offset:0
    v_xad_u32 v238, v238, v3, v4
    v_smfmac_f32_16x16x64_bf16 v[156:159], a[140:143], v[220:227], v49 abid:1
    ds_read2st64_b32 v[246:247], v237 offset0:0 offset1:72
    v_xad_u32 v239, v239, v3, v4
    v_smfmac_f32_16x16x64_bf16 v[156:159], a[176:179], v[228:235], v50
    ds_read2st64_b32 v[248:249], v238 offset0:0 offset1:72
    v_mov_b32_dpp v176, v184 row_ror:8 row_mask:0xf bank_mask:0xc
    v_smfmac_f32_16x16x64_bf16 v[140:143], a[196:199], v[196:203], v34
    ds_read2st64_b32 v[250:251], v239 offset0:0 offset1:72
    ds_read_b128 v[236:239], v9 offset:9728
    v_mov_b32_dpp v177, v185 row_ror:8 row_mask:0xf bank_mask:0xc
    v_smfmac_f32_16x16x64_bf16 v[140:143], a[232:235], v[204:211], v38
    v_mov_b32_dpp v178, v186 row_ror:8 row_mask:0xf bank_mask:0xc
    v_smfmac_f32_16x16x64_bf16 v[128:131], a[184:187], v[196:203], v32 abid:1
    v_mov_b32_dpp v179, v187 row_ror:8 row_mask:0xf bank_mask:0xc
    v_smfmac_f32_16x16x64_bf16 v[128:131], a[220:223], v[204:211], v36 abid:1
    s_waitcnt vmcnt(5)
    buffer_store_dwordx4 v[176:179], v6, s[12:15], s23 offen offset:128 sc1
    ds_read_b128 v[180:183], v9 offset:10560
    v_smfmac_f32_16x16x64_bf16 v[132:135], a[188:191], v[196:203], v33
    ds_read_b128 v[184:187], v9 offset:10624
    ds_read_b128 v[176:179], v9 offset:10496
    v_smfmac_f32_16x16x64_bf16 v[132:135], a[224:227], v[204:211], v37
    v_smfmac_f32_16x16x64_bf16 v[136:139], a[192:195], v[196:203], v33 abid:1
    ds_read_b128 v[220:223], v1 offset:7168
    v_smfmac_f32_16x16x64_bf16 v[136:139], a[228:231], v[204:211], v37 abid:1
    ds_read_b128 v[224:227], v2 offset:7168
    v_smfmac_f32_16x16x64_bf16 v[124:127], a[180:183], v[196:203], v32
    ds_read_b128 v[228:231], v1 offset:8192
    v_smfmac_f32_16x16x64_bf16 v[124:127], a[216:219], v[204:211], v36
    s_waitcnt vmcnt(7)
    s_waitcnt lgkmcnt(6)
    v_xad_u32 v236, v236, v3, v4
    v_smfmac_f32_16x16x64_bf16 v[124:127], v[240:243], v[244:251], v10
    ds_read_b128 v[232:235], v2 offset:8192
    v_xad_u32 v237, v237, v3, v4
    v_smfmac_f32_16x16x64_bf16 v[160:163], v[240:243], v[244:251], v10 abid:1
    ds_read2st64_b32 v[244:245], v236 offset0:0 offset1:72
    ds_read_b128 v[240:243], v8 offset:8192
    v_xad_u32 v238, v238, v3, v4
    v_smfmac_f32_16x16x64_bf16 v[144:147], a[200:203], v[196:203], v34 abid:1
    ds_read2st64_b32 v[246:247], v237 offset0:0 offset1:72
    v_xad_u32 v239, v239, v3, v4
    v_smfmac_f32_16x16x64_bf16 v[144:147], a[236:239], v[204:211], v38 abid:1
    ds_read2st64_b32 v[248:249], v238 offset0:0 offset1:72
    v_mul_u32_u24 v0, s94, v0
    v_smfmac_f32_16x16x64_bf16 v[148:151], a[204:207], v[196:203], v35
    ds_read2st64_b32 v[250:251], v239 offset0:0 offset1:72
    ds_read_b128 v[236:239], v9 offset:9664
    v_add_u32 v0, s93, v0
    v_smfmac_f32_16x16x64_bf16 v[148:151], a[240:243], v[204:211], v39
    s_waitcnt lgkmcnt(10)
    s_cmp_lt_i32 s81, 0
    s_cbranch_scc1 M_ovrE0
    s_swappc_b64 s[78:79], s[72:73]
M_ovrE0:
    v_smfmac_f32_16x16x64_bf16 v[152:155], a[208:211], v[196:203], v35 abid:1
    ds_write_b32 v11, v0
    v_mov_b32 v0, 162048
    v_smfmac_f32_16x16x64_bf16 v[152:155], a[244:247], v[204:211], v39 abid:1
    s_add_u32 m0, m0, 896
    v_smfmac_f32_16x16x64_bf16 v[156:159], a[212:215], v[196:203], v50 abid:1
    s_waitcnt vmcnt(6)
    buffer_load_dwordx4 v5, s[8:11], s22 offen offset:896 nt lds
    v_smfmac_f32_16x16x64_bf16 v[156:159], a[248:251], v[204:211], v51
    s_waitcnt lgkmcnt(9)
    v_smfmac_f32_16x16x64_bf16 v[124:127], a[252:255], v[220:227], v40
    ds_read_b128 v[196:199], v1 offset:18432
    s_waitcnt lgkmcnt(8)
    v_smfmac_f32_16x16x64_bf16 v[124:127], v[88:91], v[228:235], v44
    ds_read_b128 v[200:203], v2 offset:18432
    v_smfmac_f32_16x16x64_bf16 v[156:159], v[84:87], v[220:227], v51 abid:1
    ds_read_b128 v[204:207], v1 offset:19456
    v_smfmac_f32_16x16x64_bf16 v[156:159], v[120:123], v[228:235], v52
    s_waitcnt lgkmcnt(3)
    s_barrier
    v_xad_u32 v236, v236, v3, v4
    v_smfmac_f32_16x16x64_bf16 v[156:159], v[240:243], v[244:251], v10
    ds_read_b128 v[208:211], v2 offset:19456
    ds_read_b32 v0, v0
    v_xad_u32 v237, v237, v3, v4
    v_smfmac_f32_16x16x64_bf16 v[192:195], v[240:243], v[244:251], v10 abid:1
    ds_read2st64_b32 v[244:245], v236 offset0:0 offset1:72
    ds_read_b128 v[240:243], v8 offset:7168
    v_xad_u32 v238, v238, v3, v4
    v_smfmac_f32_16x16x64_bf16 v[132:135], v[60:63], v[220:227], v41
    ds_read2st64_b32 v[246:247], v237 offset0:0 offset1:72
    v_xad_u32 v239, v239, v3, v4
    v_smfmac_f32_16x16x64_bf16 v[132:135], v[96:99], v[228:235], v45
    ds_read2st64_b32 v[248:249], v238 offset0:0 offset1:72
    s_add_u32 m0, m0, 896
    v_smfmac_f32_16x16x64_bf16 v[136:139], v[64:67], v[220:227], v41 abid:1
    ds_read2st64_b32 v[250:251], v239 offset0:0 offset1:72
    ds_read_b128 v[236:239], v9 offset:9536
    s_waitcnt vmcnt(5)
    v_smfmac_f32_16x16x64_bf16 v[136:139], v[100:103], v[228:235], v45 abid:1
    buffer_load_dwordx4 v5, s[8:11], s22 offen offset:1024 nt lds
    s_waitcnt lgkmcnt(6)
    v_readfirstlane_b32 s88, v0
    v_smfmac_f32_16x16x64_bf16 v[140:143], v[68:71], v[220:227], v42
    s_add_u32 s30, s88, 74612736
    s_lshr_b32 s30, s30, 1
    s_min_u32 s88, s88, s30
    v_smfmac_f32_16x16x64_bf16 v[140:143], v[104:107], v[228:235], v46
    s_min_u32 s88, s88, s14
    v_smfmac_f32_16x16x64_bf16 v[144:147], v[72:75], v[220:227], v42 abid:1
    ds_read_b128 v[212:215], v1 offset:20480
    s_cmp_lt_u32 s22, 74612736
    s_cselect_b32 s88, s88, s14
    v_smfmac_f32_16x16x64_bf16 v[144:147], v[108:111], v[228:235], v46 abid:1
    ds_read_b128 v[216:219], v2 offset:20480
    s_cmp_lt_u32 s88, s99
    s_cselect_b32 s10, 75497472, 0
    v_smfmac_f32_16x16x64_bf16 v[148:151], v[76:79], v[220:227], v43
    v_smfmac_f32_16x16x64_bf16 v[148:151], v[112:115], v[228:235], v47
    v_smfmac_f32_16x16x64_bf16 v[152:155], v[80:83], v[220:227], v43 abid:1
    v_smfmac_f32_16x16x64_bf16 v[152:155], v[116:119], v[228:235], v47 abid:1
    s_waitcnt lgkmcnt(2)
    v_xad_u32 v236, v236, v3, v4
    v_smfmac_f32_16x16x64_bf16 v[152:155], v[240:243], v[244:251], v10
    v_xad_u32 v237, v237, v3, v4
    v_smfmac_f32_16x16x64_bf16 v[188:191], v[240:243], v[244:251], v10 abid:1
    s_cmp_gt_u32 s46, s80
    s_cbranch_scc1 M_slow
M_slowrE0:
    v_xad_u32 v238, v238, v3, v4
    v_smfmac_f32_16x16x64_bf16 v[128:131], v[56:59], v[220:227], v40 abid:1
    ds_read2st64_b32 v[244:245], v236 offset0:0 offset1:72
    ds_read_b128 v[240:243], v8 offset:5120
    v_xad_u32 v239, v239, v3, v4
    v_smfmac_f32_16x16x64_bf16 v[128:131], v[92:95], v[228:235], v44 abid:1
    ds_read2st64_b32 v[246:247], v237 offset0:0 offset1:72
    v_smfmac_f32_16x16x64_bf16 v[160:163], a[0:3], v[196:203], v12
    ds_read2st64_b32 v[248:249], v238 offset0:0 offset1:72
    v_smfmac_f32_16x16x64_bf16 v[160:163], a[36:39], v[204:211], v16
    ds_read2st64_b32 v[250:251], v239 offset0:0 offset1:72
    ds_read_b128 v[236:239], v9 offset:9600
    s_waitcnt lgkmcnt(6)
    v_smfmac_f32_16x16x64_bf16 v[160:163], a[72:75], v[212:219], v20
    v_smfmac_f32_16x16x64_bf16 v[164:167], a[4:7], v[196:203], v12 abid:1
    s_mov_b32 m0, s28
    v_cvt_pk_bf16_f32 v156, v156, v157
    v_smfmac_f32_16x16x64_bf16 v[164:167], a[40:43], v[204:211], v16 abid:1
    s_waitcnt vmcnt(6)
    buffer_load_dwordx4 v5, s[8:11], s88 offen offset:0 nt lds
    v_cvt_pk_bf16_f32 v157, v158, v159
    v_smfmac_f32_16x16x64_bf16 v[164:167], a[76:79], v[212:219], v20 abid:1
    ds_write_b64 v53, v[156:157] offset:25728
    ds_read_b128 v[156:159], v9 offset:10752
    v_smfmac_f32_16x16x64_bf16 v[180:183], a[20:23], v[196:203], v14 abid:1
    v_smfmac_f32_16x16x64_bf16 v[180:183], a[56:59], v[204:211], v18 abid:1
    ds_read_b128 v[220:223], v1 offset:21504
    v_cvt_pk_bf16_f32 v124, v124, v125
    v_smfmac_f32_16x16x64_bf16 v[180:183], a[92:95], v[212:219], v22 abid:1
    s_waitcnt lgkmcnt(3)
    v_xad_u32 v236, v236, v3, v4
    v_smfmac_f32_16x16x64_bf16 v[180:183], v[240:243], v[244:251], v10 abid:1
    v_xad_u32 v237, v237, v3, v4
    v_smfmac_f32_16x16x64_bf16 v[144:147], v[240:243], v[244:251], v10
    ds_read2st64_b32 v[244:245], v236 offset0:0 offset1:72
    ds_read_b128 v[240:243], v8 offset:6144
    v_xad_u32 v238, v238, v3, v4
    v_smfmac_f32_16x16x64_bf16 v[172:175], a[12:15], v[196:203], v13 abid:1
    ds_read2st64_b32 v[246:247], v237 offset0:0 offset1:72
    v_xad_u32 v239, v239, v3, v4
    v_smfmac_f32_16x16x64_bf16 v[172:175], a[48:51], v[204:211], v17 abid:1
    ds_read2st64_b32 v[248:249], v238 offset0:0 offset1:72
    v_cvt_pk_bf16_f32 v125, v126, v127
    v_smfmac_f32_16x16x64_bf16 v[172:175], a[84:87], v[212:219], v21 abid:1
    ds_read2st64_b32 v[250:251], v239 offset0:0 offset1:72
    ds_read_b128 v[236:239], v9 offset:9472
    v_cvt_pk_bf16_f32 v126, v128, v129
    v_smfmac_f32_16x16x64_bf16 v[176:179], a[16:19], v[196:203], v14
    v_cvt_pk_bf16_f32 v127, v130, v131
    v_smfmac_f32_16x16x64_bf16 v[176:179], a[52:55], v[204:211], v18
    v_cvt_pk_bf16_f32 v132, v132, v133
    v_smfmac_f32_16x16x64_bf16 v[176:179], a[88:91], v[212:219], v22
    v_cvt_pk_bf16_f32 v133, v134, v135
    v_smfmac_f32_16x16x64_bf16 v[168:171], a[8:11], v[196:203], v13
    s_add_u32 m0, m0, 896
    v_cvt_pk_bf16_f32 v134, v136, v137
    v_smfmac_f32_16x16x64_bf16 v[168:171], a[44:47], v[204:211], v17
    s_waitcnt vmcnt(5)
    buffer_load_dwordx4 v5, s[8:11], s88 offen offset:128 nt lds
    v_cvt_pk_bf16_f32 v135, v138, v139
    v_smfmac_f32_16x16x64_bf16 v[168:171], a[80:83], v[212:219], v21
    ds_read_b128 v[224:227], v2 offset:21504
    ds_read_b128 v[136:139], v9 offset:10432
    v_cndmask_b32_dpp v128, v124, v132, vcc row_ror:8 row_mask:0xf bank_mask:0xf
    v_smfmac_f32_16x16x64_bf16 v[184:187], a[24:27], v[196:203], v15
    ds_read_b128 v[228:231], v1 offset:22528
    v_cndmask_b32_dpp v129, v125, v133, vcc row_ror:8 row_mask:0xf bank_mask:0xf
    v_smfmac_f32_16x16x64_bf16 v[184:187], a[60:63], v[204:211], v19
    ds_read_b128 v[232:235], v2 offset:22528
    v_cndmask_b32_dpp v130, v126, v134, vcc row_ror:8 row_mask:0xf bank_mask:0xf
    v_smfmac_f32_16x16x64_bf16 v[184:187], a[96:99], v[212:219], v23
    s_waitcnt lgkmcnt(4)
    v_xad_u32 v236, v236, v3, v4
    v_smfmac_f32_16x16x64_bf16 v[184:187], v[240:243], v[244:251], v10 abid:1
    v_xad_u32 v237, v237, v3, v4
    v_smfmac_f32_16x16x64_bf16 v[148:151], v[240:243], v[244:251], v10
    ds_read2st64_b32 v[244:245], v236 offset0:0 offset1:72
    ds_read_b128 v[240:243], v8 offset:4096
    v_xad_u32 v238, v238, v3, v4
    v_smfmac_f32_16x16x64_bf16 v[188:191], a[28:31], v[196:203], v15 abid:1
    ds_read2st64_b32 v[246:247], v237 offset0:0 offset1:72
    v_xad_u32 v239, v239, v3, v4
    v_smfmac_f32_16x16x64_bf16 v[188:191], a[64:67], v[204:211], v19 abid:1
    ds_read2st64_b32 v[248:249], v238 offset0:0 offset1:72
    v_cndmask_b32_dpp v131, v127, v135, vcc row_ror:8 row_mask:0xf bank_mask:0xf
    v_smfmac_f32_16x16x64_bf16 v[188:191], a[100:103], v[212:219], v23 abid:1
    ds_read2st64_b32 v[250:251], v239 offset0:0 offset1:72
    s_waitcnt vmcnt(6)
    buffer_store_dwordx4 v[128:131], v6, s[12:15], s59 offen offset:0 sc1
    v_smfmac_f32_16x16x64_bf16 v[192:195], a[32:35], v[196:203], v48
    v_mov_b32_dpp v124, v132 row_ror:8 row_mask:0xf bank_mask:0xc
    v_smfmac_f32_16x16x64_bf16 v[192:195], a[68:71], v[204:211], v48 abid:1
    v_mov_b32_dpp v125, v133 row_ror:8 row_mask:0xf bank_mask:0xc
    v_smfmac_f32_16x16x64_bf16 v[192:195], a[104:107], v[212:219], v49
    s_waitcnt lgkmcnt(8)
    v_mov_b32_dpp v126, v134 row_ror:8 row_mask:0xf bank_mask:0xc
    v_smfmac_f32_16x16x64_bf16 v[160:163], a[108:111], v[220:227], v24
    s_waitcnt lgkmcnt(5)
    v_mov_b32_dpp v127, v135 row_ror:8 row_mask:0xf bank_mask:0xc
    v_smfmac_f32_16x16x64_bf16 v[160:163], a[144:147], v[228:235], v28
    ds_read_b128 v[196:199], v1 offset:23552
    s_waitcnt vmcnt(5)
    buffer_store_dwordx4 v[124:127], v6, s[12:15], s24 offen offset:0 sc1
    v_smfmac_f32_16x16x64_bf16 v[164:167], a[112:115], v[220:227], v24 abid:1
    ds_read_b128 v[200:203], v2 offset:23552
    ds_read_b128 v[128:131], v9 offset:10304
    ds_read_b128 v[132:135], v9 offset:10368
    v_smfmac_f32_16x16x64_bf16 v[164:167], a[148:151], v[228:235], v28 abid:1
    ds_read_b128 v[204:207], v1 offset:24576
    ds_read_b128 v[124:127], v9 offset:10240
    v_smfmac_f32_16x16x64_bf16 v[176:179], a[124:127], v[220:227], v26
    ds_read_b128 v[208:211], v2 offset:24576
    v_smfmac_f32_16x16x64_bf16 v[176:179], a[160:163], v[228:235], v30
    s_waitcnt lgkmcnt(7)
    v_smfmac_f32_16x16x64_bf16 v[176:179], v[240:243], v[244:251], v10 abid:1
    v_smfmac_f32_16x16x64_bf16 v[140:143], v[240:243], v[244:251], v10
    v_smfmac_f32_16x16x64_bf16 v[172:175], a[120:123], v[220:227], v25 abid:1
    s_add_u32 s28, s28, 36864
    s_cmp_ge_u32 s28, 110592
    s_cselect_b32 s28, s26, s28
    v_smfmac_f32_16x16x64_bf16 v[172:175], a[156:159], v[228:235], v29 abid:1
    s_add_u32 s30, s25, 36864
    s_cmp_eq_u32 s30, 110592
    s_cselect_b32 s30, 0, s30
    v_smfmac_f32_16x16x64_bf16 v[168:171], a[116:119], v[220:227], v25
    s_sub_u32 s31, s30, s25
    s_mov_b32 s25, s30
    s_mov_b32 s90, s22
    v_smfmac_f32_16x16x64_bf16 v[168:171], a[152:155], v[228:235], v29
    s_mov_b32 s22, s88
    s_add_u32 s91, s91, 1
    s_cmp_lt_u32 s20, 2
    v_smfmac_f32_16x16x64_bf16 v[180:183], a[128:131], v[220:227], v26 abid:1
    s_cselect_b32 s66, s23, s24
    s_add_u32 s66, s66, s95
    v_smfmac_f32_16x16x64_bf16 v[180:183], a[164:167], v[228:235], v30 abid:1
    v_cvt_pk_bf16_f32 v140, v140, v141
    v_smfmac_f32_16x16x64_bf16 v[184:187], a[132:135], v[220:227], v27
    s_add_u32 m0, m0, 896
    v_cvt_pk_bf16_f32 v141, v142, v143
    v_smfmac_f32_16x16x64_bf16 v[184:187], a[168:171], v[228:235], v31
    s_waitcnt vmcnt(6)
    buffer_load_dwordx4 v5, s[8:11], s88 offen offset:256 nt lds
    v_cvt_pk_bf16_f32 v142, v144, v145
    v_smfmac_f32_16x16x64_bf16 v[188:191], a[136:139], v[220:227], v27 abid:1
    v_cvt_pk_bf16_f32 v143, v146, v147
    v_smfmac_f32_16x16x64_bf16 v[188:191], a[172:175], v[228:235], v31 abid:1
    v_cvt_pk_bf16_f32 v148, v148, v149
    v_smfmac_f32_16x16x64_bf16 v[192:195], a[140:143], v[220:227], v49 abid:1
    v_cvt_pk_bf16_f32 v149, v150, v151
    v_smfmac_f32_16x16x64_bf16 v[192:195], a[176:179], v[228:235], v50
    ds_read_b128 v[220:223], v1 offset:25600
    s_waitcnt lgkmcnt(6)
    v_cvt_pk_bf16_f32 v150, v152, v153
    v_smfmac_f32_16x16x64_bf16 v[160:163], a[180:183], v[196:203], v32
    ds_read_b128 v[224:227], v2 offset:25600
    s_waitcnt lgkmcnt(2)
    v_cvt_pk_bf16_f32 v151, v154, v155
    v_smfmac_f32_16x16x64_bf16 v[160:163], a[216:219], v[204:211], v36
    ds_read_b128 v[228:231], v1 offset:26624
    ds_read_b128 v[152:155], v9 offset:10688
    v_cndmask_b32_dpp v144, v140, v148, vcc row_ror:8 row_mask:0xf bank_mask:0xf
    v_smfmac_f32_16x16x64_bf16 v[164:167], a[184:187], v[196:203], v32 abid:1
    ds_read_b128 v[232:235], v2 offset:26624
    v_cndmask_b32_dpp v145, v141, v149, vcc row_ror:8 row_mask:0xf bank_mask:0xf
    v_smfmac_f32_16x16x64_bf16 v[164:167], a[220:223], v[204:211], v36 abid:1
    s_add_u32 m0, m0, 896
    v_cndmask_b32_dpp v146, v142, v150, vcc row_ror:8 row_mask:0xf bank_mask:0xf
    v_smfmac_f32_16x16x64_bf16 v[168:171], a[188:191], v[196:203], v33
    s_waitcnt vmcnt(5)
    buffer_load_dwordx4 v5, s[8:11], s88 offen offset:384 nt lds
    v_cndmask_b32_dpp v147, v143, v151, vcc row_ror:8 row_mask:0xf bank_mask:0xf
    v_smfmac_f32_16x16x64_bf16 v[168:171], a[224:227], v[204:211], v37
    s_waitcnt vmcnt(6)
    buffer_store_dwordx4 v[144:147], v6, s[12:15], s59 offen offset:128 sc1
    v_mov_b32_dpp v140, v148 row_ror:8 row_mask:0xf bank_mask:0xc
    v_smfmac_f32_16x16x64_bf16 v[172:175], a[192:195], v[196:203], v33 abid:1
    v_mov_b32_dpp v141, v149 row_ror:8 row_mask:0xf bank_mask:0xc
    v_smfmac_f32_16x16x64_bf16 v[172:175], a[228:231], v[204:211], v37 abid:1
    v_mov_b32_dpp v142, v150 row_ror:8 row_mask:0xf bank_mask:0xc
    v_smfmac_f32_16x16x64_bf16 v[176:179], a[196:199], v[196:203], v34
    v_mov_b32_dpp v143, v151 row_ror:8 row_mask:0xf bank_mask:0xc
    v_smfmac_f32_16x16x64_bf16 v[176:179], a[232:235], v[204:211], v38
    s_waitcnt vmcnt(5)
    buffer_store_dwordx4 v[140:143], v6, s[12:15], s24 offen offset:128 sc1
    ds_read_b128 v[144:147], v9 offset:10560
    v_smfmac_f32_16x16x64_bf16 v[180:183], a[200:203], v[196:203], v34 abid:1
    ds_read_b128 v[148:151], v9 offset:10624
    ds_read_b128 v[140:143], v9 offset:10496
    v_add_u32 v4, s31, v4
    v_smfmac_f32_16x16x64_bf16 v[180:183], a[236:239], v[204:211], v38 abid:1
    v_add_u32 v1, s31, v1
    v_smfmac_f32_16x16x64_bf16 v[184:187], a[204:207], v[196:203], v35
    v_add_u32 v2, s31, v2
    v_smfmac_f32_16x16x64_bf16 v[184:187], a[240:243], v[204:211], v39
    v_smfmac_f32_16x16x64_bf16 v[188:191], a[208:211], v[196:203], v35 abid:1
    v_smfmac_f32_16x16x64_bf16 v[188:191], a[244:247], v[204:211], v39 abid:1
    v_smfmac_f32_16x16x64_bf16 v[192:195], a[212:215], v[196:203], v50 abid:1
    v_smfmac_f32_16x16x64_bf16 v[192:195], a[248:251], v[204:211], v51
    s_waitcnt vmcnt(8)
    s_branch M_top1
M_q:
    s_mov_b32 s21, 3
    v_smfmac_f32_16x16x64_bf16 v[148:151], v[112:115], v[228:235], v47
    v_smfmac_f32_16x16x64_bf16 v[152:155], v[80:83], v[220:227], v43 abid:1
    v_smfmac_f32_16x16x64_bf16 v[152:155], v[116:119], v[228:235], v47 abid:1
    s_waitcnt lgkmcnt(2)
    v_xad_u32 v236, v236, v3, v4
    v_smfmac_f32_16x16x64_bf16 v[152:155], v[240:243], v[244:251], v10
    v_xad_u32 v237, v237, v3, v4
    v_smfmac_f32_16x16x64_bf16 v[188:191], v[240:243], v[244:251], v10 abid:1
    s_cmp_gt_u32 s46, s80
    s_cbranch_scc1 M_slow
M_slowrQ:
    v_xad_u32 v238, v238, v3, v4
    v_smfmac_f32_16x16x64_bf16 v[128:131], v[56:59], v[220:227], v40 abid:1
    ds_read2st64_b32 v[244:245], v236 offset0:0 offset1:72
    ds_read_b128 v[240:243], v8 offset:5120
    v_xad_u32 v239, v239, v3, v4
    v_smfmac_f32_16x16x64_bf16 v[128:131], v[92:95], v[228:235], v44 abid:1
    ds_read2st64_b32 v[246:247], v237 offset0:0 offset1:72
    v_smfmac_f32_16x16x64_bf16 v[160:163], a[0:3], v[196:203], v12
    ds_read2st64_b32 v[248:249], v238 offset0:0 offset1:72
    v_smfmac_f32_16x16x64_bf16 v[160:163], a[36:39], v[204:211], v16
    ds_read2st64_b32 v[250:251], v239 offset0:0 offset1:72
    ds_read_b128 v[236:239], v9 offset:9600
    s_waitcnt lgkmcnt(6)
    v_smfmac_f32_16x16x64_bf16 v[160:163], a[72:75], v[212:219], v20
    v_smfmac_f32_16x16x64_bf16 v[164:167], a[4:7], v[196:203], v12 abid:1
    v_cvt_pk_bf16_f32 v156, v156, v157
    v_smfmac_f32_16x16x64_bf16 v[164:167], a[40:43], v[204:211], v16 abid:1
    v_cvt_pk_bf16_f32 v157, v158, v159
    v_smfmac_f32_16x16x64_bf16 v[164:167], a[76:79], v[212:219], v20 abid:1
    ds_write_b64 v53, v[156:157] offset:25728
    ds_read_b128 v[156:159], v9 offset:10752
    v_smfmac_f32_16x16x64_bf16 v[180:183], a[20:23], v[196:203], v14 abid:1
    v_smfmac_f32_16x16x64_bf16 v[180:183], a[56:59], v[204:211], v18 abid:1
    ds_read_b128 v[220:223], v1 offset:21504
    v_cvt_pk_bf16_f32 v124, v124, v125
    v_smfmac_f32_16x16x64_bf16 v[180:183], a[92:95], v[212:219], v22 abid:1
    s_waitcnt lgkmcnt(3)
    v_xad_u32 v236, v236, v3, v4
    v_smfmac_f32_16x16x64_bf16 v[180:183], v[240:243], v[244:251], v10 abid:1
    v_xad_u32 v237, v237, v3, v4
    v_smfmac_f32_16x16x64_bf16 v[144:147], v[240:243], v[244:251], v10
    ds_read2st64_b32 v[244:245], v236 offset0:0 offset1:72
    ds_read_b128 v[240:243], v8 offset:6144
    v_xad_u32 v238, v238, v3, v4
    v_smfmac_f32_16x16x64_bf16 v[172:175], a[12:15], v[196:203], v13 abid:1
    ds_read2st64_b32 v[246:247], v237 offset0:0 offset1:72
    v_xad_u32 v239, v239, v3, v4
    v_smfmac_f32_16x16x64_bf16 v[172:175], a[48:51], v[204:211], v17 abid:1
    ds_read2st64_b32 v[248:249], v238 offset0:0 offset1:72
    v_cvt_pk_bf16_f32 v125, v126, v127
    v_smfmac_f32_16x16x64_bf16 v[172:175], a[84:87], v[212:219], v21 abid:1
    ds_read2st64_b32 v[250:251], v239 offset0:0 offset1:72
    ds_read_b128 v[236:239], v9 offset:9472
    v_cvt_pk_bf16_f32 v126, v128, v129
    v_smfmac_f32_16x16x64_bf16 v[176:179], a[16:19], v[196:203], v14
    v_cvt_pk_bf16_f32 v127, v130, v131
    v_smfmac_f32_16x16x64_bf16 v[176:179], a[52:55], v[204:211], v18
    v_cvt_pk_bf16_f32 v132, v132, v133
    v_smfmac_f32_16x16x64_bf16 v[176:179], a[88:91], v[212:219], v22
    v_cvt_pk_bf16_f32 v133, v134, v135
    v_smfmac_f32_16x16x64_bf16 v[168:171], a[8:11], v[196:203], v13
    v_cvt_pk_bf16_f32 v134, v136, v137
    v_smfmac_f32_16x16x64_bf16 v[168:171], a[44:47], v[204:211], v17
    v_cvt_pk_bf16_f32 v135, v138, v139
    v_smfmac_f32_16x16x64_bf16 v[168:171], a[80:83], v[212:219], v21
    ds_read_b128 v[224:227], v2 offset:21504
    ds_read_b128 v[136:139], v9 offset:10432
    v_cndmask_b32_dpp v128, v124, v132, vcc row_ror:8 row_mask:0xf bank_mask:0xf
    v_smfmac_f32_16x16x64_bf16 v[184:187], a[24:27], v[196:203], v15
    ds_read_b128 v[228:231], v1 offset:22528
    v_cndmask_b32_dpp v129, v125, v133, vcc row_ror:8 row_mask:0xf bank_mask:0xf
    v_smfmac_f32_16x16x64_bf16 v[184:187], a[60:63], v[204:211], v19
    ds_read_b128 v[232:235], v2 offset:22528
    v_cndmask_b32_dpp v130, v126, v134, vcc row_ror:8 row_mask:0xf bank_mask:0xf
    v_smfmac_f32_16x16x64_bf16 v[184:187], a[96:99], v[212:219], v23
    s_waitcnt lgkmcnt(4)
    v_xad_u32 v236, v236, v3, v4
    v_smfmac_f32_16x16x64_bf16 v[184:187], v[240:243], v[244:251], v10 abid:1
    v_xad_u32 v237, v237, v3, v4
    v_smfmac_f32_16x16x64_bf16 v[148:151], v[240:243], v[244:251], v10
    ds_read2st64_b32 v[244:245], v236 offset0:0 offset1:72
    ds_read_b128 v[240:243], v8 offset:4096
    v_xad_u32 v238, v238, v3, v4
    v_smfmac_f32_16x16x64_bf16 v[188:191], a[28:31], v[196:203], v15 abid:1
    ds_read2st64_b32 v[246:247], v237 offset0:0 offset1:72
    v_xad_u32 v239, v239, v3, v4
    v_smfmac_f32_16x16x64_bf16 v[188:191], a[64:67], v[204:211], v19 abid:1
    ds_read2st64_b32 v[248:249], v238 offset0:0 offset1:72
    v_cndmask_b32_dpp v131, v127, v135, vcc row_ror:8 row_mask:0xf bank_mask:0xf
    v_smfmac_f32_16x16x64_bf16 v[188:191], a[100:103], v[212:219], v23 abid:1
    ds_read2st64_b32 v[250:251], v239 offset0:0 offset1:72
    buffer_store_dwordx4 v[128:131], v6, s[12:15], s59 offen offset:0 sc1
    v_smfmac_f32_16x16x64_bf16 v[192:195], a[32:35], v[196:203], v48
    v_mov_b32_dpp v124, v132 row_ror:8 row_mask:0xf bank_mask:0xc
    v_smfmac_f32_16x16x64_bf16 v[192:195], a[68:71], v[204:211], v48 abid:1
    v_mov_b32_dpp v125, v133 row_ror:8 row_mask:0xf bank_mask:0xc
    v_smfmac_f32_16x16x64_bf16 v[192:195], a[104:107], v[212:219], v49
    s_waitcnt lgkmcnt(8)
    v_mov_b32_dpp v126, v134 row_ror:8 row_mask:0xf bank_mask:0xc
    v_smfmac_f32_16x16x64_bf16 v[160:163], a[108:111], v[220:227], v24
    s_waitcnt lgkmcnt(5)
    v_mov_b32_dpp v127, v135 row_ror:8 row_mask:0xf bank_mask:0xc
    v_smfmac_f32_16x16x64_bf16 v[160:163], a[144:147], v[228:235], v28
    ds_read_b128 v[196:199], v1 offset:23552
    buffer_store_dwordx4 v[124:127], v6, s[12:15], s24 offen offset:0 sc1
    v_smfmac_f32_16x16x64_bf16 v[164:167], a[112:115], v[220:227], v24 abid:1
    ds_read_b128 v[200:203], v2 offset:23552
    ds_read_b128 v[128:131], v9 offset:10304
    ds_read_b128 v[132:135], v9 offset:10368
    v_smfmac_f32_16x16x64_bf16 v[164:167], a[148:151], v[228:235], v28 abid:1
    ds_read_b128 v[204:207], v1 offset:24576
    ds_read_b128 v[124:127], v9 offset:10240
    v_smfmac_f32_16x16x64_bf16 v[176:179], a[124:127], v[220:227], v26
    ds_read_b128 v[208:211], v2 offset:24576
    v_smfmac_f32_16x16x64_bf16 v[176:179], a[160:163], v[228:235], v30
    s_waitcnt lgkmcnt(7)
    v_smfmac_f32_16x16x64_bf16 v[176:179], v[240:243], v[244:251], v10 abid:1
    v_smfmac_f32_16x16x64_bf16 v[140:143], v[240:243], v[244:251], v10
    v_smfmac_f32_16x16x64_bf16 v[172:175], a[120:123], v[220:227], v25 abid:1
    s_add_u32 s28, s28, 36864
    s_cmp_ge_u32 s28, 110592
    s_cselect_b32 s28, s26, s28
    v_smfmac_f32_16x16x64_bf16 v[172:175], a[156:159], v[228:235], v29 abid:1
    s_add_u32 s30, s25, 36864
    s_cmp_eq_u32 s30, 110592
    s_cselect_b32 s30, 0, s30
    v_smfmac_f32_16x16x64_bf16 v[168:171], a[116:119], v[220:227], v25
    s_sub_u32 s31, s30, s25
    s_mov_b32 s25, s30
    s_mov_b32 s90, s22
    v_smfmac_f32_16x16x64_bf16 v[168:171], a[152:155], v[228:235], v29
    s_mov_b32 s22, s88
    s_add_u32 s91, s91, 1
    s_cmp_lt_u32 s20, 2
    v_smfmac_f32_16x16x64_bf16 v[180:183], a[128:131], v[220:227], v26 abid:1
    s_cselect_b32 s66, s23, s24
    s_add_u32 s66, s66, s95
    v_smfmac_f32_16x16x64_bf16 v[180:183], a[164:167], v[228:235], v30 abid:1
    v_cvt_pk_bf16_f32 v140, v140, v141
    v_smfmac_f32_16x16x64_bf16 v[184:187], a[132:135], v[220:227], v27
    v_cvt_pk_bf16_f32 v141, v142, v143
    v_smfmac_f32_16x16x64_bf16 v[184:187], a[168:171], v[228:235], v31
    v_cvt_pk_bf16_f32 v142, v144, v145
    v_smfmac_f32_16x16x64_bf16 v[188:191], a[136:139], v[220:227], v27 abid:1
    v_cvt_pk_bf16_f32 v143, v146, v147
    v_smfmac_f32_16x16x64_bf16 v[188:191], a[172:175], v[228:235], v31 abid:1
    v_cvt_pk_bf16_f32 v148, v148, v149
    v_smfmac_f32_16x16x64_bf16 v[192:195], a[140:143], v[220:227], v49 abid:1
    v_cvt_pk_bf16_f32 v149, v150, v151
    v_smfmac_f32_16x16x64_bf16 v[192:195], a[176:179], v[228:235], v50
    ds_read_b128 v[220:223], v1 offset:25600
    s_waitcnt lgkmcnt(6)
    v_cvt_pk_bf16_f32 v150, v152, v153
    v_smfmac_f32_16x16x64_bf16 v[160:163], a[180:183], v[196:203], v32
    ds_read_b128 v[224:227], v2 offset:25600
    s_waitcnt lgkmcnt(2)
    v_cvt_pk_bf16_f32 v151, v154, v155
    v_smfmac_f32_16x16x64_bf16 v[160:163], a[216:219], v[204:211], v36
    ds_read_b128 v[228:231], v1 offset:26624
    ds_read_b128 v[152:155], v9 offset:10688
    v_cndmask_b32_dpp v144, v140, v148, vcc row_ror:8 row_mask:0xf bank_mask:0xf
    v_smfmac_f32_16x16x64_bf16 v[164:167], a[184:187], v[196:203], v32 abid:1
    ds_read_b128 v[232:235], v2 offset:26624
    v_cndmask_b32_dpp v145, v141, v149, vcc row_ror:8 row_mask:0xf bank_mask:0xf
    v_smfmac_f32_16x16x64_bf16 v[164:167], a[220:223], v[204:211], v36 abid:1
    v_cndmask_b32_dpp v146, v142, v150, vcc row_ror:8 row_mask:0xf bank_mask:0xf
    v_smfmac_f32_16x16x64_bf16 v[168:171], a[188:191], v[196:203], v33
    v_cndmask_b32_dpp v147, v143, v151, vcc row_ror:8 row_mask:0xf bank_mask:0xf
    v_smfmac_f32_16x16x64_bf16 v[168:171], a[224:227], v[204:211], v37
    buffer_store_dwordx4 v[144:147], v6, s[12:15], s59 offen offset:128 sc1
    v_mov_b32_dpp v140, v148 row_ror:8 row_mask:0xf bank_mask:0xc
    v_smfmac_f32_16x16x64_bf16 v[172:175], a[192:195], v[196:203], v33 abid:1
    v_mov_b32_dpp v141, v149 row_ror:8 row_mask:0xf bank_mask:0xc
    v_smfmac_f32_16x16x64_bf16 v[172:175], a[228:231], v[204:211], v37 abid:1
    v_mov_b32_dpp v142, v150 row_ror:8 row_mask:0xf bank_mask:0xc
    v_smfmac_f32_16x16x64_bf16 v[176:179], a[196:199], v[196:203], v34
    v_mov_b32_dpp v143, v151 row_ror:8 row_mask:0xf bank_mask:0xc
    v_smfmac_f32_16x16x64_bf16 v[176:179], a[232:235], v[204:211], v38
    buffer_store_dwordx4 v[140:143], v6, s[12:15], s24 offen offset:128 sc1
    ds_read_b128 v[144:147], v9 offset:10560
    v_smfmac_f32_16x16x64_bf16 v[180:183], a[200:203], v[196:203], v34 abid:1
    ds_read_b128 v[148:151], v9 offset:10624
    ds_read_b128 v[140:143], v9 offset:10496
    v_add_u32 v4, s31, v4
    v_smfmac_f32_16x16x64_bf16 v[180:183], a[236:239], v[204:211], v38 abid:1
    v_add_u32 v1, s31, v1
    v_smfmac_f32_16x16x64_bf16 v[184:187], a[204:207], v[196:203], v35
    v_add_u32 v2, s31, v2
    v_smfmac_f32_16x16x64_bf16 v[184:187], a[240:243], v[204:211], v39
    v_smfmac_f32_16x16x64_bf16 v[188:191], a[208:211], v[196:203], v35 abid:1
    v_smfmac_f32_16x16x64_bf16 v[188:191], a[244:247], v[204:211], v39 abid:1
    v_smfmac_f32_16x16x64_bf16 v[192:195], a[212:215], v[196:203], v50 abid:1
    v_smfmac_f32_16x16x64_bf16 v[192:195], a[248:251], v[204:211], v51
    s_waitcnt vmcnt(4)
    s_branch M_top1
M_bH:
    v_smfmac_f32_16x16x64_bf16 v[164:167], v[56:59], v[220:227], v40 abid:1
    ds_read_b128 v[204:207], v1 offset:1024
    ds_read_b128 v[236:239], v9 offset:9728
    v_smfmac_f32_16x16x64_bf16 v[164:167], v[92:95], v[228:235], v44 abid:1
    ds_read_b128 v[208:211], v2 offset:1024
    v_smfmac_f32_16x16x64_bf16 v[168:171], v[60:63], v[220:227], v41
    ds_read_b128 v[212:215], v1 offset:2048
    v_smfmac_f32_16x16x64_bf16 v[168:171], v[96:99], v[228:235], v45
    ds_read_b128 v[216:219], v2 offset:2048
    s_waitcnt lgkmcnt(7)
    buffer_store_dwordx4 v[244:247], v7, s[12:15], s66 offen sc1
    v_smfmac_f32_16x16x64_bf16 v[172:175], v[64:67], v[220:227], v41 abid:1
    s_mov_b32 s21, 5
    s_barrier
    v_smfmac_f32_16x16x64_bf16 v[172:175], v[100:103], v[228:235], v45 abid:1
    s_cmp_lt_u32 s20, 2
    s_cselect_b32 s66, s23, s24
    s_add_u32 s66, s66, s95
    s_waitcnt lgkmcnt(3)
    v_xad_u32 v236, v236, v3, v4
    v_smfmac_f32_16x16x64_bf16 v[176:179], v[68:71], v[220:227], v42
    ds_read_b32 v244, v236
    ds_read_b128 v[240:243], v8 offset:8192
    v_xad_u32 v237, v237, v3, v4
    v_smfmac_f32_16x16x64_bf16 v[176:179], v[104:107], v[228:235], v46
    ds_read_b32 v246, v237
    v_xad_u32 v238, v238, v3, v4
    v_smfmac_f32_16x16x64_bf16 v[180:183], v[72:75], v[220:227], v42 abid:1
    ds_read_b32 v248, v238
    v_xad_u32 v239, v239, v3, v4
    v_smfmac_f32_16x16x64_bf16 v[180:183], v[108:111], v[228:235], v46 abid:1
    ds_read_b32 v250, v239
    ds_read_b128 v[236:239], v9 offset:9216
    v_cvt_pk_bf16_f32 v160, v160, v161
    v_smfmac_f32_16x16x64_bf16 v[184:187], v[76:79], v[220:227], v43
    v_cvt_pk_bf16_f32 v161, v162, v163
    v_smfmac_f32_16x16x64_bf16 v[184:187], v[112:115], v[228:235], v47
    v_cvt_pk_bf16_f32 v162, v164, v165
    v_smfmac_f32_16x16x64_bf16 v[188:191], v[80:83], v[220:227], v43 abid:1
    v_cvt_pk_bf16_f32 v163, v166, v167
    v_smfmac_f32_16x16x64_bf16 v[188:191], v[116:119], v[228:235], v47 abid:1
    v_cvt_pk_bf16_f32 v168, v168, v169
    v_smfmac_f32_16x16x64_bf16 v[192:195], v[84:87], v[220:227], v51 abid:1
    v_cvt_pk_bf16_f32 v169, v170, v171
    v_smfmac_f32_16x16x64_bf16 v[192:195], v[120:123], v[228:235], v52
    ds_read_b128 v[220:223], v1 offset:3072
    s_waitcnt lgkmcnt(1)
    v_xad_u32 v236, v236, v3, v4
    v_smfmac_f32_16x16x64_bf16 v[156:159], v[240:243], v[244:251], v10
    ds_read_b32 v244, v236
    ds_read_b128 v[240:243], v8 offset:0
    v_xad_u32 v237, v237, v3, v4
    v_smfmac_f32_16x16x64_bf16 v[156:159], a[32:35], v[196:203], v48
    ds_read_b32 v246, v237
    ds_read_b128 v[224:227], v2 offset:3072
    v_xad_u32 v238, v238, v3, v4
    v_smfmac_f32_16x16x64_bf16 v[156:159], a[68:71], v[204:211], v48 abid:1
    ds_read_b32 v248, v238
    ds_read_b128 v[228:231], v1 offset:4096
    v_xad_u32 v239, v239, v3, v4
    v_smfmac_f32_16x16x64_bf16 v[156:159], a[104:107], v[212:219], v49
    ds_read_b32 v250, v239
    ds_read_b128 v[236:239], v9 offset:9280
    ds_read_b128 v[232:235], v2 offset:4096
    v_smfmac_f32_16x16x64_bf16 v[124:127], a[0:3], v[196:203], v12
    v_cvt_pk_bf16_f32 v170, v172, v173
    v_smfmac_f32_16x16x64_bf16 v[124:127], a[36:39], v[204:211], v16
    v_cvt_pk_bf16_f32 v192, v192, v193
    v_smfmac_f32_16x16x64_bf16 v[124:127], a[72:75], v[212:219], v20
    v_cvt_pk_bf16_f32 v193, v194, v195
    v_smfmac_f32_16x16x64_bf16 v[128:131], a[4:7], v[196:203], v12 abid:1
    ds_write_b64 v53, v[192:193] offset:0
    v_cvt_pk_bf16_f32 v171, v174, v175
    v_smfmac_f32_16x16x64_bf16 v[128:131], a[40:43], v[204:211], v16 abid:1
    v_cndmask_b32_dpp v164, v160, v168, vcc row_ror:8 row_mask:0xf bank_mask:0xf
    v_smfmac_f32_16x16x64_bf16 v[128:131], a[76:79], v[212:219], v20 abid:1
    s_waitcnt lgkmcnt(2)
    v_xad_u32 v236, v236, v3, v4
    v_smfmac_f32_16x16x64_bf16 v[124:127], v[240:243], v[244:251], v10
    ds_read_b32 v244, v236
    ds_read_b128 v[240:243], v8 offset:1024
    v_xad_u32 v237, v237, v3, v4
    v_smfmac_f32_16x16x64_bf16 v[132:135], a[8:11], v[196:203], v13
    ds_read_b32 v246, v237
    v_xad_u32 v238, v238, v3, v4
    v_smfmac_f32_16x16x64_bf16 v[132:135], a[44:47], v[204:211], v17
    ds_read_b32 v248, v238
    v_xad_u32 v239, v239, v3, v4
    v_smfmac_f32_16x16x64_bf16 v[132:135], a[80:83], v[212:219], v21
    ds_read_b32 v250, v239
    ds_read_b128 v[236:239], v9 offset:9344
    v_cndmask_b32_dpp v165, v161, v169, vcc row_ror:8 row_mask:0xf bank_mask:0xf
    v_smfmac_f32_16x16x64_bf16 v[136:139], a[12:15], v[196:203], v13 abid:1
    v_cndmask_b32_dpp v166, v162, v170, vcc row_ror:8 row_mask:0xf bank_mask:0xf
    v_smfmac_f32_16x16x64_bf16 v[136:139], a[48:51], v[204:211], v17 abid:1
    v_cndmask_b32_dpp v167, v163, v171, vcc row_ror:8 row_mask:0xf bank_mask:0xf
    v_smfmac_f32_16x16x64_bf16 v[136:139], a[84:87], v[212:219], v21 abid:1
    ds_read_b128 v[196:199], v1 offset:5120
    buffer_store_dwordx4 v[164:167], v6, s[12:15], s58 offen offset:0 sc1
    v_mov_b32_dpp v160, v168 row_ror:8 row_mask:0xf bank_mask:0xc
    v_smfmac_f32_16x16x64_bf16 v[156:159], a[140:143], v[220:227], v49 abid:1
    ds_read_b128 v[200:203], v2 offset:5120
    ds_read_b64 v[216:217], v9 offset:10056
    s_waitcnt lgkmcnt(10)
    v_mov_b32_dpp v161, v169 row_ror:8 row_mask:0xf bank_mask:0xc
    v_smfmac_f32_16x16x64_bf16 v[156:159], a[176:179], v[228:235], v50
    ds_read_b128 v[204:207], v1 offset:6144
    s_waitcnt lgkmcnt(4)
    v_xad_u32 v236, v236, v3, v4
    v_smfmac_f32_16x16x64_bf16 v[128:131], v[240:243], v[244:251], v10
    ds_read_b32 v244, v236
    ds_read_b128 v[240:243], v8 offset:2048
    v_xad_u32 v237, v237, v3, v4
    v_smfmac_f32_16x16x64_bf16 v[124:127], a[108:111], v[220:227], v24
    ds_read_b32 v246, v237
    ds_read_b128 v[208:211], v2 offset:6144
    v_xad_u32 v238, v238, v3, v4
    v_smfmac_f32_16x16x64_bf16 v[124:127], a[144:147], v[228:235], v28
    ds_read_b32 v248, v238
    v_xad_u32 v239, v239, v3, v4
    v_smfmac_f32_16x16x64_bf16 v[128:131], a[112:115], v[220:227], v24 abid:1
    ds_read_b32 v250, v239
    ds_read_b128 v[236:239], v9 offset:9408
    s_waitcnt lgkmcnt(8)
    v_xad_u32 v212, v216, v3, v4
    v_smfmac_f32_16x16x64_bf16 v[128:131], a[148:151], v[228:235], v28 abid:1
    ds_read2st64_b32 v[212:213], v212 offset0:0 offset1:72
    v_xad_u32 v214, v217, v3, v4
    v_smfmac_f32_16x16x64_bf16 v[132:135], a[116:119], v[220:227], v25
    ds_read2st64_b32 v[214:215], v214 offset0:0 offset1:72
    v_mov_b32_dpp v162, v170 row_ror:8 row_mask:0xf bank_mask:0xc
    v_smfmac_f32_16x16x64_bf16 v[132:135], a[152:155], v[228:235], v29
    v_mov_b32_dpp v163, v171 row_ror:8 row_mask:0xf bank_mask:0xc
    v_smfmac_f32_16x16x64_bf16 v[136:139], a[120:123], v[220:227], v25 abid:1
    buffer_store_dwordx4 v[160:163], v6, s[12:15], s23 offen offset:0 sc1
    v_cvt_pk_bf16_f32 v176, v176, v177
    v_smfmac_f32_16x16x64_bf16 v[136:139], a[156:159], v[228:235], v29 abid:1
    ds_read_b128 v[220:223], v1 offset:7168
    v_cvt_pk_bf16_f32 v177, v178, v179
    v_smfmac_f32_16x16x64_bf16 v[156:159], a[212:215], v[196:203], v50 abid:1
    ds_read_b128 v[224:227], v2 offset:7168
    s_waitcnt lgkmcnt(7)
    v_cvt_pk_bf16_f32 v178, v180, v181
    v_smfmac_f32_16x16x64_bf16 v[156:159], a[248:251], v[204:211], v51
    ds_read_b128 v[228:231], v1 offset:8192
    s_waitcnt lgkmcnt(5)
    v_xad_u32 v236, v236, v3, v4
    v_smfmac_f32_16x16x64_bf16 v[132:135], v[240:243], v[244:251], v10
    ds_read_b32 v244, v236
    ds_read_b128 v[240:243], v8 offset:3072
    v_xad_u32 v237, v237, v3, v4
    v_smfmac_f32_16x16x64_bf16 v[124:127], a[180:183], v[196:203], v32
    ds_read_b32 v246, v237
    ds_read_b128 v[232:235], v2 offset:8192
    v_xad_u32 v238, v238, v3, v4
    v_smfmac_f32_16x16x64_bf16 v[124:127], a[216:219], v[204:211], v36
    ds_read_b32 v248, v238
    v_xad_u32 v239, v239, v3, v4
    v_smfmac_f32_16x16x64_bf16 v[128:131], a[184:187], v[196:203], v32 abid:1
    ds_read_b32 v250, v239
    ds_read_b128 v[236:239], v9 offset:9472
    v_cvt_pk_bf16_f32 v179, v182, v183
    v_smfmac_f32_16x16x64_bf16 v[128:131], a[220:223], v[204:211], v36 abid:1
    v_cvt_pk_bf16_f32 v184, v184, v185
    v_smfmac_f32_16x16x64_bf16 v[132:135], a[188:191], v[196:203], v33
    v_cvt_pk_bf16_f32 v185, v186, v187
    v_smfmac_f32_16x16x64_bf16 v[132:135], a[224:227], v[204:211], v37
    v_cvt_pk_bf16_f32 v186, v188, v189
    v_smfmac_f32_16x16x64_bf16 v[136:139], a[192:195], v[196:203], v33 abid:1
    v_cvt_pk_bf16_f32 v187, v190, v191
    v_smfmac_f32_16x16x64_bf16 v[136:139], a[228:231], v[204:211], v37 abid:1
    ds_read_b128 v[196:199], v1 offset:0
    s_waitcnt lgkmcnt(1)
    v_xad_u32 v236, v236, v3, v4
    v_smfmac_f32_16x16x64_bf16 v[136:139], v[240:243], v[244:251], v10
    ds_read_b32 v244, v236
    ds_read_b128 v[240:243], v8 offset:4096
    v_xad_u32 v237, v237, v3, v4
    v_smfmac_f32_16x16x64_bf16 v[156:159], v[84:87], v[220:227], v51 abid:1
    ds_read_b32 v246, v237
    ds_read_b128 v[200:203], v2 offset:0
    v_xad_u32 v238, v238, v3, v4
    v_smfmac_f32_16x16x64_bf16 v[156:159], v[120:123], v[228:235], v52
    ds_read_b32 v248, v238
    ds_read_b128 v[204:207], v1 offset:1024
    v_xad_u32 v239, v239, v3, v4
    v_smfmac_f32_16x16x64_bf16 v[124:127], a[252:255], v[220:227], v40
    ds_read_b32 v250, v239
    ds_read_b128 v[236:239], v9 offset:9536
    ds_read_b128 v[208:211], v2 offset:1024
    v_smfmac_f32_16x16x64_bf16 v[124:127], v[88:91], v[228:235], v44
    v_cndmask_b32_dpp v180, v176, v184, vcc row_ror:8 row_mask:0xf bank_mask:0xf
    v_smfmac_f32_16x16x64_bf16 v[128:131], v[56:59], v[220:227], v40 abid:1
    v_cndmask_b32_dpp v181, v177, v185, vcc row_ror:8 row_mask:0xf bank_mask:0xf
    v_smfmac_f32_16x16x64_bf16 v[128:131], v[92:95], v[228:235], v44 abid:1
    v_cndmask_b32_dpp v182, v178, v186, vcc row_ror:8 row_mask:0xf bank_mask:0xf
    v_smfmac_f32_16x16x64_bf16 v[132:135], v[60:63], v[220:227], v41
    v_cndmask_b32_dpp v183, v179, v187, vcc row_ror:8 row_mask:0xf bank_mask:0xf
    v_smfmac_f32_16x16x64_bf16 v[132:135], v[96:99], v[228:235], v45
    buffer_store_dwordx4 v[180:183], v6, s[12:15], s58 offen offset:128 sc1
    v_mov_b32_dpp v176, v184 row_ror:8 row_mask:0xf bank_mask:0xc
    v_smfmac_f32_16x16x64_bf16 v[136:139], v[64:67], v[220:227], v41 abid:1
    v_mov_b32_dpp v177, v185 row_ror:8 row_mask:0xf bank_mask:0xc
    v_smfmac_f32_16x16x64_bf16 v[136:139], v[100:103], v[228:235], v45 abid:1
    ds_read_b128 v[220:223], v1 offset:2048
    s_waitcnt lgkmcnt(2)
    v_xad_u32 v236, v236, v3, v4
    v_smfmac_f32_16x16x64_bf16 v[140:143], v[240:243], v[244:251], v10
    ds_read_b32 v244, v236
    ds_read_b128 v[240:243], v8 offset:5120
    v_xad_u32 v237, v237, v3, v4
    v_smfmac_f32_16x16x64_bf16 v[140:143], a[16:19], v[196:203], v14
    ds_read_b32 v246, v237
    ds_read_b128 v[224:227], v2 offset:2048
    s_waitcnt lgkmcnt(5)
    v_xad_u32 v238, v238, v3, v4
    v_smfmac_f32_16x16x64_bf16 v[140:143], a[52:55], v[204:211], v18
    ds_read_b32 v248, v238
    ds_read_b128 v[228:231], v1 offset:3072
    v_xad_u32 v239, v239, v3, v4
    v_smfmac_f32_16x16x64_bf16 v[144:147], a[20:23], v[196:203], v14 abid:1
    ds_read_b32 v250, v239
    ds_read_b128 v[236:239], v9 offset:9600
    ds_read_b128 v[232:235], v2 offset:3072
    v_smfmac_f32_16x16x64_bf16 v[144:147], a[56:59], v[204:211], v18 abid:1
    v_mov_b32_dpp v178, v186 row_ror:8 row_mask:0xf bank_mask:0xc
    v_smfmac_f32_16x16x64_bf16 v[148:151], a[24:27], v[196:203], v15
    v_mov_b32_dpp v179, v187 row_ror:8 row_mask:0xf bank_mask:0xc
    v_smfmac_f32_16x16x64_bf16 v[148:151], a[60:63], v[204:211], v19
    buffer_store_dwordx4 v[176:179], v6, s[12:15], s23 offen offset:128 sc1
    v_smfmac_f32_16x16x64_bf16 v[152:155], a[28:31], v[196:203], v15 abid:1
    s_cmp_lt_i32 s81, 0
    s_cbranch_scc1 M_ovrH
    s_swappc_b64 s[78:79], s[72:73]
M_ovrH:
    v_smfmac_f32_16x16x64_bf16 v[152:155], a[64:67], v[204:211], v19 abid:1
    ds_read_b128 v[196:199], v1 offset:4096
    s_waitcnt lgkmcnt(2)
    v_xad_u32 v236, v236, v3, v4
    v_smfmac_f32_16x16x64_bf16 v[144:147], v[240:243], v[244:251], v10
    s_cmp_gt_u32 s46, s80
    s_cbranch_scc1 M_slow
M_slowrH:
    ds_read_b32 v244, v236
    v_smfmac_f32_16x16x64_bf16 v[140:143], a[88:91], v[220:227], v22
    ds_read_b128 v[240:243], v8 offset:6144
    ds_read_b128 v[200:203], v2 offset:4096
    s_waitcnt lgkmcnt(4)
    v_xad_u32 v237, v237, v3, v4
    v_smfmac_f32_16x16x64_bf16 v[140:143], a[124:127], v[228:235], v26
    ds_read_b32 v246, v237
    ds_read_b128 v[204:207], v1 offset:5120
    v_xad_u32 v238, v238, v3, v4
    v_smfmac_f32_16x16x64_bf16 v[144:147], a[92:95], v[220:227], v22 abid:1
    ds_read_b32 v248, v238
    ds_read_b128 v[208:211], v2 offset:5120
    v_xad_u32 v239, v239, v3, v4
    v_smfmac_f32_16x16x64_bf16 v[144:147], a[128:131], v[228:235], v26 abid:1
    ds_read_b32 v250, v239
    ds_read_b128 v[236:239], v9 offset:9664
    ds_read_b128 v[212:215], v1 offset:8192
    v_smfmac_f32_16x16x64_bf16 v[148:151], a[96:99], v[220:227], v23
    ds_read_b128 v[216:219], v2 offset:8192
    v_cvt_pk_bf16_f32 v156, v156, v157
    v_smfmac_f32_16x16x64_bf16 v[148:151], a[132:135], v[228:235], v27
    v_cvt_pk_bf16_f32 v157, v158, v159
    v_smfmac_f32_16x16x64_bf16 v[152:155], a[100:103], v[220:227], v23 abid:1
    ds_write_b64 v53, v[156:157] offset:25728
    v_cvt_pk_bf16_f32 v124, v124, v125
    v_smfmac_f32_16x16x64_bf16 v[152:155], a[136:139], v[228:235], v27 abid:1
    ds_read_b128 v[220:223], v1 offset:6144
    s_waitcnt lgkmcnt(10)
    v_cvt_pk_bf16_f32 v125, v126, v127
    v_smfmac_f32_16x16x64_bf16 v[140:143], a[160:163], v[196:203], v30
    ds_read_b128 v[224:227], v2 offset:6144
    s_waitcnt lgkmcnt(7)
    v_cvt_pk_bf16_f32 v126, v128, v129
    v_smfmac_f32_16x16x64_bf16 v[140:143], a[196:199], v[204:211], v34
    ds_read_b128 v[228:231], v1 offset:7168
    s_waitcnt lgkmcnt(6)
    v_xad_u32 v236, v236, v3, v4
    v_smfmac_f32_16x16x64_bf16 v[148:151], v[240:243], v[244:251], v10
    ds_read_b32 v244, v236
    ds_read_b128 v[240:243], v8 offset:7168
    v_xad_u32 v237, v237, v3, v4
    v_smfmac_f32_16x16x64_bf16 v[144:147], a[164:167], v[196:203], v30 abid:1
    ds_read_b32 v246, v237
    ds_read_b128 v[232:235], v2 offset:7168
    v_xad_u32 v238, v238, v3, v4
    v_smfmac_f32_16x16x64_bf16 v[144:147], a[200:203], v[204:211], v34 abid:1
    ds_read_b32 v248, v238
    s_waitcnt lgkmcnt(8)
    s_barrier
    v_xad_u32 v239, v239, v3, v4
    v_smfmac_f32_16x16x64_bf16 v[148:151], a[168:171], v[196:203], v31
    ds_read_b32 v250, v239
    ds_read_b128 v[160:163], v8 offset:10816
    v_cvt_pk_bf16_f32 v127, v130, v131
    v_smfmac_f32_16x16x64_bf16 v[148:151], a[204:207], v[204:211], v35
    v_cvt_pk_bf16_f32 v132, v132, v133
    v_smfmac_f32_16x16x64_bf16 v[152:155], a[172:175], v[196:203], v31 abid:1
    v_cvt_pk_bf16_f32 v133, v134, v135
    v_smfmac_f32_16x16x64_bf16 v[152:155], a[208:211], v[204:211], v35 abid:1
    s_waitcnt lgkmcnt(8)
    v_cvt_pk_bf16_f32 v134, v136, v137
    v_smfmac_f32_16x16x64_bf16 v[140:143], a[232:235], v[220:227], v38
    s_waitcnt lgkmcnt(3)
    v_cvt_pk_bf16_f32 v135, v138, v139
    v_smfmac_f32_16x16x64_bf16 v[140:143], v[68:71], v[228:235], v42
    v_cndmask_b32_dpp v128, v124, v132, vcc row_ror:8 row_mask:0xf bank_mask:0xf
    v_smfmac_f32_16x16x64_bf16 v[140:143], v[104:107], v[212:219], v46
    s_waitcnt lgkmcnt(0)
    buffer_store_dwordx4 v[160:163], v7, s[12:15], s66 offen sc1
    v_cndmask_b32_dpp v129, v125, v133, vcc row_ror:8 row_mask:0xf bank_mask:0xf
    v_smfmac_f32_16x16x64_bf16 v[152:155], v[240:243], v[244:251], v10
    v_cndmask_b32_dpp v130, v126, v134, vcc row_ror:8 row_mask:0xf bank_mask:0xf
    v_smfmac_f32_16x16x64_bf16 v[144:147], a[236:239], v[220:227], v38 abid:1
    v_cndmask_b32_dpp v131, v127, v135, vcc row_ror:8 row_mask:0xf bank_mask:0xf
    v_smfmac_f32_16x16x64_bf16 v[144:147], v[72:75], v[228:235], v42 abid:1
    buffer_store_dwordx4 v[128:131], v6, s[12:15], s59 offen offset:0 sc1
    v_mov_b32_dpp v124, v132 row_ror:8 row_mask:0xf bank_mask:0xc
    v_smfmac_f32_16x16x64_bf16 v[144:147], v[108:111], v[212:219], v46 abid:1
    v_mov_b32_dpp v125, v133 row_ror:8 row_mask:0xf bank_mask:0xc
    v_smfmac_f32_16x16x64_bf16 v[148:151], a[240:243], v[220:227], v39
    v_mov_b32_dpp v126, v134 row_ror:8 row_mask:0xf bank_mask:0xc
    v_smfmac_f32_16x16x64_bf16 v[148:151], v[76:79], v[228:235], v43
    v_mov_b32_dpp v127, v135 row_ror:8 row_mask:0xf bank_mask:0xc
    v_smfmac_f32_16x16x64_bf16 v[148:151], v[112:115], v[212:219], v47
    buffer_store_dwordx4 v[124:127], v6, s[12:15], s24 offen offset:0 sc1
    v_smfmac_f32_16x16x64_bf16 v[152:155], a[244:247], v[220:227], v39 abid:1
    v_cvt_pk_bf16_f32 v140, v140, v141
    v_smfmac_f32_16x16x64_bf16 v[152:155], v[80:83], v[228:235], v43 abid:1
    v_cvt_pk_bf16_f32 v141, v142, v143
    v_smfmac_f32_16x16x64_bf16 v[152:155], v[116:119], v[212:219], v47 abid:1
    v_cvt_pk_bf16_f32 v142, v144, v145
    v_cvt_pk_bf16_f32 v143, v146, v147
    v_cvt_pk_bf16_f32 v148, v148, v149
    v_cvt_pk_bf16_f32 v149, v150, v151
    s_nop 3
    v_cvt_pk_bf16_f32 v150, v152, v153
    v_cvt_pk_bf16_f32 v151, v154, v155
    v_cndmask_b32_dpp v144, v140, v148, vcc row_ror:8 row_mask:0xf bank_mask:0xf
    v_cndmask_b32_dpp v145, v141, v149, vcc row_ror:8 row_mask:0xf bank_mask:0xf
    v_cndmask_b32_dpp v146, v142, v150, vcc row_ror:8 row_mask:0xf bank_mask:0xf
    v_cndmask_b32_dpp v147, v143, v151, vcc row_ror:8 row_mask:0xf bank_mask:0xf
    buffer_store_dwordx4 v[144:147], v6, s[12:15], s59 offen offset:128 sc1
    v_mov_b32_dpp v140, v148 row_ror:8 row_mask:0xf bank_mask:0xc
    v_mov_b32_dpp v141, v149 row_ror:8 row_mask:0xf bank_mask:0xc
    v_mov_b32_dpp v142, v150 row_ror:8 row_mask:0xf bank_mask:0xc
    v_mov_b32_dpp v143, v151 row_ror:8 row_mask:0xf bank_mask:0xc
    buffer_store_dwordx4 v[140:143], v6, s[12:15], s24 offen offset:128 sc1
    s_branch M_done
M_bF:
    s_cmp_ge_u32 s24, 74612736
    s_cbranch_scc1 M_bH
    v_smfmac_f32_16x16x64_bf16 v[164:167], v[56:59], v[220:227], v40 abid:1
    ds_read_b128 v[204:207], v1 offset:1024
    v_smfmac_f32_16x16x64_bf16 v[164:167], v[92:95], v[228:235], v44 abid:1
    ds_read_b128 v[208:211], v2 offset:1024
    v_smfmac_f32_16x16x64_bf16 v[168:171], v[60:63], v[220:227], v41
    ds_read_b128 v[212:215], v1 offset:2048
    v_smfmac_f32_16x16x64_bf16 v[168:171], v[96:99], v[228:235], v45
    ds_read_b128 v[216:219], v2 offset:2048
    v_smfmac_f32_16x16x64_bf16 v[172:175], v[64:67], v[220:227], v41 abid:1
    s_waitcnt lgkmcnt(6)
    buffer_store_dwordx4 v[244:247], v7, s[12:15], s66 offen sc1
    v_smfmac_f32_16x16x64_bf16 v[172:175], v[100:103], v[228:235], v45 abid:1
    ds_read_b128 v[236:239], v9 offset:9408
    v_smfmac_f32_16x16x64_bf16 v[176:179], v[68:71], v[220:227], v42
    s_mov_b32 s21, 4
    v_smfmac_f32_16x16x64_bf16 v[176:179], v[104:107], v[228:235], v46
    v_smfmac_f32_16x16x64_bf16 v[180:183], v[72:75], v[220:227], v42 abid:1
    v_cvt_pk_bf16_f32 v160, v160, v161
    v_smfmac_f32_16x16x64_bf16 v[180:183], v[108:111], v[228:235], v46 abid:1
    v_cvt_pk_bf16_f32 v161, v162, v163
    v_smfmac_f32_16x16x64_bf16 v[184:187], v[76:79], v[220:227], v43
    v_cvt_pk_bf16_f32 v162, v164, v165
    v_smfmac_f32_16x16x64_bf16 v[184:187], v[112:115], v[228:235], v47
    v_cvt_pk_bf16_f32 v163, v166, v167
    v_smfmac_f32_16x16x64_bf16 v[188:191], v[80:83], v[220:227], v43 abid:1
    v_cvt_pk_bf16_f32 v168, v168, v169
    v_smfmac_f32_16x16x64_bf16 v[188:191], v[116:119], v[228:235], v47 abid:1
    v_cvt_pk_bf16_f32 v169, v170, v171
    v_smfmac_f32_16x16x64_bf16 v[192:195], v[84:87], v[220:227], v51 abid:1
    v_cvt_pk_bf16_f32 v170, v172, v173
    v_smfmac_f32_16x16x64_bf16 v[192:195], v[120:123], v[228:235], v52
    ds_read_b128 v[220:223], v1 offset:3072
    s_waitcnt lgkmcnt(6)
    v_cvt_pk_bf16_f32 v171, v174, v175
    v_smfmac_f32_16x16x64_bf16 v[124:127], a[0:3], v[196:203], v12
    ds_read_b128 v[224:227], v2 offset:3072
    ds_read_b128 v[172:175], v9 offset:10432
    s_waitcnt lgkmcnt(6)
    v_cndmask_b32_dpp v164, v160, v168, vcc row_ror:8 row_mask:0xf bank_mask:0xf
    v_smfmac_f32_16x16x64_bf16 v[124:127], a[36:39], v[204:211], v16
    ds_read_b128 v[228:231], v1 offset:4096
    s_waitcnt lgkmcnt(5)
    v_cndmask_b32_dpp v165, v161, v169, vcc row_ror:8 row_mask:0xf bank_mask:0xf
    v_smfmac_f32_16x16x64_bf16 v[124:127], a[72:75], v[212:219], v20
    ds_read_b128 v[232:235], v2 offset:4096
    s_waitcnt lgkmcnt(5)
    v_xad_u32 v236, v236, v3, v4
    v_smfmac_f32_16x16x64_bf16 v[156:159], a[32:35], v[196:203], v48
    s_barrier
    v_xad_u32 v237, v237, v3, v4
    v_smfmac_f32_16x16x64_bf16 v[156:159], a[68:71], v[204:211], v48 abid:1
    ds_read2st64_b32 v[244:245], v236 offset0:0 offset1:72
    ds_read_b128 v[240:243], v8 offset:3072
    v_xad_u32 v238, v238, v3, v4
    v_smfmac_f32_16x16x64_bf16 v[156:159], a[104:107], v[212:219], v49
    ds_read2st64_b32 v[246:247], v237 offset0:0 offset1:72
    v_xad_u32 v239, v239, v3, v4
    v_smfmac_f32_16x16x64_bf16 v[132:135], a[8:11], v[196:203], v13
    ds_read2st64_b32 v[248:249], v238 offset0:0 offset1:72
    v_cndmask_b32_dpp v166, v162, v170, vcc row_ror:8 row_mask:0xf bank_mask:0xf
    v_smfmac_f32_16x16x64_bf16 v[132:135], a[44:47], v[204:211], v17
    ds_read2st64_b32 v[250:251], v239 offset0:0 offset1:72
    ds_read_b128 v[236:239], v9 offset:9280
    v_cndmask_b32_dpp v167, v163, v171, vcc row_ror:8 row_mask:0xf bank_mask:0xf
    v_smfmac_f32_16x16x64_bf16 v[132:135], a[80:83], v[212:219], v21
    buffer_store_dwordx4 v[164:167], v6, s[12:15], s58 offen offset:0 sc1
    v_mov_b32_dpp v160, v168 row_ror:8 row_mask:0xf bank_mask:0xc
    v_smfmac_f32_16x16x64_bf16 v[140:143], a[16:19], v[196:203], v14
    v_mov_b32_dpp v161, v169 row_ror:8 row_mask:0xf bank_mask:0xc
    v_smfmac_f32_16x16x64_bf16 v[140:143], a[52:55], v[204:211], v18
    v_mov_b32_dpp v162, v170 row_ror:8 row_mask:0xf bank_mask:0xc
    v_smfmac_f32_16x16x64_bf16 v[140:143], a[88:91], v[212:219], v22
    v_mov_b32_dpp v163, v171 row_ror:8 row_mask:0xf bank_mask:0xc
    v_smfmac_f32_16x16x64_bf16 v[136:139], a[12:15], v[196:203], v13 abid:1
    buffer_store_dwordx4 v[160:163], v6, s[12:15], s23 offen offset:0 sc1
    ds_read_b128 v[164:167], v9 offset:10304
    ds_read_b128 v[168:171], v9 offset:10368
    v_smfmac_f32_16x16x64_bf16 v[136:139], a[48:51], v[204:211], v17 abid:1
    ds_read_b128 v[160:163], v9 offset:10240
    v_smfmac_f32_16x16x64_bf16 v[136:139], a[84:87], v[212:219], v21 abid:1
    s_waitcnt lgkmcnt(3)
    v_xad_u32 v236, v236, v3, v4
    v_smfmac_f32_16x16x64_bf16 v[136:139], v[240:243], v[244:251], v10
    v_xad_u32 v237, v237, v3, v4
    v_smfmac_f32_16x16x64_bf16 v[172:175], v[240:243], v[244:251], v10 abid:1
    ds_read2st64_b32 v[244:245], v236 offset0:0 offset1:72
    ds_read_b128 v[240:243], v8 offset:1024
    v_xad_u32 v238, v238, v3, v4
    v_smfmac_f32_16x16x64_bf16 v[144:147], a[20:23], v[196:203], v14 abid:1
    ds_read2st64_b32 v[246:247], v237 offset0:0 offset1:72
    v_xad_u32 v239, v239, v3, v4
    v_smfmac_f32_16x16x64_bf16 v[144:147], a[56:59], v[204:211], v18 abid:1
    ds_read2st64_b32 v[248:249], v238 offset0:0 offset1:72
    v_smfmac_f32_16x16x64_bf16 v[144:147], a[92:95], v[212:219], v22 abid:1
    ds_read2st64_b32 v[250:251], v239 offset0:0 offset1:72
    ds_read_b128 v[236:239], v9 offset:9344
    v_smfmac_f32_16x16x64_bf16 v[148:151], a[24:27], v[196:203], v15
    v_cvt_pk_bf16_f32 v192, v192, v193
    v_smfmac_f32_16x16x64_bf16 v[148:151], a[60:63], v[204:211], v19
    v_cvt_pk_bf16_f32 v193, v194, v195
    v_smfmac_f32_16x16x64_bf16 v[148:151], a[96:99], v[212:219], v23
    ds_write_b64 v53, v[192:193] offset:0
    ds_read_b128 v[192:195], v9 offset:10752
    v_smfmac_f32_16x16x64_bf16 v[152:155], a[28:31], v[196:203], v15 abid:1
    v_smfmac_f32_16x16x64_bf16 v[152:155], a[64:67], v[204:211], v19 abid:1
    v_smfmac_f32_16x16x64_bf16 v[152:155], a[100:103], v[212:219], v23 abid:1
    v_smfmac_f32_16x16x64_bf16 v[128:131], a[4:7], v[196:203], v12 abid:1
    v_smfmac_f32_16x16x64_bf16 v[128:131], a[40:43], v[204:211], v16 abid:1
    v_smfmac_f32_16x16x64_bf16 v[128:131], a[76:79], v[212:219], v20 abid:1
    s_waitcnt lgkmcnt(2)
    v_xad_u32 v236, v236, v3, v4
    v_smfmac_f32_16x16x64_bf16 v[128:131], v[240:243], v[244:251], v10
    v_xad_u32 v237, v237, v3, v4
    v_smfmac_f32_16x16x64_bf16 v[164:167], v[240:243], v[244:251], v10 abid:1
    ds_read2st64_b32 v[244:245], v236 offset0:0 offset1:72
    ds_read_b128 v[240:243], v8 offset:2048
    v_xad_u32 v238, v238, v3, v4
    v_smfmac_f32_16x16x64_bf16 v[124:127], a[108:111], v[220:227], v24
    ds_read2st64_b32 v[246:247], v237 offset0:0 offset1:72
    v_xad_u32 v239, v239, v3, v4
    v_smfmac_f32_16x16x64_bf16 v[124:127], a[144:147], v[228:235], v28
    ds_read2st64_b32 v[248:249], v238 offset0:0 offset1:72
    ds_read_b64 v[216:217], v9 offset:10056
    v_cvt_pk_bf16_f32 v176, v176, v177
    v_smfmac_f32_16x16x64_bf16 v[128:131], a[112:115], v[220:227], v24 abid:1
    ds_read2st64_b32 v[250:251], v239 offset0:0 offset1:72
    ds_read_b128 v[236:239], v9 offset:9216
    v_cvt_pk_bf16_f32 v177, v178, v179
    v_smfmac_f32_16x16x64_bf16 v[128:131], a[148:151], v[228:235], v28 abid:1
    v_cvt_pk_bf16_f32 v178, v180, v181
    v_smfmac_f32_16x16x64_bf16 v[140:143], a[124:127], v[220:227], v26
    v_cvt_pk_bf16_f32 v179, v182, v183
    v_smfmac_f32_16x16x64_bf16 v[140:143], a[160:163], v[228:235], v30
    v_cvt_pk_bf16_f32 v184, v184, v185
    v_smfmac_f32_16x16x64_bf16 v[136:139], a[120:123], v[220:227], v25 abid:1
    v_cvt_pk_bf16_f32 v185, v186, v187
    v_smfmac_f32_16x16x64_bf16 v[136:139], a[156:159], v[228:235], v29 abid:1
    ds_read_b128 v[196:199], v1 offset:5120
    v_cvt_pk_bf16_f32 v186, v188, v189
    v_smfmac_f32_16x16x64_bf16 v[132:135], a[116:119], v[220:227], v25
    ds_read_b128 v[200:203], v2 offset:5120
    v_cvt_pk_bf16_f32 v187, v190, v191
    v_smfmac_f32_16x16x64_bf16 v[132:135], a[152:155], v[228:235], v29
    ds_read_b128 v[188:191], v9 offset:10688
    s_waitcnt lgkmcnt(3)
    v_xad_u32 v236, v236, v3, v4
    v_smfmac_f32_16x16x64_bf16 v[132:135], v[240:243], v[244:251], v10
    ds_read_b128 v[204:207], v1 offset:6144
    v_xad_u32 v237, v237, v3, v4
    v_smfmac_f32_16x16x64_bf16 v[168:171], v[240:243], v[244:251], v10 abid:1
    ds_read2st64_b32 v[244:245], v236 offset0:0 offset1:72
    ds_read_b128 v[240:243], v8 offset:0
    v_xad_u32 v238, v238, v3, v4
    v_smfmac_f32_16x16x64_bf16 v[144:147], a[128:131], v[220:227], v26 abid:1
    ds_read2st64_b32 v[246:247], v237 offset0:0 offset1:72
    v_xad_u32 v239, v239, v3, v4
    v_smfmac_f32_16x16x64_bf16 v[144:147], a[164:167], v[228:235], v30 abid:1
    ds_read2st64_b32 v[248:249], v238 offset0:0 offset1:72
    ds_read_b128 v[208:211], v2 offset:6144
    v_cndmask_b32_dpp v180, v176, v184, vcc row_ror:8 row_mask:0xf bank_mask:0xf
    v_smfmac_f32_16x16x64_bf16 v[148:151], a[132:135], v[220:227], v27
    ds_read2st64_b32 v[250:251], v239 offset0:0 offset1:72
    ds_read_b128 v[236:239], v9 offset:9728
    v_cndmask_b32_dpp v181, v177, v185, vcc row_ror:8 row_mask:0xf bank_mask:0xf
    v_smfmac_f32_16x16x64_bf16 v[148:151], a[168:171], v[228:235], v31
    v_xad_u32 v212, v216, v3, v4
    v_smfmac_f32_16x16x64_bf16 v[152:155], a[136:139], v[220:227], v27 abid:1
    ds_read2st64_b32 v[212:213], v212 offset0:0 offset1:72
    v_xad_u32 v214, v217, v3, v4
    v_smfmac_f32_16x16x64_bf16 v[152:155], a[172:175], v[228:235], v31 abid:1
    ds_read2st64_b32 v[214:215], v214 offset0:0 offset1:72
    v_cndmask_b32_dpp v182, v178, v186, vcc row_ror:8 row_mask:0xf bank_mask:0xf
    v_smfmac_f32_16x16x64_bf16 v[156:159], a[140:143], v[220:227], v49 abid:1
    v_cndmask_b32_dpp v183, v179, v187, vcc row_ror:8 row_mask:0xf bank_mask:0xf
    v_smfmac_f32_16x16x64_bf16 v[156:159], a[176:179], v[228:235], v50
    buffer_store_dwordx4 v[180:183], v6, s[12:15], s58 offen offset:128 sc1
    s_waitcnt lgkmcnt(11)
    v_mov_b32_dpp v176, v184 row_ror:8 row_mask:0xf bank_mask:0xc
    v_smfmac_f32_16x16x64_bf16 v[128:131], a[184:187], v[196:203], v32 abid:1
    s_waitcnt lgkmcnt(4)
    v_mov_b32_dpp v177, v185 row_ror:8 row_mask:0xf bank_mask:0xc
    v_smfmac_f32_16x16x64_bf16 v[128:131], a[220:223], v[204:211], v36 abid:1
    v_mov_b32_dpp v178, v186 row_ror:8 row_mask:0xf bank_mask:0xc
    v_smfmac_f32_16x16x64_bf16 v[124:127], a[180:183], v[196:203], v32
    ds_read_b128 v[220:223], v1 offset:7168
    v_mov_b32_dpp v179, v187 row_ror:8 row_mask:0xf bank_mask:0xc
    v_smfmac_f32_16x16x64_bf16 v[124:127], a[216:219], v[204:211], v36
    buffer_store_dwordx4 v[176:179], v6, s[12:15], s23 offen offset:128 sc1
    s_waitcnt lgkmcnt(3)
    v_xad_u32 v236, v236, v3, v4
    v_smfmac_f32_16x16x64_bf16 v[124:127], v[240:243], v[244:251], v10
    ds_read_b128 v[224:227], v2 offset:7168
    ds_read_b128 v[180:183], v9 offset:10560
    v_xad_u32 v237, v237, v3, v4
    v_smfmac_f32_16x16x64_bf16 v[160:163], v[240:243], v[244:251], v10 abid:1
    ds_read2st64_b32 v[244:245], v236 offset0:0 offset1:72
    ds_read_b128 v[240:243], v8 offset:8192
    v_xad_u32 v238, v238, v3, v4
    v_smfmac_f32_16x16x64_bf16 v[132:135], a[188:191], v[196:203], v33
    ds_read2st64_b32 v[246:247], v237 offset0:0 offset1:72
    ds_read_b128 v[184:187], v9 offset:10624
    v_xad_u32 v239, v239, v3, v4
    v_smfmac_f32_16x16x64_bf16 v[132:135], a[224:227], v[204:211], v37
    ds_read2st64_b32 v[248:249], v238 offset0:0 offset1:72
    ds_read_b128 v[176:179], v9 offset:10496
    v_smfmac_f32_16x16x64_bf16 v[136:139], a[192:195], v[196:203], v33 abid:1
    ds_read2st64_b32 v[250:251], v239 offset0:0 offset1:72
    ds_read_b128 v[236:239], v9 offset:9664
    v_smfmac_f32_16x16x64_bf16 v[136:139], a[228:231], v[204:211], v37 abid:1
    v_smfmac_f32_16x16x64_bf16 v[140:143], a[196:199], v[196:203], v34
    v_smfmac_f32_16x16x64_bf16 v[140:143], a[232:235], v[204:211], v38
    ds_read_b128 v[228:231], v1 offset:8192
    v_smfmac_f32_16x16x64_bf16 v[144:147], a[200:203], v[196:203], v34 abid:1
    ds_read_b128 v[232:235], v2 offset:8192
    v_smfmac_f32_16x16x64_bf16 v[144:147], a[236:239], v[204:211], v38 abid:1
    s_waitcnt lgkmcnt(4)
    s_cmp_lt_i32 s81, 0
    s_cbranch_scc1 M_ovrF
    s_swappc_b64 s[78:79], s[72:73]
M_ovrF:
    v_smfmac_f32_16x16x64_bf16 v[156:159], a[212:215], v[196:203], v50 abid:1
    v_smfmac_f32_16x16x64_bf16 v[156:159], a[248:251], v[204:211], v51
    s_waitcnt lgkmcnt(2)
    v_xad_u32 v236, v236, v3, v4
    v_smfmac_f32_16x16x64_bf16 v[156:159], v[240:243], v[244:251], v10
    v_xad_u32 v237, v237, v3, v4
    v_smfmac_f32_16x16x64_bf16 v[192:195], v[240:243], v[244:251], v10 abid:1
    ds_read2st64_b32 v[244:245], v236 offset0:0 offset1:72
    ds_read_b128 v[240:243], v8 offset:7168
    v_xad_u32 v238, v238, v3, v4
    v_smfmac_f32_16x16x64_bf16 v[152:155], a[208:211], v[196:203], v35 abid:1
    ds_read2st64_b32 v[246:247], v237 offset0:0 offset1:72
    v_xad_u32 v239, v239, v3, v4
    v_smfmac_f32_16x16x64_bf16 v[152:155], a[244:247], v[204:211], v39 abid:1
    ds_read2st64_b32 v[248:249], v238 offset0:0 offset1:72
    v_smfmac_f32_16x16x64_bf16 v[148:151], a[204:207], v[196:203], v35
    ds_read2st64_b32 v[250:251], v239 offset0:0 offset1:72
    ds_read_b128 v[236:239], v9 offset:9536
    v_smfmac_f32_16x16x64_bf16 v[148:151], a[240:243], v[204:211], v39
    v_smfmac_f32_16x16x64_bf16 v[124:127], a[252:255], v[220:227], v40
    s_waitcnt lgkmcnt(6)
    v_smfmac_f32_16x16x64_bf16 v[124:127], v[88:91], v[228:235], v44
    v_smfmac_f32_16x16x64_bf16 v[128:131], v[56:59], v[220:227], v40 abid:1
    v_smfmac_f32_16x16x64_bf16 v[128:131], v[92:95], v[228:235], v44 abid:1
    s_cmp_lt_u32 s20, 2
    s_cselect_b32 s66, s23, s24
    s_add_u32 s66, s66, s95
    v_smfmac_f32_16x16x64_bf16 v[132:135], v[60:63], v[220:227], v41
    ds_read_b128 v[196:199], v1 offset:18432
    s_add_u32 s23, s24, 18432
    s_add_u32 s58, s24, 27648
    v_smfmac_f32_16x16x64_bf16 v[132:135], v[96:99], v[228:235], v45
    ds_read_b128 v[200:203], v2 offset:18432
    s_add_u32 s67, s23, s95
    v_smfmac_f32_16x16x64_bf16 v[152:155], v[80:83], v[220:227], v43 abid:1
    ds_read_b128 v[204:207], v1 offset:19456
    v_smfmac_f32_16x16x64_bf16 v[152:155], v[116:119], v[228:235], v47 abid:1
    s_waitcnt lgkmcnt(3)
    v_xad_u32 v236, v236, v3, v4
    v_smfmac_f32_16x16x64_bf16 v[152:155], v[240:243], v[244:251], v10
    ds_read_b128 v[208:211], v2 offset:19456
    v_xad_u32 v237, v237, v3, v4
    v_smfmac_f32_16x16x64_bf16 v[188:191], v[240:243], v[244:251], v10 abid:1
    s_cmp_gt_u32 s46, s80
    s_cbranch_scc1 M_slow
M_slowrF:
    v_xad_u32 v238, v238, v3, v4
    v_smfmac_f32_16x16x64_bf16 v[140:143], v[68:71], v[220:227], v42
    ds_read2st64_b32 v[244:245], v236 offset0:0 offset1:72
    ds_read_b128 v[240:243], v8 offset:5120
    v_xad_u32 v239, v239, v3, v4
    v_smfmac_f32_16x16x64_bf16 v[140:143], v[104:107], v[228:235], v46
    ds_read2st64_b32 v[246:247], v237 offset0:0 offset1:72
    v_smfmac_f32_16x16x64_bf16 v[156:159], v[84:87], v[220:227], v51 abid:1
    ds_read2st64_b32 v[248:249], v238 offset0:0 offset1:72
    ds_read_b128 v[212:215], v1 offset:20480
    v_smfmac_f32_16x16x64_bf16 v[156:159], v[120:123], v[228:235], v52
    ds_read2st64_b32 v[250:251], v239 offset0:0 offset1:72
    ds_read_b128 v[236:239], v9 offset:9600
    v_smfmac_f32_16x16x64_bf16 v[148:151], v[76:79], v[220:227], v43
    ds_read_b128 v[216:219], v2 offset:20480
    v_smfmac_f32_16x16x64_bf16 v[148:151], v[112:115], v[228:235], v47
    v_smfmac_f32_16x16x64_bf16 v[136:139], v[64:67], v[220:227], v41 abid:1
    v_smfmac_f32_16x16x64_bf16 v[136:139], v[100:103], v[228:235], v45 abid:1
    v_smfmac_f32_16x16x64_bf16 v[144:147], v[72:75], v[220:227], v42 abid:1
    v_smfmac_f32_16x16x64_bf16 v[144:147], v[108:111], v[228:235], v46 abid:1
    ds_read_b128 v[220:223], v1 offset:21504
    s_waitcnt lgkmcnt(2)
    v_xad_u32 v236, v236, v3, v4
    v_smfmac_f32_16x16x64_bf16 v[144:147], v[240:243], v[244:251], v10
    ds_read_b128 v[224:227], v2 offset:21504
    v_xad_u32 v237, v237, v3, v4
    v_smfmac_f32_16x16x64_bf16 v[180:183], v[240:243], v[244:251], v10 abid:1
    ds_read2st64_b32 v[244:245], v236 offset0:0 offset1:72
    ds_read_b128 v[240:243], v8 offset:6144
    v_xad_u32 v238, v238, v3, v4
    v_smfmac_f32_16x16x64_bf16 v[192:195], a[32:35], v[196:203], v48
    ds_read2st64_b32 v[246:247], v237 offset0:0 offset1:72
    ds_read_b128 v[228:231], v1 offset:22528
    v_xad_u32 v239, v239, v3, v4
    v_smfmac_f32_16x16x64_bf16 v[192:195], a[68:71], v[204:211], v48 abid:1
    ds_read2st64_b32 v[248:249], v238 offset0:0 offset1:72
    ds_read_b128 v[232:235], v2 offset:22528
    s_waitcnt lgkmcnt(8)
    v_cvt_pk_bf16_f32 v124, v124, v125
    v_smfmac_f32_16x16x64_bf16 v[192:195], a[104:107], v[212:219], v49
    ds_read2st64_b32 v[250:251], v239 offset0:0 offset1:72
    ds_read_b128 v[236:239], v9 offset:9472
    v_cvt_pk_bf16_f32 v125, v126, v127
    v_smfmac_f32_16x16x64_bf16 v[160:163], a[0:3], v[196:203], v12
    v_cvt_pk_bf16_f32 v126, v128, v129
    v_smfmac_f32_16x16x64_bf16 v[160:163], a[36:39], v[204:211], v16
    v_cvt_pk_bf16_f32 v127, v130, v131
    v_smfmac_f32_16x16x64_bf16 v[160:163], a[72:75], v[212:219], v20
    v_cvt_pk_bf16_f32 v156, v156, v157
    v_smfmac_f32_16x16x64_bf16 v[164:167], a[4:7], v[196:203], v12 abid:1
    v_cvt_pk_bf16_f32 v157, v158, v159
    v_smfmac_f32_16x16x64_bf16 v[164:167], a[40:43], v[204:211], v16 abid:1
    ds_write_b64 v53, v[156:157] offset:25728
    v_cvt_pk_bf16_f32 v132, v132, v133
    v_smfmac_f32_16x16x64_bf16 v[164:167], a[76:79], v[212:219], v20 abid:1
    v_cvt_pk_bf16_f32 v133, v134, v135
    v_smfmac_f32_16x16x64_bf16 v[168:171], a[8:11], v[196:203], v13
    v_cvt_pk_bf16_f32 v134, v136, v137
    v_smfmac_f32_16x16x64_bf16 v[168:171], a[44:47], v[204:211], v17
    v_cvt_pk_bf16_f32 v135, v138, v139
    v_smfmac_f32_16x16x64_bf16 v[168:171], a[80:83], v[212:219], v21
    s_waitcnt lgkmcnt(1)
    v_xad_u32 v236, v236, v3, v4
    v_smfmac_f32_16x16x64_bf16 v[184:187], v[240:243], v[244:251], v10 abid:1
    v_xad_u32 v237, v237, v3, v4
    v_smfmac_f32_16x16x64_bf16 v[148:151], v[240:243], v[244:251], v10
    ds_read2st64_b32 v[244:245], v236 offset0:0 offset1:72
    ds_read_b128 v[240:243], v8 offset:4096
    v_xad_u32 v238, v238, v3, v4
    v_smfmac_f32_16x16x64_bf16 v[172:175], a[12:15], v[196:203], v13 abid:1
    ds_read2st64_b32 v[246:247], v237 offset0:0 offset1:72
    v_xad_u32 v239, v239, v3, v4
    v_smfmac_f32_16x16x64_bf16 v[172:175], a[48:51], v[204:211], v17 abid:1
    ds_read2st64_b32 v[248:249], v238 offset0:0 offset1:72
    v_cndmask_b32_dpp v128, v124, v132, vcc row_ror:8 row_mask:0xf bank_mask:0xf
    v_smfmac_f32_16x16x64_bf16 v[172:175], a[84:87], v[212:219], v21 abid:1
    ds_read2st64_b32 v[250:251], v239 offset0:0 offset1:72
    ds_read_b128 v[196:199], v1 offset:23552
    v_cndmask_b32_dpp v129, v125, v133, vcc row_ror:8 row_mask:0xf bank_mask:0xf
    v_smfmac_f32_16x16x64_bf16 v[192:195], a[140:143], v[220:227], v49 abid:1
    ds_read_b128 v[200:203], v2 offset:23552
    v_cndmask_b32_dpp v130, v126, v134, vcc row_ror:8 row_mask:0xf bank_mask:0xf
    v_smfmac_f32_16x16x64_bf16 v[192:195], a[176:179], v[228:235], v50
    ds_read_b128 v[204:207], v1 offset:24576
    v_cndmask_b32_dpp v131, v127, v135, vcc row_ror:8 row_mask:0xf bank_mask:0xf
    v_smfmac_f32_16x16x64_bf16 v[160:163], a[108:111], v[220:227], v24
    ds_read_b128 v[208:211], v2 offset:24576
    buffer_store_dwordx4 v[128:131], v6, s[12:15], s59 offen offset:0 sc1
    v_mov_b32_dpp v124, v132 row_ror:8 row_mask:0xf bank_mask:0xc
    v_smfmac_f32_16x16x64_bf16 v[160:163], a[144:147], v[228:235], v28
    s_waitcnt lgkmcnt(9)
    s_barrier
    ds_read_b128 v[236:239], v8 offset:10816
    v_mov_b32_dpp v125, v133 row_ror:8 row_mask:0xf bank_mask:0xc
    v_smfmac_f32_16x16x64_bf16 v[164:167], a[112:115], v[220:227], v24 abid:1
    ds_read_b128 v[212:215], v1 offset:20480
    v_mov_b32_dpp v126, v134 row_ror:8 row_mask:0xf bank_mask:0xc
    v_smfmac_f32_16x16x64_bf16 v[164:167], a[148:151], v[228:235], v28 abid:1
    ds_read_b128 v[216:219], v2 offset:20480
    v_mov_b32_dpp v127, v135 row_ror:8 row_mask:0xf bank_mask:0xc
    v_smfmac_f32_16x16x64_bf16 v[168:171], a[116:119], v[220:227], v25
    buffer_store_dwordx4 v[124:127], v6, s[12:15], s24 offen offset:0 sc1
    v_smfmac_f32_16x16x64_bf16 v[168:171], a[152:155], v[228:235], v29
    s_waitcnt lgkmcnt(7)
    v_smfmac_f32_16x16x64_bf16 v[176:179], v[240:243], v[244:251], v10 abid:1
    v_smfmac_f32_16x16x64_bf16 v[140:143], v[240:243], v[244:251], v10
    s_waitcnt lgkmcnt(2)
    buffer_store_dwordx4 v[236:239], v7, s[12:15], s66 offen sc1
    v_smfmac_f32_16x16x64_bf16 v[172:175], a[120:123], v[220:227], v25 abid:1
    v_smfmac_f32_16x16x64_bf16 v[172:175], a[156:159], v[228:235], v29 abid:1
    ds_read_b128 v[220:223], v1 offset:25600
    v_smfmac_f32_16x16x64_bf16 v[192:195], a[212:215], v[196:203], v50 abid:1
    ds_read_b128 v[224:227], v2 offset:25600
    s_nop 0
    v_cvt_pk_bf16_f32 v140, v140, v141
    v_smfmac_f32_16x16x64_bf16 v[192:195], a[248:251], v[204:211], v51
    ds_read_b128 v[228:231], v1 offset:26624
    v_cvt_pk_bf16_f32 v141, v142, v143
    v_smfmac_f32_16x16x64_bf16 v[160:163], a[180:183], v[196:203], v32
    ds_read_b128 v[232:235], v2 offset:26624
    v_cvt_pk_bf16_f32 v142, v144, v145
    v_smfmac_f32_16x16x64_bf16 v[160:163], a[216:219], v[204:211], v36
    v_cvt_pk_bf16_f32 v143, v146, v147
    v_smfmac_f32_16x16x64_bf16 v[164:167], a[184:187], v[196:203], v32 abid:1
    v_cvt_pk_bf16_f32 v148, v148, v149
    v_smfmac_f32_16x16x64_bf16 v[164:167], a[220:223], v[204:211], v36 abid:1
    v_cvt_pk_bf16_f32 v149, v150, v151
    v_smfmac_f32_16x16x64_bf16 v[168:171], a[188:191], v[196:203], v33
    v_cvt_pk_bf16_f32 v150, v152, v153
    v_smfmac_f32_16x16x64_bf16 v[168:171], a[224:227], v[204:211], v37
    v_cvt_pk_bf16_f32 v151, v154, v155
    v_smfmac_f32_16x16x64_bf16 v[172:175], a[192:195], v[196:203], v33 abid:1
    v_cndmask_b32_dpp v144, v140, v148, vcc row_ror:8 row_mask:0xf bank_mask:0xf
    v_smfmac_f32_16x16x64_bf16 v[172:175], a[228:231], v[204:211], v37 abid:1
    ds_read_b128 v[196:199], v1 offset:18432
    s_waitcnt lgkmcnt(3)
    v_cndmask_b32_dpp v145, v141, v149, vcc row_ror:8 row_mask:0xf bank_mask:0xf
    v_smfmac_f32_16x16x64_bf16 v[192:195], v[84:87], v[220:227], v51 abid:1
    ds_read_b128 v[200:203], v2 offset:18432
    s_waitcnt lgkmcnt(2)
    v_cndmask_b32_dpp v146, v142, v150, vcc row_ror:8 row_mask:0xf bank_mask:0xf
    v_smfmac_f32_16x16x64_bf16 v[192:195], v[120:123], v[228:235], v52
    ds_read_b128 v[204:207], v1 offset:19456
    v_cndmask_b32_dpp v147, v143, v151, vcc row_ror:8 row_mask:0xf bank_mask:0xf
    v_smfmac_f32_16x16x64_bf16 v[160:163], a[252:255], v[220:227], v40
    ds_read_b128 v[208:211], v2 offset:19456
    buffer_store_dwordx4 v[144:147], v6, s[12:15], s59 offen offset:128 sc1
    v_mov_b32_dpp v140, v148 row_ror:8 row_mask:0xf bank_mask:0xc
    v_smfmac_f32_16x16x64_bf16 v[160:163], v[88:91], v[228:235], v44
    v_mov_b32_dpp v141, v149 row_ror:8 row_mask:0xf bank_mask:0xc
    v_smfmac_f32_16x16x64_bf16 v[164:167], v[56:59], v[220:227], v40 abid:1
    v_mov_b32_dpp v142, v150 row_ror:8 row_mask:0xf bank_mask:0xc
    v_smfmac_f32_16x16x64_bf16 v[164:167], v[92:95], v[228:235], v44 abid:1
    v_mov_b32_dpp v143, v151 row_ror:8 row_mask:0xf bank_mask:0xc
    v_smfmac_f32_16x16x64_bf16 v[168:171], v[60:63], v[220:227], v41
    buffer_store_dwordx4 v[140:143], v6, s[12:15], s24 offen offset:128 sc1
    v_cvt_pk_bf16_f32 v192, v192, v193
    v_smfmac_f32_16x16x64_bf16 v[168:171], v[96:99], v[228:235], v45
    v_cvt_pk_bf16_f32 v193, v194, v195
    v_smfmac_f32_16x16x64_bf16 v[172:175], v[64:67], v[220:227], v41 abid:1
    ds_write_b64 v53, v[192:193] offset:1024
    v_smfmac_f32_16x16x64_bf16 v[172:175], v[100:103], v[228:235], v45 abid:1
    ds_read_b128 v[220:223], v1 offset:21504
    s_waitcnt lgkmcnt(4)
    v_smfmac_f32_16x16x64_bf16 v[176:179], a[16:19], v[196:203], v14
    ds_read_b128 v[224:227], v2 offset:21504
    s_waitcnt lgkmcnt(3)
    v_smfmac_f32_16x16x64_bf16 v[176:179], a[52:55], v[204:211], v18
    ds_read_b128 v[228:231], v1 offset:22528
    v_smfmac_f32_16x16x64_bf16 v[176:179], a[88:91], v[212:219], v22
    ds_read_b128 v[232:235], v2 offset:22528
    s_waitcnt lgkmcnt(4)
    s_barrier
    ds_read_b128 v[236:239], v8 offset:11840
    v_smfmac_f32_16x16x64_bf16 v[180:183], a[20:23], v[196:203], v14 abid:1
    v_cvt_pk_bf16_f32 v160, v160, v161
    v_smfmac_f32_16x16x64_bf16 v[180:183], a[56:59], v[204:211], v18 abid:1
    v_cvt_pk_bf16_f32 v161, v162, v163
    v_smfmac_f32_16x16x64_bf16 v[180:183], a[92:95], v[212:219], v22 abid:1
    v_cvt_pk_bf16_f32 v162, v164, v165
    v_smfmac_f32_16x16x64_bf16 v[184:187], a[24:27], v[196:203], v15
    v_cvt_pk_bf16_f32 v163, v166, v167
    v_smfmac_f32_16x16x64_bf16 v[184:187], a[60:63], v[204:211], v19
    v_cvt_pk_bf16_f32 v168, v168, v169
    v_smfmac_f32_16x16x64_bf16 v[184:187], a[96:99], v[212:219], v23
    s_cmp_lt_u32 s20, 2
    s_waitcnt lgkmcnt(0)
    s_cbranch_scc0 M_fx
    buffer_store_dwordx4 v[236:239], v7, s[12:15], s67 offen sc1
M_fx:
    v_smfmac_f32_16x16x64_bf16 v[188:191], a[28:31], v[196:203], v15 abid:1
    v_cvt_pk_bf16_f32 v169, v170, v171
    v_smfmac_f32_16x16x64_bf16 v[188:191], a[64:67], v[204:211], v19 abid:1
    v_cvt_pk_bf16_f32 v170, v172, v173
    v_smfmac_f32_16x16x64_bf16 v[188:191], a[100:103], v[212:219], v23 abid:1
    ds_read_b128 v[196:199], v1 offset:23552
    v_cvt_pk_bf16_f32 v171, v174, v175
    v_smfmac_f32_16x16x64_bf16 v[176:179], a[124:127], v[220:227], v26
    ds_read_b128 v[200:203], v2 offset:23552
    v_cndmask_b32_dpp v164, v160, v168, vcc row_ror:8 row_mask:0xf bank_mask:0xf
    v_smfmac_f32_16x16x64_bf16 v[176:179], a[160:163], v[228:235], v30
    ds_read_b128 v[204:207], v1 offset:24576
    v_cndmask_b32_dpp v165, v161, v169, vcc row_ror:8 row_mask:0xf bank_mask:0xf
    v_smfmac_f32_16x16x64_bf16 v[180:183], a[128:131], v[220:227], v26 abid:1
    ds_read_b128 v[208:211], v2 offset:24576
    v_cndmask_b32_dpp v166, v162, v170, vcc row_ror:8 row_mask:0xf bank_mask:0xf
    v_smfmac_f32_16x16x64_bf16 v[180:183], a[164:167], v[228:235], v30 abid:1
    v_cndmask_b32_dpp v167, v163, v171, vcc row_ror:8 row_mask:0xf bank_mask:0xf
    v_smfmac_f32_16x16x64_bf16 v[184:187], a[132:135], v[220:227], v27
    buffer_store_dwordx4 v[164:167], v6, s[12:15], s58 offen offset:0 sc1
    v_mov_b32_dpp v160, v168 row_ror:8 row_mask:0xf bank_mask:0xc
    v_smfmac_f32_16x16x64_bf16 v[184:187], a[168:171], v[228:235], v31
    v_mov_b32_dpp v161, v169 row_ror:8 row_mask:0xf bank_mask:0xc
    v_smfmac_f32_16x16x64_bf16 v[188:191], a[136:139], v[220:227], v27 abid:1
    v_mov_b32_dpp v162, v170 row_ror:8 row_mask:0xf bank_mask:0xc
    v_smfmac_f32_16x16x64_bf16 v[188:191], a[172:175], v[228:235], v31 abid:1
    ds_read_b128 v[220:223], v1 offset:25600
    s_waitcnt lgkmcnt(3)
    v_mov_b32_dpp v163, v171 row_ror:8 row_mask:0xf bank_mask:0xc
    v_smfmac_f32_16x16x64_bf16 v[176:179], a[196:199], v[196:203], v34
    ds_read_b128 v[224:227], v2 offset:25600
    buffer_store_dwordx4 v[160:163], v6, s[12:15], s23 offen offset:0 sc1
    s_waitcnt lgkmcnt(2)
    v_smfmac_f32_16x16x64_bf16 v[176:179], a[232:235], v[204:211], v38
    ds_read_b128 v[228:231], v1 offset:26624
    v_smfmac_f32_16x16x64_bf16 v[180:183], a[200:203], v[196:203], v34 abid:1
    ds_read_b128 v[232:235], v2 offset:26624
    v_smfmac_f32_16x16x64_bf16 v[180:183], a[236:239], v[204:211], v38 abid:1
    v_smfmac_f32_16x16x64_bf16 v[184:187], a[204:207], v[196:203], v35
    v_smfmac_f32_16x16x64_bf16 v[184:187], a[240:243], v[204:211], v39
    v_smfmac_f32_16x16x64_bf16 v[188:191], a[208:211], v[196:203], v35 abid:1
    v_smfmac_f32_16x16x64_bf16 v[188:191], a[244:247], v[204:211], v39 abid:1
    s_waitcnt lgkmcnt(2)
    v_smfmac_f32_16x16x64_bf16 v[176:179], v[68:71], v[220:227], v42
    s_waitcnt lgkmcnt(0)
    v_smfmac_f32_16x16x64_bf16 v[176:179], v[104:107], v[228:235], v46
    v_smfmac_f32_16x16x64_bf16 v[180:183], v[72:75], v[220:227], v42 abid:1
    v_smfmac_f32_16x16x64_bf16 v[180:183], v[108:111], v[228:235], v46 abid:1
    v_smfmac_f32_16x16x64_bf16 v[184:187], v[76:79], v[220:227], v43
    v_smfmac_f32_16x16x64_bf16 v[184:187], v[112:115], v[228:235], v47
    v_smfmac_f32_16x16x64_bf16 v[188:191], v[80:83], v[220:227], v43 abid:1
    v_smfmac_f32_16x16x64_bf16 v[188:191], v[116:119], v[228:235], v47 abid:1
    s_nop 1
    v_cvt_pk_bf16_f32 v176, v176, v177
    v_cvt_pk_bf16_f32 v177, v178, v179
    v_cvt_pk_bf16_f32 v178, v180, v181
    v_cvt_pk_bf16_f32 v179, v182, v183
    v_cvt_pk_bf16_f32 v184, v184, v185
    v_cvt_pk_bf16_f32 v185, v186, v187
    v_cvt_pk_bf16_f32 v186, v188, v189
    v_cvt_pk_bf16_f32 v187, v190, v191
    v_cndmask_b32_dpp v180, v176, v184, vcc row_ror:8 row_mask:0xf bank_mask:0xf
    v_cndmask_b32_dpp v181, v177, v185, vcc row_ror:8 row_mask:0xf bank_mask:0xf
    v_cndmask_b32_dpp v182, v178, v186, vcc row_ror:8 row_mask:0xf bank_mask:0xf
    v_cndmask_b32_dpp v183, v179, v187, vcc row_ror:8 row_mask:0xf bank_mask:0xf
    buffer_store_dwordx4 v[180:183], v6, s[12:15], s58 offen offset:128 sc1
    v_mov_b32_dpp v176, v184 row_ror:8 row_mask:0xf bank_mask:0xc
    v_mov_b32_dpp v177, v185 row_ror:8 row_mask:0xf bank_mask:0xc
    v_mov_b32_dpp v178, v186 row_ror:8 row_mask:0xf bank_mask:0xc
    v_mov_b32_dpp v179, v187 row_ror:8 row_mask:0xf bank_mask:0xc
    buffer_store_dwordx4 v[176:179], v6, s[12:15], s23 offen offset:128 sc1
M_done:
M_end:
    s_endpgm
M_pf_spin:
    s_sleep 4
    v_mov_b32 v0, 0
    s_mov_b64 exec, 1
    buffer_atomic_add v0, off, s[16:19], s96 sc0 sc1
    s_mov_b64 exec, -1
    s_add_u32 s31, s31, 1
    s_waitcnt vmcnt(0)
    v_readfirstlane_b32 s30, v0
    s_nop 0
    s_sub_u32 s30, s30, s100
    s_cmp_eq_u32 s30, 27
    s_cbranch_scc1 M_pf_ok
    s_cmp_lt_u32 s31, 6
    s_cbranch_scc1 M_pf_spin
    s_cmp_eq_u32 s98, 0
    s_cbranch_scc1 M_pf_spin2
    s_mov_b32 s98, 0
    v_mov_b32 v250, 1
    s_mov_b64 exec, 1
    buffer_atomic_add v250, off, s[68:71], 0 offset:0 sc1
    s_mov_b64 exec, -1
    s_nop 3
M_pf_spin2:
    buffer_load_dword v0, off, s[68:71], 0 offset:0 sc1
    s_cmp_ge_u32 s31, 131072
    s_cbranch_scc1 M_end
    s_waitcnt vmcnt(0)
    v_readfirstlane_b32 s30, v0
    s_nop 0
    s_cmp_eq_u32 s30, 81
    s_cbranch_scc0 M_pf_spin
    s_branch M_pf_ok
M_r3:
    v_bfe_u32 v110, v96, 24, 4
    v_lshlrev_b32 v111, 1, v96
    v_lshl_add_u32 v110, v110, 2, s49
    v_and_b32 v111, 16, v111
    v_and_or_b32 v110, v96, 2.0, v110
    v_lshlrev_b32 v111, v111, 1
    ds_add_rtn_u32 v100, v110, v111
    v_and_b32 v110, 8, v96
    v_lshrrev_b32 v113, 14, v96
    v_cmp_ne_u32 s[44:45], 0, v110
    v_and_b32 v116, 0x3cf0, v113
    s_waitcnt lgkmcnt(0)
    v_lshrrev_b32 v111, 16, v100
    v_and_b32 v112, 0xffff, v100
    v_sub_u32 v110, 15, v111
    v_and_b32 v100, 2.0, v96
    v_add3_u32 v100, v112, v111, v100
    v_cndmask_b32 v110, v112, v110, s[44:45]
    v_cmp_gt_u32 s[44:45], 16, v100
    v_cmp_gt_u32 s[36:37], 2.0, v100
    v_lshlrev_b32 v110, 2, v110
    v_lshrrev_b64 v[112:113], v110, s[50:51]
    s_andn2_b64 s[36:37], s[36:37], s[44:45]
    v_lshrrev_b64 v[114:115], v110, s[52:53]
    v_bfe_u32 v110, v96, 24, 4
    v_mbcnt_lo_u32_b32 v111, s36, 0
    v_and_b32 v112, 15, v112
    v_mbcnt_hi_u32_b32 v111, s37, v111
    v_and_b32 v114, 15, v114
    v_lshl_add_u32 v111, v111, 3, s40
    v_lshl_add_u32 v112, v110, 4, v112
    v_min_u32 v111, s41, v111
    v_mul_u32_u24 v114, 68, v114
    v_cndmask_b32 v111, v118, v111, s[36:37]
    ds_write_b64 v111, v[96:97]
    s_bcnt1_i32_b64 s30, s[36:37]
    s_lshl3_add_u32 s40, s30, s40
    v_lshl_add_u32 v112, v112, 2, s47
    v_and_b32 v114, 0x30c, v114
    v_cndmask_b32 v112, v118, v112, s[44:45]
    v_add3_u32 v113, v116, v114, s29
    v_and_b32 v114, 0x3fff, v96
    v_cndmask_b32 v110, v118, v113, s[44:45]
    ds_write_b32 v112, v114
    ds_write_b32 v110, v97
    s_cmp_gt_u32 s38, s39
    s_cselect_b32 s32, 1, s32
    s_branch M_r3r
M_dn:
    s_mov_b32 s27, 0
    s_mov_b32 s46, 0x80000000
    v_mov_b32 v244, 0
    v_mov_b32 v245, 0
    v_mov_b32 v246, 0
    v_mov_b32 v247, 0
    ds_write_b128 v8, v[244:247] offset:0
    ds_write_b128 v8, v[244:247] offset:1024
    ds_write_b128 v8, v[244:247] offset:2048
    ds_write_b128 v8, v[244:247] offset:3072
    ds_write_b128 v8, v[244:247] offset:4096
    ds_write_b128 v8, v[244:247] offset:5120
    ds_write_b128 v8, v[244:247] offset:6144
    ds_write_b128 v8, v[244:247] offset:7168
    ds_write_b128 v8, v[244:247] offset:8192
    s_waitcnt lgkmcnt(0)
    s_branch M_dnr
M_ovc0:
    v_smfmac_f32_16x16x32_bf16 v[124:127], v[54:55], v[212:215], v10
    v_smfmac_f32_16x16x32_bf16 v[160:163], v[54:55], v[212:215], v10 abid:2
    s_setpc_b64 s[74:75]
    v_smfmac_f32_16x16x32_bf16 v[128:131], v[54:55], v[212:215], v10
    v_smfmac_f32_16x16x32_bf16 v[164:167], v[54:55], v[212:215], v10 abid:2
    s_setpc_b64 s[74:75]
    v_smfmac_f32_16x16x32_bf16 v[132:135], v[54:55], v[212:215], v10
    v_smfmac_f32_16x16x32_bf16 v[168:171], v[54:55], v[212:215], v10 abid:2
    s_setpc_b64 s[74:75]
    v_smfmac_f32_16x16x32_bf16 v[136:139], v[54:55], v[212:215], v10
    v_smfmac_f32_16x16x32_bf16 v[172:175], v[54:55], v[212:215], v10 abid:2
    s_setpc_b64 s[74:75]
    v_smfmac_f32_16x16x32_bf16 v[140:143], v[54:55], v[212:215], v10
    v_smfmac_f32_16x16x32_bf16 v[176:179], v[54:55], v[212:215], v10 abid:2
    s_setpc_b64 s[74:75]
    v_smfmac_f32_16x16x32_bf16 v[144:147], v[54:55], v[212:215], v10
    v_smfmac_f32_16x16x32_bf16 v[180:183], v[54:55], v[212:215], v10 abid:2
    s_setpc_b64 s[74:75]
    v_smfmac_f32_16x16x32_bf16 v[148:151], v[54:55], v[212:215], v10
    v_smfmac_f32_16x16x32_bf16 v[184:187], v[54:55], v[212:215], v10 abid:2
    s_setpc_b64 s[74:75]
    v_smfmac_f32_16x16x32_bf16 v[152:155], v[54:55], v[212:215], v10
    v_smfmac_f32_16x16x32_bf16 v[188:191], v[54:55], v[212:215], v10 abid:2
    s_setpc_b64 s[74:75]
    v_smfmac_f32_16x16x32_bf16 v[156:159], v[54:55], v[212:215], v10
    v_smfmac_f32_16x16x32_bf16 v[192:195], v[54:55], v[212:215], v10 abid:2
    s_setpc_b64 s[74:75]
M_ovl0:
    v_smfmac_f32_16x16x32_bf16 v[124:127], v[54:55], v[212:215], v10
    v_smfmac_f32_16x16x32_bf16 v[160:163], v[54:55], v[212:215], v10 abid:2
    s_setpc_b64 s[78:79]
    v_smfmac_f32_16x16x32_bf16 v[128:131], v[54:55], v[212:215], v10
    v_smfmac_f32_16x16x32_bf16 v[164:167], v[54:55], v[212:215], v10 abid:2
    s_setpc_b64 s[78:79]
    v_smfmac_f32_16x16x32_bf16 v[132:135], v[54:55], v[212:215], v10
    v_smfmac_f32_16x16x32_bf16 v[168:171], v[54:55], v[212:215], v10 abid:2
    s_setpc_b64 s[78:79]
    v_smfmac_f32_16x16x32_bf16 v[136:139], v[54:55], v[212:215], v10
    v_smfmac_f32_16x16x32_bf16 v[172:175], v[54:55], v[212:215], v10 abid:2
    s_setpc_b64 s[78:79]
    v_smfmac_f32_16x16x32_bf16 v[140:143], v[54:55], v[212:215], v10
    v_smfmac_f32_16x16x32_bf16 v[176:179], v[54:55], v[212:215], v10 abid:2
    s_setpc_b64 s[78:79]
    v_smfmac_f32_16x16x32_bf16 v[144:147], v[54:55], v[212:215], v10
    v_smfmac_f32_16x16x32_bf16 v[180:183], v[54:55], v[212:215], v10 abid:2
    s_setpc_b64 s[78:79]
    v_smfmac_f32_16x16x32_bf16 v[148:151], v[54:55], v[212:215], v10
    v_smfmac_f32_16x16x32_bf16 v[184:187], v[54:55], v[212:215], v10 abid:2
    s_setpc_b64 s[78:79]
    v_smfmac_f32_16x16x32_bf16 v[152:155], v[54:55], v[212:215], v10
    v_smfmac_f32_16x16x32_bf16 v[188:191], v[54:55], v[212:215], v10 abid:2
    s_setpc_b64 s[78:79]
    v_smfmac_f32_16x16x32_bf16 v[156:159], v[54:55], v[212:215], v10
    v_smfmac_f32_16x16x32_bf16 v[192:195], v[54:55], v[212:215], v10 abid:2
    s_setpc_b64 s[78:79]
M_ovc1:
    v_smfmac_f32_16x16x32_bf16 v[124:127], v[252:253], v[212:215], v10
    v_smfmac_f32_16x16x32_bf16 v[160:163], v[252:253], v[212:215], v10 abid:2
    s_setpc_b64 s[76:77]
    v_smfmac_f32_16x16x32_bf16 v[128:131], v[252:253], v[212:215], v10
    v_smfmac_f32_16x16x32_bf16 v[164:167], v[252:253], v[212:215], v10 abid:2
    s_setpc_b64 s[76:77]
    v_smfmac_f32_16x16x32_bf16 v[132:135], v[252:253], v[212:215], v10
    v_smfmac_f32_16x16x32_bf16 v[168:171], v[252:253], v[212:215], v10 abid:2
    s_setpc_b64 s[76:77]
    v_smfmac_f32_16x16x32_bf16 v[136:139], v[252:253], v[212:215], v10
    v_smfmac_f32_16x16x32_bf16 v[172:175], v[252:253], v[212:215], v10 abid:2
    s_setpc_b64 s[76:77]
    v_smfmac_f32_16x16x32_bf16 v[140:143], v[252:253], v[212:215], v10
    v_smfmac_f32_16x16x32_bf16 v[176:179], v[252:253], v[212:215], v10 abid:2
    s_setpc_b64 s[76:77]
    v_smfmac_f32_16x16x32_bf16 v[144:147], v[252:253], v[212:215], v10
    v_smfmac_f32_16x16x32_bf16 v[180:183], v[252:253], v[212:215], v10 abid:2
    s_setpc_b64 s[76:77]
    v_smfmac_f32_16x16x32_bf16 v[148:151], v[252:253], v[212:215], v10
    v_smfmac_f32_16x16x32_bf16 v[184:187], v[252:253], v[212:215], v10 abid:2
    s_setpc_b64 s[76:77]
    v_smfmac_f32_16x16x32_bf16 v[152:155], v[252:253], v[212:215], v10
    v_smfmac_f32_16x16x32_bf16 v[188:191], v[252:253], v[212:215], v10 abid:2
    s_setpc_b64 s[76:77]
    v_smfmac_f32_16x16x32_bf16 v[156:159], v[252:253], v[212:215], v10
    v_smfmac_f32_16x16x32_bf16 v[192:195], v[252:253], v[212:215], v10 abid:2
    s_setpc_b64 s[76:77]
M_ovl1:
    v_smfmac_f32_16x16x32_bf16 v[124:127], v[252:253], v[212:215], v10
    v_smfmac_f32_16x16x32_bf16 v[160:163], v[252:253], v[212:215], v10 abid:2
    s_setpc_b64 s[78:79]
    v_smfmac_f32_16x16x32_bf16 v[128:131], v[252:253], v[212:215], v10
    v_smfmac_f32_16x16x32_bf16 v[164:167], v[252:253], v[212:215], v10 abid:2
    s_setpc_b64 s[78:79]
    v_smfmac_f32_16x16x32_bf16 v[132:135], v[252:253], v[212:215], v10
    v_smfmac_f32_16x16x32_bf16 v[168:171], v[252:253], v[212:215], v10 abid:2
    s_setpc_b64 s[78:79]
    v_smfmac_f32_16x16x32_bf16 v[136:139], v[252:253], v[212:215], v10
    v_smfmac_f32_16x16x32_bf16 v[172:175], v[252:253], v[212:215], v10 abid:2
    s_setpc_b64 s[78:79]
    v_smfmac_f32_16x16x32_bf16 v[140:143], v[252:253], v[212:215], v10
    v_smfmac_f32_16x16x32_bf16 v[176:179], v[252:253], v[212:215], v10 abid:2
    s_setpc_b64 s[78:79]
    v_smfmac_f32_16x16x32_bf16 v[144:147], v[252:253], v[212:215], v10
    v_smfmac_f32_16x16x32_bf16 v[180:183], v[252:253], v[212:215], v10 abid:2
    s_setpc_b64 s[78:79]
    v_smfmac_f32_16x16x32_bf16 v[148:151], v[252:253], v[212:215], v10
    v_smfmac_f32_16x16x32_bf16 v[184:187], v[252:253], v[212:215], v10 abid:2
    s_setpc_b64 s[78:79]
    v_smfmac_f32_16x16x32_bf16 v[152:155], v[252:253], v[212:215], v10
    v_smfmac_f32_16x16x32_bf16 v[188:191], v[252:253], v[212:215], v10 abid:2
    s_setpc_b64 s[78:79]
    v_smfmac_f32_16x16x32_bf16 v[156:159], v[252:253], v[212:215], v10
    v_smfmac_f32_16x16x32_bf16 v[192:195], v[252:253], v[212:215], v10 abid:2
    s_setpc_b64 s[78:79]
M_ovl2:
    v_smfmac_f32_16x16x32_bf16 v[124:127], v[254:255], v[212:215], v10
    v_smfmac_f32_16x16x32_bf16 v[160:163], v[254:255], v[212:215], v10 abid:2
    s_setpc_b64 s[78:79]
    v_smfmac_f32_16x16x32_bf16 v[128:131], v[254:255], v[212:215], v10
    v_smfmac_f32_16x16x32_bf16 v[164:167], v[254:255], v[212:215], v10 abid:2
    s_setpc_b64 s[78:79]
    v_smfmac_f32_16x16x32_bf16 v[132:135], v[254:255], v[212:215], v10
    v_smfmac_f32_16x16x32_bf16 v[168:171], v[254:255], v[212:215], v10 abid:2
    s_setpc_b64 s[78:79]
    v_smfmac_f32_16x16x32_bf16 v[136:139], v[254:255], v[212:215], v10
    v_smfmac_f32_16x16x32_bf16 v[172:175], v[254:255], v[212:215], v10 abid:2
    s_setpc_b64 s[78:79]
    v_smfmac_f32_16x16x32_bf16 v[140:143], v[254:255], v[212:215], v10
    v_smfmac_f32_16x16x32_bf16 v[176:179], v[254:255], v[212:215], v10 abid:2
    s_setpc_b64 s[78:79]
    v_smfmac_f32_16x16x32_bf16 v[144:147], v[254:255], v[212:215], v10
    v_smfmac_f32_16x16x32_bf16 v[180:183], v[254:255], v[212:215], v10 abid:2
    s_setpc_b64 s[78:79]
    v_smfmac_f32_16x16x32_bf16 v[148:151], v[254:255], v[212:215], v10
    v_smfmac_f32_16x16x32_bf16 v[184:187], v[254:255], v[212:215], v10 abid:2
    s_setpc_b64 s[78:79]
    v_smfmac_f32_16x16x32_bf16 v[152:155], v[254:255], v[212:215], v10
    v_smfmac_f32_16x16x32_bf16 v[188:191], v[254:255], v[212:215], v10 abid:2
    s_setpc_b64 s[78:79]
    v_smfmac_f32_16x16x32_bf16 v[156:159], v[254:255], v[212:215], v10
    v_smfmac_f32_16x16x32_bf16 v[192:195], v[254:255], v[212:215], v10 abid:2
    s_setpc_b64 s[78:79]
M_ovn:
    s_setpc_b64 s[78:79]
M_slow:
    s_bitcmp1_b32 s46, 31
    s_cbranch_scc1 M_dense
    s_mov_b32 s56, s80
M_sl:
    s_lshl_b32 s57, s56, 6
    v_add_u32 v240, s57, v9
    ds_read_b128 v[248:251], v240 offset:9792
    s_waitcnt lgkmcnt(0)
    v_and_b32 v240, 0x3fff, v248
    v_and_b32 v241, 0x3fff, v250
    v_xad_u32 v240, v240, v3, v4
    v_xad_u32 v241, v241, v3, v4
    ds_read2st64_b32 v[244:245], v240 offset0:0 offset1:72
    ds_read2st64_b32 v[246:247], v241 offset0:0 offset1:72
    v_subrev_u32 v240, s29, v8
    v_bfe_u32 v240, v240, 4, 4
    s_waitcnt lgkmcnt(0)
    s_bitcmp1_b32 s27, 0
    s_cbranch_scc0 M_sle0
    v_lshrrev_b32 v242, 18, v248
    v_lshrrev_b32 v243, 18, v250
    v_or_b32 v241, 0, v240
    v_cmp_eq_u32 s[44:45], v242, v241
    v_cmp_eq_u32 s[54:55], v243, v241
    s_nop 0
    v_cndmask_b32 v242, 0, v249, s[44:45]
    v_cndmask_b32 v243, 0, v251, s[54:55]
    s_nop 1
    v_smfmac_f32_16x16x32_bf16 v[124:127], v[242:243], v[244:247], v10
    v_smfmac_f32_16x16x32_bf16 v[160:163], v[242:243], v[244:247], v10 abid:2
M_sle0:
    s_bitcmp1_b32 s27, 1
    s_cbranch_scc0 M_sle1
    v_lshrrev_b32 v242, 18, v248
    v_lshrrev_b32 v243, 18, v250
    v_or_b32 v241, 64, v240
    v_cmp_eq_u32 s[44:45], v242, v241
    v_cmp_eq_u32 s[54:55], v243, v241
    s_nop 0
    v_cndmask_b32 v242, 0, v249, s[44:45]
    v_cndmask_b32 v243, 0, v251, s[54:55]
    s_nop 1
    v_smfmac_f32_16x16x32_bf16 v[128:131], v[242:243], v[244:247], v10
    v_smfmac_f32_16x16x32_bf16 v[164:167], v[242:243], v[244:247], v10 abid:2
M_sle1:
    s_bitcmp1_b32 s27, 2
    s_cbranch_scc0 M_sle2
    v_lshrrev_b32 v242, 18, v248
    v_lshrrev_b32 v243, 18, v250
    v_or_b32 v241, 128, v240
    v_cmp_eq_u32 s[44:45], v242, v241
    v_cmp_eq_u32 s[54:55], v243, v241
    s_nop 0
    v_cndmask_b32 v242, 0, v249, s[44:45]
    v_cndmask_b32 v243, 0, v251, s[54:55]
    s_nop 1
    v_smfmac_f32_16x16x32_bf16 v[132:135], v[242:243], v[244:247], v10
    v_smfmac_f32_16x16x32_bf16 v[168:171], v[242:243], v[244:247], v10 abid:2
M_sle2:
    s_bitcmp1_b32 s27, 3
    s_cbranch_scc0 M_sle3
    v_lshrrev_b32 v242, 18, v248
    v_lshrrev_b32 v243, 18, v250
    v_or_b32 v241, 192, v240
    v_cmp_eq_u32 s[44:45], v242, v241
    v_cmp_eq_u32 s[54:55], v243, v241
    s_nop 0
    v_cndmask_b32 v242, 0, v249, s[44:45]
    v_cndmask_b32 v243, 0, v251, s[54:55]
    s_nop 1
    v_smfmac_f32_16x16x32_bf16 v[136:139], v[242:243], v[244:247], v10
    v_smfmac_f32_16x16x32_bf16 v[172:175], v[242:243], v[244:247], v10 abid:2
M_sle3:
    s_bitcmp1_b32 s27, 4
    s_cbranch_scc0 M_sle4
    v_lshrrev_b32 v242, 18, v248
    v_lshrrev_b32 v243, 18, v250
    v_or_b32 v241, 256, v240
    v_cmp_eq_u32 s[44:45], v242, v241
    v_cmp_eq_u32 s[54:55], v243, v241
    s_nop 0
    v_cndmask_b32 v242, 0, v249, s[44:45]
    v_cndmask_b32 v243, 0, v251, s[54:55]
    s_nop 1
    v_smfmac_f32_16x16x32_bf16 v[140:143], v[242:243], v[244:247], v10
    v_smfmac_f32_16x16x32_bf16 v[176:179], v[242:243], v[244:247], v10 abid:2
M_sle4:
    s_bitcmp1_b32 s27, 5
    s_cbranch_scc0 M_sle5
    v_lshrrev_b32 v242, 18, v248
    v_lshrrev_b32 v243, 18, v250
    v_or_b32 v241, 320, v240
    v_cmp_eq_u32 s[44:45], v242, v241
    v_cmp_eq_u32 s[54:55], v243, v241
    s_nop 0
    v_cndmask_b32 v242, 0, v249, s[44:45]
    v_cndmask_b32 v243, 0, v251, s[54:55]
    s_nop 1
    v_smfmac_f32_16x16x32_bf16 v[144:147], v[242:243], v[244:247], v10
    v_smfmac_f32_16x16x32_bf16 v[180:183], v[242:243], v[244:247], v10 abid:2
M_sle5:
    s_bitcmp1_b32 s27, 6
    s_cbranch_scc0 M_sle6
    v_lshrrev_b32 v242, 18, v248
    v_lshrrev_b32 v243, 18, v250
    v_or_b32 v241, 384, v240
    v_cmp_eq_u32 s[44:45], v242, v241
    v_cmp_eq_u32 s[54:55], v243, v241
    s_nop 0
    v_cndmask_b32 v242, 0, v249, s[44:45]
    v_cndmask_b32 v243, 0, v251, s[54:55]
    s_nop 1
    v_smfmac_f32_16x16x32_bf16 v[148:151], v[242:243], v[244:247], v10
    v_smfmac_f32_16x16x32_bf16 v[184:187], v[242:243], v[244:247], v10 abid:2
M_sle6:
    s_bitcmp1_b32 s27, 7
    s_cbranch_scc0 M_sle7
    v_lshrrev_b32 v242, 18, v248
    v_lshrrev_b32 v243, 18, v250
    v_or_b32 v241, 448, v240
    v_cmp_eq_u32 s[44:45], v242, v241
    v_cmp_eq_u32 s[54:55], v243, v241
    s_nop 0
    v_cndmask_b32 v242, 0, v249, s[44:45]
    v_cndmask_b32 v243, 0, v251, s[54:55]
    s_nop 1
    v_smfmac_f32_16x16x32_bf16 v[152:155], v[242:243], v[244:247], v10
    v_smfmac_f32_16x16x32_bf16 v[188:191], v[242:243], v[244:247], v10 abid:2
M_sle7:
    s_bitcmp1_b32 s27, 8
    s_cbranch_scc0 M_sle8
    v_lshrrev_b32 v242, 18, v248
    v_lshrrev_b32 v243, 18, v250
    v_or_b32 v241, 512, v240
    v_cmp_eq_u32 s[44:45], v242, v241
    v_cmp_eq_u32 s[54:55], v243, v241
    s_nop 0
    v_cndmask_b32 v242, 0, v249, s[44:45]
    v_cndmask_b32 v243, 0, v251, s[54:55]
    s_nop 1
    v_smfmac_f32_16x16x32_bf16 v[156:159], v[242:243], v[244:247], v10
    v_smfmac_f32_16x16x32_bf16 v[192:195], v[242:243], v[244:247], v10 abid:2
M_sle8:
    s_add_u32 s56, s56, 1
    s_cmp_lt_u32 s56, s46
    s_cbranch_scc1 M_sl
M_slx:
    s_nop 7
    s_cmp_eq_u32 s21, 1
    s_cbranch_scc1 M_slowrL
    s_cmp_eq_u32 s21, 2
    s_cbranch_scc1 M_slowrE0
    s_cmp_eq_u32 s21, 3
    s_cbranch_scc1 M_slowrQ
    s_cmp_eq_u32 s21, 4
    s_cbranch_scc1 M_slowrF
    s_cmp_eq_u32 s21, 5
    s_cbranch_scc1 M_slowrH
    s_branch M_slowr0
M_dense:
    s_mul_i32 s57, s20, 82944
    s_add_u32 s57, s57, 393216
    s_mov_b32 s56, 0
    v_mov_b32 v54, v1
    v_mov_b32 v55, v2
    v_subrev_u32 v252, s29, v8
M_dn0:
    ds_read_b128 v[244:247], v54 offset:0
    ds_read_b128 v[248:251], v55 offset:0
    v_add_u32 v54, 1024, v54
    v_add_u32 v55, 1024, v55
    buffer_load_dwordx4 v[240:243], v252, s[16:19], s57 offen sc1
    s_add_u32 s57, s57, 1024
    s_waitcnt vmcnt(0) lgkmcnt(0)
    v_smfmac_f32_16x16x64_bf16 v[124:127], v[240:243], v[244:251], v10
    buffer_load_dwordx4 v[240:243], v252, s[16:19], s57 offen sc1
    s_add_u32 s57, s57, 1024
    s_waitcnt vmcnt(0) lgkmcnt(0)
    v_smfmac_f32_16x16x64_bf16 v[128:131], v[240:243], v[244:251], v10
    buffer_load_dwordx4 v[240:243], v252, s[16:19], s57 offen sc1
    s_add_u32 s57, s57, 1024
    s_waitcnt vmcnt(0) lgkmcnt(0)
    v_smfmac_f32_16x16x64_bf16 v[132:135], v[240:243], v[244:251], v10
    buffer_load_dwordx4 v[240:243], v252, s[16:19], s57 offen sc1
    s_add_u32 s57, s57, 1024
    s_waitcnt vmcnt(0) lgkmcnt(0)
    v_smfmac_f32_16x16x64_bf16 v[136:139], v[240:243], v[244:251], v10
    buffer_load_dwordx4 v[240:243], v252, s[16:19], s57 offen sc1
    s_add_u32 s57, s57, 1024
    s_waitcnt vmcnt(0) lgkmcnt(0)
    v_smfmac_f32_16x16x64_bf16 v[140:143], v[240:243], v[244:251], v10
    buffer_load_dwordx4 v[240:243], v252, s[16:19], s57 offen sc1
    s_add_u32 s57, s57, 1024
    s_waitcnt vmcnt(0) lgkmcnt(0)
    v_smfmac_f32_16x16x64_bf16 v[144:147], v[240:243], v[244:251], v10
    buffer_load_dwordx4 v[240:243], v252, s[16:19], s57 offen sc1
    s_add_u32 s57, s57, 1024
    s_waitcnt vmcnt(0) lgkmcnt(0)
    v_smfmac_f32_16x16x64_bf16 v[148:151], v[240:243], v[244:251], v10
    buffer_load_dwordx4 v[240:243], v252, s[16:19], s57 offen sc1
    s_add_u32 s57, s57, 1024
    s_waitcnt vmcnt(0) lgkmcnt(0)
    v_smfmac_f32_16x16x64_bf16 v[152:155], v[240:243], v[244:251], v10
    buffer_load_dwordx4 v[240:243], v252, s[16:19], s57 offen sc1
    s_add_u32 s57, s57, 1024
    s_waitcnt vmcnt(0) lgkmcnt(0)
    v_smfmac_f32_16x16x64_bf16 v[156:159], v[240:243], v[244:251], v10
    s_add_u32 s56, s56, 1
    s_cmp_lt_u32 s56, 9
    s_cbranch_scc1 M_dn0
    s_mul_i32 s57, s20, 82944
    s_add_u32 s57, s57, 393216
    s_mov_b32 s56, 0
    v_mov_b32 v54, v1
    v_mov_b32 v55, v2
    v_subrev_u32 v252, s29, v8
M_dn1:
    ds_read_b128 v[244:247], v54 offset:18432
    ds_read_b128 v[248:251], v55 offset:18432
    v_add_u32 v54, 1024, v54
    v_add_u32 v55, 1024, v55
    buffer_load_dwordx4 v[240:243], v252, s[16:19], s57 offen sc1
    s_add_u32 s57, s57, 1024
    s_waitcnt vmcnt(0) lgkmcnt(0)
    v_smfmac_f32_16x16x64_bf16 v[160:163], v[240:243], v[244:251], v10
    buffer_load_dwordx4 v[240:243], v252, s[16:19], s57 offen sc1
    s_add_u32 s57, s57, 1024
    s_waitcnt vmcnt(0) lgkmcnt(0)
    v_smfmac_f32_16x16x64_bf16 v[164:167], v[240:243], v[244:251], v10
    buffer_load_dwordx4 v[240:243], v252, s[16:19], s57 offen sc1
    s_add_u32 s57, s57, 1024
    s_waitcnt vmcnt(0) lgkmcnt(0)
    v_smfmac_f32_16x16x64_bf16 v[168:171], v[240:243], v[244:251], v10
    buffer_load_dwordx4 v[240:243], v252, s[16:19], s57 offen sc1
    s_add_u32 s57, s57, 1024
    s_waitcnt vmcnt(0) lgkmcnt(0)
    v_smfmac_f32_16x16x64_bf16 v[172:175], v[240:243], v[244:251], v10
    buffer_load_dwordx4 v[240:243], v252, s[16:19], s57 offen sc1
    s_add_u32 s57, s57, 1024
    s_waitcnt vmcnt(0) lgkmcnt(0)
    v_smfmac_f32_16x16x64_bf16 v[176:179], v[240:243], v[244:251], v10
    buffer_load_dwordx4 v[240:243], v252, s[16:19], s57 offen sc1
    s_add_u32 s57, s57, 1024
    s_waitcnt vmcnt(0) lgkmcnt(0)
    v_smfmac_f32_16x16x64_bf16 v[180:183], v[240:243], v[244:251], v10
    buffer_load_dwordx4 v[240:243], v252, s[16:19], s57 offen sc1
    s_add_u32 s57, s57, 1024
    s_waitcnt vmcnt(0) lgkmcnt(0)
    v_smfmac_f32_16x16x64_bf16 v[184:187], v[240:243], v[244:251], v10
    buffer_load_dwordx4 v[240:243], v252, s[16:19], s57 offen sc1
    s_add_u32 s57, s57, 1024
    s_waitcnt vmcnt(0) lgkmcnt(0)
    v_smfmac_f32_16x16x64_bf16 v[188:191], v[240:243], v[244:251], v10
    buffer_load_dwordx4 v[240:243], v252, s[16:19], s57 offen sc1
    s_add_u32 s57, s57, 1024
    s_waitcnt vmcnt(0) lgkmcnt(0)
    v_smfmac_f32_16x16x64_bf16 v[192:195], v[240:243], v[244:251], v10
    s_add_u32 s56, s56, 1
    s_cmp_lt_u32 s56, 9
    s_cbranch_scc1 M_dn1
    s_branch M_slx
M_codeend:
.section .rodata,"a"
.p2align 6
.amdhsa_kernel standalone__structured_sparse_n_m__ragged_kernel
  .amdhsa_next_free_vgpr 512
  .amdhsa_next_free_sgpr 102
  .amdhsa_accum_offset 256
  .amdhsa_group_segment_fixed_size 0
  .amdhsa_kernarg_size 48
  .amdhsa_user_sgpr_count 2
  .amdhsa_user_sgpr_kernarg_segment_ptr 1
  .amdhsa_system_sgpr_workgroup_id_x 1
  .amdhsa_float_denorm_mode_32 3
.end_amdhsa_kernel
```

```asm
; @launch grid=(256,1,1) block=(256,1,1) lds=162064
.amdgcn_target "amdgcn-amd-amdhsa--gfx950"
.text
.globl standalone__structured_sparse_n_m__ragged_kernel
.p2align 8
.type standalone__structured_sparse_n_m__ragged_kernel,@function
standalone__structured_sparse_n_m__ragged_kernel:
    s_cmp_ge_u32 s2, 256
    s_cbranch_scc1 M_end
    s_load_dwordx8 s[72:79], s[0:1], 0
    s_load_dwordx4 s[80:83], s[0:1], 32
    s_getpc_b64 s[84:85]
    s_lshr_b32 s30, s2, 3
    s_and_b32 s30, s30, 15
    s_lshl_b32 s30, s30, 11
    s_and_b32 s84, s84, 0xffffff00
    s_cmp_ge_u32 s2, 88
    s_cselect_b32 s86, M_codeend-standalone__structured_sparse_n_m__ragged_kernel, 0
    s_mov_b32 s87, 0x20000
    v_lshlrev_b32 v254, 3, v0
    s_mov_b32 exec_lo, 0x00010001
    s_mov_b32 exec_hi, 0x00010001
    buffer_load_dword v254, v254, s[84:87], s30 offen
    s_mov_b64 exec, -1
    v_lshrrev_b32 v20, 6, v0
    v_and_b32 v12, 63, v0
    v_readfirstlane_b32 s20, v20
    v_lshrrev_b32 v22, 3, v0
    v_mul_u32_u24 v22, 1152, v22
    v_lshrrev_b32 v23, 4, v0
    v_xor_b32 v23, v23, v0
    v_and_b32 v23, 7, v23
    v_lshl_add_u32 v5, v23, 4, v22
    v_lshrrev_b32 v13, 4, v12
    v_and_b32 v14, 15, v12
    v_lshlrev_b32 v11, 4, v12
    v_lshlrev_b32 v54, 3, v12
    v_lshlrev_b32 v25, 4, v13
    v_lshlrev_b32 v26, 3, v13
    s_mov_b32 s6, 663552
    s_mov_b32 s7, 0x20000
    s_mov_b32 s10, 75497472
    s_mov_b32 s11, s7
    s_mov_b32 s18, 791552
    s_mov_b32 s19, s7
    s_movk_i32 s70, 256
    s_mov_b32 s71, s7
    s_movk_i32 s86, 1152
    s_mov_b32 s87, s7
    s_mov_b32 s98, 0
    s_mul_i32 s96, s20, 16
    s_and_b32 s97, s2, 15
    s_add_u32 s96, s96, s97
    s_lshl_b32 s96, s96, 8
    s_add_u32 s96, s96, 726016
    s_mul_i32 s22, s2, 36864
    s_mul_i32 s26, s20, 9216
    s_mov_b32 s24, s22
    s_mov_b32 s42, s26
    s_lshl_b32 s28, s20, 8
    s_lshl_b32 s97, s20, 5
    s_cmp_lt_u32 s2, 81
    s_cbranch_scc0 M_x1
    s_mul_i32 s32, s2, 57
    s_lshr_b32 s32, s32, 9
    s_mul_i32 s33, s32, 9
    s_sub_u32 s33, s2, s33
    s_mul_i32 s54, s32, 73728
    s_lshl_b32 s35, s33, 7
    s_add_u32 s54, s54, s35
    s_add_u32 s55, s54, 36864
    s_lshl_b32 s36, s20, 10
    s_add_u32 m0, s36, 73728
    s_lshr_b32 s30, s33, 1
    s_and_b32 s31, s33, 1
    s_lshl1_add_u32 s37, s32, s31
    s_mul_i32 s37, s37, 176
    s_mul_i32 s38, s32, 96
    s_add_u32 s38, s38, 3168
    s_cmp_lt_u32 s33, 8
    s_cselect_b32 s30, s30, s20
    s_cselect_b32 s37, s37, s38
    s_cselect_b32 s44, 2047, 63
    s_cselect_b32 s45, s20, 3
    s_cmp_eq_u32 s45, 3
    s_cselect_b32 s99, 791552, 0
    s_mul_i32 s48, s30, 98304
    s_add_u32 s37, s37, s48
    v_mov_b32 v44, 2.0
    v_mov_b32 v45, 0
    v_mov_b32 v46, 2.0
    v_mov_b32 v47, 0
    s_waitcnt lgkmcnt(0)
    s_mov_b64 s[4:5], s[74:75]
    buffer_load_dwordx4 v5, s[4:7], s54 offen lds
    s_add_u32 m0, m0, 4096
    s_mov_b32 s45, 0
    buffer_load_dwordx4 v5, s[4:7], s55 offen lds
    s_mov_b64 s[16:17], s[82:83]
    s_mov_b64 s[8:9], s[72:73]
    s_mov_b64 s[84:85], s[76:77]
    s_mov_b64 s[68:69], s[80:81]
    v_mov_b32 v10, 0
    s_mov_b64 exec, 1
    buffer_atomic_add v10, off, s[16:19], s96 sc0 sc1
    s_mov_b64 exec, -1
    s_mov_b64 exec, s[44:45]
    s_mov_b32 s18, s99
    buffer_store_dwordx4 v[44:47], v11, s[16:19], s37 offen sc1
    s_mov_b32 s18, 791552
    s_mov_b64 exec, -1
    s_mov_b32 m0, s42
    s_nop 0
    buffer_load_dwordx4 v5, s[8:11], s22 offen offset:0 nt lds
    s_add_u32 m0, m0, 896
    s_nop 0
    buffer_load_dwordx4 v5, s[8:11], s22 offen offset:128 nt lds
    s_add_u32 m0, m0, 896
    s_nop 0
    buffer_load_dwordx4 v5, s[8:11], s22 offen offset:256 nt lds
    s_lshl_b32 s34, s31, 2
    s_add_u32 s34, s34, s20
    s_lshr_b32 s35, s20, 1
    s_lshl_b32 s35, s35, 6
    s_and_b32 s36, s20, 1
    s_lshl_b32 s36, s36, 3
    s_add_u32 s35, s35, s36
    s_lshl_b32 s36, s20, 5
    s_mul_i32 s39, s32, 10240
    s_add_u32 s39, s39, 6144
    s_lshl_b32 s40, s34, 1
    s_add_u32 s40, s40, s39
    s_lshl_b32 s38, s32, 1
    s_cmp_eq_u32 s32, 8
    s_cselect_b32 s38, 1024, s38
    s_add_u32 s38, s38, 4096
    s_cmp_lt_u32 s33, 8
    s_cselect_b32 s34, s34, 8
    s_cselect_b32 s35, s35, s36
    s_cselect_b32 s36, 4, 3
    s_cselect_b32 s40, s40, s38
    s_cselect_b32 s46, 0, s20
    s_cselect_b32 s47, 22, 12
    s_add_u32 s40, s40, s48
    s_lshl_b32 s38, s34, 10
    s_add_u32 s39, s39, s38
    s_add_u32 s39, s39, s48
    s_add_u32 s39, s39, 1024
    v_and_b32 v15, 3, v14
    v_lshlrev_b32 v15, s36, v15
    v_add_u32 v15, s35, v15
    v_lshrrev_b32 v16, 3, v14
    v_lshlrev_b32 v16, 4, v16
    v_xor_b32 v15, v15, v16
    v_lshrrev_b32 v16, 2, v14
    v_lshl_add_u32 v16, v13, 4, v16
    v_lshl_add_u32 v15, v16, 7, v15
    v_add_u32 v24, 73728, v15
    v_xor_b32 v27, 32, v24
    v_xor_b32 v28, 64, v24
    v_xor_b32 v29, 0x60, v24
    s_lshl_b32 s31, s46, 2
    s_add_u32 s31, s31, 81920
    v_mov_b32 v60, s31
    v_mov_b32 v61, 1
    ds_write_b32 v60, v61
    s_mul_i32 s49, s30, 81
    s_mul_i32 s31, s32, 9
    s_add_u32 s49, s49, s31
    s_add_u32 s49, s49, s34
    s_lshl_b32 s49, s49, 10
    s_add_u32 s49, s49, 393216
    s_lshl_b32 s31, s34, 24
    s_lshl_b32 s38, s32, 10
    s_add_u32 s31, s31, s38
    v_lshlrev_b32 v31, 18, v14
    v_lshl_add_u32 v31, v13, 5, v31
    v_add_u32 v31, s31, v31
    s_mov_b32 s50, 3437096686
    s_mov_b32 s51, 1150609561
    s_mov_b32 s52, 0x00010001
    s_mov_b32 s53, 0x00200010
    s_mov_b32 s38, 0x0202
    s_mul_i32 s57, s30, 4096
    s_add_u32 s57, s57, 726016
    s_cmp_eq_u32 s33, 8
    s_cselect_b32 s56, 0, s20
    s_cmp_eq_u32 s20, 0
    s_cselect_b32 s98, 1, 0
    v_add_u32 v74, 81984, v54
    v_lshl_add_u32 v73, s20, 1, v74
    v_mov_b32 v41, 0x01000100
    v_mov_b32 v40, 0
    v_mov_b32 v63, -2.0
    s_waitcnt vmcnt(5) lgkmcnt(0)
    s_barrier
    ds_read_b64_tr_b16 v[16:17], v24
    ds_read_b64_tr_b16 v[18:19], v27 offset:512
    ds_read_b64_tr_b16 v[20:21], v28 offset:1024
    ds_read_b64_tr_b16 v[22:23], v29 offset:1536
    s_waitcnt lgkmcnt(3)
    v_and_b32 v44, 0x7fff7fff, v16
    v_and_b32 v45, 0x7fff7fff, v17
    v_pk_max_u16 v46, v44, v45
    v_pk_min_u16 v47, v44, v45
    v_pk_min_u16 v46, v46, v46 op_sel:[0,1] op_sel_hi:[1,0]
    v_pk_max_u16 v47, v47, v47 op_sel:[0,1] op_sel_hi:[1,0]
    v_pk_max_u16 v46, v46, s52
    v_pk_max_u16 v46, v46, v47
    v_pk_sub_i16 v44, v44, v46
    v_pk_sub_i16 v45, v45, v46
    v_pk_ashrrev_i16 v44, 15, v44 op_sel_hi:[0,1]
    v_pk_ashrrev_i16 v45, 15, v45 op_sel_hi:[0,1]
    v_alignbit_b32 v47, -1, v44, 16
    v_alignbit_b32 v46, v45, v45, 16
    v_and_b32 v48, 0x00080004, v44
    v_bitop3_b32 v46, v45, v46, v47 bitop3:0xe8
    v_and_or_b32 v64, v45, s53, v48
    v_bitop3_b32 v36, v16, v44, v46 bitop3:0x10
    v_min_u32 v68, 1, v36
    s_waitcnt lgkmcnt(2)
    v_and_b32 v44, 0x7fff7fff, v18
    v_and_b32 v45, 0x7fff7fff, v19
    v_pk_max_u16 v46, v44, v45
    v_pk_min_u16 v47, v44, v45
    v_pk_min_u16 v46, v46, v46 op_sel:[0,1] op_sel_hi:[1,0]
    v_pk_max_u16 v47, v47, v47 op_sel:[0,1] op_sel_hi:[1,0]
    v_pk_max_u16 v46, v46, s52
    v_pk_max_u16 v46, v46, v47
    v_pk_sub_i16 v44, v44, v46
    v_pk_sub_i16 v45, v45, v46
    v_pk_ashrrev_i16 v44, 15, v44 op_sel_hi:[0,1]
    v_pk_ashrrev_i16 v45, 15, v45 op_sel_hi:[0,1]
    v_alignbit_b32 v47, -1, v44, 16
    v_alignbit_b32 v46, v45, v45, 16
    v_and_b32 v48, 0x00080004, v44
    v_bitop3_b32 v46, v45, v46, v47 bitop3:0xe8
    v_and_or_b32 v65, v45, s53, v48
    v_bitop3_b32 v37, v18, v44, v46 bitop3:0x10
    v_min_u32 v69, 1, v37
    s_waitcnt lgkmcnt(1)
    v_and_b32 v44, 0x7fff7fff, v20
    v_and_b32 v45, 0x7fff7fff, v21
    v_pk_max_u16 v46, v44, v45
    v_pk_min_u16 v47, v44, v45
    v_pk_min_u16 v46, v46, v46 op_sel:[0,1] op_sel_hi:[1,0]
    v_pk_max_u16 v47, v47, v47 op_sel:[0,1] op_sel_hi:[1,0]
    v_pk_max_u16 v46, v46, s52
    v_pk_max_u16 v46, v46, v47
    v_pk_sub_i16 v44, v44, v46
    v_pk_sub_i16 v45, v45, v46
    v_pk_ashrrev_i16 v44, 15, v44 op_sel_hi:[0,1]
    v_pk_ashrrev_i16 v45, 15, v45 op_sel_hi:[0,1]
    v_alignbit_b32 v47, -1, v44, 16
    v_alignbit_b32 v46, v45, v45, 16
    v_and_b32 v48, 0x00080004, v44
    v_bitop3_b32 v46, v45, v46, v47 bitop3:0xe8
    v_and_or_b32 v66, v45, s53, v48
    v_bitop3_b32 v38, v20, v44, v46 bitop3:0x10
    v_min_u32 v70, 1, v38
    s_waitcnt lgkmcnt(0)
    v_and_b32 v44, 0x7fff7fff, v22
    v_and_b32 v45, 0x7fff7fff, v23
    v_pk_max_u16 v46, v44, v45
    v_pk_min_u16 v47, v44, v45
    v_pk_min_u16 v46, v46, v46 op_sel:[0,1] op_sel_hi:[1,0]
    v_pk_max_u16 v47, v47, v47 op_sel:[0,1] op_sel_hi:[1,0]
    v_pk_max_u16 v46, v46, s52
    v_pk_max_u16 v46, v46, v47
    v_pk_sub_i16 v44, v44, v46
    v_pk_sub_i16 v45, v45, v46
    v_pk_ashrrev_i16 v44, 15, v44 op_sel_hi:[0,1]
    v_pk_ashrrev_i16 v45, 15, v45 op_sel_hi:[0,1]
    v_alignbit_b32 v47, -1, v44, 16
    v_alignbit_b32 v46, v45, v45, 16
    v_and_b32 v48, 0x00080004, v44
    v_bitop3_b32 v46, v45, v46, v47 bitop3:0xe8
    v_and_or_b32 v67, v45, s53, v48
    v_bitop3_b32 v39, v22, v44, v46 bitop3:0x10
    v_min_u32 v71, 1, v39
    v_add_u32 v72, v68, v69
    v_add3_u32 v72, v72, v70, v71
    buffer_store_dwordx4 v[36:39], v11, s[16:19], s49 offen sc1
    v_cmp_ne_u32 vcc, 0, v72
    s_and_saveexec_b64 s[44:45], vcc
    ds_add_rtn_u32 v62, v60, v72
    s_mov_b64 exec, -1
    v_lshrrev_b32 v48, 16, v64
    v_or_b32 v48, v48, v64
    v_lshrrev_b64 v[52:53], v48, s[50:51]
    v_and_b32 v64, 15, v52
    v_lshl_or_b32 v40, v64, 0, v40
    v_lshrrev_b32 v48, 16, v65
    v_or_b32 v48, v48, v65
    v_lshrrev_b64 v[52:53], v48, s[50:51]
    v_and_b32 v65, 15, v52
    v_lshl_or_b32 v40, v65, 4, v40
    v_lshrrev_b32 v48, 16, v66
    v_or_b32 v48, v48, v66
    v_lshrrev_b64 v[52:53], v48, s[50:51]
    v_and_b32 v66, 15, v52
    v_lshl_or_b32 v40, v66, 8, v40
    v_lshrrev_b32 v48, 16, v67
    v_or_b32 v48, v48, v67
    v_lshrrev_b64 v[52:53], v48, s[50:51]
    v_and_b32 v67, 15, v52
    v_lshl_or_b32 v40, v67, 12, v40
    v_lshrrev_b32 v44, 2, v40
    v_lshlrev_b32 v45, 2, v40
    s_movk_i32 s31, 0x3333
    v_not_b32 v47, v40
    v_bfi_b32 v44, s31, v44, v45
    s_movk_i32 s31, 0x1111
    s_nop 0
    v_mov_b32_dpp v47, v44 row_shr:4 row_mask:0xf bank_mask:0xf
    v_xor_b32 v47, v47, v40
    v_lshrrev_b32 v45, 1, v47
    v_or_b32 v47, v47, v45
    v_lshrrev_b32 v45, 2, v47
    v_bitop3_b32 v47, v47, v45, s31 bitop3:0x2a
    s_nop 1
    v_xor_b32_dpp v47, v47, v47 row_shr:4 row_mask:0xf bank_mask:0xe
    s_nop 1
    v_xor_b32_dpp v47, v47, v47 row_shr:8 row_mask:0xf bank_mask:0xc
    v_mul_u32_u24 v47, 15, v47
    v_bfi_b32 v40, v47, v44, v40
    ds_write_b16 v73, v40
    v_bfe_u32 v64, v40, 0, 4
    v_mul_u32_u24 v46, 0x4001, v64
    v_and_b32 v46, 0x30003, v46
    v_mad_u32_u24 v46, v46, s38, v41
    v_perm_b32 v32, v17, v16, v46
    v_bfe_u32 v65, v40, 4, 4
    v_mul_u32_u24 v46, 0x4001, v65
    v_and_b32 v46, 0x30003, v46
    v_mad_u32_u24 v46, v46, s38, v41
    v_perm_b32 v33, v19, v18, v46
    s_waitcnt vmcnt(4) lgkmcnt(0)
    s_barrier
    ds_read_b64 v[50:51], v74
    v_bfe_u32 v66, v40, 8, 4
    v_mul_u32_u24 v46, 0x4001, v66
    v_and_b32 v46, 0x30003, v46
    v_mad_u32_u24 v46, v46, s38, v41
    v_perm_b32 v34, v21, v20, v46
    v_bfe_u32 v67, v40, 12, 4
    v_mul_u32_u24 v46, 0x4001, v67
    v_and_b32 v46, 0x30003, v46
    v_mad_u32_u24 v46, v46, s38, v41
    v_perm_b32 v35, v23, v22, v46
    buffer_store_dwordx4 v[32:35], v11, s[16:19], s39 offen sc1
    s_cmp_eq_u32 s33, 8
    s_cbranch_scc0 F_i1
    buffer_store_short v40, v11, s[16:19], s40 offen sc1
    s_branch F_i2
F_i1:
    s_cmp_eq_u32 s20, 0
    s_cbranch_scc0 F_i2
    s_waitcnt lgkmcnt(0)
    buffer_store_dwordx2 v[50:51], v11, s[16:19], s40 offen sc1
F_i2:
    s_cbranch_vccz F_z
    v_cmp_ne_u32 vcc, 0, v36
    s_and_saveexec_b64 s[44:45], vcc
    s_cbranch_execz F_e0
    v_cmp_gt_u32 vcc, s47, v62
    v_add_u32 v42, 0, v31
    v_lshlrev_b32 v44, 3, v62
    v_add_u32 v62, 1, v62
    v_cndmask_b32 v42, v63, v42, vcc
    v_cndmask_b32 v43, 0, v36, vcc
    v_cndmask_b32 v44, 0, v44, vcc
    buffer_store_dwordx2 v[42:43], v44, s[16:19], s37 offen sc1
F_e0:
    s_mov_b64 exec, -1
    v_cmp_ne_u32 vcc, 0, v37
    s_and_saveexec_b64 s[44:45], vcc
    s_cbranch_execz F_e1
    v_cmp_gt_u32 vcc, s47, v62
    v_add_u32 v42, 8, v31
    v_lshlrev_b32 v44, 3, v62
    v_add_u32 v62, 1, v62
    v_cndmask_b32 v42, v63, v42, vcc
    v_cndmask_b32 v43, 0, v37, vcc
    v_cndmask_b32 v44, 0, v44, vcc
    buffer_store_dwordx2 v[42:43], v44, s[16:19], s37 offen sc1
F_e1:
    s_mov_b64 exec, -1
    v_cmp_ne_u32 vcc, 0, v38
    s_and_saveexec_b64 s[44:45], vcc
    s_cbranch_execz F_e2
    v_cmp_gt_u32 vcc, s47, v62
    v_add_u32 v42, 16, v31
    v_lshlrev_b32 v44, 3, v62
    v_add_u32 v62, 1, v62
    v_cndmask_b32 v42, v63, v42, vcc
    v_cndmask_b32 v43, 0, v38, vcc
    v_cndmask_b32 v44, 0, v44, vcc
    buffer_store_dwordx2 v[42:43], v44, s[16:19], s37 offen sc1
F_e2:
    s_mov_b64 exec, -1
    v_cmp_ne_u32 vcc, 0, v39
    s_and_saveexec_b64 s[44:45], vcc
    s_cbranch_execz F_e3
    v_cmp_gt_u32 vcc, s47, v62
    v_add_u32 v42, 24, v31
    v_lshlrev_b32 v44, 3, v62
    v_add_u32 v62, 1, v62
    v_cndmask_b32 v42, v63, v42, vcc
    v_cndmask_b32 v43, 0, v39, vcc
    v_cndmask_b32 v44, 0, v44, vcc
    buffer_store_dwordx2 v[42:43], v44, s[16:19], s37 offen sc1
F_e3:
    s_mov_b64 exec, -1
F_z:
    s_cmp_lg_u32 s2, 0
    s_cbranch_scc1 M_set
    v_mov_b32 v64, 0
    v_mov_b32 v65, 0
    v_mov_b32 v66, 0
    v_mov_b32 v67, 0
    s_mov_b32 s40, 724992
    buffer_store_dwordx4 v[64:67], v11, s[16:19], s40 offen sc1
    s_branch M_set
F_sig:
    v_lshlrev_b32 v30, 8, v12
    s_waitcnt vmcnt(0)
    s_barrier
    s_cmp_lg_u32 s56, 0
    s_cbranch_scc1 F_end
    s_bfm_b64 exec, 16, 0
    buffer_atomic_add v61, v30, s[16:19], s57 offen sc1
    s_mov_b64 exec, -1
    s_cmp_eq_u32 s98, 0
    s_cbranch_scc1 F_cnt
    s_mov_b32 s98, 0
    v_mov_b32 v250, 1
    s_mov_b64 exec, 1
    buffer_atomic_add v250, off, s[68:71], 0 offset:0 sc1
    s_mov_b64 exec, -1
    s_nop 3
F_cnt:
F_end:
    s_add_u32 m0, m0, 896
    s_nop 0
    buffer_load_dwordx4 v5, s[8:11], s22 offen offset:384 nt lds
    s_add_u32 m0, m0, 896
    s_nop 0
    buffer_load_dwordx4 v5, s[8:11], s22 offen offset:512 nt lds
    s_branch M_x2
M_x1:
    s_waitcnt lgkmcnt(0)
    s_mov_b64 s[4:5], s[74:75]
    s_mov_b64 s[16:17], s[82:83]
    s_mov_b64 s[8:9], s[72:73]
    s_mov_b64 s[84:85], s[76:77]
    s_mov_b64 s[68:69], s[80:81]
    v_mov_b32 v10, 0
    s_mov_b64 exec, 1
    buffer_atomic_add v10, off, s[16:19], s96 sc0 sc1
    s_mov_b64 exec, -1
    s_mov_b32 m0, s42
    s_nop 0
    buffer_load_dwordx4 v5, s[8:11], s22 offen offset:0 nt lds
    s_add_u32 m0, m0, 896
    s_nop 0
    buffer_load_dwordx4 v5, s[8:11], s22 offen offset:128 nt lds
    s_add_u32 m0, m0, 896
    s_nop 0
    buffer_load_dwordx4 v5, s[8:11], s22 offen offset:256 nt lds
    s_add_u32 m0, m0, 896
    s_nop 0
    buffer_load_dwordx4 v5, s[8:11], s22 offen offset:384 nt lds
    s_add_u32 m0, m0, 896
    s_nop 0
    buffer_load_dwordx4 v5, s[8:11], s22 offen offset:512 nt lds
M_set:
    s_mov_b32 s12, s78
    s_mov_b32 s13, s79
    s_mov_b32 s14, 75497472
    s_mov_b32 s15, 0x20000
    s_mul_i32 s29, s20, 12864
    s_add_u32 s29, s29, 110592
    v_lshrrev_b32 v24, 1, v14
    v_and_b32 v27, 7, v14
    v_lshlrev_b32 v22, 7, v27
    v_lshl_or_b32 v3, v24, 4, v22
    v_lshrrev_b32 v23, 3, v14
    v_mul_u32_u24 v4, 9216, v23
    v_xad_u32 v1, v25, v3, v4
    v_xor_b32 v2, 64, v1
    v_add_u32 v9, s29, v25
    v_add_u32 v8, s29, v11
    v_mul_u32_u24 v24, 1152, v27
    v_lshl_add_u32 v24, v23, 6, v24
    v_add3_u32 v6, v24, v25, s28
    v_lshrrev_b32 v24, 3, v12
    v_xor_b32 v28, v24, v12
    v_and_b32 v28, 7, v28
    v_mul_u32_u24 v24, 1152, v24
    v_lshl_add_u32 v24, v28, 4, v24
    v_add_u32 v7, 1024, v24
    s_lshl_b32 s30, s20, 1
    v_lshrrev_b32 v24, 1, v13
    v_add_u32 v24, s30, v24
    v_xor_b32 v24, v24, v27
    v_lshl_add_u32 v24, v24, 4, v22
    v_and_b32 v28, 8, v26
    v_mul_u32_u24 v29, 12864, v23
    v_add3_u32 v24, v24, v28, v29
    v_add_u32 v53, 121408, v24
    s_lshr_b32 s30, s2, 3
    s_and_b32 s30, s30, 1
    s_mul_i32 s92, s30, 256
    s_add_u32 s92, s92, 562944
    s_add_u32 s30, s30, 768
    s_mul_i32 s93, s30, 36864
    s_mov_b32 s94, 73728
    s_and_b32 s95, s20, 1
    s_mul_i32 s95, s95, 9216
    s_add_u32 s59, s24, 9216
    s_mul_i32 s43, s20, 98304
    s_add_u32 s47, s29, 9216
    s_add_u32 s48, s29, 9792
    s_add_u32 s49, s29, 10112
    s_add_u32 s54, s29, 1073751872
    s_add_u32 s38, s26, 73728
    s_add_u32 s35, s38, 1024
    s_add_u32 s39, s38, 1536
    s_mov_b32 s40, s48
    s_add_u32 s41, s48, 256
    s_mov_b32 s50, 3130536464
    s_mov_b32 s51, 1164430831
    s_mov_b32 s52, 3696531472
    s_mov_b32 s53, 598435823
    v_mov_b32 v16, 0
    v_mov_b32 v17, 0
    v_mov_b32 v18, 0
    v_mov_b32 v19, 0
    v_cmp_gt_u32 s[44:45], 36, v12
    v_mov_b32 v20, 2.0
    s_nop 0
    v_cndmask_b32 v20, 0, v20, s[44:45]
    v_mov_b32 v21, v20
    v_mov_b32 v22, v20
    v_mov_b32 v23, v20
    v_mov_b32 v104, 1073741824
    v_mov_b32 v105, 0
    v_mov_b32 v106, 1073741824
    v_mov_b32 v107, 0
    v_lshl_add_u32 v121, v12, 2, s49
    v_add_u32 v55, s38, v54
    v_add_u32 v24, s38, v11
    ds_write_b128 v8, v[16:19] offset:0
    ds_write_b128 v8, v[16:19] offset:1024
    ds_write_b128 v8, v[16:19] offset:2048
    ds_write_b128 v8, v[16:19] offset:3072
    ds_write_b128 v8, v[16:19] offset:4096
    ds_write_b128 v8, v[16:19] offset:5120
    ds_write_b128 v8, v[16:19] offset:6144
    ds_write_b128 v8, v[16:19] offset:7168
    ds_write_b128 v8, v[16:19] offset:8192
    ds_write_b128 v24, v[104:107]
    ds_write_b128 v24, v[104:107] offset:1024
    ds_write_b128 v8, v[20:23] offset:9216
    s_cmp_lt_u32 s2, 81
    s_cbranch_scc1 F_sig
M_x2:
    s_add_u32 m0, m0, 896
    s_nop 0
    buffer_load_dwordx4 v5, s[8:11], s22 offen offset:640 nt lds
    s_add_u32 m0, m0, 896
    s_nop 0
    buffer_load_dwordx4 v5, s[8:11], s22 offen offset:768 nt lds
    s_add_u32 m0, m0, 896
    s_nop 0
    buffer_load_dwordx4 v5, s[8:11], s22 offen offset:896 nt lds
    s_add_u32 m0, m0, 896
    s_nop 0
    buffer_load_dwordx4 v5, s[8:11], s22 offen offset:1024 nt lds
    s_add_u32 s22, s22, 9437184
    s_add_u32 s42, s42, 36864
    buffer_load_dwordx4 v[196:199], v25, s[84:87], s28 offen offset:0
    buffer_load_dwordx4 v[200:203], v25, s[84:87], s28 offen offset:64
    buffer_load_dwordx4 v[204:207], v25, s[84:87], s28 offen offset:128
    buffer_load_dwordx4 v[208:211], v25, s[84:87], s28 offen offset:192
    buffer_load_dwordx2 v[212:213], v26, s[84:87], s97 offen offset:1024
    s_mov_b32 m0, s42
    s_nop 0
    buffer_load_dwordx4 v5, s[8:11], s22 offen offset:0 nt lds
    s_add_u32 m0, m0, 896
    s_nop 0
    buffer_load_dwordx4 v5, s[8:11], s22 offen offset:128 nt lds
    s_add_u32 m0, m0, 896
    s_nop 0
    buffer_load_dwordx4 v5, s[8:11], s22 offen offset:256 nt lds
    s_add_u32 m0, m0, 896
    s_nop 0
    buffer_load_dwordx4 v5, s[8:11], s22 offen offset:384 nt lds
    s_add_u32 m0, m0, 896
    s_nop 0
    buffer_load_dwordx4 v5, s[8:11], s22 offen offset:512 nt lds
    s_add_u32 m0, m0, 896
    s_nop 0
    buffer_load_dwordx4 v5, s[8:11], s22 offen offset:640 nt lds
    s_add_u32 m0, m0, 896
    s_nop 0
    buffer_load_dwordx4 v5, s[8:11], s22 offen offset:768 nt lds
    s_add_u32 m0, m0, 896
    s_nop 0
    buffer_load_dwordx4 v5, s[8:11], s22 offen offset:896 nt lds
    s_add_u32 m0, m0, 896
    s_nop 0
    buffer_load_dwordx4 v5, s[8:11], s22 offen offset:1024 nt lds
    s_add_u32 s22, s22, 9437184
    s_add_u32 s42, s42, 36864
    s_waitcnt vmcnt(3)
    v_mov_b32 v0, 0
    s_mov_b64 exec, 1
    buffer_atomic_add v0, off, s[16:19], s96 sc0 sc1
    s_mov_b64 exec, -1
    v_readlane_b32 s100, v10, 0
    v_mov_b32 v10, 0xeeee4444
    v_lshlrev_b32 v124, 16, v196
    v_and_b32 v125, 0xffff0000, v196
    v_lshlrev_b32 v126, 16, v197
    v_and_b32 v127, 0xffff0000, v197
    v_lshlrev_b32 v128, 16, v198
    v_and_b32 v129, 0xffff0000, v198
    v_lshlrev_b32 v130, 16, v199
    v_and_b32 v131, 0xffff0000, v199
    v_lshlrev_b32 v132, 16, v200
    v_and_b32 v133, 0xffff0000, v200
    v_lshlrev_b32 v134, 16, v201
    v_and_b32 v135, 0xffff0000, v201
    v_lshlrev_b32 v136, 16, v202
    v_and_b32 v137, 0xffff0000, v202
    v_lshlrev_b32 v138, 16, v203
    v_and_b32 v139, 0xffff0000, v203
    v_lshlrev_b32 v140, 16, v204
    v_and_b32 v141, 0xffff0000, v204
    v_lshlrev_b32 v142, 16, v205
    v_and_b32 v143, 0xffff0000, v205
    v_lshlrev_b32 v144, 16, v206
    v_and_b32 v145, 0xffff0000, v206
    v_lshlrev_b32 v146, 16, v207
    v_and_b32 v147, 0xffff0000, v207
    v_lshlrev_b32 v148, 16, v208
    v_and_b32 v149, 0xffff0000, v208
    v_lshlrev_b32 v150, 16, v209
    v_and_b32 v151, 0xffff0000, v209
    v_lshlrev_b32 v152, 16, v210
    v_and_b32 v153, 0xffff0000, v210
    v_lshlrev_b32 v154, 16, v211
    v_and_b32 v155, 0xffff0000, v211
    v_lshlrev_b32 v156, 16, v212
    v_and_b32 v157, 0xffff0000, v212
    v_lshlrev_b32 v158, 16, v213
    v_and_b32 v159, 0xffff0000, v213
    s_mov_b32 exec_lo, 0x00010001
    s_mov_b32 exec_hi, 0x00010001
    ds_write_b128 v9, v[124:127] offset:10240
    ds_write_b128 v9, v[128:131] offset:10304
    ds_write_b128 v9, v[132:135] offset:10368
    ds_write_b128 v9, v[136:139] offset:10432
    ds_write_b128 v9, v[140:143] offset:10496
    ds_write_b128 v9, v[144:147] offset:10560
    ds_write_b128 v9, v[148:151] offset:10624
    ds_write_b128 v9, v[152:155] offset:10688
    ds_write_b128 v9, v[156:159] offset:10752
    s_mov_b64 exec, -1
    s_mul_i32 s30, s20, 256
    s_xor_b32 s31, s2, 0
    s_add_u32 s30, s30, s31
    s_sub_u32 s30, s30, 0
    s_cmp_lt_u32 s2, 0
    s_cselect_b32 s30, 1023, s30
    s_lshl_b32 s30, s30, 1
    v_lshrrev_b32 v244, 5, v12
    v_add_u32 v248, s30, v244
    v_mov_b32 v244, -1
    v_mov_b32 v245, 0
    v_subrev_u32 v246, 664, v248
    v_cmp_gt_u32 vcc, 12, v246
    v_mov_b32 v247, 0
    s_nop 0
    v_cndmask_b32 v244, v244, v246, vcc
    v_cndmask_b32 v245, v245, v247, vcc
    v_subrev_u32 v246, 638, v248
    v_cmp_gt_u32 vcc, 26, v246
    v_mov_b32 v247, 1
    s_nop 0
    v_cndmask_b32 v244, v244, v246, vcc
    v_cndmask_b32 v245, v245, v247, vcc
    v_subrev_u32 v246, 598, v248
    v_cmp_gt_u32 vcc, 40, v246
    v_mov_b32 v247, 2
    s_nop 0
    v_cndmask_b32 v244, v244, v246, vcc
    v_cndmask_b32 v245, v245, v247, vcc
    v_subrev_u32 v246, 542, v248
    v_cmp_gt_u32 vcc, 56, v246
    v_mov_b32 v247, 3
    s_nop 0
    v_cndmask_b32 v244, v244, v246, vcc
    v_cndmask_b32 v245, v245, v247, vcc
    v_subrev_u32 v246, 468, v248
    v_cmp_gt_u32 vcc, 74, v246
    v_mov_b32 v247, 4
    s_nop 0
    v_cndmask_b32 v244, v244, v246, vcc
    v_cndmask_b32 v245, v245, v247, vcc
    v_subrev_u32 v246, 376, v248
    v_cmp_gt_u32 vcc, 92, v246
    v_mov_b32 v247, 5
    s_nop 0
    v_cndmask_b32 v244, v244, v246, vcc
    v_cndmask_b32 v245, v245, v247, vcc
    v_subrev_u32 v246, 268, v248
    v_cmp_gt_u32 vcc, 108, v246
    v_mov_b32 v247, 6
    s_nop 0
    v_cndmask_b32 v244, v244, v246, vcc
    v_cndmask_b32 v245, v245, v247, vcc
    v_subrev_u32 v246, 142, v248
    v_cmp_gt_u32 vcc, 126, v246
    v_mov_b32 v247, 7
    s_nop 0
    v_cndmask_b32 v244, v244, v246, vcc
    v_cndmask_b32 v245, v245, v247, vcc
    v_subrev_u32 v246, 0, v248
    v_cmp_gt_u32 vcc, 142, v246
    v_mov_b32 v247, 8
    s_nop 0
    v_cndmask_b32 v244, v244, v246, vcc
    v_cndmask_b32 v245, v245, v247, vcc
    v_sub_u32 v244, 2047, v244
    v_mul_u32_u24 v244, 36864, v244
    v_lshl_add_u32 v244, v245, 7, v244
    v_and_b32 v245, 31, v12
    v_mul_u32_u24 v245, 1152, v245
    v_add_u32 v249, v244, v245
    s_mov_b32 vcc_lo, 0xff00ff00
    s_mov_b32 vcc_hi, 0xff00ff00
    s_waitcnt vmcnt(0)
    v_readfirstlane_b32 s30, v0
    s_mov_b32 s31, 0
    s_sub_u32 s30, s30, s100
    s_cmp_eq_u32 s30, 27
    s_cbranch_scc0 M_pf_spin
M_pf_ok:
    s_lshr_b32 s30, s2, 3
    s_sub_u32 s31, s30, 11
    s_cselect_b32 s30, s30, s31
    s_mul_i32 s30, s30, 3072
    s_add_u32 s30, s30, s43
    s_add_u32 s30, s30, 33792
    v_lshlrev_b32 v244, 3, v11
    v_mov_b32 v0, v249
    buffer_load_dwordx4 v[92:95], v11, s[16:19], s43 offen offset:0 sc1
    buffer_load_dwordx4 v[96:99], v11, s[16:19], s43 offen offset:1024 sc1
    buffer_load_dwordx4 v[100:103], v11, s[16:19], s43 offen offset:2048 sc1
    s_mov_b32 exec_hi, 268435455
    buffer_load_dwordx4 v[104:107], v11, s[16:19], s43 offen offset:3072 sc1
    s_mov_b32 exec_hi, -1
    s_add_u32 s43, s43, 4096
    buffer_load_dwordx4 v[48:51], v11, s[16:19], s43 offen offset:0 sc1
    buffer_load_dword v52, v11, s[16:19], s43 offen offset:1024 sc1
    buffer_load_dwordx4 v[12:15], v11, s[16:19], s43 offen offset:2048 sc1
    buffer_load_dwordx4 a[0:3], v11, s[16:19], s43 offen offset:3072 sc1
    s_add_u32 s43, s43, 4096
    buffer_load_dwordx4 a[4:7], v11, s[16:19], s43 offen offset:0 sc1
    buffer_load_dwordx4 a[8:11], v11, s[16:19], s43 offen offset:1024 sc1
    buffer_load_dwordx4 a[12:15], v11, s[16:19], s43 offen offset:2048 sc1
    buffer_load_dwordx4 a[16:19], v11, s[16:19], s43 offen offset:3072 sc1
    s_add_u32 s43, s43, 4096
    s_bfm_b64 exec, 24, 0
    buffer_load_dword v244, v244, s[16:19], s30 offen sc1
    s_mov_b64 exec, -1
    buffer_load_dwordx4 a[20:23], v11, s[16:19], s43 offen offset:0 sc1
    buffer_load_dwordx4 a[24:27], v11, s[16:19], s43 offen offset:1024 sc1
    buffer_load_dwordx4 a[28:31], v11, s[16:19], s43 offen offset:2048 sc1
    buffer_load_dwordx4 a[32:35], v11, s[16:19], s43 offen offset:3072 sc1
    s_add_u32 s43, s43, 4096
    buffer_load_dwordx4 v[16:19], v11, s[16:19], s43 offen offset:0 sc1
    buffer_load_dwordx4 a[36:39], v11, s[16:19], s43 offen offset:1024 sc1
    buffer_load_dwordx4 a[40:43], v11, s[16:19], s43 offen offset:2048 sc1
    buffer_load_dwordx4 a[44:47], v11, s[16:19], s43 offen offset:3072 sc1
    s_add_u32 s43, s43, 4096
    buffer_load_dwordx4 a[48:51], v11, s[16:19], s43 offen offset:0 sc1
    buffer_load_dwordx4 a[52:55], v11, s[16:19], s43 offen offset:1024 sc1
    buffer_load_dwordx4 a[56:59], v11, s[16:19], s43 offen offset:2048 sc1
    buffer_load_dwordx4 a[60:63], v11, s[16:19], s43 offen offset:3072 sc1
    s_add_u32 s43, s43, 4096
    buffer_load_dwordx4 a[64:67], v11, s[16:19], s43 offen offset:0 sc1
    buffer_load_dwordx4 a[68:71], v11, s[16:19], s43 offen offset:1024 sc1
    buffer_load_dwordx4 v[20:23], v11, s[16:19], s43 offen offset:2048 sc1
    buffer_load_dwordx4 a[72:75], v11, s[16:19], s43 offen offset:3072 sc1
    s_add_u32 s43, s43, 4096
    buffer_load_dwordx4 a[76:79], v11, s[16:19], s43 offen offset:0 sc1
    buffer_load_dwordx4 a[80:83], v11, s[16:19], s43 offen offset:1024 sc1
    buffer_load_dwordx4 a[84:87], v11, s[16:19], s43 offen offset:2048 sc1
    buffer_load_dwordx4 a[88:91], v11, s[16:19], s43 offen offset:3072 sc1
    s_add_u32 s43, s43, 4096
    buffer_load_dwordx4 a[92:95], v11, s[16:19], s43 offen offset:0 sc1
    buffer_load_dwordx4 a[96:99], v11, s[16:19], s43 offen offset:1024 sc1
    buffer_load_dwordx4 a[100:103], v11, s[16:19], s43 offen offset:2048 sc1
    buffer_load_dwordx4 a[104:107], v11, s[16:19], s43 offen offset:3072 sc1
    s_add_u32 s43, s43, 4096
    buffer_load_dwordx4 v[24:27], v11, s[16:19], s43 offen offset:0 sc1
    buffer_load_dwordx4 a[108:111], v11, s[16:19], s43 offen offset:1024 sc1
    ds_read_b128 v[160:163], v9 offset:10240
    ds_read_b128 v[164:167], v9 offset:10304
    ds_read_b128 v[168:171], v9 offset:10368
    ds_read_b128 v[172:175], v9 offset:10432
    ds_read_b128 v[176:179], v9 offset:10496
    ds_read_b128 v[180:183], v9 offset:10560
    ds_read_b128 v[184:187], v9 offset:10624
    ds_read_b128 v[188:191], v9 offset:10688
    ds_read_b128 v[192:195], v9 offset:10752
    s_waitcnt vmcnt(31)
    s_barrier
    ds_read_b128 v[196:199], v1 offset:0
    ds_read_b128 v[200:203], v2 offset:0
    ds_read_b128 v[228:231], v1 offset:18432
    ds_read_b128 v[232:235], v2 offset:18432
    s_waitcnt lgkmcnt(2)
    v_smfmac_f32_16x16x64_bf16 v[124:127], a[0:3], v[196:203], v12
    buffer_load_dwordx4 a[112:115], v11, s[16:19], s43 offen offset:2048 sc1
    s_waitcnt lgkmcnt(0)
    v_mov_b32 v118, s54
    v_smfmac_f32_16x16x64_bf16 v[160:163], a[0:3], v[228:235], v12
    ds_read_b128 v[204:207], v1 offset:1024
    ds_read_b128 v[208:211], v2 offset:1024
    v_or3_b32 v114, v92, v96, v100
    v_or_b32 v114, v114, v104
    v_cmp_gt_i32 s[32:33], 0, v114
    v_cmp_gt_u32 s[36:37], 2.0, v92
    s_nop 1
    v_mbcnt_lo_u32_b32 v110, s36, 0
    s_waitcnt vmcnt(31)
    v_mbcnt_hi_u32_b32 v110, s37, v110
    v_smfmac_f32_16x16x64_bf16 v[128:131], a[4:7], v[196:203], v12 abid:1
    buffer_load_dwordx4 a[116:119], v11, s[16:19], s43 offen offset:3072 sc1
    v_lshl_add_u32 v110, v110, 3, s38
    v_smfmac_f32_16x16x64_bf16 v[164:167], a[4:7], v[228:235], v12 abid:1
    ds_read_b128 v[220:223], v1 offset:19456
    ds_read_b128 v[224:227], v2 offset:19456
    v_min_u32 v110, s39, v110
    s_waitcnt vmcnt(31)
    v_cndmask_b32 v110, v118, v110, s[36:37]
    v_smfmac_f32_16x16x64_bf16 v[132:135], a[8:11], v[196:203], v13
    s_add_u32 s43, s43, 4096
    buffer_load_dwordx4 a[120:123], v11, s[16:19], s43 offen offset:0 sc1
    ds_write_b64 v110, v[92:93]
    s_bcnt1_i32_b64 s30, s[36:37]
    s_lshl3_add_u32 s38, s30, s38
    v_cmp_gt_u32 s[44:45], 2.0, v94
    v_smfmac_f32_16x16x64_bf16 v[168:171], a[8:11], v[228:235], v13
    s_nop 0
    v_mbcnt_lo_u32_b32 v111, s44, 0
    v_mbcnt_hi_u32_b32 v111, s45, v111
    v_lshl_add_u32 v111, v111, 3, s38
    v_min_u32 v111, s39, v111
    s_waitcnt vmcnt(31)
    v_cndmask_b32 v111, v118, v111, s[44:45]
    v_smfmac_f32_16x16x64_bf16 v[136:139], a[12:15], v[196:203], v13 abid:1
    buffer_load_dwordx4 a[124:127], v11, s[16:19], s43 offen offset:1024 sc1
    ds_write_b64 v111, v[94:95]
    s_bcnt1_i32_b64 s30, s[44:45]
    s_lshl3_add_u32 s38, s30, s38
    v_cmp_gt_u32 s[36:37], 2.0, v96
    v_smfmac_f32_16x16x64_bf16 v[172:175], a[12:15], v[228:235], v13 abid:1
    s_nop 0
    v_mbcnt_lo_u32_b32 v110, s36, 0
    v_mbcnt_hi_u32_b32 v110, s37, v110
    v_lshl_add_u32 v110, v110, 3, s38
    s_waitcnt vmcnt(31)
    v_min_u32 v110, s39, v110
    v_smfmac_f32_16x16x64_bf16 v[140:143], a[16:19], v[196:203], v14
    buffer_load_dwordx4 a[128:131], v11, s[16:19], s43 offen offset:2048 sc1
    v_cndmask_b32 v110, v118, v110, s[36:37]
    v_smfmac_f32_16x16x64_bf16 v[176:179], a[16:19], v[228:235], v14
    ds_write_b64 v110, v[96:97]
    s_bcnt1_i32_b64 s30, s[36:37]
    s_lshl3_add_u32 s38, s30, s38
    v_cmp_gt_u32 s[44:45], 2.0, v98
    s_nop 1
    v_mbcnt_lo_u32_b32 v111, s44, 0
    s_waitcnt vmcnt(30)
    v_mbcnt_hi_u32_b32 v111, s45, v111
    v_smfmac_f32_16x16x64_bf16 v[144:147], a[20:23], v[196:203], v14 abid:1
    buffer_load_dwordx4 a[132:135], v11, s[16:19], s43 offen offset:3072 sc1
    v_lshl_add_u32 v111, v111, 3, s38
    v_smfmac_f32_16x16x64_bf16 v[180:183], a[20:23], v[228:235], v14 abid:1
    v_min_u32 v111, s39, v111
    s_waitcnt vmcnt(30)
    v_cndmask_b32 v111, v118, v111, s[44:45]
    v_smfmac_f32_16x16x64_bf16 v[148:151], a[24:27], v[196:203], v15
    s_add_u32 s43, s43, 4096
    buffer_load_dwordx4 a[136:139], v11, s[16:19], s43 offen offset:0 sc1
    ds_write_b64 v111, v[98:99]
    s_bcnt1_i32_b64 s30, s[44:45]
    s_lshl3_add_u32 s38, s30, s38
    v_cmp_gt_u32 s[36:37], 2.0, v100
    v_smfmac_f32_16x16x64_bf16 v[184:187], a[24:27], v[228:235], v15
    s_nop 0
    v_mbcnt_lo_u32_b32 v110, s36, 0
    v_mbcnt_hi_u32_b32 v110, s37, v110
    v_lshl_add_u32 v110, v110, 3, s38
    v_min_u32 v110, s39, v110
    s_waitcnt vmcnt(30)
    v_cndmask_b32 v110, v118, v110, s[36:37]
    v_smfmac_f32_16x16x64_bf16 v[152:155], a[28:31], v[196:203], v15 abid:1
    buffer_load_dwordx4 a[140:143], v11, s[16:19], s43 offen offset:1024 sc1
    ds_write_b64 v110, v[100:101]
    s_bcnt1_i32_b64 s30, s[36:37]
    s_lshl3_add_u32 s38, s30, s38
    v_cmp_gt_u32 s[44:45], 2.0, v102
    v_smfmac_f32_16x16x64_bf16 v[188:191], a[28:31], v[228:235], v15 abid:1
    s_nop 0
    v_mbcnt_lo_u32_b32 v111, s44, 0
    v_mbcnt_hi_u32_b32 v111, s45, v111
    v_lshl_add_u32 v111, v111, 3, s38
    s_waitcnt vmcnt(30)
    v_min_u32 v111, s39, v111
    v_smfmac_f32_16x16x64_bf16 v[156:159], a[32:35], v[196:203], v48
    buffer_load_dwordx4 v[28:31], v11, s[16:19], s43 offen offset:2048 sc1
    buffer_load_dwordx4 a[144:147], v11, s[16:19], s43 offen offset:3072 sc1
    v_cndmask_b32 v111, v118, v111, s[44:45]
    v_smfmac_f32_16x16x64_bf16 v[192:195], a[32:35], v[228:235], v48
    ds_write_b64 v111, v[102:103]
    s_bcnt1_i32_b64 s30, s[44:45]
    s_lshl3_add_u32 s38, s30, s38
    v_cmp_gt_u32 s[36:37], 2.0, v104
    s_nop 1
    s_waitcnt vmcnt(30)
    s_waitcnt lgkmcnt(8)
    v_mbcnt_lo_u32_b32 v110, s36, 0
    v_smfmac_f32_16x16x64_bf16 v[124:127], a[36:39], v[204:211], v16
    s_add_u32 s43, s43, 4096
    buffer_load_dwordx4 a[148:151], v11, s[16:19], s43 offen offset:0 sc1
    s_waitcnt lgkmcnt(6)
    v_mbcnt_hi_u32_b32 v110, s37, v110
    v_smfmac_f32_16x16x64_bf16 v[160:163], a[36:39], v[220:227], v16
    ds_read_b128 v[196:199], v1 offset:2048
    ds_read_b128 v[200:203], v2 offset:2048
    v_lshl_add_u32 v110, v110, 3, s38
    v_min_u32 v110, s39, v110
    s_waitcnt vmcnt(30)
    v_cndmask_b32 v110, v118, v110, s[36:37]
    v_smfmac_f32_16x16x64_bf16 v[128:131], a[40:43], v[204:211], v16 abid:1
    buffer_load_dwordx4 a[152:155], v11, s[16:19], s43 offen offset:1024 sc1
    ds_write_b64 v110, v[104:105]
    s_bcnt1_i32_b64 s30, s[36:37]
    s_lshl3_add_u32 s38, s30, s38
    v_cmp_gt_u32 s[44:45], 2.0, v106
    v_smfmac_f32_16x16x64_bf16 v[164:167], a[40:43], v[220:227], v16 abid:1
    ds_read_b128 v[228:231], v1 offset:20480
    ds_read_b128 v[232:235], v2 offset:20480
    v_mbcnt_lo_u32_b32 v111, s44, 0
    v_mbcnt_hi_u32_b32 v111, s45, v111
    v_lshl_add_u32 v111, v111, 3, s38
    v_min_u32 v111, s39, v111
    s_waitcnt vmcnt(30)
    v_cndmask_b32 v111, v118, v111, s[44:45]
    v_smfmac_f32_16x16x64_bf16 v[132:135], a[44:47], v[204:211], v17
    buffer_load_dwordx4 a[156:159], v11, s[16:19], s43 offen offset:2048 sc1
    ds_write_b64 v111, v[106:107]
    s_bcnt1_i32_b64 s30, s[44:45]
    s_lshl3_add_u32 s38, s30, s38
    ds_read_b64 v[92:93], v55 offset:0
    ds_read_b64 v[94:95], v55 offset:512
    ds_read_b64 v[96:97], v55 offset:1024
    v_smfmac_f32_16x16x64_bf16 v[168:171], a[44:47], v[220:227], v17
    s_waitcnt vmcnt(30)
    v_smfmac_f32_16x16x64_bf16 v[136:139], a[48:51], v[204:211], v17 abid:1
    buffer_load_dwordx4 a[160:163], v11, s[16:19], s43 offen offset:3072 sc1
    v_smfmac_f32_16x16x64_bf16 v[172:175], a[48:51], v[220:227], v17 abid:1
    s_waitcnt vmcnt(30)
    v_smfmac_f32_16x16x64_bf16 v[140:143], a[52:55], v[204:211], v18
    s_add_u32 s43, s43, 4096
    buffer_load_dwordx4 a[164:167], v11, s[16:19], s43 offen offset:0 sc1
    s_waitcnt lgkmcnt(2)
    v_bfe_u32 v110, v92, 24, 4
    v_smfmac_f32_16x16x64_bf16 v[176:179], a[52:55], v[220:227], v18
    v_lshlrev_b32 v111, 1, v92
    v_lshl_add_u32 v110, v110, 2, s49
    v_and_b32 v111, 16, v111
    s_waitcnt vmcnt(30)
    v_and_or_b32 v110, v92, 2.0, v110
    v_smfmac_f32_16x16x64_bf16 v[144:147], a[56:59], v[204:211], v18 abid:1
    buffer_load_dwordx4 a[168:171], v11, s[16:19], s43 offen offset:1024 sc1
    v_lshlrev_b32 v111, v111, 1
    v_smfmac_f32_16x16x64_bf16 v[180:183], a[56:59], v[220:227], v18 abid:1
    ds_add_rtn_u32 v98, v110, v111
    s_waitcnt lgkmcnt(2)
    v_bfe_u32 v112, v94, 24, 4
    v_lshlrev_b32 v113, 1, v94
    v_lshl_add_u32 v112, v112, 2, s49
    s_waitcnt vmcnt(30)
    v_and_b32 v113, 16, v113
    v_smfmac_f32_16x16x64_bf16 v[148:151], a[60:63], v[204:211], v19
    buffer_load_dwordx4 a[172:175], v11, s[16:19], s43 offen offset:2048 sc1
    v_and_or_b32 v112, v94, 2.0, v112
    v_smfmac_f32_16x16x64_bf16 v[184:187], a[60:63], v[220:227], v19
    s_waitcnt vmcnt(30)
    v_lshlrev_b32 v113, v113, 1
    v_smfmac_f32_16x16x64_bf16 v[152:155], a[64:67], v[204:211], v19 abid:1
    buffer_load_dwordx4 a[176:179], v11, s[16:19], s43 offen offset:3072 sc1
    ds_add_rtn_u32 v99, v112, v113
    s_waitcnt lgkmcnt(2)
    s_cmp_gt_u32 s38, s35
    s_cbranch_scc1 M_r3
M_r3r:
    ds_read_b32 v117, v121
    v_and_b32 v110, 8, v92
    v_smfmac_f32_16x16x64_bf16 v[188:191], a[64:67], v[220:227], v19 abid:1
    v_lshrrev_b32 v113, 14, v92
    v_cmp_ne_u32 s[44:45], 0, v110
    v_and_b32 v116, 0x3cf0, v113
    s_waitcnt lgkmcnt(2)
    v_lshrrev_b32 v111, 16, v98
    v_and_b32 v112, 0xffff, v98
    s_waitcnt vmcnt(30)
    v_sub_u32 v110, 15, v111
    v_smfmac_f32_16x16x64_bf16 v[156:159], a[68:71], v[204:211], v48 abid:1
    s_add_u32 s43, s43, 4096
    buffer_load_dwordx4 v[32:35], v11, s[16:19], s43 offen offset:0 sc1
    buffer_load_dwordx4 a[180:183], v11, s[16:19], s43 offen offset:1024 sc1
    v_and_b32 v98, 2.0, v92
    v_smfmac_f32_16x16x64_bf16 v[192:195], a[68:71], v[220:227], v48 abid:1
    v_add3_u32 v98, v112, v111, v98
    v_cndmask_b32 v110, v112, v110, s[44:45]
    v_cmp_gt_u32 s[44:45], 16, v98
    v_cmp_gt_u32 s[36:37], 2.0, v98
    v_lshlrev_b32 v110, 2, v110
    s_waitcnt vmcnt(30)
    v_lshrrev_b64 v[112:113], v110, s[50:51]
    v_smfmac_f32_16x16x64_bf16 v[124:127], a[72:75], v[196:203], v20
    buffer_load_dwordx4 a[184:187], v11, s[16:19], s43 offen offset:2048 sc1
    s_andn2_b64 s[36:37], s[36:37], s[44:45]
    v_lshrrev_b64 v[114:115], v110, s[52:53]
    v_smfmac_f32_16x16x64_bf16 v[160:163], a[72:75], v[228:235], v20
    ds_read_b128 v[204:207], v1 offset:3072
    ds_read_b128 v[208:211], v2 offset:3072
    v_bfe_u32 v110, v92, 24, 4
    v_mbcnt_lo_u32_b32 v111, s36, 0
    v_and_b32 v112, 15, v112
    v_mbcnt_hi_u32_b32 v111, s37, v111
    v_and_b32 v114, 15, v114
    s_waitcnt vmcnt(30)
    v_lshl_add_u32 v111, v111, 3, s40
    v_smfmac_f32_16x16x64_bf16 v[128:131], a[76:79], v[196:203], v20 abid:1
    buffer_load_dwordx4 a[188:191], v11, s[16:19], s43 offen offset:3072 sc1
    v_lshl_add_u32 v112, v110, 4, v112
    v_smfmac_f32_16x16x64_bf16 v[164:167], a[76:79], v[228:235], v20 abid:1
    ds_read_b128 v[220:223], v1 offset:21504
    ds_read_b128 v[224:227], v2 offset:21504
    v_min_u32 v111, s41, v111
    v_mul_u32_u24 v114, 68, v114
    s_waitcnt vmcnt(30)
    v_cndmask_b32 v111, v118, v111, s[36:37]
    v_smfmac_f32_16x16x64_bf16 v[132:135], a[80:83], v[196:203], v21
    s_add_u32 s43, s43, 4096
    buffer_load_dwordx4 a[192:195], v11, s[16:19], s43 offen offset:0 sc1
    ds_write_b64 v111, v[92:93]
    s_bcnt1_i32_b64 s30, s[36:37]
    s_lshl3_add_u32 s40, s30, s40
    v_lshl_add_u32 v112, v112, 2, s47
    v_smfmac_f32_16x16x64_bf16 v[168:171], a[80:83], v[228:235], v21
    v_and_b32 v114, 0x30c, v114
    v_cndmask_b32 v112, v118, v112, s[44:45]
    v_add3_u32 v113, v116, v114, s29
    v_and_b32 v114, 0x3fff, v92
    s_waitcnt vmcnt(30)
    v_cndmask_b32 v110, v118, v113, s[44:45]
    v_smfmac_f32_16x16x64_bf16 v[136:139], a[84:87], v[196:203], v21 abid:1
    buffer_load_dwordx4 a[196:199], v11, s[16:19], s43 offen offset:1024 sc1
    ds_write_b32 v112, v114
    ds_write_b32 v110, v93
    v_and_b32 v110, 8, v94
    v_smfmac_f32_16x16x64_bf16 v[172:175], a[84:87], v[228:235], v21 abid:1
    v_lshrrev_b32 v113, 14, v94
    v_cmp_ne_u32 s[44:45], 0, v110
    v_and_b32 v116, 0x3cf0, v113
    s_waitcnt lgkmcnt(8)
    s_waitcnt vmcnt(30)
    v_lshrrev_b32 v111, 16, v99
    v_smfmac_f32_16x16x64_bf16 v[140:143], a[88:91], v[196:203], v22
    buffer_load_dwordx4 a[200:203], v11, s[16:19], s43 offen offset:2048 sc1
    v_and_b32 v112, 0xffff, v99
    v_smfmac_f32_16x16x64_bf16 v[176:179], a[88:91], v[228:235], v22
    v_sub_u32 v110, 15, v111
    v_and_b32 v99, 2.0, v94
    v_add3_u32 v99, v112, v111, v99
    v_cndmask_b32 v110, v112, v110, s[44:45]
    s_waitcnt vmcnt(30)
    v_cmp_gt_u32 s[44:45], 16, v99
    v_smfmac_f32_16x16x64_bf16 v[144:147], a[92:95], v[196:203], v22 abid:1
    buffer_load_dwordx4 a[204:207], v11, s[16:19], s43 offen offset:3072 sc1
    v_cmp_gt_u32 s[36:37], 2.0, v99
    v_smfmac_f32_16x16x64_bf16 v[180:183], a[92:95], v[228:235], v22 abid:1
    v_lshlrev_b32 v110, 2, v110
    s_waitcnt vmcnt(30)
    v_lshrrev_b64 v[112:113], v110, s[50:51]
    v_smfmac_f32_16x16x64_bf16 v[148:151], a[96:99], v[196:203], v23
    s_add_u32 s43, s43, 4096
    buffer_load_dwordx4 a[208:211], v11, s[16:19], s43 offen offset:0 sc1
    s_andn2_b64 s[36:37], s[36:37], s[44:45]
    v_lshrrev_b64 v[114:115], v110, s[52:53]
    v_smfmac_f32_16x16x64_bf16 v[184:187], a[96:99], v[228:235], v23
    v_bfe_u32 v110, v94, 24, 4
    v_mbcnt_lo_u32_b32 v111, s36, 0
    v_and_b32 v112, 15, v112
    v_mbcnt_hi_u32_b32 v111, s37, v111
    v_and_b32 v114, 15, v114
    s_waitcnt vmcnt(30)
    v_lshl_add_u32 v111, v111, 3, s40
    v_smfmac_f32_16x16x64_bf16 v[152:155], a[100:103], v[196:203], v23 abid:1
    buffer_load_dwordx4 a[212:215], v11, s[16:19], s43 offen offset:1024 sc1
    v_lshl_add_u32 v112, v110, 4, v112
    v_smfmac_f32_16x16x64_bf16 v[188:191], a[100:103], v[228:235], v23 abid:1
    v_min_u32 v111, s41, v111
    v_mul_u32_u24 v114, 68, v114
    s_waitcnt vmcnt(30)
    v_cndmask_b32 v111, v118, v111, s[36:37]
    v_smfmac_f32_16x16x64_bf16 v[156:159], a[104:107], v[196:203], v49
    buffer_load_dwordx4 v[36:39], v11, s[16:19], s43 offen offset:2048 sc1
    buffer_load_dwordx4 a[216:219], v11, s[16:19], s43 offen offset:3072 sc1
    ds_write_b64 v111, v[94:95]
    s_bcnt1_i32_b64 s30, s[36:37]
    s_lshl3_add_u32 s40, s30, s40
    v_lshl_add_u32 v112, v112, 2, s47
    v_smfmac_f32_16x16x64_bf16 v[192:195], a[104:107], v[228:235], v49
    v_and_b32 v114, 0x30c, v114
    v_cndmask_b32 v112, v118, v112, s[44:45]
    v_add3_u32 v113, v116, v114, s29
    v_and_b32 v114, 0x3fff, v94
    s_waitcnt vmcnt(30)
    s_waitcnt lgkmcnt(6)
    v_cndmask_b32 v110, v118, v113, s[44:45]
    v_smfmac_f32_16x16x64_bf16 v[124:127], a[108:111], v[204:211], v24
    s_add_u32 s43, s43, 4096
    buffer_load_dwordx4 a[220:223], v11, s[16:19], s43 offen offset:0 sc1
    ds_write_b32 v112, v114
    ds_write_b32 v110, v95
    s_waitcnt lgkmcnt(6)
    v_lshrrev_b32 v110, 16, v117
    v_smfmac_f32_16x16x64_bf16 v[160:163], a[108:111], v[220:227], v24
    ds_read_b128 v[196:199], v1 offset:4096
    ds_read_b128 v[200:203], v2 offset:4096
    v_and_b32 v117, 0xffff, v117
    v_add_u32 v117, v117, v110
    s_waitcnt vmcnt(30)
    v_cmp_lt_u32 s[34:35], 16, v117
    v_smfmac_f32_16x16x64_bf16 v[128:131], a[112:115], v[204:211], v24 abid:1
    buffer_load_dwordx4 a[224:227], v11, s[16:19], s43 offen offset:1024 sc1
    s_sub_u32 s46, s40, s48
    s_add_u32 s46, s46, 56
    s_lshr_b32 s46, s46, 6
    s_mov_b32 s21, 0
    s_and_b32 s27, s34, 0x1ff
    s_cmp_gt_u32 s46, 4
    s_cselect_b32 s32, 1, s32
    s_or_b32 s32, s32, s33
    s_cbranch_scc1 M_dn
M_dnr:
    ds_read_b128 v[92:95], v9 offset:9792
    s_bcnt1_i32_b32 s30, s27
    s_cmp_gt_u32 s30, 3
    s_cselect_b32 s34, 0, s27
    s_cselect_b32 s80, 0, 1
    s_getpc_b64 s[36:37]
M_pc:
    v_bfe_u32 v110, v11, 4, 4
    v_smfmac_f32_16x16x64_bf16 v[164:167], a[112:115], v[220:227], v24 abid:1
    ds_read_b128 v[228:231], v1 offset:22528
    ds_read_b128 v[232:235], v2 offset:22528
    s_waitcnt vmcnt(30)
    v_smfmac_f32_16x16x64_bf16 v[132:135], a[116:119], v[204:211], v25
    buffer_load_dwordx4 a[228:231], v11, s[16:19], s43 offen offset:2048 sc1
    s_ff1_i32_b32 s81, s34
    s_bitset0_b32 s34, s81
    s_mul_i32 s30, s81, 20
    s_add_u32 s31, s30, M_ovc0-M_pc
    s_add_u32 s30, s30, M_ovl0-M_pc
    s_cmp_lg_u32 s34, 0
    s_cselect_b32 s30, s31, s30
    s_cmp_lt_i32 s81, 0
    s_cselect_b32 s30, M_ovn-M_pc, s30
    s_add_u32 s72, s36, s30
    s_addc_u32 s73, s37, 0
    s_ff1_i32_b32 s82, s34
    s_bitset0_b32 s34, s82
    s_mul_i32 s30, s82, 20
    s_add_u32 s31, s30, M_ovc1-M_pc
    s_add_u32 s30, s30, M_ovl1-M_pc
    s_cmp_lg_u32 s34, 0
    s_cselect_b32 s30, s31, s30
    s_cmp_lt_i32 s82, 0
    s_cselect_b32 s30, M_ovn-M_pc, s30
    v_smfmac_f32_16x16x64_bf16 v[168:171], a[116:119], v[220:227], v25
    s_waitcnt vmcnt(30)
    v_smfmac_f32_16x16x64_bf16 v[136:139], a[120:123], v[204:211], v25 abid:1
    buffer_load_dwordx4 a[232:235], v11, s[16:19], s43 offen offset:3072 sc1
    s_add_u32 s74, s36, s30
    s_addc_u32 s75, s37, 0
    s_ff1_i32_b32 s83, s34
    s_bitset0_b32 s34, s83
    s_mul_i32 s30, s83, 20
    s_add_u32 s31, s30, M_ovc1-M_pc
    s_add_u32 s30, s30, M_ovl2-M_pc
    s_cmp_lg_u32 s34, 0
    s_cselect_b32 s30, s31, s30
    s_cmp_lt_i32 s83, 0
    s_cselect_b32 s30, M_ovn-M_pc, s30
    s_add_u32 s76, s36, s30
    s_addc_u32 s77, s37, 0
    s_waitcnt lgkmcnt(2)
    v_lshrrev_b32 v112, 18, v92
    v_smfmac_f32_16x16x64_bf16 v[172:175], a[120:123], v[220:227], v25 abid:1
    s_waitcnt vmcnt(30)
    v_lshrrev_b32 v113, 18, v94
    v_smfmac_f32_16x16x64_bf16 v[140:143], a[124:127], v[204:211], v26
    s_add_u32 s43, s43, 4096
    buffer_load_dwordx4 a[236:239], v11, s[16:19], s43 offen offset:0 sc1
    v_and_b32 v114, 0x3fff, v92
    v_smfmac_f32_16x16x64_bf16 v[176:179], a[124:127], v[220:227], v26
    s_waitcnt vmcnt(30)
    v_and_b32 v115, 0x3fff, v94
    v_smfmac_f32_16x16x64_bf16 v[144:147], a[128:131], v[204:211], v26 abid:1
    buffer_load_dwordx4 a[240:243], v11, s[16:19], s43 offen offset:1024 sc1
    ds_write_b64 v9, v[114:115] offset:10056
    v_lshl_or_b32 v111, s81, 6, v110
    v_smfmac_f32_16x16x64_bf16 v[180:183], a[128:131], v[220:227], v26 abid:1
    v_cmp_eq_u32 s[44:45], v112, v111
    v_cmp_eq_u32 s[36:37], v113, v111
    s_nop 0
    v_cndmask_b32 v54, 0, v93, s[44:45]
    v_cndmask_b32 v55, 0, v95, s[36:37]
    v_lshl_or_b32 v111, s82, 6, v110
    s_waitcnt vmcnt(30)
    v_cmp_eq_u32 s[44:45], v112, v111
    v_smfmac_f32_16x16x64_bf16 v[148:151], a[132:135], v[204:211], v27
    buffer_load_dwordx4 a[244:247], v11, s[16:19], s43 offen offset:2048 sc1
    v_cmp_eq_u32 s[36:37], v113, v111
    v_smfmac_f32_16x16x64_bf16 v[184:187], a[132:135], v[220:227], v27
    v_cndmask_b32 v252, 0, v93, s[44:45]
    v_cndmask_b32 v253, 0, v95, s[36:37]
    v_lshl_or_b32 v111, s83, 6, v110
    v_cmp_eq_u32 s[44:45], v112, v111
    v_cmp_eq_u32 s[36:37], v113, v111
    s_nop 0
    s_waitcnt vmcnt(30)
    v_cndmask_b32 v254, 0, v93, s[44:45]
    v_smfmac_f32_16x16x64_bf16 v[152:155], a[136:139], v[204:211], v27 abid:1
    buffer_load_dwordx4 a[248:251], v11, s[16:19], s43 offen offset:3072 sc1
    v_cndmask_b32 v255, 0, v95, s[36:37]
    v_smfmac_f32_16x16x64_bf16 v[188:191], a[136:139], v[220:227], v27 abid:1
    ds_read_b128 v[236:239], v9 offset:9408
    ds_read_b64 v[216:217], v9 offset:10056
    s_waitcnt vmcnt(30)
    v_smfmac_f32_16x16x64_bf16 v[156:159], a[140:143], v[204:211], v49 abid:1
    s_add_u32 s43, s43, 4096
    buffer_load_dwordx4 v[40:43], v11, s[16:19], s43 offen offset:0 sc1
    buffer_load_dwordx4 a[252:255], v11, s[16:19], s43 offen offset:1024 sc1
    s_waitcnt lgkmcnt(1)
    v_xad_u32 v236, v236, v3, v4
    v_smfmac_f32_16x16x64_bf16 v[192:195], a[140:143], v[220:227], v49 abid:1
    s_waitcnt vmcnt(30)
    v_xad_u32 v237, v237, v3, v4
    v_smfmac_f32_16x16x64_bf16 v[124:127], a[144:147], v[196:203], v28
    buffer_load_dwordx4 v[56:59], v11, s[16:19], s43 offen offset:2048 sc1
    ds_read2st64_b32 v[244:245], v236 offset0:0 offset1:72
    ds_read2st64_b32 v[246:247], v237 offset0:0 offset1:72
    v_xad_u32 v238, v238, v3, v4
    v_smfmac_f32_16x16x64_bf16 v[160:163], a[144:147], v[228:235], v28
    ds_read_b128 v[204:207], v1 offset:5120
    ds_read_b128 v[208:211], v2 offset:5120
    s_waitcnt vmcnt(30)
    v_xad_u32 v239, v239, v3, v4
    v_smfmac_f32_16x16x64_bf16 v[128:131], a[148:151], v[196:203], v28 abid:1
    buffer_load_dwordx4 v[60:63], v11, s[16:19], s43 offen offset:3072 sc1
    ds_read2st64_b32 v[248:249], v238 offset0:0 offset1:72
    ds_read2st64_b32 v[250:251], v239 offset0:0 offset1:72
    ds_read_b128 v[240:243], v8 offset:3072
    ds_read_b128 v[236:239], v9 offset:9280
    s_waitcnt lgkmcnt(8)
    v_xad_u32 v212, v216, v3, v4
    v_smfmac_f32_16x16x64_bf16 v[164:167], a[148:151], v[228:235], v28 abid:1
    ds_read_b128 v[220:223], v1 offset:23552
    ds_read_b128 v[224:227], v2 offset:23552
    ds_read2st64_b32 v[212:213], v212 offset0:0 offset1:72
    s_waitcnt vmcnt(30)
    v_xad_u32 v214, v217, v3, v4
    v_smfmac_f32_16x16x64_bf16 v[132:135], a[152:155], v[196:203], v29
    s_add_u32 s43, s43, 4096
    buffer_load_dwordx4 v[64:67], v11, s[16:19], s43 offen offset:0 sc1
    ds_read2st64_b32 v[214:215], v214 offset0:0 offset1:72
    v_smfmac_f32_16x16x64_bf16 v[168:171], a[152:155], v[228:235], v29
    s_waitcnt vmcnt(30)
    v_smfmac_f32_16x16x64_bf16 v[136:139], a[156:159], v[196:203], v29 abid:1
    buffer_load_dwordx4 v[68:71], v11, s[16:19], s43 offen offset:1024 sc1
    v_smfmac_f32_16x16x64_bf16 v[172:175], a[156:159], v[228:235], v29 abid:1
    s_waitcnt vmcnt(30)
    v_smfmac_f32_16x16x64_bf16 v[140:143], a[160:163], v[196:203], v30
    buffer_load_dwordx4 v[72:75], v11, s[16:19], s43 offen offset:2048 sc1
    s_waitcnt lgkmcnt(5)
    v_smfmac_f32_16x16x64_bf16 v[136:139], v[240:243], v[244:251], v10
    v_smfmac_f32_16x16x64_bf16 v[172:175], v[240:243], v[244:251], v10 abid:1
    s_waitcnt lgkmcnt(4)
    v_xad_u32 v236, v236, v3, v4
    v_smfmac_f32_16x16x64_bf16 v[176:179], a[160:163], v[228:235], v30
    s_waitcnt vmcnt(30)
    v_xad_u32 v237, v237, v3, v4
    v_smfmac_f32_16x16x64_bf16 v[144:147], a[164:167], v[196:203], v30 abid:1
    buffer_load_dwordx4 v[76:79], v11, s[16:19], s43 offen offset:3072 sc1
    ds_read2st64_b32 v[244:245], v236 offset0:0 offset1:72
    ds_read2st64_b32 v[246:247], v237 offset0:0 offset1:72
    v_xad_u32 v238, v238, v3, v4
    v_smfmac_f32_16x16x64_bf16 v[180:183], a[164:167], v[228:235], v30 abid:1
    s_waitcnt vmcnt(30)
    v_xad_u32 v239, v239, v3, v4
    v_smfmac_f32_16x16x64_bf16 v[148:151], a[168:171], v[196:203], v31
    s_add_u32 s43, s43, 4096
    buffer_load_dwordx4 v[80:83], v11, s[16:19], s43 offen offset:0 sc1
    ds_read2st64_b32 v[248:249], v238 offset0:0 offset1:72
    ds_read2st64_b32 v[250:251], v239 offset0:0 offset1:72
    ds_read_b128 v[240:243], v8 offset:1024
    ds_read_b128 v[236:239], v9 offset:9344
    v_smfmac_f32_16x16x64_bf16 v[184:187], a[168:171], v[228:235], v31
    s_waitcnt vmcnt(30)
    v_smfmac_f32_16x16x64_bf16 v[152:155], a[172:175], v[196:203], v31 abid:1
    buffer_load_dwordx4 v[84:87], v11, s[16:19], s43 offen offset:1024 sc1
    s_waitcnt lgkmcnt(6)
    s_cmp_lt_i32 s81, 0
    s_cbranch_scc1 M_ovr0
    s_swappc_b64 s[78:79], s[72:73]
M_ovr0:
    v_smfmac_f32_16x16x64_bf16 v[188:191], a[172:175], v[228:235], v31 abid:1
    s_waitcnt vmcnt(30)
    v_smfmac_f32_16x16x64_bf16 v[156:159], a[176:179], v[196:203], v50
    buffer_load_dwordx4 v[44:47], v11, s[16:19], s43 offen offset:2048 sc1
    buffer_load_dwordx4 v[88:91], v11, s[16:19], s43 offen offset:3072 sc1
    v_smfmac_f32_16x16x64_bf16 v[192:195], a[176:179], v[228:235], v50
    s_waitcnt vmcnt(30)
    v_smfmac_f32_16x16x64_bf16 v[124:127], a[180:183], v[204:211], v32
    s_add_u32 s43, s43, 4096
    buffer_load_dwordx4 v[92:95], v11, s[16:19], s43 offen offset:0 sc1
    s_waitcnt lgkmcnt(1)
    v_smfmac_f32_16x16x64_bf16 v[128:131], v[240:243], v[244:251], v10
    v_smfmac_f32_16x16x64_bf16 v[164:167], v[240:243], v[244:251], v10 abid:1
    s_waitcnt lgkmcnt(0)
    v_xad_u32 v236, v236, v3, v4
    v_smfmac_f32_16x16x64_bf16 v[160:163], a[180:183], v[220:227], v32
    ds_read_b128 v[196:199], v1 offset:6144
    ds_read_b128 v[200:203], v2 offset:6144
    s_waitcnt vmcnt(30)
    v_xad_u32 v237, v237, v3, v4
    v_smfmac_f32_16x16x64_bf16 v[128:131], a[184:187], v[204:211], v32 abid:1
    buffer_load_dwordx4 v[96:99], v11, s[16:19], s43 offen offset:1024 sc1
    ds_read2st64_b32 v[244:245], v236 offset0:0 offset1:72
    ds_read2st64_b32 v[246:247], v237 offset0:0 offset1:72
    v_xad_u32 v238, v238, v3, v4
    v_smfmac_f32_16x16x64_bf16 v[164:167], a[184:187], v[220:227], v32 abid:1
    ds_read_b128 v[228:231], v1 offset:24576
    ds_read_b128 v[232:235], v2 offset:24576
    s_waitcnt vmcnt(30)
    v_xad_u32 v239, v239, v3, v4
    v_smfmac_f32_16x16x64_bf16 v[132:135], a[188:191], v[204:211], v33
    buffer_load_dwordx4 v[100:103], v11, s[16:19], s43 offen offset:2048 sc1
    ds_read2st64_b32 v[248:249], v238 offset0:0 offset1:72
    ds_read2st64_b32 v[250:251], v239 offset0:0 offset1:72
    ds_read_b128 v[240:243], v8 offset:2048
    ds_read_b128 v[236:239], v9 offset:9216
    v_smfmac_f32_16x16x64_bf16 v[168:171], a[188:191], v[220:227], v33
    s_waitcnt vmcnt(30)
    v_smfmac_f32_16x16x64_bf16 v[136:139], a[192:195], v[204:211], v33 abid:1
    buffer_load_dwordx4 v[104:107], v11, s[16:19], s43 offen offset:3072 sc1
    v_smfmac_f32_16x16x64_bf16 v[172:175], a[192:195], v[220:227], v33 abid:1
    s_waitcnt vmcnt(30)
    v_smfmac_f32_16x16x64_bf16 v[140:143], a[196:199], v[204:211], v34
    s_add_u32 s43, s43, 4096
    buffer_load_dwordx4 v[108:111], v11, s[16:19], s43 offen offset:0 sc1
    v_smfmac_f32_16x16x64_bf16 v[176:179], a[196:199], v[220:227], v34
    s_waitcnt vmcnt(30)
    v_smfmac_f32_16x16x64_bf16 v[144:147], a[200:203], v[204:211], v34 abid:1
    buffer_load_dwordx4 v[112:115], v11, s[16:19], s43 offen offset:1024 sc1
    s_waitcnt lgkmcnt(1)
    v_smfmac_f32_16x16x64_bf16 v[132:135], v[240:243], v[244:251], v10
    v_smfmac_f32_16x16x64_bf16 v[168:171], v[240:243], v[244:251], v10 abid:1
    s_waitcnt lgkmcnt(0)
    v_xad_u32 v236, v236, v3, v4
    v_smfmac_f32_16x16x64_bf16 v[180:183], a[200:203], v[220:227], v34 abid:1
    s_waitcnt vmcnt(30)
    v_xad_u32 v237, v237, v3, v4
    v_smfmac_f32_16x16x64_bf16 v[148:151], a[204:207], v[204:211], v35
    buffer_load_dwordx4 v[116:119], v11, s[16:19], s43 offen offset:2048 sc1
    ds_read2st64_b32 v[244:245], v236 offset0:0 offset1:72
    ds_read2st64_b32 v[246:247], v237 offset0:0 offset1:72
    v_xad_u32 v238, v238, v3, v4
    v_smfmac_f32_16x16x64_bf16 v[184:187], a[204:207], v[220:227], v35
    s_waitcnt vmcnt(30)
    v_xad_u32 v239, v239, v3, v4
    v_smfmac_f32_16x16x64_bf16 v[152:155], a[208:211], v[204:211], v35 abid:1
    buffer_load_dwordx4 v[120:123], v11, s[16:19], s43 offen offset:3072 sc1
    ds_read2st64_b32 v[248:249], v238 offset0:0 offset1:72
    ds_read2st64_b32 v[250:251], v239 offset0:0 offset1:72
    ds_read_b128 v[240:243], v8 offset:0
    ds_read_b128 v[236:239], v9 offset:9728
    v_smfmac_f32_16x16x64_bf16 v[188:191], a[208:211], v[220:227], v35 abid:1
    s_waitcnt vmcnt(30)
    v_smfmac_f32_16x16x64_bf16 v[156:159], a[212:215], v[204:211], v50 abid:1
    s_add_u32 m0, s29, 11840
    s_nop 0
    buffer_load_dword v0, s[8:11], 0 offen lds
    v_smfmac_f32_16x16x64_bf16 v[192:195], a[212:215], v[220:227], v50 abid:1
    s_waitcnt vmcnt(29)
    v_smfmac_f32_16x16x64_bf16 v[124:127], a[216:219], v[196:203], v36
    v_smfmac_f32_16x16x64_bf16 v[160:163], a[216:219], v[228:235], v36
    ds_read_b128 v[204:207], v1 offset:7168
    ds_read_b128 v[208:211], v2 offset:7168
    s_waitcnt vmcnt(28)
    v_smfmac_f32_16x16x64_bf16 v[128:131], a[220:223], v[196:203], v36 abid:1
    s_waitcnt lgkmcnt(3)
    v_smfmac_f32_16x16x64_bf16 v[124:127], v[240:243], v[244:251], v10
    v_smfmac_f32_16x16x64_bf16 v[160:163], v[240:243], v[244:251], v10 abid:1
    s_waitcnt lgkmcnt(2)
    v_xad_u32 v236, v236, v3, v4
    v_smfmac_f32_16x16x64_bf16 v[164:167], a[220:223], v[228:235], v36 abid:1
    ds_read_b128 v[220:223], v1 offset:25600
    ds_read_b128 v[224:227], v2 offset:25600
    s_waitcnt vmcnt(27)
    v_xad_u32 v237, v237, v3, v4
    v_smfmac_f32_16x16x64_bf16 v[132:135], a[224:227], v[196:203], v37
    ds_read2st64_b32 v[244:245], v236 offset0:0 offset1:72
    ds_read2st64_b32 v[246:247], v237 offset0:0 offset1:72
    v_xad_u32 v238, v238, v3, v4
    v_smfmac_f32_16x16x64_bf16 v[168:171], a[224:227], v[228:235], v37
    s_waitcnt vmcnt(26)
    v_xad_u32 v239, v239, v3, v4
    v_smfmac_f32_16x16x64_bf16 v[136:139], a[228:231], v[196:203], v37 abid:1
    ds_read2st64_b32 v[248:249], v238 offset0:0 offset1:72
    ds_read2st64_b32 v[250:251], v239 offset0:0 offset1:72
    ds_read_b128 v[240:243], v8 offset:8192
    ds_read_b128 v[236:239], v9 offset:9664
    v_smfmac_f32_16x16x64_bf16 v[172:175], a[228:231], v[228:235], v37 abid:1
    s_waitcnt vmcnt(25)
    v_smfmac_f32_16x16x64_bf16 v[140:143], a[232:235], v[196:203], v38
    v_smfmac_f32_16x16x64_bf16 v[176:179], a[232:235], v[228:235], v38
    s_waitcnt vmcnt(24)
    v_smfmac_f32_16x16x64_bf16 v[144:147], a[236:239], v[196:203], v38 abid:1
    v_smfmac_f32_16x16x64_bf16 v[180:183], a[236:239], v[228:235], v38 abid:1
    s_waitcnt vmcnt(23)
    v_smfmac_f32_16x16x64_bf16 v[148:151], a[240:243], v[196:203], v39
    s_mov_b32 m0, s42
    s_nop 0
    buffer_load_dwordx4 v5, s[8:11], s22 offen offset:0 nt lds
    s_waitcnt lgkmcnt(1)
    v_smfmac_f32_16x16x64_bf16 v[156:159], v[240:243], v[244:251], v10
    v_smfmac_f32_16x16x64_bf16 v[192:195], v[240:243], v[244:251], v10 abid:1
    s_waitcnt lgkmcnt(0)
    v_xad_u32 v236, v236, v3, v4
    v_smfmac_f32_16x16x64_bf16 v[184:187], a[240:243], v[228:235], v39
    s_waitcnt vmcnt(23)
    v_xad_u32 v237, v237, v3, v4
    v_smfmac_f32_16x16x64_bf16 v[152:155], a[244:247], v[196:203], v39 abid:1
    ds_read2st64_b32 v[244:245], v236 offset0:0 offset1:72
    ds_read2st64_b32 v[246:247], v237 offset0:0 offset1:72
    v_xad_u32 v238, v238, v3, v4
    v_smfmac_f32_16x16x64_bf16 v[188:191], a[244:247], v[228:235], v39 abid:1
    s_waitcnt vmcnt(22)
    v_xad_u32 v239, v239, v3, v4
    v_smfmac_f32_16x16x64_bf16 v[156:159], a[248:251], v[196:203], v51
    s_add_u32 m0, m0, 896
    s_nop 0
    buffer_load_dwordx4 v5, s[8:11], s22 offen offset:128 nt lds
    ds_read2st64_b32 v[248:249], v238 offset0:0 offset1:72
    ds_read2st64_b32 v[250:251], v239 offset0:0 offset1:72
    ds_read_b128 v[240:243], v8 offset:7168
    ds_read_b128 v[236:239], v9 offset:9536
    v_smfmac_f32_16x16x64_bf16 v[192:195], a[248:251], v[228:235], v51
    s_waitcnt vmcnt(21)
    v_smfmac_f32_16x16x64_bf16 v[124:127], a[252:255], v[204:211], v40
    ds_read_b128 v[196:199], v1 offset:8192
    ds_read_b128 v[200:203], v2 offset:8192
    s_waitcnt vmcnt(20)
    v_smfmac_f32_16x16x64_bf16 v[128:131], v[56:59], v[204:211], v40 abid:1
    s_add_u32 m0, m0, 896
    s_nop 0
    buffer_load_dwordx4 v5, s[8:11], s22 offen offset:256 nt lds
    ds_read_b128 v[228:231], v1 offset:26624
    ds_read_b128 v[232:235], v2 offset:26624
    s_waitcnt vmcnt(20)
    v_smfmac_f32_16x16x64_bf16 v[132:135], v[60:63], v[204:211], v41
    s_waitcnt lgkmcnt(5)
    v_smfmac_f32_16x16x64_bf16 v[152:155], v[240:243], v[244:251], v10
    v_smfmac_f32_16x16x64_bf16 v[188:191], v[240:243], v[244:251], v10 abid:1
    s_waitcnt lgkmcnt(4)
    v_xad_u32 v236, v236, v3, v4
    s_waitcnt vmcnt(19)
    v_xad_u32 v237, v237, v3, v4
    v_smfmac_f32_16x16x64_bf16 v[136:139], v[64:67], v[204:211], v41 abid:1
    s_add_u32 m0, m0, 896
    s_nop 0
    buffer_load_dwordx4 v5, s[8:11], s22 offen offset:384 nt lds
    ds_read2st64_b32 v[244:245], v236 offset0:0 offset1:72
    ds_read2st64_b32 v[246:247], v237 offset0:0 offset1:72
    v_xad_u32 v238, v238, v3, v4
    s_waitcnt vmcnt(19)
    v_xad_u32 v239, v239, v3, v4
    v_smfmac_f32_16x16x64_bf16 v[140:143], v[68:71], v[204:211], v42
    ds_read2st64_b32 v[248:249], v238 offset0:0 offset1:72
    ds_read2st64_b32 v[250:251], v239 offset0:0 offset1:72
    ds_read_b128 v[240:243], v8 offset:5120
    ds_read_b128 v[236:239], v9 offset:9600
    s_waitcnt vmcnt(18)
    v_smfmac_f32_16x16x64_bf16 v[144:147], v[72:75], v[204:211], v42 abid:1
    s_waitcnt vmcnt(17)
    v_smfmac_f32_16x16x64_bf16 v[148:151], v[76:79], v[204:211], v43
    s_waitcnt vmcnt(16)
    v_smfmac_f32_16x16x64_bf16 v[152:155], v[80:83], v[204:211], v43 abid:1
    s_waitcnt lgkmcnt(1)
    v_smfmac_f32_16x16x64_bf16 v[144:147], v[240:243], v[244:251], v10
    v_smfmac_f32_16x16x64_bf16 v[180:183], v[240:243], v[244:251], v10 abid:1
    s_waitcnt lgkmcnt(0)
    v_xad_u32 v236, v236, v3, v4
    s_waitcnt vmcnt(15)
    v_xad_u32 v237, v237, v3, v4
    v_smfmac_f32_16x16x64_bf16 v[156:159], v[84:87], v[204:211], v51 abid:1
    ds_read2st64_b32 v[244:245], v236 offset0:0 offset1:72
    ds_read2st64_b32 v[246:247], v237 offset0:0 offset1:72
    v_xad_u32 v238, v238, v3, v4
    s_waitcnt vmcnt(13)
    v_xad_u32 v239, v239, v3, v4
    v_smfmac_f32_16x16x64_bf16 v[124:127], v[88:91], v[196:203], v44
    ds_read2st64_b32 v[248:249], v238 offset0:0 offset1:72
    ds_read2st64_b32 v[250:251], v239 offset0:0 offset1:72
    ds_read_b128 v[240:243], v8 offset:6144
    ds_read_b128 v[236:239], v9 offset:9472
    s_waitcnt vmcnt(12)
    v_smfmac_f32_16x16x64_bf16 v[128:131], v[92:95], v[196:203], v44 abid:1
    s_waitcnt vmcnt(11)
    v_smfmac_f32_16x16x64_bf16 v[132:135], v[96:99], v[196:203], v45
    s_waitcnt vmcnt(10)
    v_smfmac_f32_16x16x64_bf16 v[136:139], v[100:103], v[196:203], v45 abid:1
    s_waitcnt lgkmcnt(1)
    v_smfmac_f32_16x16x64_bf16 v[148:151], v[240:243], v[244:251], v10
    v_smfmac_f32_16x16x64_bf16 v[184:187], v[240:243], v[244:251], v10 abid:1
    s_waitcnt lgkmcnt(0)
    v_xad_u32 v236, v236, v3, v4
    s_waitcnt vmcnt(9)
    v_xad_u32 v237, v237, v3, v4
    v_smfmac_f32_16x16x64_bf16 v[140:143], v[104:107], v[196:203], v46
    ds_read2st64_b32 v[244:245], v236 offset0:0 offset1:72
    ds_read2st64_b32 v[246:247], v237 offset0:0 offset1:72
    v_xad_u32 v238, v238, v3, v4
    s_waitcnt vmcnt(8)
    v_xad_u32 v239, v239, v3, v4
    v_smfmac_f32_16x16x64_bf16 v[144:147], v[108:111], v[196:203], v46 abid:1
    ds_read2st64_b32 v[248:249], v238 offset0:0 offset1:72
    ds_read2st64_b32 v[250:251], v239 offset0:0 offset1:72
    ds_read_b128 v[240:243], v8 offset:4096
    s_waitcnt vmcnt(7)
    v_smfmac_f32_16x16x64_bf16 v[148:151], v[112:115], v[196:203], v47
    s_waitcnt vmcnt(6)
    v_smfmac_f32_16x16x64_bf16 v[152:155], v[116:119], v[196:203], v47 abid:1
    s_waitcnt vmcnt(5)
    v_smfmac_f32_16x16x64_bf16 v[156:159], v[120:123], v[196:203], v52
    s_waitcnt lgkmcnt(0)
    v_smfmac_f32_16x16x64_bf16 v[140:143], v[240:243], v[244:251], v10
    v_smfmac_f32_16x16x64_bf16 v[176:179], v[240:243], v[244:251], v10 abid:1
    s_cmp_gt_u32 s46, s80
    s_cbranch_scc1 M_slow
M_slowr0:
    s_cmp_eq_u32 s20, 0
    s_mov_b32 s31, 1073903880
    s_cselect_b32 s30, 162048, s31
    v_mov_b32 v11, s31
    v_writelane_b32 v11, s30, 0
    v_cvt_pk_bf16_f32 v124, v124, v125
    v_cvt_pk_bf16_f32 v125, v126, v127
    v_cvt_pk_bf16_f32 v126, v128, v129
    v_cvt_pk_bf16_f32 v127, v130, v131
    v_cvt_pk_bf16_f32 v132, v132, v133
    v_cvt_pk_bf16_f32 v133, v134, v135
    v_cvt_pk_bf16_f32 v134, v136, v137
    v_cvt_pk_bf16_f32 v135, v138, v139
    ds_read_b128 v[136:139], v9 offset:10432
    v_cndmask_b32_dpp v128, v124, v132, vcc row_ror:8 row_mask:0xf bank_mask:0xf
    v_cndmask_b32_dpp v129, v125, v133, vcc row_ror:8 row_mask:0xf bank_mask:0xf
    v_cndmask_b32_dpp v130, v126, v134, vcc row_ror:8 row_mask:0xf bank_mask:0xf
    v_cndmask_b32_dpp v131, v127, v135, vcc row_ror:8 row_mask:0xf bank_mask:0xf
    buffer_store_dwordx4 v[128:131], v6, s[12:15], s59 offen offset:0 sc1
    v_mov_b32_dpp v124, v132 row_ror:8 row_mask:0xf bank_mask:0xc
    v_mov_b32_dpp v125, v133 row_ror:8 row_mask:0xf bank_mask:0xc
    v_mov_b32_dpp v126, v134 row_ror:8 row_mask:0xf bank_mask:0xc
    v_mov_b32_dpp v127, v135 row_ror:8 row_mask:0xf bank_mask:0xc
    buffer_store_dwordx4 v[124:127], v6, s[12:15], s24 offen offset:0 sc1
    ds_read_b128 v[128:131], v9 offset:10304
    ds_read_b128 v[132:135], v9 offset:10368
    ds_read_b128 v[124:127], v9 offset:10240
    v_cvt_pk_bf16_f32 v140, v140, v141
    v_cvt_pk_bf16_f32 v141, v142, v143
    v_cvt_pk_bf16_f32 v142, v144, v145
    v_cvt_pk_bf16_f32 v143, v146, v147
    v_cvt_pk_bf16_f32 v148, v148, v149
    v_cvt_pk_bf16_f32 v149, v150, v151
    v_cvt_pk_bf16_f32 v150, v152, v153
    v_cvt_pk_bf16_f32 v151, v154, v155
    ds_read_b128 v[152:155], v9 offset:10688
    v_cndmask_b32_dpp v144, v140, v148, vcc row_ror:8 row_mask:0xf bank_mask:0xf
    v_cndmask_b32_dpp v145, v141, v149, vcc row_ror:8 row_mask:0xf bank_mask:0xf
    v_cndmask_b32_dpp v146, v142, v150, vcc row_ror:8 row_mask:0xf bank_mask:0xf
    v_cndmask_b32_dpp v147, v143, v151, vcc row_ror:8 row_mask:0xf bank_mask:0xf
    buffer_store_dwordx4 v[144:147], v6, s[12:15], s59 offen offset:128 sc1
    v_mov_b32_dpp v140, v148 row_ror:8 row_mask:0xf bank_mask:0xc
    v_mov_b32_dpp v141, v149 row_ror:8 row_mask:0xf bank_mask:0xc
    v_mov_b32_dpp v142, v150 row_ror:8 row_mask:0xf bank_mask:0xc
    v_mov_b32_dpp v143, v151 row_ror:8 row_mask:0xf bank_mask:0xc
    buffer_store_dwordx4 v[140:143], v6, s[12:15], s24 offen offset:128 sc1
    ds_read_b128 v[144:147], v9 offset:10560
    ds_read_b128 v[148:151], v9 offset:10624
    ds_read_b128 v[140:143], v9 offset:10496
    v_cvt_pk_bf16_f32 v156, v156, v157
    v_cvt_pk_bf16_f32 v157, v158, v159
    ds_write_b64 v53, v[156:157] offset:25728
    ds_read_b128 v[156:159], v9 offset:10752
    s_mov_b32 s89, 0
    s_mov_b32 s101, 34209792
    s_mov_b32 s91, 0
    s_mov_b32 s25, 36864
    s_add_u32 s90, s24, 9437184
    s_mov_b32 s28, s26
    s_add_u32 s23, s24, 18432
    s_cmp_lt_u32 s20, 2
    s_cselect_b32 s66, s23, s24
    s_cselect_b32 s99, s14, 74612736
    s_add_u32 s66, s66, s95
    v_add_u32 v4, 36864, v4
    v_add_u32 v1, 36864, v1
    v_add_u32 v2, 36864, v2
M_top:
M_top1:
    s_add_u32 s23, s24, 18432
    s_add_u32 s58, s24, 27648
    s_mov_b32 s24, s90
    s_add_u32 s59, s90, 9216
    s_waitcnt lgkmcnt(0)
    s_barrier
    ds_read_b128 v[244:247], v8 offset:10816
    v_smfmac_f32_16x16x64_bf16 v[160:163], a[252:255], v[220:227], v40
    ds_read_b128 v[196:199], v1 offset:0
    v_smfmac_f32_16x16x64_bf16 v[160:163], v[88:91], v[228:235], v44
    ds_read_b128 v[200:203], v2 offset:0
    s_cmp_lt_u32 s22, 75497472
    s_cbranch_scc0 M_bF
    s_cmp_eq_u32 s91, 1
    s_cbranch_scc1 M_bE0
M_bL:
    v_smfmac_f32_16x16x64_bf16 v[164:167], v[56:59], v[220:227], v40 abid:1
    ds_read_b128 v[204:207], v1 offset:1024
    s_cmp_lt_u32 s22, 74612736
    s_cselect_b32 s30, 1, 0
    v_smfmac_f32_16x16x64_bf16 v[164:167], v[92:95], v[228:235], v44 abid:1
    ds_read_b128 v[208:211], v2 offset:1024
    v_mov_b32 v0, s30
    v_smfmac_f32_16x16x64_bf16 v[168:171], v[60:63], v[220:227], v41
    ds_read_b128 v[212:215], v1 offset:2048
    v_smfmac_f32_16x16x64_bf16 v[168:171], v[96:99], v[228:235], v45
    ds_read_b128 v[216:219], v2 offset:2048
    v_smfmac_f32_16x16x64_bf16 v[172:175], v[64:67], v[220:227], v41 abid:1
    s_waitcnt vmcnt(6)
    s_waitcnt lgkmcnt(6)
    buffer_store_dwordx4 v[244:247], v7, s[12:15], s66 offen sc1
    v_smfmac_f32_16x16x64_bf16 v[172:175], v[100:103], v[228:235], v45 abid:1
    ds_read_b128 v[236:239], v9 offset:9408
    v_smfmac_f32_16x16x64_bf16 v[176:179], v[68:71], v[220:227], v42
    s_waitcnt vmcnt(6)
    buffer_atomic_add v0, v11, s[16:19], s92 offen sc0 sc1
    s_mov_b32 s21, 1
    v_smfmac_f32_16x16x64_bf16 v[176:179], v[104:107], v[228:235], v46
    v_smfmac_f32_16x16x64_bf16 v[180:183], v[72:75], v[220:227], v42 abid:1
    v_cvt_pk_bf16_f32 v160, v160, v161
    v_smfmac_f32_16x16x64_bf16 v[180:183], v[108:111], v[228:235], v46 abid:1
    v_cvt_pk_bf16_f32 v161, v162, v163
    v_smfmac_f32_16x16x64_bf16 v[184:187], v[76:79], v[220:227], v43
    v_cvt_pk_bf16_f32 v162, v164, v165
    v_smfmac_f32_16x16x64_bf16 v[184:187], v[112:115], v[228:235], v47
    v_cvt_pk_bf16_f32 v163, v166, v167
    v_smfmac_f32_16x16x64_bf16 v[188:191], v[80:83], v[220:227], v43 abid:1
    s_add_u32 m0, m0, 896
    v_cvt_pk_bf16_f32 v168, v168, v169
    v_smfmac_f32_16x16x64_bf16 v[188:191], v[116:119], v[228:235], v47 abid:1
    s_waitcnt vmcnt(6)
    buffer_load_dwordx4 v5, s[8:11], s22 offen offset:512 nt lds
    v_cvt_pk_bf16_f32 v169, v170, v171
    v_smfmac_f32_16x16x64_bf16 v[192:195], v[84:87], v[220:227], v51 abid:1
    v_cvt_pk_bf16_f32 v170, v172, v173
    v_smfmac_f32_16x16x64_bf16 v[192:195], v[120:123], v[228:235], v52
    ds_read_b128 v[220:223], v1 offset:3072
    s_waitcnt lgkmcnt(6)
    v_cvt_pk_bf16_f32 v171, v174, v175
    v_smfmac_f32_16x16x64_bf16 v[124:127], a[0:3], v[196:203], v12
    ds_read_b128 v[224:227], v2 offset:3072
    ds_read_b128 v[172:175], v9 offset:10432
    s_waitcnt lgkmcnt(6)
    v_cndmask_b32_dpp v164, v160, v168, vcc row_ror:8 row_mask:0xf bank_mask:0xf
    v_smfmac_f32_16x16x64_bf16 v[124:127], a[36:39], v[204:211], v16
    ds_read_b128 v[228:231], v1 offset:4096
    s_waitcnt lgkmcnt(5)
    v_cndmask_b32_dpp v165, v161, v169, vcc row_ror:8 row_mask:0xf bank_mask:0xf
    v_smfmac_f32_16x16x64_bf16 v[124:127], a[72:75], v[212:219], v20
    ds_read_b128 v[232:235], v2 offset:4096
    v_cndmask_b32_dpp v166, v162, v170, vcc row_ror:8 row_mask:0xf bank_mask:0xf
    v_smfmac_f32_16x16x64_bf16 v[128:131], a[4:7], v[196:203], v12 abid:1
    s_barrier
    v_cndmask_b32_dpp v167, v163, v171, vcc row_ror:8 row_mask:0xf bank_mask:0xf
    v_smfmac_f32_16x16x64_bf16 v[128:131], a[40:43], v[204:211], v16 abid:1
    s_waitcnt vmcnt(6)
    buffer_store_dwordx4 v[164:167], v6, s[12:15], s58 offen offset:0 sc1
    s_waitcnt lgkmcnt(5)
    v_xad_u32 v236, v236, v3, v4
    v_smfmac_f32_16x16x64_bf16 v[128:131], a[76:79], v[212:219], v20 abid:1
    v_xad_u32 v237, v237, v3, v4
    v_smfmac_f32_16x16x64_bf16 v[132:135], a[8:11], v[196:203], v13
    ds_read2st64_b32 v[244:245], v236 offset0:0 offset1:72
    ds_read_b128 v[240:243], v8 offset:3072
    v_xad_u32 v238, v238, v3, v4
    v_smfmac_f32_16x16x64_bf16 v[132:135], a[44:47], v[204:211], v17
    ds_read2st64_b32 v[246:247], v237 offset0:0 offset1:72
    v_xad_u32 v239, v239, v3, v4
    v_smfmac_f32_16x16x64_bf16 v[132:135], a[80:83], v[212:219], v21
    ds_read2st64_b32 v[248:249], v238 offset0:0 offset1:72
    v_mov_b32_dpp v160, v168 row_ror:8 row_mask:0xf bank_mask:0xc
    v_smfmac_f32_16x16x64_bf16 v[144:147], a[20:23], v[196:203], v14 abid:1
    ds_read2st64_b32 v[250:251], v239 offset0:0 offset1:72
    ds_read_b128 v[236:239], v9 offset:9280
    v_mov_b32_dpp v161, v169 row_ror:8 row_mask:0xf bank_mask:0xc
    v_smfmac_f32_16x16x64_bf16 v[144:147], a[56:59], v[204:211], v18 abid:1
    v_mov_b32_dpp v162, v170 row_ror:8 row_mask:0xf bank_mask:0xc
    v_smfmac_f32_16x16x64_bf16 v[144:147], a[92:95], v[212:219], v22 abid:1
    v_mov_b32_dpp v163, v171 row_ror:8 row_mask:0xf bank_mask:0xc
    v_smfmac_f32_16x16x64_bf16 v[140:143], a[16:19], v[196:203], v14
    s_waitcnt vmcnt(6)
    buffer_store_dwordx4 v[160:163], v6, s[12:15], s23 offen offset:0 sc1
    ds_read_b128 v[164:167], v9 offset:10304
    v_smfmac_f32_16x16x64_bf16 v[140:143], a[52:55], v[204:211], v18
    ds_read_b128 v[168:171], v9 offset:10368
    ds_read_b128 v[160:163], v9 offset:10240
    v_smfmac_f32_16x16x64_bf16 v[140:143], a[88:91], v[212:219], v22
    v_smfmac_f32_16x16x64_bf16 v[136:139], a[12:15], v[196:203], v13 abid:1
    v_smfmac_f32_16x16x64_bf16 v[136:139], a[48:51], v[204:211], v17 abid:1
    v_smfmac_f32_16x16x64_bf16 v[136:139], a[84:87], v[212:219], v21 abid:1
    s_waitcnt lgkmcnt(3)
    v_xad_u32 v236, v236, v3, v4
    v_smfmac_f32_16x16x64_bf16 v[136:139], v[240:243], v[244:251], v10
    v_xad_u32 v237, v237, v3, v4
    v_smfmac_f32_16x16x64_bf16 v[172:175], v[240:243], v[244:251], v10 abid:1
    ds_read2st64_b32 v[244:245], v236 offset0:0 offset1:72
    ds_read_b128 v[240:243], v8 offset:1024
    v_xad_u32 v238, v238, v3, v4
    v_smfmac_f32_16x16x64_bf16 v[148:151], a[24:27], v[196:203], v15
    ds_read2st64_b32 v[246:247], v237 offset0:0 offset1:72
    v_xad_u32 v239, v239, v3, v4
    v_smfmac_f32_16x16x64_bf16 v[148:151], a[60:63], v[204:211], v19
    ds_read2st64_b32 v[248:249], v238 offset0:0 offset1:72
    v_cvt_pk_bf16_f32 v192, v192, v193
    v_smfmac_f32_16x16x64_bf16 v[148:151], a[96:99], v[212:219], v23
    ds_read2st64_b32 v[250:251], v239 offset0:0 offset1:72
    ds_read_b128 v[236:239], v9 offset:9344
    v_cvt_pk_bf16_f32 v193, v194, v195
    v_smfmac_f32_16x16x64_bf16 v[152:155], a[28:31], v[196:203], v15 abid:1
    ds_write_b64 v53, v[192:193] offset:0
    ds_read_b128 v[192:195], v9 offset:10752
    v_smfmac_f32_16x16x64_bf16 v[152:155], a[64:67], v[204:211], v19 abid:1
    s_add_u32 m0, m0, 896
    v_smfmac_f32_16x16x64_bf16 v[152:155], a[100:103], v[212:219], v23 abid:1
    s_waitcnt vmcnt(6)
    buffer_load_dwordx4 v5, s[8:11], s22 offen offset:640 nt lds
    v_smfmac_f32_16x16x64_bf16 v[156:159], a[32:35], v[196:203], v48
    v_smfmac_f32_16x16x64_bf16 v[156:159], a[68:71], v[204:211], v48 abid:1
    v_smfmac_f32_16x16x64_bf16 v[156:159], a[104:107], v[212:219], v49
    ds_read_b128 v[196:199], v1 offset:5120
    v_cvt_pk_bf16_f32 v176, v176, v177
    v_smfmac_f32_16x16x64_bf16 v[124:127], a[108:111], v[220:227], v24
    ds_read_b128 v[200:203], v2 offset:5120
    v_cvt_pk_bf16_f32 v177, v178, v179
    v_smfmac_f32_16x16x64_bf16 v[124:127], a[144:147], v[228:235], v28
    ds_read_b128 v[204:207], v1 offset:6144
    ds_read_b64 v[216:217], v9 offset:10056
    v_cvt_pk_bf16_f32 v178, v180, v181
    v_smfmac_f32_16x16x64_bf16 v[128:131], a[112:115], v[220:227], v24 abid:1
    ds_read_b128 v[208:211], v2 offset:6144
    v_cvt_pk_bf16_f32 v179, v182, v183
    v_smfmac_f32_16x16x64_bf16 v[128:131], a[148:151], v[228:235], v28 abid:1
    s_waitcnt lgkmcnt(7)
    v_xad_u32 v236, v236, v3, v4
    v_smfmac_f32_16x16x64_bf16 v[128:131], v[240:243], v[244:251], v10
    s_add_u32 m0, m0, 896
    v_xad_u32 v237, v237, v3, v4
    v_smfmac_f32_16x16x64_bf16 v[164:167], v[240:243], v[244:251], v10 abid:1
    ds_read2st64_b32 v[244:245], v236 offset0:0 offset1:72
    ds_read_b128 v[240:243], v8 offset:2048
    v_xad_u32 v238, v238, v3, v4
    v_smfmac_f32_16x16x64_bf16 v[152:155], a[136:139], v[220:227], v27 abid:1
    ds_read2st64_b32 v[246:247], v237 offset0:0 offset1:72
    s_waitcnt vmcnt(6)
    v_xad_u32 v239, v239, v3, v4
    v_smfmac_f32_16x16x64_bf16 v[152:155], a[172:175], v[228:235], v31 abid:1
    ds_read2st64_b32 v[248:249], v238 offset0:0 offset1:72
    buffer_load_dwordx4 v5, s[8:11], s22 offen offset:768 nt lds
    v_cvt_pk_bf16_f32 v184, v184, v185
    v_smfmac_f32_16x16x64_bf16 v[136:139], a[120:123], v[220:227], v25 abid:1
    ds_read2st64_b32 v[250:251], v239 offset0:0 offset1:72
    ds_read_b128 v[236:239], v9 offset:9216
    v_cvt_pk_bf16_f32 v185, v186, v187
    v_smfmac_f32_16x16x64_bf16 v[136:139], a[156:159], v[228:235], v29 abid:1
    v_cvt_pk_bf16_f32 v186, v188, v189
    v_smfmac_f32_16x16x64_bf16 v[140:143], a[124:127], v[220:227], v26
    v_cvt_pk_bf16_f32 v187, v190, v191
    v_smfmac_f32_16x16x64_bf16 v[140:143], a[160:163], v[228:235], v30
    ds_read_b128 v[188:191], v9 offset:10688
    v_cndmask_b32_dpp v180, v176, v184, vcc row_ror:8 row_mask:0xf bank_mask:0xf
    v_smfmac_f32_16x16x64_bf16 v[144:147], a[128:131], v[220:227], v26 abid:1
    v_cndmask_b32_dpp v181, v177, v185, vcc row_ror:8 row_mask:0xf bank_mask:0xf
    v_smfmac_f32_16x16x64_bf16 v[144:147], a[164:167], v[228:235], v30 abid:1
    v_cndmask_b32_dpp v182, v178, v186, vcc row_ror:8 row_mask:0xf bank_mask:0xf
    v_smfmac_f32_16x16x64_bf16 v[148:151], a[132:135], v[220:227], v27
    v_cndmask_b32_dpp v183, v179, v187, vcc row_ror:8 row_mask:0xf bank_mask:0xf
    v_smfmac_f32_16x16x64_bf16 v[148:151], a[168:171], v[228:235], v31
    s_waitcnt vmcnt(6)
    buffer_store_dwordx4 v[180:183], v6, s[12:15], s58 offen offset:128 sc1
    s_waitcnt lgkmcnt(8)
    v_xad_u32 v212, v216, v3, v4
    v_smfmac_f32_16x16x64_bf16 v[132:135], a[116:119], v[220:227], v25
    ds_read2st64_b32 v[212:213], v212 offset0:0 offset1:72
    v_xad_u32 v214, v217, v3, v4
    v_smfmac_f32_16x16x64_bf16 v[132:135], a[152:155], v[228:235], v29
    ds_read2st64_b32 v[214:215], v214 offset0:0 offset1:72
    s_waitcnt lgkmcnt(3)
    v_xad_u32 v236, v236, v3, v4
    v_smfmac_f32_16x16x64_bf16 v[132:135], v[240:243], v[244:251], v10
    v_xad_u32 v237, v237, v3, v4
    v_smfmac_f32_16x16x64_bf16 v[168:171], v[240:243], v[244:251], v10 abid:1
    ds_read2st64_b32 v[244:245], v236 offset0:0 offset1:72
    ds_read_b128 v[240:243], v8 offset:0
    v_xad_u32 v238, v238, v3, v4
    v_smfmac_f32_16x16x64_bf16 v[156:159], a[140:143], v[220:227], v49 abid:1
    ds_read2st64_b32 v[246:247], v237 offset0:0 offset1:72
    v_xad_u32 v239, v239, v3, v4
    v_smfmac_f32_16x16x64_bf16 v[156:159], a[176:179], v[228:235], v50
    ds_read2st64_b32 v[248:249], v238 offset0:0 offset1:72
    v_mov_b32_dpp v176, v184 row_ror:8 row_mask:0xf bank_mask:0xc
    v_smfmac_f32_16x16x64_bf16 v[140:143], a[196:199], v[196:203], v34
    ds_read2st64_b32 v[250:251], v239 offset0:0 offset1:72
    ds_read_b128 v[236:239], v9 offset:9728
    v_mov_b32_dpp v177, v185 row_ror:8 row_mask:0xf bank_mask:0xc
    v_smfmac_f32_16x16x64_bf16 v[140:143], a[232:235], v[204:211], v38
    v_mov_b32_dpp v178, v186 row_ror:8 row_mask:0xf bank_mask:0xc
    v_smfmac_f32_16x16x64_bf16 v[128:131], a[184:187], v[196:203], v32 abid:1
    v_mov_b32_dpp v179, v187 row_ror:8 row_mask:0xf bank_mask:0xc
    v_smfmac_f32_16x16x64_bf16 v[128:131], a[220:223], v[204:211], v36 abid:1
    s_waitcnt vmcnt(6)
    buffer_store_dwordx4 v[176:179], v6, s[12:15], s23 offen offset:128 sc1
    ds_read_b128 v[180:183], v9 offset:10560
    v_smfmac_f32_16x16x64_bf16 v[132:135], a[188:191], v[196:203], v33
    ds_read_b128 v[184:187], v9 offset:10624
    ds_read_b128 v[176:179], v9 offset:10496
    v_smfmac_f32_16x16x64_bf16 v[132:135], a[224:227], v[204:211], v37
    v_smfmac_f32_16x16x64_bf16 v[136:139], a[192:195], v[196:203], v33 abid:1
    ds_read_b128 v[220:223], v1 offset:7168
    v_smfmac_f32_16x16x64_bf16 v[136:139], a[228:231], v[204:211], v37 abid:1
    ds_read_b128 v[224:227], v2 offset:7168
    v_smfmac_f32_16x16x64_bf16 v[124:127], a[180:183], v[196:203], v32
    ds_read_b128 v[228:231], v1 offset:8192
    v_smfmac_f32_16x16x64_bf16 v[124:127], a[216:219], v[204:211], v36
    s_waitcnt vmcnt(7)
    s_waitcnt lgkmcnt(6)
    v_xad_u32 v236, v236, v3, v4
    v_smfmac_f32_16x16x64_bf16 v[124:127], v[240:243], v[244:251], v10
    ds_read_b128 v[232:235], v2 offset:8192
    v_xad_u32 v237, v237, v3, v4
    v_smfmac_f32_16x16x64_bf16 v[160:163], v[240:243], v[244:251], v10 abid:1
    ds_read2st64_b32 v[244:245], v236 offset0:0 offset1:72
    ds_read_b128 v[240:243], v8 offset:8192
    v_xad_u32 v238, v238, v3, v4
    v_smfmac_f32_16x16x64_bf16 v[144:147], a[200:203], v[196:203], v34 abid:1
    ds_read2st64_b32 v[246:247], v237 offset0:0 offset1:72
    v_xad_u32 v239, v239, v3, v4
    v_smfmac_f32_16x16x64_bf16 v[144:147], a[236:239], v[204:211], v38 abid:1
    ds_read2st64_b32 v[248:249], v238 offset0:0 offset1:72
    v_mul_u32_u24 v0, s94, v0
    v_smfmac_f32_16x16x64_bf16 v[148:151], a[204:207], v[196:203], v35
    ds_read2st64_b32 v[250:251], v239 offset0:0 offset1:72
    ds_read_b128 v[236:239], v9 offset:9664
    v_add_u32 v0, s93, v0
    v_smfmac_f32_16x16x64_bf16 v[148:151], a[240:243], v[204:211], v39
    s_waitcnt lgkmcnt(10)
    s_cmp_lt_i32 s81, 0
    s_cbranch_scc1 M_ovrL
    s_swappc_b64 s[78:79], s[72:73]
M_ovrL:
    v_smfmac_f32_16x16x64_bf16 v[152:155], a[208:211], v[196:203], v35 abid:1
    ds_write_b32 v11, v0
    v_mov_b32 v0, 162048
    v_smfmac_f32_16x16x64_bf16 v[152:155], a[244:247], v[204:211], v39 abid:1
    s_add_u32 m0, m0, 896
    v_smfmac_f32_16x16x64_bf16 v[156:159], a[212:215], v[196:203], v50 abid:1
    s_waitcnt vmcnt(6)
    buffer_load_dwordx4 v5, s[8:11], s22 offen offset:896 nt lds
    v_smfmac_f32_16x16x64_bf16 v[156:159], a[248:251], v[204:211], v51
    s_waitcnt lgkmcnt(9)
    v_smfmac_f32_16x16x64_bf16 v[124:127], a[252:255], v[220:227], v40
    ds_read_b128 v[196:199], v1 offset:18432
    s_waitcnt lgkmcnt(8)
    v_smfmac_f32_16x16x64_bf16 v[124:127], v[88:91], v[228:235], v44
    ds_read_b128 v[200:203], v2 offset:18432
    v_smfmac_f32_16x16x64_bf16 v[156:159], v[84:87], v[220:227], v51 abid:1
    ds_read_b128 v[204:207], v1 offset:19456
    v_smfmac_f32_16x16x64_bf16 v[156:159], v[120:123], v[228:235], v52
    s_waitcnt lgkmcnt(3)
    s_barrier
    v_xad_u32 v236, v236, v3, v4
    v_smfmac_f32_16x16x64_bf16 v[156:159], v[240:243], v[244:251], v10
    ds_read_b128 v[208:211], v2 offset:19456
    ds_read_b32 v0, v0
    v_xad_u32 v237, v237, v3, v4
    v_smfmac_f32_16x16x64_bf16 v[192:195], v[240:243], v[244:251], v10 abid:1
    ds_read2st64_b32 v[244:245], v236 offset0:0 offset1:72
    ds_read_b128 v[240:243], v8 offset:7168
    v_xad_u32 v238, v238, v3, v4
    v_smfmac_f32_16x16x64_bf16 v[132:135], v[60:63], v[220:227], v41
    ds_read2st64_b32 v[246:247], v237 offset0:0 offset1:72
    v_xad_u32 v239, v239, v3, v4
    v_smfmac_f32_16x16x64_bf16 v[132:135], v[96:99], v[228:235], v45
    ds_read2st64_b32 v[248:249], v238 offset0:0 offset1:72
    s_add_u32 m0, m0, 896
    v_smfmac_f32_16x16x64_bf16 v[136:139], v[64:67], v[220:227], v41 abid:1
    ds_read2st64_b32 v[250:251], v239 offset0:0 offset1:72
    ds_read_b128 v[236:239], v9 offset:9536
    s_waitcnt vmcnt(6)
    v_smfmac_f32_16x16x64_bf16 v[136:139], v[100:103], v[228:235], v45 abid:1
    buffer_load_dwordx4 v5, s[8:11], s22 offen offset:1024 nt lds
    s_waitcnt lgkmcnt(6)
    v_readfirstlane_b32 s88, v0
    v_smfmac_f32_16x16x64_bf16 v[140:143], v[68:71], v[220:227], v42
    s_add_u32 s30, s88, 74612736
    s_lshr_b32 s30, s30, 1
    s_min_u32 s88, s88, s30
    v_smfmac_f32_16x16x64_bf16 v[140:143], v[104:107], v[228:235], v46
    s_min_u32 s88, s88, s14
    v_smfmac_f32_16x16x64_bf16 v[144:147], v[72:75], v[220:227], v42 abid:1
    ds_read_b128 v[212:215], v1 offset:20480
    s_cmp_lt_u32 s22, 74612736
    s_cselect_b32 s88, s88, s14
    v_smfmac_f32_16x16x64_bf16 v[144:147], v[108:111], v[228:235], v46 abid:1
    ds_read_b128 v[216:219], v2 offset:20480
    s_cmp_lt_u32 s88, s99
    s_cselect_b32 s10, 75497472, 0
    v_smfmac_f32_16x16x64_bf16 v[148:151], v[76:79], v[220:227], v43
    s_cmp_lt_u32 s88, s14
    s_cbranch_scc0 M_q
M_nq:
    v_smfmac_f32_16x16x64_bf16 v[148:151], v[112:115], v[228:235], v47
    v_smfmac_f32_16x16x64_bf16 v[152:155], v[80:83], v[220:227], v43 abid:1
    v_smfmac_f32_16x16x64_bf16 v[152:155], v[116:119], v[228:235], v47 abid:1
    s_waitcnt lgkmcnt(2)
    v_xad_u32 v236, v236, v3, v4
    v_smfmac_f32_16x16x64_bf16 v[152:155], v[240:243], v[244:251], v10
    v_xad_u32 v237, v237, v3, v4
    v_smfmac_f32_16x16x64_bf16 v[188:191], v[240:243], v[244:251], v10 abid:1
    s_cmp_gt_u32 s46, s80
    s_cbranch_scc1 M_slow
M_slowrL:
    v_xad_u32 v238, v238, v3, v4
    v_smfmac_f32_16x16x64_bf16 v[128:131], v[56:59], v[220:227], v40 abid:1
    ds_read2st64_b32 v[244:245], v236 offset0:0 offset1:72
    ds_read_b128 v[240:243], v8 offset:5120
    v_xad_u32 v239, v239, v3, v4
    v_smfmac_f32_16x16x64_bf16 v[128:131], v[92:95], v[228:235], v44 abid:1
    ds_read2st64_b32 v[246:247], v237 offset0:0 offset1:72
    v_smfmac_f32_16x16x64_bf16 v[160:163], a[0:3], v[196:203], v12
    ds_read2st64_b32 v[248:249], v238 offset0:0 offset1:72
    v_smfmac_f32_16x16x64_bf16 v[160:163], a[36:39], v[204:211], v16
    ds_read2st64_b32 v[250:251], v239 offset0:0 offset1:72
    ds_read_b128 v[236:239], v9 offset:9600
    s_waitcnt lgkmcnt(6)
    v_smfmac_f32_16x16x64_bf16 v[160:163], a[72:75], v[212:219], v20
    v_smfmac_f32_16x16x64_bf16 v[164:167], a[4:7], v[196:203], v12 abid:1
    s_mov_b32 m0, s28
    v_cvt_pk_bf16_f32 v156, v156, v157
    v_smfmac_f32_16x16x64_bf16 v[164:167], a[40:43], v[204:211], v16 abid:1
    s_waitcnt vmcnt(6)
    buffer_load_dwordx4 v5, s[8:11], s88 offen offset:0 nt lds
    v_cvt_pk_bf16_f32 v157, v158, v159
    v_smfmac_f32_16x16x64_bf16 v[164:167], a[76:79], v[212:219], v20 abid:1
    ds_write_b64 v53, v[156:157] offset:25728
    ds_read_b128 v[156:159], v9 offset:10752
    v_smfmac_f32_16x16x64_bf16 v[180:183], a[20:23], v[196:203], v14 abid:1
    v_smfmac_f32_16x16x64_bf16 v[180:183], a[56:59], v[204:211], v18 abid:1
    ds_read_b128 v[220:223], v1 offset:21504
    v_cvt_pk_bf16_f32 v124, v124, v125
    v_smfmac_f32_16x16x64_bf16 v[180:183], a[92:95], v[212:219], v22 abid:1
    s_waitcnt lgkmcnt(3)
    v_xad_u32 v236, v236, v3, v4
    v_smfmac_f32_16x16x64_bf16 v[180:183], v[240:243], v[244:251], v10 abid:1
    v_xad_u32 v237, v237, v3, v4
    v_smfmac_f32_16x16x64_bf16 v[144:147], v[240:243], v[244:251], v10
    ds_read2st64_b32 v[244:245], v236 offset0:0 offset1:72
    ds_read_b128 v[240:243], v8 offset:6144
    v_xad_u32 v238, v238, v3, v4
    v_smfmac_f32_16x16x64_bf16 v[172:175], a[12:15], v[196:203], v13 abid:1
    ds_read2st64_b32 v[246:247], v237 offset0:0 offset1:72
    v_xad_u32 v239, v239, v3, v4
    v_smfmac_f32_16x16x64_bf16 v[172:175], a[48:51], v[204:211], v17 abid:1
    ds_read2st64_b32 v[248:249], v238 offset0:0 offset1:72
    v_cvt_pk_bf16_f32 v125, v126, v127
    v_smfmac_f32_16x16x64_bf16 v[172:175], a[84:87], v[212:219], v21 abid:1
    ds_read2st64_b32 v[250:251], v239 offset0:0 offset1:72
    ds_read_b128 v[236:239], v9 offset:9472
    v_cvt_pk_bf16_f32 v126, v128, v129
    v_smfmac_f32_16x16x64_bf16 v[176:179], a[16:19], v[196:203], v14
    v_cvt_pk_bf16_f32 v127, v130, v131
    v_smfmac_f32_16x16x64_bf16 v[176:179], a[52:55], v[204:211], v18
    v_cvt_pk_bf16_f32 v132, v132, v133
    v_smfmac_f32_16x16x64_bf16 v[176:179], a[88:91], v[212:219], v22
    v_cvt_pk_bf16_f32 v133, v134, v135
    v_smfmac_f32_16x16x64_bf16 v[168:171], a[8:11], v[196:203], v13
    s_add_u32 m0, m0, 896
    v_cvt_pk_bf16_f32 v134, v136, v137
    v_smfmac_f32_16x16x64_bf16 v[168:171], a[44:47], v[204:211], v17
    s_waitcnt vmcnt(6)
    buffer_load_dwordx4 v5, s[8:11], s88 offen offset:128 nt lds
    v_cvt_pk_bf16_f32 v135, v138, v139
    v_smfmac_f32_16x16x64_bf16 v[168:171], a[80:83], v[212:219], v21
    ds_read_b128 v[224:227], v2 offset:21504
    ds_read_b128 v[136:139], v9 offset:10432
    v_cndmask_b32_dpp v128, v124, v132, vcc row_ror:8 row_mask:0xf bank_mask:0xf
    v_smfmac_f32_16x16x64_bf16 v[184:187], a[24:27], v[196:203], v15
    ds_read_b128 v[228:231], v1 offset:22528
    v_cndmask_b32_dpp v129, v125, v133, vcc row_ror:8 row_mask:0xf bank_mask:0xf
    v_smfmac_f32_16x16x64_bf16 v[184:187], a[60:63], v[204:211], v19
    ds_read_b128 v[232:235], v2 offset:22528
    v_cndmask_b32_dpp v130, v126, v134, vcc row_ror:8 row_mask:0xf bank_mask:0xf
    v_smfmac_f32_16x16x64_bf16 v[184:187], a[96:99], v[212:219], v23
    s_waitcnt lgkmcnt(4)
    v_xad_u32 v236, v236, v3, v4
    v_smfmac_f32_16x16x64_bf16 v[184:187], v[240:243], v[244:251], v10 abid:1
    v_xad_u32 v237, v237, v3, v4
    v_smfmac_f32_16x16x64_bf16 v[148:151], v[240:243], v[244:251], v10
    ds_read2st64_b32 v[244:245], v236 offset0:0 offset1:72
    ds_read_b128 v[240:243], v8 offset:4096
    v_xad_u32 v238, v238, v3, v4
    v_smfmac_f32_16x16x64_bf16 v[188:191], a[28:31], v[196:203], v15 abid:1
    ds_read2st64_b32 v[246:247], v237 offset0:0 offset1:72
    v_xad_u32 v239, v239, v3, v4
    v_smfmac_f32_16x16x64_bf16 v[188:191], a[64:67], v[204:211], v19 abid:1
    ds_read2st64_b32 v[248:249], v238 offset0:0 offset1:72
    v_cndmask_b32_dpp v131, v127, v135, vcc row_ror:8 row_mask:0xf bank_mask:0xf
    v_smfmac_f32_16x16x64_bf16 v[188:191], a[100:103], v[212:219], v23 abid:1
    ds_read2st64_b32 v[250:251], v239 offset0:0 offset1:72
    s_waitcnt vmcnt(6)
    buffer_store_dwordx4 v[128:131], v6, s[12:15], s59 offen offset:0 sc1
    v_smfmac_f32_16x16x64_bf16 v[192:195], a[32:35], v[196:203], v48
    v_mov_b32_dpp v124, v132 row_ror:8 row_mask:0xf bank_mask:0xc
    v_smfmac_f32_16x16x64_bf16 v[192:195], a[68:71], v[204:211], v48 abid:1
    v_mov_b32_dpp v125, v133 row_ror:8 row_mask:0xf bank_mask:0xc
    v_smfmac_f32_16x16x64_bf16 v[192:195], a[104:107], v[212:219], v49
    s_waitcnt lgkmcnt(8)
    v_mov_b32_dpp v126, v134 row_ror:8 row_mask:0xf bank_mask:0xc
    v_smfmac_f32_16x16x64_bf16 v[160:163], a[108:111], v[220:227], v24
    s_waitcnt lgkmcnt(5)
    v_mov_b32_dpp v127, v135 row_ror:8 row_mask:0xf bank_mask:0xc
    v_smfmac_f32_16x16x64_bf16 v[160:163], a[144:147], v[228:235], v28
    ds_read_b128 v[196:199], v1 offset:23552
    s_waitcnt vmcnt(6)
    buffer_store_dwordx4 v[124:127], v6, s[12:15], s24 offen offset:0 sc1
    v_smfmac_f32_16x16x64_bf16 v[164:167], a[112:115], v[220:227], v24 abid:1
    ds_read_b128 v[200:203], v2 offset:23552
    ds_read_b128 v[128:131], v9 offset:10304
    ds_read_b128 v[132:135], v9 offset:10368
    v_smfmac_f32_16x16x64_bf16 v[164:167], a[148:151], v[228:235], v28 abid:1
    ds_read_b128 v[204:207], v1 offset:24576
    ds_read_b128 v[124:127], v9 offset:10240
    v_smfmac_f32_16x16x64_bf16 v[176:179], a[124:127], v[220:227], v26
    ds_read_b128 v[208:211], v2 offset:24576
    v_smfmac_f32_16x16x64_bf16 v[176:179], a[160:163], v[228:235], v30
    s_waitcnt lgkmcnt(7)
    v_smfmac_f32_16x16x64_bf16 v[176:179], v[240:243], v[244:251], v10 abid:1
    v_smfmac_f32_16x16x64_bf16 v[140:143], v[240:243], v[244:251], v10
    v_smfmac_f32_16x16x64_bf16 v[172:175], a[120:123], v[220:227], v25 abid:1
    s_add_u32 s28, s28, 36864
    s_cmp_ge_u32 s28, 110592
    s_cselect_b32 s28, s26, s28
    v_smfmac_f32_16x16x64_bf16 v[172:175], a[156:159], v[228:235], v29 abid:1
    s_add_u32 s30, s25, 36864
    s_cmp_eq_u32 s30, 110592
    s_cselect_b32 s30, 0, s30
    v_smfmac_f32_16x16x64_bf16 v[168:171], a[116:119], v[220:227], v25
    s_sub_u32 s31, s30, s25
    s_mov_b32 s25, s30
    s_mov_b32 s90, s22
    v_smfmac_f32_16x16x64_bf16 v[168:171], a[152:155], v[228:235], v29
    s_mov_b32 s22, s88
    s_add_u32 s91, s91, 1
    s_cmp_lt_u32 s20, 2
    v_smfmac_f32_16x16x64_bf16 v[180:183], a[128:131], v[220:227], v26 abid:1
    s_cselect_b32 s66, s23, s24
    s_add_u32 s66, s66, s95
    v_smfmac_f32_16x16x64_bf16 v[180:183], a[164:167], v[228:235], v30 abid:1
    v_cvt_pk_bf16_f32 v140, v140, v141
    v_smfmac_f32_16x16x64_bf16 v[184:187], a[132:135], v[220:227], v27
    s_add_u32 m0, m0, 896
    v_cvt_pk_bf16_f32 v141, v142, v143
    v_smfmac_f32_16x16x64_bf16 v[184:187], a[168:171], v[228:235], v31
    s_waitcnt vmcnt(6)
    buffer_load_dwordx4 v5, s[8:11], s88 offen offset:256 nt lds
    v_cvt_pk_bf16_f32 v142, v144, v145
    v_smfmac_f32_16x16x64_bf16 v[188:191], a[136:139], v[220:227], v27 abid:1
    v_cvt_pk_bf16_f32 v143, v146, v147
    v_smfmac_f32_16x16x64_bf16 v[188:191], a[172:175], v[228:235], v31 abid:1
    v_cvt_pk_bf16_f32 v148, v148, v149
    v_smfmac_f32_16x16x64_bf16 v[192:195], a[140:143], v[220:227], v49 abid:1
    v_cvt_pk_bf16_f32 v149, v150, v151
    v_smfmac_f32_16x16x64_bf16 v[192:195], a[176:179], v[228:235], v50
    ds_read_b128 v[220:223], v1 offset:25600
    s_waitcnt lgkmcnt(6)
    v_cvt_pk_bf16_f32 v150, v152, v153
    v_smfmac_f32_16x16x64_bf16 v[160:163], a[180:183], v[196:203], v32
    ds_read_b128 v[224:227], v2 offset:25600
    s_waitcnt lgkmcnt(2)
    v_cvt_pk_bf16_f32 v151, v154, v155
    v_smfmac_f32_16x16x64_bf16 v[160:163], a[216:219], v[204:211], v36
    ds_read_b128 v[228:231], v1 offset:26624
    ds_read_b128 v[152:155], v9 offset:10688
    v_cndmask_b32_dpp v144, v140, v148, vcc row_ror:8 row_mask:0xf bank_mask:0xf
    v_smfmac_f32_16x16x64_bf16 v[164:167], a[184:187], v[196:203], v32 abid:1
    ds_read_b128 v[232:235], v2 offset:26624
    v_cndmask_b32_dpp v145, v141, v149, vcc row_ror:8 row_mask:0xf bank_mask:0xf
    v_smfmac_f32_16x16x64_bf16 v[164:167], a[220:223], v[204:211], v36 abid:1
    s_add_u32 m0, m0, 896
    v_cndmask_b32_dpp v146, v142, v150, vcc row_ror:8 row_mask:0xf bank_mask:0xf
    v_smfmac_f32_16x16x64_bf16 v[168:171], a[188:191], v[196:203], v33
    s_waitcnt vmcnt(6)
    buffer_load_dwordx4 v5, s[8:11], s88 offen offset:384 nt lds
    v_cndmask_b32_dpp v147, v143, v151, vcc row_ror:8 row_mask:0xf bank_mask:0xf
    v_smfmac_f32_16x16x64_bf16 v[168:171], a[224:227], v[204:211], v37
    s_waitcnt vmcnt(6)
    buffer_store_dwordx4 v[144:147], v6, s[12:15], s59 offen offset:128 sc1
    v_mov_b32_dpp v140, v148 row_ror:8 row_mask:0xf bank_mask:0xc
    v_smfmac_f32_16x16x64_bf16 v[172:175], a[192:195], v[196:203], v33 abid:1
    v_mov_b32_dpp v141, v149 row_ror:8 row_mask:0xf bank_mask:0xc
    v_smfmac_f32_16x16x64_bf16 v[172:175], a[228:231], v[204:211], v37 abid:1
    v_mov_b32_dpp v142, v150 row_ror:8 row_mask:0xf bank_mask:0xc
    v_smfmac_f32_16x16x64_bf16 v[176:179], a[196:199], v[196:203], v34
    v_mov_b32_dpp v143, v151 row_ror:8 row_mask:0xf bank_mask:0xc
    v_smfmac_f32_16x16x64_bf16 v[176:179], a[232:235], v[204:211], v38
    s_waitcnt vmcnt(6)
    buffer_store_dwordx4 v[140:143], v6, s[12:15], s24 offen offset:128 sc1
    ds_read_b128 v[144:147], v9 offset:10560
    v_smfmac_f32_16x16x64_bf16 v[180:183], a[200:203], v[196:203], v34 abid:1
    ds_read_b128 v[148:151], v9 offset:10624
    ds_read_b128 v[140:143], v9 offset:10496
    v_add_u32 v4, s31, v4
    v_smfmac_f32_16x16x64_bf16 v[180:183], a[236:239], v[204:211], v38 abid:1
    v_add_u32 v1, s31, v1
    v_smfmac_f32_16x16x64_bf16 v[184:187], a[204:207], v[196:203], v35
    v_add_u32 v2, s31, v2
    v_smfmac_f32_16x16x64_bf16 v[184:187], a[240:243], v[204:211], v39
    v_smfmac_f32_16x16x64_bf16 v[188:191], a[208:211], v[196:203], v35 abid:1
    v_smfmac_f32_16x16x64_bf16 v[188:191], a[244:247], v[204:211], v39 abid:1
    v_smfmac_f32_16x16x64_bf16 v[192:195], a[212:215], v[196:203], v50 abid:1
    v_smfmac_f32_16x16x64_bf16 v[192:195], a[248:251], v[204:211], v51
    s_waitcnt vmcnt(8)
    s_branch M_top1
M_bE0:
    v_smfmac_f32_16x16x64_bf16 v[164:167], v[56:59], v[220:227], v40 abid:1
    ds_read_b128 v[204:207], v1 offset:1024
    s_cmp_lt_u32 s22, 74612736
    s_cselect_b32 s30, 1, 0
    v_smfmac_f32_16x16x64_bf16 v[164:167], v[92:95], v[228:235], v44 abid:1
    ds_read_b128 v[208:211], v2 offset:1024
    v_mov_b32 v0, s30
    v_smfmac_f32_16x16x64_bf16 v[168:171], v[60:63], v[220:227], v41
    ds_read_b128 v[212:215], v1 offset:2048
    v_smfmac_f32_16x16x64_bf16 v[168:171], v[96:99], v[228:235], v45
    ds_read_b128 v[216:219], v2 offset:2048
    v_smfmac_f32_16x16x64_bf16 v[172:175], v[64:67], v[220:227], v41 abid:1
    s_waitcnt vmcnt(5)
    s_waitcnt lgkmcnt(6)
    buffer_store_dwordx4 v[244:247], v7, s[12:15], s66 offen sc1
    v_smfmac_f32_16x16x64_bf16 v[172:175], v[100:103], v[228:235], v45 abid:1
    ds_read_b128 v[236:239], v9 offset:9408
    v_smfmac_f32_16x16x64_bf16 v[176:179], v[68:71], v[220:227], v42
    s_waitcnt vmcnt(6)
    buffer_atomic_add v0, v11, s[16:19], s92 offen sc0 sc1
    s_mov_b32 s21, 2
    v_smfmac_f32_16x16x64_bf16 v[176:179], v[104:107], v[228:235], v46
    v_smfmac_f32_16x16x64_bf16 v[180:183], v[72:75], v[220:227], v42 abid:1
    v_cvt_pk_bf16_f32 v160, v160, v161
    v_smfmac_f32_16x16x64_bf16 v[180:183], v[108:111], v[228:235], v46 abid:1
    v_cvt_pk_bf16_f32 v161, v162, v163
    v_smfmac_f32_16x16x64_bf16 v[184:187], v[76:79], v[220:227], v43
    v_cvt_pk_bf16_f32 v162, v164, v165
    v_smfmac_f32_16x16x64_bf16 v[184:187], v[112:115], v[228:235], v47
    v_cvt_pk_bf16_f32 v163, v166, v167
    v_smfmac_f32_16x16x64_bf16 v[188:191], v[80:83], v[220:227], v43 abid:1
    s_add_u32 m0, m0, 896
    v_cvt_pk_bf16_f32 v168, v168, v169
    v_smfmac_f32_16x16x64_bf16 v[188:191], v[116:119], v[228:235], v47 abid:1
    s_waitcnt vmcnt(5)
    buffer_load_dwordx4 v5, s[8:11], s22 offen offset:512 nt lds
    v_cvt_pk_bf16_f32 v169, v170, v171
    v_smfmac_f32_16x16x64_bf16 v[192:195], v[84:87], v[220:227], v51 abid:1
    v_cvt_pk_bf16_f32 v170, v172, v173
    v_smfmac_f32_16x16x64_bf16 v[192:195], v[120:123], v[228:235], v52
    ds_read_b128 v[220:223], v1 offset:3072
    s_waitcnt lgkmcnt(6)
    v_cvt_pk_bf16_f32 v171, v174, v175
    v_smfmac_f32_16x16x64_bf16 v[124:127], a[0:3], v[196:203], v12
    ds_read_b128 v[224:227], v2 offset:3072
    ds_read_b128 v[172:175], v9 offset:10432
    s_waitcnt lgkmcnt(6)
    v_cndmask_b32_dpp v164, v160, v168, vcc row_ror:8 row_mask:0xf bank_mask:0xf
    v_smfmac_f32_16x16x64_bf16 v[124:127], a[36:39], v[204:211], v16
    ds_read_b128 v[228:231], v1 offset:4096
    s_waitcnt lgkmcnt(5)
    v_cndmask_b32_dpp v165, v161, v169, vcc row_ror:8 row_mask:0xf bank_mask:0xf
    v_smfmac_f32_16x16x64_bf16 v[124:127], a[72:75], v[212:219], v20
    ds_read_b128 v[232:235], v2 offset:4096
    v_cndmask_b32_dpp v166, v162, v170, vcc row_ror:8 row_mask:0xf bank_mask:0xf
    v_smfmac_f32_16x16x64_bf16 v[128:131], a[4:7], v[196:203], v12 abid:1
    s_barrier
    v_cndmask_b32_dpp v167, v163, v171, vcc row_ror:8 row_mask:0xf bank_mask:0xf
    v_smfmac_f32_16x16x64_bf16 v[128:131], a[40:43], v[204:211], v16 abid:1
    s_waitcnt vmcnt(6)
    buffer_store_dwordx4 v[164:167], v6, s[12:15], s58 offen offset:0 sc1
    s_waitcnt lgkmcnt(5)
    v_xad_u32 v236, v236, v3, v4
    v_smfmac_f32_16x16x64_bf16 v[128:131], a[76:79], v[212:219], v20 abid:1
    v_xad_u32 v237, v237, v3, v4
    v_smfmac_f32_16x16x64_bf16 v[132:135], a[8:11], v[196:203], v13
    ds_read2st64_b32 v[244:245], v236 offset0:0 offset1:72
    ds_read_b128 v[240:243], v8 offset:3072
    v_xad_u32 v238, v238, v3, v4
    v_smfmac_f32_16x16x64_bf16 v[132:135], a[44:47], v[204:211], v17
    ds_read2st64_b32 v[246:247], v237 offset0:0 offset1:72
    v_xad_u32 v239, v239, v3, v4
    v_smfmac_f32_16x16x64_bf16 v[132:135], a[80:83], v[212:219], v21
    ds_read2st64_b32 v[248:249], v238 offset0:0 offset1:72
    v_mov_b32_dpp v160, v168 row_ror:8 row_mask:0xf bank_mask:0xc
    v_smfmac_f32_16x16x64_bf16 v[144:147], a[20:23], v[196:203], v14 abid:1
    ds_read2st64_b32 v[250:251], v239 offset0:0 offset1:72
    ds_read_b128 v[236:239], v9 offset:9280
    v_mov_b32_dpp v161, v169 row_ror:8 row_mask:0xf bank_mask:0xc
    v_smfmac_f32_16x16x64_bf16 v[144:147], a[56:59], v[204:211], v18 abid:1
    v_mov_b32_dpp v162, v170 row_ror:8 row_mask:0xf bank_mask:0xc
    v_smfmac_f32_16x16x64_bf16 v[144:147], a[92:95], v[212:219], v22 abid:1
    v_mov_b32_dpp v163, v171 row_ror:8 row_mask:0xf bank_mask:0xc
    v_smfmac_f32_16x16x64_bf16 v[140:143], a[16:19], v[196:203], v14
    s_waitcnt vmcnt(5)
    buffer_store_dwordx4 v[160:163], v6, s[12:15], s23 offen offset:0 sc1
    ds_read_b128 v[164:167], v9 offset:10304
    v_smfmac_f32_16x16x64_bf16 v[140:143], a[52:55], v[204:211], v18
    ds_read_b128 v[168:171], v9 offset:10368
    ds_read_b128 v[160:163], v9 offset:10240
    v_smfmac_f32_16x16x64_bf16 v[140:143], a[88:91], v[212:219], v22
    v_smfmac_f32_16x16x64_bf16 v[136:139], a[12:15], v[196:203], v13 abid:1
    v_smfmac_f32_16x16x64_bf16 v[136:139], a[48:51], v[204:211], v17 abid:1
    v_smfmac_f32_16x16x64_bf16 v[136:139], a[84:87], v[212:219], v21 abid:1
    s_waitcnt lgkmcnt(3)
    v_xad_u32 v236, v236, v3, v4
    v_smfmac_f32_16x16x64_bf16 v[136:139], v[240:243], v[244:251], v10
    v_xad_u32 v237, v237, v3, v4
    v_smfmac_f32_16x16x64_bf16 v[172:175], v[240:243], v[244:251], v10 abid:1
    ds_read2st64_b32 v[244:245], v236 offset0:0 offset1:72
    ds_read_b128 v[240:243], v8 offset:1024
    v_xad_u32 v238, v238, v3, v4
    v_smfmac_f32_16x16x64_bf16 v[148:151], a[24:27], v[196:203], v15
    ds_read2st64_b32 v[246:247], v237 offset0:0 offset1:72
    v_xad_u32 v239, v239, v3, v4
    v_smfmac_f32_16x16x64_bf16 v[148:151], a[60:63], v[204:211], v19
    ds_read2st64_b32 v[248:249], v238 offset0:0 offset1:72
    v_cvt_pk_bf16_f32 v192, v192, v193
    v_smfmac_f32_16x16x64_bf16 v[148:151], a[96:99], v[212:219], v23
    ds_read2st64_b32 v[250:251], v239 offset0:0 offset1:72
    ds_read_b128 v[236:239], v9 offset:9344
    v_cvt_pk_bf16_f32 v193, v194, v195
    v_smfmac_f32_16x16x64_bf16 v[152:155], a[28:31], v[196:203], v15 abid:1
    ds_write_b64 v53, v[192:193] offset:0
    ds_read_b128 v[192:195], v9 offset:10752
    v_smfmac_f32_16x16x64_bf16 v[152:155], a[64:67], v[204:211], v19 abid:1
    s_add_u32 m0, m0, 896
    v_smfmac_f32_16x16x64_bf16 v[152:155], a[100:103], v[212:219], v23 abid:1
    s_waitcnt vmcnt(6)
    buffer_load_dwordx4 v5, s[8:11], s22 offen offset:640 nt lds
    v_smfmac_f32_16x16x64_bf16 v[156:159], a[32:35], v[196:203], v48
    v_smfmac_f32_16x16x64_bf16 v[156:159], a[68:71], v[204:211], v48 abid:1
    v_smfmac_f32_16x16x64_bf16 v[156:159], a[104:107], v[212:219], v49
    ds_read_b128 v[196:199], v1 offset:5120
    v_cvt_pk_bf16_f32 v176, v176, v177
    v_smfmac_f32_16x16x64_bf16 v[124:127], a[108:111], v[220:227], v24
    ds_read_b128 v[200:203], v2 offset:5120
    v_cvt_pk_bf16_f32 v177, v178, v179
    v_smfmac_f32_16x16x64_bf16 v[124:127], a[144:147], v[228:235], v28
    ds_read_b128 v[204:207], v1 offset:6144
    ds_read_b64 v[216:217], v9 offset:10056
    v_cvt_pk_bf16_f32 v178, v180, v181
    v_smfmac_f32_16x16x64_bf16 v[128:131], a[112:115], v[220:227], v24 abid:1
    ds_read_b128 v[208:211], v2 offset:6144
    v_cvt_pk_bf16_f32 v179, v182, v183
    v_smfmac_f32_16x16x64_bf16 v[128:131], a[148:151], v[228:235], v28 abid:1
    s_waitcnt lgkmcnt(7)
    v_xad_u32 v236, v236, v3, v4
    v_smfmac_f32_16x16x64_bf16 v[128:131], v[240:243], v[244:251], v10
    s_add_u32 m0, m0, 896
    v_xad_u32 v237, v237, v3, v4
    v_smfmac_f32_16x16x64_bf16 v[164:167], v[240:243], v[244:251], v10 abid:1
    ds_read2st64_b32 v[244:245], v236 offset0:0 offset1:72
    ds_read_b128 v[240:243], v8 offset:2048
    v_xad_u32 v238, v238, v3, v4
    v_smfmac_f32_16x16x64_bf16 v[152:155], a[136:139], v[220:227], v27 abid:1
    ds_read2st64_b32 v[246:247], v237 offset0:0 offset1:72
    s_waitcnt vmcnt(5)
    v_xad_u32 v239, v239, v3, v4
    v_smfmac_f32_16x16x64_bf16 v[152:155], a[172:175], v[228:235], v31 abid:1
    ds_read2st64_b32 v[248:249], v238 offset0:0 offset1:72
    buffer_load_dwordx4 v5, s[8:11], s22 offen offset:768 nt lds
    v_cvt_pk_bf16_f32 v184, v184, v185
    v_smfmac_f32_16x16x64_bf16 v[136:139], a[120:123], v[220:227], v25 abid:1
    ds_read2st64_b32 v[250:251], v239 offset0:0 offset1:72
    ds_read_b128 v[236:239], v9 offset:9216
    v_cvt_pk_bf16_f32 v185, v186, v187
    v_smfmac_f32_16x16x64_bf16 v[136:139], a[156:159], v[228:235], v29 abid:1
    v_cvt_pk_bf16_f32 v186, v188, v189
    v_smfmac_f32_16x16x64_bf16 v[140:143], a[124:127], v[220:227], v26
    v_cvt_pk_bf16_f32 v187, v190, v191
    v_smfmac_f32_16x16x64_bf16 v[140:143], a[160:163], v[228:235], v30
    ds_read_b128 v[188:191], v9 offset:10688
    v_cndmask_b32_dpp v180, v176, v184, vcc row_ror:8 row_mask:0xf bank_mask:0xf
    v_smfmac_f32_16x16x64_bf16 v[144:147], a[128:131], v[220:227], v26 abid:1
    v_cndmask_b32_dpp v181, v177, v185, vcc row_ror:8 row_mask:0xf bank_mask:0xf
    v_smfmac_f32_16x16x64_bf16 v[144:147], a[164:167], v[228:235], v30 abid:1
    v_cndmask_b32_dpp v182, v178, v186, vcc row_ror:8 row_mask:0xf bank_mask:0xf
    v_smfmac_f32_16x16x64_bf16 v[148:151], a[132:135], v[220:227], v27
    v_cndmask_b32_dpp v183, v179, v187, vcc row_ror:8 row_mask:0xf bank_mask:0xf
    v_smfmac_f32_16x16x64_bf16 v[148:151], a[168:171], v[228:235], v31
    s_waitcnt vmcnt(6)
    buffer_store_dwordx4 v[180:183], v6, s[12:15], s58 offen offset:128 sc1
    s_waitcnt lgkmcnt(8)
    v_xad_u32 v212, v216, v3, v4
    v_smfmac_f32_16x16x64_bf16 v[132:135], a[116:119], v[220:227], v25
    ds_read2st64_b32 v[212:213], v212 offset0:0 offset1:72
    v_xad_u32 v214, v217, v3, v4
    v_smfmac_f32_16x16x64_bf16 v[132:135], a[152:155], v[228:235], v29
    ds_read2st64_b32 v[214:215], v214 offset0:0 offset1:72
    s_waitcnt lgkmcnt(3)
    v_xad_u32 v236, v236, v3, v4
    v_smfmac_f32_16x16x64_bf16 v[132:135], v[240:243], v[244:251], v10
    v_xad_u32 v237, v237, v3, v4
    v_smfmac_f32_16x16x64_bf16 v[168:171], v[240:243], v[244:251], v10 abid:1
    ds_read2st64_b32 v[244:245], v236 offset0:0 offset1:72
    ds_read_b128 v[240:243], v8 offset:0
    v_xad_u32 v238, v238, v3, v4
    v_smfmac_f32_16x16x64_bf16 v[156:159], a[140:143], v[220:227], v49 abid:1
    ds_read2st64_b32 v[246:247], v237 offset0:0 offset1:72
    v_xad_u32 v239, v239, v3, v4
    v_smfmac_f32_16x16x64_bf16 v[156:159], a[176:179], v[228:235], v50
    ds_read2st64_b32 v[248:249], v238 offset0:0 offset1:72
    v_mov_b32_dpp v176, v184 row_ror:8 row_mask:0xf bank_mask:0xc
    v_smfmac_f32_16x16x64_bf16 v[140:143], a[196:199], v[196:203], v34
    ds_read2st64_b32 v[250:251], v239 offset0:0 offset1:72
    ds_read_b128 v[236:239], v9 offset:9728
    v_mov_b32_dpp v177, v185 row_ror:8 row_mask:0xf bank_mask:0xc
    v_smfmac_f32_16x16x64_bf16 v[140:143], a[232:235], v[204:211], v38
    v_mov_b32_dpp v178, v186 row_ror:8 row_mask:0xf bank_mask:0xc
    v_smfmac_f32_16x16x64_bf16 v[128:131], a[184:187], v[196:203], v32 abid:1
    v_mov_b32_dpp v179, v187 row_ror:8 row_mask:0xf bank_mask:0xc
    v_smfmac_f32_16x16x64_bf16 v[128:131], a[220:223], v[204:211], v36 abid:1
    s_waitcnt vmcnt(5)
    buffer_store_dwordx4 v[176:179], v6, s[12:15], s23 offen offset:128 sc1
    ds_read_b128 v[180:183], v9 offset:10560
    v_smfmac_f32_16x16x64_bf16 v[132:135], a[188:191], v[196:203], v33
    ds_read_b128 v[184:187], v9 offset:10624
    ds_read_b128 v[176:179], v9 offset:10496
    v_smfmac_f32_16x16x64_bf16 v[132:135], a[224:227], v[204:211], v37
    v_smfmac_f32_16x16x64_bf16 v[136:139], a[192:195], v[196:203], v33 abid:1
    ds_read_b128 v[220:223], v1 offset:7168
    v_smfmac_f32_16x16x64_bf16 v[136:139], a[228:231], v[204:211], v37 abid:1
    ds_read_b128 v[224:227], v2 offset:7168
    v_smfmac_f32_16x16x64_bf16 v[124:127], a[180:183], v[196:203], v32
    ds_read_b128 v[228:231], v1 offset:8192
    v_smfmac_f32_16x16x64_bf16 v[124:127], a[216:219], v[204:211], v36
    s_waitcnt vmcnt(7)
    s_waitcnt lgkmcnt(6)
    v_xad_u32 v236, v236, v3, v4
    v_smfmac_f32_16x16x64_bf16 v[124:127], v[240:243], v[244:251], v10
    ds_read_b128 v[232:235], v2 offset:8192
    v_xad_u32 v237, v237, v3, v4
    v_smfmac_f32_16x16x64_bf16 v[160:163], v[240:243], v[244:251], v10 abid:1
    ds_read2st64_b32 v[244:245], v236 offset0:0 offset1:72
    ds_read_b128 v[240:243], v8 offset:8192
    v_xad_u32 v238, v238, v3, v4
    v_smfmac_f32_16x16x64_bf16 v[144:147], a[200:203], v[196:203], v34 abid:1
    ds_read2st64_b32 v[246:247], v237 offset0:0 offset1:72
    v_xad_u32 v239, v239, v3, v4
    v_smfmac_f32_16x16x64_bf16 v[144:147], a[236:239], v[204:211], v38 abid:1
    ds_read2st64_b32 v[248:249], v238 offset0:0 offset1:72
    v_mul_u32_u24 v0, s94, v0
    v_smfmac_f32_16x16x64_bf16 v[148:151], a[204:207], v[196:203], v35
    ds_read2st64_b32 v[250:251], v239 offset0:0 offset1:72
    ds_read_b128 v[236:239], v9 offset:9664
    v_add_u32 v0, s93, v0
    v_smfmac_f32_16x16x64_bf16 v[148:151], a[240:243], v[204:211], v39
    s_waitcnt lgkmcnt(10)
    s_cmp_lt_i32 s81, 0
    s_cbranch_scc1 M_ovrE0
    s_swappc_b64 s[78:79], s[72:73]
M_ovrE0:
    v_smfmac_f32_16x16x64_bf16 v[152:155], a[208:211], v[196:203], v35 abid:1
    ds_write_b32 v11, v0
    v_mov_b32 v0, 162048
    v_smfmac_f32_16x16x64_bf16 v[152:155], a[244:247], v[204:211], v39 abid:1
    s_add_u32 m0, m0, 896
    v_smfmac_f32_16x16x64_bf16 v[156:159], a[212:215], v[196:203], v50 abid:1
    s_waitcnt vmcnt(6)
    buffer_load_dwordx4 v5, s[8:11], s22 offen offset:896 nt lds
    v_smfmac_f32_16x16x64_bf16 v[156:159], a[248:251], v[204:211], v51
    s_waitcnt lgkmcnt(9)
    v_smfmac_f32_16x16x64_bf16 v[124:127], a[252:255], v[220:227], v40
    ds_read_b128 v[196:199], v1 offset:18432
    s_waitcnt lgkmcnt(8)
    v_smfmac_f32_16x16x64_bf16 v[124:127], v[88:91], v[228:235], v44
    ds_read_b128 v[200:203], v2 offset:18432
    v_smfmac_f32_16x16x64_bf16 v[156:159], v[84:87], v[220:227], v51 abid:1
    ds_read_b128 v[204:207], v1 offset:19456
    v_smfmac_f32_16x16x64_bf16 v[156:159], v[120:123], v[228:235], v52
    s_waitcnt lgkmcnt(3)
    s_barrier
    v_xad_u32 v236, v236, v3, v4
    v_smfmac_f32_16x16x64_bf16 v[156:159], v[240:243], v[244:251], v10
    ds_read_b128 v[208:211], v2 offset:19456
    ds_read_b32 v0, v0
    v_xad_u32 v237, v237, v3, v4
    v_smfmac_f32_16x16x64_bf16 v[192:195], v[240:243], v[244:251], v10 abid:1
    ds_read2st64_b32 v[244:245], v236 offset0:0 offset1:72
    ds_read_b128 v[240:243], v8 offset:7168
    v_xad_u32 v238, v238, v3, v4
    v_smfmac_f32_16x16x64_bf16 v[132:135], v[60:63], v[220:227], v41
    ds_read2st64_b32 v[246:247], v237 offset0:0 offset1:72
    v_xad_u32 v239, v239, v3, v4
    v_smfmac_f32_16x16x64_bf16 v[132:135], v[96:99], v[228:235], v45
    ds_read2st64_b32 v[248:249], v238 offset0:0 offset1:72
    s_add_u32 m0, m0, 896
    v_smfmac_f32_16x16x64_bf16 v[136:139], v[64:67], v[220:227], v41 abid:1
    ds_read2st64_b32 v[250:251], v239 offset0:0 offset1:72
    ds_read_b128 v[236:239], v9 offset:9536
    s_waitcnt vmcnt(5)
    v_smfmac_f32_16x16x64_bf16 v[136:139], v[100:103], v[228:235], v45 abid:1
    buffer_load_dwordx4 v5, s[8:11], s22 offen offset:1024 nt lds
    s_waitcnt lgkmcnt(6)
    v_readfirstlane_b32 s88, v0
    v_smfmac_f32_16x16x64_bf16 v[140:143], v[68:71], v[220:227], v42
    s_add_u32 s30, s88, 74612736
    s_lshr_b32 s30, s30, 1
    s_min_u32 s88, s88, s30
    v_smfmac_f32_16x16x64_bf16 v[140:143], v[104:107], v[228:235], v46
    s_min_u32 s88, s88, s14
    v_smfmac_f32_16x16x64_bf16 v[144:147], v[72:75], v[220:227], v42 abid:1
    ds_read_b128 v[212:215], v1 offset:20480
    s_cmp_lt_u32 s22, 74612736
    s_cselect_b32 s88, s88, s14
    v_smfmac_f32_16x16x64_bf16 v[144:147], v[108:111], v[228:235], v46 abid:1
    ds_read_b128 v[216:219], v2 offset:20480
    s_cmp_lt_u32 s88, s99
    s_cselect_b32 s10, 75497472, 0
    v_smfmac_f32_16x16x64_bf16 v[148:151], v[76:79], v[220:227], v43
    v_smfmac_f32_16x16x64_bf16 v[148:151], v[112:115], v[228:235], v47
    v_smfmac_f32_16x16x64_bf16 v[152:155], v[80:83], v[220:227], v43 abid:1
    v_smfmac_f32_16x16x64_bf16 v[152:155], v[116:119], v[228:235], v47 abid:1
    s_waitcnt lgkmcnt(2)
    v_xad_u32 v236, v236, v3, v4
    v_smfmac_f32_16x16x64_bf16 v[152:155], v[240:243], v[244:251], v10
    v_xad_u32 v237, v237, v3, v4
    v_smfmac_f32_16x16x64_bf16 v[188:191], v[240:243], v[244:251], v10 abid:1
    s_cmp_gt_u32 s46, s80
    s_cbranch_scc1 M_slow
M_slowrE0:
    v_xad_u32 v238, v238, v3, v4
    v_smfmac_f32_16x16x64_bf16 v[128:131], v[56:59], v[220:227], v40 abid:1
    ds_read2st64_b32 v[244:245], v236 offset0:0 offset1:72
    ds_read_b128 v[240:243], v8 offset:5120
    v_xad_u32 v239, v239, v3, v4
    v_smfmac_f32_16x16x64_bf16 v[128:131], v[92:95], v[228:235], v44 abid:1
    ds_read2st64_b32 v[246:247], v237 offset0:0 offset1:72
    v_smfmac_f32_16x16x64_bf16 v[160:163], a[0:3], v[196:203], v12
    ds_read2st64_b32 v[248:249], v238 offset0:0 offset1:72
    v_smfmac_f32_16x16x64_bf16 v[160:163], a[36:39], v[204:211], v16
    ds_read2st64_b32 v[250:251], v239 offset0:0 offset1:72
    ds_read_b128 v[236:239], v9 offset:9600
    s_waitcnt lgkmcnt(6)
    v_smfmac_f32_16x16x64_bf16 v[160:163], a[72:75], v[212:219], v20
    v_smfmac_f32_16x16x64_bf16 v[164:167], a[4:7], v[196:203], v12 abid:1
    s_mov_b32 m0, s28
    v_cvt_pk_bf16_f32 v156, v156, v157
    v_smfmac_f32_16x16x64_bf16 v[164:167], a[40:43], v[204:211], v16 abid:1
    s_waitcnt vmcnt(6)
    buffer_load_dwordx4 v5, s[8:11], s88 offen offset:0 nt lds
    v_cvt_pk_bf16_f32 v157, v158, v159
    v_smfmac_f32_16x16x64_bf16 v[164:167], a[76:79], v[212:219], v20 abid:1
    ds_write_b64 v53, v[156:157] offset:25728
    ds_read_b128 v[156:159], v9 offset:10752
    v_smfmac_f32_16x16x64_bf16 v[180:183], a[20:23], v[196:203], v14 abid:1
    v_smfmac_f32_16x16x64_bf16 v[180:183], a[56:59], v[204:211], v18 abid:1
    ds_read_b128 v[220:223], v1 offset:21504
    v_cvt_pk_bf16_f32 v124, v124, v125
    v_smfmac_f32_16x16x64_bf16 v[180:183], a[92:95], v[212:219], v22 abid:1
    s_waitcnt lgkmcnt(3)
    v_xad_u32 v236, v236, v3, v4
    v_smfmac_f32_16x16x64_bf16 v[180:183], v[240:243], v[244:251], v10 abid:1
    v_xad_u32 v237, v237, v3, v4
    v_smfmac_f32_16x16x64_bf16 v[144:147], v[240:243], v[244:251], v10
    ds_read2st64_b32 v[244:245], v236 offset0:0 offset1:72
    ds_read_b128 v[240:243], v8 offset:6144
    v_xad_u32 v238, v238, v3, v4
    v_smfmac_f32_16x16x64_bf16 v[172:175], a[12:15], v[196:203], v13 abid:1
    ds_read2st64_b32 v[246:247], v237 offset0:0 offset1:72
    v_xad_u32 v239, v239, v3, v4
    v_smfmac_f32_16x16x64_bf16 v[172:175], a[48:51], v[204:211], v17 abid:1
    ds_read2st64_b32 v[248:249], v238 offset0:0 offset1:72
    v_cvt_pk_bf16_f32 v125, v126, v127
    v_smfmac_f32_16x16x64_bf16 v[172:175], a[84:87], v[212:219], v21 abid:1
    ds_read2st64_b32 v[250:251], v239 offset0:0 offset1:72
    ds_read_b128 v[236:239], v9 offset:9472
    v_cvt_pk_bf16_f32 v126, v128, v129
    v_smfmac_f32_16x16x64_bf16 v[176:179], a[16:19], v[196:203], v14
    v_cvt_pk_bf16_f32 v127, v130, v131
    v_smfmac_f32_16x16x64_bf16 v[176:179], a[52:55], v[204:211], v18
    v_cvt_pk_bf16_f32 v132, v132, v133
    v_smfmac_f32_16x16x64_bf16 v[176:179], a[88:91], v[212:219], v22
    v_cvt_pk_bf16_f32 v133, v134, v135
    v_smfmac_f32_16x16x64_bf16 v[168:171], a[8:11], v[196:203], v13
    s_add_u32 m0, m0, 896
    v_cvt_pk_bf16_f32 v134, v136, v137
    v_smfmac_f32_16x16x64_bf16 v[168:171], a[44:47], v[204:211], v17
    s_waitcnt vmcnt(5)
    buffer_load_dwordx4 v5, s[8:11], s88 offen offset:128 nt lds
    v_cvt_pk_bf16_f32 v135, v138, v139
    v_smfmac_f32_16x16x64_bf16 v[168:171], a[80:83], v[212:219], v21
    ds_read_b128 v[224:227], v2 offset:21504
    ds_read_b128 v[136:139], v9 offset:10432
    v_cndmask_b32_dpp v128, v124, v132, vcc row_ror:8 row_mask:0xf bank_mask:0xf
    v_smfmac_f32_16x16x64_bf16 v[184:187], a[24:27], v[196:203], v15
    ds_read_b128 v[228:231], v1 offset:22528
    v_cndmask_b32_dpp v129, v125, v133, vcc row_ror:8 row_mask:0xf bank_mask:0xf
    v_smfmac_f32_16x16x64_bf16 v[184:187], a[60:63], v[204:211], v19
    ds_read_b128 v[232:235], v2 offset:22528
    v_cndmask_b32_dpp v130, v126, v134, vcc row_ror:8 row_mask:0xf bank_mask:0xf
    v_smfmac_f32_16x16x64_bf16 v[184:187], a[96:99], v[212:219], v23
    s_waitcnt lgkmcnt(4)
    v_xad_u32 v236, v236, v3, v4
    v_smfmac_f32_16x16x64_bf16 v[184:187], v[240:243], v[244:251], v10 abid:1
    v_xad_u32 v237, v237, v3, v4
    v_smfmac_f32_16x16x64_bf16 v[148:151], v[240:243], v[244:251], v10
    ds_read2st64_b32 v[244:245], v236 offset0:0 offset1:72
    ds_read_b128 v[240:243], v8 offset:4096
    v_xad_u32 v238, v238, v3, v4
    v_smfmac_f32_16x16x64_bf16 v[188:191], a[28:31], v[196:203], v15 abid:1
    ds_read2st64_b32 v[246:247], v237 offset0:0 offset1:72
    v_xad_u32 v239, v239, v3, v4
    v_smfmac_f32_16x16x64_bf16 v[188:191], a[64:67], v[204:211], v19 abid:1
    ds_read2st64_b32 v[248:249], v238 offset0:0 offset1:72
    v_cndmask_b32_dpp v131, v127, v135, vcc row_ror:8 row_mask:0xf bank_mask:0xf
    v_smfmac_f32_16x16x64_bf16 v[188:191], a[100:103], v[212:219], v23 abid:1
    ds_read2st64_b32 v[250:251], v239 offset0:0 offset1:72
    s_waitcnt vmcnt(6)
    buffer_store_dwordx4 v[128:131], v6, s[12:15], s59 offen offset:0 sc1
    v_smfmac_f32_16x16x64_bf16 v[192:195], a[32:35], v[196:203], v48
    v_mov_b32_dpp v124, v132 row_ror:8 row_mask:0xf bank_mask:0xc
    v_smfmac_f32_16x16x64_bf16 v[192:195], a[68:71], v[204:211], v48 abid:1
    v_mov_b32_dpp v125, v133 row_ror:8 row_mask:0xf bank_mask:0xc
    v_smfmac_f32_16x16x64_bf16 v[192:195], a[104:107], v[212:219], v49
    s_waitcnt lgkmcnt(8)
    v_mov_b32_dpp v126, v134 row_ror:8 row_mask:0xf bank_mask:0xc
    v_smfmac_f32_16x16x64_bf16 v[160:163], a[108:111], v[220:227], v24
    s_waitcnt lgkmcnt(5)
    v_mov_b32_dpp v127, v135 row_ror:8 row_mask:0xf bank_mask:0xc
    v_smfmac_f32_16x16x64_bf16 v[160:163], a[144:147], v[228:235], v28
    ds_read_b128 v[196:199], v1 offset:23552
    s_waitcnt vmcnt(5)
    buffer_store_dwordx4 v[124:127], v6, s[12:15], s24 offen offset:0 sc1
    v_smfmac_f32_16x16x64_bf16 v[164:167], a[112:115], v[220:227], v24 abid:1
    ds_read_b128 v[200:203], v2 offset:23552
    ds_read_b128 v[128:131], v9 offset:10304
    ds_read_b128 v[132:135], v9 offset:10368
    v_smfmac_f32_16x16x64_bf16 v[164:167], a[148:151], v[228:235], v28 abid:1
    ds_read_b128 v[204:207], v1 offset:24576
    ds_read_b128 v[124:127], v9 offset:10240
    v_smfmac_f32_16x16x64_bf16 v[176:179], a[124:127], v[220:227], v26
    ds_read_b128 v[208:211], v2 offset:24576
    v_smfmac_f32_16x16x64_bf16 v[176:179], a[160:163], v[228:235], v30
    s_waitcnt lgkmcnt(7)
    v_smfmac_f32_16x16x64_bf16 v[176:179], v[240:243], v[244:251], v10 abid:1
    v_smfmac_f32_16x16x64_bf16 v[140:143], v[240:243], v[244:251], v10
    v_smfmac_f32_16x16x64_bf16 v[172:175], a[120:123], v[220:227], v25 abid:1
    s_add_u32 s28, s28, 36864
    s_cmp_ge_u32 s28, 110592
    s_cselect_b32 s28, s26, s28
    v_smfmac_f32_16x16x64_bf16 v[172:175], a[156:159], v[228:235], v29 abid:1
    s_add_u32 s30, s25, 36864
    s_cmp_eq_u32 s30, 110592
    s_cselect_b32 s30, 0, s30
    v_smfmac_f32_16x16x64_bf16 v[168:171], a[116:119], v[220:227], v25
    s_sub_u32 s31, s30, s25
    s_mov_b32 s25, s30
    s_mov_b32 s90, s22
    v_smfmac_f32_16x16x64_bf16 v[168:171], a[152:155], v[228:235], v29
    s_mov_b32 s22, s88
    s_add_u32 s91, s91, 1
    s_cmp_lt_u32 s20, 2
    v_smfmac_f32_16x16x64_bf16 v[180:183], a[128:131], v[220:227], v26 abid:1
    s_cselect_b32 s66, s23, s24
    s_add_u32 s66, s66, s95
    v_smfmac_f32_16x16x64_bf16 v[180:183], a[164:167], v[228:235], v30 abid:1
    v_cvt_pk_bf16_f32 v140, v140, v141
    v_smfmac_f32_16x16x64_bf16 v[184:187], a[132:135], v[220:227], v27
    s_add_u32 m0, m0, 896
    v_cvt_pk_bf16_f32 v141, v142, v143
    v_smfmac_f32_16x16x64_bf16 v[184:187], a[168:171], v[228:235], v31
    s_waitcnt vmcnt(6)
    buffer_load_dwordx4 v5, s[8:11], s88 offen offset:256 nt lds
    v_cvt_pk_bf16_f32 v142, v144, v145
    v_smfmac_f32_16x16x64_bf16 v[188:191], a[136:139], v[220:227], v27 abid:1
    v_cvt_pk_bf16_f32 v143, v146, v147
    v_smfmac_f32_16x16x64_bf16 v[188:191], a[172:175], v[228:235], v31 abid:1
    v_cvt_pk_bf16_f32 v148, v148, v149
    v_smfmac_f32_16x16x64_bf16 v[192:195], a[140:143], v[220:227], v49 abid:1
    v_cvt_pk_bf16_f32 v149, v150, v151
    v_smfmac_f32_16x16x64_bf16 v[192:195], a[176:179], v[228:235], v50
    ds_read_b128 v[220:223], v1 offset:25600
    s_waitcnt lgkmcnt(6)
    v_cvt_pk_bf16_f32 v150, v152, v153
    v_smfmac_f32_16x16x64_bf16 v[160:163], a[180:183], v[196:203], v32
    ds_read_b128 v[224:227], v2 offset:25600
    s_waitcnt lgkmcnt(2)
    v_cvt_pk_bf16_f32 v151, v154, v155
    v_smfmac_f32_16x16x64_bf16 v[160:163], a[216:219], v[204:211], v36
    ds_read_b128 v[228:231], v1 offset:26624
    ds_read_b128 v[152:155], v9 offset:10688
    v_cndmask_b32_dpp v144, v140, v148, vcc row_ror:8 row_mask:0xf bank_mask:0xf
    v_smfmac_f32_16x16x64_bf16 v[164:167], a[184:187], v[196:203], v32 abid:1
    ds_read_b128 v[232:235], v2 offset:26624
    v_cndmask_b32_dpp v145, v141, v149, vcc row_ror:8 row_mask:0xf bank_mask:0xf
    v_smfmac_f32_16x16x64_bf16 v[164:167], a[220:223], v[204:211], v36 abid:1
    s_add_u32 m0, m0, 896
    v_cndmask_b32_dpp v146, v142, v150, vcc row_ror:8 row_mask:0xf bank_mask:0xf
    v_smfmac_f32_16x16x64_bf16 v[168:171], a[188:191], v[196:203], v33
    s_waitcnt vmcnt(5)
    buffer_load_dwordx4 v5, s[8:11], s88 offen offset:384 nt lds
    v_cndmask_b32_dpp v147, v143, v151, vcc row_ror:8 row_mask:0xf bank_mask:0xf
    v_smfmac_f32_16x16x64_bf16 v[168:171], a[224:227], v[204:211], v37
    s_waitcnt vmcnt(6)
    buffer_store_dwordx4 v[144:147], v6, s[12:15], s59 offen offset:128 sc1
    v_mov_b32_dpp v140, v148 row_ror:8 row_mask:0xf bank_mask:0xc
    v_smfmac_f32_16x16x64_bf16 v[172:175], a[192:195], v[196:203], v33 abid:1
    v_mov_b32_dpp v141, v149 row_ror:8 row_mask:0xf bank_mask:0xc
    v_smfmac_f32_16x16x64_bf16 v[172:175], a[228:231], v[204:211], v37 abid:1
    v_mov_b32_dpp v142, v150 row_ror:8 row_mask:0xf bank_mask:0xc
    v_smfmac_f32_16x16x64_bf16 v[176:179], a[196:199], v[196:203], v34
    v_mov_b32_dpp v143, v151 row_ror:8 row_mask:0xf bank_mask:0xc
    v_smfmac_f32_16x16x64_bf16 v[176:179], a[232:235], v[204:211], v38
    s_waitcnt vmcnt(5)
    buffer_store_dwordx4 v[140:143], v6, s[12:15], s24 offen offset:128 sc1
    ds_read_b128 v[144:147], v9 offset:10560
    v_smfmac_f32_16x16x64_bf16 v[180:183], a[200:203], v[196:203], v34 abid:1
    ds_read_b128 v[148:151], v9 offset:10624
    ds_read_b128 v[140:143], v9 offset:10496
    v_add_u32 v4, s31, v4
    v_smfmac_f32_16x16x64_bf16 v[180:183], a[236:239], v[204:211], v38 abid:1
    v_add_u32 v1, s31, v1
    v_smfmac_f32_16x16x64_bf16 v[184:187], a[204:207], v[196:203], v35
    v_add_u32 v2, s31, v2
    v_smfmac_f32_16x16x64_bf16 v[184:187], a[240:243], v[204:211], v39
    v_smfmac_f32_16x16x64_bf16 v[188:191], a[208:211], v[196:203], v35 abid:1
    v_smfmac_f32_16x16x64_bf16 v[188:191], a[244:247], v[204:211], v39 abid:1
    v_smfmac_f32_16x16x64_bf16 v[192:195], a[212:215], v[196:203], v50 abid:1
    v_smfmac_f32_16x16x64_bf16 v[192:195], a[248:251], v[204:211], v51
    s_waitcnt vmcnt(8)
    s_branch M_top1
M_q:
    s_mov_b32 s21, 3
    v_smfmac_f32_16x16x64_bf16 v[148:151], v[112:115], v[228:235], v47
    v_smfmac_f32_16x16x64_bf16 v[152:155], v[80:83], v[220:227], v43 abid:1
    v_smfmac_f32_16x16x64_bf16 v[152:155], v[116:119], v[228:235], v47 abid:1
    s_waitcnt lgkmcnt(2)
    v_xad_u32 v236, v236, v3, v4
    v_smfmac_f32_16x16x64_bf16 v[152:155], v[240:243], v[244:251], v10
    v_xad_u32 v237, v237, v3, v4
    v_smfmac_f32_16x16x64_bf16 v[188:191], v[240:243], v[244:251], v10 abid:1
    s_cmp_gt_u32 s46, s80
    s_cbranch_scc1 M_slow
M_slowrQ:
    v_xad_u32 v238, v238, v3, v4
    v_smfmac_f32_16x16x64_bf16 v[128:131], v[56:59], v[220:227], v40 abid:1
    ds_read2st64_b32 v[244:245], v236 offset0:0 offset1:72
    ds_read_b128 v[240:243], v8 offset:5120
    v_xad_u32 v239, v239, v3, v4
    v_smfmac_f32_16x16x64_bf16 v[128:131], v[92:95], v[228:235], v44 abid:1
    ds_read2st64_b32 v[246:247], v237 offset0:0 offset1:72
    v_smfmac_f32_16x16x64_bf16 v[160:163], a[0:3], v[196:203], v12
    ds_read2st64_b32 v[248:249], v238 offset0:0 offset1:72
    v_smfmac_f32_16x16x64_bf16 v[160:163], a[36:39], v[204:211], v16
    ds_read2st64_b32 v[250:251], v239 offset0:0 offset1:72
    ds_read_b128 v[236:239], v9 offset:9600
    s_waitcnt lgkmcnt(6)
    v_smfmac_f32_16x16x64_bf16 v[160:163], a[72:75], v[212:219], v20
    v_smfmac_f32_16x16x64_bf16 v[164:167], a[4:7], v[196:203], v12 abid:1
    v_cvt_pk_bf16_f32 v156, v156, v157
    v_smfmac_f32_16x16x64_bf16 v[164:167], a[40:43], v[204:211], v16 abid:1
    v_cvt_pk_bf16_f32 v157, v158, v159
    v_smfmac_f32_16x16x64_bf16 v[164:167], a[76:79], v[212:219], v20 abid:1
    ds_write_b64 v53, v[156:157] offset:25728
    ds_read_b128 v[156:159], v9 offset:10752
    v_smfmac_f32_16x16x64_bf16 v[180:183], a[20:23], v[196:203], v14 abid:1
    v_smfmac_f32_16x16x64_bf16 v[180:183], a[56:59], v[204:211], v18 abid:1
    ds_read_b128 v[220:223], v1 offset:21504
    v_cvt_pk_bf16_f32 v124, v124, v125
    v_smfmac_f32_16x16x64_bf16 v[180:183], a[92:95], v[212:219], v22 abid:1
    s_waitcnt lgkmcnt(3)
    v_xad_u32 v236, v236, v3, v4
    v_smfmac_f32_16x16x64_bf16 v[180:183], v[240:243], v[244:251], v10 abid:1
    v_xad_u32 v237, v237, v3, v4
    v_smfmac_f32_16x16x64_bf16 v[144:147], v[240:243], v[244:251], v10
    ds_read2st64_b32 v[244:245], v236 offset0:0 offset1:72
    ds_read_b128 v[240:243], v8 offset:6144
    v_xad_u32 v238, v238, v3, v4
    v_smfmac_f32_16x16x64_bf16 v[172:175], a[12:15], v[196:203], v13 abid:1
    ds_read2st64_b32 v[246:247], v237 offset0:0 offset1:72
    v_xad_u32 v239, v239, v3, v4
    v_smfmac_f32_16x16x64_bf16 v[172:175], a[48:51], v[204:211], v17 abid:1
    ds_read2st64_b32 v[248:249], v238 offset0:0 offset1:72
    v_cvt_pk_bf16_f32 v125, v126, v127
    v_smfmac_f32_16x16x64_bf16 v[172:175], a[84:87], v[212:219], v21 abid:1
    ds_read2st64_b32 v[250:251], v239 offset0:0 offset1:72
    ds_read_b128 v[236:239], v9 offset:9472
    v_cvt_pk_bf16_f32 v126, v128, v129
    v_smfmac_f32_16x16x64_bf16 v[176:179], a[16:19], v[196:203], v14
    v_cvt_pk_bf16_f32 v127, v130, v131
    v_smfmac_f32_16x16x64_bf16 v[176:179], a[52:55], v[204:211], v18
    v_cvt_pk_bf16_f32 v132, v132, v133
    v_smfmac_f32_16x16x64_bf16 v[176:179], a[88:91], v[212:219], v22
    v_cvt_pk_bf16_f32 v133, v134, v135
    v_smfmac_f32_16x16x64_bf16 v[168:171], a[8:11], v[196:203], v13
    v_cvt_pk_bf16_f32 v134, v136, v137
    v_smfmac_f32_16x16x64_bf16 v[168:171], a[44:47], v[204:211], v17
    v_cvt_pk_bf16_f32 v135, v138, v139
    v_smfmac_f32_16x16x64_bf16 v[168:171], a[80:83], v[212:219], v21
    ds_read_b128 v[224:227], v2 offset:21504
    ds_read_b128 v[136:139], v9 offset:10432
    v_cndmask_b32_dpp v128, v124, v132, vcc row_ror:8 row_mask:0xf bank_mask:0xf
    v_smfmac_f32_16x16x64_bf16 v[184:187], a[24:27], v[196:203], v15
    ds_read_b128 v[228:231], v1 offset:22528
    v_cndmask_b32_dpp v129, v125, v133, vcc row_ror:8 row_mask:0xf bank_mask:0xf
    v_smfmac_f32_16x16x64_bf16 v[184:187], a[60:63], v[204:211], v19
    ds_read_b128 v[232:235], v2 offset:22528
    v_cndmask_b32_dpp v130, v126, v134, vcc row_ror:8 row_mask:0xf bank_mask:0xf
    v_smfmac_f32_16x16x64_bf16 v[184:187], a[96:99], v[212:219], v23
    s_waitcnt lgkmcnt(4)
    v_xad_u32 v236, v236, v3, v4
    v_smfmac_f32_16x16x64_bf16 v[184:187], v[240:243], v[244:251], v10 abid:1
    v_xad_u32 v237, v237, v3, v4
    v_smfmac_f32_16x16x64_bf16 v[148:151], v[240:243], v[244:251], v10
    ds_read2st64_b32 v[244:245], v236 offset0:0 offset1:72
    ds_read_b128 v[240:243], v8 offset:4096
    v_xad_u32 v238, v238, v3, v4
    v_smfmac_f32_16x16x64_bf16 v[188:191], a[28:31], v[196:203], v15 abid:1
    ds_read2st64_b32 v[246:247], v237 offset0:0 offset1:72
    v_xad_u32 v239, v239, v3, v4
    v_smfmac_f32_16x16x64_bf16 v[188:191], a[64:67], v[204:211], v19 abid:1
    ds_read2st64_b32 v[248:249], v238 offset0:0 offset1:72
    v_cndmask_b32_dpp v131, v127, v135, vcc row_ror:8 row_mask:0xf bank_mask:0xf
    v_smfmac_f32_16x16x64_bf16 v[188:191], a[100:103], v[212:219], v23 abid:1
    ds_read2st64_b32 v[250:251], v239 offset0:0 offset1:72
    buffer_store_dwordx4 v[128:131], v6, s[12:15], s59 offen offset:0 sc1
    v_smfmac_f32_16x16x64_bf16 v[192:195], a[32:35], v[196:203], v48
    v_mov_b32_dpp v124, v132 row_ror:8 row_mask:0xf bank_mask:0xc
    v_smfmac_f32_16x16x64_bf16 v[192:195], a[68:71], v[204:211], v48 abid:1
    v_mov_b32_dpp v125, v133 row_ror:8 row_mask:0xf bank_mask:0xc
    v_smfmac_f32_16x16x64_bf16 v[192:195], a[104:107], v[212:219], v49
    s_waitcnt lgkmcnt(8)
    v_mov_b32_dpp v126, v134 row_ror:8 row_mask:0xf bank_mask:0xc
    v_smfmac_f32_16x16x64_bf16 v[160:163], a[108:111], v[220:227], v24
    s_waitcnt lgkmcnt(5)
    v_mov_b32_dpp v127, v135 row_ror:8 row_mask:0xf bank_mask:0xc
    v_smfmac_f32_16x16x64_bf16 v[160:163], a[144:147], v[228:235], v28
    ds_read_b128 v[196:199], v1 offset:23552
    buffer_store_dwordx4 v[124:127], v6, s[12:15], s24 offen offset:0 sc1
    v_smfmac_f32_16x16x64_bf16 v[164:167], a[112:115], v[220:227], v24 abid:1
    ds_read_b128 v[200:203], v2 offset:23552
    ds_read_b128 v[128:131], v9 offset:10304
    ds_read_b128 v[132:135], v9 offset:10368
    v_smfmac_f32_16x16x64_bf16 v[164:167], a[148:151], v[228:235], v28 abid:1
    ds_read_b128 v[204:207], v1 offset:24576
    ds_read_b128 v[124:127], v9 offset:10240
    v_smfmac_f32_16x16x64_bf16 v[176:179], a[124:127], v[220:227], v26
    ds_read_b128 v[208:211], v2 offset:24576
    v_smfmac_f32_16x16x64_bf16 v[176:179], a[160:163], v[228:235], v30
    s_waitcnt lgkmcnt(7)
    v_smfmac_f32_16x16x64_bf16 v[176:179], v[240:243], v[244:251], v10 abid:1
    v_smfmac_f32_16x16x64_bf16 v[140:143], v[240:243], v[244:251], v10
    v_smfmac_f32_16x16x64_bf16 v[172:175], a[120:123], v[220:227], v25 abid:1
    s_add_u32 s28, s28, 36864
    s_cmp_ge_u32 s28, 110592
    s_cselect_b32 s28, s26, s28
    v_smfmac_f32_16x16x64_bf16 v[172:175], a[156:159], v[228:235], v29 abid:1
    s_add_u32 s30, s25, 36864
    s_cmp_eq_u32 s30, 110592
    s_cselect_b32 s30, 0, s30
    v_smfmac_f32_16x16x64_bf16 v[168:171], a[116:119], v[220:227], v25
    s_sub_u32 s31, s30, s25
    s_mov_b32 s25, s30
    s_mov_b32 s90, s22
    v_smfmac_f32_16x16x64_bf16 v[168:171], a[152:155], v[228:235], v29
    s_mov_b32 s22, s88
    s_add_u32 s91, s91, 1
    s_cmp_lt_u32 s20, 2
    v_smfmac_f32_16x16x64_bf16 v[180:183], a[128:131], v[220:227], v26 abid:1
    s_cselect_b32 s66, s23, s24
    s_add_u32 s66, s66, s95
    v_smfmac_f32_16x16x64_bf16 v[180:183], a[164:167], v[228:235], v30 abid:1
    v_cvt_pk_bf16_f32 v140, v140, v141
    v_smfmac_f32_16x16x64_bf16 v[184:187], a[132:135], v[220:227], v27
    v_cvt_pk_bf16_f32 v141, v142, v143
    v_smfmac_f32_16x16x64_bf16 v[184:187], a[168:171], v[228:235], v31
    v_cvt_pk_bf16_f32 v142, v144, v145
    v_smfmac_f32_16x16x64_bf16 v[188:191], a[136:139], v[220:227], v27 abid:1
    v_cvt_pk_bf16_f32 v143, v146, v147
    v_smfmac_f32_16x16x64_bf16 v[188:191], a[172:175], v[228:235], v31 abid:1
    v_cvt_pk_bf16_f32 v148, v148, v149
    v_smfmac_f32_16x16x64_bf16 v[192:195], a[140:143], v[220:227], v49 abid:1
    v_cvt_pk_bf16_f32 v149, v150, v151
    v_smfmac_f32_16x16x64_bf16 v[192:195], a[176:179], v[228:235], v50
    ds_read_b128 v[220:223], v1 offset:25600
    s_waitcnt lgkmcnt(6)
    v_cvt_pk_bf16_f32 v150, v152, v153
    v_smfmac_f32_16x16x64_bf16 v[160:163], a[180:183], v[196:203], v32
    ds_read_b128 v[224:227], v2 offset:25600
    s_waitcnt lgkmcnt(2)
    v_cvt_pk_bf16_f32 v151, v154, v155
    v_smfmac_f32_16x16x64_bf16 v[160:163], a[216:219], v[204:211], v36
    ds_read_b128 v[228:231], v1 offset:26624
    ds_read_b128 v[152:155], v9 offset:10688
    v_cndmask_b32_dpp v144, v140, v148, vcc row_ror:8 row_mask:0xf bank_mask:0xf
    v_smfmac_f32_16x16x64_bf16 v[164:167], a[184:187], v[196:203], v32 abid:1
    ds_read_b128 v[232:235], v2 offset:26624
    v_cndmask_b32_dpp v145, v141, v149, vcc row_ror:8 row_mask:0xf bank_mask:0xf
    v_smfmac_f32_16x16x64_bf16 v[164:167], a[220:223], v[204:211], v36 abid:1
    v_cndmask_b32_dpp v146, v142, v150, vcc row_ror:8 row_mask:0xf bank_mask:0xf
    v_smfmac_f32_16x16x64_bf16 v[168:171], a[188:191], v[196:203], v33
    v_cndmask_b32_dpp v147, v143, v151, vcc row_ror:8 row_mask:0xf bank_mask:0xf
    v_smfmac_f32_16x16x64_bf16 v[168:171], a[224:227], v[204:211], v37
    buffer_store_dwordx4 v[144:147], v6, s[12:15], s59 offen offset:128 sc1
    v_mov_b32_dpp v140, v148 row_ror:8 row_mask:0xf bank_mask:0xc
    v_smfmac_f32_16x16x64_bf16 v[172:175], a[192:195], v[196:203], v33 abid:1
    v_mov_b32_dpp v141, v149 row_ror:8 row_mask:0xf bank_mask:0xc
    v_smfmac_f32_16x16x64_bf16 v[172:175], a[228:231], v[204:211], v37 abid:1
    v_mov_b32_dpp v142, v150 row_ror:8 row_mask:0xf bank_mask:0xc
    v_smfmac_f32_16x16x64_bf16 v[176:179], a[196:199], v[196:203], v34
    v_mov_b32_dpp v143, v151 row_ror:8 row_mask:0xf bank_mask:0xc
    v_smfmac_f32_16x16x64_bf16 v[176:179], a[232:235], v[204:211], v38
    buffer_store_dwordx4 v[140:143], v6, s[12:15], s24 offen offset:128 sc1
    ds_read_b128 v[144:147], v9 offset:10560
    v_smfmac_f32_16x16x64_bf16 v[180:183], a[200:203], v[196:203], v34 abid:1
    ds_read_b128 v[148:151], v9 offset:10624
    ds_read_b128 v[140:143], v9 offset:10496
    v_add_u32 v4, s31, v4
    v_smfmac_f32_16x16x64_bf16 v[180:183], a[236:239], v[204:211], v38 abid:1
    v_add_u32 v1, s31, v1
    v_smfmac_f32_16x16x64_bf16 v[184:187], a[204:207], v[196:203], v35
    v_add_u32 v2, s31, v2
    v_smfmac_f32_16x16x64_bf16 v[184:187], a[240:243], v[204:211], v39
    v_smfmac_f32_16x16x64_bf16 v[188:191], a[208:211], v[196:203], v35 abid:1
    v_smfmac_f32_16x16x64_bf16 v[188:191], a[244:247], v[204:211], v39 abid:1
    v_smfmac_f32_16x16x64_bf16 v[192:195], a[212:215], v[196:203], v50 abid:1
    v_smfmac_f32_16x16x64_bf16 v[192:195], a[248:251], v[204:211], v51
    s_waitcnt vmcnt(4)
    s_branch M_top1
M_bH:
    v_smfmac_f32_16x16x64_bf16 v[164:167], v[56:59], v[220:227], v40 abid:1
    ds_read_b128 v[204:207], v1 offset:1024
    ds_read_b128 v[236:239], v9 offset:9728
    v_smfmac_f32_16x16x64_bf16 v[164:167], v[92:95], v[228:235], v44 abid:1
    ds_read_b128 v[208:211], v2 offset:1024
    v_smfmac_f32_16x16x64_bf16 v[168:171], v[60:63], v[220:227], v41
    ds_read_b128 v[212:215], v1 offset:2048
    v_smfmac_f32_16x16x64_bf16 v[168:171], v[96:99], v[228:235], v45
    ds_read_b128 v[216:219], v2 offset:2048
    s_waitcnt lgkmcnt(7)
    buffer_store_dwordx4 v[244:247], v7, s[12:15], s66 offen sc1
    v_smfmac_f32_16x16x64_bf16 v[172:175], v[64:67], v[220:227], v41 abid:1
    s_mov_b32 s21, 5
    s_barrier
    v_smfmac_f32_16x16x64_bf16 v[172:175], v[100:103], v[228:235], v45 abid:1
    s_cmp_lt_u32 s20, 2
    s_cselect_b32 s66, s23, s24
    s_add_u32 s66, s66, s95
    s_waitcnt lgkmcnt(3)
    v_xad_u32 v236, v236, v3, v4
    v_smfmac_f32_16x16x64_bf16 v[176:179], v[68:71], v[220:227], v42
    ds_read_b32 v244, v236
    ds_read_b128 v[240:243], v8 offset:8192
    v_xad_u32 v237, v237, v3, v4
    v_smfmac_f32_16x16x64_bf16 v[176:179], v[104:107], v[228:235], v46
    ds_read_b32 v246, v237
    v_xad_u32 v238, v238, v3, v4
    v_smfmac_f32_16x16x64_bf16 v[180:183], v[72:75], v[220:227], v42 abid:1
    ds_read_b32 v248, v238
    v_xad_u32 v239, v239, v3, v4
    v_smfmac_f32_16x16x64_bf16 v[180:183], v[108:111], v[228:235], v46 abid:1
    ds_read_b32 v250, v239
    ds_read_b128 v[236:239], v9 offset:9216
    v_cvt_pk_bf16_f32 v160, v160, v161
    v_smfmac_f32_16x16x64_bf16 v[184:187], v[76:79], v[220:227], v43
    v_cvt_pk_bf16_f32 v161, v162, v163
    v_smfmac_f32_16x16x64_bf16 v[184:187], v[112:115], v[228:235], v47
    v_cvt_pk_bf16_f32 v162, v164, v165
    v_smfmac_f32_16x16x64_bf16 v[188:191], v[80:83], v[220:227], v43 abid:1
    v_cvt_pk_bf16_f32 v163, v166, v167
    v_smfmac_f32_16x16x64_bf16 v[188:191], v[116:119], v[228:235], v47 abid:1
    v_cvt_pk_bf16_f32 v168, v168, v169
    v_smfmac_f32_16x16x64_bf16 v[192:195], v[84:87], v[220:227], v51 abid:1
    v_cvt_pk_bf16_f32 v169, v170, v171
    v_smfmac_f32_16x16x64_bf16 v[192:195], v[120:123], v[228:235], v52
    ds_read_b128 v[220:223], v1 offset:3072
    s_waitcnt lgkmcnt(1)
    v_xad_u32 v236, v236, v3, v4
    v_smfmac_f32_16x16x64_bf16 v[156:159], v[240:243], v[244:251], v10
    ds_read_b32 v244, v236
    ds_read_b128 v[240:243], v8 offset:0
    v_xad_u32 v237, v237, v3, v4
    v_smfmac_f32_16x16x64_bf16 v[156:159], a[32:35], v[196:203], v48
    ds_read_b32 v246, v237
    ds_read_b128 v[224:227], v2 offset:3072
    v_xad_u32 v238, v238, v3, v4
    v_smfmac_f32_16x16x64_bf16 v[156:159], a[68:71], v[204:211], v48 abid:1
    ds_read_b32 v248, v238
    ds_read_b128 v[228:231], v1 offset:4096
    v_xad_u32 v239, v239, v3, v4
    v_smfmac_f32_16x16x64_bf16 v[156:159], a[104:107], v[212:219], v49
    ds_read_b32 v250, v239
    ds_read_b128 v[236:239], v9 offset:9280
    ds_read_b128 v[232:235], v2 offset:4096
    v_smfmac_f32_16x16x64_bf16 v[124:127], a[0:3], v[196:203], v12
    v_cvt_pk_bf16_f32 v170, v172, v173
    v_smfmac_f32_16x16x64_bf16 v[124:127], a[36:39], v[204:211], v16
    v_cvt_pk_bf16_f32 v192, v192, v193
    v_smfmac_f32_16x16x64_bf16 v[124:127], a[72:75], v[212:219], v20
    v_cvt_pk_bf16_f32 v193, v194, v195
    v_smfmac_f32_16x16x64_bf16 v[128:131], a[4:7], v[196:203], v12 abid:1
    ds_write_b64 v53, v[192:193] offset:0
    v_cvt_pk_bf16_f32 v171, v174, v175
    v_smfmac_f32_16x16x64_bf16 v[128:131], a[40:43], v[204:211], v16 abid:1
    v_cndmask_b32_dpp v164, v160, v168, vcc row_ror:8 row_mask:0xf bank_mask:0xf
    v_smfmac_f32_16x16x64_bf16 v[128:131], a[76:79], v[212:219], v20 abid:1
    s_waitcnt lgkmcnt(2)
    v_xad_u32 v236, v236, v3, v4
    v_smfmac_f32_16x16x64_bf16 v[124:127], v[240:243], v[244:251], v10
    ds_read_b32 v244, v236
    ds_read_b128 v[240:243], v8 offset:1024
    v_xad_u32 v237, v237, v3, v4
    v_smfmac_f32_16x16x64_bf16 v[132:135], a[8:11], v[196:203], v13
    ds_read_b32 v246, v237
    v_xad_u32 v238, v238, v3, v4
    v_smfmac_f32_16x16x64_bf16 v[132:135], a[44:47], v[204:211], v17
    ds_read_b32 v248, v238
    v_xad_u32 v239, v239, v3, v4
    v_smfmac_f32_16x16x64_bf16 v[132:135], a[80:83], v[212:219], v21
    ds_read_b32 v250, v239
    ds_read_b128 v[236:239], v9 offset:9344
    v_cndmask_b32_dpp v165, v161, v169, vcc row_ror:8 row_mask:0xf bank_mask:0xf
    v_smfmac_f32_16x16x64_bf16 v[136:139], a[12:15], v[196:203], v13 abid:1
    v_cndmask_b32_dpp v166, v162, v170, vcc row_ror:8 row_mask:0xf bank_mask:0xf
    v_smfmac_f32_16x16x64_bf16 v[136:139], a[48:51], v[204:211], v17 abid:1
    v_cndmask_b32_dpp v167, v163, v171, vcc row_ror:8 row_mask:0xf bank_mask:0xf
    v_smfmac_f32_16x16x64_bf16 v[136:139], a[84:87], v[212:219], v21 abid:1
    ds_read_b128 v[196:199], v1 offset:5120
    buffer_store_dwordx4 v[164:167], v6, s[12:15], s58 offen offset:0 sc1
    v_mov_b32_dpp v160, v168 row_ror:8 row_mask:0xf bank_mask:0xc
    v_smfmac_f32_16x16x64_bf16 v[156:159], a[140:143], v[220:227], v49 abid:1
    ds_read_b128 v[200:203], v2 offset:5120
    ds_read_b64 v[216:217], v9 offset:10056
    s_waitcnt lgkmcnt(10)
    v_mov_b32_dpp v161, v169 row_ror:8 row_mask:0xf bank_mask:0xc
    v_smfmac_f32_16x16x64_bf16 v[156:159], a[176:179], v[228:235], v50
    ds_read_b128 v[204:207], v1 offset:6144
    s_waitcnt lgkmcnt(4)
    v_xad_u32 v236, v236, v3, v4
    v_smfmac_f32_16x16x64_bf16 v[128:131], v[240:243], v[244:251], v10
    ds_read_b32 v244, v236
    ds_read_b128 v[240:243], v8 offset:2048
    v_xad_u32 v237, v237, v3, v4
    v_smfmac_f32_16x16x64_bf16 v[124:127], a[108:111], v[220:227], v24
    ds_read_b32 v246, v237
    ds_read_b128 v[208:211], v2 offset:6144
    v_xad_u32 v238, v238, v3, v4
    v_smfmac_f32_16x16x64_bf16 v[124:127], a[144:147], v[228:235], v28
    ds_read_b32 v248, v238
    v_xad_u32 v239, v239, v3, v4
    v_smfmac_f32_16x16x64_bf16 v[128:131], a[112:115], v[220:227], v24 abid:1
    ds_read_b32 v250, v239
    ds_read_b128 v[236:239], v9 offset:9408
    s_waitcnt lgkmcnt(8)
    v_xad_u32 v212, v216, v3, v4
    v_smfmac_f32_16x16x64_bf16 v[128:131], a[148:151], v[228:235], v28 abid:1
    ds_read2st64_b32 v[212:213], v212 offset0:0 offset1:72
    v_xad_u32 v214, v217, v3, v4
    v_smfmac_f32_16x16x64_bf16 v[132:135], a[116:119], v[220:227], v25
    ds_read2st64_b32 v[214:215], v214 offset0:0 offset1:72
    v_mov_b32_dpp v162, v170 row_ror:8 row_mask:0xf bank_mask:0xc
    v_smfmac_f32_16x16x64_bf16 v[132:135], a[152:155], v[228:235], v29
    v_mov_b32_dpp v163, v171 row_ror:8 row_mask:0xf bank_mask:0xc
    v_smfmac_f32_16x16x64_bf16 v[136:139], a[120:123], v[220:227], v25 abid:1
    buffer_store_dwordx4 v[160:163], v6, s[12:15], s23 offen offset:0 sc1
    v_cvt_pk_bf16_f32 v176, v176, v177
    v_smfmac_f32_16x16x64_bf16 v[136:139], a[156:159], v[228:235], v29 abid:1
    ds_read_b128 v[220:223], v1 offset:7168
    v_cvt_pk_bf16_f32 v177, v178, v179
    v_smfmac_f32_16x16x64_bf16 v[156:159], a[212:215], v[196:203], v50 abid:1
    ds_read_b128 v[224:227], v2 offset:7168
    s_waitcnt lgkmcnt(7)
    v_cvt_pk_bf16_f32 v178, v180, v181
    v_smfmac_f32_16x16x64_bf16 v[156:159], a[248:251], v[204:211], v51
    ds_read_b128 v[228:231], v1 offset:8192
    s_waitcnt lgkmcnt(5)
    v_xad_u32 v236, v236, v3, v4
    v_smfmac_f32_16x16x64_bf16 v[132:135], v[240:243], v[244:251], v10
    ds_read_b32 v244, v236
    ds_read_b128 v[240:243], v8 offset:3072
    v_xad_u32 v237, v237, v3, v4
    v_smfmac_f32_16x16x64_bf16 v[124:127], a[180:183], v[196:203], v32
    ds_read_b32 v246, v237
    ds_read_b128 v[232:235], v2 offset:8192
    v_xad_u32 v238, v238, v3, v4
    v_smfmac_f32_16x16x64_bf16 v[124:127], a[216:219], v[204:211], v36
    ds_read_b32 v248, v238
    v_xad_u32 v239, v239, v3, v4
    v_smfmac_f32_16x16x64_bf16 v[128:131], a[184:187], v[196:203], v32 abid:1
    ds_read_b32 v250, v239
    ds_read_b128 v[236:239], v9 offset:9472
    v_cvt_pk_bf16_f32 v179, v182, v183
    v_smfmac_f32_16x16x64_bf16 v[128:131], a[220:223], v[204:211], v36 abid:1
    v_cvt_pk_bf16_f32 v184, v184, v185
    v_smfmac_f32_16x16x64_bf16 v[132:135], a[188:191], v[196:203], v33
    v_cvt_pk_bf16_f32 v185, v186, v187
    v_smfmac_f32_16x16x64_bf16 v[132:135], a[224:227], v[204:211], v37
    v_cvt_pk_bf16_f32 v186, v188, v189
    v_smfmac_f32_16x16x64_bf16 v[136:139], a[192:195], v[196:203], v33 abid:1
    v_cvt_pk_bf16_f32 v187, v190, v191
    v_smfmac_f32_16x16x64_bf16 v[136:139], a[228:231], v[204:211], v37 abid:1
    ds_read_b128 v[196:199], v1 offset:0
    s_waitcnt lgkmcnt(1)
    v_xad_u32 v236, v236, v3, v4
    v_smfmac_f32_16x16x64_bf16 v[136:139], v[240:243], v[244:251], v10
    ds_read_b32 v244, v236
    ds_read_b128 v[240:243], v8 offset:4096
    v_xad_u32 v237, v237, v3, v4
    v_smfmac_f32_16x16x64_bf16 v[156:159], v[84:87], v[220:227], v51 abid:1
    ds_read_b32 v246, v237
    ds_read_b128 v[200:203], v2 offset:0
    v_xad_u32 v238, v238, v3, v4
    v_smfmac_f32_16x16x64_bf16 v[156:159], v[120:123], v[228:235], v52
    ds_read_b32 v248, v238
    ds_read_b128 v[204:207], v1 offset:1024
    v_xad_u32 v239, v239, v3, v4
    v_smfmac_f32_16x16x64_bf16 v[124:127], a[252:255], v[220:227], v40
    ds_read_b32 v250, v239
    ds_read_b128 v[236:239], v9 offset:9536
    ds_read_b128 v[208:211], v2 offset:1024
    v_smfmac_f32_16x16x64_bf16 v[124:127], v[88:91], v[228:235], v44
    v_cndmask_b32_dpp v180, v176, v184, vcc row_ror:8 row_mask:0xf bank_mask:0xf
    v_smfmac_f32_16x16x64_bf16 v[128:131], v[56:59], v[220:227], v40 abid:1
    v_cndmask_b32_dpp v181, v177, v185, vcc row_ror:8 row_mask:0xf bank_mask:0xf
    v_smfmac_f32_16x16x64_bf16 v[128:131], v[92:95], v[228:235], v44 abid:1
    v_cndmask_b32_dpp v182, v178, v186, vcc row_ror:8 row_mask:0xf bank_mask:0xf
    v_smfmac_f32_16x16x64_bf16 v[132:135], v[60:63], v[220:227], v41
    v_cndmask_b32_dpp v183, v179, v187, vcc row_ror:8 row_mask:0xf bank_mask:0xf
    v_smfmac_f32_16x16x64_bf16 v[132:135], v[96:99], v[228:235], v45
    buffer_store_dwordx4 v[180:183], v6, s[12:15], s58 offen offset:128 sc1
    v_mov_b32_dpp v176, v184 row_ror:8 row_mask:0xf bank_mask:0xc
    v_smfmac_f32_16x16x64_bf16 v[136:139], v[64:67], v[220:227], v41 abid:1
    v_mov_b32_dpp v177, v185 row_ror:8 row_mask:0xf bank_mask:0xc
    v_smfmac_f32_16x16x64_bf16 v[136:139], v[100:103], v[228:235], v45 abid:1
    ds_read_b128 v[220:223], v1 offset:2048
    s_waitcnt lgkmcnt(2)
    v_xad_u32 v236, v236, v3, v4
    v_smfmac_f32_16x16x64_bf16 v[140:143], v[240:243], v[244:251], v10
    ds_read_b32 v244, v236
    ds_read_b128 v[240:243], v8 offset:5120
    v_xad_u32 v237, v237, v3, v4
    v_smfmac_f32_16x16x64_bf16 v[140:143], a[16:19], v[196:203], v14
    ds_read_b32 v246, v237
    ds_read_b128 v[224:227], v2 offset:2048
    s_waitcnt lgkmcnt(5)
    v_xad_u32 v238, v238, v3, v4
    v_smfmac_f32_16x16x64_bf16 v[140:143], a[52:55], v[204:211], v18
    ds_read_b32 v248, v238
    ds_read_b128 v[228:231], v1 offset:3072
    v_xad_u32 v239, v239, v3, v4
    v_smfmac_f32_16x16x64_bf16 v[144:147], a[20:23], v[196:203], v14 abid:1
    ds_read_b32 v250, v239
    ds_read_b128 v[236:239], v9 offset:9600
    ds_read_b128 v[232:235], v2 offset:3072
    v_smfmac_f32_16x16x64_bf16 v[144:147], a[56:59], v[204:211], v18 abid:1
    v_mov_b32_dpp v178, v186 row_ror:8 row_mask:0xf bank_mask:0xc
    v_smfmac_f32_16x16x64_bf16 v[148:151], a[24:27], v[196:203], v15
    v_mov_b32_dpp v179, v187 row_ror:8 row_mask:0xf bank_mask:0xc
    v_smfmac_f32_16x16x64_bf16 v[148:151], a[60:63], v[204:211], v19
    buffer_store_dwordx4 v[176:179], v6, s[12:15], s23 offen offset:128 sc1
    v_smfmac_f32_16x16x64_bf16 v[152:155], a[28:31], v[196:203], v15 abid:1
    s_cmp_lt_i32 s81, 0
    s_cbranch_scc1 M_ovrH
    s_swappc_b64 s[78:79], s[72:73]
M_ovrH:
    v_smfmac_f32_16x16x64_bf16 v[152:155], a[64:67], v[204:211], v19 abid:1
    ds_read_b128 v[196:199], v1 offset:4096
    s_waitcnt lgkmcnt(2)
    v_xad_u32 v236, v236, v3, v4
    v_smfmac_f32_16x16x64_bf16 v[144:147], v[240:243], v[244:251], v10
    s_cmp_gt_u32 s46, s80
    s_cbranch_scc1 M_slow
M_slowrH:
    ds_read_b32 v244, v236
    v_smfmac_f32_16x16x64_bf16 v[140:143], a[88:91], v[220:227], v22
    ds_read_b128 v[240:243], v8 offset:6144
    ds_read_b128 v[200:203], v2 offset:4096
    s_waitcnt lgkmcnt(4)
    v_xad_u32 v237, v237, v3, v4
    v_smfmac_f32_16x16x64_bf16 v[140:143], a[124:127], v[228:235], v26
    ds_read_b32 v246, v237
    ds_read_b128 v[204:207], v1 offset:5120
    v_xad_u32 v238, v238, v3, v4
    v_smfmac_f32_16x16x64_bf16 v[144:147], a[92:95], v[220:227], v22 abid:1
    ds_read_b32 v248, v238
    ds_read_b128 v[208:211], v2 offset:5120
    v_xad_u32 v239, v239, v3, v4
    v_smfmac_f32_16x16x64_bf16 v[144:147], a[128:131], v[228:235], v26 abid:1
    ds_read_b32 v250, v239
    ds_read_b128 v[236:239], v9 offset:9664
    ds_read_b128 v[212:215], v1 offset:8192
    v_smfmac_f32_16x16x64_bf16 v[148:151], a[96:99], v[220:227], v23
    ds_read_b128 v[216:219], v2 offset:8192
    v_cvt_pk_bf16_f32 v156, v156, v157
    v_smfmac_f32_16x16x64_bf16 v[148:151], a[132:135], v[228:235], v27
    v_cvt_pk_bf16_f32 v157, v158, v159
    v_smfmac_f32_16x16x64_bf16 v[152:155], a[100:103], v[220:227], v23 abid:1
    ds_write_b64 v53, v[156:157] offset:25728
    v_cvt_pk_bf16_f32 v124, v124, v125
    v_smfmac_f32_16x16x64_bf16 v[152:155], a[136:139], v[228:235], v27 abid:1
    ds_read_b128 v[220:223], v1 offset:6144
    s_waitcnt lgkmcnt(10)
    v_cvt_pk_bf16_f32 v125, v126, v127
    v_smfmac_f32_16x16x64_bf16 v[140:143], a[160:163], v[196:203], v30
    ds_read_b128 v[224:227], v2 offset:6144
    s_waitcnt lgkmcnt(7)
    v_cvt_pk_bf16_f32 v126, v128, v129
    v_smfmac_f32_16x16x64_bf16 v[140:143], a[196:199], v[204:211], v34
    ds_read_b128 v[228:231], v1 offset:7168
    s_waitcnt lgkmcnt(6)
    v_xad_u32 v236, v236, v3, v4
    v_smfmac_f32_16x16x64_bf16 v[148:151], v[240:243], v[244:251], v10
    ds_read_b32 v244, v236
    ds_read_b128 v[240:243], v8 offset:7168
    v_xad_u32 v237, v237, v3, v4
    v_smfmac_f32_16x16x64_bf16 v[144:147], a[164:167], v[196:203], v30 abid:1
    ds_read_b32 v246, v237
    ds_read_b128 v[232:235], v2 offset:7168
    v_xad_u32 v238, v238, v3, v4
    v_smfmac_f32_16x16x64_bf16 v[144:147], a[200:203], v[204:211], v34 abid:1
    ds_read_b32 v248, v238
    s_waitcnt lgkmcnt(8)
    s_barrier
    v_xad_u32 v239, v239, v3, v4
    v_smfmac_f32_16x16x64_bf16 v[148:151], a[168:171], v[196:203], v31
    ds_read_b32 v250, v239
    ds_read_b128 v[160:163], v8 offset:10816
    v_cvt_pk_bf16_f32 v127, v130, v131
    v_smfmac_f32_16x16x64_bf16 v[148:151], a[204:207], v[204:211], v35
    v_cvt_pk_bf16_f32 v132, v132, v133
    v_smfmac_f32_16x16x64_bf16 v[152:155], a[172:175], v[196:203], v31 abid:1
    v_cvt_pk_bf16_f32 v133, v134, v135
    v_smfmac_f32_16x16x64_bf16 v[152:155], a[208:211], v[204:211], v35 abid:1
    s_waitcnt lgkmcnt(8)
    v_cvt_pk_bf16_f32 v134, v136, v137
    v_smfmac_f32_16x16x64_bf16 v[140:143], a[232:235], v[220:227], v38
    s_waitcnt lgkmcnt(3)
    v_cvt_pk_bf16_f32 v135, v138, v139
    v_smfmac_f32_16x16x64_bf16 v[140:143], v[68:71], v[228:235], v42
    v_cndmask_b32_dpp v128, v124, v132, vcc row_ror:8 row_mask:0xf bank_mask:0xf
    v_smfmac_f32_16x16x64_bf16 v[140:143], v[104:107], v[212:219], v46
    s_waitcnt lgkmcnt(0)
    buffer_store_dwordx4 v[160:163], v7, s[12:15], s66 offen sc1
    v_cndmask_b32_dpp v129, v125, v133, vcc row_ror:8 row_mask:0xf bank_mask:0xf
    v_smfmac_f32_16x16x64_bf16 v[152:155], v[240:243], v[244:251], v10
    v_cndmask_b32_dpp v130, v126, v134, vcc row_ror:8 row_mask:0xf bank_mask:0xf
    v_smfmac_f32_16x16x64_bf16 v[144:147], a[236:239], v[220:227], v38 abid:1
    v_cndmask_b32_dpp v131, v127, v135, vcc row_ror:8 row_mask:0xf bank_mask:0xf
    v_smfmac_f32_16x16x64_bf16 v[144:147], v[72:75], v[228:235], v42 abid:1
    buffer_store_dwordx4 v[128:131], v6, s[12:15], s59 offen offset:0 sc1
    v_mov_b32_dpp v124, v132 row_ror:8 row_mask:0xf bank_mask:0xc
    v_smfmac_f32_16x16x64_bf16 v[144:147], v[108:111], v[212:219], v46 abid:1
    v_mov_b32_dpp v125, v133 row_ror:8 row_mask:0xf bank_mask:0xc
    v_smfmac_f32_16x16x64_bf16 v[148:151], a[240:243], v[220:227], v39
    v_mov_b32_dpp v126, v134 row_ror:8 row_mask:0xf bank_mask:0xc
    v_smfmac_f32_16x16x64_bf16 v[148:151], v[76:79], v[228:235], v43
    v_mov_b32_dpp v127, v135 row_ror:8 row_mask:0xf bank_mask:0xc
    v_smfmac_f32_16x16x64_bf16 v[148:151], v[112:115], v[212:219], v47
    buffer_store_dwordx4 v[124:127], v6, s[12:15], s24 offen offset:0 sc1
    v_smfmac_f32_16x16x64_bf16 v[152:155], a[244:247], v[220:227], v39 abid:1
    v_cvt_pk_bf16_f32 v140, v140, v141
    v_smfmac_f32_16x16x64_bf16 v[152:155], v[80:83], v[228:235], v43 abid:1
    v_cvt_pk_bf16_f32 v141, v142, v143
    v_smfmac_f32_16x16x64_bf16 v[152:155], v[116:119], v[212:219], v47 abid:1
    v_cvt_pk_bf16_f32 v142, v144, v145
    v_cvt_pk_bf16_f32 v143, v146, v147
    v_cvt_pk_bf16_f32 v148, v148, v149
    v_cvt_pk_bf16_f32 v149, v150, v151
    s_nop 3
    v_cvt_pk_bf16_f32 v150, v152, v153
    v_cvt_pk_bf16_f32 v151, v154, v155
    v_cndmask_b32_dpp v144, v140, v148, vcc row_ror:8 row_mask:0xf bank_mask:0xf
    v_cndmask_b32_dpp v145, v141, v149, vcc row_ror:8 row_mask:0xf bank_mask:0xf
    v_cndmask_b32_dpp v146, v142, v150, vcc row_ror:8 row_mask:0xf bank_mask:0xf
    v_cndmask_b32_dpp v147, v143, v151, vcc row_ror:8 row_mask:0xf bank_mask:0xf
    buffer_store_dwordx4 v[144:147], v6, s[12:15], s59 offen offset:128 sc1
    v_mov_b32_dpp v140, v148 row_ror:8 row_mask:0xf bank_mask:0xc
    v_mov_b32_dpp v141, v149 row_ror:8 row_mask:0xf bank_mask:0xc
    v_mov_b32_dpp v142, v150 row_ror:8 row_mask:0xf bank_mask:0xc
    v_mov_b32_dpp v143, v151 row_ror:8 row_mask:0xf bank_mask:0xc
    buffer_store_dwordx4 v[140:143], v6, s[12:15], s24 offen offset:128 sc1
    s_branch M_done
M_bF:
    s_cmp_ge_u32 s24, 74612736
    s_cbranch_scc1 M_bH
    v_smfmac_f32_16x16x64_bf16 v[164:167], v[56:59], v[220:227], v40 abid:1
    ds_read_b128 v[204:207], v1 offset:1024
    v_smfmac_f32_16x16x64_bf16 v[164:167], v[92:95], v[228:235], v44 abid:1
    ds_read_b128 v[208:211], v2 offset:1024
    v_smfmac_f32_16x16x64_bf16 v[168:171], v[60:63], v[220:227], v41
    ds_read_b128 v[212:215], v1 offset:2048
    v_smfmac_f32_16x16x64_bf16 v[168:171], v[96:99], v[228:235], v45
    ds_read_b128 v[216:219], v2 offset:2048
    v_smfmac_f32_16x16x64_bf16 v[172:175], v[64:67], v[220:227], v41 abid:1
    s_waitcnt lgkmcnt(6)
    buffer_store_dwordx4 v[244:247], v7, s[12:15], s66 offen sc1
    v_smfmac_f32_16x16x64_bf16 v[172:175], v[100:103], v[228:235], v45 abid:1
    ds_read_b128 v[236:239], v9 offset:9408
    v_smfmac_f32_16x16x64_bf16 v[176:179], v[68:71], v[220:227], v42
    s_mov_b32 s21, 4
    v_smfmac_f32_16x16x64_bf16 v[176:179], v[104:107], v[228:235], v46
    v_smfmac_f32_16x16x64_bf16 v[180:183], v[72:75], v[220:227], v42 abid:1
    v_cvt_pk_bf16_f32 v160, v160, v161
    v_smfmac_f32_16x16x64_bf16 v[180:183], v[108:111], v[228:235], v46 abid:1
    v_cvt_pk_bf16_f32 v161, v162, v163
    v_smfmac_f32_16x16x64_bf16 v[184:187], v[76:79], v[220:227], v43
    v_cvt_pk_bf16_f32 v162, v164, v165
    v_smfmac_f32_16x16x64_bf16 v[184:187], v[112:115], v[228:235], v47
    v_cvt_pk_bf16_f32 v163, v166, v167
    v_smfmac_f32_16x16x64_bf16 v[188:191], v[80:83], v[220:227], v43 abid:1
    v_cvt_pk_bf16_f32 v168, v168, v169
    v_smfmac_f32_16x16x64_bf16 v[188:191], v[116:119], v[228:235], v47 abid:1
    v_cvt_pk_bf16_f32 v169, v170, v171
    v_smfmac_f32_16x16x64_bf16 v[192:195], v[84:87], v[220:227], v51 abid:1
    v_cvt_pk_bf16_f32 v170, v172, v173
    v_smfmac_f32_16x16x64_bf16 v[192:195], v[120:123], v[228:235], v52
    ds_read_b128 v[220:223], v1 offset:3072
    s_waitcnt lgkmcnt(6)
    v_cvt_pk_bf16_f32 v171, v174, v175
    v_smfmac_f32_16x16x64_bf16 v[124:127], a[0:3], v[196:203], v12
    ds_read_b128 v[224:227], v2 offset:3072
    ds_read_b128 v[172:175], v9 offset:10432
    s_waitcnt lgkmcnt(6)
    v_cndmask_b32_dpp v164, v160, v168, vcc row_ror:8 row_mask:0xf bank_mask:0xf
    v_smfmac_f32_16x16x64_bf16 v[124:127], a[36:39], v[204:211], v16
    ds_read_b128 v[228:231], v1 offset:4096
    s_waitcnt lgkmcnt(5)
    v_cndmask_b32_dpp v165, v161, v169, vcc row_ror:8 row_mask:0xf bank_mask:0xf
    v_smfmac_f32_16x16x64_bf16 v[124:127], a[72:75], v[212:219], v20
    ds_read_b128 v[232:235], v2 offset:4096
    s_waitcnt lgkmcnt(5)
    v_xad_u32 v236, v236, v3, v4
    v_smfmac_f32_16x16x64_bf16 v[156:159], a[32:35], v[196:203], v48
    s_barrier
    v_xad_u32 v237, v237, v3, v4
    v_smfmac_f32_16x16x64_bf16 v[156:159], a[68:71], v[204:211], v48 abid:1
    ds_read2st64_b32 v[244:245], v236 offset0:0 offset1:72
    ds_read_b128 v[240:243], v8 offset:3072
    v_xad_u32 v238, v238, v3, v4
    v_smfmac_f32_16x16x64_bf16 v[156:159], a[104:107], v[212:219], v49
    ds_read2st64_b32 v[246:247], v237 offset0:0 offset1:72
    v_xad_u32 v239, v239, v3, v4
    v_smfmac_f32_16x16x64_bf16 v[132:135], a[8:11], v[196:203], v13
    ds_read2st64_b32 v[248:249], v238 offset0:0 offset1:72
    v_cndmask_b32_dpp v166, v162, v170, vcc row_ror:8 row_mask:0xf bank_mask:0xf
    v_smfmac_f32_16x16x64_bf16 v[132:135], a[44:47], v[204:211], v17
    ds_read2st64_b32 v[250:251], v239 offset0:0 offset1:72
    ds_read_b128 v[236:239], v9 offset:9280
    v_cndmask_b32_dpp v167, v163, v171, vcc row_ror:8 row_mask:0xf bank_mask:0xf
    v_smfmac_f32_16x16x64_bf16 v[132:135], a[80:83], v[212:219], v21
    buffer_store_dwordx4 v[164:167], v6, s[12:15], s58 offen offset:0 sc1
    v_mov_b32_dpp v160, v168 row_ror:8 row_mask:0xf bank_mask:0xc
    v_smfmac_f32_16x16x64_bf16 v[140:143], a[16:19], v[196:203], v14
    v_mov_b32_dpp v161, v169 row_ror:8 row_mask:0xf bank_mask:0xc
    v_smfmac_f32_16x16x64_bf16 v[140:143], a[52:55], v[204:211], v18
    v_mov_b32_dpp v162, v170 row_ror:8 row_mask:0xf bank_mask:0xc
    v_smfmac_f32_16x16x64_bf16 v[140:143], a[88:91], v[212:219], v22
    v_mov_b32_dpp v163, v171 row_ror:8 row_mask:0xf bank_mask:0xc
    v_smfmac_f32_16x16x64_bf16 v[136:139], a[12:15], v[196:203], v13 abid:1
    buffer_store_dwordx4 v[160:163], v6, s[12:15], s23 offen offset:0 sc1
    ds_read_b128 v[164:167], v9 offset:10304
    ds_read_b128 v[168:171], v9 offset:10368
    v_smfmac_f32_16x16x64_bf16 v[136:139], a[48:51], v[204:211], v17 abid:1
    ds_read_b128 v[160:163], v9 offset:10240
    v_smfmac_f32_16x16x64_bf16 v[136:139], a[84:87], v[212:219], v21 abid:1
    s_waitcnt lgkmcnt(3)
    v_xad_u32 v236, v236, v3, v4
    v_smfmac_f32_16x16x64_bf16 v[136:139], v[240:243], v[244:251], v10
    v_xad_u32 v237, v237, v3, v4
    v_smfmac_f32_16x16x64_bf16 v[172:175], v[240:243], v[244:251], v10 abid:1
    ds_read2st64_b32 v[244:245], v236 offset0:0 offset1:72
    ds_read_b128 v[240:243], v8 offset:1024
    v_xad_u32 v238, v238, v3, v4
    v_smfmac_f32_16x16x64_bf16 v[144:147], a[20:23], v[196:203], v14 abid:1
    ds_read2st64_b32 v[246:247], v237 offset0:0 offset1:72
    v_xad_u32 v239, v239, v3, v4
    v_smfmac_f32_16x16x64_bf16 v[144:147], a[56:59], v[204:211], v18 abid:1
    ds_read2st64_b32 v[248:249], v238 offset0:0 offset1:72
    v_smfmac_f32_16x16x64_bf16 v[144:147], a[92:95], v[212:219], v22 abid:1
    ds_read2st64_b32 v[250:251], v239 offset0:0 offset1:72
    ds_read_b128 v[236:239], v9 offset:9344
    v_smfmac_f32_16x16x64_bf16 v[148:151], a[24:27], v[196:203], v15
    v_cvt_pk_bf16_f32 v192, v192, v193
    v_smfmac_f32_16x16x64_bf16 v[148:151], a[60:63], v[204:211], v19
    v_cvt_pk_bf16_f32 v193, v194, v195
    v_smfmac_f32_16x16x64_bf16 v[148:151], a[96:99], v[212:219], v23
    ds_write_b64 v53, v[192:193] offset:0
    ds_read_b128 v[192:195], v9 offset:10752
    v_smfmac_f32_16x16x64_bf16 v[152:155], a[28:31], v[196:203], v15 abid:1
    v_smfmac_f32_16x16x64_bf16 v[152:155], a[64:67], v[204:211], v19 abid:1
    v_smfmac_f32_16x16x64_bf16 v[152:155], a[100:103], v[212:219], v23 abid:1
    v_smfmac_f32_16x16x64_bf16 v[128:131], a[4:7], v[196:203], v12 abid:1
    v_smfmac_f32_16x16x64_bf16 v[128:131], a[40:43], v[204:211], v16 abid:1
    v_smfmac_f32_16x16x64_bf16 v[128:131], a[76:79], v[212:219], v20 abid:1
    s_waitcnt lgkmcnt(2)
    v_xad_u32 v236, v236, v3, v4
    v_smfmac_f32_16x16x64_bf16 v[128:131], v[240:243], v[244:251], v10
    v_xad_u32 v237, v237, v3, v4
    v_smfmac_f32_16x16x64_bf16 v[164:167], v[240:243], v[244:251], v10 abid:1
    ds_read2st64_b32 v[244:245], v236 offset0:0 offset1:72
    ds_read_b128 v[240:243], v8 offset:2048
    v_xad_u32 v238, v238, v3, v4
    v_smfmac_f32_16x16x64_bf16 v[124:127], a[108:111], v[220:227], v24
    ds_read2st64_b32 v[246:247], v237 offset0:0 offset1:72
    v_xad_u32 v239, v239, v3, v4
    v_smfmac_f32_16x16x64_bf16 v[124:127], a[144:147], v[228:235], v28
    ds_read2st64_b32 v[248:249], v238 offset0:0 offset1:72
    ds_read_b64 v[216:217], v9 offset:10056
    v_cvt_pk_bf16_f32 v176, v176, v177
    v_smfmac_f32_16x16x64_bf16 v[128:131], a[112:115], v[220:227], v24 abid:1
    ds_read2st64_b32 v[250:251], v239 offset0:0 offset1:72
    ds_read_b128 v[236:239], v9 offset:9216
    v_cvt_pk_bf16_f32 v177, v178, v179
    v_smfmac_f32_16x16x64_bf16 v[128:131], a[148:151], v[228:235], v28 abid:1
    v_cvt_pk_bf16_f32 v178, v180, v181
    v_smfmac_f32_16x16x64_bf16 v[140:143], a[124:127], v[220:227], v26
    v_cvt_pk_bf16_f32 v179, v182, v183
    v_smfmac_f32_16x16x64_bf16 v[140:143], a[160:163], v[228:235], v30
    v_cvt_pk_bf16_f32 v184, v184, v185
    v_smfmac_f32_16x16x64_bf16 v[136:139], a[120:123], v[220:227], v25 abid:1
    v_cvt_pk_bf16_f32 v185, v186, v187
    v_smfmac_f32_16x16x64_bf16 v[136:139], a[156:159], v[228:235], v29 abid:1
    ds_read_b128 v[196:199], v1 offset:5120
    v_cvt_pk_bf16_f32 v186, v188, v189
    v_smfmac_f32_16x16x64_bf16 v[132:135], a[116:119], v[220:227], v25
    ds_read_b128 v[200:203], v2 offset:5120
    v_cvt_pk_bf16_f32 v187, v190, v191
    v_smfmac_f32_16x16x64_bf16 v[132:135], a[152:155], v[228:235], v29
    ds_read_b128 v[188:191], v9 offset:10688
    s_waitcnt lgkmcnt(3)
    v_xad_u32 v236, v236, v3, v4
    v_smfmac_f32_16x16x64_bf16 v[132:135], v[240:243], v[244:251], v10
    ds_read_b128 v[204:207], v1 offset:6144
    v_xad_u32 v237, v237, v3, v4
    v_smfmac_f32_16x16x64_bf16 v[168:171], v[240:243], v[244:251], v10 abid:1
    ds_read2st64_b32 v[244:245], v236 offset0:0 offset1:72
    ds_read_b128 v[240:243], v8 offset:0
    v_xad_u32 v238, v238, v3, v4
    v_smfmac_f32_16x16x64_bf16 v[144:147], a[128:131], v[220:227], v26 abid:1
    ds_read2st64_b32 v[246:247], v237 offset0:0 offset1:72
    v_xad_u32 v239, v239, v3, v4
    v_smfmac_f32_16x16x64_bf16 v[144:147], a[164:167], v[228:235], v30 abid:1
    ds_read2st64_b32 v[248:249], v238 offset0:0 offset1:72
    ds_read_b128 v[208:211], v2 offset:6144
    v_cndmask_b32_dpp v180, v176, v184, vcc row_ror:8 row_mask:0xf bank_mask:0xf
    v_smfmac_f32_16x16x64_bf16 v[148:151], a[132:135], v[220:227], v27
    ds_read2st64_b32 v[250:251], v239 offset0:0 offset1:72
    ds_read_b128 v[236:239], v9 offset:9728
    v_cndmask_b32_dpp v181, v177, v185, vcc row_ror:8 row_mask:0xf bank_mask:0xf
    v_smfmac_f32_16x16x64_bf16 v[148:151], a[168:171], v[228:235], v31
    v_xad_u32 v212, v216, v3, v4
    v_smfmac_f32_16x16x64_bf16 v[152:155], a[136:139], v[220:227], v27 abid:1
    ds_read2st64_b32 v[212:213], v212 offset0:0 offset1:72
    v_xad_u32 v214, v217, v3, v4
    v_smfmac_f32_16x16x64_bf16 v[152:155], a[172:175], v[228:235], v31 abid:1
    ds_read2st64_b32 v[214:215], v214 offset0:0 offset1:72
    v_cndmask_b32_dpp v182, v178, v186, vcc row_ror:8 row_mask:0xf bank_mask:0xf
    v_smfmac_f32_16x16x64_bf16 v[156:159], a[140:143], v[220:227], v49 abid:1
    v_cndmask_b32_dpp v183, v179, v187, vcc row_ror:8 row_mask:0xf bank_mask:0xf
    v_smfmac_f32_16x16x64_bf16 v[156:159], a[176:179], v[228:235], v50
    buffer_store_dwordx4 v[180:183], v6, s[12:15], s58 offen offset:128 sc1
    s_waitcnt lgkmcnt(11)
    v_mov_b32_dpp v176, v184 row_ror:8 row_mask:0xf bank_mask:0xc
    v_smfmac_f32_16x16x64_bf16 v[128:131], a[184:187], v[196:203], v32 abid:1
    s_waitcnt lgkmcnt(4)
    v_mov_b32_dpp v177, v185 row_ror:8 row_mask:0xf bank_mask:0xc
    v_smfmac_f32_16x16x64_bf16 v[128:131], a[220:223], v[204:211], v36 abid:1
    v_mov_b32_dpp v178, v186 row_ror:8 row_mask:0xf bank_mask:0xc
    v_smfmac_f32_16x16x64_bf16 v[124:127], a[180:183], v[196:203], v32
    ds_read_b128 v[220:223], v1 offset:7168
    v_mov_b32_dpp v179, v187 row_ror:8 row_mask:0xf bank_mask:0xc
    v_smfmac_f32_16x16x64_bf16 v[124:127], a[216:219], v[204:211], v36
    buffer_store_dwordx4 v[176:179], v6, s[12:15], s23 offen offset:128 sc1
    s_waitcnt lgkmcnt(3)
    v_xad_u32 v236, v236, v3, v4
    v_smfmac_f32_16x16x64_bf16 v[124:127], v[240:243], v[244:251], v10
    ds_read_b128 v[224:227], v2 offset:7168
    ds_read_b128 v[180:183], v9 offset:10560
    v_xad_u32 v237, v237, v3, v4
    v_smfmac_f32_16x16x64_bf16 v[160:163], v[240:243], v[244:251], v10 abid:1
    ds_read2st64_b32 v[244:245], v236 offset0:0 offset1:72
    ds_read_b128 v[240:243], v8 offset:8192
    v_xad_u32 v238, v238, v3, v4
    v_smfmac_f32_16x16x64_bf16 v[132:135], a[188:191], v[196:203], v33
    ds_read2st64_b32 v[246:247], v237 offset0:0 offset1:72
    ds_read_b128 v[184:187], v9 offset:10624
    v_xad_u32 v239, v239, v3, v4
    v_smfmac_f32_16x16x64_bf16 v[132:135], a[224:227], v[204:211], v37
    ds_read2st64_b32 v[248:249], v238 offset0:0 offset1:72
    ds_read_b128 v[176:179], v9 offset:10496
    v_smfmac_f32_16x16x64_bf16 v[136:139], a[192:195], v[196:203], v33 abid:1
    ds_read2st64_b32 v[250:251], v239 offset0:0 offset1:72
    ds_read_b128 v[236:239], v9 offset:9664
    v_smfmac_f32_16x16x64_bf16 v[136:139], a[228:231], v[204:211], v37 abid:1
    v_smfmac_f32_16x16x64_bf16 v[140:143], a[196:199], v[196:203], v34
    v_smfmac_f32_16x16x64_bf16 v[140:143], a[232:235], v[204:211], v38
    ds_read_b128 v[228:231], v1 offset:8192
    v_smfmac_f32_16x16x64_bf16 v[144:147], a[200:203], v[196:203], v34 abid:1
    ds_read_b128 v[232:235], v2 offset:8192
    v_smfmac_f32_16x16x64_bf16 v[144:147], a[236:239], v[204:211], v38 abid:1
    s_waitcnt lgkmcnt(4)
    s_cmp_lt_i32 s81, 0
    s_cbranch_scc1 M_ovrF
    s_swappc_b64 s[78:79], s[72:73]
M_ovrF:
    v_smfmac_f32_16x16x64_bf16 v[156:159], a[212:215], v[196:203], v50 abid:1
    v_smfmac_f32_16x16x64_bf16 v[156:159], a[248:251], v[204:211], v51
    s_waitcnt lgkmcnt(2)
    v_xad_u32 v236, v236, v3, v4
    v_smfmac_f32_16x16x64_bf16 v[156:159], v[240:243], v[244:251], v10
    v_xad_u32 v237, v237, v3, v4
    v_smfmac_f32_16x16x64_bf16 v[192:195], v[240:243], v[244:251], v10 abid:1
    ds_read2st64_b32 v[244:245], v236 offset0:0 offset1:72
    ds_read_b128 v[240:243], v8 offset:7168
    v_xad_u32 v238, v238, v3, v4
    v_smfmac_f32_16x16x64_bf16 v[152:155], a[208:211], v[196:203], v35 abid:1
    ds_read2st64_b32 v[246:247], v237 offset0:0 offset1:72
    v_xad_u32 v239, v239, v3, v4
    v_smfmac_f32_16x16x64_bf16 v[152:155], a[244:247], v[204:211], v39 abid:1
    ds_read2st64_b32 v[248:249], v238 offset0:0 offset1:72
    v_smfmac_f32_16x16x64_bf16 v[148:151], a[204:207], v[196:203], v35
    ds_read2st64_b32 v[250:251], v239 offset0:0 offset1:72
    ds_read_b128 v[236:239], v9 offset:9536
    v_smfmac_f32_16x16x64_bf16 v[148:151], a[240:243], v[204:211], v39
    v_smfmac_f32_16x16x64_bf16 v[124:127], a[252:255], v[220:227], v40
    s_waitcnt lgkmcnt(6)
    v_smfmac_f32_16x16x64_bf16 v[124:127], v[88:91], v[228:235], v44
    v_smfmac_f32_16x16x64_bf16 v[128:131], v[56:59], v[220:227], v40 abid:1
    v_smfmac_f32_16x16x64_bf16 v[128:131], v[92:95], v[228:235], v44 abid:1
    s_cmp_lt_u32 s20, 2
    s_cselect_b32 s66, s23, s24
    s_add_u32 s66, s66, s95
    v_smfmac_f32_16x16x64_bf16 v[132:135], v[60:63], v[220:227], v41
    ds_read_b128 v[196:199], v1 offset:18432
    s_add_u32 s23, s24, 18432
    s_add_u32 s58, s24, 27648
    v_smfmac_f32_16x16x64_bf16 v[132:135], v[96:99], v[228:235], v45
    ds_read_b128 v[200:203], v2 offset:18432
    s_add_u32 s67, s23, s95
    v_smfmac_f32_16x16x64_bf16 v[152:155], v[80:83], v[220:227], v43 abid:1
    ds_read_b128 v[204:207], v1 offset:19456
    v_smfmac_f32_16x16x64_bf16 v[152:155], v[116:119], v[228:235], v47 abid:1
    s_waitcnt lgkmcnt(3)
    v_xad_u32 v236, v236, v3, v4
    v_smfmac_f32_16x16x64_bf16 v[152:155], v[240:243], v[244:251], v10
    ds_read_b128 v[208:211], v2 offset:19456
    v_xad_u32 v237, v237, v3, v4
    v_smfmac_f32_16x16x64_bf16 v[188:191], v[240:243], v[244:251], v10 abid:1
    s_cmp_gt_u32 s46, s80
    s_cbranch_scc1 M_slow
M_slowrF:
    v_xad_u32 v238, v238, v3, v4
    v_smfmac_f32_16x16x64_bf16 v[140:143], v[68:71], v[220:227], v42
    ds_read2st64_b32 v[244:245], v236 offset0:0 offset1:72
    ds_read_b128 v[240:243], v8 offset:5120
    v_xad_u32 v239, v239, v3, v4
    v_smfmac_f32_16x16x64_bf16 v[140:143], v[104:107], v[228:235], v46
    ds_read2st64_b32 v[246:247], v237 offset0:0 offset1:72
    v_smfmac_f32_16x16x64_bf16 v[156:159], v[84:87], v[220:227], v51 abid:1
    ds_read2st64_b32 v[248:249], v238 offset0:0 offset1:72
    ds_read_b128 v[212:215], v1 offset:20480
    v_smfmac_f32_16x16x64_bf16 v[156:159], v[120:123], v[228:235], v52
    ds_read2st64_b32 v[250:251], v239 offset0:0 offset1:72
    ds_read_b128 v[236:239], v9 offset:9600
    v_smfmac_f32_16x16x64_bf16 v[148:151], v[76:79], v[220:227], v43
    ds_read_b128 v[216:219], v2 offset:20480
    v_smfmac_f32_16x16x64_bf16 v[148:151], v[112:115], v[228:235], v47
    v_smfmac_f32_16x16x64_bf16 v[136:139], v[64:67], v[220:227], v41 abid:1
    v_smfmac_f32_16x16x64_bf16 v[136:139], v[100:103], v[228:235], v45 abid:1
    v_smfmac_f32_16x16x64_bf16 v[144:147], v[72:75], v[220:227], v42 abid:1
    v_smfmac_f32_16x16x64_bf16 v[144:147], v[108:111], v[228:235], v46 abid:1
    ds_read_b128 v[220:223], v1 offset:21504
    s_waitcnt lgkmcnt(2)
    v_xad_u32 v236, v236, v3, v4
    v_smfmac_f32_16x16x64_bf16 v[144:147], v[240:243], v[244:251], v10
    ds_read_b128 v[224:227], v2 offset:21504
    v_xad_u32 v237, v237, v3, v4
    v_smfmac_f32_16x16x64_bf16 v[180:183], v[240:243], v[244:251], v10 abid:1
    ds_read2st64_b32 v[244:245], v236 offset0:0 offset1:72
    ds_read_b128 v[240:243], v8 offset:6144
    v_xad_u32 v238, v238, v3, v4
    v_smfmac_f32_16x16x64_bf16 v[192:195], a[32:35], v[196:203], v48
    ds_read2st64_b32 v[246:247], v237 offset0:0 offset1:72
    ds_read_b128 v[228:231], v1 offset:22528
    v_xad_u32 v239, v239, v3, v4
    v_smfmac_f32_16x16x64_bf16 v[192:195], a[68:71], v[204:211], v48 abid:1
    ds_read2st64_b32 v[248:249], v238 offset0:0 offset1:72
    ds_read_b128 v[232:235], v2 offset:22528
    s_waitcnt lgkmcnt(8)
    v_cvt_pk_bf16_f32 v124, v124, v125
    v_smfmac_f32_16x16x64_bf16 v[192:195], a[104:107], v[212:219], v49
    ds_read2st64_b32 v[250:251], v239 offset0:0 offset1:72
    ds_read_b128 v[236:239], v9 offset:9472
    v_cvt_pk_bf16_f32 v125, v126, v127
    v_smfmac_f32_16x16x64_bf16 v[160:163], a[0:3], v[196:203], v12
    v_cvt_pk_bf16_f32 v126, v128, v129
    v_smfmac_f32_16x16x64_bf16 v[160:163], a[36:39], v[204:211], v16
    v_cvt_pk_bf16_f32 v127, v130, v131
    v_smfmac_f32_16x16x64_bf16 v[160:163], a[72:75], v[212:219], v20
    v_cvt_pk_bf16_f32 v156, v156, v157
    v_smfmac_f32_16x16x64_bf16 v[164:167], a[4:7], v[196:203], v12 abid:1
    v_cvt_pk_bf16_f32 v157, v158, v159
    v_smfmac_f32_16x16x64_bf16 v[164:167], a[40:43], v[204:211], v16 abid:1
    ds_write_b64 v53, v[156:157] offset:25728
    v_cvt_pk_bf16_f32 v132, v132, v133
    v_smfmac_f32_16x16x64_bf16 v[164:167], a[76:79], v[212:219], v20 abid:1
    v_cvt_pk_bf16_f32 v133, v134, v135
    v_smfmac_f32_16x16x64_bf16 v[168:171], a[8:11], v[196:203], v13
    v_cvt_pk_bf16_f32 v134, v136, v137
    v_smfmac_f32_16x16x64_bf16 v[168:171], a[44:47], v[204:211], v17
    v_cvt_pk_bf16_f32 v135, v138, v139
    v_smfmac_f32_16x16x64_bf16 v[168:171], a[80:83], v[212:219], v21
    s_waitcnt lgkmcnt(1)
    v_xad_u32 v236, v236, v3, v4
    v_smfmac_f32_16x16x64_bf16 v[184:187], v[240:243], v[244:251], v10 abid:1
    v_xad_u32 v237, v237, v3, v4
    v_smfmac_f32_16x16x64_bf16 v[148:151], v[240:243], v[244:251], v10
    ds_read2st64_b32 v[244:245], v236 offset0:0 offset1:72
    ds_read_b128 v[240:243], v8 offset:4096
    v_xad_u32 v238, v238, v3, v4
    v_smfmac_f32_16x16x64_bf16 v[172:175], a[12:15], v[196:203], v13 abid:1
    ds_read2st64_b32 v[246:247], v237 offset0:0 offset1:72
    v_xad_u32 v239, v239, v3, v4
    v_smfmac_f32_16x16x64_bf16 v[172:175], a[48:51], v[204:211], v17 abid:1
    ds_read2st64_b32 v[248:249], v238 offset0:0 offset1:72
    v_cndmask_b32_dpp v128, v124, v132, vcc row_ror:8 row_mask:0xf bank_mask:0xf
    v_smfmac_f32_16x16x64_bf16 v[172:175], a[84:87], v[212:219], v21 abid:1
    ds_read2st64_b32 v[250:251], v239 offset0:0 offset1:72
    ds_read_b128 v[196:199], v1 offset:23552
    v_cndmask_b32_dpp v129, v125, v133, vcc row_ror:8 row_mask:0xf bank_mask:0xf
    v_smfmac_f32_16x16x64_bf16 v[192:195], a[140:143], v[220:227], v49 abid:1
    ds_read_b128 v[200:203], v2 offset:23552
    v_cndmask_b32_dpp v130, v126, v134, vcc row_ror:8 row_mask:0xf bank_mask:0xf
    v_smfmac_f32_16x16x64_bf16 v[192:195], a[176:179], v[228:235], v50
    ds_read_b128 v[204:207], v1 offset:24576
    v_cndmask_b32_dpp v131, v127, v135, vcc row_ror:8 row_mask:0xf bank_mask:0xf
    v_smfmac_f32_16x16x64_bf16 v[160:163], a[108:111], v[220:227], v24
    ds_read_b128 v[208:211], v2 offset:24576
    buffer_store_dwordx4 v[128:131], v6, s[12:15], s59 offen offset:0 sc1
    v_mov_b32_dpp v124, v132 row_ror:8 row_mask:0xf bank_mask:0xc
    v_smfmac_f32_16x16x64_bf16 v[160:163], a[144:147], v[228:235], v28
    s_waitcnt lgkmcnt(9)
    s_barrier
    ds_read_b128 v[236:239], v8 offset:10816
    v_mov_b32_dpp v125, v133 row_ror:8 row_mask:0xf bank_mask:0xc
    v_smfmac_f32_16x16x64_bf16 v[164:167], a[112:115], v[220:227], v24 abid:1
    ds_read_b128 v[212:215], v1 offset:20480
    v_mov_b32_dpp v126, v134 row_ror:8 row_mask:0xf bank_mask:0xc
    v_smfmac_f32_16x16x64_bf16 v[164:167], a[148:151], v[228:235], v28 abid:1
    ds_read_b128 v[216:219], v2 offset:20480
    v_mov_b32_dpp v127, v135 row_ror:8 row_mask:0xf bank_mask:0xc
    v_smfmac_f32_16x16x64_bf16 v[168:171], a[116:119], v[220:227], v25
    buffer_store_dwordx4 v[124:127], v6, s[12:15], s24 offen offset:0 sc1
    v_smfmac_f32_16x16x64_bf16 v[168:171], a[152:155], v[228:235], v29
    s_waitcnt lgkmcnt(7)
    v_smfmac_f32_16x16x64_bf16 v[176:179], v[240:243], v[244:251], v10 abid:1
    v_smfmac_f32_16x16x64_bf16 v[140:143], v[240:243], v[244:251], v10
    s_waitcnt lgkmcnt(2)
    buffer_store_dwordx4 v[236:239], v7, s[12:15], s66 offen sc1
    v_smfmac_f32_16x16x64_bf16 v[172:175], a[120:123], v[220:227], v25 abid:1
    v_smfmac_f32_16x16x64_bf16 v[172:175], a[156:159], v[228:235], v29 abid:1
    ds_read_b128 v[220:223], v1 offset:25600
    v_smfmac_f32_16x16x64_bf16 v[192:195], a[212:215], v[196:203], v50 abid:1
    ds_read_b128 v[224:227], v2 offset:25600
    s_nop 0
    v_cvt_pk_bf16_f32 v140, v140, v141
    v_smfmac_f32_16x16x64_bf16 v[192:195], a[248:251], v[204:211], v51
    ds_read_b128 v[228:231], v1 offset:26624
    v_cvt_pk_bf16_f32 v141, v142, v143
    v_smfmac_f32_16x16x64_bf16 v[160:163], a[180:183], v[196:203], v32
    ds_read_b128 v[232:235], v2 offset:26624
    v_cvt_pk_bf16_f32 v142, v144, v145
    v_smfmac_f32_16x16x64_bf16 v[160:163], a[216:219], v[204:211], v36
    v_cvt_pk_bf16_f32 v143, v146, v147
    v_smfmac_f32_16x16x64_bf16 v[164:167], a[184:187], v[196:203], v32 abid:1
    v_cvt_pk_bf16_f32 v148, v148, v149
    v_smfmac_f32_16x16x64_bf16 v[164:167], a[220:223], v[204:211], v36 abid:1
    v_cvt_pk_bf16_f32 v149, v150, v151
    v_smfmac_f32_16x16x64_bf16 v[168:171], a[188:191], v[196:203], v33
    v_cvt_pk_bf16_f32 v150, v152, v153
    v_smfmac_f32_16x16x64_bf16 v[168:171], a[224:227], v[204:211], v37
    v_cvt_pk_bf16_f32 v151, v154, v155
    v_smfmac_f32_16x16x64_bf16 v[172:175], a[192:195], v[196:203], v33 abid:1
    v_cndmask_b32_dpp v144, v140, v148, vcc row_ror:8 row_mask:0xf bank_mask:0xf
    v_smfmac_f32_16x16x64_bf16 v[172:175], a[228:231], v[204:211], v37 abid:1
    ds_read_b128 v[196:199], v1 offset:18432
    s_waitcnt lgkmcnt(3)
    v_cndmask_b32_dpp v145, v141, v149, vcc row_ror:8 row_mask:0xf bank_mask:0xf
    v_smfmac_f32_16x16x64_bf16 v[192:195], v[84:87], v[220:227], v51 abid:1
    ds_read_b128 v[200:203], v2 offset:18432
    s_waitcnt lgkmcnt(2)
    v_cndmask_b32_dpp v146, v142, v150, vcc row_ror:8 row_mask:0xf bank_mask:0xf
    v_smfmac_f32_16x16x64_bf16 v[192:195], v[120:123], v[228:235], v52
    ds_read_b128 v[204:207], v1 offset:19456
    v_cndmask_b32_dpp v147, v143, v151, vcc row_ror:8 row_mask:0xf bank_mask:0xf
    v_smfmac_f32_16x16x64_bf16 v[160:163], a[252:255], v[220:227], v40
    ds_read_b128 v[208:211], v2 offset:19456
    buffer_store_dwordx4 v[144:147], v6, s[12:15], s59 offen offset:128 sc1
    v_mov_b32_dpp v140, v148 row_ror:8 row_mask:0xf bank_mask:0xc
    v_smfmac_f32_16x16x64_bf16 v[160:163], v[88:91], v[228:235], v44
    v_mov_b32_dpp v141, v149 row_ror:8 row_mask:0xf bank_mask:0xc
    v_smfmac_f32_16x16x64_bf16 v[164:167], v[56:59], v[220:227], v40 abid:1
    v_mov_b32_dpp v142, v150 row_ror:8 row_mask:0xf bank_mask:0xc
    v_smfmac_f32_16x16x64_bf16 v[164:167], v[92:95], v[228:235], v44 abid:1
    v_mov_b32_dpp v143, v151 row_ror:8 row_mask:0xf bank_mask:0xc
    v_smfmac_f32_16x16x64_bf16 v[168:171], v[60:63], v[220:227], v41
    buffer_store_dwordx4 v[140:143], v6, s[12:15], s24 offen offset:128 sc1
    v_cvt_pk_bf16_f32 v192, v192, v193
    v_smfmac_f32_16x16x64_bf16 v[168:171], v[96:99], v[228:235], v45
    v_cvt_pk_bf16_f32 v193, v194, v195
    v_smfmac_f32_16x16x64_bf16 v[172:175], v[64:67], v[220:227], v41 abid:1
    ds_write_b64 v53, v[192:193] offset:1024
    v_smfmac_f32_16x16x64_bf16 v[172:175], v[100:103], v[228:235], v45 abid:1
    ds_read_b128 v[220:223], v1 offset:21504
    s_waitcnt lgkmcnt(4)
    v_smfmac_f32_16x16x64_bf16 v[176:179], a[16:19], v[196:203], v14
    ds_read_b128 v[224:227], v2 offset:21504
    s_waitcnt lgkmcnt(3)
    v_smfmac_f32_16x16x64_bf16 v[176:179], a[52:55], v[204:211], v18
    ds_read_b128 v[228:231], v1 offset:22528
    v_smfmac_f32_16x16x64_bf16 v[176:179], a[88:91], v[212:219], v22
    ds_read_b128 v[232:235], v2 offset:22528
    s_waitcnt lgkmcnt(4)
    s_barrier
    ds_read_b128 v[236:239], v8 offset:11840
    v_smfmac_f32_16x16x64_bf16 v[180:183], a[20:23], v[196:203], v14 abid:1
    v_cvt_pk_bf16_f32 v160, v160, v161
    v_smfmac_f32_16x16x64_bf16 v[180:183], a[56:59], v[204:211], v18 abid:1
    v_cvt_pk_bf16_f32 v161, v162, v163
    v_smfmac_f32_16x16x64_bf16 v[180:183], a[92:95], v[212:219], v22 abid:1
    v_cvt_pk_bf16_f32 v162, v164, v165
    v_smfmac_f32_16x16x64_bf16 v[184:187], a[24:27], v[196:203], v15
    v_cvt_pk_bf16_f32 v163, v166, v167
    v_smfmac_f32_16x16x64_bf16 v[184:187], a[60:63], v[204:211], v19
    v_cvt_pk_bf16_f32 v168, v168, v169
    v_smfmac_f32_16x16x64_bf16 v[184:187], a[96:99], v[212:219], v23
    s_cmp_lt_u32 s20, 2
    s_waitcnt lgkmcnt(0)
    s_cbranch_scc0 M_fx
    buffer_store_dwordx4 v[236:239], v7, s[12:15], s67 offen sc1
M_fx:
    v_smfmac_f32_16x16x64_bf16 v[188:191], a[28:31], v[196:203], v15 abid:1
    v_cvt_pk_bf16_f32 v169, v170, v171
    v_smfmac_f32_16x16x64_bf16 v[188:191], a[64:67], v[204:211], v19 abid:1
    v_cvt_pk_bf16_f32 v170, v172, v173
    v_smfmac_f32_16x16x64_bf16 v[188:191], a[100:103], v[212:219], v23 abid:1
    ds_read_b128 v[196:199], v1 offset:23552
    v_cvt_pk_bf16_f32 v171, v174, v175
    v_smfmac_f32_16x16x64_bf16 v[176:179], a[124:127], v[220:227], v26
    ds_read_b128 v[200:203], v2 offset:23552
    v_cndmask_b32_dpp v164, v160, v168, vcc row_ror:8 row_mask:0xf bank_mask:0xf
    v_smfmac_f32_16x16x64_bf16 v[176:179], a[160:163], v[228:235], v30
    ds_read_b128 v[204:207], v1 offset:24576
    v_cndmask_b32_dpp v165, v161, v169, vcc row_ror:8 row_mask:0xf bank_mask:0xf
    v_smfmac_f32_16x16x64_bf16 v[180:183], a[128:131], v[220:227], v26 abid:1
    ds_read_b128 v[208:211], v2 offset:24576
    v_cndmask_b32_dpp v166, v162, v170, vcc row_ror:8 row_mask:0xf bank_mask:0xf
    v_smfmac_f32_16x16x64_bf16 v[180:183], a[164:167], v[228:235], v30 abid:1
    v_cndmask_b32_dpp v167, v163, v171, vcc row_ror:8 row_mask:0xf bank_mask:0xf
    v_smfmac_f32_16x16x64_bf16 v[184:187], a[132:135], v[220:227], v27
    buffer_store_dwordx4 v[164:167], v6, s[12:15], s58 offen offset:0 sc1
    v_mov_b32_dpp v160, v168 row_ror:8 row_mask:0xf bank_mask:0xc
    v_smfmac_f32_16x16x64_bf16 v[184:187], a[168:171], v[228:235], v31
    v_mov_b32_dpp v161, v169 row_ror:8 row_mask:0xf bank_mask:0xc
    v_smfmac_f32_16x16x64_bf16 v[188:191], a[136:139], v[220:227], v27 abid:1
    v_mov_b32_dpp v162, v170 row_ror:8 row_mask:0xf bank_mask:0xc
    v_smfmac_f32_16x16x64_bf16 v[188:191], a[172:175], v[228:235], v31 abid:1
    ds_read_b128 v[220:223], v1 offset:25600
    s_waitcnt lgkmcnt(3)
    v_mov_b32_dpp v163, v171 row_ror:8 row_mask:0xf bank_mask:0xc
    v_smfmac_f32_16x16x64_bf16 v[176:179], a[196:199], v[196:203], v34
    ds_read_b128 v[224:227], v2 offset:25600
    buffer_store_dwordx4 v[160:163], v6, s[12:15], s23 offen offset:0 sc1
    s_waitcnt lgkmcnt(2)
    v_smfmac_f32_16x16x64_bf16 v[176:179], a[232:235], v[204:211], v38
    ds_read_b128 v[228:231], v1 offset:26624
    v_smfmac_f32_16x16x64_bf16 v[180:183], a[200:203], v[196:203], v34 abid:1
    ds_read_b128 v[232:235], v2 offset:26624
    v_smfmac_f32_16x16x64_bf16 v[180:183], a[236:239], v[204:211], v38 abid:1
    v_smfmac_f32_16x16x64_bf16 v[184:187], a[204:207], v[196:203], v35
    v_smfmac_f32_16x16x64_bf16 v[184:187], a[240:243], v[204:211], v39
    v_smfmac_f32_16x16x64_bf16 v[188:191], a[208:211], v[196:203], v35 abid:1
    v_smfmac_f32_16x16x64_bf16 v[188:191], a[244:247], v[204:211], v39 abid:1
    s_waitcnt lgkmcnt(2)
    v_smfmac_f32_16x16x64_bf16 v[176:179], v[68:71], v[220:227], v42
    s_waitcnt lgkmcnt(0)
    v_smfmac_f32_16x16x64_bf16 v[176:179], v[104:107], v[228:235], v46
    v_smfmac_f32_16x16x64_bf16 v[180:183], v[72:75], v[220:227], v42 abid:1
    v_smfmac_f32_16x16x64_bf16 v[180:183], v[108:111], v[228:235], v46 abid:1
    v_smfmac_f32_16x16x64_bf16 v[184:187], v[76:79], v[220:227], v43
    v_smfmac_f32_16x16x64_bf16 v[184:187], v[112:115], v[228:235], v47
    v_smfmac_f32_16x16x64_bf16 v[188:191], v[80:83], v[220:227], v43 abid:1
    v_smfmac_f32_16x16x64_bf16 v[188:191], v[116:119], v[228:235], v47 abid:1
    s_nop 1
    v_cvt_pk_bf16_f32 v176, v176, v177
    v_cvt_pk_bf16_f32 v177, v178, v179
    v_cvt_pk_bf16_f32 v178, v180, v181
    v_cvt_pk_bf16_f32 v179, v182, v183
    v_cvt_pk_bf16_f32 v184, v184, v185
    v_cvt_pk_bf16_f32 v185, v186, v187
    v_cvt_pk_bf16_f32 v186, v188, v189
    v_cvt_pk_bf16_f32 v187, v190, v191
    v_cndmask_b32_dpp v180, v176, v184, vcc row_ror:8 row_mask:0xf bank_mask:0xf
    v_cndmask_b32_dpp v181, v177, v185, vcc row_ror:8 row_mask:0xf bank_mask:0xf
    v_cndmask_b32_dpp v182, v178, v186, vcc row_ror:8 row_mask:0xf bank_mask:0xf
    v_cndmask_b32_dpp v183, v179, v187, vcc row_ror:8 row_mask:0xf bank_mask:0xf
    buffer_store_dwordx4 v[180:183], v6, s[12:15], s58 offen offset:128 sc1
    v_mov_b32_dpp v176, v184 row_ror:8 row_mask:0xf bank_mask:0xc
    v_mov_b32_dpp v177, v185 row_ror:8 row_mask:0xf bank_mask:0xc
    v_mov_b32_dpp v178, v186 row_ror:8 row_mask:0xf bank_mask:0xc
    v_mov_b32_dpp v179, v187 row_ror:8 row_mask:0xf bank_mask:0xc
    buffer_store_dwordx4 v[176:179], v6, s[12:15], s23 offen offset:128 sc1
M_done:
M_end:
    s_endpgm
M_pf_spin:
    s_sleep 4
    v_mov_b32 v0, 0
    s_mov_b64 exec, 1
    buffer_atomic_add v0, off, s[16:19], s96 sc0 sc1
    s_mov_b64 exec, -1
    s_add_u32 s31, s31, 1
    s_waitcnt vmcnt(0)
    v_readfirstlane_b32 s30, v0
    s_nop 0
    s_sub_u32 s30, s30, s100
    s_cmp_eq_u32 s30, 27
    s_cbranch_scc1 M_pf_ok
    s_cmp_lt_u32 s31, 6
    s_cbranch_scc1 M_pf_spin
    s_cmp_eq_u32 s98, 0
    s_cbranch_scc1 M_pf_spin2
    s_mov_b32 s98, 0
    v_mov_b32 v250, 1
    s_mov_b64 exec, 1
    buffer_atomic_add v250, off, s[68:71], 0 offset:0 sc1
    s_mov_b64 exec, -1
    s_nop 3
M_pf_spin2:
    buffer_load_dword v0, off, s[68:71], 0 offset:0 sc1
    s_cmp_ge_u32 s31, 131072
    s_cbranch_scc1 M_end
    s_waitcnt vmcnt(0)
    v_readfirstlane_b32 s30, v0
    s_nop 0
    s_cmp_eq_u32 s30, 81
    s_cbranch_scc0 M_pf_spin
    s_branch M_pf_ok
M_r3:
    v_bfe_u32 v110, v96, 24, 4
    v_lshlrev_b32 v111, 1, v96
    v_lshl_add_u32 v110, v110, 2, s49
    v_and_b32 v111, 16, v111
    v_and_or_b32 v110, v96, 2.0, v110
    v_lshlrev_b32 v111, v111, 1
    ds_add_rtn_u32 v100, v110, v111
    v_and_b32 v110, 8, v96
    v_lshrrev_b32 v113, 14, v96
    v_cmp_ne_u32 s[44:45], 0, v110
    v_and_b32 v116, 0x3cf0, v113
    s_waitcnt lgkmcnt(0)
    v_lshrrev_b32 v111, 16, v100
    v_and_b32 v112, 0xffff, v100
    v_sub_u32 v110, 15, v111
    v_and_b32 v100, 2.0, v96
    v_add3_u32 v100, v112, v111, v100
    v_cndmask_b32 v110, v112, v110, s[44:45]
    v_cmp_gt_u32 s[44:45], 16, v100
    v_cmp_gt_u32 s[36:37], 2.0, v100
    v_lshlrev_b32 v110, 2, v110
    v_lshrrev_b64 v[112:113], v110, s[50:51]
    s_andn2_b64 s[36:37], s[36:37], s[44:45]
    v_lshrrev_b64 v[114:115], v110, s[52:53]
    v_bfe_u32 v110, v96, 24, 4
    v_mbcnt_lo_u32_b32 v111, s36, 0
    v_and_b32 v112, 15, v112
    v_mbcnt_hi_u32_b32 v111, s37, v111
    v_and_b32 v114, 15, v114
    v_lshl_add_u32 v111, v111, 3, s40
    v_lshl_add_u32 v112, v110, 4, v112
    v_min_u32 v111, s41, v111
    v_mul_u32_u24 v114, 68, v114
    v_cndmask_b32 v111, v118, v111, s[36:37]
    ds_write_b64 v111, v[96:97]
    s_bcnt1_i32_b64 s30, s[36:37]
    s_lshl3_add_u32 s40, s30, s40
    v_lshl_add_u32 v112, v112, 2, s47
    v_and_b32 v114, 0x30c, v114
    v_cndmask_b32 v112, v118, v112, s[44:45]
    v_add3_u32 v113, v116, v114, s29
    v_and_b32 v114, 0x3fff, v96
    v_cndmask_b32 v110, v118, v113, s[44:45]
    ds_write_b32 v112, v114
    ds_write_b32 v110, v97
    s_cmp_gt_u32 s38, s39
    s_cselect_b32 s32, 1, s32
    s_branch M_r3r
M_dn:
    s_mov_b32 s27, 0
    s_mov_b32 s46, 0x80000000
    v_mov_b32 v244, 0
    v_mov_b32 v245, 0
    v_mov_b32 v246, 0
    v_mov_b32 v247, 0
    ds_write_b128 v8, v[244:247] offset:0
    ds_write_b128 v8, v[244:247] offset:1024
    ds_write_b128 v8, v[244:247] offset:2048
    ds_write_b128 v8, v[244:247] offset:3072
    ds_write_b128 v8, v[244:247] offset:4096
    ds_write_b128 v8, v[244:247] offset:5120
    ds_write_b128 v8, v[244:247] offset:6144
    ds_write_b128 v8, v[244:247] offset:7168
    ds_write_b128 v8, v[244:247] offset:8192
    s_waitcnt lgkmcnt(0)
    s_branch M_dnr
M_ovc0:
    v_smfmac_f32_16x16x32_bf16 v[124:127], v[54:55], v[212:215], v10
    v_smfmac_f32_16x16x32_bf16 v[160:163], v[54:55], v[212:215], v10 abid:2
    s_setpc_b64 s[74:75]
    v_smfmac_f32_16x16x32_bf16 v[128:131], v[54:55], v[212:215], v10
    v_smfmac_f32_16x16x32_bf16 v[164:167], v[54:55], v[212:215], v10 abid:2
    s_setpc_b64 s[74:75]
    v_smfmac_f32_16x16x32_bf16 v[132:135], v[54:55], v[212:215], v10
    v_smfmac_f32_16x16x32_bf16 v[168:171], v[54:55], v[212:215], v10 abid:2
    s_setpc_b64 s[74:75]
    v_smfmac_f32_16x16x32_bf16 v[136:139], v[54:55], v[212:215], v10
    v_smfmac_f32_16x16x32_bf16 v[172:175], v[54:55], v[212:215], v10 abid:2
    s_setpc_b64 s[74:75]
    v_smfmac_f32_16x16x32_bf16 v[140:143], v[54:55], v[212:215], v10
    v_smfmac_f32_16x16x32_bf16 v[176:179], v[54:55], v[212:215], v10 abid:2
    s_setpc_b64 s[74:75]
    v_smfmac_f32_16x16x32_bf16 v[144:147], v[54:55], v[212:215], v10
    v_smfmac_f32_16x16x32_bf16 v[180:183], v[54:55], v[212:215], v10 abid:2
    s_setpc_b64 s[74:75]
    v_smfmac_f32_16x16x32_bf16 v[148:151], v[54:55], v[212:215], v10
    v_smfmac_f32_16x16x32_bf16 v[184:187], v[54:55], v[212:215], v10 abid:2
    s_setpc_b64 s[74:75]
    v_smfmac_f32_16x16x32_bf16 v[152:155], v[54:55], v[212:215], v10
    v_smfmac_f32_16x16x32_bf16 v[188:191], v[54:55], v[212:215], v10 abid:2
    s_setpc_b64 s[74:75]
    v_smfmac_f32_16x16x32_bf16 v[156:159], v[54:55], v[212:215], v10
    v_smfmac_f32_16x16x32_bf16 v[192:195], v[54:55], v[212:215], v10 abid:2
    s_setpc_b64 s[74:75]
M_ovl0:
    v_smfmac_f32_16x16x32_bf16 v[124:127], v[54:55], v[212:215], v10
    v_smfmac_f32_16x16x32_bf16 v[160:163], v[54:55], v[212:215], v10 abid:2
    s_setpc_b64 s[78:79]
    v_smfmac_f32_16x16x32_bf16 v[128:131], v[54:55], v[212:215], v10
    v_smfmac_f32_16x16x32_bf16 v[164:167], v[54:55], v[212:215], v10 abid:2
    s_setpc_b64 s[78:79]
    v_smfmac_f32_16x16x32_bf16 v[132:135], v[54:55], v[212:215], v10
    v_smfmac_f32_16x16x32_bf16 v[168:171], v[54:55], v[212:215], v10 abid:2
    s_setpc_b64 s[78:79]
    v_smfmac_f32_16x16x32_bf16 v[136:139], v[54:55], v[212:215], v10
    v_smfmac_f32_16x16x32_bf16 v[172:175], v[54:55], v[212:215], v10 abid:2
    s_setpc_b64 s[78:79]
    v_smfmac_f32_16x16x32_bf16 v[140:143], v[54:55], v[212:215], v10
    v_smfmac_f32_16x16x32_bf16 v[176:179], v[54:55], v[212:215], v10 abid:2
    s_setpc_b64 s[78:79]
    v_smfmac_f32_16x16x32_bf16 v[144:147], v[54:55], v[212:215], v10
    v_smfmac_f32_16x16x32_bf16 v[180:183], v[54:55], v[212:215], v10 abid:2
    s_setpc_b64 s[78:79]
    v_smfmac_f32_16x16x32_bf16 v[148:151], v[54:55], v[212:215], v10
    v_smfmac_f32_16x16x32_bf16 v[184:187], v[54:55], v[212:215], v10 abid:2
    s_setpc_b64 s[78:79]
    v_smfmac_f32_16x16x32_bf16 v[152:155], v[54:55], v[212:215], v10
    v_smfmac_f32_16x16x32_bf16 v[188:191], v[54:55], v[212:215], v10 abid:2
    s_setpc_b64 s[78:79]
    v_smfmac_f32_16x16x32_bf16 v[156:159], v[54:55], v[212:215], v10
    v_smfmac_f32_16x16x32_bf16 v[192:195], v[54:55], v[212:215], v10 abid:2
    s_setpc_b64 s[78:79]
M_ovc1:
    v_smfmac_f32_16x16x32_bf16 v[124:127], v[252:253], v[212:215], v10
    v_smfmac_f32_16x16x32_bf16 v[160:163], v[252:253], v[212:215], v10 abid:2
    s_setpc_b64 s[76:77]
    v_smfmac_f32_16x16x32_bf16 v[128:131], v[252:253], v[212:215], v10
    v_smfmac_f32_16x16x32_bf16 v[164:167], v[252:253], v[212:215], v10 abid:2
    s_setpc_b64 s[76:77]
    v_smfmac_f32_16x16x32_bf16 v[132:135], v[252:253], v[212:215], v10
    v_smfmac_f32_16x16x32_bf16 v[168:171], v[252:253], v[212:215], v10 abid:2
    s_setpc_b64 s[76:77]
    v_smfmac_f32_16x16x32_bf16 v[136:139], v[252:253], v[212:215], v10
    v_smfmac_f32_16x16x32_bf16 v[172:175], v[252:253], v[212:215], v10 abid:2
    s_setpc_b64 s[76:77]
    v_smfmac_f32_16x16x32_bf16 v[140:143], v[252:253], v[212:215], v10
    v_smfmac_f32_16x16x32_bf16 v[176:179], v[252:253], v[212:215], v10 abid:2
    s_setpc_b64 s[76:77]
    v_smfmac_f32_16x16x32_bf16 v[144:147], v[252:253], v[212:215], v10
    v_smfmac_f32_16x16x32_bf16 v[180:183], v[252:253], v[212:215], v10 abid:2
    s_setpc_b64 s[76:77]
    v_smfmac_f32_16x16x32_bf16 v[148:151], v[252:253], v[212:215], v10
    v_smfmac_f32_16x16x32_bf16 v[184:187], v[252:253], v[212:215], v10 abid:2
    s_setpc_b64 s[76:77]
    v_smfmac_f32_16x16x32_bf16 v[152:155], v[252:253], v[212:215], v10
    v_smfmac_f32_16x16x32_bf16 v[188:191], v[252:253], v[212:215], v10 abid:2
    s_setpc_b64 s[76:77]
    v_smfmac_f32_16x16x32_bf16 v[156:159], v[252:253], v[212:215], v10
    v_smfmac_f32_16x16x32_bf16 v[192:195], v[252:253], v[212:215], v10 abid:2
    s_setpc_b64 s[76:77]
M_ovl1:
    v_smfmac_f32_16x16x32_bf16 v[124:127], v[252:253], v[212:215], v10
    v_smfmac_f32_16x16x32_bf16 v[160:163], v[252:253], v[212:215], v10 abid:2
    s_setpc_b64 s[78:79]
    v_smfmac_f32_16x16x32_bf16 v[128:131], v[252:253], v[212:215], v10
    v_smfmac_f32_16x16x32_bf16 v[164:167], v[252:253], v[212:215], v10 abid:2
    s_setpc_b64 s[78:79]
    v_smfmac_f32_16x16x32_bf16 v[132:135], v[252:253], v[212:215], v10
    v_smfmac_f32_16x16x32_bf16 v[168:171], v[252:253], v[212:215], v10 abid:2
    s_setpc_b64 s[78:79]
    v_smfmac_f32_16x16x32_bf16 v[136:139], v[252:253], v[212:215], v10
    v_smfmac_f32_16x16x32_bf16 v[172:175], v[252:253], v[212:215], v10 abid:2
    s_setpc_b64 s[78:79]
    v_smfmac_f32_16x16x32_bf16 v[140:143], v[252:253], v[212:215], v10
    v_smfmac_f32_16x16x32_bf16 v[176:179], v[252:253], v[212:215], v10 abid:2
    s_setpc_b64 s[78:79]
    v_smfmac_f32_16x16x32_bf16 v[144:147], v[252:253], v[212:215], v10
    v_smfmac_f32_16x16x32_bf16 v[180:183], v[252:253], v[212:215], v10 abid:2
    s_setpc_b64 s[78:79]
    v_smfmac_f32_16x16x32_bf16 v[148:151], v[252:253], v[212:215], v10
    v_smfmac_f32_16x16x32_bf16 v[184:187], v[252:253], v[212:215], v10 abid:2
    s_setpc_b64 s[78:79]
    v_smfmac_f32_16x16x32_bf16 v[152:155], v[252:253], v[212:215], v10
    v_smfmac_f32_16x16x32_bf16 v[188:191], v[252:253], v[212:215], v10 abid:2
    s_setpc_b64 s[78:79]
    v_smfmac_f32_16x16x32_bf16 v[156:159], v[252:253], v[212:215], v10
    v_smfmac_f32_16x16x32_bf16 v[192:195], v[252:253], v[212:215], v10 abid:2
    s_setpc_b64 s[78:79]
M_ovl2:
    v_smfmac_f32_16x16x32_bf16 v[124:127], v[254:255], v[212:215], v10
    v_smfmac_f32_16x16x32_bf16 v[160:163], v[254:255], v[212:215], v10 abid:2
    s_setpc_b64 s[78:79]
    v_smfmac_f32_16x16x32_bf16 v[128:131], v[254:255], v[212:215], v10
    v_smfmac_f32_16x16x32_bf16 v[164:167], v[254:255], v[212:215], v10 abid:2
    s_setpc_b64 s[78:79]
    v_smfmac_f32_16x16x32_bf16 v[132:135], v[254:255], v[212:215], v10
    v_smfmac_f32_16x16x32_bf16 v[168:171], v[254:255], v[212:215], v10 abid:2
    s_setpc_b64 s[78:79]
    v_smfmac_f32_16x16x32_bf16 v[136:139], v[254:255], v[212:215], v10
    v_smfmac_f32_16x16x32_bf16 v[172:175], v[254:255], v[212:215], v10 abid:2
    s_setpc_b64 s[78:79]
    v_smfmac_f32_16x16x32_bf16 v[140:143], v[254:255], v[212:215], v10
    v_smfmac_f32_16x16x32_bf16 v[176:179], v[254:255], v[212:215], v10 abid:2
    s_setpc_b64 s[78:79]
    v_smfmac_f32_16x16x32_bf16 v[144:147], v[254:255], v[212:215], v10
    v_smfmac_f32_16x16x32_bf16 v[180:183], v[254:255], v[212:215], v10 abid:2
    s_setpc_b64 s[78:79]
    v_smfmac_f32_16x16x32_bf16 v[148:151], v[254:255], v[212:215], v10
    v_smfmac_f32_16x16x32_bf16 v[184:187], v[254:255], v[212:215], v10 abid:2
    s_setpc_b64 s[78:79]
    v_smfmac_f32_16x16x32_bf16 v[152:155], v[254:255], v[212:215], v10
    v_smfmac_f32_16x16x32_bf16 v[188:191], v[254:255], v[212:215], v10 abid:2
    s_setpc_b64 s[78:79]
    v_smfmac_f32_16x16x32_bf16 v[156:159], v[254:255], v[212:215], v10
    v_smfmac_f32_16x16x32_bf16 v[192:195], v[254:255], v[212:215], v10 abid:2
    s_setpc_b64 s[78:79]
M_ovn:
    s_setpc_b64 s[78:79]
M_slow:
    s_bitcmp1_b32 s46, 31
    s_cbranch_scc1 M_dense
    s_mov_b32 s56, s80
M_sl:
    s_lshl_b32 s57, s56, 6
    v_add_u32 v240, s57, v9
    ds_read_b128 v[248:251], v240 offset:9792
    s_waitcnt lgkmcnt(0)
    v_and_b32 v240, 0x3fff, v248
    v_and_b32 v241, 0x3fff, v250
    v_xad_u32 v240, v240, v3, v4
    v_xad_u32 v241, v241, v3, v4
    ds_read2st64_b32 v[244:245], v240 offset0:0 offset1:72
    ds_read2st64_b32 v[246:247], v241 offset0:0 offset1:72
    v_subrev_u32 v240, s29, v8
    v_bfe_u32 v240, v240, 4, 4
    s_waitcnt lgkmcnt(0)
    s_bitcmp1_b32 s27, 0
    s_cbranch_scc0 M_sle0
    v_lshrrev_b32 v242, 18, v248
    v_lshrrev_b32 v243, 18, v250
    v_or_b32 v241, 0, v240
    v_cmp_eq_u32 s[44:45], v242, v241
    v_cmp_eq_u32 s[54:55], v243, v241
    s_nop 0
    v_cndmask_b32 v242, 0, v249, s[44:45]
    v_cndmask_b32 v243, 0, v251, s[54:55]
    s_nop 1
    v_smfmac_f32_16x16x32_bf16 v[124:127], v[242:243], v[244:247], v10
    v_smfmac_f32_16x16x32_bf16 v[160:163], v[242:243], v[244:247], v10 abid:2
M_sle0:
    s_bitcmp1_b32 s27, 1
    s_cbranch_scc0 M_sle1
    v_lshrrev_b32 v242, 18, v248
    v_lshrrev_b32 v243, 18, v250
    v_or_b32 v241, 64, v240
    v_cmp_eq_u32 s[44:45], v242, v241
    v_cmp_eq_u32 s[54:55], v243, v241
    s_nop 0
    v_cndmask_b32 v242, 0, v249, s[44:45]
    v_cndmask_b32 v243, 0, v251, s[54:55]
    s_nop 1
    v_smfmac_f32_16x16x32_bf16 v[128:131], v[242:243], v[244:247], v10
    v_smfmac_f32_16x16x32_bf16 v[164:167], v[242:243], v[244:247], v10 abid:2
M_sle1:
    s_bitcmp1_b32 s27, 2
    s_cbranch_scc0 M_sle2
    v_lshrrev_b32 v242, 18, v248
    v_lshrrev_b32 v243, 18, v250
    v_or_b32 v241, 128, v240
    v_cmp_eq_u32 s[44:45], v242, v241
    v_cmp_eq_u32 s[54:55], v243, v241
    s_nop 0
    v_cndmask_b32 v242, 0, v249, s[44:45]
    v_cndmask_b32 v243, 0, v251, s[54:55]
    s_nop 1
    v_smfmac_f32_16x16x32_bf16 v[132:135], v[242:243], v[244:247], v10
    v_smfmac_f32_16x16x32_bf16 v[168:171], v[242:243], v[244:247], v10 abid:2
M_sle2:
    s_bitcmp1_b32 s27, 3
    s_cbranch_scc0 M_sle3
    v_lshrrev_b32 v242, 18, v248
    v_lshrrev_b32 v243, 18, v250
    v_or_b32 v241, 192, v240
    v_cmp_eq_u32 s[44:45], v242, v241
    v_cmp_eq_u32 s[54:55], v243, v241
    s_nop 0
    v_cndmask_b32 v242, 0, v249, s[44:45]
    v_cndmask_b32 v243, 0, v251, s[54:55]
    s_nop 1
    v_smfmac_f32_16x16x32_bf16 v[136:139], v[242:243], v[244:247], v10
    v_smfmac_f32_16x16x32_bf16 v[172:175], v[242:243], v[244:247], v10 abid:2
M_sle3:
    s_bitcmp1_b32 s27, 4
    s_cbranch_scc0 M_sle4
    v_lshrrev_b32 v242, 18, v248
    v_lshrrev_b32 v243, 18, v250
    v_or_b32 v241, 256, v240
    v_cmp_eq_u32 s[44:45], v242, v241
    v_cmp_eq_u32 s[54:55], v243, v241
    s_nop 0
    v_cndmask_b32 v242, 0, v249, s[44:45]
    v_cndmask_b32 v243, 0, v251, s[54:55]
    s_nop 1
    v_smfmac_f32_16x16x32_bf16 v[140:143], v[242:243], v[244:247], v10
    v_smfmac_f32_16x16x32_bf16 v[176:179], v[242:243], v[244:247], v10 abid:2
M_sle4:
    s_bitcmp1_b32 s27, 5
    s_cbranch_scc0 M_sle5
    v_lshrrev_b32 v242, 18, v248
    v_lshrrev_b32 v243, 18, v250
    v_or_b32 v241, 320, v240
    v_cmp_eq_u32 s[44:45], v242, v241
    v_cmp_eq_u32 s[54:55], v243, v241
    s_nop 0
    v_cndmask_b32 v242, 0, v249, s[44:45]
    v_cndmask_b32 v243, 0, v251, s[54:55]
    s_nop 1
    v_smfmac_f32_16x16x32_bf16 v[144:147], v[242:243], v[244:247], v10
    v_smfmac_f32_16x16x32_bf16 v[180:183], v[242:243], v[244:247], v10 abid:2
M_sle5:
    s_bitcmp1_b32 s27, 6
    s_cbranch_scc0 M_sle6
    v_lshrrev_b32 v242, 18, v248
    v_lshrrev_b32 v243, 18, v250
    v_or_b32 v241, 384, v240
    v_cmp_eq_u32 s[44:45], v242, v241
    v_cmp_eq_u32 s[54:55], v243, v241
    s_nop 0
    v_cndmask_b32 v242, 0, v249, s[44:45]
    v_cndmask_b32 v243, 0, v251, s[54:55]
    s_nop 1
    v_smfmac_f32_16x16x32_bf16 v[148:151], v[242:243], v[244:247], v10
    v_smfmac_f32_16x16x32_bf16 v[184:187], v[242:243], v[244:247], v10 abid:2
M_sle6:
    s_bitcmp1_b32 s27, 7
    s_cbranch_scc0 M_sle7
    v_lshrrev_b32 v242, 18, v248
    v_lshrrev_b32 v243, 18, v250
    v_or_b32 v241, 448, v240
    v_cmp_eq_u32 s[44:45], v242, v241
    v_cmp_eq_u32 s[54:55], v243, v241
    s_nop 0
    v_cndmask_b32 v242, 0, v249, s[44:45]
    v_cndmask_b32 v243, 0, v251, s[54:55]
    s_nop 1
    v_smfmac_f32_16x16x32_bf16 v[152:155], v[242:243], v[244:247], v10
    v_smfmac_f32_16x16x32_bf16 v[188:191], v[242:243], v[244:247], v10 abid:2
M_sle7:
    s_bitcmp1_b32 s27, 8
    s_cbranch_scc0 M_sle8
    v_lshrrev_b32 v242, 18, v248
    v_lshrrev_b32 v243, 18, v250
    v_or_b32 v241, 512, v240
    v_cmp_eq_u32 s[44:45], v242, v241
    v_cmp_eq_u32 s[54:55], v243, v241
    s_nop 0
    v_cndmask_b32 v242, 0, v249, s[44:45]
    v_cndmask_b32 v243, 0, v251, s[54:55]
    s_nop 1
    v_smfmac_f32_16x16x32_bf16 v[156:159], v[242:243], v[244:247], v10
    v_smfmac_f32_16x16x32_bf16 v[192:195], v[242:243], v[244:247], v10 abid:2
M_sle8:
    s_add_u32 s56, s56, 1
    s_cmp_lt_u32 s56, s46
    s_cbranch_scc1 M_sl
M_slx:
    s_nop 7
    s_cmp_eq_u32 s21, 1
    s_cbranch_scc1 M_slowrL
    s_cmp_eq_u32 s21, 2
    s_cbranch_scc1 M_slowrE0
    s_cmp_eq_u32 s21, 3
    s_cbranch_scc1 M_slowrQ
    s_cmp_eq_u32 s21, 4
    s_cbranch_scc1 M_slowrF
    s_cmp_eq_u32 s21, 5
    s_cbranch_scc1 M_slowrH
    s_branch M_slowr0
M_dense:
    s_mul_i32 s57, s20, 82944
    s_add_u32 s57, s57, 393216
    s_mov_b32 s56, 0
    v_mov_b32 v54, v1
    v_mov_b32 v55, v2
    v_subrev_u32 v252, s29, v8
M_dn0:
    ds_read_b128 v[244:247], v54 offset:0
    ds_read_b128 v[248:251], v55 offset:0
    v_add_u32 v54, 1024, v54
    v_add_u32 v55, 1024, v55
    buffer_load_dwordx4 v[240:243], v252, s[16:19], s57 offen sc1
    s_add_u32 s57, s57, 1024
    s_waitcnt vmcnt(0) lgkmcnt(0)
    v_smfmac_f32_16x16x64_bf16 v[124:127], v[240:243], v[244:251], v10
    buffer_load_dwordx4 v[240:243], v252, s[16:19], s57 offen sc1
    s_add_u32 s57, s57, 1024
    s_waitcnt vmcnt(0) lgkmcnt(0)
    v_smfmac_f32_16x16x64_bf16 v[128:131], v[240:243], v[244:251], v10
    buffer_load_dwordx4 v[240:243], v252, s[16:19], s57 offen sc1
    s_add_u32 s57, s57, 1024
    s_waitcnt vmcnt(0) lgkmcnt(0)
    v_smfmac_f32_16x16x64_bf16 v[132:135], v[240:243], v[244:251], v10
    buffer_load_dwordx4 v[240:243], v252, s[16:19], s57 offen sc1
    s_add_u32 s57, s57, 1024
    s_waitcnt vmcnt(0) lgkmcnt(0)
    v_smfmac_f32_16x16x64_bf16 v[136:139], v[240:243], v[244:251], v10
    buffer_load_dwordx4 v[240:243], v252, s[16:19], s57 offen sc1
    s_add_u32 s57, s57, 1024
    s_waitcnt vmcnt(0) lgkmcnt(0)
    v_smfmac_f32_16x16x64_bf16 v[140:143], v[240:243], v[244:251], v10
    buffer_load_dwordx4 v[240:243], v252, s[16:19], s57 offen sc1
    s_add_u32 s57, s57, 1024
    s_waitcnt vmcnt(0) lgkmcnt(0)
    v_smfmac_f32_16x16x64_bf16 v[144:147], v[240:243], v[244:251], v10
    buffer_load_dwordx4 v[240:243], v252, s[16:19], s57 offen sc1
    s_add_u32 s57, s57, 1024
    s_waitcnt vmcnt(0) lgkmcnt(0)
    v_smfmac_f32_16x16x64_bf16 v[148:151], v[240:243], v[244:251], v10
    buffer_load_dwordx4 v[240:243], v252, s[16:19], s57 offen sc1
    s_add_u32 s57, s57, 1024
    s_waitcnt vmcnt(0) lgkmcnt(0)
    v_smfmac_f32_16x16x64_bf16 v[152:155], v[240:243], v[244:251], v10
    buffer_load_dwordx4 v[240:243], v252, s[16:19], s57 offen sc1
    s_add_u32 s57, s57, 1024
    s_waitcnt vmcnt(0) lgkmcnt(0)
    v_smfmac_f32_16x16x64_bf16 v[156:159], v[240:243], v[244:251], v10
    s_add_u32 s56, s56, 1
    s_cmp_lt_u32 s56, 9
    s_cbranch_scc1 M_dn0
    s_mul_i32 s57, s20, 82944
    s_add_u32 s57, s57, 393216
    s_mov_b32 s56, 0
    v_mov_b32 v54, v1
    v_mov_b32 v55, v2
    v_subrev_u32 v252, s29, v8
M_dn1:
    ds_read_b128 v[244:247], v54 offset:18432
    ds_read_b128 v[248:251], v55 offset:18432
    v_add_u32 v54, 1024, v54
    v_add_u32 v55, 1024, v55
    buffer_load_dwordx4 v[240:243], v252, s[16:19], s57 offen sc1
    s_add_u32 s57, s57, 1024
    s_waitcnt vmcnt(0) lgkmcnt(0)
    v_smfmac_f32_16x16x64_bf16 v[160:163], v[240:243], v[244:251], v10
    buffer_load_dwordx4 v[240:243], v252, s[16:19], s57 offen sc1
    s_add_u32 s57, s57, 1024
    s_waitcnt vmcnt(0) lgkmcnt(0)
    v_smfmac_f32_16x16x64_bf16 v[164:167], v[240:243], v[244:251], v10
    buffer_load_dwordx4 v[240:243], v252, s[16:19], s57 offen sc1
    s_add_u32 s57, s57, 1024
    s_waitcnt vmcnt(0) lgkmcnt(0)
    v_smfmac_f32_16x16x64_bf16 v[168:171], v[240:243], v[244:251], v10
    buffer_load_dwordx4 v[240:243], v252, s[16:19], s57 offen sc1
    s_add_u32 s57, s57, 1024
    s_waitcnt vmcnt(0) lgkmcnt(0)
    v_smfmac_f32_16x16x64_bf16 v[172:175], v[240:243], v[244:251], v10
    buffer_load_dwordx4 v[240:243], v252, s[16:19], s57 offen sc1
    s_add_u32 s57, s57, 1024
    s_waitcnt vmcnt(0) lgkmcnt(0)
    v_smfmac_f32_16x16x64_bf16 v[176:179], v[240:243], v[244:251], v10
    buffer_load_dwordx4 v[240:243], v252, s[16:19], s57 offen sc1
    s_add_u32 s57, s57, 1024
    s_waitcnt vmcnt(0) lgkmcnt(0)
    v_smfmac_f32_16x16x64_bf16 v[180:183], v[240:243], v[244:251], v10
    buffer_load_dwordx4 v[240:243], v252, s[16:19], s57 offen sc1
    s_add_u32 s57, s57, 1024
    s_waitcnt vmcnt(0) lgkmcnt(0)
    v_smfmac_f32_16x16x64_bf16 v[184:187], v[240:243], v[244:251], v10
    buffer_load_dwordx4 v[240:243], v252, s[16:19], s57 offen sc1
    s_add_u32 s57, s57, 1024
    s_waitcnt vmcnt(0) lgkmcnt(0)
    v_smfmac_f32_16x16x64_bf16 v[188:191], v[240:243], v[244:251], v10
    buffer_load_dwordx4 v[240:243], v252, s[16:19], s57 offen sc1
    s_add_u32 s57, s57, 1024
    s_waitcnt vmcnt(0) lgkmcnt(0)
    v_smfmac_f32_16x16x64_bf16 v[192:195], v[240:243], v[244:251], v10
    s_add_u32 s56, s56, 1
    s_cmp_lt_u32 s56, 9
    s_cbranch_scc1 M_dn1
    s_branch M_slx
M_codeend:
.section .rodata,"a"
.p2align 6
.amdhsa_kernel standalone__structured_sparse_n_m__ragged_kernel
  .amdhsa_next_free_vgpr 512
  .amdhsa_next_free_sgpr 102
  .amdhsa_accum_offset 256
  .amdhsa_group_segment_fixed_size 0
  .amdhsa_kernarg_size 48
  .amdhsa_user_sgpr_count 2
  .amdhsa_user_sgpr_kernarg_segment_ptr 1
  .amdhsa_system_sgpr_workgroup_id_x 1
  .amdhsa_float_denorm_mode_32 3
.end_amdhsa_kernel
```

```asm
; @launch grid=(256,1,1) block=(256,1,1) lds=162064
.amdgcn_target "amdgcn-amd-amdhsa--gfx950"
.text
.globl standalone__structured_sparse_n_m__ragged_kernel
.p2align 8
.type standalone__structured_sparse_n_m__ragged_kernel,@function
standalone__structured_sparse_n_m__ragged_kernel:
    s_cmp_ge_u32 s2, 256
    s_cbranch_scc1 M_end
    s_load_dwordx8 s[72:79], s[0:1], 0
    s_load_dwordx4 s[80:83], s[0:1], 32
    s_getpc_b64 s[84:85]
    s_lshr_b32 s30, s2, 3
    s_and_b32 s30, s30, 15
    s_lshl_b32 s30, s30, 11
    s_and_b32 s84, s84, 0xffffff00
    s_cmp_ge_u32 s2, 88
    s_cselect_b32 s86, M_codeend-standalone__structured_sparse_n_m__ragged_kernel, 0
    s_mov_b32 s87, 0x20000
    v_lshlrev_b32 v254, 3, v0
    s_mov_b32 exec_lo, 0x00010001
    s_mov_b32 exec_hi, 0x00010001
    buffer_load_dword v254, v254, s[84:87], s30 offen
    s_mov_b64 exec, -1
    v_lshrrev_b32 v20, 6, v0
    v_and_b32 v12, 63, v0
    v_readfirstlane_b32 s20, v20
    v_lshrrev_b32 v22, 3, v0
    v_mul_u32_u24 v22, 1152, v22
    v_lshrrev_b32 v23, 4, v0
    v_xor_b32 v23, v23, v0
    v_and_b32 v23, 7, v23
    v_lshl_add_u32 v5, v23, 4, v22
    v_lshrrev_b32 v13, 4, v12
    v_and_b32 v14, 15, v12
    v_lshlrev_b32 v11, 4, v12
    v_lshlrev_b32 v54, 3, v12
    v_lshlrev_b32 v25, 4, v13
    v_lshlrev_b32 v26, 3, v13
    s_mov_b32 s6, 663552
    s_mov_b32 s7, 0x20000
    s_mov_b32 s10, 75497472
    s_mov_b32 s11, s7
    s_mov_b32 s18, 791552
    s_mov_b32 s19, s7
    s_movk_i32 s70, 256
    s_mov_b32 s71, s7
    s_movk_i32 s86, 1152
    s_mov_b32 s87, s7
    s_mov_b32 s98, 0
    s_mul_i32 s96, s20, 16
    s_and_b32 s97, s2, 15
    s_add_u32 s96, s96, s97
    s_lshl_b32 s96, s96, 8
    s_add_u32 s96, s96, 726016
    s_mul_i32 s22, s2, 36864
    s_mul_i32 s26, s20, 9216
    s_mov_b32 s24, s22
    s_mov_b32 s42, s26
    s_lshl_b32 s28, s20, 8
    s_lshl_b32 s97, s20, 5
    s_cmp_lt_u32 s2, 81
    s_cbranch_scc0 M_x1
    s_mul_i32 s32, s2, 57
    s_lshr_b32 s32, s32, 9
    s_mul_i32 s33, s32, 9
    s_sub_u32 s33, s2, s33
    s_mul_i32 s54, s32, 73728
    s_lshl_b32 s35, s33, 7
    s_add_u32 s54, s54, s35
    s_add_u32 s55, s54, 36864
    s_lshl_b32 s36, s20, 10
    s_add_u32 m0, s36, 73728
    s_lshr_b32 s30, s33, 1
    s_and_b32 s31, s33, 1
    s_lshl1_add_u32 s37, s32, s31
    s_mul_i32 s37, s37, 176
    s_mul_i32 s38, s32, 96
    s_add_u32 s38, s38, 3168
    s_cmp_lt_u32 s33, 8
    s_cselect_b32 s30, s30, s20
    s_cselect_b32 s37, s37, s38
    s_cselect_b32 s44, 2047, 63
    s_cselect_b32 s45, s20, 3
    s_cmp_eq_u32 s45, 3
    s_cselect_b32 s99, 791552, 0
    s_mul_i32 s48, s30, 98304
    s_add_u32 s37, s37, s48
    v_mov_b32 v44, 2.0
    v_mov_b32 v45, 0
    v_mov_b32 v46, 2.0
    v_mov_b32 v47, 0
    s_waitcnt lgkmcnt(0)
    s_mov_b64 s[4:5], s[74:75]
    buffer_load_dwordx4 v5, s[4:7], s54 offen lds
    s_add_u32 m0, m0, 4096
    s_mov_b32 s45, 0
    buffer_load_dwordx4 v5, s[4:7], s55 offen lds
    s_mov_b64 s[16:17], s[82:83]
    s_mov_b64 s[8:9], s[72:73]
    s_mov_b64 s[84:85], s[76:77]
    s_mov_b64 s[68:69], s[80:81]
    v_mov_b32 v10, 0
    s_mov_b64 exec, 1
    buffer_atomic_add v10, off, s[16:19], s96 sc0 sc1
    s_mov_b64 exec, -1
    s_mov_b64 exec, s[44:45]
    s_mov_b32 s18, s99
    buffer_store_dwordx4 v[44:47], v11, s[16:19], s37 offen sc1
    s_mov_b32 s18, 791552
    s_mov_b64 exec, -1
    s_mov_b32 m0, s42
    s_nop 0
    buffer_load_dwordx4 v5, s[8:11], s22 offen offset:0 nt lds
    s_add_u32 m0, m0, 896
    s_nop 0
    buffer_load_dwordx4 v5, s[8:11], s22 offen offset:128 nt lds
    s_add_u32 m0, m0, 896
    s_nop 0
    buffer_load_dwordx4 v5, s[8:11], s22 offen offset:256 nt lds
    s_lshl_b32 s34, s31, 2
    s_add_u32 s34, s34, s20
    s_lshr_b32 s35, s20, 1
    s_lshl_b32 s35, s35, 6
    s_and_b32 s36, s20, 1
    s_lshl_b32 s36, s36, 3
    s_add_u32 s35, s35, s36
    s_lshl_b32 s36, s20, 5
    s_mul_i32 s39, s32, 10240
    s_add_u32 s39, s39, 6144
    s_lshl_b32 s40, s34, 1
    s_add_u32 s40, s40, s39
    s_lshl_b32 s38, s32, 1
    s_cmp_eq_u32 s32, 8
    s_cselect_b32 s38, 1024, s38
    s_add_u32 s38, s38, 4096
    s_cmp_lt_u32 s33, 8
    s_cselect_b32 s34, s34, 8
    s_cselect_b32 s35, s35, s36
    s_cselect_b32 s36, 4, 3
    s_cselect_b32 s40, s40, s38
    s_cselect_b32 s46, 0, s20
    s_cselect_b32 s47, 22, 12
    s_add_u32 s40, s40, s48
    s_lshl_b32 s38, s34, 10
    s_add_u32 s39, s39, s38
    s_add_u32 s39, s39, s48
    s_add_u32 s39, s39, 1024
    v_and_b32 v15, 3, v14
    v_lshlrev_b32 v15, s36, v15
    v_add_u32 v15, s35, v15
    v_lshrrev_b32 v16, 3, v14
    v_lshlrev_b32 v16, 4, v16
    v_xor_b32 v15, v15, v16
    v_lshrrev_b32 v16, 2, v14
    v_lshl_add_u32 v16, v13, 4, v16
    v_lshl_add_u32 v15, v16, 7, v15
    v_add_u32 v24, 73728, v15
    v_xor_b32 v27, 32, v24
    v_xor_b32 v28, 64, v24
    v_xor_b32 v29, 0x60, v24
    s_lshl_b32 s31, s46, 2
    s_add_u32 s31, s31, 81920
    v_mov_b32 v60, s31
    v_mov_b32 v61, 1
    ds_write_b32 v60, v61
    s_mul_i32 s49, s30, 81
    s_mul_i32 s31, s32, 9
    s_add_u32 s49, s49, s31
    s_add_u32 s49, s49, s34
    s_lshl_b32 s49, s49, 10
    s_add_u32 s49, s49, 393216
    s_lshl_b32 s31, s34, 24
    s_lshl_b32 s38, s32, 10
    s_add_u32 s31, s31, s38
    v_lshlrev_b32 v31, 18, v14
    v_lshl_add_u32 v31, v13, 5, v31
    v_add_u32 v31, s31, v31
    s_mov_b32 s50, 3437096686
    s_mov_b32 s51, 1150609561
    s_mov_b32 s52, 0x00010001
    s_mov_b32 s53, 0x00200010
    s_mov_b32 s38, 0x0202
    s_mul_i32 s57, s30, 4096
    s_add_u32 s57, s57, 726016
    s_cmp_eq_u32 s33, 8
    s_cselect_b32 s56, 0, s20
    s_cmp_eq_u32 s20, 0
    s_cselect_b32 s98, 1, 0
    v_add_u32 v74, 81984, v54
    v_lshl_add_u32 v73, s20, 1, v74
    v_mov_b32 v41, 0x01000100
    v_mov_b32 v40, 0
    v_mov_b32 v63, -2.0
    s_waitcnt vmcnt(5) lgkmcnt(0)
    s_barrier
    ds_read_b64_tr_b16 v[16:17], v24
    ds_read_b64_tr_b16 v[18:19], v27 offset:512
    ds_read_b64_tr_b16 v[20:21], v28 offset:1024
    ds_read_b64_tr_b16 v[22:23], v29 offset:1536
    s_waitcnt lgkmcnt(3)
    v_and_b32 v44, 0x7fff7fff, v16
    v_and_b32 v45, 0x7fff7fff, v17
    v_pk_max_u16 v46, v44, v45
    v_pk_min_u16 v47, v44, v45
    v_pk_min_u16 v46, v46, v46 op_sel:[0,1] op_sel_hi:[1,0]
    v_pk_max_u16 v47, v47, v47 op_sel:[0,1] op_sel_hi:[1,0]
    v_pk_max_u16 v46, v46, s52
    v_pk_max_u16 v46, v46, v47
    v_pk_sub_i16 v44, v44, v46
    v_pk_sub_i16 v45, v45, v46
    v_pk_ashrrev_i16 v44, 15, v44 op_sel_hi:[0,1]
    v_pk_ashrrev_i16 v45, 15, v45 op_sel_hi:[0,1]
    v_alignbit_b32 v47, -1, v44, 16
    v_alignbit_b32 v46, v45, v45, 16
    v_and_b32 v48, 0x00080004, v44
    v_bitop3_b32 v46, v45, v46, v47 bitop3:0xe8
    v_and_or_b32 v64, v45, s53, v48
    v_bitop3_b32 v36, v16, v44, v46 bitop3:0x10
    v_min_u32 v68, 1, v36
    s_waitcnt lgkmcnt(2)
    v_and_b32 v44, 0x7fff7fff, v18
    v_and_b32 v45, 0x7fff7fff, v19
    v_pk_max_u16 v46, v44, v45
    v_pk_min_u16 v47, v44, v45
    v_pk_min_u16 v46, v46, v46 op_sel:[0,1] op_sel_hi:[1,0]
    v_pk_max_u16 v47, v47, v47 op_sel:[0,1] op_sel_hi:[1,0]
    v_pk_max_u16 v46, v46, s52
    v_pk_max_u16 v46, v46, v47
    v_pk_sub_i16 v44, v44, v46
    v_pk_sub_i16 v45, v45, v46
    v_pk_ashrrev_i16 v44, 15, v44 op_sel_hi:[0,1]
    v_pk_ashrrev_i16 v45, 15, v45 op_sel_hi:[0,1]
    v_alignbit_b32 v47, -1, v44, 16
    v_alignbit_b32 v46, v45, v45, 16
    v_and_b32 v48, 0x00080004, v44
    v_bitop3_b32 v46, v45, v46, v47 bitop3:0xe8
    v_and_or_b32 v65, v45, s53, v48
    v_bitop3_b32 v37, v18, v44, v46 bitop3:0x10
    v_min_u32 v69, 1, v37
    s_waitcnt lgkmcnt(1)
    v_and_b32 v44, 0x7fff7fff, v20
    v_and_b32 v45, 0x7fff7fff, v21
    v_pk_max_u16 v46, v44, v45
    v_pk_min_u16 v47, v44, v45
    v_pk_min_u16 v46, v46, v46 op_sel:[0,1] op_sel_hi:[1,0]
    v_pk_max_u16 v47, v47, v47 op_sel:[0,1] op_sel_hi:[1,0]
    v_pk_max_u16 v46, v46, s52
    v_pk_max_u16 v46, v46, v47
    v_pk_sub_i16 v44, v44, v46
    v_pk_sub_i16 v45, v45, v46
    v_pk_ashrrev_i16 v44, 15, v44 op_sel_hi:[0,1]
    v_pk_ashrrev_i16 v45, 15, v45 op_sel_hi:[0,1]
    v_alignbit_b32 v47, -1, v44, 16
    v_alignbit_b32 v46, v45, v45, 16
    v_and_b32 v48, 0x00080004, v44
    v_bitop3_b32 v46, v45, v46, v47 bitop3:0xe8
    v_and_or_b32 v66, v45, s53, v48
    v_bitop3_b32 v38, v20, v44, v46 bitop3:0x10
    v_min_u32 v70, 1, v38
    s_waitcnt lgkmcnt(0)
    v_and_b32 v44, 0x7fff7fff, v22
    v_and_b32 v45, 0x7fff7fff, v23
    v_pk_max_u16 v46, v44, v45
    v_pk_min_u16 v47, v44, v45
    v_pk_min_u16 v46, v46, v46 op_sel:[0,1] op_sel_hi:[1,0]
    v_pk_max_u16 v47, v47, v47 op_sel:[0,1] op_sel_hi:[1,0]
    v_pk_max_u16 v46, v46, s52
    v_pk_max_u16 v46, v46, v47
    v_pk_sub_i16 v44, v44, v46
    v_pk_sub_i16 v45, v45, v46
    v_pk_ashrrev_i16 v44, 15, v44 op_sel_hi:[0,1]
    v_pk_ashrrev_i16 v45, 15, v45 op_sel_hi:[0,1]
    v_alignbit_b32 v47, -1, v44, 16
    v_alignbit_b32 v46, v45, v45, 16
    v_and_b32 v48, 0x00080004, v44
    v_bitop3_b32 v46, v45, v46, v47 bitop3:0xe8
    v_and_or_b32 v67, v45, s53, v48
    v_bitop3_b32 v39, v22, v44, v46 bitop3:0x10
    v_min_u32 v71, 1, v39
    v_add_u32 v72, v68, v69
    v_add3_u32 v72, v72, v70, v71
    buffer_store_dwordx4 v[36:39], v11, s[16:19], s49 offen sc1
    v_cmp_ne_u32 vcc, 0, v72
    s_and_saveexec_b64 s[44:45], vcc
    ds_add_rtn_u32 v62, v60, v72
    s_mov_b64 exec, -1
    v_lshrrev_b32 v48, 16, v64
    v_or_b32 v48, v48, v64
    v_lshrrev_b64 v[52:53], v48, s[50:51]
    v_and_b32 v64, 15, v52
    v_lshl_or_b32 v40, v64, 0, v40
    v_lshrrev_b32 v48, 16, v65
    v_or_b32 v48, v48, v65
    v_lshrrev_b64 v[52:53], v48, s[50:51]
    v_and_b32 v65, 15, v52
    v_lshl_or_b32 v40, v65, 4, v40
    v_lshrrev_b32 v48, 16, v66
    v_or_b32 v48, v48, v66
    v_lshrrev_b64 v[52:53], v48, s[50:51]
    v_and_b32 v66, 15, v52
    v_lshl_or_b32 v40, v66, 8, v40
    v_lshrrev_b32 v48, 16, v67
    v_or_b32 v48, v48, v67
    v_lshrrev_b64 v[52:53], v48, s[50:51]
    v_and_b32 v67, 15, v52
    v_lshl_or_b32 v40, v67, 12, v40
    v_lshrrev_b32 v44, 2, v40
    v_lshlrev_b32 v45, 2, v40
    s_movk_i32 s31, 0x3333
    v_not_b32 v47, v40
    v_bfi_b32 v44, s31, v44, v45
    s_movk_i32 s31, 0x1111
    s_nop 0
    v_mov_b32_dpp v47, v44 row_shr:4 row_mask:0xf bank_mask:0xf
    v_xor_b32 v47, v47, v40
    v_lshrrev_b32 v45, 1, v47
    v_or_b32 v47, v47, v45
    v_lshrrev_b32 v45, 2, v47
    v_bitop3_b32 v47, v47, v45, s31 bitop3:0x2a
    s_nop 1
    v_xor_b32_dpp v47, v47, v47 row_shr:4 row_mask:0xf bank_mask:0xe
    s_nop 1
    v_xor_b32_dpp v47, v47, v47 row_shr:8 row_mask:0xf bank_mask:0xc
    v_mul_u32_u24 v47, 15, v47
    v_bfi_b32 v40, v47, v44, v40
    ds_write_b16 v73, v40
    v_bfe_u32 v64, v40, 0, 4
    v_mul_u32_u24 v46, 0x4001, v64
    v_and_b32 v46, 0x30003, v46
    v_mad_u32_u24 v46, v46, s38, v41
    v_perm_b32 v32, v17, v16, v46
    v_bfe_u32 v65, v40, 4, 4
    v_mul_u32_u24 v46, 0x4001, v65
    v_and_b32 v46, 0x30003, v46
    v_mad_u32_u24 v46, v46, s38, v41
    v_perm_b32 v33, v19, v18, v46
    s_waitcnt vmcnt(4) lgkmcnt(0)
    s_barrier
    ds_read_b64 v[50:51], v74
    v_bfe_u32 v66, v40, 8, 4
    v_mul_u32_u24 v46, 0x4001, v66
    v_and_b32 v46, 0x30003, v46
    v_mad_u32_u24 v46, v46, s38, v41
    v_perm_b32 v34, v21, v20, v46
    v_bfe_u32 v67, v40, 12, 4
    v_mul_u32_u24 v46, 0x4001, v67
    v_and_b32 v46, 0x30003, v46
    v_mad_u32_u24 v46, v46, s38, v41
    v_perm_b32 v35, v23, v22, v46
    buffer_store_dwordx4 v[32:35], v11, s[16:19], s39 offen sc1
    s_cmp_eq_u32 s33, 8
    s_cbranch_scc0 F_i1
    buffer_store_short v40, v11, s[16:19], s40 offen sc1
    s_branch F_i2
F_i1:
    s_cmp_eq_u32 s20, 0
    s_cbranch_scc0 F_i2
    s_waitcnt lgkmcnt(0)
    buffer_store_dwordx2 v[50:51], v11, s[16:19], s40 offen sc1
F_i2:
    s_cbranch_vccz F_z
    v_cmp_ne_u32 vcc, 0, v36
    s_and_saveexec_b64 s[44:45], vcc
    s_cbranch_execz F_e0
    v_cmp_gt_u32 vcc, s47, v62
    v_add_u32 v42, 0, v31
    v_lshlrev_b32 v44, 3, v62
    v_add_u32 v62, 1, v62
    v_cndmask_b32 v42, v63, v42, vcc
    v_cndmask_b32 v43, 0, v36, vcc
    v_cndmask_b32 v44, 0, v44, vcc
    buffer_store_dwordx2 v[42:43], v44, s[16:19], s37 offen sc1
F_e0:
    s_mov_b64 exec, -1
    v_cmp_ne_u32 vcc, 0, v37
    s_and_saveexec_b64 s[44:45], vcc
    s_cbranch_execz F_e1
    v_cmp_gt_u32 vcc, s47, v62
    v_add_u32 v42, 8, v31
    v_lshlrev_b32 v44, 3, v62
    v_add_u32 v62, 1, v62
    v_cndmask_b32 v42, v63, v42, vcc
    v_cndmask_b32 v43, 0, v37, vcc
    v_cndmask_b32 v44, 0, v44, vcc
    buffer_store_dwordx2 v[42:43], v44, s[16:19], s37 offen sc1
F_e1:
    s_mov_b64 exec, -1
    v_cmp_ne_u32 vcc, 0, v38
    s_and_saveexec_b64 s[44:45], vcc
    s_cbranch_execz F_e2
    v_cmp_gt_u32 vcc, s47, v62
    v_add_u32 v42, 16, v31
    v_lshlrev_b32 v44, 3, v62
    v_add_u32 v62, 1, v62
    v_cndmask_b32 v42, v63, v42, vcc
    v_cndmask_b32 v43, 0, v38, vcc
    v_cndmask_b32 v44, 0, v44, vcc
    buffer_store_dwordx2 v[42:43], v44, s[16:19], s37 offen sc1
F_e2:
    s_mov_b64 exec, -1
    v_cmp_ne_u32 vcc, 0, v39
    s_and_saveexec_b64 s[44:45], vcc
    s_cbranch_execz F_e3
    v_cmp_gt_u32 vcc, s47, v62
    v_add_u32 v42, 24, v31
    v_lshlrev_b32 v44, 3, v62
    v_add_u32 v62, 1, v62
    v_cndmask_b32 v42, v63, v42, vcc
    v_cndmask_b32 v43, 0, v39, vcc
    v_cndmask_b32 v44, 0, v44, vcc
    buffer_store_dwordx2 v[42:43], v44, s[16:19], s37 offen sc1
F_e3:
    s_mov_b64 exec, -1
F_z:
    s_cmp_lg_u32 s2, 0
    s_cbranch_scc1 M_set
    v_mov_b32 v64, 0
    v_mov_b32 v65, 0
    v_mov_b32 v66, 0
    v_mov_b32 v67, 0
    s_mov_b32 s40, 724992
    buffer_store_dwordx4 v[64:67], v11, s[16:19], s40 offen sc1
    s_branch M_set
F_sig:
    v_lshlrev_b32 v30, 8, v12
    s_waitcnt vmcnt(0)
    s_barrier
    s_cmp_lg_u32 s56, 0
    s_cbranch_scc1 F_end
    s_bfm_b64 exec, 16, 0
    buffer_atomic_add v61, v30, s[16:19], s57 offen sc1
    s_mov_b64 exec, -1
    s_cmp_eq_u32 s98, 0
    s_cbranch_scc1 F_cnt
    s_mov_b32 s98, 0
    v_mov_b32 v250, 1
    s_mov_b64 exec, 1
    buffer_atomic_add v250, off, s[68:71], 0 offset:0 sc1
    s_mov_b64 exec, -1
    s_nop 3
F_cnt:
F_end:
    s_add_u32 m0, m0, 896
    s_nop 0
    buffer_load_dwordx4 v5, s[8:11], s22 offen offset:384 nt lds
    s_add_u32 m0, m0, 896
    s_nop 0
    buffer_load_dwordx4 v5, s[8:11], s22 offen offset:512 nt lds
    s_branch M_x2
M_x1:
    s_waitcnt lgkmcnt(0)
    s_mov_b64 s[4:5], s[74:75]
    s_mov_b64 s[16:17], s[82:83]
    s_mov_b64 s[8:9], s[72:73]
    s_mov_b64 s[84:85], s[76:77]
    s_mov_b64 s[68:69], s[80:81]
    v_mov_b32 v10, 0
    s_mov_b64 exec, 1
    buffer_atomic_add v10, off, s[16:19], s96 sc0 sc1
    s_mov_b64 exec, -1
    s_mov_b32 m0, s42
    s_nop 0
    buffer_load_dwordx4 v5, s[8:11], s22 offen offset:0 nt lds
    s_add_u32 m0, m0, 896
    s_nop 0
    buffer_load_dwordx4 v5, s[8:11], s22 offen offset:128 nt lds
    s_add_u32 m0, m0, 896
    s_nop 0
    buffer_load_dwordx4 v5, s[8:11], s22 offen offset:256 nt lds
    s_add_u32 m0, m0, 896
    s_nop 0
    buffer_load_dwordx4 v5, s[8:11], s22 offen offset:384 nt lds
    s_add_u32 m0, m0, 896
    s_nop 0
    buffer_load_dwordx4 v5, s[8:11], s22 offen offset:512 nt lds
M_set:
    s_mov_b32 s12, s78
    s_mov_b32 s13, s79
    s_mov_b32 s14, 75497472
    s_mov_b32 s15, 0x20000
    s_mul_i32 s29, s20, 12864
    s_add_u32 s29, s29, 110592
    v_lshrrev_b32 v24, 1, v14
    v_and_b32 v27, 7, v14
    v_lshlrev_b32 v22, 7, v27
    v_lshl_or_b32 v3, v24, 4, v22
    v_lshrrev_b32 v23, 3, v14
    v_mul_u32_u24 v4, 9216, v23
    v_xad_u32 v1, v25, v3, v4
    v_xor_b32 v2, 64, v1
    v_add_u32 v9, s29, v25
    v_add_u32 v8, s29, v11
    v_mul_u32_u24 v24, 1152, v27
    v_lshl_add_u32 v24, v23, 6, v24
    v_add3_u32 v6, v24, v25, s28
    v_lshrrev_b32 v24, 3, v12
    v_xor_b32 v28, v24, v12
    v_and_b32 v28, 7, v28
    v_mul_u32_u24 v24, 1152, v24
    v_lshl_add_u32 v24, v28, 4, v24
    v_add_u32 v7, 1024, v24
    s_lshl_b32 s30, s20, 1
    v_lshrrev_b32 v24, 1, v13
    v_add_u32 v24, s30, v24
    v_xor_b32 v24, v24, v27
    v_lshl_add_u32 v24, v24, 4, v22
    v_and_b32 v28, 8, v26
    v_mul_u32_u24 v29, 12864, v23
    v_add3_u32 v24, v24, v28, v29
    v_add_u32 v53, 121408, v24
    s_lshr_b32 s30, s2, 3
    s_and_b32 s30, s30, 1
    s_mul_i32 s92, s30, 256
    s_add_u32 s92, s92, 562944
    s_add_u32 s30, s30, 768
    s_mul_i32 s93, s30, 36864
    s_mov_b32 s94, 73728
    s_and_b32 s95, s20, 1
    s_mul_i32 s95, s95, 9216
    s_add_u32 s59, s24, 9216
    s_mul_i32 s43, s20, 98304
    s_add_u32 s47, s29, 9216
    s_add_u32 s48, s29, 9792
    s_add_u32 s49, s29, 10112
    s_add_u32 s54, s29, 1073751872
    s_add_u32 s38, s26, 73728
    s_add_u32 s35, s38, 1024
    s_add_u32 s39, s38, 1536
    s_mov_b32 s40, s48
    s_add_u32 s41, s48, 256
    s_mov_b32 s50, 3130536464
    s_mov_b32 s51, 1164430831
    s_mov_b32 s52, 3696531472
    s_mov_b32 s53, 598435823
    v_mov_b32 v16, 0
    v_mov_b32 v17, 0
    v_mov_b32 v18, 0
    v_mov_b32 v19, 0
    v_cmp_gt_u32 s[44:45], 36, v12
    v_mov_b32 v20, 2.0
    s_nop 0
    v_cndmask_b32 v20, 0, v20, s[44:45]
    v_mov_b32 v21, v20
    v_mov_b32 v22, v20
    v_mov_b32 v23, v20
    v_mov_b32 v104, 1073741824
    v_mov_b32 v105, 0
    v_mov_b32 v106, 1073741824
    v_mov_b32 v107, 0
    v_lshl_add_u32 v121, v12, 2, s49
    v_add_u32 v55, s38, v54
    v_add_u32 v24, s38, v11
    ds_write_b128 v8, v[16:19] offset:0
    ds_write_b128 v8, v[16:19] offset:1024
    ds_write_b128 v8, v[16:19] offset:2048
    ds_write_b128 v8, v[16:19] offset:3072
    ds_write_b128 v8, v[16:19] offset:4096
    ds_write_b128 v8, v[16:19] offset:5120
    ds_write_b128 v8, v[16:19] offset:6144
    ds_write_b128 v8, v[16:19] offset:7168
    ds_write_b128 v8, v[16:19] offset:8192
    ds_write_b128 v24, v[104:107]
    ds_write_b128 v24, v[104:107] offset:1024
    ds_write_b128 v8, v[20:23] offset:9216
    s_cmp_lt_u32 s2, 81
    s_cbranch_scc1 F_sig
M_x2:
    s_add_u32 m0, m0, 896
    s_nop 0
    buffer_load_dwordx4 v5, s[8:11], s22 offen offset:640 nt lds
    s_add_u32 m0, m0, 896
    s_nop 0
    buffer_load_dwordx4 v5, s[8:11], s22 offen offset:768 nt lds
    s_add_u32 m0, m0, 896
    s_nop 0
    buffer_load_dwordx4 v5, s[8:11], s22 offen offset:896 nt lds
    s_add_u32 m0, m0, 896
    s_nop 0
    buffer_load_dwordx4 v5, s[8:11], s22 offen offset:1024 nt lds
    s_add_u32 s22, s22, 9437184
    s_add_u32 s42, s42, 36864
    buffer_load_dwordx4 v[196:199], v25, s[84:87], s28 offen offset:0
    buffer_load_dwordx4 v[200:203], v25, s[84:87], s28 offen offset:64
    buffer_load_dwordx4 v[204:207], v25, s[84:87], s28 offen offset:128
    buffer_load_dwordx4 v[208:211], v25, s[84:87], s28 offen offset:192
    buffer_load_dwordx2 v[212:213], v26, s[84:87], s97 offen offset:1024
    s_mov_b32 m0, s42
    s_nop 0
    buffer_load_dwordx4 v5, s[8:11], s22 offen offset:0 nt lds
    s_add_u32 m0, m0, 896
    s_nop 0
    buffer_load_dwordx4 v5, s[8:11], s22 offen offset:128 nt lds
    s_add_u32 m0, m0, 896
    s_nop 0
    buffer_load_dwordx4 v5, s[8:11], s22 offen offset:256 nt lds
    s_add_u32 m0, m0, 896
    s_nop 0
    buffer_load_dwordx4 v5, s[8:11], s22 offen offset:384 nt lds
    s_add_u32 m0, m0, 896
    s_nop 0
    buffer_load_dwordx4 v5, s[8:11], s22 offen offset:512 nt lds
    s_add_u32 m0, m0, 896
    s_nop 0
    buffer_load_dwordx4 v5, s[8:11], s22 offen offset:640 nt lds
    s_add_u32 m0, m0, 896
    s_nop 0
    buffer_load_dwordx4 v5, s[8:11], s22 offen offset:768 nt lds
    s_add_u32 m0, m0, 896
    s_nop 0
    buffer_load_dwordx4 v5, s[8:11], s22 offen offset:896 nt lds
    s_add_u32 m0, m0, 896
    s_nop 0
    buffer_load_dwordx4 v5, s[8:11], s22 offen offset:1024 nt lds
    s_add_u32 s22, s22, 9437184
    s_add_u32 s42, s42, 36864
    s_waitcnt vmcnt(3)
    v_mov_b32 v0, 0
    s_mov_b64 exec, 1
    buffer_atomic_add v0, off, s[16:19], s96 sc0 sc1
    s_mov_b64 exec, -1
    v_readlane_b32 s100, v10, 0
    v_mov_b32 v10, 0xeeee4444
    v_lshlrev_b32 v124, 16, v196
    v_and_b32 v125, 0xffff0000, v196
    v_lshlrev_b32 v126, 16, v197
    v_and_b32 v127, 0xffff0000, v197
    v_lshlrev_b32 v128, 16, v198
    v_and_b32 v129, 0xffff0000, v198
    v_lshlrev_b32 v130, 16, v199
    v_and_b32 v131, 0xffff0000, v199
    v_lshlrev_b32 v132, 16, v200
    v_and_b32 v133, 0xffff0000, v200
    v_lshlrev_b32 v134, 16, v201
    v_and_b32 v135, 0xffff0000, v201
    v_lshlrev_b32 v136, 16, v202
    v_and_b32 v137, 0xffff0000, v202
    v_lshlrev_b32 v138, 16, v203
    v_and_b32 v139, 0xffff0000, v203
    v_lshlrev_b32 v140, 16, v204
    v_and_b32 v141, 0xffff0000, v204
    v_lshlrev_b32 v142, 16, v205
    v_and_b32 v143, 0xffff0000, v205
    v_lshlrev_b32 v144, 16, v206
    v_and_b32 v145, 0xffff0000, v206
    v_lshlrev_b32 v146, 16, v207
    v_and_b32 v147, 0xffff0000, v207
    v_lshlrev_b32 v148, 16, v208
    v_and_b32 v149, 0xffff0000, v208
    v_lshlrev_b32 v150, 16, v209
    v_and_b32 v151, 0xffff0000, v209
    v_lshlrev_b32 v152, 16, v210
    v_and_b32 v153, 0xffff0000, v210
    v_lshlrev_b32 v154, 16, v211
    v_and_b32 v155, 0xffff0000, v211
    v_lshlrev_b32 v156, 16, v212
    v_and_b32 v157, 0xffff0000, v212
    v_lshlrev_b32 v158, 16, v213
    v_and_b32 v159, 0xffff0000, v213
    s_mov_b32 exec_lo, 0x00010001
    s_mov_b32 exec_hi, 0x00010001
    ds_write_b128 v9, v[124:127] offset:10240
    ds_write_b128 v9, v[128:131] offset:10304
    ds_write_b128 v9, v[132:135] offset:10368
    ds_write_b128 v9, v[136:139] offset:10432
    ds_write_b128 v9, v[140:143] offset:10496
    ds_write_b128 v9, v[144:147] offset:10560
    ds_write_b128 v9, v[148:151] offset:10624
    ds_write_b128 v9, v[152:155] offset:10688
    ds_write_b128 v9, v[156:159] offset:10752
    s_mov_b64 exec, -1
    s_mul_i32 s30, s20, 256
    s_xor_b32 s31, s2, 0
    s_add_u32 s30, s30, s31
    s_sub_u32 s30, s30, 0
    s_cmp_lt_u32 s2, 0
    s_cselect_b32 s30, 1023, s30
    s_lshl_b32 s30, s30, 1
    v_lshrrev_b32 v244, 5, v12
    v_add_u32 v248, s30, v244
    v_mov_b32 v244, -1
    v_mov_b32 v245, 0
    v_subrev_u32 v246, 664, v248
    v_cmp_gt_u32 vcc, 12, v246
    v_mov_b32 v247, 0
    s_nop 0
    v_cndmask_b32 v244, v244, v246, vcc
    v_cndmask_b32 v245, v245, v247, vcc
    v_subrev_u32 v246, 638, v248
    v_cmp_gt_u32 vcc, 26, v246
    v_mov_b32 v247, 1
    s_nop 0
    v_cndmask_b32 v244, v244, v246, vcc
    v_cndmask_b32 v245, v245, v247, vcc
    v_subrev_u32 v246, 598, v248
    v_cmp_gt_u32 vcc, 40, v246
    v_mov_b32 v247, 2
    s_nop 0
    v_cndmask_b32 v244, v244, v246, vcc
    v_cndmask_b32 v245, v245, v247, vcc
    v_subrev_u32 v246, 542, v248
    v_cmp_gt_u32 vcc, 56, v246
    v_mov_b32 v247, 3
    s_nop 0
    v_cndmask_b32 v244, v244, v246, vcc
    v_cndmask_b32 v245, v245, v247, vcc
    v_subrev_u32 v246, 468, v248
    v_cmp_gt_u32 vcc, 74, v246
    v_mov_b32 v247, 4
    s_nop 0
    v_cndmask_b32 v244, v244, v246, vcc
    v_cndmask_b32 v245, v245, v247, vcc
    v_subrev_u32 v246, 376, v248
    v_cmp_gt_u32 vcc, 92, v246
    v_mov_b32 v247, 5
    s_nop 0
    v_cndmask_b32 v244, v244, v246, vcc
    v_cndmask_b32 v245, v245, v247, vcc
    v_subrev_u32 v246, 268, v248
    v_cmp_gt_u32 vcc, 108, v246
    v_mov_b32 v247, 6
    s_nop 0
    v_cndmask_b32 v244, v244, v246, vcc
    v_cndmask_b32 v245, v245, v247, vcc
    v_subrev_u32 v246, 142, v248
    v_cmp_gt_u32 vcc, 126, v246
    v_mov_b32 v247, 7
    s_nop 0
    v_cndmask_b32 v244, v244, v246, vcc
    v_cndmask_b32 v245, v245, v247, vcc
    v_subrev_u32 v246, 0, v248
    v_cmp_gt_u32 vcc, 142, v246
    v_mov_b32 v247, 8
    s_nop 0
    v_cndmask_b32 v244, v244, v246, vcc
    v_cndmask_b32 v245, v245, v247, vcc
    v_sub_u32 v244, 2047, v244
    v_mul_u32_u24 v244, 36864, v244
    v_lshl_add_u32 v244, v245, 7, v244
    v_and_b32 v245, 31, v12
    v_mul_u32_u24 v245, 1152, v245
    v_add_u32 v249, v244, v245
    s_mov_b32 vcc_lo, 0xff00ff00
    s_mov_b32 vcc_hi, 0xff00ff00
    s_waitcnt vmcnt(0)
    v_readfirstlane_b32 s30, v0
    s_mov_b32 s31, 0
    s_sub_u32 s30, s30, s100
    s_cmp_eq_u32 s30, 27
    s_cbranch_scc0 M_pf_spin
M_pf_ok:
    s_lshr_b32 s30, s2, 3
    s_sub_u32 s31, s30, 11
    s_cselect_b32 s30, s30, s31
    s_mul_i32 s30, s30, 3072
    s_add_u32 s30, s30, s43
    s_add_u32 s30, s30, 33792
    v_lshlrev_b32 v244, 3, v11
    v_mov_b32 v0, v249
    buffer_load_dwordx4 v[92:95], v11, s[16:19], s43 offen offset:0 sc1
    buffer_load_dwordx4 v[96:99], v11, s[16:19], s43 offen offset:1024 sc1
    buffer_load_dwordx4 v[100:103], v11, s[16:19], s43 offen offset:2048 sc1
    s_mov_b32 exec_hi, 268435455
    buffer_load_dwordx4 v[104:107], v11, s[16:19], s43 offen offset:3072 sc1
    s_mov_b32 exec_hi, -1
    s_add_u32 s43, s43, 4096
    buffer_load_dwordx4 v[48:51], v11, s[16:19], s43 offen offset:0 sc1
    buffer_load_dword v52, v11, s[16:19], s43 offen offset:1024 sc1
    buffer_load_dwordx4 v[12:15], v11, s[16:19], s43 offen offset:2048 sc1
    buffer_load_dwordx4 a[0:3], v11, s[16:19], s43 offen offset:3072 sc1
    s_add_u32 s43, s43, 4096
    buffer_load_dwordx4 a[4:7], v11, s[16:19], s43 offen offset:0 sc1
    buffer_load_dwordx4 a[8:11], v11, s[16:19], s43 offen offset:1024 sc1
    buffer_load_dwordx4 a[12:15], v11, s[16:19], s43 offen offset:2048 sc1
    buffer_load_dwordx4 a[16:19], v11, s[16:19], s43 offen offset:3072 sc1
    s_add_u32 s43, s43, 4096
    s_bfm_b64 exec, 24, 0
    buffer_load_dword v244, v244, s[16:19], s30 offen sc1
    s_mov_b64 exec, -1
    buffer_load_dwordx4 a[20:23], v11, s[16:19], s43 offen offset:0 sc1
    buffer_load_dwordx4 a[24:27], v11, s[16:19], s43 offen offset:1024 sc1
    buffer_load_dwordx4 a[28:31], v11, s[16:19], s43 offen offset:2048 sc1
    buffer_load_dwordx4 a[32:35], v11, s[16:19], s43 offen offset:3072 sc1
    s_add_u32 s43, s43, 4096
    buffer_load_dwordx4 v[16:19], v11, s[16:19], s43 offen offset:0 sc1
    buffer_load_dwordx4 a[36:39], v11, s[16:19], s43 offen offset:1024 sc1
    buffer_load_dwordx4 a[40:43], v11, s[16:19], s43 offen offset:2048 sc1
    buffer_load_dwordx4 a[44:47], v11, s[16:19], s43 offen offset:3072 sc1
    s_add_u32 s43, s43, 4096
    buffer_load_dwordx4 a[48:51], v11, s[16:19], s43 offen offset:0 sc1
    buffer_load_dwordx4 a[52:55], v11, s[16:19], s43 offen offset:1024 sc1
    buffer_load_dwordx4 a[56:59], v11, s[16:19], s43 offen offset:2048 sc1
    buffer_load_dwordx4 a[60:63], v11, s[16:19], s43 offen offset:3072 sc1
    s_add_u32 s43, s43, 4096
    buffer_load_dwordx4 a[64:67], v11, s[16:19], s43 offen offset:0 sc1
    buffer_load_dwordx4 a[68:71], v11, s[16:19], s43 offen offset:1024 sc1
    buffer_load_dwordx4 v[20:23], v11, s[16:19], s43 offen offset:2048 sc1
    buffer_load_dwordx4 a[72:75], v11, s[16:19], s43 offen offset:3072 sc1
    s_add_u32 s43, s43, 4096
    buffer_load_dwordx4 a[76:79], v11, s[16:19], s43 offen offset:0 sc1
    buffer_load_dwordx4 a[80:83], v11, s[16:19], s43 offen offset:1024 sc1
    buffer_load_dwordx4 a[84:87], v11, s[16:19], s43 offen offset:2048 sc1
    buffer_load_dwordx4 a[88:91], v11, s[16:19], s43 offen offset:3072 sc1
    s_add_u32 s43, s43, 4096
    buffer_load_dwordx4 a[92:95], v11, s[16:19], s43 offen offset:0 sc1
    buffer_load_dwordx4 a[96:99], v11, s[16:19], s43 offen offset:1024 sc1
    buffer_load_dwordx4 a[100:103], v11, s[16:19], s43 offen offset:2048 sc1
    buffer_load_dwordx4 a[104:107], v11, s[16:19], s43 offen offset:3072 sc1
    s_add_u32 s43, s43, 4096
    buffer_load_dwordx4 v[24:27], v11, s[16:19], s43 offen offset:0 sc1
    buffer_load_dwordx4 a[108:111], v11, s[16:19], s43 offen offset:1024 sc1
    ds_read_b128 v[160:163], v9 offset:10240
    ds_read_b128 v[164:167], v9 offset:10304
    ds_read_b128 v[168:171], v9 offset:10368
    ds_read_b128 v[172:175], v9 offset:10432
    ds_read_b128 v[176:179], v9 offset:10496
    ds_read_b128 v[180:183], v9 offset:10560
    ds_read_b128 v[184:187], v9 offset:10624
    ds_read_b128 v[188:191], v9 offset:10688
    ds_read_b128 v[192:195], v9 offset:10752
    s_waitcnt vmcnt(31)
    s_barrier
    ds_read_b128 v[196:199], v1 offset:0
    ds_read_b128 v[200:203], v2 offset:0
    ds_read_b128 v[228:231], v1 offset:18432
    ds_read_b128 v[232:235], v2 offset:18432
    s_waitcnt lgkmcnt(2)
    v_smfmac_f32_16x16x64_bf16 v[124:127], a[0:3], v[196:203], v12
    buffer_load_dwordx4 a[112:115], v11, s[16:19], s43 offen offset:2048 sc1
    s_waitcnt lgkmcnt(0)
    v_mov_b32 v118, s54
    v_smfmac_f32_16x16x64_bf16 v[160:163], a[0:3], v[228:235], v12
    ds_read_b128 v[204:207], v1 offset:1024
    ds_read_b128 v[208:211], v2 offset:1024
    v_or3_b32 v114, v92, v96, v100
    v_or_b32 v114, v114, v104
    v_cmp_gt_i32 s[32:33], 0, v114
    v_cmp_gt_u32 s[36:37], 2.0, v92
    s_nop 1
    v_mbcnt_lo_u32_b32 v110, s36, 0
    s_waitcnt vmcnt(31)
    v_mbcnt_hi_u32_b32 v110, s37, v110
    v_smfmac_f32_16x16x64_bf16 v[128:131], a[4:7], v[196:203], v12 abid:1
    buffer_load_dwordx4 a[116:119], v11, s[16:19], s43 offen offset:3072 sc1
    v_lshl_add_u32 v110, v110, 3, s38
    v_smfmac_f32_16x16x64_bf16 v[164:167], a[4:7], v[228:235], v12 abid:1
    ds_read_b128 v[220:223], v1 offset:19456
    ds_read_b128 v[224:227], v2 offset:19456
    v_min_u32 v110, s39, v110
    s_waitcnt vmcnt(31)
    v_cndmask_b32 v110, v118, v110, s[36:37]
    v_smfmac_f32_16x16x64_bf16 v[132:135], a[8:11], v[196:203], v13
    s_add_u32 s43, s43, 4096
    buffer_load_dwordx4 a[120:123], v11, s[16:19], s43 offen offset:0 sc1
    ds_write_b64 v110, v[92:93]
    s_bcnt1_i32_b64 s30, s[36:37]
    s_lshl3_add_u32 s38, s30, s38
    v_cmp_gt_u32 s[44:45], 2.0, v94
    v_smfmac_f32_16x16x64_bf16 v[168:171], a[8:11], v[228:235], v13
    s_nop 0
    v_mbcnt_lo_u32_b32 v111, s44, 0
    v_mbcnt_hi_u32_b32 v111, s45, v111
    v_lshl_add_u32 v111, v111, 3, s38
    v_min_u32 v111, s39, v111
    s_waitcnt vmcnt(31)
    v_cndmask_b32 v111, v118, v111, s[44:45]
    v_smfmac_f32_16x16x64_bf16 v[136:139], a[12:15], v[196:203], v13 abid:1
    buffer_load_dwordx4 a[124:127], v11, s[16:19], s43 offen offset:1024 sc1
    ds_write_b64 v111, v[94:95]
    s_bcnt1_i32_b64 s30, s[44:45]
    s_lshl3_add_u32 s38, s30, s38
    v_cmp_gt_u32 s[36:37], 2.0, v96
    v_smfmac_f32_16x16x64_bf16 v[172:175], a[12:15], v[228:235], v13 abid:1
    s_nop 0
    v_mbcnt_lo_u32_b32 v110, s36, 0
    v_mbcnt_hi_u32_b32 v110, s37, v110
    v_lshl_add_u32 v110, v110, 3, s38
    s_waitcnt vmcnt(31)
    v_min_u32 v110, s39, v110
    v_smfmac_f32_16x16x64_bf16 v[140:143], a[16:19], v[196:203], v14
    buffer_load_dwordx4 a[128:131], v11, s[16:19], s43 offen offset:2048 sc1
    v_cndmask_b32 v110, v118, v110, s[36:37]
    v_smfmac_f32_16x16x64_bf16 v[176:179], a[16:19], v[228:235], v14
    ds_write_b64 v110, v[96:97]
    s_bcnt1_i32_b64 s30, s[36:37]
    s_lshl3_add_u32 s38, s30, s38
    v_cmp_gt_u32 s[44:45], 2.0, v98
    s_nop 1
    v_mbcnt_lo_u32_b32 v111, s44, 0
    s_waitcnt vmcnt(30)
    v_mbcnt_hi_u32_b32 v111, s45, v111
    v_smfmac_f32_16x16x64_bf16 v[144:147], a[20:23], v[196:203], v14 abid:1
    buffer_load_dwordx4 a[132:135], v11, s[16:19], s43 offen offset:3072 sc1
    v_lshl_add_u32 v111, v111, 3, s38
    v_smfmac_f32_16x16x64_bf16 v[180:183], a[20:23], v[228:235], v14 abid:1
    v_min_u32 v111, s39, v111
    s_waitcnt vmcnt(30)
    v_cndmask_b32 v111, v118, v111, s[44:45]
    v_smfmac_f32_16x16x64_bf16 v[148:151], a[24:27], v[196:203], v15
    s_add_u32 s43, s43, 4096
    buffer_load_dwordx4 a[136:139], v11, s[16:19], s43 offen offset:0 sc1
    ds_write_b64 v111, v[98:99]
    s_bcnt1_i32_b64 s30, s[44:45]
    s_lshl3_add_u32 s38, s30, s38
    v_cmp_gt_u32 s[36:37], 2.0, v100
    v_smfmac_f32_16x16x64_bf16 v[184:187], a[24:27], v[228:235], v15
    s_nop 0
    v_mbcnt_lo_u32_b32 v110, s36, 0
    v_mbcnt_hi_u32_b32 v110, s37, v110
    v_lshl_add_u32 v110, v110, 3, s38
    v_min_u32 v110, s39, v110
    s_waitcnt vmcnt(30)
    v_cndmask_b32 v110, v118, v110, s[36:37]
    v_smfmac_f32_16x16x64_bf16 v[152:155], a[28:31], v[196:203], v15 abid:1
    buffer_load_dwordx4 a[140:143], v11, s[16:19], s43 offen offset:1024 sc1
    ds_write_b64 v110, v[100:101]
    s_bcnt1_i32_b64 s30, s[36:37]
    s_lshl3_add_u32 s38, s30, s38
    v_cmp_gt_u32 s[44:45], 2.0, v102
    v_smfmac_f32_16x16x64_bf16 v[188:191], a[28:31], v[228:235], v15 abid:1
    s_nop 0
    v_mbcnt_lo_u32_b32 v111, s44, 0
    v_mbcnt_hi_u32_b32 v111, s45, v111
    v_lshl_add_u32 v111, v111, 3, s38
    s_waitcnt vmcnt(30)
    v_min_u32 v111, s39, v111
    v_smfmac_f32_16x16x64_bf16 v[156:159], a[32:35], v[196:203], v48
    buffer_load_dwordx4 v[28:31], v11, s[16:19], s43 offen offset:2048 sc1
    buffer_load_dwordx4 a[144:147], v11, s[16:19], s43 offen offset:3072 sc1
    v_cndmask_b32 v111, v118, v111, s[44:45]
    v_smfmac_f32_16x16x64_bf16 v[192:195], a[32:35], v[228:235], v48
    ds_write_b64 v111, v[102:103]
    s_bcnt1_i32_b64 s30, s[44:45]
    s_lshl3_add_u32 s38, s30, s38
    v_cmp_gt_u32 s[36:37], 2.0, v104
    s_nop 1
    s_waitcnt vmcnt(30)
    s_waitcnt lgkmcnt(8)
    v_mbcnt_lo_u32_b32 v110, s36, 0
    v_smfmac_f32_16x16x64_bf16 v[124:127], a[36:39], v[204:211], v16
    s_add_u32 s43, s43, 4096
    buffer_load_dwordx4 a[148:151], v11, s[16:19], s43 offen offset:0 sc1
    s_waitcnt lgkmcnt(6)
    v_mbcnt_hi_u32_b32 v110, s37, v110
    v_smfmac_f32_16x16x64_bf16 v[160:163], a[36:39], v[220:227], v16
    ds_read_b128 v[196:199], v1 offset:2048
    ds_read_b128 v[200:203], v2 offset:2048
    v_lshl_add_u32 v110, v110, 3, s38
    v_min_u32 v110, s39, v110
    s_waitcnt vmcnt(30)
    v_cndmask_b32 v110, v118, v110, s[36:37]
    v_smfmac_f32_16x16x64_bf16 v[128:131], a[40:43], v[204:211], v16 abid:1
    buffer_load_dwordx4 a[152:155], v11, s[16:19], s43 offen offset:1024 sc1
    ds_write_b64 v110, v[104:105]
    s_bcnt1_i32_b64 s30, s[36:37]
    s_lshl3_add_u32 s38, s30, s38
    v_cmp_gt_u32 s[44:45], 2.0, v106
    v_smfmac_f32_16x16x64_bf16 v[164:167], a[40:43], v[220:227], v16 abid:1
    ds_read_b128 v[228:231], v1 offset:20480
    ds_read_b128 v[232:235], v2 offset:20480
    v_mbcnt_lo_u32_b32 v111, s44, 0
    v_mbcnt_hi_u32_b32 v111, s45, v111
    v_lshl_add_u32 v111, v111, 3, s38
    v_min_u32 v111, s39, v111
    s_waitcnt vmcnt(30)
    v_cndmask_b32 v111, v118, v111, s[44:45]
    v_smfmac_f32_16x16x64_bf16 v[132:135], a[44:47], v[204:211], v17
    buffer_load_dwordx4 a[156:159], v11, s[16:19], s43 offen offset:2048 sc1
    ds_write_b64 v111, v[106:107]
    s_bcnt1_i32_b64 s30, s[44:45]
    s_lshl3_add_u32 s38, s30, s38
    ds_read_b64 v[92:93], v55 offset:0
    ds_read_b64 v[94:95], v55 offset:512
    ds_read_b64 v[96:97], v55 offset:1024
    v_smfmac_f32_16x16x64_bf16 v[168:171], a[44:47], v[220:227], v17
    s_waitcnt vmcnt(30)
    v_smfmac_f32_16x16x64_bf16 v[136:139], a[48:51], v[204:211], v17 abid:1
    buffer_load_dwordx4 a[160:163], v11, s[16:19], s43 offen offset:3072 sc1
    v_smfmac_f32_16x16x64_bf16 v[172:175], a[48:51], v[220:227], v17 abid:1
    s_waitcnt vmcnt(30)
    v_smfmac_f32_16x16x64_bf16 v[140:143], a[52:55], v[204:211], v18
    s_add_u32 s43, s43, 4096
    buffer_load_dwordx4 a[164:167], v11, s[16:19], s43 offen offset:0 sc1
    s_waitcnt lgkmcnt(2)
    v_bfe_u32 v110, v92, 24, 4
    v_smfmac_f32_16x16x64_bf16 v[176:179], a[52:55], v[220:227], v18
    v_lshlrev_b32 v111, 1, v92
    v_lshl_add_u32 v110, v110, 2, s49
    v_and_b32 v111, 16, v111
    s_waitcnt vmcnt(30)
    v_and_or_b32 v110, v92, 2.0, v110
    v_smfmac_f32_16x16x64_bf16 v[144:147], a[56:59], v[204:211], v18 abid:1
    buffer_load_dwordx4 a[168:171], v11, s[16:19], s43 offen offset:1024 sc1
    v_lshlrev_b32 v111, v111, 1
    v_smfmac_f32_16x16x64_bf16 v[180:183], a[56:59], v[220:227], v18 abid:1
    ds_add_rtn_u32 v98, v110, v111
    s_waitcnt lgkmcnt(2)
    v_bfe_u32 v112, v94, 24, 4
    v_lshlrev_b32 v113, 1, v94
    v_lshl_add_u32 v112, v112, 2, s49
    s_waitcnt vmcnt(30)
    v_and_b32 v113, 16, v113
    v_smfmac_f32_16x16x64_bf16 v[148:151], a[60:63], v[204:211], v19
    buffer_load_dwordx4 a[172:175], v11, s[16:19], s43 offen offset:2048 sc1
    v_and_or_b32 v112, v94, 2.0, v112
    v_smfmac_f32_16x16x64_bf16 v[184:187], a[60:63], v[220:227], v19
    s_waitcnt vmcnt(30)
    v_lshlrev_b32 v113, v113, 1
    v_smfmac_f32_16x16x64_bf16 v[152:155], a[64:67], v[204:211], v19 abid:1
    buffer_load_dwordx4 a[176:179], v11, s[16:19], s43 offen offset:3072 sc1
    ds_add_rtn_u32 v99, v112, v113
    s_waitcnt lgkmcnt(2)
    s_cmp_gt_u32 s38, s35
    s_cbranch_scc1 M_r3
M_r3r:
    ds_read_b32 v117, v121
    v_and_b32 v110, 8, v92
    v_smfmac_f32_16x16x64_bf16 v[188:191], a[64:67], v[220:227], v19 abid:1
    v_lshrrev_b32 v113, 14, v92
    v_cmp_ne_u32 s[44:45], 0, v110
    v_and_b32 v116, 0x3cf0, v113
    s_waitcnt lgkmcnt(2)
    v_lshrrev_b32 v111, 16, v98
    v_and_b32 v112, 0xffff, v98
    s_waitcnt vmcnt(30)
    v_sub_u32 v110, 15, v111
    v_smfmac_f32_16x16x64_bf16 v[156:159], a[68:71], v[204:211], v48 abid:1
    s_add_u32 s43, s43, 4096
    buffer_load_dwordx4 v[32:35], v11, s[16:19], s43 offen offset:0 sc1
    buffer_load_dwordx4 a[180:183], v11, s[16:19], s43 offen offset:1024 sc1
    v_and_b32 v98, 2.0, v92
    v_smfmac_f32_16x16x64_bf16 v[192:195], a[68:71], v[220:227], v48 abid:1
    v_add3_u32 v98, v112, v111, v98
    v_cndmask_b32 v110, v112, v110, s[44:45]
    v_cmp_gt_u32 s[44:45], 16, v98
    v_cmp_gt_u32 s[36:37], 2.0, v98
    v_lshlrev_b32 v110, 2, v110
    s_waitcnt vmcnt(30)
    v_lshrrev_b64 v[112:113], v110, s[50:51]
    v_smfmac_f32_16x16x64_bf16 v[124:127], a[72:75], v[196:203], v20
    buffer_load_dwordx4 a[184:187], v11, s[16:19], s43 offen offset:2048 sc1
    s_andn2_b64 s[36:37], s[36:37], s[44:45]
    v_lshrrev_b64 v[114:115], v110, s[52:53]
    v_smfmac_f32_16x16x64_bf16 v[160:163], a[72:75], v[228:235], v20
    ds_read_b128 v[204:207], v1 offset:3072
    ds_read_b128 v[208:211], v2 offset:3072
    v_bfe_u32 v110, v92, 24, 4
    v_mbcnt_lo_u32_b32 v111, s36, 0
    v_and_b32 v112, 15, v112
    v_mbcnt_hi_u32_b32 v111, s37, v111
    v_and_b32 v114, 15, v114
    s_waitcnt vmcnt(30)
    v_lshl_add_u32 v111, v111, 3, s40
    v_smfmac_f32_16x16x64_bf16 v[128:131], a[76:79], v[196:203], v20 abid:1
    buffer_load_dwordx4 a[188:191], v11, s[16:19], s43 offen offset:3072 sc1
    v_lshl_add_u32 v112, v110, 4, v112
    v_smfmac_f32_16x16x64_bf16 v[164:167], a[76:79], v[228:235], v20 abid:1
    ds_read_b128 v[220:223], v1 offset:21504
    ds_read_b128 v[224:227], v2 offset:21504
    v_min_u32 v111, s41, v111
    v_mul_u32_u24 v114, 68, v114
    s_waitcnt vmcnt(30)
    v_cndmask_b32 v111, v118, v111, s[36:37]
    v_smfmac_f32_16x16x64_bf16 v[132:135], a[80:83], v[196:203], v21
    s_add_u32 s43, s43, 4096
    buffer_load_dwordx4 a[192:195], v11, s[16:19], s43 offen offset:0 sc1
    ds_write_b64 v111, v[92:93]
    s_bcnt1_i32_b64 s30, s[36:37]
    s_lshl3_add_u32 s40, s30, s40
    v_lshl_add_u32 v112, v112, 2, s47
    v_smfmac_f32_16x16x64_bf16 v[168:171], a[80:83], v[228:235], v21
    v_and_b32 v114, 0x30c, v114
    v_cndmask_b32 v112, v118, v112, s[44:45]
    v_add3_u32 v113, v116, v114, s29
    v_and_b32 v114, 0x3fff, v92
    s_waitcnt vmcnt(30)
    v_cndmask_b32 v110, v118, v113, s[44:45]
    v_smfmac_f32_16x16x64_bf16 v[136:139], a[84:87], v[196:203], v21 abid:1
    buffer_load_dwordx4 a[196:199], v11, s[16:19], s43 offen offset:1024 sc1
    ds_write_b32 v112, v114
    ds_write_b32 v110, v93
    v_and_b32 v110, 8, v94
    v_smfmac_f32_16x16x64_bf16 v[172:175], a[84:87], v[228:235], v21 abid:1
    v_lshrrev_b32 v113, 14, v94
    v_cmp_ne_u32 s[44:45], 0, v110
    v_and_b32 v116, 0x3cf0, v113
    s_waitcnt lgkmcnt(8)
    s_waitcnt vmcnt(30)
    v_lshrrev_b32 v111, 16, v99
    v_smfmac_f32_16x16x64_bf16 v[140:143], a[88:91], v[196:203], v22
    buffer_load_dwordx4 a[200:203], v11, s[16:19], s43 offen offset:2048 sc1
    v_and_b32 v112, 0xffff, v99
    v_smfmac_f32_16x16x64_bf16 v[176:179], a[88:91], v[228:235], v22
    v_sub_u32 v110, 15, v111
    v_and_b32 v99, 2.0, v94
    v_add3_u32 v99, v112, v111, v99
    v_cndmask_b32 v110, v112, v110, s[44:45]
    s_waitcnt vmcnt(30)
    v_cmp_gt_u32 s[44:45], 16, v99
    v_smfmac_f32_16x16x64_bf16 v[144:147], a[92:95], v[196:203], v22 abid:1
    buffer_load_dwordx4 a[204:207], v11, s[16:19], s43 offen offset:3072 sc1
    v_cmp_gt_u32 s[36:37], 2.0, v99
    v_smfmac_f32_16x16x64_bf16 v[180:183], a[92:95], v[228:235], v22 abid:1
    v_lshlrev_b32 v110, 2, v110
    s_waitcnt vmcnt(30)
    v_lshrrev_b64 v[112:113], v110, s[50:51]
    v_smfmac_f32_16x16x64_bf16 v[148:151], a[96:99], v[196:203], v23
    s_add_u32 s43, s43, 4096
    buffer_load_dwordx4 a[208:211], v11, s[16:19], s43 offen offset:0 sc1
    s_andn2_b64 s[36:37], s[36:37], s[44:45]
    v_lshrrev_b64 v[114:115], v110, s[52:53]
    v_smfmac_f32_16x16x64_bf16 v[184:187], a[96:99], v[228:235], v23
    v_bfe_u32 v110, v94, 24, 4
    v_mbcnt_lo_u32_b32 v111, s36, 0
    v_and_b32 v112, 15, v112
    v_mbcnt_hi_u32_b32 v111, s37, v111
    v_and_b32 v114, 15, v114
    s_waitcnt vmcnt(30)
    v_lshl_add_u32 v111, v111, 3, s40
    v_smfmac_f32_16x16x64_bf16 v[152:155], a[100:103], v[196:203], v23 abid:1
    buffer_load_dwordx4 a[212:215], v11, s[16:19], s43 offen offset:1024 sc1
    v_lshl_add_u32 v112, v110, 4, v112
    v_smfmac_f32_16x16x64_bf16 v[188:191], a[100:103], v[228:235], v23 abid:1
    v_min_u32 v111, s41, v111
    v_mul_u32_u24 v114, 68, v114
    s_waitcnt vmcnt(30)
    v_cndmask_b32 v111, v118, v111, s[36:37]
    v_smfmac_f32_16x16x64_bf16 v[156:159], a[104:107], v[196:203], v49
    buffer_load_dwordx4 v[36:39], v11, s[16:19], s43 offen offset:2048 sc1
    buffer_load_dwordx4 a[216:219], v11, s[16:19], s43 offen offset:3072 sc1
    ds_write_b64 v111, v[94:95]
    s_bcnt1_i32_b64 s30, s[36:37]
    s_lshl3_add_u32 s40, s30, s40
    v_lshl_add_u32 v112, v112, 2, s47
    v_smfmac_f32_16x16x64_bf16 v[192:195], a[104:107], v[228:235], v49
    v_and_b32 v114, 0x30c, v114
    v_cndmask_b32 v112, v118, v112, s[44:45]
    v_add3_u32 v113, v116, v114, s29
    v_and_b32 v114, 0x3fff, v94
    s_waitcnt vmcnt(30)
    s_waitcnt lgkmcnt(6)
    v_cndmask_b32 v110, v118, v113, s[44:45]
    v_smfmac_f32_16x16x64_bf16 v[124:127], a[108:111], v[204:211], v24
    s_add_u32 s43, s43, 4096
    buffer_load_dwordx4 a[220:223], v11, s[16:19], s43 offen offset:0 sc1
    ds_write_b32 v112, v114
    ds_write_b32 v110, v95
    s_waitcnt lgkmcnt(6)
    v_lshrrev_b32 v110, 16, v117
    v_smfmac_f32_16x16x64_bf16 v[160:163], a[108:111], v[220:227], v24
    ds_read_b128 v[196:199], v1 offset:4096
    ds_read_b128 v[200:203], v2 offset:4096
    v_and_b32 v117, 0xffff, v117
    v_add_u32 v117, v117, v110
    s_waitcnt vmcnt(30)
    v_cmp_lt_u32 s[34:35], 16, v117
    v_smfmac_f32_16x16x64_bf16 v[128:131], a[112:115], v[204:211], v24 abid:1
    buffer_load_dwordx4 a[224:227], v11, s[16:19], s43 offen offset:1024 sc1
    s_sub_u32 s46, s40, s48
    s_add_u32 s46, s46, 56
    s_lshr_b32 s46, s46, 6
    s_mov_b32 s21, 0
    s_and_b32 s27, s34, 0x1ff
    s_cmp_gt_u32 s46, 4
    s_cselect_b32 s32, 1, s32
    s_or_b32 s32, s32, s33
    s_cbranch_scc1 M_dn
M_dnr:
    ds_read_b128 v[92:95], v9 offset:9792
    s_bcnt1_i32_b32 s30, s27
    s_cmp_gt_u32 s30, 3
    s_cselect_b32 s34, 0, s27
    s_cselect_b32 s80, 0, 1
    s_getpc_b64 s[36:37]
M_pc:
    v_bfe_u32 v110, v11, 4, 4
    v_smfmac_f32_16x16x64_bf16 v[164:167], a[112:115], v[220:227], v24 abid:1
    ds_read_b128 v[228:231], v1 offset:22528
    ds_read_b128 v[232:235], v2 offset:22528
    s_waitcnt vmcnt(30)
    v_smfmac_f32_16x16x64_bf16 v[132:135], a[116:119], v[204:211], v25
    buffer_load_dwordx4 a[228:231], v11, s[16:19], s43 offen offset:2048 sc1
    s_ff1_i32_b32 s81, s34
    s_bitset0_b32 s34, s81
    s_mul_i32 s30, s81, 20
    s_add_u32 s31, s30, M_ovc0-M_pc
    s_add_u32 s30, s30, M_ovl0-M_pc
    s_cmp_lg_u32 s34, 0
    s_cselect_b32 s30, s31, s30
    s_cmp_lt_i32 s81, 0
    s_cselect_b32 s30, M_ovn-M_pc, s30
    s_add_u32 s72, s36, s30
    s_addc_u32 s73, s37, 0
    s_ff1_i32_b32 s82, s34
    s_bitset0_b32 s34, s82
    s_mul_i32 s30, s82, 20
    s_add_u32 s31, s30, M_ovc1-M_pc
    s_add_u32 s30, s30, M_ovl1-M_pc
    s_cmp_lg_u32 s34, 0
    s_cselect_b32 s30, s31, s30
    s_cmp_lt_i32 s82, 0
    s_cselect_b32 s30, M_ovn-M_pc, s30
    v_smfmac_f32_16x16x64_bf16 v[168:171], a[116:119], v[220:227], v25
    s_waitcnt vmcnt(30)
    v_smfmac_f32_16x16x64_bf16 v[136:139], a[120:123], v[204:211], v25 abid:1
    buffer_load_dwordx4 a[232:235], v11, s[16:19], s43 offen offset:3072 sc1
    s_add_u32 s74, s36, s30
    s_addc_u32 s75, s37, 0
    s_ff1_i32_b32 s83, s34
    s_bitset0_b32 s34, s83
    s_mul_i32 s30, s83, 20
    s_add_u32 s31, s30, M_ovc1-M_pc
    s_add_u32 s30, s30, M_ovl2-M_pc
    s_cmp_lg_u32 s34, 0
    s_cselect_b32 s30, s31, s30
    s_cmp_lt_i32 s83, 0
    s_cselect_b32 s30, M_ovn-M_pc, s30
    s_add_u32 s76, s36, s30
    s_addc_u32 s77, s37, 0
    s_waitcnt lgkmcnt(2)
    v_lshrrev_b32 v112, 18, v92
    v_smfmac_f32_16x16x64_bf16 v[172:175], a[120:123], v[220:227], v25 abid:1
    s_waitcnt vmcnt(30)
    v_lshrrev_b32 v113, 18, v94
    v_smfmac_f32_16x16x64_bf16 v[140:143], a[124:127], v[204:211], v26
    s_add_u32 s43, s43, 4096
    buffer_load_dwordx4 a[236:239], v11, s[16:19], s43 offen offset:0 sc1
    v_and_b32 v114, 0x3fff, v92
    v_smfmac_f32_16x16x64_bf16 v[176:179], a[124:127], v[220:227], v26
    s_waitcnt vmcnt(30)
    v_and_b32 v115, 0x3fff, v94
    v_smfmac_f32_16x16x64_bf16 v[144:147], a[128:131], v[204:211], v26 abid:1
    buffer_load_dwordx4 a[240:243], v11, s[16:19], s43 offen offset:1024 sc1
    ds_write_b64 v9, v[114:115] offset:10056
    v_lshl_or_b32 v111, s81, 6, v110
    v_smfmac_f32_16x16x64_bf16 v[180:183], a[128:131], v[220:227], v26 abid:1
    v_cmp_eq_u32 s[44:45], v112, v111
    v_cmp_eq_u32 s[36:37], v113, v111
    s_nop 0
    v_cndmask_b32 v54, 0, v93, s[44:45]
    v_cndmask_b32 v55, 0, v95, s[36:37]
    v_lshl_or_b32 v111, s82, 6, v110
    s_waitcnt vmcnt(30)
    v_cmp_eq_u32 s[44:45], v112, v111
    v_smfmac_f32_16x16x64_bf16 v[148:151], a[132:135], v[204:211], v27
    buffer_load_dwordx4 a[244:247], v11, s[16:19], s43 offen offset:2048 sc1
    v_cmp_eq_u32 s[36:37], v113, v111
    v_smfmac_f32_16x16x64_bf16 v[184:187], a[132:135], v[220:227], v27
    v_cndmask_b32 v252, 0, v93, s[44:45]
    v_cndmask_b32 v253, 0, v95, s[36:37]
    v_lshl_or_b32 v111, s83, 6, v110
    v_cmp_eq_u32 s[44:45], v112, v111
    v_cmp_eq_u32 s[36:37], v113, v111
    s_nop 0
    s_waitcnt vmcnt(30)
    v_cndmask_b32 v254, 0, v93, s[44:45]
    v_smfmac_f32_16x16x64_bf16 v[152:155], a[136:139], v[204:211], v27 abid:1
    buffer_load_dwordx4 a[248:251], v11, s[16:19], s43 offen offset:3072 sc1
    v_cndmask_b32 v255, 0, v95, s[36:37]
    v_smfmac_f32_16x16x64_bf16 v[188:191], a[136:139], v[220:227], v27 abid:1
    ds_read_b128 v[236:239], v9 offset:9408
    ds_read_b64 v[216:217], v9 offset:10056
    s_waitcnt vmcnt(30)
    v_smfmac_f32_16x16x64_bf16 v[156:159], a[140:143], v[204:211], v49 abid:1
    s_add_u32 s43, s43, 4096
    buffer_load_dwordx4 v[40:43], v11, s[16:19], s43 offen offset:0 sc1
    buffer_load_dwordx4 a[252:255], v11, s[16:19], s43 offen offset:1024 sc1
    s_waitcnt lgkmcnt(1)
    v_xad_u32 v236, v236, v3, v4
    v_smfmac_f32_16x16x64_bf16 v[192:195], a[140:143], v[220:227], v49 abid:1
    s_waitcnt vmcnt(30)
    v_xad_u32 v237, v237, v3, v4
    v_smfmac_f32_16x16x64_bf16 v[124:127], a[144:147], v[196:203], v28
    buffer_load_dwordx4 v[56:59], v11, s[16:19], s43 offen offset:2048 sc1
    ds_read2st64_b32 v[244:245], v236 offset0:0 offset1:72
    ds_read2st64_b32 v[246:247], v237 offset0:0 offset1:72
    v_xad_u32 v238, v238, v3, v4
    v_smfmac_f32_16x16x64_bf16 v[160:163], a[144:147], v[228:235], v28
    ds_read_b128 v[204:207], v1 offset:5120
    ds_read_b128 v[208:211], v2 offset:5120
    s_waitcnt vmcnt(30)
    v_xad_u32 v239, v239, v3, v4
    v_smfmac_f32_16x16x64_bf16 v[128:131], a[148:151], v[196:203], v28 abid:1
    buffer_load_dwordx4 v[60:63], v11, s[16:19], s43 offen offset:3072 sc1
    ds_read2st64_b32 v[248:249], v238 offset0:0 offset1:72
    ds_read2st64_b32 v[250:251], v239 offset0:0 offset1:72
    ds_read_b128 v[240:243], v8 offset:3072
    ds_read_b128 v[236:239], v9 offset:9280
    s_waitcnt lgkmcnt(8)
    v_xad_u32 v212, v216, v3, v4
    v_smfmac_f32_16x16x64_bf16 v[164:167], a[148:151], v[228:235], v28 abid:1
    ds_read_b128 v[220:223], v1 offset:23552
    ds_read_b128 v[224:227], v2 offset:23552
    ds_read2st64_b32 v[212:213], v212 offset0:0 offset1:72
    s_waitcnt vmcnt(30)
    v_xad_u32 v214, v217, v3, v4
    v_smfmac_f32_16x16x64_bf16 v[132:135], a[152:155], v[196:203], v29
    s_add_u32 s43, s43, 4096
    buffer_load_dwordx4 v[64:67], v11, s[16:19], s43 offen offset:0 sc1
    ds_read2st64_b32 v[214:215], v214 offset0:0 offset1:72
    v_smfmac_f32_16x16x64_bf16 v[168:171], a[152:155], v[228:235], v29
    s_waitcnt vmcnt(30)
    v_smfmac_f32_16x16x64_bf16 v[136:139], a[156:159], v[196:203], v29 abid:1
    buffer_load_dwordx4 v[68:71], v11, s[16:19], s43 offen offset:1024 sc1
    v_smfmac_f32_16x16x64_bf16 v[172:175], a[156:159], v[228:235], v29 abid:1
    s_waitcnt vmcnt(30)
    v_smfmac_f32_16x16x64_bf16 v[140:143], a[160:163], v[196:203], v30
    buffer_load_dwordx4 v[72:75], v11, s[16:19], s43 offen offset:2048 sc1
    s_waitcnt lgkmcnt(5)
    v_smfmac_f32_16x16x64_bf16 v[136:139], v[240:243], v[244:251], v10
    v_smfmac_f32_16x16x64_bf16 v[172:175], v[240:243], v[244:251], v10 abid:1
    s_waitcnt lgkmcnt(4)
    v_xad_u32 v236, v236, v3, v4
    v_smfmac_f32_16x16x64_bf16 v[176:179], a[160:163], v[228:235], v30
    s_waitcnt vmcnt(30)
    v_xad_u32 v237, v237, v3, v4
    v_smfmac_f32_16x16x64_bf16 v[144:147], a[164:167], v[196:203], v30 abid:1
    buffer_load_dwordx4 v[76:79], v11, s[16:19], s43 offen offset:3072 sc1
    ds_read2st64_b32 v[244:245], v236 offset0:0 offset1:72
    ds_read2st64_b32 v[246:247], v237 offset0:0 offset1:72
    v_xad_u32 v238, v238, v3, v4
    v_smfmac_f32_16x16x64_bf16 v[180:183], a[164:167], v[228:235], v30 abid:1
    s_waitcnt vmcnt(30)
    v_xad_u32 v239, v239, v3, v4
    v_smfmac_f32_16x16x64_bf16 v[148:151], a[168:171], v[196:203], v31
    s_add_u32 s43, s43, 4096
    buffer_load_dwordx4 v[80:83], v11, s[16:19], s43 offen offset:0 sc1
    ds_read2st64_b32 v[248:249], v238 offset0:0 offset1:72
    ds_read2st64_b32 v[250:251], v239 offset0:0 offset1:72
    ds_read_b128 v[240:243], v8 offset:1024
    ds_read_b128 v[236:239], v9 offset:9344
    v_smfmac_f32_16x16x64_bf16 v[184:187], a[168:171], v[228:235], v31
    s_waitcnt vmcnt(30)
    v_smfmac_f32_16x16x64_bf16 v[152:155], a[172:175], v[196:203], v31 abid:1
    buffer_load_dwordx4 v[84:87], v11, s[16:19], s43 offen offset:1024 sc1
    s_waitcnt lgkmcnt(6)
    s_cmp_lt_i32 s81, 0
    s_cbranch_scc1 M_ovr0
    s_swappc_b64 s[78:79], s[72:73]
M_ovr0:
    v_smfmac_f32_16x16x64_bf16 v[188:191], a[172:175], v[228:235], v31 abid:1
    s_waitcnt vmcnt(30)
    v_smfmac_f32_16x16x64_bf16 v[156:159], a[176:179], v[196:203], v50
    buffer_load_dwordx4 v[44:47], v11, s[16:19], s43 offen offset:2048 sc1
    buffer_load_dwordx4 v[88:91], v11, s[16:19], s43 offen offset:3072 sc1
    v_smfmac_f32_16x16x64_bf16 v[192:195], a[176:179], v[228:235], v50
    s_waitcnt vmcnt(30)
    v_smfmac_f32_16x16x64_bf16 v[124:127], a[180:183], v[204:211], v32
    s_add_u32 s43, s43, 4096
    buffer_load_dwordx4 v[92:95], v11, s[16:19], s43 offen offset:0 sc1
    s_waitcnt lgkmcnt(1)
    v_smfmac_f32_16x16x64_bf16 v[128:131], v[240:243], v[244:251], v10
    v_smfmac_f32_16x16x64_bf16 v[164:167], v[240:243], v[244:251], v10 abid:1
    s_waitcnt lgkmcnt(0)
    v_xad_u32 v236, v236, v3, v4
    v_smfmac_f32_16x16x64_bf16 v[160:163], a[180:183], v[220:227], v32
    ds_read_b128 v[196:199], v1 offset:6144
    ds_read_b128 v[200:203], v2 offset:6144
    s_waitcnt vmcnt(30)
    v_xad_u32 v237, v237, v3, v4
    v_smfmac_f32_16x16x64_bf16 v[128:131], a[184:187], v[204:211], v32 abid:1
    buffer_load_dwordx4 v[96:99], v11, s[16:19], s43 offen offset:1024 sc1
    ds_read2st64_b32 v[244:245], v236 offset0:0 offset1:72
    ds_read2st64_b32 v[246:247], v237 offset0:0 offset1:72
    v_xad_u32 v238, v238, v3, v4
    v_smfmac_f32_16x16x64_bf16 v[164:167], a[184:187], v[220:227], v32 abid:1
    ds_read_b128 v[228:231], v1 offset:24576
    ds_read_b128 v[232:235], v2 offset:24576
    s_waitcnt vmcnt(30)
    v_xad_u32 v239, v239, v3, v4
    v_smfmac_f32_16x16x64_bf16 v[132:135], a[188:191], v[204:211], v33
    buffer_load_dwordx4 v[100:103], v11, s[16:19], s43 offen offset:2048 sc1
    ds_read2st64_b32 v[248:249], v238 offset0:0 offset1:72
    ds_read2st64_b32 v[250:251], v239 offset0:0 offset1:72
    ds_read_b128 v[240:243], v8 offset:2048
    ds_read_b128 v[236:239], v9 offset:9216
    v_smfmac_f32_16x16x64_bf16 v[168:171], a[188:191], v[220:227], v33
    s_waitcnt vmcnt(30)
    v_smfmac_f32_16x16x64_bf16 v[136:139], a[192:195], v[204:211], v33 abid:1
    buffer_load_dwordx4 v[104:107], v11, s[16:19], s43 offen offset:3072 sc1
    v_smfmac_f32_16x16x64_bf16 v[172:175], a[192:195], v[220:227], v33 abid:1
    s_waitcnt vmcnt(30)
    v_smfmac_f32_16x16x64_bf16 v[140:143], a[196:199], v[204:211], v34
    s_add_u32 s43, s43, 4096
    buffer_load_dwordx4 v[108:111], v11, s[16:19], s43 offen offset:0 sc1
    v_smfmac_f32_16x16x64_bf16 v[176:179], a[196:199], v[220:227], v34
    s_waitcnt vmcnt(30)
    v_smfmac_f32_16x16x64_bf16 v[144:147], a[200:203], v[204:211], v34 abid:1
    buffer_load_dwordx4 v[112:115], v11, s[16:19], s43 offen offset:1024 sc1
    s_waitcnt lgkmcnt(1)
    v_smfmac_f32_16x16x64_bf16 v[132:135], v[240:243], v[244:251], v10
    v_smfmac_f32_16x16x64_bf16 v[168:171], v[240:243], v[244:251], v10 abid:1
    s_waitcnt lgkmcnt(0)
    v_xad_u32 v236, v236, v3, v4
    v_smfmac_f32_16x16x64_bf16 v[180:183], a[200:203], v[220:227], v34 abid:1
    s_waitcnt vmcnt(30)
    v_xad_u32 v237, v237, v3, v4
    v_smfmac_f32_16x16x64_bf16 v[148:151], a[204:207], v[204:211], v35
    buffer_load_dwordx4 v[116:119], v11, s[16:19], s43 offen offset:2048 sc1
    ds_read2st64_b32 v[244:245], v236 offset0:0 offset1:72
    ds_read2st64_b32 v[246:247], v237 offset0:0 offset1:72
    v_xad_u32 v238, v238, v3, v4
    v_smfmac_f32_16x16x64_bf16 v[184:187], a[204:207], v[220:227], v35
    s_waitcnt vmcnt(30)
    v_xad_u32 v239, v239, v3, v4
    v_smfmac_f32_16x16x64_bf16 v[152:155], a[208:211], v[204:211], v35 abid:1
    buffer_load_dwordx4 v[120:123], v11, s[16:19], s43 offen offset:3072 sc1
    ds_read2st64_b32 v[248:249], v238 offset0:0 offset1:72
    ds_read2st64_b32 v[250:251], v239 offset0:0 offset1:72
    ds_read_b128 v[240:243], v8 offset:0
    ds_read_b128 v[236:239], v9 offset:9728
    v_smfmac_f32_16x16x64_bf16 v[188:191], a[208:211], v[220:227], v35 abid:1
    s_waitcnt vmcnt(30)
    v_smfmac_f32_16x16x64_bf16 v[156:159], a[212:215], v[204:211], v50 abid:1
    s_add_u32 m0, s29, 11840
    s_nop 0
    buffer_load_dword v0, s[8:11], 0 offen lds
    v_smfmac_f32_16x16x64_bf16 v[192:195], a[212:215], v[220:227], v50 abid:1
    s_waitcnt vmcnt(29)
    v_smfmac_f32_16x16x64_bf16 v[124:127], a[216:219], v[196:203], v36
    v_smfmac_f32_16x16x64_bf16 v[160:163], a[216:219], v[228:235], v36
    ds_read_b128 v[204:207], v1 offset:7168
    ds_read_b128 v[208:211], v2 offset:7168
    s_waitcnt vmcnt(28)
    v_smfmac_f32_16x16x64_bf16 v[128:131], a[220:223], v[196:203], v36 abid:1
    s_waitcnt lgkmcnt(3)
    v_smfmac_f32_16x16x64_bf16 v[124:127], v[240:243], v[244:251], v10
    v_smfmac_f32_16x16x64_bf16 v[160:163], v[240:243], v[244:251], v10 abid:1
    s_waitcnt lgkmcnt(2)
    v_xad_u32 v236, v236, v3, v4
    v_smfmac_f32_16x16x64_bf16 v[164:167], a[220:223], v[228:235], v36 abid:1
    ds_read_b128 v[220:223], v1 offset:25600
    ds_read_b128 v[224:227], v2 offset:25600
    s_waitcnt vmcnt(27)
    v_xad_u32 v237, v237, v3, v4
    v_smfmac_f32_16x16x64_bf16 v[132:135], a[224:227], v[196:203], v37
    ds_read2st64_b32 v[244:245], v236 offset0:0 offset1:72
    ds_read2st64_b32 v[246:247], v237 offset0:0 offset1:72
    v_xad_u32 v238, v238, v3, v4
    v_smfmac_f32_16x16x64_bf16 v[168:171], a[224:227], v[228:235], v37
    s_waitcnt vmcnt(26)
    v_xad_u32 v239, v239, v3, v4
    v_smfmac_f32_16x16x64_bf16 v[136:139], a[228:231], v[196:203], v37 abid:1
    ds_read2st64_b32 v[248:249], v238 offset0:0 offset1:72
    ds_read2st64_b32 v[250:251], v239 offset0:0 offset1:72
    ds_read_b128 v[240:243], v8 offset:8192
    ds_read_b128 v[236:239], v9 offset:9664
    v_smfmac_f32_16x16x64_bf16 v[172:175], a[228:231], v[228:235], v37 abid:1
    s_waitcnt vmcnt(25)
    v_smfmac_f32_16x16x64_bf16 v[140:143], a[232:235], v[196:203], v38
    v_smfmac_f32_16x16x64_bf16 v[176:179], a[232:235], v[228:235], v38
    s_waitcnt vmcnt(24)
    v_smfmac_f32_16x16x64_bf16 v[144:147], a[236:239], v[196:203], v38 abid:1
    v_smfmac_f32_16x16x64_bf16 v[180:183], a[236:239], v[228:235], v38 abid:1
    s_waitcnt vmcnt(23)
    v_smfmac_f32_16x16x64_bf16 v[148:151], a[240:243], v[196:203], v39
    s_mov_b32 m0, s42
    s_nop 0
    buffer_load_dwordx4 v5, s[8:11], s22 offen offset:0 nt lds
    s_waitcnt lgkmcnt(1)
    v_smfmac_f32_16x16x64_bf16 v[156:159], v[240:243], v[244:251], v10
    v_smfmac_f32_16x16x64_bf16 v[192:195], v[240:243], v[244:251], v10 abid:1
    s_waitcnt lgkmcnt(0)
    v_xad_u32 v236, v236, v3, v4
    v_smfmac_f32_16x16x64_bf16 v[184:187], a[240:243], v[228:235], v39
    s_waitcnt vmcnt(23)
    v_xad_u32 v237, v237, v3, v4
    v_smfmac_f32_16x16x64_bf16 v[152:155], a[244:247], v[196:203], v39 abid:1
    ds_read2st64_b32 v[244:245], v236 offset0:0 offset1:72
    ds_read2st64_b32 v[246:247], v237 offset0:0 offset1:72
    v_xad_u32 v238, v238, v3, v4
    v_smfmac_f32_16x16x64_bf16 v[188:191], a[244:247], v[228:235], v39 abid:1
    s_waitcnt vmcnt(22)
    v_xad_u32 v239, v239, v3, v4
    v_smfmac_f32_16x16x64_bf16 v[156:159], a[248:251], v[196:203], v51
    s_add_u32 m0, m0, 896
    s_nop 0
    buffer_load_dwordx4 v5, s[8:11], s22 offen offset:128 nt lds
    ds_read2st64_b32 v[248:249], v238 offset0:0 offset1:72
    ds_read2st64_b32 v[250:251], v239 offset0:0 offset1:72
    ds_read_b128 v[240:243], v8 offset:7168
    ds_read_b128 v[236:239], v9 offset:9536
    v_smfmac_f32_16x16x64_bf16 v[192:195], a[248:251], v[228:235], v51
    s_waitcnt vmcnt(21)
    v_smfmac_f32_16x16x64_bf16 v[124:127], a[252:255], v[204:211], v40
    ds_read_b128 v[196:199], v1 offset:8192
    ds_read_b128 v[200:203], v2 offset:8192
    s_waitcnt vmcnt(20)
    v_smfmac_f32_16x16x64_bf16 v[128:131], v[56:59], v[204:211], v40 abid:1
    s_add_u32 m0, m0, 896
    s_nop 0
    buffer_load_dwordx4 v5, s[8:11], s22 offen offset:256 nt lds
    ds_read_b128 v[228:231], v1 offset:26624
    ds_read_b128 v[232:235], v2 offset:26624
    s_waitcnt vmcnt(20)
    v_smfmac_f32_16x16x64_bf16 v[132:135], v[60:63], v[204:211], v41
    s_waitcnt lgkmcnt(5)
    v_smfmac_f32_16x16x64_bf16 v[152:155], v[240:243], v[244:251], v10
    v_smfmac_f32_16x16x64_bf16 v[188:191], v[240:243], v[244:251], v10 abid:1
    s_waitcnt lgkmcnt(4)
    v_xad_u32 v236, v236, v3, v4
    s_waitcnt vmcnt(19)
    v_xad_u32 v237, v237, v3, v4
    v_smfmac_f32_16x16x64_bf16 v[136:139], v[64:67], v[204:211], v41 abid:1
    s_add_u32 m0, m0, 896
    s_nop 0
    buffer_load_dwordx4 v5, s[8:11], s22 offen offset:384 nt lds
    ds_read2st64_b32 v[244:245], v236 offset0:0 offset1:72
    ds_read2st64_b32 v[246:247], v237 offset0:0 offset1:72
    v_xad_u32 v238, v238, v3, v4
    s_waitcnt vmcnt(19)
    v_xad_u32 v239, v239, v3, v4
    v_smfmac_f32_16x16x64_bf16 v[140:143], v[68:71], v[204:211], v42
    ds_read2st64_b32 v[248:249], v238 offset0:0 offset1:72
    ds_read2st64_b32 v[250:251], v239 offset0:0 offset1:72
    ds_read_b128 v[240:243], v8 offset:5120
    ds_read_b128 v[236:239], v9 offset:9600
    s_waitcnt vmcnt(18)
    v_smfmac_f32_16x16x64_bf16 v[144:147], v[72:75], v[204:211], v42 abid:1
    s_waitcnt vmcnt(17)
    v_smfmac_f32_16x16x64_bf16 v[148:151], v[76:79], v[204:211], v43
    s_waitcnt vmcnt(16)
    v_smfmac_f32_16x16x64_bf16 v[152:155], v[80:83], v[204:211], v43 abid:1
    s_waitcnt lgkmcnt(1)
    v_smfmac_f32_16x16x64_bf16 v[144:147], v[240:243], v[244:251], v10
    v_smfmac_f32_16x16x64_bf16 v[180:183], v[240:243], v[244:251], v10 abid:1
    s_waitcnt lgkmcnt(0)
    v_xad_u32 v236, v236, v3, v4
    s_waitcnt vmcnt(15)
    v_xad_u32 v237, v237, v3, v4
    v_smfmac_f32_16x16x64_bf16 v[156:159], v[84:87], v[204:211], v51 abid:1
    ds_read2st64_b32 v[244:245], v236 offset0:0 offset1:72
    ds_read2st64_b32 v[246:247], v237 offset0:0 offset1:72
    v_xad_u32 v238, v238, v3, v4
    s_waitcnt vmcnt(13)
    v_xad_u32 v239, v239, v3, v4
    v_smfmac_f32_16x16x64_bf16 v[124:127], v[88:91], v[196:203], v44
    ds_read2st64_b32 v[248:249], v238 offset0:0 offset1:72
    ds_read2st64_b32 v[250:251], v239 offset0:0 offset1:72
    ds_read_b128 v[240:243], v8 offset:6144
    ds_read_b128 v[236:239], v9 offset:9472
    s_waitcnt vmcnt(12)
    v_smfmac_f32_16x16x64_bf16 v[128:131], v[92:95], v[196:203], v44 abid:1
    s_waitcnt vmcnt(11)
    v_smfmac_f32_16x16x64_bf16 v[132:135], v[96:99], v[196:203], v45
    s_waitcnt vmcnt(10)
    v_smfmac_f32_16x16x64_bf16 v[136:139], v[100:103], v[196:203], v45 abid:1
    s_waitcnt lgkmcnt(1)
    v_smfmac_f32_16x16x64_bf16 v[148:151], v[240:243], v[244:251], v10
    v_smfmac_f32_16x16x64_bf16 v[184:187], v[240:243], v[244:251], v10 abid:1
    s_waitcnt lgkmcnt(0)
    v_xad_u32 v236, v236, v3, v4
    s_waitcnt vmcnt(9)
    v_xad_u32 v237, v237, v3, v4
    v_smfmac_f32_16x16x64_bf16 v[140:143], v[104:107], v[196:203], v46
    ds_read2st64_b32 v[244:245], v236 offset0:0 offset1:72
    ds_read2st64_b32 v[246:247], v237 offset0:0 offset1:72
    v_xad_u32 v238, v238, v3, v4
    s_waitcnt vmcnt(8)
    v_xad_u32 v239, v239, v3, v4
    v_smfmac_f32_16x16x64_bf16 v[144:147], v[108:111], v[196:203], v46 abid:1
    ds_read2st64_b32 v[248:249], v238 offset0:0 offset1:72
    ds_read2st64_b32 v[250:251], v239 offset0:0 offset1:72
    ds_read_b128 v[240:243], v8 offset:4096
    s_waitcnt vmcnt(7)
    v_smfmac_f32_16x16x64_bf16 v[148:151], v[112:115], v[196:203], v47
    s_waitcnt vmcnt(6)
    v_smfmac_f32_16x16x64_bf16 v[152:155], v[116:119], v[196:203], v47 abid:1
    s_waitcnt vmcnt(5)
    v_smfmac_f32_16x16x64_bf16 v[156:159], v[120:123], v[196:203], v52
    s_waitcnt lgkmcnt(0)
    v_smfmac_f32_16x16x64_bf16 v[140:143], v[240:243], v[244:251], v10
    v_smfmac_f32_16x16x64_bf16 v[176:179], v[240:243], v[244:251], v10 abid:1
    s_cmp_gt_u32 s46, s80
    s_cbranch_scc1 M_slow
M_slowr0:
    s_cmp_eq_u32 s20, 0
    s_mov_b32 s31, 1073903880
    s_cselect_b32 s30, 162048, s31
    v_mov_b32 v11, s31
    v_writelane_b32 v11, s30, 0
    v_cvt_pk_bf16_f32 v124, v124, v125
    v_cvt_pk_bf16_f32 v125, v126, v127
    v_cvt_pk_bf16_f32 v126, v128, v129
    v_cvt_pk_bf16_f32 v127, v130, v131
    v_cvt_pk_bf16_f32 v132, v132, v133
    v_cvt_pk_bf16_f32 v133, v134, v135
    v_cvt_pk_bf16_f32 v134, v136, v137
    v_cvt_pk_bf16_f32 v135, v138, v139
    ds_read_b128 v[136:139], v9 offset:10432
    v_cndmask_b32_dpp v128, v124, v132, vcc row_ror:8 row_mask:0xf bank_mask:0xf
    v_cndmask_b32_dpp v129, v125, v133, vcc row_ror:8 row_mask:0xf bank_mask:0xf
    v_cndmask_b32_dpp v130, v126, v134, vcc row_ror:8 row_mask:0xf bank_mask:0xf
    v_cndmask_b32_dpp v131, v127, v135, vcc row_ror:8 row_mask:0xf bank_mask:0xf
    buffer_store_dwordx4 v[128:131], v6, s[12:15], s59 offen offset:0 sc1
    v_mov_b32_dpp v124, v132 row_ror:8 row_mask:0xf bank_mask:0xc
    v_mov_b32_dpp v125, v133 row_ror:8 row_mask:0xf bank_mask:0xc
    v_mov_b32_dpp v126, v134 row_ror:8 row_mask:0xf bank_mask:0xc
    v_mov_b32_dpp v127, v135 row_ror:8 row_mask:0xf bank_mask:0xc
    buffer_store_dwordx4 v[124:127], v6, s[12:15], s24 offen offset:0 sc1
    ds_read_b128 v[128:131], v9 offset:10304
    ds_read_b128 v[132:135], v9 offset:10368
    ds_read_b128 v[124:127], v9 offset:10240
    v_cvt_pk_bf16_f32 v140, v140, v141
    v_cvt_pk_bf16_f32 v141, v142, v143
    v_cvt_pk_bf16_f32 v142, v144, v145
    v_cvt_pk_bf16_f32 v143, v146, v147
    v_cvt_pk_bf16_f32 v148, v148, v149
    v_cvt_pk_bf16_f32 v149, v150, v151
    v_cvt_pk_bf16_f32 v150, v152, v153
    v_cvt_pk_bf16_f32 v151, v154, v155
    ds_read_b128 v[152:155], v9 offset:10688
    v_cndmask_b32_dpp v144, v140, v148, vcc row_ror:8 row_mask:0xf bank_mask:0xf
    v_cndmask_b32_dpp v145, v141, v149, vcc row_ror:8 row_mask:0xf bank_mask:0xf
    v_cndmask_b32_dpp v146, v142, v150, vcc row_ror:8 row_mask:0xf bank_mask:0xf
    v_cndmask_b32_dpp v147, v143, v151, vcc row_ror:8 row_mask:0xf bank_mask:0xf
    buffer_store_dwordx4 v[144:147], v6, s[12:15], s59 offen offset:128 sc1
    v_mov_b32_dpp v140, v148 row_ror:8 row_mask:0xf bank_mask:0xc
    v_mov_b32_dpp v141, v149 row_ror:8 row_mask:0xf bank_mask:0xc
    v_mov_b32_dpp v142, v150 row_ror:8 row_mask:0xf bank_mask:0xc
    v_mov_b32_dpp v143, v151 row_ror:8 row_mask:0xf bank_mask:0xc
    buffer_store_dwordx4 v[140:143], v6, s[12:15], s24 offen offset:128 sc1
    ds_read_b128 v[144:147], v9 offset:10560
    ds_read_b128 v[148:151], v9 offset:10624
    ds_read_b128 v[140:143], v9 offset:10496
    v_cvt_pk_bf16_f32 v156, v156, v157
    v_cvt_pk_bf16_f32 v157, v158, v159
    ds_write_b64 v53, v[156:157] offset:25728
    ds_read_b128 v[156:159], v9 offset:10752
    s_mov_b32 s89, 0
    s_mov_b32 s101, 34209792
    s_mov_b32 s91, 0
    s_mov_b32 s25, 36864
    s_add_u32 s90, s24, 9437184
    s_mov_b32 s28, s26
    s_add_u32 s23, s24, 18432
    s_cmp_lt_u32 s20, 2
    s_cselect_b32 s66, s23, s24
    s_cselect_b32 s99, s14, 75497472
    s_add_u32 s66, s66, s95
    v_add_u32 v4, 36864, v4
    v_add_u32 v1, 36864, v1
    v_add_u32 v2, 36864, v2
M_top:
M_top1:
    s_add_u32 s23, s24, 18432
    s_add_u32 s58, s24, 27648
    s_mov_b32 s24, s90
    s_add_u32 s59, s90, 9216
    s_waitcnt lgkmcnt(0)
    s_barrier
    ds_read_b128 v[244:247], v8 offset:10816
    v_smfmac_f32_16x16x64_bf16 v[160:163], a[252:255], v[220:227], v40
    ds_read_b128 v[196:199], v1 offset:0
    v_smfmac_f32_16x16x64_bf16 v[160:163], v[88:91], v[228:235], v44
    ds_read_b128 v[200:203], v2 offset:0
    s_cmp_lt_u32 s22, 75497472
    s_cbranch_scc0 M_bF
    s_cmp_eq_u32 s91, 1
    s_cbranch_scc1 M_bE0
M_bL:
    v_smfmac_f32_16x16x64_bf16 v[164:167], v[56:59], v[220:227], v40 abid:1
    ds_read_b128 v[204:207], v1 offset:1024
    v_smfmac_f32_16x16x64_bf16 v[164:167], v[92:95], v[228:235], v44 abid:1
    ds_read_b128 v[208:211], v2 offset:1024
    v_mov_b32 v0, 1
    v_smfmac_f32_16x16x64_bf16 v[168:171], v[60:63], v[220:227], v41
    ds_read_b128 v[212:215], v1 offset:2048
    v_smfmac_f32_16x16x64_bf16 v[168:171], v[96:99], v[228:235], v45
    ds_read_b128 v[216:219], v2 offset:2048
    v_smfmac_f32_16x16x64_bf16 v[172:175], v[64:67], v[220:227], v41 abid:1
    s_waitcnt vmcnt(6)
    s_waitcnt lgkmcnt(6)
    buffer_store_dwordx4 v[244:247], v7, s[12:15], s66 offen sc1
    v_smfmac_f32_16x16x64_bf16 v[172:175], v[100:103], v[228:235], v45 abid:1
    ds_read_b128 v[236:239], v9 offset:9408
    v_smfmac_f32_16x16x64_bf16 v[176:179], v[68:71], v[220:227], v42
    s_waitcnt vmcnt(6)
    buffer_atomic_add v0, v11, s[16:19], s92 offen sc0 sc1
    s_mov_b32 s21, 1
    v_smfmac_f32_16x16x64_bf16 v[176:179], v[104:107], v[228:235], v46
    v_smfmac_f32_16x16x64_bf16 v[180:183], v[72:75], v[220:227], v42 abid:1
    v_cvt_pk_bf16_f32 v160, v160, v161
    v_smfmac_f32_16x16x64_bf16 v[180:183], v[108:111], v[228:235], v46 abid:1
    v_cvt_pk_bf16_f32 v161, v162, v163
    v_smfmac_f32_16x16x64_bf16 v[184:187], v[76:79], v[220:227], v43
    v_cvt_pk_bf16_f32 v162, v164, v165
    v_smfmac_f32_16x16x64_bf16 v[184:187], v[112:115], v[228:235], v47
    v_cvt_pk_bf16_f32 v163, v166, v167
    v_smfmac_f32_16x16x64_bf16 v[188:191], v[80:83], v[220:227], v43 abid:1
    s_add_u32 m0, m0, 896
    v_cvt_pk_bf16_f32 v168, v168, v169
    v_smfmac_f32_16x16x64_bf16 v[188:191], v[116:119], v[228:235], v47 abid:1
    s_waitcnt vmcnt(6)
    buffer_load_dwordx4 v5, s[8:11], s22 offen offset:512 nt lds
    v_cvt_pk_bf16_f32 v169, v170, v171
    v_smfmac_f32_16x16x64_bf16 v[192:195], v[84:87], v[220:227], v51 abid:1
    v_cvt_pk_bf16_f32 v170, v172, v173
    v_smfmac_f32_16x16x64_bf16 v[192:195], v[120:123], v[228:235], v52
    ds_read_b128 v[220:223], v1 offset:3072
    s_waitcnt lgkmcnt(6)
    v_cvt_pk_bf16_f32 v171, v174, v175
    v_smfmac_f32_16x16x64_bf16 v[124:127], a[0:3], v[196:203], v12
    ds_read_b128 v[224:227], v2 offset:3072
    ds_read_b128 v[172:175], v9 offset:10432
    s_waitcnt lgkmcnt(6)
    v_cndmask_b32_dpp v164, v160, v168, vcc row_ror:8 row_mask:0xf bank_mask:0xf
    v_smfmac_f32_16x16x64_bf16 v[124:127], a[36:39], v[204:211], v16
    ds_read_b128 v[228:231], v1 offset:4096
    s_waitcnt lgkmcnt(5)
    v_cndmask_b32_dpp v165, v161, v169, vcc row_ror:8 row_mask:0xf bank_mask:0xf
    v_smfmac_f32_16x16x64_bf16 v[124:127], a[72:75], v[212:219], v20
    ds_read_b128 v[232:235], v2 offset:4096
    v_cndmask_b32_dpp v166, v162, v170, vcc row_ror:8 row_mask:0xf bank_mask:0xf
    v_smfmac_f32_16x16x64_bf16 v[128:131], a[4:7], v[196:203], v12 abid:1
    s_barrier
    v_cndmask_b32_dpp v167, v163, v171, vcc row_ror:8 row_mask:0xf bank_mask:0xf
    v_smfmac_f32_16x16x64_bf16 v[128:131], a[40:43], v[204:211], v16 abid:1
    s_waitcnt vmcnt(6)
    buffer_store_dwordx4 v[164:167], v6, s[12:15], s58 offen offset:0 sc1
    s_waitcnt lgkmcnt(5)
    v_xad_u32 v236, v236, v3, v4
    v_smfmac_f32_16x16x64_bf16 v[128:131], a[76:79], v[212:219], v20 abid:1
    v_xad_u32 v237, v237, v3, v4
    v_smfmac_f32_16x16x64_bf16 v[132:135], a[8:11], v[196:203], v13
    ds_read2st64_b32 v[244:245], v236 offset0:0 offset1:72
    ds_read_b128 v[240:243], v8 offset:3072
    v_xad_u32 v238, v238, v3, v4
    v_smfmac_f32_16x16x64_bf16 v[132:135], a[44:47], v[204:211], v17
    ds_read2st64_b32 v[246:247], v237 offset0:0 offset1:72
    v_xad_u32 v239, v239, v3, v4
    v_smfmac_f32_16x16x64_bf16 v[132:135], a[80:83], v[212:219], v21
    ds_read2st64_b32 v[248:249], v238 offset0:0 offset1:72
    v_mov_b32_dpp v160, v168 row_ror:8 row_mask:0xf bank_mask:0xc
    v_smfmac_f32_16x16x64_bf16 v[144:147], a[20:23], v[196:203], v14 abid:1
    ds_read2st64_b32 v[250:251], v239 offset0:0 offset1:72
    ds_read_b128 v[236:239], v9 offset:9280
    v_mov_b32_dpp v161, v169 row_ror:8 row_mask:0xf bank_mask:0xc
    v_smfmac_f32_16x16x64_bf16 v[144:147], a[56:59], v[204:211], v18 abid:1
    v_mov_b32_dpp v162, v170 row_ror:8 row_mask:0xf bank_mask:0xc
    v_smfmac_f32_16x16x64_bf16 v[144:147], a[92:95], v[212:219], v22 abid:1
    v_mov_b32_dpp v163, v171 row_ror:8 row_mask:0xf bank_mask:0xc
    v_smfmac_f32_16x16x64_bf16 v[140:143], a[16:19], v[196:203], v14
    s_waitcnt vmcnt(6)
    buffer_store_dwordx4 v[160:163], v6, s[12:15], s23 offen offset:0 sc1
    ds_read_b128 v[164:167], v9 offset:10304
    v_smfmac_f32_16x16x64_bf16 v[140:143], a[52:55], v[204:211], v18
    ds_read_b128 v[168:171], v9 offset:10368
    ds_read_b128 v[160:163], v9 offset:10240
    v_smfmac_f32_16x16x64_bf16 v[140:143], a[88:91], v[212:219], v22
    v_smfmac_f32_16x16x64_bf16 v[136:139], a[12:15], v[196:203], v13 abid:1
    v_smfmac_f32_16x16x64_bf16 v[136:139], a[48:51], v[204:211], v17 abid:1
    v_smfmac_f32_16x16x64_bf16 v[136:139], a[84:87], v[212:219], v21 abid:1
    s_waitcnt lgkmcnt(3)
    v_xad_u32 v236, v236, v3, v4
    v_smfmac_f32_16x16x64_bf16 v[136:139], v[240:243], v[244:251], v10
    v_xad_u32 v237, v237, v3, v4
    v_smfmac_f32_16x16x64_bf16 v[172:175], v[240:243], v[244:251], v10 abid:1
    ds_read2st64_b32 v[244:245], v236 offset0:0 offset1:72
    ds_read_b128 v[240:243], v8 offset:1024
    v_xad_u32 v238, v238, v3, v4
    v_smfmac_f32_16x16x64_bf16 v[148:151], a[24:27], v[196:203], v15
    ds_read2st64_b32 v[246:247], v237 offset0:0 offset1:72
    v_xad_u32 v239, v239, v3, v4
    v_smfmac_f32_16x16x64_bf16 v[148:151], a[60:63], v[204:211], v19
    ds_read2st64_b32 v[248:249], v238 offset0:0 offset1:72
    v_cvt_pk_bf16_f32 v192, v192, v193
    v_smfmac_f32_16x16x64_bf16 v[148:151], a[96:99], v[212:219], v23
    ds_read2st64_b32 v[250:251], v239 offset0:0 offset1:72
    ds_read_b128 v[236:239], v9 offset:9344
    v_cvt_pk_bf16_f32 v193, v194, v195
    v_smfmac_f32_16x16x64_bf16 v[152:155], a[28:31], v[196:203], v15 abid:1
    ds_write_b64 v53, v[192:193] offset:0
    ds_read_b128 v[192:195], v9 offset:10752
    v_smfmac_f32_16x16x64_bf16 v[152:155], a[64:67], v[204:211], v19 abid:1
    s_add_u32 m0, m0, 896
    v_smfmac_f32_16x16x64_bf16 v[152:155], a[100:103], v[212:219], v23 abid:1
    s_waitcnt vmcnt(6)
    buffer_load_dwordx4 v5, s[8:11], s22 offen offset:640 nt lds
    v_smfmac_f32_16x16x64_bf16 v[156:159], a[32:35], v[196:203], v48
    v_smfmac_f32_16x16x64_bf16 v[156:159], a[68:71], v[204:211], v48 abid:1
    v_smfmac_f32_16x16x64_bf16 v[156:159], a[104:107], v[212:219], v49
    ds_read_b128 v[196:199], v1 offset:5120
    v_cvt_pk_bf16_f32 v176, v176, v177
    v_smfmac_f32_16x16x64_bf16 v[124:127], a[108:111], v[220:227], v24
    ds_read_b128 v[200:203], v2 offset:5120
    v_cvt_pk_bf16_f32 v177, v178, v179
    v_smfmac_f32_16x16x64_bf16 v[124:127], a[144:147], v[228:235], v28
    ds_read_b128 v[204:207], v1 offset:6144
    ds_read_b64 v[216:217], v9 offset:10056
    v_cvt_pk_bf16_f32 v178, v180, v181
    v_smfmac_f32_16x16x64_bf16 v[128:131], a[112:115], v[220:227], v24 abid:1
    ds_read_b128 v[208:211], v2 offset:6144
    v_cvt_pk_bf16_f32 v179, v182, v183
    v_smfmac_f32_16x16x64_bf16 v[128:131], a[148:151], v[228:235], v28 abid:1
    s_waitcnt lgkmcnt(7)
    v_xad_u32 v236, v236, v3, v4
    v_smfmac_f32_16x16x64_bf16 v[128:131], v[240:243], v[244:251], v10
    s_add_u32 m0, m0, 896
    v_xad_u32 v237, v237, v3, v4
    v_smfmac_f32_16x16x64_bf16 v[164:167], v[240:243], v[244:251], v10 abid:1
    ds_read2st64_b32 v[244:245], v236 offset0:0 offset1:72
    ds_read_b128 v[240:243], v8 offset:2048
    v_xad_u32 v238, v238, v3, v4
    v_smfmac_f32_16x16x64_bf16 v[152:155], a[136:139], v[220:227], v27 abid:1
    ds_read2st64_b32 v[246:247], v237 offset0:0 offset1:72
    s_waitcnt vmcnt(6)
    v_xad_u32 v239, v239, v3, v4
    v_smfmac_f32_16x16x64_bf16 v[152:155], a[172:175], v[228:235], v31 abid:1
    ds_read2st64_b32 v[248:249], v238 offset0:0 offset1:72
    buffer_load_dwordx4 v5, s[8:11], s22 offen offset:768 nt lds
    v_cvt_pk_bf16_f32 v184, v184, v185
    v_smfmac_f32_16x16x64_bf16 v[136:139], a[120:123], v[220:227], v25 abid:1
    ds_read2st64_b32 v[250:251], v239 offset0:0 offset1:72
    ds_read_b128 v[236:239], v9 offset:9216
    v_cvt_pk_bf16_f32 v185, v186, v187
    v_smfmac_f32_16x16x64_bf16 v[136:139], a[156:159], v[228:235], v29 abid:1
    v_cvt_pk_bf16_f32 v186, v188, v189
    v_smfmac_f32_16x16x64_bf16 v[140:143], a[124:127], v[220:227], v26
    v_cvt_pk_bf16_f32 v187, v190, v191
    v_smfmac_f32_16x16x64_bf16 v[140:143], a[160:163], v[228:235], v30
    ds_read_b128 v[188:191], v9 offset:10688
    v_cndmask_b32_dpp v180, v176, v184, vcc row_ror:8 row_mask:0xf bank_mask:0xf
    v_smfmac_f32_16x16x64_bf16 v[144:147], a[128:131], v[220:227], v26 abid:1
    v_cndmask_b32_dpp v181, v177, v185, vcc row_ror:8 row_mask:0xf bank_mask:0xf
    v_smfmac_f32_16x16x64_bf16 v[144:147], a[164:167], v[228:235], v30 abid:1
    v_cndmask_b32_dpp v182, v178, v186, vcc row_ror:8 row_mask:0xf bank_mask:0xf
    v_smfmac_f32_16x16x64_bf16 v[148:151], a[132:135], v[220:227], v27
    v_cndmask_b32_dpp v183, v179, v187, vcc row_ror:8 row_mask:0xf bank_mask:0xf
    v_smfmac_f32_16x16x64_bf16 v[148:151], a[168:171], v[228:235], v31
    s_waitcnt vmcnt(6)
    buffer_store_dwordx4 v[180:183], v6, s[12:15], s58 offen offset:128 sc1
    s_waitcnt lgkmcnt(8)
    v_xad_u32 v212, v216, v3, v4
    v_smfmac_f32_16x16x64_bf16 v[132:135], a[116:119], v[220:227], v25
    ds_read2st64_b32 v[212:213], v212 offset0:0 offset1:72
    v_xad_u32 v214, v217, v3, v4
    v_smfmac_f32_16x16x64_bf16 v[132:135], a[152:155], v[228:235], v29
    ds_read2st64_b32 v[214:215], v214 offset0:0 offset1:72
    s_waitcnt lgkmcnt(3)
    v_xad_u32 v236, v236, v3, v4
    v_smfmac_f32_16x16x64_bf16 v[132:135], v[240:243], v[244:251], v10
    v_xad_u32 v237, v237, v3, v4
    v_smfmac_f32_16x16x64_bf16 v[168:171], v[240:243], v[244:251], v10 abid:1
    ds_read2st64_b32 v[244:245], v236 offset0:0 offset1:72
    ds_read_b128 v[240:243], v8 offset:0
    v_xad_u32 v238, v238, v3, v4
    v_smfmac_f32_16x16x64_bf16 v[156:159], a[140:143], v[220:227], v49 abid:1
    ds_read2st64_b32 v[246:247], v237 offset0:0 offset1:72
    v_xad_u32 v239, v239, v3, v4
    v_smfmac_f32_16x16x64_bf16 v[156:159], a[176:179], v[228:235], v50
    ds_read2st64_b32 v[248:249], v238 offset0:0 offset1:72
    v_mov_b32_dpp v176, v184 row_ror:8 row_mask:0xf bank_mask:0xc
    v_smfmac_f32_16x16x64_bf16 v[140:143], a[196:199], v[196:203], v34
    ds_read2st64_b32 v[250:251], v239 offset0:0 offset1:72
    ds_read_b128 v[236:239], v9 offset:9728
    v_mov_b32_dpp v177, v185 row_ror:8 row_mask:0xf bank_mask:0xc
    v_smfmac_f32_16x16x64_bf16 v[140:143], a[232:235], v[204:211], v38
    v_mov_b32_dpp v178, v186 row_ror:8 row_mask:0xf bank_mask:0xc
    v_smfmac_f32_16x16x64_bf16 v[128:131], a[184:187], v[196:203], v32 abid:1
    v_mov_b32_dpp v179, v187 row_ror:8 row_mask:0xf bank_mask:0xc
    v_smfmac_f32_16x16x64_bf16 v[128:131], a[220:223], v[204:211], v36 abid:1
    s_waitcnt vmcnt(6)
    buffer_store_dwordx4 v[176:179], v6, s[12:15], s23 offen offset:128 sc1
    ds_read_b128 v[180:183], v9 offset:10560
    v_smfmac_f32_16x16x64_bf16 v[132:135], a[188:191], v[196:203], v33
    ds_read_b128 v[184:187], v9 offset:10624
    ds_read_b128 v[176:179], v9 offset:10496
    v_smfmac_f32_16x16x64_bf16 v[132:135], a[224:227], v[204:211], v37
    v_smfmac_f32_16x16x64_bf16 v[136:139], a[192:195], v[196:203], v33 abid:1
    ds_read_b128 v[220:223], v1 offset:7168
    v_smfmac_f32_16x16x64_bf16 v[136:139], a[228:231], v[204:211], v37 abid:1
    ds_read_b128 v[224:227], v2 offset:7168
    v_smfmac_f32_16x16x64_bf16 v[124:127], a[180:183], v[196:203], v32
    ds_read_b128 v[228:231], v1 offset:8192
    v_smfmac_f32_16x16x64_bf16 v[124:127], a[216:219], v[204:211], v36
    s_waitcnt vmcnt(7)
    s_waitcnt lgkmcnt(6)
    v_xad_u32 v236, v236, v3, v4
    v_smfmac_f32_16x16x64_bf16 v[124:127], v[240:243], v[244:251], v10
    ds_read_b128 v[232:235], v2 offset:8192
    v_xad_u32 v237, v237, v3, v4
    v_smfmac_f32_16x16x64_bf16 v[160:163], v[240:243], v[244:251], v10 abid:1
    ds_read2st64_b32 v[244:245], v236 offset0:0 offset1:72
    ds_read_b128 v[240:243], v8 offset:8192
    v_xad_u32 v238, v238, v3, v4
    v_smfmac_f32_16x16x64_bf16 v[144:147], a[200:203], v[196:203], v34 abid:1
    ds_read2st64_b32 v[246:247], v237 offset0:0 offset1:72
    v_xad_u32 v239, v239, v3, v4
    v_smfmac_f32_16x16x64_bf16 v[144:147], a[236:239], v[204:211], v38 abid:1
    ds_read2st64_b32 v[248:249], v238 offset0:0 offset1:72
    v_mul_u32_u24 v0, s94, v0
    v_smfmac_f32_16x16x64_bf16 v[148:151], a[204:207], v[196:203], v35
    ds_read2st64_b32 v[250:251], v239 offset0:0 offset1:72
    ds_read_b128 v[236:239], v9 offset:9664
    v_add_u32 v0, s93, v0
    v_smfmac_f32_16x16x64_bf16 v[148:151], a[240:243], v[204:211], v39
    s_waitcnt lgkmcnt(10)
    s_cmp_lt_i32 s81, 0
    s_cbranch_scc1 M_ovrL
    s_swappc_b64 s[78:79], s[72:73]
M_ovrL:
    v_smfmac_f32_16x16x64_bf16 v[152:155], a[208:211], v[196:203], v35 abid:1
    s_add_u32 m0, m0, 896
    v_min_u32 v0, 75497472, v0
    v_smfmac_f32_16x16x64_bf16 v[152:155], a[244:247], v[204:211], v39 abid:1
    ds_write_b32 v11, v0
    s_waitcnt vmcnt(6)
    v_mov_b32 v0, 162048
    v_smfmac_f32_16x16x64_bf16 v[156:159], a[212:215], v[196:203], v50 abid:1
    buffer_load_dwordx4 v5, s[8:11], s22 offen offset:896 nt lds
    v_smfmac_f32_16x16x64_bf16 v[156:159], a[248:251], v[204:211], v51
    s_waitcnt lgkmcnt(9)
    v_smfmac_f32_16x16x64_bf16 v[124:127], a[252:255], v[220:227], v40
    ds_read_b128 v[196:199], v1 offset:18432
    s_waitcnt lgkmcnt(8)
    v_smfmac_f32_16x16x64_bf16 v[124:127], v[88:91], v[228:235], v44
    ds_read_b128 v[200:203], v2 offset:18432
    v_smfmac_f32_16x16x64_bf16 v[156:159], v[84:87], v[220:227], v51 abid:1
    ds_read_b128 v[204:207], v1 offset:19456
    v_smfmac_f32_16x16x64_bf16 v[156:159], v[120:123], v[228:235], v52
    s_waitcnt lgkmcnt(3)
    s_barrier
    v_xad_u32 v236, v236, v3, v4
    v_smfmac_f32_16x16x64_bf16 v[156:159], v[240:243], v[244:251], v10
    ds_read_b128 v[208:211], v2 offset:19456
    ds_read_b32 v0, v0
    v_xad_u32 v237, v237, v3, v4
    v_smfmac_f32_16x16x64_bf16 v[192:195], v[240:243], v[244:251], v10 abid:1
    ds_read2st64_b32 v[244:245], v236 offset0:0 offset1:72
    ds_read_b128 v[240:243], v8 offset:7168
    v_xad_u32 v238, v238, v3, v4
    v_smfmac_f32_16x16x64_bf16 v[132:135], v[60:63], v[220:227], v41
    ds_read2st64_b32 v[246:247], v237 offset0:0 offset1:72
    v_xad_u32 v239, v239, v3, v4
    v_smfmac_f32_16x16x64_bf16 v[132:135], v[96:99], v[228:235], v45
    ds_read2st64_b32 v[248:249], v238 offset0:0 offset1:72
    s_add_u32 m0, m0, 896
    v_smfmac_f32_16x16x64_bf16 v[136:139], v[64:67], v[220:227], v41 abid:1
    ds_read2st64_b32 v[250:251], v239 offset0:0 offset1:72
    ds_read_b128 v[236:239], v9 offset:9536
    s_waitcnt vmcnt(6)
    v_smfmac_f32_16x16x64_bf16 v[136:139], v[100:103], v[228:235], v45 abid:1
    buffer_load_dwordx4 v5, s[8:11], s22 offen offset:1024 nt lds
    s_waitcnt lgkmcnt(6)
    v_readfirstlane_b32 s88, v0
    v_smfmac_f32_16x16x64_bf16 v[140:143], v[68:71], v[220:227], v42
    s_cmp_lt_u32 s88, s99
    s_cselect_b32 s10, 75497472, 0
    v_smfmac_f32_16x16x64_bf16 v[140:143], v[104:107], v[228:235], v46
    s_cmp_lt_u32 s88, s14
    s_cbranch_scc0 M_q
M_nq:
    v_smfmac_f32_16x16x64_bf16 v[144:147], v[72:75], v[220:227], v42 abid:1
    ds_read_b128 v[212:215], v1 offset:20480
    v_smfmac_f32_16x16x64_bf16 v[144:147], v[108:111], v[228:235], v46 abid:1
    ds_read_b128 v[216:219], v2 offset:20480
    v_smfmac_f32_16x16x64_bf16 v[148:151], v[76:79], v[220:227], v43
    v_smfmac_f32_16x16x64_bf16 v[148:151], v[112:115], v[228:235], v47
    v_smfmac_f32_16x16x64_bf16 v[152:155], v[80:83], v[220:227], v43 abid:1
    v_smfmac_f32_16x16x64_bf16 v[152:155], v[116:119], v[228:235], v47 abid:1
    s_waitcnt lgkmcnt(2)
    v_xad_u32 v236, v236, v3, v4
    v_smfmac_f32_16x16x64_bf16 v[152:155], v[240:243], v[244:251], v10
    v_xad_u32 v237, v237, v3, v4
    v_smfmac_f32_16x16x64_bf16 v[188:191], v[240:243], v[244:251], v10 abid:1
    s_cmp_gt_u32 s46, s80
    s_cbranch_scc1 M_slow
M_slowrL:
    v_xad_u32 v238, v238, v3, v4
    v_smfmac_f32_16x16x64_bf16 v[128:131], v[56:59], v[220:227], v40 abid:1
    ds_read2st64_b32 v[244:245], v236 offset0:0 offset1:72
    ds_read_b128 v[240:243], v8 offset:5120
    v_xad_u32 v239, v239, v3, v4
    v_smfmac_f32_16x16x64_bf16 v[128:131], v[92:95], v[228:235], v44 abid:1
    ds_read2st64_b32 v[246:247], v237 offset0:0 offset1:72
    v_smfmac_f32_16x16x64_bf16 v[160:163], a[0:3], v[196:203], v12
    ds_read2st64_b32 v[248:249], v238 offset0:0 offset1:72
    v_smfmac_f32_16x16x64_bf16 v[160:163], a[36:39], v[204:211], v16
    ds_read2st64_b32 v[250:251], v239 offset0:0 offset1:72
    ds_read_b128 v[236:239], v9 offset:9600
    s_waitcnt lgkmcnt(6)
    v_smfmac_f32_16x16x64_bf16 v[160:163], a[72:75], v[212:219], v20
    v_smfmac_f32_16x16x64_bf16 v[164:167], a[4:7], v[196:203], v12 abid:1
    s_mov_b32 m0, s28
    v_cvt_pk_bf16_f32 v156, v156, v157
    v_smfmac_f32_16x16x64_bf16 v[164:167], a[40:43], v[204:211], v16 abid:1
    s_waitcnt vmcnt(6)
    buffer_load_dwordx4 v5, s[8:11], s88 offen offset:0 nt lds
    v_cvt_pk_bf16_f32 v157, v158, v159
    v_smfmac_f32_16x16x64_bf16 v[164:167], a[76:79], v[212:219], v20 abid:1
    ds_write_b64 v53, v[156:157] offset:25728
    ds_read_b128 v[156:159], v9 offset:10752
    v_smfmac_f32_16x16x64_bf16 v[180:183], a[20:23], v[196:203], v14 abid:1
    v_smfmac_f32_16x16x64_bf16 v[180:183], a[56:59], v[204:211], v18 abid:1
    ds_read_b128 v[220:223], v1 offset:21504
    v_cvt_pk_bf16_f32 v124, v124, v125
    v_smfmac_f32_16x16x64_bf16 v[180:183], a[92:95], v[212:219], v22 abid:1
    s_waitcnt lgkmcnt(3)
    v_xad_u32 v236, v236, v3, v4
    v_smfmac_f32_16x16x64_bf16 v[180:183], v[240:243], v[244:251], v10 abid:1
    v_xad_u32 v237, v237, v3, v4
    v_smfmac_f32_16x16x64_bf16 v[144:147], v[240:243], v[244:251], v10
    ds_read2st64_b32 v[244:245], v236 offset0:0 offset1:72
    ds_read_b128 v[240:243], v8 offset:6144
    v_xad_u32 v238, v238, v3, v4
    v_smfmac_f32_16x16x64_bf16 v[172:175], a[12:15], v[196:203], v13 abid:1
    ds_read2st64_b32 v[246:247], v237 offset0:0 offset1:72
    v_xad_u32 v239, v239, v3, v4
    v_smfmac_f32_16x16x64_bf16 v[172:175], a[48:51], v[204:211], v17 abid:1
    ds_read2st64_b32 v[248:249], v238 offset0:0 offset1:72
    v_cvt_pk_bf16_f32 v125, v126, v127
    v_smfmac_f32_16x16x64_bf16 v[172:175], a[84:87], v[212:219], v21 abid:1
    ds_read2st64_b32 v[250:251], v239 offset0:0 offset1:72
    ds_read_b128 v[236:239], v9 offset:9472
    v_cvt_pk_bf16_f32 v126, v128, v129
    v_smfmac_f32_16x16x64_bf16 v[176:179], a[16:19], v[196:203], v14
    v_cvt_pk_bf16_f32 v127, v130, v131
    v_smfmac_f32_16x16x64_bf16 v[176:179], a[52:55], v[204:211], v18
    v_cvt_pk_bf16_f32 v132, v132, v133
    v_smfmac_f32_16x16x64_bf16 v[176:179], a[88:91], v[212:219], v22
    v_cvt_pk_bf16_f32 v133, v134, v135
    v_smfmac_f32_16x16x64_bf16 v[168:171], a[8:11], v[196:203], v13
    s_add_u32 m0, m0, 896
    v_cvt_pk_bf16_f32 v134, v136, v137
    v_smfmac_f32_16x16x64_bf16 v[168:171], a[44:47], v[204:211], v17
    s_waitcnt vmcnt(6)
    buffer_load_dwordx4 v5, s[8:11], s88 offen offset:128 nt lds
    v_cvt_pk_bf16_f32 v135, v138, v139
    v_smfmac_f32_16x16x64_bf16 v[168:171], a[80:83], v[212:219], v21
    ds_read_b128 v[224:227], v2 offset:21504
    ds_read_b128 v[136:139], v9 offset:10432
    v_cndmask_b32_dpp v128, v124, v132, vcc row_ror:8 row_mask:0xf bank_mask:0xf
    v_smfmac_f32_16x16x64_bf16 v[184:187], a[24:27], v[196:203], v15
    ds_read_b128 v[228:231], v1 offset:22528
    v_cndmask_b32_dpp v129, v125, v133, vcc row_ror:8 row_mask:0xf bank_mask:0xf
    v_smfmac_f32_16x16x64_bf16 v[184:187], a[60:63], v[204:211], v19
    ds_read_b128 v[232:235], v2 offset:22528
    v_cndmask_b32_dpp v130, v126, v134, vcc row_ror:8 row_mask:0xf bank_mask:0xf
    v_smfmac_f32_16x16x64_bf16 v[184:187], a[96:99], v[212:219], v23
    s_waitcnt lgkmcnt(4)
    v_xad_u32 v236, v236, v3, v4
    v_smfmac_f32_16x16x64_bf16 v[184:187], v[240:243], v[244:251], v10 abid:1
    v_xad_u32 v237, v237, v3, v4
    v_smfmac_f32_16x16x64_bf16 v[148:151], v[240:243], v[244:251], v10
    ds_read2st64_b32 v[244:245], v236 offset0:0 offset1:72
    ds_read_b128 v[240:243], v8 offset:4096
    v_xad_u32 v238, v238, v3, v4
    v_smfmac_f32_16x16x64_bf16 v[188:191], a[28:31], v[196:203], v15 abid:1
    ds_read2st64_b32 v[246:247], v237 offset0:0 offset1:72
    v_xad_u32 v239, v239, v3, v4
    v_smfmac_f32_16x16x64_bf16 v[188:191], a[64:67], v[204:211], v19 abid:1
    ds_read2st64_b32 v[248:249], v238 offset0:0 offset1:72
    v_cndmask_b32_dpp v131, v127, v135, vcc row_ror:8 row_mask:0xf bank_mask:0xf
    v_smfmac_f32_16x16x64_bf16 v[188:191], a[100:103], v[212:219], v23 abid:1
    ds_read2st64_b32 v[250:251], v239 offset0:0 offset1:72
    s_waitcnt vmcnt(6)
    buffer_store_dwordx4 v[128:131], v6, s[12:15], s59 offen offset:0 sc1
    v_smfmac_f32_16x16x64_bf16 v[192:195], a[32:35], v[196:203], v48
    v_mov_b32_dpp v124, v132 row_ror:8 row_mask:0xf bank_mask:0xc
    v_smfmac_f32_16x16x64_bf16 v[192:195], a[68:71], v[204:211], v48 abid:1
    v_mov_b32_dpp v125, v133 row_ror:8 row_mask:0xf bank_mask:0xc
    v_smfmac_f32_16x16x64_bf16 v[192:195], a[104:107], v[212:219], v49
    s_waitcnt lgkmcnt(8)
    v_mov_b32_dpp v126, v134 row_ror:8 row_mask:0xf bank_mask:0xc
    v_smfmac_f32_16x16x64_bf16 v[160:163], a[108:111], v[220:227], v24
    s_waitcnt lgkmcnt(5)
    v_mov_b32_dpp v127, v135 row_ror:8 row_mask:0xf bank_mask:0xc
    v_smfmac_f32_16x16x64_bf16 v[160:163], a[144:147], v[228:235], v28
    ds_read_b128 v[196:199], v1 offset:23552
    s_waitcnt vmcnt(6)
    buffer_store_dwordx4 v[124:127], v6, s[12:15], s24 offen offset:0 sc1
    v_smfmac_f32_16x16x64_bf16 v[164:167], a[112:115], v[220:227], v24 abid:1
    ds_read_b128 v[200:203], v2 offset:23552
    ds_read_b128 v[128:131], v9 offset:10304
    ds_read_b128 v[132:135], v9 offset:10368
    v_smfmac_f32_16x16x64_bf16 v[164:167], a[148:151], v[228:235], v28 abid:1
    ds_read_b128 v[204:207], v1 offset:24576
    ds_read_b128 v[124:127], v9 offset:10240
    v_smfmac_f32_16x16x64_bf16 v[176:179], a[124:127], v[220:227], v26
    ds_read_b128 v[208:211], v2 offset:24576
    v_smfmac_f32_16x16x64_bf16 v[176:179], a[160:163], v[228:235], v30
    s_waitcnt lgkmcnt(7)
    v_smfmac_f32_16x16x64_bf16 v[176:179], v[240:243], v[244:251], v10 abid:1
    v_smfmac_f32_16x16x64_bf16 v[140:143], v[240:243], v[244:251], v10
    v_smfmac_f32_16x16x64_bf16 v[172:175], a[120:123], v[220:227], v25 abid:1
    s_add_u32 s28, s28, 36864
    s_cmp_ge_u32 s28, 110592
    s_cselect_b32 s28, s26, s28
    v_smfmac_f32_16x16x64_bf16 v[172:175], a[156:159], v[228:235], v29 abid:1
    s_add_u32 s30, s25, 36864
    s_cmp_eq_u32 s30, 110592
    s_cselect_b32 s30, 0, s30
    v_smfmac_f32_16x16x64_bf16 v[168:171], a[116:119], v[220:227], v25
    s_sub_u32 s31, s30, s25
    s_mov_b32 s25, s30
    s_mov_b32 s90, s22
    v_smfmac_f32_16x16x64_bf16 v[168:171], a[152:155], v[228:235], v29
    s_mov_b32 s22, s88
    s_add_u32 s91, s91, 1
    s_cmp_lt_u32 s20, 2
    v_smfmac_f32_16x16x64_bf16 v[180:183], a[128:131], v[220:227], v26 abid:1
    s_cselect_b32 s66, s23, s24
    s_add_u32 s66, s66, s95
    v_smfmac_f32_16x16x64_bf16 v[180:183], a[164:167], v[228:235], v30 abid:1
    v_cvt_pk_bf16_f32 v140, v140, v141
    v_smfmac_f32_16x16x64_bf16 v[184:187], a[132:135], v[220:227], v27
    s_add_u32 m0, m0, 896
    v_cvt_pk_bf16_f32 v141, v142, v143
    v_smfmac_f32_16x16x64_bf16 v[184:187], a[168:171], v[228:235], v31
    s_waitcnt vmcnt(6)
    buffer_load_dwordx4 v5, s[8:11], s88 offen offset:256 nt lds
    v_cvt_pk_bf16_f32 v142, v144, v145
    v_smfmac_f32_16x16x64_bf16 v[188:191], a[136:139], v[220:227], v27 abid:1
    v_cvt_pk_bf16_f32 v143, v146, v147
    v_smfmac_f32_16x16x64_bf16 v[188:191], a[172:175], v[228:235], v31 abid:1
    v_cvt_pk_bf16_f32 v148, v148, v149
    v_smfmac_f32_16x16x64_bf16 v[192:195], a[140:143], v[220:227], v49 abid:1
    v_cvt_pk_bf16_f32 v149, v150, v151
    v_smfmac_f32_16x16x64_bf16 v[192:195], a[176:179], v[228:235], v50
    ds_read_b128 v[220:223], v1 offset:25600
    s_waitcnt lgkmcnt(6)
    v_cvt_pk_bf16_f32 v150, v152, v153
    v_smfmac_f32_16x16x64_bf16 v[160:163], a[180:183], v[196:203], v32
    ds_read_b128 v[224:227], v2 offset:25600
    s_waitcnt lgkmcnt(2)
    v_cvt_pk_bf16_f32 v151, v154, v155
    v_smfmac_f32_16x16x64_bf16 v[160:163], a[216:219], v[204:211], v36
    ds_read_b128 v[228:231], v1 offset:26624
    ds_read_b128 v[152:155], v9 offset:10688
    v_cndmask_b32_dpp v144, v140, v148, vcc row_ror:8 row_mask:0xf bank_mask:0xf
    v_smfmac_f32_16x16x64_bf16 v[164:167], a[184:187], v[196:203], v32 abid:1
    ds_read_b128 v[232:235], v2 offset:26624
    v_cndmask_b32_dpp v145, v141, v149, vcc row_ror:8 row_mask:0xf bank_mask:0xf
    v_smfmac_f32_16x16x64_bf16 v[164:167], a[220:223], v[204:211], v36 abid:1
    s_add_u32 m0, m0, 896
    v_cndmask_b32_dpp v146, v142, v150, vcc row_ror:8 row_mask:0xf bank_mask:0xf
    v_smfmac_f32_16x16x64_bf16 v[168:171], a[188:191], v[196:203], v33
    s_waitcnt vmcnt(6)
    buffer_load_dwordx4 v5, s[8:11], s88 offen offset:384 nt lds
    v_cndmask_b32_dpp v147, v143, v151, vcc row_ror:8 row_mask:0xf bank_mask:0xf
    v_smfmac_f32_16x16x64_bf16 v[168:171], a[224:227], v[204:211], v37
    s_waitcnt vmcnt(6)
    buffer_store_dwordx4 v[144:147], v6, s[12:15], s59 offen offset:128 sc1
    v_mov_b32_dpp v140, v148 row_ror:8 row_mask:0xf bank_mask:0xc
    v_smfmac_f32_16x16x64_bf16 v[172:175], a[192:195], v[196:203], v33 abid:1
    v_mov_b32_dpp v141, v149 row_ror:8 row_mask:0xf bank_mask:0xc
    v_smfmac_f32_16x16x64_bf16 v[172:175], a[228:231], v[204:211], v37 abid:1
    v_mov_b32_dpp v142, v150 row_ror:8 row_mask:0xf bank_mask:0xc
    v_smfmac_f32_16x16x64_bf16 v[176:179], a[196:199], v[196:203], v34
    v_mov_b32_dpp v143, v151 row_ror:8 row_mask:0xf bank_mask:0xc
    v_smfmac_f32_16x16x64_bf16 v[176:179], a[232:235], v[204:211], v38
    s_waitcnt vmcnt(6)
    buffer_store_dwordx4 v[140:143], v6, s[12:15], s24 offen offset:128 sc1
    ds_read_b128 v[144:147], v9 offset:10560
    v_smfmac_f32_16x16x64_bf16 v[180:183], a[200:203], v[196:203], v34 abid:1
    ds_read_b128 v[148:151], v9 offset:10624
    ds_read_b128 v[140:143], v9 offset:10496
    v_add_u32 v4, s31, v4
    v_smfmac_f32_16x16x64_bf16 v[180:183], a[236:239], v[204:211], v38 abid:1
    v_add_u32 v1, s31, v1
    v_smfmac_f32_16x16x64_bf16 v[184:187], a[204:207], v[196:203], v35
    v_add_u32 v2, s31, v2
    v_smfmac_f32_16x16x64_bf16 v[184:187], a[240:243], v[204:211], v39
    v_smfmac_f32_16x16x64_bf16 v[188:191], a[208:211], v[196:203], v35 abid:1
    v_smfmac_f32_16x16x64_bf16 v[188:191], a[244:247], v[204:211], v39 abid:1
    v_smfmac_f32_16x16x64_bf16 v[192:195], a[212:215], v[196:203], v50 abid:1
    v_smfmac_f32_16x16x64_bf16 v[192:195], a[248:251], v[204:211], v51
    s_waitcnt vmcnt(8)
    s_branch M_top1
M_bE0:
    v_smfmac_f32_16x16x64_bf16 v[164:167], v[56:59], v[220:227], v40 abid:1
    ds_read_b128 v[204:207], v1 offset:1024
    v_smfmac_f32_16x16x64_bf16 v[164:167], v[92:95], v[228:235], v44 abid:1
    ds_read_b128 v[208:211], v2 offset:1024
    v_mov_b32 v0, 1
    v_smfmac_f32_16x16x64_bf16 v[168:171], v[60:63], v[220:227], v41
    ds_read_b128 v[212:215], v1 offset:2048
    v_smfmac_f32_16x16x64_bf16 v[168:171], v[96:99], v[228:235], v45
    ds_read_b128 v[216:219], v2 offset:2048
    v_smfmac_f32_16x16x64_bf16 v[172:175], v[64:67], v[220:227], v41 abid:1
    s_waitcnt vmcnt(5)
    s_waitcnt lgkmcnt(6)
    buffer_store_dwordx4 v[244:247], v7, s[12:15], s66 offen sc1
    v_smfmac_f32_16x16x64_bf16 v[172:175], v[100:103], v[228:235], v45 abid:1
    ds_read_b128 v[236:239], v9 offset:9408
    v_smfmac_f32_16x16x64_bf16 v[176:179], v[68:71], v[220:227], v42
    s_waitcnt vmcnt(6)
    buffer_atomic_add v0, v11, s[16:19], s92 offen sc0 sc1
    s_mov_b32 s21, 2
    v_smfmac_f32_16x16x64_bf16 v[176:179], v[104:107], v[228:235], v46
    v_smfmac_f32_16x16x64_bf16 v[180:183], v[72:75], v[220:227], v42 abid:1
    v_cvt_pk_bf16_f32 v160, v160, v161
    v_smfmac_f32_16x16x64_bf16 v[180:183], v[108:111], v[228:235], v46 abid:1
    v_cvt_pk_bf16_f32 v161, v162, v163
    v_smfmac_f32_16x16x64_bf16 v[184:187], v[76:79], v[220:227], v43
    v_cvt_pk_bf16_f32 v162, v164, v165
    v_smfmac_f32_16x16x64_bf16 v[184:187], v[112:115], v[228:235], v47
    v_cvt_pk_bf16_f32 v163, v166, v167
    v_smfmac_f32_16x16x64_bf16 v[188:191], v[80:83], v[220:227], v43 abid:1
    s_add_u32 m0, m0, 896
    v_cvt_pk_bf16_f32 v168, v168, v169
    v_smfmac_f32_16x16x64_bf16 v[188:191], v[116:119], v[228:235], v47 abid:1
    s_waitcnt vmcnt(5)
    buffer_load_dwordx4 v5, s[8:11], s22 offen offset:512 nt lds
    v_cvt_pk_bf16_f32 v169, v170, v171
    v_smfmac_f32_16x16x64_bf16 v[192:195], v[84:87], v[220:227], v51 abid:1
    v_cvt_pk_bf16_f32 v170, v172, v173
    v_smfmac_f32_16x16x64_bf16 v[192:195], v[120:123], v[228:235], v52
    ds_read_b128 v[220:223], v1 offset:3072
    s_waitcnt lgkmcnt(6)
    v_cvt_pk_bf16_f32 v171, v174, v175
    v_smfmac_f32_16x16x64_bf16 v[124:127], a[0:3], v[196:203], v12
    ds_read_b128 v[224:227], v2 offset:3072
    ds_read_b128 v[172:175], v9 offset:10432
    s_waitcnt lgkmcnt(6)
    v_cndmask_b32_dpp v164, v160, v168, vcc row_ror:8 row_mask:0xf bank_mask:0xf
    v_smfmac_f32_16x16x64_bf16 v[124:127], a[36:39], v[204:211], v16
    ds_read_b128 v[228:231], v1 offset:4096
    s_waitcnt lgkmcnt(5)
    v_cndmask_b32_dpp v165, v161, v169, vcc row_ror:8 row_mask:0xf bank_mask:0xf
    v_smfmac_f32_16x16x64_bf16 v[124:127], a[72:75], v[212:219], v20
    ds_read_b128 v[232:235], v2 offset:4096
    v_cndmask_b32_dpp v166, v162, v170, vcc row_ror:8 row_mask:0xf bank_mask:0xf
    v_smfmac_f32_16x16x64_bf16 v[128:131], a[4:7], v[196:203], v12 abid:1
    s_barrier
    v_cndmask_b32_dpp v167, v163, v171, vcc row_ror:8 row_mask:0xf bank_mask:0xf
    v_smfmac_f32_16x16x64_bf16 v[128:131], a[40:43], v[204:211], v16 abid:1
    s_waitcnt vmcnt(6)
    buffer_store_dwordx4 v[164:167], v6, s[12:15], s58 offen offset:0 sc1
    s_waitcnt lgkmcnt(5)
    v_xad_u32 v236, v236, v3, v4
    v_smfmac_f32_16x16x64_bf16 v[128:131], a[76:79], v[212:219], v20 abid:1
    v_xad_u32 v237, v237, v3, v4
    v_smfmac_f32_16x16x64_bf16 v[132:135], a[8:11], v[196:203], v13
    ds_read2st64_b32 v[244:245], v236 offset0:0 offset1:72
    ds_read_b128 v[240:243], v8 offset:3072
    v_xad_u32 v238, v238, v3, v4
    v_smfmac_f32_16x16x64_bf16 v[132:135], a[44:47], v[204:211], v17
    ds_read2st64_b32 v[246:247], v237 offset0:0 offset1:72
    v_xad_u32 v239, v239, v3, v4
    v_smfmac_f32_16x16x64_bf16 v[132:135], a[80:83], v[212:219], v21
    ds_read2st64_b32 v[248:249], v238 offset0:0 offset1:72
    v_mov_b32_dpp v160, v168 row_ror:8 row_mask:0xf bank_mask:0xc
    v_smfmac_f32_16x16x64_bf16 v[144:147], a[20:23], v[196:203], v14 abid:1
    ds_read2st64_b32 v[250:251], v239 offset0:0 offset1:72
    ds_read_b128 v[236:239], v9 offset:9280
    v_mov_b32_dpp v161, v169 row_ror:8 row_mask:0xf bank_mask:0xc
    v_smfmac_f32_16x16x64_bf16 v[144:147], a[56:59], v[204:211], v18 abid:1
    v_mov_b32_dpp v162, v170 row_ror:8 row_mask:0xf bank_mask:0xc
    v_smfmac_f32_16x16x64_bf16 v[144:147], a[92:95], v[212:219], v22 abid:1
    v_mov_b32_dpp v163, v171 row_ror:8 row_mask:0xf bank_mask:0xc
    v_smfmac_f32_16x16x64_bf16 v[140:143], a[16:19], v[196:203], v14
    s_waitcnt vmcnt(5)
    buffer_store_dwordx4 v[160:163], v6, s[12:15], s23 offen offset:0 sc1
    ds_read_b128 v[164:167], v9 offset:10304
    v_smfmac_f32_16x16x64_bf16 v[140:143], a[52:55], v[204:211], v18
    ds_read_b128 v[168:171], v9 offset:10368
    ds_read_b128 v[160:163], v9 offset:10240
    v_smfmac_f32_16x16x64_bf16 v[140:143], a[88:91], v[212:219], v22
    v_smfmac_f32_16x16x64_bf16 v[136:139], a[12:15], v[196:203], v13 abid:1
    v_smfmac_f32_16x16x64_bf16 v[136:139], a[48:51], v[204:211], v17 abid:1
    v_smfmac_f32_16x16x64_bf16 v[136:139], a[84:87], v[212:219], v21 abid:1
    s_waitcnt lgkmcnt(3)
    v_xad_u32 v236, v236, v3, v4
    v_smfmac_f32_16x16x64_bf16 v[136:139], v[240:243], v[244:251], v10
    v_xad_u32 v237, v237, v3, v4
    v_smfmac_f32_16x16x64_bf16 v[172:175], v[240:243], v[244:251], v10 abid:1
    ds_read2st64_b32 v[244:245], v236 offset0:0 offset1:72
    ds_read_b128 v[240:243], v8 offset:1024
    v_xad_u32 v238, v238, v3, v4
    v_smfmac_f32_16x16x64_bf16 v[148:151], a[24:27], v[196:203], v15
    ds_read2st64_b32 v[246:247], v237 offset0:0 offset1:72
    v_xad_u32 v239, v239, v3, v4
    v_smfmac_f32_16x16x64_bf16 v[148:151], a[60:63], v[204:211], v19
    ds_read2st64_b32 v[248:249], v238 offset0:0 offset1:72
    v_cvt_pk_bf16_f32 v192, v192, v193
    v_smfmac_f32_16x16x64_bf16 v[148:151], a[96:99], v[212:219], v23
    ds_read2st64_b32 v[250:251], v239 offset0:0 offset1:72
    ds_read_b128 v[236:239], v9 offset:9344
    v_cvt_pk_bf16_f32 v193, v194, v195
    v_smfmac_f32_16x16x64_bf16 v[152:155], a[28:31], v[196:203], v15 abid:1
    ds_write_b64 v53, v[192:193] offset:0
    ds_read_b128 v[192:195], v9 offset:10752
    v_smfmac_f32_16x16x64_bf16 v[152:155], a[64:67], v[204:211], v19 abid:1
    s_add_u32 m0, m0, 896
    v_smfmac_f32_16x16x64_bf16 v[152:155], a[100:103], v[212:219], v23 abid:1
    s_waitcnt vmcnt(6)
    buffer_load_dwordx4 v5, s[8:11], s22 offen offset:640 nt lds
    v_smfmac_f32_16x16x64_bf16 v[156:159], a[32:35], v[196:203], v48
    v_smfmac_f32_16x16x64_bf16 v[156:159], a[68:71], v[204:211], v48 abid:1
    v_smfmac_f32_16x16x64_bf16 v[156:159], a[104:107], v[212:219], v49
    ds_read_b128 v[196:199], v1 offset:5120
    v_cvt_pk_bf16_f32 v176, v176, v177
    v_smfmac_f32_16x16x64_bf16 v[124:127], a[108:111], v[220:227], v24
    ds_read_b128 v[200:203], v2 offset:5120
    v_cvt_pk_bf16_f32 v177, v178, v179
    v_smfmac_f32_16x16x64_bf16 v[124:127], a[144:147], v[228:235], v28
    ds_read_b128 v[204:207], v1 offset:6144
    ds_read_b64 v[216:217], v9 offset:10056
    v_cvt_pk_bf16_f32 v178, v180, v181
    v_smfmac_f32_16x16x64_bf16 v[128:131], a[112:115], v[220:227], v24 abid:1
    ds_read_b128 v[208:211], v2 offset:6144
    v_cvt_pk_bf16_f32 v179, v182, v183
    v_smfmac_f32_16x16x64_bf16 v[128:131], a[148:151], v[228:235], v28 abid:1
    s_waitcnt lgkmcnt(7)
    v_xad_u32 v236, v236, v3, v4
    v_smfmac_f32_16x16x64_bf16 v[128:131], v[240:243], v[244:251], v10
    s_add_u32 m0, m0, 896
    v_xad_u32 v237, v237, v3, v4
    v_smfmac_f32_16x16x64_bf16 v[164:167], v[240:243], v[244:251], v10 abid:1
    ds_read2st64_b32 v[244:245], v236 offset0:0 offset1:72
    ds_read_b128 v[240:243], v8 offset:2048
    v_xad_u32 v238, v238, v3, v4
    v_smfmac_f32_16x16x64_bf16 v[152:155], a[136:139], v[220:227], v27 abid:1
    ds_read2st64_b32 v[246:247], v237 offset0:0 offset1:72
    s_waitcnt vmcnt(5)
    v_xad_u32 v239, v239, v3, v4
    v_smfmac_f32_16x16x64_bf16 v[152:155], a[172:175], v[228:235], v31 abid:1
    ds_read2st64_b32 v[248:249], v238 offset0:0 offset1:72
    buffer_load_dwordx4 v5, s[8:11], s22 offen offset:768 nt lds
    v_cvt_pk_bf16_f32 v184, v184, v185
    v_smfmac_f32_16x16x64_bf16 v[136:139], a[120:123], v[220:227], v25 abid:1
    ds_read2st64_b32 v[250:251], v239 offset0:0 offset1:72
    ds_read_b128 v[236:239], v9 offset:9216
    v_cvt_pk_bf16_f32 v185, v186, v187
    v_smfmac_f32_16x16x64_bf16 v[136:139], a[156:159], v[228:235], v29 abid:1
    v_cvt_pk_bf16_f32 v186, v188, v189
    v_smfmac_f32_16x16x64_bf16 v[140:143], a[124:127], v[220:227], v26
    v_cvt_pk_bf16_f32 v187, v190, v191
    v_smfmac_f32_16x16x64_bf16 v[140:143], a[160:163], v[228:235], v30
    ds_read_b128 v[188:191], v9 offset:10688
    v_cndmask_b32_dpp v180, v176, v184, vcc row_ror:8 row_mask:0xf bank_mask:0xf
    v_smfmac_f32_16x16x64_bf16 v[144:147], a[128:131], v[220:227], v26 abid:1
    v_cndmask_b32_dpp v181, v177, v185, vcc row_ror:8 row_mask:0xf bank_mask:0xf
    v_smfmac_f32_16x16x64_bf16 v[144:147], a[164:167], v[228:235], v30 abid:1
    v_cndmask_b32_dpp v182, v178, v186, vcc row_ror:8 row_mask:0xf bank_mask:0xf
    v_smfmac_f32_16x16x64_bf16 v[148:151], a[132:135], v[220:227], v27
    v_cndmask_b32_dpp v183, v179, v187, vcc row_ror:8 row_mask:0xf bank_mask:0xf
    v_smfmac_f32_16x16x64_bf16 v[148:151], a[168:171], v[228:235], v31
    s_waitcnt vmcnt(6)
    buffer_store_dwordx4 v[180:183], v6, s[12:15], s58 offen offset:128 sc1
    s_waitcnt lgkmcnt(8)
    v_xad_u32 v212, v216, v3, v4
    v_smfmac_f32_16x16x64_bf16 v[132:135], a[116:119], v[220:227], v25
    ds_read2st64_b32 v[212:213], v212 offset0:0 offset1:72
    v_xad_u32 v214, v217, v3, v4
    v_smfmac_f32_16x16x64_bf16 v[132:135], a[152:155], v[228:235], v29
    ds_read2st64_b32 v[214:215], v214 offset0:0 offset1:72
    s_waitcnt lgkmcnt(3)
    v_xad_u32 v236, v236, v3, v4
    v_smfmac_f32_16x16x64_bf16 v[132:135], v[240:243], v[244:251], v10
    v_xad_u32 v237, v237, v3, v4
    v_smfmac_f32_16x16x64_bf16 v[168:171], v[240:243], v[244:251], v10 abid:1
    ds_read2st64_b32 v[244:245], v236 offset0:0 offset1:72
    ds_read_b128 v[240:243], v8 offset:0
    v_xad_u32 v238, v238, v3, v4
    v_smfmac_f32_16x16x64_bf16 v[156:159], a[140:143], v[220:227], v49 abid:1
    ds_read2st64_b32 v[246:247], v237 offset0:0 offset1:72
    v_xad_u32 v239, v239, v3, v4
    v_smfmac_f32_16x16x64_bf16 v[156:159], a[176:179], v[228:235], v50
    ds_read2st64_b32 v[248:249], v238 offset0:0 offset1:72
    v_mov_b32_dpp v176, v184 row_ror:8 row_mask:0xf bank_mask:0xc
    v_smfmac_f32_16x16x64_bf16 v[140:143], a[196:199], v[196:203], v34
    ds_read2st64_b32 v[250:251], v239 offset0:0 offset1:72
    ds_read_b128 v[236:239], v9 offset:9728
    v_mov_b32_dpp v177, v185 row_ror:8 row_mask:0xf bank_mask:0xc
    v_smfmac_f32_16x16x64_bf16 v[140:143], a[232:235], v[204:211], v38
    v_mov_b32_dpp v178, v186 row_ror:8 row_mask:0xf bank_mask:0xc
    v_smfmac_f32_16x16x64_bf16 v[128:131], a[184:187], v[196:203], v32 abid:1
    v_mov_b32_dpp v179, v187 row_ror:8 row_mask:0xf bank_mask:0xc
    v_smfmac_f32_16x16x64_bf16 v[128:131], a[220:223], v[204:211], v36 abid:1
    s_waitcnt vmcnt(5)
    buffer_store_dwordx4 v[176:179], v6, s[12:15], s23 offen offset:128 sc1
    ds_read_b128 v[180:183], v9 offset:10560
    v_smfmac_f32_16x16x64_bf16 v[132:135], a[188:191], v[196:203], v33
    ds_read_b128 v[184:187], v9 offset:10624
    ds_read_b128 v[176:179], v9 offset:10496
    v_smfmac_f32_16x16x64_bf16 v[132:135], a[224:227], v[204:211], v37
    v_smfmac_f32_16x16x64_bf16 v[136:139], a[192:195], v[196:203], v33 abid:1
    ds_read_b128 v[220:223], v1 offset:7168
    v_smfmac_f32_16x16x64_bf16 v[136:139], a[228:231], v[204:211], v37 abid:1
    ds_read_b128 v[224:227], v2 offset:7168
    v_smfmac_f32_16x16x64_bf16 v[124:127], a[180:183], v[196:203], v32
    ds_read_b128 v[228:231], v1 offset:8192
    v_smfmac_f32_16x16x64_bf16 v[124:127], a[216:219], v[204:211], v36
    s_waitcnt vmcnt(7)
    s_waitcnt lgkmcnt(6)
    v_xad_u32 v236, v236, v3, v4
    v_smfmac_f32_16x16x64_bf16 v[124:127], v[240:243], v[244:251], v10
    ds_read_b128 v[232:235], v2 offset:8192
    v_xad_u32 v237, v237, v3, v4
    v_smfmac_f32_16x16x64_bf16 v[160:163], v[240:243], v[244:251], v10 abid:1
    ds_read2st64_b32 v[244:245], v236 offset0:0 offset1:72
    ds_read_b128 v[240:243], v8 offset:8192
    v_xad_u32 v238, v238, v3, v4
    v_smfmac_f32_16x16x64_bf16 v[144:147], a[200:203], v[196:203], v34 abid:1
    ds_read2st64_b32 v[246:247], v237 offset0:0 offset1:72
    v_xad_u32 v239, v239, v3, v4
    v_smfmac_f32_16x16x64_bf16 v[144:147], a[236:239], v[204:211], v38 abid:1
    ds_read2st64_b32 v[248:249], v238 offset0:0 offset1:72
    v_mul_u32_u24 v0, s94, v0
    v_smfmac_f32_16x16x64_bf16 v[148:151], a[204:207], v[196:203], v35
    ds_read2st64_b32 v[250:251], v239 offset0:0 offset1:72
    ds_read_b128 v[236:239], v9 offset:9664
    v_add_u32 v0, s93, v0
    v_smfmac_f32_16x16x64_bf16 v[148:151], a[240:243], v[204:211], v39
    s_waitcnt lgkmcnt(10)
    s_cmp_lt_i32 s81, 0
    s_cbranch_scc1 M_ovrE0
    s_swappc_b64 s[78:79], s[72:73]
M_ovrE0:
    v_smfmac_f32_16x16x64_bf16 v[152:155], a[208:211], v[196:203], v35 abid:1
    s_add_u32 m0, m0, 896
    v_min_u32 v0, 75497472, v0
    v_smfmac_f32_16x16x64_bf16 v[152:155], a[244:247], v[204:211], v39 abid:1
    ds_write_b32 v11, v0
    s_waitcnt vmcnt(6)
    v_mov_b32 v0, 162048
    v_smfmac_f32_16x16x64_bf16 v[156:159], a[212:215], v[196:203], v50 abid:1
    buffer_load_dwordx4 v5, s[8:11], s22 offen offset:896 nt lds
    v_smfmac_f32_16x16x64_bf16 v[156:159], a[248:251], v[204:211], v51
    s_waitcnt lgkmcnt(9)
    v_smfmac_f32_16x16x64_bf16 v[124:127], a[252:255], v[220:227], v40
    ds_read_b128 v[196:199], v1 offset:18432
    s_waitcnt lgkmcnt(8)
    v_smfmac_f32_16x16x64_bf16 v[124:127], v[88:91], v[228:235], v44
    ds_read_b128 v[200:203], v2 offset:18432
    v_smfmac_f32_16x16x64_bf16 v[156:159], v[84:87], v[220:227], v51 abid:1
    ds_read_b128 v[204:207], v1 offset:19456
    v_smfmac_f32_16x16x64_bf16 v[156:159], v[120:123], v[228:235], v52
    s_waitcnt lgkmcnt(3)
    s_barrier
    v_xad_u32 v236, v236, v3, v4
    v_smfmac_f32_16x16x64_bf16 v[156:159], v[240:243], v[244:251], v10
    ds_read_b128 v[208:211], v2 offset:19456
    ds_read_b32 v0, v0
    v_xad_u32 v237, v237, v3, v4
    v_smfmac_f32_16x16x64_bf16 v[192:195], v[240:243], v[244:251], v10 abid:1
    ds_read2st64_b32 v[244:245], v236 offset0:0 offset1:72
    ds_read_b128 v[240:243], v8 offset:7168
    v_xad_u32 v238, v238, v3, v4
    v_smfmac_f32_16x16x64_bf16 v[132:135], v[60:63], v[220:227], v41
    ds_read2st64_b32 v[246:247], v237 offset0:0 offset1:72
    v_xad_u32 v239, v239, v3, v4
    v_smfmac_f32_16x16x64_bf16 v[132:135], v[96:99], v[228:235], v45
    ds_read2st64_b32 v[248:249], v238 offset0:0 offset1:72
    s_add_u32 m0, m0, 896
    v_smfmac_f32_16x16x64_bf16 v[136:139], v[64:67], v[220:227], v41 abid:1
    ds_read2st64_b32 v[250:251], v239 offset0:0 offset1:72
    ds_read_b128 v[236:239], v9 offset:9536
    s_waitcnt vmcnt(5)
    v_smfmac_f32_16x16x64_bf16 v[136:139], v[100:103], v[228:235], v45 abid:1
    buffer_load_dwordx4 v5, s[8:11], s22 offen offset:1024 nt lds
    s_waitcnt lgkmcnt(6)
    v_readfirstlane_b32 s88, v0
    v_smfmac_f32_16x16x64_bf16 v[140:143], v[68:71], v[220:227], v42
    s_cmp_lt_u32 s88, s99
    s_cselect_b32 s10, 75497472, 0
    v_smfmac_f32_16x16x64_bf16 v[140:143], v[104:107], v[228:235], v46
    v_smfmac_f32_16x16x64_bf16 v[144:147], v[72:75], v[220:227], v42 abid:1
    ds_read_b128 v[212:215], v1 offset:20480
    v_smfmac_f32_16x16x64_bf16 v[144:147], v[108:111], v[228:235], v46 abid:1
    ds_read_b128 v[216:219], v2 offset:20480
    v_smfmac_f32_16x16x64_bf16 v[148:151], v[76:79], v[220:227], v43
    v_smfmac_f32_16x16x64_bf16 v[148:151], v[112:115], v[228:235], v47
    v_smfmac_f32_16x16x64_bf16 v[152:155], v[80:83], v[220:227], v43 abid:1
    v_smfmac_f32_16x16x64_bf16 v[152:155], v[116:119], v[228:235], v47 abid:1
    s_waitcnt lgkmcnt(2)
    v_xad_u32 v236, v236, v3, v4
    v_smfmac_f32_16x16x64_bf16 v[152:155], v[240:243], v[244:251], v10
    v_xad_u32 v237, v237, v3, v4
    v_smfmac_f32_16x16x64_bf16 v[188:191], v[240:243], v[244:251], v10 abid:1
    s_cmp_gt_u32 s46, s80
    s_cbranch_scc1 M_slow
M_slowrE0:
    v_xad_u32 v238, v238, v3, v4
    v_smfmac_f32_16x16x64_bf16 v[128:131], v[56:59], v[220:227], v40 abid:1
    ds_read2st64_b32 v[244:245], v236 offset0:0 offset1:72
    ds_read_b128 v[240:243], v8 offset:5120
    v_xad_u32 v239, v239, v3, v4
    v_smfmac_f32_16x16x64_bf16 v[128:131], v[92:95], v[228:235], v44 abid:1
    ds_read2st64_b32 v[246:247], v237 offset0:0 offset1:72
    v_smfmac_f32_16x16x64_bf16 v[160:163], a[0:3], v[196:203], v12
    ds_read2st64_b32 v[248:249], v238 offset0:0 offset1:72
    v_smfmac_f32_16x16x64_bf16 v[160:163], a[36:39], v[204:211], v16
    ds_read2st64_b32 v[250:251], v239 offset0:0 offset1:72
    ds_read_b128 v[236:239], v9 offset:9600
    s_waitcnt lgkmcnt(6)
    v_smfmac_f32_16x16x64_bf16 v[160:163], a[72:75], v[212:219], v20
    v_smfmac_f32_16x16x64_bf16 v[164:167], a[4:7], v[196:203], v12 abid:1
    s_mov_b32 m0, s28
    v_cvt_pk_bf16_f32 v156, v156, v157
    v_smfmac_f32_16x16x64_bf16 v[164:167], a[40:43], v[204:211], v16 abid:1
    s_waitcnt vmcnt(6)
    buffer_load_dwordx4 v5, s[8:11], s88 offen offset:0 nt lds
    v_cvt_pk_bf16_f32 v157, v158, v159
    v_smfmac_f32_16x16x64_bf16 v[164:167], a[76:79], v[212:219], v20 abid:1
    ds_write_b64 v53, v[156:157] offset:25728
    ds_read_b128 v[156:159], v9 offset:10752
    v_smfmac_f32_16x16x64_bf16 v[180:183], a[20:23], v[196:203], v14 abid:1
    v_smfmac_f32_16x16x64_bf16 v[180:183], a[56:59], v[204:211], v18 abid:1
    ds_read_b128 v[220:223], v1 offset:21504
    v_cvt_pk_bf16_f32 v124, v124, v125
    v_smfmac_f32_16x16x64_bf16 v[180:183], a[92:95], v[212:219], v22 abid:1
    s_waitcnt lgkmcnt(3)
    v_xad_u32 v236, v236, v3, v4
    v_smfmac_f32_16x16x64_bf16 v[180:183], v[240:243], v[244:251], v10 abid:1
    v_xad_u32 v237, v237, v3, v4
    v_smfmac_f32_16x16x64_bf16 v[144:147], v[240:243], v[244:251], v10
    ds_read2st64_b32 v[244:245], v236 offset0:0 offset1:72
    ds_read_b128 v[240:243], v8 offset:6144
    v_xad_u32 v238, v238, v3, v4
    v_smfmac_f32_16x16x64_bf16 v[172:175], a[12:15], v[196:203], v13 abid:1
    ds_read2st64_b32 v[246:247], v237 offset0:0 offset1:72
    v_xad_u32 v239, v239, v3, v4
    v_smfmac_f32_16x16x64_bf16 v[172:175], a[48:51], v[204:211], v17 abid:1
    ds_read2st64_b32 v[248:249], v238 offset0:0 offset1:72
    v_cvt_pk_bf16_f32 v125, v126, v127
    v_smfmac_f32_16x16x64_bf16 v[172:175], a[84:87], v[212:219], v21 abid:1
    ds_read2st64_b32 v[250:251], v239 offset0:0 offset1:72
    ds_read_b128 v[236:239], v9 offset:9472
    v_cvt_pk_bf16_f32 v126, v128, v129
    v_smfmac_f32_16x16x64_bf16 v[176:179], a[16:19], v[196:203], v14
    v_cvt_pk_bf16_f32 v127, v130, v131
    v_smfmac_f32_16x16x64_bf16 v[176:179], a[52:55], v[204:211], v18
    v_cvt_pk_bf16_f32 v132, v132, v133
    v_smfmac_f32_16x16x64_bf16 v[176:179], a[88:91], v[212:219], v22
    v_cvt_pk_bf16_f32 v133, v134, v135
    v_smfmac_f32_16x16x64_bf16 v[168:171], a[8:11], v[196:203], v13
    s_add_u32 m0, m0, 896
    v_cvt_pk_bf16_f32 v134, v136, v137
    v_smfmac_f32_16x16x64_bf16 v[168:171], a[44:47], v[204:211], v17
    s_waitcnt vmcnt(5)
    buffer_load_dwordx4 v5, s[8:11], s88 offen offset:128 nt lds
    v_cvt_pk_bf16_f32 v135, v138, v139
    v_smfmac_f32_16x16x64_bf16 v[168:171], a[80:83], v[212:219], v21
    ds_read_b128 v[224:227], v2 offset:21504
    ds_read_b128 v[136:139], v9 offset:10432
    v_cndmask_b32_dpp v128, v124, v132, vcc row_ror:8 row_mask:0xf bank_mask:0xf
    v_smfmac_f32_16x16x64_bf16 v[184:187], a[24:27], v[196:203], v15
    ds_read_b128 v[228:231], v1 offset:22528
    v_cndmask_b32_dpp v129, v125, v133, vcc row_ror:8 row_mask:0xf bank_mask:0xf
    v_smfmac_f32_16x16x64_bf16 v[184:187], a[60:63], v[204:211], v19
    ds_read_b128 v[232:235], v2 offset:22528
    v_cndmask_b32_dpp v130, v126, v134, vcc row_ror:8 row_mask:0xf bank_mask:0xf
    v_smfmac_f32_16x16x64_bf16 v[184:187], a[96:99], v[212:219], v23
    s_waitcnt lgkmcnt(4)
    v_xad_u32 v236, v236, v3, v4
    v_smfmac_f32_16x16x64_bf16 v[184:187], v[240:243], v[244:251], v10 abid:1
    v_xad_u32 v237, v237, v3, v4
    v_smfmac_f32_16x16x64_bf16 v[148:151], v[240:243], v[244:251], v10
    ds_read2st64_b32 v[244:245], v236 offset0:0 offset1:72
    ds_read_b128 v[240:243], v8 offset:4096
    v_xad_u32 v238, v238, v3, v4
    v_smfmac_f32_16x16x64_bf16 v[188:191], a[28:31], v[196:203], v15 abid:1
    ds_read2st64_b32 v[246:247], v237 offset0:0 offset1:72
    v_xad_u32 v239, v239, v3, v4
    v_smfmac_f32_16x16x64_bf16 v[188:191], a[64:67], v[204:211], v19 abid:1
    ds_read2st64_b32 v[248:249], v238 offset0:0 offset1:72
    v_cndmask_b32_dpp v131, v127, v135, vcc row_ror:8 row_mask:0xf bank_mask:0xf
    v_smfmac_f32_16x16x64_bf16 v[188:191], a[100:103], v[212:219], v23 abid:1
    ds_read2st64_b32 v[250:251], v239 offset0:0 offset1:72
    s_waitcnt vmcnt(6)
    buffer_store_dwordx4 v[128:131], v6, s[12:15], s59 offen offset:0 sc1
    v_smfmac_f32_16x16x64_bf16 v[192:195], a[32:35], v[196:203], v48
    v_mov_b32_dpp v124, v132 row_ror:8 row_mask:0xf bank_mask:0xc
    v_smfmac_f32_16x16x64_bf16 v[192:195], a[68:71], v[204:211], v48 abid:1
    v_mov_b32_dpp v125, v133 row_ror:8 row_mask:0xf bank_mask:0xc
    v_smfmac_f32_16x16x64_bf16 v[192:195], a[104:107], v[212:219], v49
    s_waitcnt lgkmcnt(8)
    v_mov_b32_dpp v126, v134 row_ror:8 row_mask:0xf bank_mask:0xc
    v_smfmac_f32_16x16x64_bf16 v[160:163], a[108:111], v[220:227], v24
    s_waitcnt lgkmcnt(5)
    v_mov_b32_dpp v127, v135 row_ror:8 row_mask:0xf bank_mask:0xc
    v_smfmac_f32_16x16x64_bf16 v[160:163], a[144:147], v[228:235], v28
    ds_read_b128 v[196:199], v1 offset:23552
    s_waitcnt vmcnt(5)
    buffer_store_dwordx4 v[124:127], v6, s[12:15], s24 offen offset:0 sc1
    v_smfmac_f32_16x16x64_bf16 v[164:167], a[112:115], v[220:227], v24 abid:1
    ds_read_b128 v[200:203], v2 offset:23552
    ds_read_b128 v[128:131], v9 offset:10304
    ds_read_b128 v[132:135], v9 offset:10368
    v_smfmac_f32_16x16x64_bf16 v[164:167], a[148:151], v[228:235], v28 abid:1
    ds_read_b128 v[204:207], v1 offset:24576
    ds_read_b128 v[124:127], v9 offset:10240
    v_smfmac_f32_16x16x64_bf16 v[176:179], a[124:127], v[220:227], v26
    ds_read_b128 v[208:211], v2 offset:24576
    v_smfmac_f32_16x16x64_bf16 v[176:179], a[160:163], v[228:235], v30
    s_waitcnt lgkmcnt(7)
    v_smfmac_f32_16x16x64_bf16 v[176:179], v[240:243], v[244:251], v10 abid:1
    v_smfmac_f32_16x16x64_bf16 v[140:143], v[240:243], v[244:251], v10
    v_smfmac_f32_16x16x64_bf16 v[172:175], a[120:123], v[220:227], v25 abid:1
    s_add_u32 s28, s28, 36864
    s_cmp_ge_u32 s28, 110592
    s_cselect_b32 s28, s26, s28
    v_smfmac_f32_16x16x64_bf16 v[172:175], a[156:159], v[228:235], v29 abid:1
    s_add_u32 s30, s25, 36864
    s_cmp_eq_u32 s30, 110592
    s_cselect_b32 s30, 0, s30
    v_smfmac_f32_16x16x64_bf16 v[168:171], a[116:119], v[220:227], v25
    s_sub_u32 s31, s30, s25
    s_mov_b32 s25, s30
    s_mov_b32 s90, s22
    v_smfmac_f32_16x16x64_bf16 v[168:171], a[152:155], v[228:235], v29
    s_mov_b32 s22, s88
    s_add_u32 s91, s91, 1
    s_cmp_lt_u32 s20, 2
    v_smfmac_f32_16x16x64_bf16 v[180:183], a[128:131], v[220:227], v26 abid:1
    s_cselect_b32 s66, s23, s24
    s_add_u32 s66, s66, s95
    v_smfmac_f32_16x16x64_bf16 v[180:183], a[164:167], v[228:235], v30 abid:1
    v_cvt_pk_bf16_f32 v140, v140, v141
    v_smfmac_f32_16x16x64_bf16 v[184:187], a[132:135], v[220:227], v27
    s_add_u32 m0, m0, 896
    v_cvt_pk_bf16_f32 v141, v142, v143
    v_smfmac_f32_16x16x64_bf16 v[184:187], a[168:171], v[228:235], v31
    s_waitcnt vmcnt(6)
    buffer_load_dwordx4 v5, s[8:11], s88 offen offset:256 nt lds
    v_cvt_pk_bf16_f32 v142, v144, v145
    v_smfmac_f32_16x16x64_bf16 v[188:191], a[136:139], v[220:227], v27 abid:1
    v_cvt_pk_bf16_f32 v143, v146, v147
    v_smfmac_f32_16x16x64_bf16 v[188:191], a[172:175], v[228:235], v31 abid:1
    v_cvt_pk_bf16_f32 v148, v148, v149
    v_smfmac_f32_16x16x64_bf16 v[192:195], a[140:143], v[220:227], v49 abid:1
    v_cvt_pk_bf16_f32 v149, v150, v151
    v_smfmac_f32_16x16x64_bf16 v[192:195], a[176:179], v[228:235], v50
    ds_read_b128 v[220:223], v1 offset:25600
    s_waitcnt lgkmcnt(6)
    v_cvt_pk_bf16_f32 v150, v152, v153
    v_smfmac_f32_16x16x64_bf16 v[160:163], a[180:183], v[196:203], v32
    ds_read_b128 v[224:227], v2 offset:25600
    s_waitcnt lgkmcnt(2)
    v_cvt_pk_bf16_f32 v151, v154, v155
    v_smfmac_f32_16x16x64_bf16 v[160:163], a[216:219], v[204:211], v36
    ds_read_b128 v[228:231], v1 offset:26624
    ds_read_b128 v[152:155], v9 offset:10688
    v_cndmask_b32_dpp v144, v140, v148, vcc row_ror:8 row_mask:0xf bank_mask:0xf
    v_smfmac_f32_16x16x64_bf16 v[164:167], a[184:187], v[196:203], v32 abid:1
    ds_read_b128 v[232:235], v2 offset:26624
    v_cndmask_b32_dpp v145, v141, v149, vcc row_ror:8 row_mask:0xf bank_mask:0xf
    v_smfmac_f32_16x16x64_bf16 v[164:167], a[220:223], v[204:211], v36 abid:1
    s_add_u32 m0, m0, 896
    v_cndmask_b32_dpp v146, v142, v150, vcc row_ror:8 row_mask:0xf bank_mask:0xf
    v_smfmac_f32_16x16x64_bf16 v[168:171], a[188:191], v[196:203], v33
    s_waitcnt vmcnt(5)
    buffer_load_dwordx4 v5, s[8:11], s88 offen offset:384 nt lds
    v_cndmask_b32_dpp v147, v143, v151, vcc row_ror:8 row_mask:0xf bank_mask:0xf
    v_smfmac_f32_16x16x64_bf16 v[168:171], a[224:227], v[204:211], v37
    s_waitcnt vmcnt(6)
    buffer_store_dwordx4 v[144:147], v6, s[12:15], s59 offen offset:128 sc1
    v_mov_b32_dpp v140, v148 row_ror:8 row_mask:0xf bank_mask:0xc
    v_smfmac_f32_16x16x64_bf16 v[172:175], a[192:195], v[196:203], v33 abid:1
    v_mov_b32_dpp v141, v149 row_ror:8 row_mask:0xf bank_mask:0xc
    v_smfmac_f32_16x16x64_bf16 v[172:175], a[228:231], v[204:211], v37 abid:1
    v_mov_b32_dpp v142, v150 row_ror:8 row_mask:0xf bank_mask:0xc
    v_smfmac_f32_16x16x64_bf16 v[176:179], a[196:199], v[196:203], v34
    v_mov_b32_dpp v143, v151 row_ror:8 row_mask:0xf bank_mask:0xc
    v_smfmac_f32_16x16x64_bf16 v[176:179], a[232:235], v[204:211], v38
    s_waitcnt vmcnt(5)
    buffer_store_dwordx4 v[140:143], v6, s[12:15], s24 offen offset:128 sc1
    ds_read_b128 v[144:147], v9 offset:10560
    v_smfmac_f32_16x16x64_bf16 v[180:183], a[200:203], v[196:203], v34 abid:1
    ds_read_b128 v[148:151], v9 offset:10624
    ds_read_b128 v[140:143], v9 offset:10496
    v_add_u32 v4, s31, v4
    v_smfmac_f32_16x16x64_bf16 v[180:183], a[236:239], v[204:211], v38 abid:1
    v_add_u32 v1, s31, v1
    v_smfmac_f32_16x16x64_bf16 v[184:187], a[204:207], v[196:203], v35
    v_add_u32 v2, s31, v2
    v_smfmac_f32_16x16x64_bf16 v[184:187], a[240:243], v[204:211], v39
    v_smfmac_f32_16x16x64_bf16 v[188:191], a[208:211], v[196:203], v35 abid:1
    v_smfmac_f32_16x16x64_bf16 v[188:191], a[244:247], v[204:211], v39 abid:1
    v_smfmac_f32_16x16x64_bf16 v[192:195], a[212:215], v[196:203], v50 abid:1
    v_smfmac_f32_16x16x64_bf16 v[192:195], a[248:251], v[204:211], v51
    s_waitcnt vmcnt(8)
    s_branch M_top1
M_q:
    s_mov_b32 s21, 3
    v_smfmac_f32_16x16x64_bf16 v[144:147], v[72:75], v[220:227], v42 abid:1
    ds_read_b128 v[212:215], v1 offset:20480
    v_smfmac_f32_16x16x64_bf16 v[144:147], v[108:111], v[228:235], v46 abid:1
    ds_read_b128 v[216:219], v2 offset:20480
    v_smfmac_f32_16x16x64_bf16 v[148:151], v[76:79], v[220:227], v43
    v_smfmac_f32_16x16x64_bf16 v[148:151], v[112:115], v[228:235], v47
    v_smfmac_f32_16x16x64_bf16 v[152:155], v[80:83], v[220:227], v43 abid:1
    v_smfmac_f32_16x16x64_bf16 v[152:155], v[116:119], v[228:235], v47 abid:1
    s_waitcnt lgkmcnt(2)
    v_xad_u32 v236, v236, v3, v4
    v_smfmac_f32_16x16x64_bf16 v[152:155], v[240:243], v[244:251], v10
    v_xad_u32 v237, v237, v3, v4
    v_smfmac_f32_16x16x64_bf16 v[188:191], v[240:243], v[244:251], v10 abid:1
    s_cmp_gt_u32 s46, s80
    s_cbranch_scc1 M_slow
M_slowrQ:
    v_xad_u32 v238, v238, v3, v4
    v_smfmac_f32_16x16x64_bf16 v[128:131], v[56:59], v[220:227], v40 abid:1
    ds_read2st64_b32 v[244:245], v236 offset0:0 offset1:72
    ds_read_b128 v[240:243], v8 offset:5120
    v_xad_u32 v239, v239, v3, v4
    v_smfmac_f32_16x16x64_bf16 v[128:131], v[92:95], v[228:235], v44 abid:1
    ds_read2st64_b32 v[246:247], v237 offset0:0 offset1:72
    v_smfmac_f32_16x16x64_bf16 v[160:163], a[0:3], v[196:203], v12
    ds_read2st64_b32 v[248:249], v238 offset0:0 offset1:72
    v_smfmac_f32_16x16x64_bf16 v[160:163], a[36:39], v[204:211], v16
    ds_read2st64_b32 v[250:251], v239 offset0:0 offset1:72
    ds_read_b128 v[236:239], v9 offset:9600
    s_waitcnt lgkmcnt(6)
    v_smfmac_f32_16x16x64_bf16 v[160:163], a[72:75], v[212:219], v20
    v_smfmac_f32_16x16x64_bf16 v[164:167], a[4:7], v[196:203], v12 abid:1
    v_cvt_pk_bf16_f32 v156, v156, v157
    v_smfmac_f32_16x16x64_bf16 v[164:167], a[40:43], v[204:211], v16 abid:1
    v_cvt_pk_bf16_f32 v157, v158, v159
    v_smfmac_f32_16x16x64_bf16 v[164:167], a[76:79], v[212:219], v20 abid:1
    ds_write_b64 v53, v[156:157] offset:25728
    ds_read_b128 v[156:159], v9 offset:10752
    v_smfmac_f32_16x16x64_bf16 v[180:183], a[20:23], v[196:203], v14 abid:1
    v_smfmac_f32_16x16x64_bf16 v[180:183], a[56:59], v[204:211], v18 abid:1
    ds_read_b128 v[220:223], v1 offset:21504
    v_cvt_pk_bf16_f32 v124, v124, v125
    v_smfmac_f32_16x16x64_bf16 v[180:183], a[92:95], v[212:219], v22 abid:1
    s_waitcnt lgkmcnt(3)
    v_xad_u32 v236, v236, v3, v4
    v_smfmac_f32_16x16x64_bf16 v[180:183], v[240:243], v[244:251], v10 abid:1
    v_xad_u32 v237, v237, v3, v4
    v_smfmac_f32_16x16x64_bf16 v[144:147], v[240:243], v[244:251], v10
    ds_read2st64_b32 v[244:245], v236 offset0:0 offset1:72
    ds_read_b128 v[240:243], v8 offset:6144
    v_xad_u32 v238, v238, v3, v4
    v_smfmac_f32_16x16x64_bf16 v[172:175], a[12:15], v[196:203], v13 abid:1
    ds_read2st64_b32 v[246:247], v237 offset0:0 offset1:72
    v_xad_u32 v239, v239, v3, v4
    v_smfmac_f32_16x16x64_bf16 v[172:175], a[48:51], v[204:211], v17 abid:1
    ds_read2st64_b32 v[248:249], v238 offset0:0 offset1:72
    v_cvt_pk_bf16_f32 v125, v126, v127
    v_smfmac_f32_16x16x64_bf16 v[172:175], a[84:87], v[212:219], v21 abid:1
    ds_read2st64_b32 v[250:251], v239 offset0:0 offset1:72
    ds_read_b128 v[236:239], v9 offset:9472
    v_cvt_pk_bf16_f32 v126, v128, v129
    v_smfmac_f32_16x16x64_bf16 v[176:179], a[16:19], v[196:203], v14
    v_cvt_pk_bf16_f32 v127, v130, v131
    v_smfmac_f32_16x16x64_bf16 v[176:179], a[52:55], v[204:211], v18
    v_cvt_pk_bf16_f32 v132, v132, v133
    v_smfmac_f32_16x16x64_bf16 v[176:179], a[88:91], v[212:219], v22
    v_cvt_pk_bf16_f32 v133, v134, v135
    v_smfmac_f32_16x16x64_bf16 v[168:171], a[8:11], v[196:203], v13
    v_cvt_pk_bf16_f32 v134, v136, v137
    v_smfmac_f32_16x16x64_bf16 v[168:171], a[44:47], v[204:211], v17
    v_cvt_pk_bf16_f32 v135, v138, v139
    v_smfmac_f32_16x16x64_bf16 v[168:171], a[80:83], v[212:219], v21
    ds_read_b128 v[224:227], v2 offset:21504
    ds_read_b128 v[136:139], v9 offset:10432
    v_cndmask_b32_dpp v128, v124, v132, vcc row_ror:8 row_mask:0xf bank_mask:0xf
    v_smfmac_f32_16x16x64_bf16 v[184:187], a[24:27], v[196:203], v15
    ds_read_b128 v[228:231], v1 offset:22528
    v_cndmask_b32_dpp v129, v125, v133, vcc row_ror:8 row_mask:0xf bank_mask:0xf
    v_smfmac_f32_16x16x64_bf16 v[184:187], a[60:63], v[204:211], v19
    ds_read_b128 v[232:235], v2 offset:22528
    v_cndmask_b32_dpp v130, v126, v134, vcc row_ror:8 row_mask:0xf bank_mask:0xf
    v_smfmac_f32_16x16x64_bf16 v[184:187], a[96:99], v[212:219], v23
    s_waitcnt lgkmcnt(4)
    v_xad_u32 v236, v236, v3, v4
    v_smfmac_f32_16x16x64_bf16 v[184:187], v[240:243], v[244:251], v10 abid:1
    v_xad_u32 v237, v237, v3, v4
    v_smfmac_f32_16x16x64_bf16 v[148:151], v[240:243], v[244:251], v10
    ds_read2st64_b32 v[244:245], v236 offset0:0 offset1:72
    ds_read_b128 v[240:243], v8 offset:4096
    v_xad_u32 v238, v238, v3, v4
    v_smfmac_f32_16x16x64_bf16 v[188:191], a[28:31], v[196:203], v15 abid:1
    ds_read2st64_b32 v[246:247], v237 offset0:0 offset1:72
    v_xad_u32 v239, v239, v3, v4
    v_smfmac_f32_16x16x64_bf16 v[188:191], a[64:67], v[204:211], v19 abid:1
    ds_read2st64_b32 v[248:249], v238 offset0:0 offset1:72
    v_cndmask_b32_dpp v131, v127, v135, vcc row_ror:8 row_mask:0xf bank_mask:0xf
    v_smfmac_f32_16x16x64_bf16 v[188:191], a[100:103], v[212:219], v23 abid:1
    ds_read2st64_b32 v[250:251], v239 offset0:0 offset1:72
    buffer_store_dwordx4 v[128:131], v6, s[12:15], s59 offen offset:0 sc1
    v_smfmac_f32_16x16x64_bf16 v[192:195], a[32:35], v[196:203], v48
    v_mov_b32_dpp v124, v132 row_ror:8 row_mask:0xf bank_mask:0xc
    v_smfmac_f32_16x16x64_bf16 v[192:195], a[68:71], v[204:211], v48 abid:1
    v_mov_b32_dpp v125, v133 row_ror:8 row_mask:0xf bank_mask:0xc
    v_smfmac_f32_16x16x64_bf16 v[192:195], a[104:107], v[212:219], v49
    s_waitcnt lgkmcnt(8)
    v_mov_b32_dpp v126, v134 row_ror:8 row_mask:0xf bank_mask:0xc
    v_smfmac_f32_16x16x64_bf16 v[160:163], a[108:111], v[220:227], v24
    s_waitcnt lgkmcnt(5)
    v_mov_b32_dpp v127, v135 row_ror:8 row_mask:0xf bank_mask:0xc
    v_smfmac_f32_16x16x64_bf16 v[160:163], a[144:147], v[228:235], v28
    ds_read_b128 v[196:199], v1 offset:23552
    buffer_store_dwordx4 v[124:127], v6, s[12:15], s24 offen offset:0 sc1
    v_smfmac_f32_16x16x64_bf16 v[164:167], a[112:115], v[220:227], v24 abid:1
    ds_read_b128 v[200:203], v2 offset:23552
    ds_read_b128 v[128:131], v9 offset:10304
    ds_read_b128 v[132:135], v9 offset:10368
    v_smfmac_f32_16x16x64_bf16 v[164:167], a[148:151], v[228:235], v28 abid:1
    ds_read_b128 v[204:207], v1 offset:24576
    ds_read_b128 v[124:127], v9 offset:10240
    v_smfmac_f32_16x16x64_bf16 v[176:179], a[124:127], v[220:227], v26
    ds_read_b128 v[208:211], v2 offset:24576
    v_smfmac_f32_16x16x64_bf16 v[176:179], a[160:163], v[228:235], v30
    s_waitcnt lgkmcnt(7)
    v_smfmac_f32_16x16x64_bf16 v[176:179], v[240:243], v[244:251], v10 abid:1
    v_smfmac_f32_16x16x64_bf16 v[140:143], v[240:243], v[244:251], v10
    v_smfmac_f32_16x16x64_bf16 v[172:175], a[120:123], v[220:227], v25 abid:1
    s_add_u32 s28, s28, 36864
    s_cmp_ge_u32 s28, 110592
    s_cselect_b32 s28, s26, s28
    v_smfmac_f32_16x16x64_bf16 v[172:175], a[156:159], v[228:235], v29 abid:1
    s_add_u32 s30, s25, 36864
    s_cmp_eq_u32 s30, 110592
    s_cselect_b32 s30, 0, s30
    v_smfmac_f32_16x16x64_bf16 v[168:171], a[116:119], v[220:227], v25
    s_sub_u32 s31, s30, s25
    s_mov_b32 s25, s30
    s_mov_b32 s90, s22
    v_smfmac_f32_16x16x64_bf16 v[168:171], a[152:155], v[228:235], v29
    s_mov_b32 s22, s88
    s_add_u32 s91, s91, 1
    s_cmp_lt_u32 s20, 2
    v_smfmac_f32_16x16x64_bf16 v[180:183], a[128:131], v[220:227], v26 abid:1
    s_cselect_b32 s66, s23, s24
    s_add_u32 s66, s66, s95
    v_smfmac_f32_16x16x64_bf16 v[180:183], a[164:167], v[228:235], v30 abid:1
    v_cvt_pk_bf16_f32 v140, v140, v141
    v_smfmac_f32_16x16x64_bf16 v[184:187], a[132:135], v[220:227], v27
    v_cvt_pk_bf16_f32 v141, v142, v143
    v_smfmac_f32_16x16x64_bf16 v[184:187], a[168:171], v[228:235], v31
    v_cvt_pk_bf16_f32 v142, v144, v145
    v_smfmac_f32_16x16x64_bf16 v[188:191], a[136:139], v[220:227], v27 abid:1
    v_cvt_pk_bf16_f32 v143, v146, v147
    v_smfmac_f32_16x16x64_bf16 v[188:191], a[172:175], v[228:235], v31 abid:1
    v_cvt_pk_bf16_f32 v148, v148, v149
    v_smfmac_f32_16x16x64_bf16 v[192:195], a[140:143], v[220:227], v49 abid:1
    v_cvt_pk_bf16_f32 v149, v150, v151
    v_smfmac_f32_16x16x64_bf16 v[192:195], a[176:179], v[228:235], v50
    ds_read_b128 v[220:223], v1 offset:25600
    s_waitcnt lgkmcnt(6)
    v_cvt_pk_bf16_f32 v150, v152, v153
    v_smfmac_f32_16x16x64_bf16 v[160:163], a[180:183], v[196:203], v32
    ds_read_b128 v[224:227], v2 offset:25600
    s_waitcnt lgkmcnt(2)
    v_cvt_pk_bf16_f32 v151, v154, v155
    v_smfmac_f32_16x16x64_bf16 v[160:163], a[216:219], v[204:211], v36
    ds_read_b128 v[228:231], v1 offset:26624
    ds_read_b128 v[152:155], v9 offset:10688
    v_cndmask_b32_dpp v144, v140, v148, vcc row_ror:8 row_mask:0xf bank_mask:0xf
    v_smfmac_f32_16x16x64_bf16 v[164:167], a[184:187], v[196:203], v32 abid:1
    ds_read_b128 v[232:235], v2 offset:26624
    v_cndmask_b32_dpp v145, v141, v149, vcc row_ror:8 row_mask:0xf bank_mask:0xf
    v_smfmac_f32_16x16x64_bf16 v[164:167], a[220:223], v[204:211], v36 abid:1
    v_cndmask_b32_dpp v146, v142, v150, vcc row_ror:8 row_mask:0xf bank_mask:0xf
    v_smfmac_f32_16x16x64_bf16 v[168:171], a[188:191], v[196:203], v33
    v_cndmask_b32_dpp v147, v143, v151, vcc row_ror:8 row_mask:0xf bank_mask:0xf
    v_smfmac_f32_16x16x64_bf16 v[168:171], a[224:227], v[204:211], v37
    buffer_store_dwordx4 v[144:147], v6, s[12:15], s59 offen offset:128 sc1
    v_mov_b32_dpp v140, v148 row_ror:8 row_mask:0xf bank_mask:0xc
    v_smfmac_f32_16x16x64_bf16 v[172:175], a[192:195], v[196:203], v33 abid:1
    v_mov_b32_dpp v141, v149 row_ror:8 row_mask:0xf bank_mask:0xc
    v_smfmac_f32_16x16x64_bf16 v[172:175], a[228:231], v[204:211], v37 abid:1
    v_mov_b32_dpp v142, v150 row_ror:8 row_mask:0xf bank_mask:0xc
    v_smfmac_f32_16x16x64_bf16 v[176:179], a[196:199], v[196:203], v34
    v_mov_b32_dpp v143, v151 row_ror:8 row_mask:0xf bank_mask:0xc
    v_smfmac_f32_16x16x64_bf16 v[176:179], a[232:235], v[204:211], v38
    buffer_store_dwordx4 v[140:143], v6, s[12:15], s24 offen offset:128 sc1
    ds_read_b128 v[144:147], v9 offset:10560
    v_smfmac_f32_16x16x64_bf16 v[180:183], a[200:203], v[196:203], v34 abid:1
    ds_read_b128 v[148:151], v9 offset:10624
    ds_read_b128 v[140:143], v9 offset:10496
    v_add_u32 v4, s31, v4
    v_smfmac_f32_16x16x64_bf16 v[180:183], a[236:239], v[204:211], v38 abid:1
    v_add_u32 v1, s31, v1
    v_smfmac_f32_16x16x64_bf16 v[184:187], a[204:207], v[196:203], v35
    v_add_u32 v2, s31, v2
    v_smfmac_f32_16x16x64_bf16 v[184:187], a[240:243], v[204:211], v39
    v_smfmac_f32_16x16x64_bf16 v[188:191], a[208:211], v[196:203], v35 abid:1
    v_smfmac_f32_16x16x64_bf16 v[188:191], a[244:247], v[204:211], v39 abid:1
    v_smfmac_f32_16x16x64_bf16 v[192:195], a[212:215], v[196:203], v50 abid:1
    v_smfmac_f32_16x16x64_bf16 v[192:195], a[248:251], v[204:211], v51
    s_waitcnt vmcnt(4)
    s_branch M_top1
M_bF:
    v_smfmac_f32_16x16x64_bf16 v[164:167], v[56:59], v[220:227], v40 abid:1
    ds_read_b128 v[204:207], v1 offset:1024
    v_smfmac_f32_16x16x64_bf16 v[164:167], v[92:95], v[228:235], v44 abid:1
    ds_read_b128 v[208:211], v2 offset:1024
    v_smfmac_f32_16x16x64_bf16 v[168:171], v[60:63], v[220:227], v41
    ds_read_b128 v[212:215], v1 offset:2048
    v_smfmac_f32_16x16x64_bf16 v[168:171], v[96:99], v[228:235], v45
    ds_read_b128 v[216:219], v2 offset:2048
    v_smfmac_f32_16x16x64_bf16 v[172:175], v[64:67], v[220:227], v41 abid:1
    s_waitcnt lgkmcnt(6)
    buffer_store_dwordx4 v[244:247], v7, s[12:15], s66 offen sc1
    v_smfmac_f32_16x16x64_bf16 v[172:175], v[100:103], v[228:235], v45 abid:1
    ds_read_b128 v[236:239], v9 offset:9408
    v_smfmac_f32_16x16x64_bf16 v[176:179], v[68:71], v[220:227], v42
    s_mov_b32 s21, 4
    v_smfmac_f32_16x16x64_bf16 v[176:179], v[104:107], v[228:235], v46
    v_smfmac_f32_16x16x64_bf16 v[180:183], v[72:75], v[220:227], v42 abid:1
    v_cvt_pk_bf16_f32 v160, v160, v161
    v_smfmac_f32_16x16x64_bf16 v[180:183], v[108:111], v[228:235], v46 abid:1
    v_cvt_pk_bf16_f32 v161, v162, v163
    v_smfmac_f32_16x16x64_bf16 v[184:187], v[76:79], v[220:227], v43
    v_cvt_pk_bf16_f32 v162, v164, v165
    v_smfmac_f32_16x16x64_bf16 v[184:187], v[112:115], v[228:235], v47
    v_cvt_pk_bf16_f32 v163, v166, v167
    v_smfmac_f32_16x16x64_bf16 v[188:191], v[80:83], v[220:227], v43 abid:1
    v_cvt_pk_bf16_f32 v168, v168, v169
    v_smfmac_f32_16x16x64_bf16 v[188:191], v[116:119], v[228:235], v47 abid:1
    v_cvt_pk_bf16_f32 v169, v170, v171
    v_smfmac_f32_16x16x64_bf16 v[192:195], v[84:87], v[220:227], v51 abid:1
    v_cvt_pk_bf16_f32 v170, v172, v173
    v_smfmac_f32_16x16x64_bf16 v[192:195], v[120:123], v[228:235], v52
    ds_read_b128 v[220:223], v1 offset:3072
    s_waitcnt lgkmcnt(6)
    v_cvt_pk_bf16_f32 v171, v174, v175
    v_smfmac_f32_16x16x64_bf16 v[124:127], a[0:3], v[196:203], v12
    ds_read_b128 v[224:227], v2 offset:3072
    ds_read_b128 v[172:175], v9 offset:10432
    s_waitcnt lgkmcnt(6)
    v_cndmask_b32_dpp v164, v160, v168, vcc row_ror:8 row_mask:0xf bank_mask:0xf
    v_smfmac_f32_16x16x64_bf16 v[124:127], a[36:39], v[204:211], v16
    ds_read_b128 v[228:231], v1 offset:4096
    s_waitcnt lgkmcnt(5)
    v_cndmask_b32_dpp v165, v161, v169, vcc row_ror:8 row_mask:0xf bank_mask:0xf
    v_smfmac_f32_16x16x64_bf16 v[124:127], a[72:75], v[212:219], v20
    ds_read_b128 v[232:235], v2 offset:4096
    s_waitcnt lgkmcnt(5)
    v_xad_u32 v236, v236, v3, v4
    v_smfmac_f32_16x16x64_bf16 v[156:159], a[32:35], v[196:203], v48
    s_barrier
    v_xad_u32 v237, v237, v3, v4
    v_smfmac_f32_16x16x64_bf16 v[156:159], a[68:71], v[204:211], v48 abid:1
    ds_read2st64_b32 v[244:245], v236 offset0:0 offset1:72
    ds_read_b128 v[240:243], v8 offset:3072
    v_xad_u32 v238, v238, v3, v4
    v_smfmac_f32_16x16x64_bf16 v[156:159], a[104:107], v[212:219], v49
    ds_read2st64_b32 v[246:247], v237 offset0:0 offset1:72
    v_xad_u32 v239, v239, v3, v4
    v_smfmac_f32_16x16x64_bf16 v[132:135], a[8:11], v[196:203], v13
    ds_read2st64_b32 v[248:249], v238 offset0:0 offset1:72
    v_cndmask_b32_dpp v166, v162, v170, vcc row_ror:8 row_mask:0xf bank_mask:0xf
    v_smfmac_f32_16x16x64_bf16 v[132:135], a[44:47], v[204:211], v17
    ds_read2st64_b32 v[250:251], v239 offset0:0 offset1:72
    ds_read_b128 v[236:239], v9 offset:9280
    v_cndmask_b32_dpp v167, v163, v171, vcc row_ror:8 row_mask:0xf bank_mask:0xf
    v_smfmac_f32_16x16x64_bf16 v[132:135], a[80:83], v[212:219], v21
    buffer_store_dwordx4 v[164:167], v6, s[12:15], s58 offen offset:0 sc1
    v_mov_b32_dpp v160, v168 row_ror:8 row_mask:0xf bank_mask:0xc
    v_smfmac_f32_16x16x64_bf16 v[140:143], a[16:19], v[196:203], v14
    v_mov_b32_dpp v161, v169 row_ror:8 row_mask:0xf bank_mask:0xc
    v_smfmac_f32_16x16x64_bf16 v[140:143], a[52:55], v[204:211], v18
    v_mov_b32_dpp v162, v170 row_ror:8 row_mask:0xf bank_mask:0xc
    v_smfmac_f32_16x16x64_bf16 v[140:143], a[88:91], v[212:219], v22
    v_mov_b32_dpp v163, v171 row_ror:8 row_mask:0xf bank_mask:0xc
    v_smfmac_f32_16x16x64_bf16 v[136:139], a[12:15], v[196:203], v13 abid:1
    buffer_store_dwordx4 v[160:163], v6, s[12:15], s23 offen offset:0 sc1
    ds_read_b128 v[164:167], v9 offset:10304
    ds_read_b128 v[168:171], v9 offset:10368
    v_smfmac_f32_16x16x64_bf16 v[136:139], a[48:51], v[204:211], v17 abid:1
    ds_read_b128 v[160:163], v9 offset:10240
    v_smfmac_f32_16x16x64_bf16 v[136:139], a[84:87], v[212:219], v21 abid:1
    s_waitcnt lgkmcnt(3)
    v_xad_u32 v236, v236, v3, v4
    v_smfmac_f32_16x16x64_bf16 v[136:139], v[240:243], v[244:251], v10
    v_xad_u32 v237, v237, v3, v4
    v_smfmac_f32_16x16x64_bf16 v[172:175], v[240:243], v[244:251], v10 abid:1
    ds_read2st64_b32 v[244:245], v236 offset0:0 offset1:72
    ds_read_b128 v[240:243], v8 offset:1024
    v_xad_u32 v238, v238, v3, v4
    v_smfmac_f32_16x16x64_bf16 v[144:147], a[20:23], v[196:203], v14 abid:1
    ds_read2st64_b32 v[246:247], v237 offset0:0 offset1:72
    v_xad_u32 v239, v239, v3, v4
    v_smfmac_f32_16x16x64_bf16 v[144:147], a[56:59], v[204:211], v18 abid:1
    ds_read2st64_b32 v[248:249], v238 offset0:0 offset1:72
    v_smfmac_f32_16x16x64_bf16 v[144:147], a[92:95], v[212:219], v22 abid:1
    ds_read2st64_b32 v[250:251], v239 offset0:0 offset1:72
    ds_read_b128 v[236:239], v9 offset:9344
    v_smfmac_f32_16x16x64_bf16 v[148:151], a[24:27], v[196:203], v15
    v_cvt_pk_bf16_f32 v192, v192, v193
    v_smfmac_f32_16x16x64_bf16 v[148:151], a[60:63], v[204:211], v19
    v_cvt_pk_bf16_f32 v193, v194, v195
    v_smfmac_f32_16x16x64_bf16 v[148:151], a[96:99], v[212:219], v23
    ds_write_b64 v53, v[192:193] offset:0
    ds_read_b128 v[192:195], v9 offset:10752
    v_smfmac_f32_16x16x64_bf16 v[152:155], a[28:31], v[196:203], v15 abid:1
    v_smfmac_f32_16x16x64_bf16 v[152:155], a[64:67], v[204:211], v19 abid:1
    v_smfmac_f32_16x16x64_bf16 v[152:155], a[100:103], v[212:219], v23 abid:1
    v_smfmac_f32_16x16x64_bf16 v[128:131], a[4:7], v[196:203], v12 abid:1
    v_smfmac_f32_16x16x64_bf16 v[128:131], a[40:43], v[204:211], v16 abid:1
    v_smfmac_f32_16x16x64_bf16 v[128:131], a[76:79], v[212:219], v20 abid:1
    s_waitcnt lgkmcnt(2)
    v_xad_u32 v236, v236, v3, v4
    v_smfmac_f32_16x16x64_bf16 v[128:131], v[240:243], v[244:251], v10
    v_xad_u32 v237, v237, v3, v4
    v_smfmac_f32_16x16x64_bf16 v[164:167], v[240:243], v[244:251], v10 abid:1
    ds_read2st64_b32 v[244:245], v236 offset0:0 offset1:72
    ds_read_b128 v[240:243], v8 offset:2048
    v_xad_u32 v238, v238, v3, v4
    v_smfmac_f32_16x16x64_bf16 v[124:127], a[108:111], v[220:227], v24
    ds_read2st64_b32 v[246:247], v237 offset0:0 offset1:72
    v_xad_u32 v239, v239, v3, v4
    v_smfmac_f32_16x16x64_bf16 v[124:127], a[144:147], v[228:235], v28
    ds_read2st64_b32 v[248:249], v238 offset0:0 offset1:72
    ds_read_b64 v[216:217], v9 offset:10056
    v_cvt_pk_bf16_f32 v176, v176, v177
    v_smfmac_f32_16x16x64_bf16 v[128:131], a[112:115], v[220:227], v24 abid:1
    ds_read2st64_b32 v[250:251], v239 offset0:0 offset1:72
    ds_read_b128 v[236:239], v9 offset:9216
    v_cvt_pk_bf16_f32 v177, v178, v179
    v_smfmac_f32_16x16x64_bf16 v[128:131], a[148:151], v[228:235], v28 abid:1
    v_cvt_pk_bf16_f32 v178, v180, v181
    v_smfmac_f32_16x16x64_bf16 v[140:143], a[124:127], v[220:227], v26
    v_cvt_pk_bf16_f32 v179, v182, v183
    v_smfmac_f32_16x16x64_bf16 v[140:143], a[160:163], v[228:235], v30
    v_cvt_pk_bf16_f32 v184, v184, v185
    v_smfmac_f32_16x16x64_bf16 v[136:139], a[120:123], v[220:227], v25 abid:1
    v_cvt_pk_bf16_f32 v185, v186, v187
    v_smfmac_f32_16x16x64_bf16 v[136:139], a[156:159], v[228:235], v29 abid:1
    ds_read_b128 v[196:199], v1 offset:5120
    v_cvt_pk_bf16_f32 v186, v188, v189
    v_smfmac_f32_16x16x64_bf16 v[132:135], a[116:119], v[220:227], v25
    ds_read_b128 v[200:203], v2 offset:5120
    v_cvt_pk_bf16_f32 v187, v190, v191
    v_smfmac_f32_16x16x64_bf16 v[132:135], a[152:155], v[228:235], v29
    ds_read_b128 v[188:191], v9 offset:10688
    s_waitcnt lgkmcnt(3)
    v_xad_u32 v236, v236, v3, v4
    v_smfmac_f32_16x16x64_bf16 v[132:135], v[240:243], v[244:251], v10
    ds_read_b128 v[204:207], v1 offset:6144
    v_xad_u32 v237, v237, v3, v4
    v_smfmac_f32_16x16x64_bf16 v[168:171], v[240:243], v[244:251], v10 abid:1
    ds_read2st64_b32 v[244:245], v236 offset0:0 offset1:72
    ds_read_b128 v[240:243], v8 offset:0
    v_xad_u32 v238, v238, v3, v4
    v_smfmac_f32_16x16x64_bf16 v[144:147], a[128:131], v[220:227], v26 abid:1
    ds_read2st64_b32 v[246:247], v237 offset0:0 offset1:72
    v_xad_u32 v239, v239, v3, v4
    v_smfmac_f32_16x16x64_bf16 v[144:147], a[164:167], v[228:235], v30 abid:1
    ds_read2st64_b32 v[248:249], v238 offset0:0 offset1:72
    ds_read_b128 v[208:211], v2 offset:6144
    v_cndmask_b32_dpp v180, v176, v184, vcc row_ror:8 row_mask:0xf bank_mask:0xf
    v_smfmac_f32_16x16x64_bf16 v[148:151], a[132:135], v[220:227], v27
    ds_read2st64_b32 v[250:251], v239 offset0:0 offset1:72
    ds_read_b128 v[236:239], v9 offset:9728
    v_cndmask_b32_dpp v181, v177, v185, vcc row_ror:8 row_mask:0xf bank_mask:0xf
    v_smfmac_f32_16x16x64_bf16 v[148:151], a[168:171], v[228:235], v31
    v_xad_u32 v212, v216, v3, v4
    v_smfmac_f32_16x16x64_bf16 v[152:155], a[136:139], v[220:227], v27 abid:1
    ds_read2st64_b32 v[212:213], v212 offset0:0 offset1:72
    v_xad_u32 v214, v217, v3, v4
    v_smfmac_f32_16x16x64_bf16 v[152:155], a[172:175], v[228:235], v31 abid:1
    ds_read2st64_b32 v[214:215], v214 offset0:0 offset1:72
    v_cndmask_b32_dpp v182, v178, v186, vcc row_ror:8 row_mask:0xf bank_mask:0xf
    v_smfmac_f32_16x16x64_bf16 v[156:159], a[140:143], v[220:227], v49 abid:1
    v_cndmask_b32_dpp v183, v179, v187, vcc row_ror:8 row_mask:0xf bank_mask:0xf
    v_smfmac_f32_16x16x64_bf16 v[156:159], a[176:179], v[228:235], v50
    buffer_store_dwordx4 v[180:183], v6, s[12:15], s58 offen offset:128 sc1
    s_waitcnt lgkmcnt(11)
    v_mov_b32_dpp v176, v184 row_ror:8 row_mask:0xf bank_mask:0xc
    v_smfmac_f32_16x16x64_bf16 v[128:131], a[184:187], v[196:203], v32 abid:1
    s_waitcnt lgkmcnt(4)
    v_mov_b32_dpp v177, v185 row_ror:8 row_mask:0xf bank_mask:0xc
    v_smfmac_f32_16x16x64_bf16 v[128:131], a[220:223], v[204:211], v36 abid:1
    v_mov_b32_dpp v178, v186 row_ror:8 row_mask:0xf bank_mask:0xc
    v_smfmac_f32_16x16x64_bf16 v[124:127], a[180:183], v[196:203], v32
    ds_read_b128 v[220:223], v1 offset:7168
    v_mov_b32_dpp v179, v187 row_ror:8 row_mask:0xf bank_mask:0xc
    v_smfmac_f32_16x16x64_bf16 v[124:127], a[216:219], v[204:211], v36
    buffer_store_dwordx4 v[176:179], v6, s[12:15], s23 offen offset:128 sc1
    s_waitcnt lgkmcnt(3)
    v_xad_u32 v236, v236, v3, v4
    v_smfmac_f32_16x16x64_bf16 v[124:127], v[240:243], v[244:251], v10
    ds_read_b128 v[224:227], v2 offset:7168
    ds_read_b128 v[180:183], v9 offset:10560
    v_xad_u32 v237, v237, v3, v4
    v_smfmac_f32_16x16x64_bf16 v[160:163], v[240:243], v[244:251], v10 abid:1
    ds_read2st64_b32 v[244:245], v236 offset0:0 offset1:72
    ds_read_b128 v[240:243], v8 offset:8192
    v_xad_u32 v238, v238, v3, v4
    v_smfmac_f32_16x16x64_bf16 v[132:135], a[188:191], v[196:203], v33
    ds_read2st64_b32 v[246:247], v237 offset0:0 offset1:72
    ds_read_b128 v[184:187], v9 offset:10624
    v_xad_u32 v239, v239, v3, v4
    v_smfmac_f32_16x16x64_bf16 v[132:135], a[224:227], v[204:211], v37
    ds_read2st64_b32 v[248:249], v238 offset0:0 offset1:72
    ds_read_b128 v[176:179], v9 offset:10496
    v_smfmac_f32_16x16x64_bf16 v[136:139], a[192:195], v[196:203], v33 abid:1
    ds_read2st64_b32 v[250:251], v239 offset0:0 offset1:72
    ds_read_b128 v[236:239], v9 offset:9664
    v_smfmac_f32_16x16x64_bf16 v[136:139], a[228:231], v[204:211], v37 abid:1
    v_smfmac_f32_16x16x64_bf16 v[140:143], a[196:199], v[196:203], v34
    v_smfmac_f32_16x16x64_bf16 v[140:143], a[232:235], v[204:211], v38
    ds_read_b128 v[228:231], v1 offset:8192
    v_smfmac_f32_16x16x64_bf16 v[144:147], a[200:203], v[196:203], v34 abid:1
    ds_read_b128 v[232:235], v2 offset:8192
    v_smfmac_f32_16x16x64_bf16 v[144:147], a[236:239], v[204:211], v38 abid:1
    s_waitcnt lgkmcnt(4)
    s_cmp_lt_i32 s81, 0
    s_cbranch_scc1 M_ovrF
    s_swappc_b64 s[78:79], s[72:73]
M_ovrF:
    v_smfmac_f32_16x16x64_bf16 v[156:159], a[212:215], v[196:203], v50 abid:1
    v_smfmac_f32_16x16x64_bf16 v[156:159], a[248:251], v[204:211], v51
    s_waitcnt lgkmcnt(2)
    v_xad_u32 v236, v236, v3, v4
    v_smfmac_f32_16x16x64_bf16 v[156:159], v[240:243], v[244:251], v10
    v_xad_u32 v237, v237, v3, v4
    v_smfmac_f32_16x16x64_bf16 v[192:195], v[240:243], v[244:251], v10 abid:1
    ds_read2st64_b32 v[244:245], v236 offset0:0 offset1:72
    ds_read_b128 v[240:243], v8 offset:7168
    v_xad_u32 v238, v238, v3, v4
    v_smfmac_f32_16x16x64_bf16 v[152:155], a[208:211], v[196:203], v35 abid:1
    ds_read2st64_b32 v[246:247], v237 offset0:0 offset1:72
    v_xad_u32 v239, v239, v3, v4
    v_smfmac_f32_16x16x64_bf16 v[152:155], a[244:247], v[204:211], v39 abid:1
    ds_read2st64_b32 v[248:249], v238 offset0:0 offset1:72
    v_smfmac_f32_16x16x64_bf16 v[148:151], a[204:207], v[196:203], v35
    ds_read2st64_b32 v[250:251], v239 offset0:0 offset1:72
    ds_read_b128 v[236:239], v9 offset:9536
    v_smfmac_f32_16x16x64_bf16 v[148:151], a[240:243], v[204:211], v39
    v_smfmac_f32_16x16x64_bf16 v[124:127], a[252:255], v[220:227], v40
    s_waitcnt lgkmcnt(6)
    v_smfmac_f32_16x16x64_bf16 v[124:127], v[88:91], v[228:235], v44
    v_smfmac_f32_16x16x64_bf16 v[128:131], v[56:59], v[220:227], v40 abid:1
    v_smfmac_f32_16x16x64_bf16 v[128:131], v[92:95], v[228:235], v44 abid:1
    s_cmp_lt_u32 s20, 2
    s_cselect_b32 s66, s23, s24
    s_add_u32 s66, s66, s95
    v_smfmac_f32_16x16x64_bf16 v[132:135], v[60:63], v[220:227], v41
    ds_read_b128 v[196:199], v1 offset:18432
    s_add_u32 s23, s24, 18432
    s_add_u32 s58, s24, 27648
    v_smfmac_f32_16x16x64_bf16 v[132:135], v[96:99], v[228:235], v45
    ds_read_b128 v[200:203], v2 offset:18432
    s_add_u32 s67, s23, s95
    v_smfmac_f32_16x16x64_bf16 v[152:155], v[80:83], v[220:227], v43 abid:1
    ds_read_b128 v[204:207], v1 offset:19456
    v_smfmac_f32_16x16x64_bf16 v[152:155], v[116:119], v[228:235], v47 abid:1
    s_waitcnt lgkmcnt(3)
    v_xad_u32 v236, v236, v3, v4
    v_smfmac_f32_16x16x64_bf16 v[152:155], v[240:243], v[244:251], v10
    ds_read_b128 v[208:211], v2 offset:19456
    v_xad_u32 v237, v237, v3, v4
    v_smfmac_f32_16x16x64_bf16 v[188:191], v[240:243], v[244:251], v10 abid:1
    s_cmp_gt_u32 s46, s80
    s_cbranch_scc1 M_slow
M_slowrF:
    v_xad_u32 v238, v238, v3, v4
    v_smfmac_f32_16x16x64_bf16 v[140:143], v[68:71], v[220:227], v42
    ds_read2st64_b32 v[244:245], v236 offset0:0 offset1:72
    ds_read_b128 v[240:243], v8 offset:5120
    v_xad_u32 v239, v239, v3, v4
    v_smfmac_f32_16x16x64_bf16 v[140:143], v[104:107], v[228:235], v46
    ds_read2st64_b32 v[246:247], v237 offset0:0 offset1:72
    v_smfmac_f32_16x16x64_bf16 v[156:159], v[84:87], v[220:227], v51 abid:1
    ds_read2st64_b32 v[248:249], v238 offset0:0 offset1:72
    ds_read_b128 v[212:215], v1 offset:20480
    v_smfmac_f32_16x16x64_bf16 v[156:159], v[120:123], v[228:235], v52
    ds_read2st64_b32 v[250:251], v239 offset0:0 offset1:72
    ds_read_b128 v[236:239], v9 offset:9600
    v_smfmac_f32_16x16x64_bf16 v[148:151], v[76:79], v[220:227], v43
    ds_read_b128 v[216:219], v2 offset:20480
    v_smfmac_f32_16x16x64_bf16 v[148:151], v[112:115], v[228:235], v47
    v_smfmac_f32_16x16x64_bf16 v[136:139], v[64:67], v[220:227], v41 abid:1
    v_smfmac_f32_16x16x64_bf16 v[136:139], v[100:103], v[228:235], v45 abid:1
    v_smfmac_f32_16x16x64_bf16 v[144:147], v[72:75], v[220:227], v42 abid:1
    v_smfmac_f32_16x16x64_bf16 v[144:147], v[108:111], v[228:235], v46 abid:1
    ds_read_b128 v[220:223], v1 offset:21504
    s_waitcnt lgkmcnt(2)
    v_xad_u32 v236, v236, v3, v4
    v_smfmac_f32_16x16x64_bf16 v[144:147], v[240:243], v[244:251], v10
    ds_read_b128 v[224:227], v2 offset:21504
    v_xad_u32 v237, v237, v3, v4
    v_smfmac_f32_16x16x64_bf16 v[180:183], v[240:243], v[244:251], v10 abid:1
    ds_read2st64_b32 v[244:245], v236 offset0:0 offset1:72
    ds_read_b128 v[240:243], v8 offset:6144
    v_xad_u32 v238, v238, v3, v4
    v_smfmac_f32_16x16x64_bf16 v[192:195], a[32:35], v[196:203], v48
    ds_read2st64_b32 v[246:247], v237 offset0:0 offset1:72
    ds_read_b128 v[228:231], v1 offset:22528
    v_xad_u32 v239, v239, v3, v4
    v_smfmac_f32_16x16x64_bf16 v[192:195], a[68:71], v[204:211], v48 abid:1
    ds_read2st64_b32 v[248:249], v238 offset0:0 offset1:72
    ds_read_b128 v[232:235], v2 offset:22528
    s_waitcnt lgkmcnt(8)
    v_cvt_pk_bf16_f32 v124, v124, v125
    v_smfmac_f32_16x16x64_bf16 v[192:195], a[104:107], v[212:219], v49
    ds_read2st64_b32 v[250:251], v239 offset0:0 offset1:72
    ds_read_b128 v[236:239], v9 offset:9472
    v_cvt_pk_bf16_f32 v125, v126, v127
    v_smfmac_f32_16x16x64_bf16 v[160:163], a[0:3], v[196:203], v12
    v_cvt_pk_bf16_f32 v126, v128, v129
    v_smfmac_f32_16x16x64_bf16 v[160:163], a[36:39], v[204:211], v16
    v_cvt_pk_bf16_f32 v127, v130, v131
    v_smfmac_f32_16x16x64_bf16 v[160:163], a[72:75], v[212:219], v20
    v_cvt_pk_bf16_f32 v156, v156, v157
    v_smfmac_f32_16x16x64_bf16 v[164:167], a[4:7], v[196:203], v12 abid:1
    v_cvt_pk_bf16_f32 v157, v158, v159
    v_smfmac_f32_16x16x64_bf16 v[164:167], a[40:43], v[204:211], v16 abid:1
    ds_write_b64 v53, v[156:157] offset:25728
    v_cvt_pk_bf16_f32 v132, v132, v133
    v_smfmac_f32_16x16x64_bf16 v[164:167], a[76:79], v[212:219], v20 abid:1
    v_cvt_pk_bf16_f32 v133, v134, v135
    v_smfmac_f32_16x16x64_bf16 v[168:171], a[8:11], v[196:203], v13
    v_cvt_pk_bf16_f32 v134, v136, v137
    v_smfmac_f32_16x16x64_bf16 v[168:171], a[44:47], v[204:211], v17
    v_cvt_pk_bf16_f32 v135, v138, v139
    v_smfmac_f32_16x16x64_bf16 v[168:171], a[80:83], v[212:219], v21
    s_waitcnt lgkmcnt(1)
    v_xad_u32 v236, v236, v3, v4
    v_smfmac_f32_16x16x64_bf16 v[184:187], v[240:243], v[244:251], v10 abid:1
    v_xad_u32 v237, v237, v3, v4
    v_smfmac_f32_16x16x64_bf16 v[148:151], v[240:243], v[244:251], v10
    ds_read2st64_b32 v[244:245], v236 offset0:0 offset1:72
    ds_read_b128 v[240:243], v8 offset:4096
    v_xad_u32 v238, v238, v3, v4
    v_smfmac_f32_16x16x64_bf16 v[172:175], a[12:15], v[196:203], v13 abid:1
    ds_read2st64_b32 v[246:247], v237 offset0:0 offset1:72
    v_xad_u32 v239, v239, v3, v4
    v_smfmac_f32_16x16x64_bf16 v[172:175], a[48:51], v[204:211], v17 abid:1
    ds_read2st64_b32 v[248:249], v238 offset0:0 offset1:72
    v_cndmask_b32_dpp v128, v124, v132, vcc row_ror:8 row_mask:0xf bank_mask:0xf
    v_smfmac_f32_16x16x64_bf16 v[172:175], a[84:87], v[212:219], v21 abid:1
    ds_read2st64_b32 v[250:251], v239 offset0:0 offset1:72
    ds_read_b128 v[196:199], v1 offset:23552
    v_cndmask_b32_dpp v129, v125, v133, vcc row_ror:8 row_mask:0xf bank_mask:0xf
    v_smfmac_f32_16x16x64_bf16 v[192:195], a[140:143], v[220:227], v49 abid:1
    ds_read_b128 v[200:203], v2 offset:23552
    v_cndmask_b32_dpp v130, v126, v134, vcc row_ror:8 row_mask:0xf bank_mask:0xf
    v_smfmac_f32_16x16x64_bf16 v[192:195], a[176:179], v[228:235], v50
    ds_read_b128 v[204:207], v1 offset:24576
    v_cndmask_b32_dpp v131, v127, v135, vcc row_ror:8 row_mask:0xf bank_mask:0xf
    v_smfmac_f32_16x16x64_bf16 v[160:163], a[108:111], v[220:227], v24
    ds_read_b128 v[208:211], v2 offset:24576
    buffer_store_dwordx4 v[128:131], v6, s[12:15], s59 offen offset:0 sc1
    v_mov_b32_dpp v124, v132 row_ror:8 row_mask:0xf bank_mask:0xc
    v_smfmac_f32_16x16x64_bf16 v[160:163], a[144:147], v[228:235], v28
    s_waitcnt lgkmcnt(9)
    s_barrier
    ds_read_b128 v[236:239], v8 offset:10816
    v_mov_b32_dpp v125, v133 row_ror:8 row_mask:0xf bank_mask:0xc
    v_smfmac_f32_16x16x64_bf16 v[164:167], a[112:115], v[220:227], v24 abid:1
    ds_read_b128 v[212:215], v1 offset:20480
    v_mov_b32_dpp v126, v134 row_ror:8 row_mask:0xf bank_mask:0xc
    v_smfmac_f32_16x16x64_bf16 v[164:167], a[148:151], v[228:235], v28 abid:1
    ds_read_b128 v[216:219], v2 offset:20480
    v_mov_b32_dpp v127, v135 row_ror:8 row_mask:0xf bank_mask:0xc
    v_smfmac_f32_16x16x64_bf16 v[168:171], a[116:119], v[220:227], v25
    buffer_store_dwordx4 v[124:127], v6, s[12:15], s24 offen offset:0 sc1
    v_smfmac_f32_16x16x64_bf16 v[168:171], a[152:155], v[228:235], v29
    s_waitcnt lgkmcnt(7)
    v_smfmac_f32_16x16x64_bf16 v[176:179], v[240:243], v[244:251], v10 abid:1
    v_smfmac_f32_16x16x64_bf16 v[140:143], v[240:243], v[244:251], v10
    s_waitcnt lgkmcnt(2)
    buffer_store_dwordx4 v[236:239], v7, s[12:15], s66 offen sc1
    v_smfmac_f32_16x16x64_bf16 v[172:175], a[120:123], v[220:227], v25 abid:1
    v_smfmac_f32_16x16x64_bf16 v[172:175], a[156:159], v[228:235], v29 abid:1
    ds_read_b128 v[220:223], v1 offset:25600
    v_smfmac_f32_16x16x64_bf16 v[192:195], a[212:215], v[196:203], v50 abid:1
    ds_read_b128 v[224:227], v2 offset:25600
    s_nop 0
    v_cvt_pk_bf16_f32 v140, v140, v141
    v_smfmac_f32_16x16x64_bf16 v[192:195], a[248:251], v[204:211], v51
    ds_read_b128 v[228:231], v1 offset:26624
    v_cvt_pk_bf16_f32 v141, v142, v143
    v_smfmac_f32_16x16x64_bf16 v[160:163], a[180:183], v[196:203], v32
    ds_read_b128 v[232:235], v2 offset:26624
    v_cvt_pk_bf16_f32 v142, v144, v145
    v_smfmac_f32_16x16x64_bf16 v[160:163], a[216:219], v[204:211], v36
    v_cvt_pk_bf16_f32 v143, v146, v147
    v_smfmac_f32_16x16x64_bf16 v[164:167], a[184:187], v[196:203], v32 abid:1
    v_cvt_pk_bf16_f32 v148, v148, v149
    v_smfmac_f32_16x16x64_bf16 v[164:167], a[220:223], v[204:211], v36 abid:1
    v_cvt_pk_bf16_f32 v149, v150, v151
    v_smfmac_f32_16x16x64_bf16 v[168:171], a[188:191], v[196:203], v33
    v_cvt_pk_bf16_f32 v150, v152, v153
    v_smfmac_f32_16x16x64_bf16 v[168:171], a[224:227], v[204:211], v37
    v_cvt_pk_bf16_f32 v151, v154, v155
    v_smfmac_f32_16x16x64_bf16 v[172:175], a[192:195], v[196:203], v33 abid:1
    v_cndmask_b32_dpp v144, v140, v148, vcc row_ror:8 row_mask:0xf bank_mask:0xf
    v_smfmac_f32_16x16x64_bf16 v[172:175], a[228:231], v[204:211], v37 abid:1
    ds_read_b128 v[196:199], v1 offset:18432
    s_waitcnt lgkmcnt(3)
    v_cndmask_b32_dpp v145, v141, v149, vcc row_ror:8 row_mask:0xf bank_mask:0xf
    v_smfmac_f32_16x16x64_bf16 v[192:195], v[84:87], v[220:227], v51 abid:1
    ds_read_b128 v[200:203], v2 offset:18432
    s_waitcnt lgkmcnt(2)
    v_cndmask_b32_dpp v146, v142, v150, vcc row_ror:8 row_mask:0xf bank_mask:0xf
    v_smfmac_f32_16x16x64_bf16 v[192:195], v[120:123], v[228:235], v52
    ds_read_b128 v[204:207], v1 offset:19456
    v_cndmask_b32_dpp v147, v143, v151, vcc row_ror:8 row_mask:0xf bank_mask:0xf
    v_smfmac_f32_16x16x64_bf16 v[160:163], a[252:255], v[220:227], v40
    ds_read_b128 v[208:211], v2 offset:19456
    buffer_store_dwordx4 v[144:147], v6, s[12:15], s59 offen offset:128 sc1
    v_mov_b32_dpp v140, v148 row_ror:8 row_mask:0xf bank_mask:0xc
    v_smfmac_f32_16x16x64_bf16 v[160:163], v[88:91], v[228:235], v44
    v_mov_b32_dpp v141, v149 row_ror:8 row_mask:0xf bank_mask:0xc
    v_smfmac_f32_16x16x64_bf16 v[164:167], v[56:59], v[220:227], v40 abid:1
    v_mov_b32_dpp v142, v150 row_ror:8 row_mask:0xf bank_mask:0xc
    v_smfmac_f32_16x16x64_bf16 v[164:167], v[92:95], v[228:235], v44 abid:1
    v_mov_b32_dpp v143, v151 row_ror:8 row_mask:0xf bank_mask:0xc
    v_smfmac_f32_16x16x64_bf16 v[168:171], v[60:63], v[220:227], v41
    buffer_store_dwordx4 v[140:143], v6, s[12:15], s24 offen offset:128 sc1
    v_cvt_pk_bf16_f32 v192, v192, v193
    v_smfmac_f32_16x16x64_bf16 v[168:171], v[96:99], v[228:235], v45
    v_cvt_pk_bf16_f32 v193, v194, v195
    v_smfmac_f32_16x16x64_bf16 v[172:175], v[64:67], v[220:227], v41 abid:1
    ds_write_b64 v53, v[192:193] offset:1024
    v_smfmac_f32_16x16x64_bf16 v[172:175], v[100:103], v[228:235], v45 abid:1
    ds_read_b128 v[220:223], v1 offset:21504
    s_waitcnt lgkmcnt(4)
    v_smfmac_f32_16x16x64_bf16 v[176:179], a[16:19], v[196:203], v14
    ds_read_b128 v[224:227], v2 offset:21504
    s_waitcnt lgkmcnt(3)
    v_smfmac_f32_16x16x64_bf16 v[176:179], a[52:55], v[204:211], v18
    ds_read_b128 v[228:231], v1 offset:22528
    v_smfmac_f32_16x16x64_bf16 v[176:179], a[88:91], v[212:219], v22
    ds_read_b128 v[232:235], v2 offset:22528
    s_waitcnt lgkmcnt(4)
    s_barrier
    ds_read_b128 v[236:239], v8 offset:11840
    v_smfmac_f32_16x16x64_bf16 v[180:183], a[20:23], v[196:203], v14 abid:1
    v_cvt_pk_bf16_f32 v160, v160, v161
    v_smfmac_f32_16x16x64_bf16 v[180:183], a[56:59], v[204:211], v18 abid:1
    v_cvt_pk_bf16_f32 v161, v162, v163
    v_smfmac_f32_16x16x64_bf16 v[180:183], a[92:95], v[212:219], v22 abid:1
    v_cvt_pk_bf16_f32 v162, v164, v165
    v_smfmac_f32_16x16x64_bf16 v[184:187], a[24:27], v[196:203], v15
    v_cvt_pk_bf16_f32 v163, v166, v167
    v_smfmac_f32_16x16x64_bf16 v[184:187], a[60:63], v[204:211], v19
    v_cvt_pk_bf16_f32 v168, v168, v169
    v_smfmac_f32_16x16x64_bf16 v[184:187], a[96:99], v[212:219], v23
    s_cmp_lt_u32 s20, 2
    s_waitcnt lgkmcnt(0)
    s_cbranch_scc0 M_fx
    buffer_store_dwordx4 v[236:239], v7, s[12:15], s67 offen sc1
M_fx:
    v_smfmac_f32_16x16x64_bf16 v[188:191], a[28:31], v[196:203], v15 abid:1
    v_cvt_pk_bf16_f32 v169, v170, v171
    v_smfmac_f32_16x16x64_bf16 v[188:191], a[64:67], v[204:211], v19 abid:1
    v_cvt_pk_bf16_f32 v170, v172, v173
    v_smfmac_f32_16x16x64_bf16 v[188:191], a[100:103], v[212:219], v23 abid:1
    ds_read_b128 v[196:199], v1 offset:23552
    v_cvt_pk_bf16_f32 v171, v174, v175
    v_smfmac_f32_16x16x64_bf16 v[176:179], a[124:127], v[220:227], v26
    ds_read_b128 v[200:203], v2 offset:23552
    v_cndmask_b32_dpp v164, v160, v168, vcc row_ror:8 row_mask:0xf bank_mask:0xf
    v_smfmac_f32_16x16x64_bf16 v[176:179], a[160:163], v[228:235], v30
    ds_read_b128 v[204:207], v1 offset:24576
    v_cndmask_b32_dpp v165, v161, v169, vcc row_ror:8 row_mask:0xf bank_mask:0xf
    v_smfmac_f32_16x16x64_bf16 v[180:183], a[128:131], v[220:227], v26 abid:1
    ds_read_b128 v[208:211], v2 offset:24576
    v_cndmask_b32_dpp v166, v162, v170, vcc row_ror:8 row_mask:0xf bank_mask:0xf
    v_smfmac_f32_16x16x64_bf16 v[180:183], a[164:167], v[228:235], v30 abid:1
    v_cndmask_b32_dpp v167, v163, v171, vcc row_ror:8 row_mask:0xf bank_mask:0xf
    v_smfmac_f32_16x16x64_bf16 v[184:187], a[132:135], v[220:227], v27
    buffer_store_dwordx4 v[164:167], v6, s[12:15], s58 offen offset:0 sc1
    v_mov_b32_dpp v160, v168 row_ror:8 row_mask:0xf bank_mask:0xc
    v_smfmac_f32_16x16x64_bf16 v[184:187], a[168:171], v[228:235], v31
    v_mov_b32_dpp v161, v169 row_ror:8 row_mask:0xf bank_mask:0xc
    v_smfmac_f32_16x16x64_bf16 v[188:191], a[136:139], v[220:227], v27 abid:1
    v_mov_b32_dpp v162, v170 row_ror:8 row_mask:0xf bank_mask:0xc
    v_smfmac_f32_16x16x64_bf16 v[188:191], a[172:175], v[228:235], v31 abid:1
    ds_read_b128 v[220:223], v1 offset:25600
    s_waitcnt lgkmcnt(3)
    v_mov_b32_dpp v163, v171 row_ror:8 row_mask:0xf bank_mask:0xc
    v_smfmac_f32_16x16x64_bf16 v[176:179], a[196:199], v[196:203], v34
    ds_read_b128 v[224:227], v2 offset:25600
    buffer_store_dwordx4 v[160:163], v6, s[12:15], s23 offen offset:0 sc1
    s_waitcnt lgkmcnt(2)
    v_smfmac_f32_16x16x64_bf16 v[176:179], a[232:235], v[204:211], v38
    ds_read_b128 v[228:231], v1 offset:26624
    v_smfmac_f32_16x16x64_bf16 v[180:183], a[200:203], v[196:203], v34 abid:1
    ds_read_b128 v[232:235], v2 offset:26624
    v_smfmac_f32_16x16x64_bf16 v[180:183], a[236:239], v[204:211], v38 abid:1
    v_smfmac_f32_16x16x64_bf16 v[184:187], a[204:207], v[196:203], v35
    v_smfmac_f32_16x16x64_bf16 v[184:187], a[240:243], v[204:211], v39
    v_smfmac_f32_16x16x64_bf16 v[188:191], a[208:211], v[196:203], v35 abid:1
    v_smfmac_f32_16x16x64_bf16 v[188:191], a[244:247], v[204:211], v39 abid:1
    s_waitcnt lgkmcnt(2)
    v_smfmac_f32_16x16x64_bf16 v[176:179], v[68:71], v[220:227], v42
    s_waitcnt lgkmcnt(0)
    v_smfmac_f32_16x16x64_bf16 v[176:179], v[104:107], v[228:235], v46
    v_smfmac_f32_16x16x64_bf16 v[180:183], v[72:75], v[220:227], v42 abid:1
    v_smfmac_f32_16x16x64_bf16 v[180:183], v[108:111], v[228:235], v46 abid:1
    v_smfmac_f32_16x16x64_bf16 v[184:187], v[76:79], v[220:227], v43
    v_smfmac_f32_16x16x64_bf16 v[184:187], v[112:115], v[228:235], v47
    v_smfmac_f32_16x16x64_bf16 v[188:191], v[80:83], v[220:227], v43 abid:1
    v_smfmac_f32_16x16x64_bf16 v[188:191], v[116:119], v[228:235], v47 abid:1
    s_nop 1
    v_cvt_pk_bf16_f32 v176, v176, v177
    v_cvt_pk_bf16_f32 v177, v178, v179
    v_cvt_pk_bf16_f32 v178, v180, v181
    v_cvt_pk_bf16_f32 v179, v182, v183
    v_cvt_pk_bf16_f32 v184, v184, v185
    v_cvt_pk_bf16_f32 v185, v186, v187
    v_cvt_pk_bf16_f32 v186, v188, v189
    v_cvt_pk_bf16_f32 v187, v190, v191
    v_cndmask_b32_dpp v180, v176, v184, vcc row_ror:8 row_mask:0xf bank_mask:0xf
    v_cndmask_b32_dpp v181, v177, v185, vcc row_ror:8 row_mask:0xf bank_mask:0xf
    v_cndmask_b32_dpp v182, v178, v186, vcc row_ror:8 row_mask:0xf bank_mask:0xf
    v_cndmask_b32_dpp v183, v179, v187, vcc row_ror:8 row_mask:0xf bank_mask:0xf
    buffer_store_dwordx4 v[180:183], v6, s[12:15], s58 offen offset:128 sc1
    v_mov_b32_dpp v176, v184 row_ror:8 row_mask:0xf bank_mask:0xc
    v_mov_b32_dpp v177, v185 row_ror:8 row_mask:0xf bank_mask:0xc
    v_mov_b32_dpp v178, v186 row_ror:8 row_mask:0xf bank_mask:0xc
    v_mov_b32_dpp v179, v187 row_ror:8 row_mask:0xf bank_mask:0xc
    buffer_store_dwordx4 v[176:179], v6, s[12:15], s23 offen offset:128 sc1
M_done:
M_end:
    s_endpgm
M_pf_spin:
    s_sleep 4
    v_mov_b32 v0, 0
    s_mov_b64 exec, 1
    buffer_atomic_add v0, off, s[16:19], s96 sc0 sc1
    s_mov_b64 exec, -1
    s_add_u32 s31, s31, 1
    s_waitcnt vmcnt(0)
    v_readfirstlane_b32 s30, v0
    s_nop 0
    s_sub_u32 s30, s30, s100
    s_cmp_eq_u32 s30, 27
    s_cbranch_scc1 M_pf_ok
    s_cmp_lt_u32 s31, 6
    s_cbranch_scc1 M_pf_spin
    s_cmp_eq_u32 s98, 0
    s_cbranch_scc1 M_pf_spin2
    s_mov_b32 s98, 0
    v_mov_b32 v250, 1
    s_mov_b64 exec, 1
    buffer_atomic_add v250, off, s[68:71], 0 offset:0 sc1
    s_mov_b64 exec, -1
    s_nop 3
M_pf_spin2:
    buffer_load_dword v0, off, s[68:71], 0 offset:0 sc1
    s_cmp_ge_u32 s31, 131072
    s_cbranch_scc1 M_end
    s_waitcnt vmcnt(0)
    v_readfirstlane_b32 s30, v0
    s_nop 0
    s_cmp_eq_u32 s30, 81
    s_cbranch_scc0 M_pf_spin
    s_branch M_pf_ok
M_r3:
    v_bfe_u32 v110, v96, 24, 4
    v_lshlrev_b32 v111, 1, v96
    v_lshl_add_u32 v110, v110, 2, s49
    v_and_b32 v111, 16, v111
    v_and_or_b32 v110, v96, 2.0, v110
    v_lshlrev_b32 v111, v111, 1
    ds_add_rtn_u32 v100, v110, v111
    v_and_b32 v110, 8, v96
    v_lshrrev_b32 v113, 14, v96
    v_cmp_ne_u32 s[44:45], 0, v110
    v_and_b32 v116, 0x3cf0, v113
    s_waitcnt lgkmcnt(0)
    v_lshrrev_b32 v111, 16, v100
    v_and_b32 v112, 0xffff, v100
    v_sub_u32 v110, 15, v111
    v_and_b32 v100, 2.0, v96
    v_add3_u32 v100, v112, v111, v100
    v_cndmask_b32 v110, v112, v110, s[44:45]
    v_cmp_gt_u32 s[44:45], 16, v100
    v_cmp_gt_u32 s[36:37], 2.0, v100
    v_lshlrev_b32 v110, 2, v110
    v_lshrrev_b64 v[112:113], v110, s[50:51]
    s_andn2_b64 s[36:37], s[36:37], s[44:45]
    v_lshrrev_b64 v[114:115], v110, s[52:53]
    v_bfe_u32 v110, v96, 24, 4
    v_mbcnt_lo_u32_b32 v111, s36, 0
    v_and_b32 v112, 15, v112
    v_mbcnt_hi_u32_b32 v111, s37, v111
    v_and_b32 v114, 15, v114
    v_lshl_add_u32 v111, v111, 3, s40
    v_lshl_add_u32 v112, v110, 4, v112
    v_min_u32 v111, s41, v111
    v_mul_u32_u24 v114, 68, v114
    v_cndmask_b32 v111, v118, v111, s[36:37]
    ds_write_b64 v111, v[96:97]
    s_bcnt1_i32_b64 s30, s[36:37]
    s_lshl3_add_u32 s40, s30, s40
    v_lshl_add_u32 v112, v112, 2, s47
    v_and_b32 v114, 0x30c, v114
    v_cndmask_b32 v112, v118, v112, s[44:45]
    v_add3_u32 v113, v116, v114, s29
    v_and_b32 v114, 0x3fff, v96
    v_cndmask_b32 v110, v118, v113, s[44:45]
    ds_write_b32 v112, v114
    ds_write_b32 v110, v97
    s_cmp_gt_u32 s38, s39
    s_cselect_b32 s32, 1, s32
    s_branch M_r3r
M_dn:
    s_mov_b32 s27, 0
    s_mov_b32 s46, 0x80000000
    v_mov_b32 v244, 0
    v_mov_b32 v245, 0
    v_mov_b32 v246, 0
    v_mov_b32 v247, 0
    ds_write_b128 v8, v[244:247] offset:0
    ds_write_b128 v8, v[244:247] offset:1024
    ds_write_b128 v8, v[244:247] offset:2048
    ds_write_b128 v8, v[244:247] offset:3072
    ds_write_b128 v8, v[244:247] offset:4096
    ds_write_b128 v8, v[244:247] offset:5120
    ds_write_b128 v8, v[244:247] offset:6144
    ds_write_b128 v8, v[244:247] offset:7168
    ds_write_b128 v8, v[244:247] offset:8192
    s_waitcnt lgkmcnt(0)
    s_branch M_dnr
M_ovc0:
    v_smfmac_f32_16x16x32_bf16 v[124:127], v[54:55], v[212:215], v10
    v_smfmac_f32_16x16x32_bf16 v[160:163], v[54:55], v[212:215], v10 abid:2
    s_setpc_b64 s[74:75]
    v_smfmac_f32_16x16x32_bf16 v[128:131], v[54:55], v[212:215], v10
    v_smfmac_f32_16x16x32_bf16 v[164:167], v[54:55], v[212:215], v10 abid:2
    s_setpc_b64 s[74:75]
    v_smfmac_f32_16x16x32_bf16 v[132:135], v[54:55], v[212:215], v10
    v_smfmac_f32_16x16x32_bf16 v[168:171], v[54:55], v[212:215], v10 abid:2
    s_setpc_b64 s[74:75]
    v_smfmac_f32_16x16x32_bf16 v[136:139], v[54:55], v[212:215], v10
    v_smfmac_f32_16x16x32_bf16 v[172:175], v[54:55], v[212:215], v10 abid:2
    s_setpc_b64 s[74:75]
    v_smfmac_f32_16x16x32_bf16 v[140:143], v[54:55], v[212:215], v10
    v_smfmac_f32_16x16x32_bf16 v[176:179], v[54:55], v[212:215], v10 abid:2
    s_setpc_b64 s[74:75]
    v_smfmac_f32_16x16x32_bf16 v[144:147], v[54:55], v[212:215], v10
    v_smfmac_f32_16x16x32_bf16 v[180:183], v[54:55], v[212:215], v10 abid:2
    s_setpc_b64 s[74:75]
    v_smfmac_f32_16x16x32_bf16 v[148:151], v[54:55], v[212:215], v10
    v_smfmac_f32_16x16x32_bf16 v[184:187], v[54:55], v[212:215], v10 abid:2
    s_setpc_b64 s[74:75]
    v_smfmac_f32_16x16x32_bf16 v[152:155], v[54:55], v[212:215], v10
    v_smfmac_f32_16x16x32_bf16 v[188:191], v[54:55], v[212:215], v10 abid:2
    s_setpc_b64 s[74:75]
    v_smfmac_f32_16x16x32_bf16 v[156:159], v[54:55], v[212:215], v10
    v_smfmac_f32_16x16x32_bf16 v[192:195], v[54:55], v[212:215], v10 abid:2
    s_setpc_b64 s[74:75]
M_ovl0:
    v_smfmac_f32_16x16x32_bf16 v[124:127], v[54:55], v[212:215], v10
    v_smfmac_f32_16x16x32_bf16 v[160:163], v[54:55], v[212:215], v10 abid:2
    s_setpc_b64 s[78:79]
    v_smfmac_f32_16x16x32_bf16 v[128:131], v[54:55], v[212:215], v10
    v_smfmac_f32_16x16x32_bf16 v[164:167], v[54:55], v[212:215], v10 abid:2
    s_setpc_b64 s[78:79]
    v_smfmac_f32_16x16x32_bf16 v[132:135], v[54:55], v[212:215], v10
    v_smfmac_f32_16x16x32_bf16 v[168:171], v[54:55], v[212:215], v10 abid:2
    s_setpc_b64 s[78:79]
    v_smfmac_f32_16x16x32_bf16 v[136:139], v[54:55], v[212:215], v10
    v_smfmac_f32_16x16x32_bf16 v[172:175], v[54:55], v[212:215], v10 abid:2
    s_setpc_b64 s[78:79]
    v_smfmac_f32_16x16x32_bf16 v[140:143], v[54:55], v[212:215], v10
    v_smfmac_f32_16x16x32_bf16 v[176:179], v[54:55], v[212:215], v10 abid:2
    s_setpc_b64 s[78:79]
    v_smfmac_f32_16x16x32_bf16 v[144:147], v[54:55], v[212:215], v10
    v_smfmac_f32_16x16x32_bf16 v[180:183], v[54:55], v[212:215], v10 abid:2
    s_setpc_b64 s[78:79]
    v_smfmac_f32_16x16x32_bf16 v[148:151], v[54:55], v[212:215], v10
    v_smfmac_f32_16x16x32_bf16 v[184:187], v[54:55], v[212:215], v10 abid:2
    s_setpc_b64 s[78:79]
    v_smfmac_f32_16x16x32_bf16 v[152:155], v[54:55], v[212:215], v10
    v_smfmac_f32_16x16x32_bf16 v[188:191], v[54:55], v[212:215], v10 abid:2
    s_setpc_b64 s[78:79]
    v_smfmac_f32_16x16x32_bf16 v[156:159], v[54:55], v[212:215], v10
    v_smfmac_f32_16x16x32_bf16 v[192:195], v[54:55], v[212:215], v10 abid:2
    s_setpc_b64 s[78:79]
M_ovc1:
    v_smfmac_f32_16x16x32_bf16 v[124:127], v[252:253], v[212:215], v10
    v_smfmac_f32_16x16x32_bf16 v[160:163], v[252:253], v[212:215], v10 abid:2
    s_setpc_b64 s[76:77]
    v_smfmac_f32_16x16x32_bf16 v[128:131], v[252:253], v[212:215], v10
    v_smfmac_f32_16x16x32_bf16 v[164:167], v[252:253], v[212:215], v10 abid:2
    s_setpc_b64 s[76:77]
    v_smfmac_f32_16x16x32_bf16 v[132:135], v[252:253], v[212:215], v10
    v_smfmac_f32_16x16x32_bf16 v[168:171], v[252:253], v[212:215], v10 abid:2
    s_setpc_b64 s[76:77]
    v_smfmac_f32_16x16x32_bf16 v[136:139], v[252:253], v[212:215], v10
    v_smfmac_f32_16x16x32_bf16 v[172:175], v[252:253], v[212:215], v10 abid:2
    s_setpc_b64 s[76:77]
    v_smfmac_f32_16x16x32_bf16 v[140:143], v[252:253], v[212:215], v10
    v_smfmac_f32_16x16x32_bf16 v[176:179], v[252:253], v[212:215], v10 abid:2
    s_setpc_b64 s[76:77]
    v_smfmac_f32_16x16x32_bf16 v[144:147], v[252:253], v[212:215], v10
    v_smfmac_f32_16x16x32_bf16 v[180:183], v[252:253], v[212:215], v10 abid:2
    s_setpc_b64 s[76:77]
    v_smfmac_f32_16x16x32_bf16 v[148:151], v[252:253], v[212:215], v10
    v_smfmac_f32_16x16x32_bf16 v[184:187], v[252:253], v[212:215], v10 abid:2
    s_setpc_b64 s[76:77]
    v_smfmac_f32_16x16x32_bf16 v[152:155], v[252:253], v[212:215], v10
    v_smfmac_f32_16x16x32_bf16 v[188:191], v[252:253], v[212:215], v10 abid:2
    s_setpc_b64 s[76:77]
    v_smfmac_f32_16x16x32_bf16 v[156:159], v[252:253], v[212:215], v10
    v_smfmac_f32_16x16x32_bf16 v[192:195], v[252:253], v[212:215], v10 abid:2
    s_setpc_b64 s[76:77]
M_ovl1:
    v_smfmac_f32_16x16x32_bf16 v[124:127], v[252:253], v[212:215], v10
    v_smfmac_f32_16x16x32_bf16 v[160:163], v[252:253], v[212:215], v10 abid:2
    s_setpc_b64 s[78:79]
    v_smfmac_f32_16x16x32_bf16 v[128:131], v[252:253], v[212:215], v10
    v_smfmac_f32_16x16x32_bf16 v[164:167], v[252:253], v[212:215], v10 abid:2
    s_setpc_b64 s[78:79]
    v_smfmac_f32_16x16x32_bf16 v[132:135], v[252:253], v[212:215], v10
    v_smfmac_f32_16x16x32_bf16 v[168:171], v[252:253], v[212:215], v10 abid:2
    s_setpc_b64 s[78:79]
    v_smfmac_f32_16x16x32_bf16 v[136:139], v[252:253], v[212:215], v10
    v_smfmac_f32_16x16x32_bf16 v[172:175], v[252:253], v[212:215], v10 abid:2
    s_setpc_b64 s[78:79]
    v_smfmac_f32_16x16x32_bf16 v[140:143], v[252:253], v[212:215], v10
    v_smfmac_f32_16x16x32_bf16 v[176:179], v[252:253], v[212:215], v10 abid:2
    s_setpc_b64 s[78:79]
    v_smfmac_f32_16x16x32_bf16 v[144:147], v[252:253], v[212:215], v10
    v_smfmac_f32_16x16x32_bf16 v[180:183], v[252:253], v[212:215], v10 abid:2
    s_setpc_b64 s[78:79]
    v_smfmac_f32_16x16x32_bf16 v[148:151], v[252:253], v[212:215], v10
    v_smfmac_f32_16x16x32_bf16 v[184:187], v[252:253], v[212:215], v10 abid:2
    s_setpc_b64 s[78:79]
    v_smfmac_f32_16x16x32_bf16 v[152:155], v[252:253], v[212:215], v10
    v_smfmac_f32_16x16x32_bf16 v[188:191], v[252:253], v[212:215], v10 abid:2
    s_setpc_b64 s[78:79]
    v_smfmac_f32_16x16x32_bf16 v[156:159], v[252:253], v[212:215], v10
    v_smfmac_f32_16x16x32_bf16 v[192:195], v[252:253], v[212:215], v10 abid:2
    s_setpc_b64 s[78:79]
M_ovl2:
    v_smfmac_f32_16x16x32_bf16 v[124:127], v[254:255], v[212:215], v10
    v_smfmac_f32_16x16x32_bf16 v[160:163], v[254:255], v[212:215], v10 abid:2
    s_setpc_b64 s[78:79]
    v_smfmac_f32_16x16x32_bf16 v[128:131], v[254:255], v[212:215], v10
    v_smfmac_f32_16x16x32_bf16 v[164:167], v[254:255], v[212:215], v10 abid:2
    s_setpc_b64 s[78:79]
    v_smfmac_f32_16x16x32_bf16 v[132:135], v[254:255], v[212:215], v10
    v_smfmac_f32_16x16x32_bf16 v[168:171], v[254:255], v[212:215], v10 abid:2
    s_setpc_b64 s[78:79]
    v_smfmac_f32_16x16x32_bf16 v[136:139], v[254:255], v[212:215], v10
    v_smfmac_f32_16x16x32_bf16 v[172:175], v[254:255], v[212:215], v10 abid:2
    s_setpc_b64 s[78:79]
    v_smfmac_f32_16x16x32_bf16 v[140:143], v[254:255], v[212:215], v10
    v_smfmac_f32_16x16x32_bf16 v[176:179], v[254:255], v[212:215], v10 abid:2
    s_setpc_b64 s[78:79]
    v_smfmac_f32_16x16x32_bf16 v[144:147], v[254:255], v[212:215], v10
    v_smfmac_f32_16x16x32_bf16 v[180:183], v[254:255], v[212:215], v10 abid:2
    s_setpc_b64 s[78:79]
    v_smfmac_f32_16x16x32_bf16 v[148:151], v[254:255], v[212:215], v10
    v_smfmac_f32_16x16x32_bf16 v[184:187], v[254:255], v[212:215], v10 abid:2
    s_setpc_b64 s[78:79]
    v_smfmac_f32_16x16x32_bf16 v[152:155], v[254:255], v[212:215], v10
    v_smfmac_f32_16x16x32_bf16 v[188:191], v[254:255], v[212:215], v10 abid:2
    s_setpc_b64 s[78:79]
    v_smfmac_f32_16x16x32_bf16 v[156:159], v[254:255], v[212:215], v10
    v_smfmac_f32_16x16x32_bf16 v[192:195], v[254:255], v[212:215], v10 abid:2
    s_setpc_b64 s[78:79]
M_ovn:
    s_setpc_b64 s[78:79]
M_slow:
    s_bitcmp1_b32 s46, 31
    s_cbranch_scc1 M_dense
    s_mov_b32 s56, s80
M_sl:
    s_lshl_b32 s57, s56, 6
    v_add_u32 v240, s57, v9
    ds_read_b128 v[248:251], v240 offset:9792
    s_waitcnt lgkmcnt(0)
    v_and_b32 v240, 0x3fff, v248
    v_and_b32 v241, 0x3fff, v250
    v_xad_u32 v240, v240, v3, v4
    v_xad_u32 v241, v241, v3, v4
    ds_read2st64_b32 v[244:245], v240 offset0:0 offset1:72
    ds_read2st64_b32 v[246:247], v241 offset0:0 offset1:72
    v_subrev_u32 v240, s29, v8
    v_bfe_u32 v240, v240, 4, 4
    s_waitcnt lgkmcnt(0)
    s_bitcmp1_b32 s27, 0
    s_cbranch_scc0 M_sle0
    v_lshrrev_b32 v242, 18, v248
    v_lshrrev_b32 v243, 18, v250
    v_or_b32 v241, 0, v240
    v_cmp_eq_u32 s[44:45], v242, v241
    v_cmp_eq_u32 s[54:55], v243, v241
    s_nop 0
    v_cndmask_b32 v242, 0, v249, s[44:45]
    v_cndmask_b32 v243, 0, v251, s[54:55]
    s_nop 1
    v_smfmac_f32_16x16x32_bf16 v[124:127], v[242:243], v[244:247], v10
    v_smfmac_f32_16x16x32_bf16 v[160:163], v[242:243], v[244:247], v10 abid:2
M_sle0:
    s_bitcmp1_b32 s27, 1
    s_cbranch_scc0 M_sle1
    v_lshrrev_b32 v242, 18, v248
    v_lshrrev_b32 v243, 18, v250
    v_or_b32 v241, 64, v240
    v_cmp_eq_u32 s[44:45], v242, v241
    v_cmp_eq_u32 s[54:55], v243, v241
    s_nop 0
    v_cndmask_b32 v242, 0, v249, s[44:45]
    v_cndmask_b32 v243, 0, v251, s[54:55]
    s_nop 1
    v_smfmac_f32_16x16x32_bf16 v[128:131], v[242:243], v[244:247], v10
    v_smfmac_f32_16x16x32_bf16 v[164:167], v[242:243], v[244:247], v10 abid:2
M_sle1:
    s_bitcmp1_b32 s27, 2
    s_cbranch_scc0 M_sle2
    v_lshrrev_b32 v242, 18, v248
    v_lshrrev_b32 v243, 18, v250
    v_or_b32 v241, 128, v240
    v_cmp_eq_u32 s[44:45], v242, v241
    v_cmp_eq_u32 s[54:55], v243, v241
    s_nop 0
    v_cndmask_b32 v242, 0, v249, s[44:45]
    v_cndmask_b32 v243, 0, v251, s[54:55]
    s_nop 1
    v_smfmac_f32_16x16x32_bf16 v[132:135], v[242:243], v[244:247], v10
    v_smfmac_f32_16x16x32_bf16 v[168:171], v[242:243], v[244:247], v10 abid:2
M_sle2:
    s_bitcmp1_b32 s27, 3
    s_cbranch_scc0 M_sle3
    v_lshrrev_b32 v242, 18, v248
    v_lshrrev_b32 v243, 18, v250
    v_or_b32 v241, 192, v240
    v_cmp_eq_u32 s[44:45], v242, v241
    v_cmp_eq_u32 s[54:55], v243, v241
    s_nop 0
    v_cndmask_b32 v242, 0, v249, s[44:45]
    v_cndmask_b32 v243, 0, v251, s[54:55]
    s_nop 1
    v_smfmac_f32_16x16x32_bf16 v[136:139], v[242:243], v[244:247], v10
    v_smfmac_f32_16x16x32_bf16 v[172:175], v[242:243], v[244:247], v10 abid:2
M_sle3:
    s_bitcmp1_b32 s27, 4
    s_cbranch_scc0 M_sle4
    v_lshrrev_b32 v242, 18, v248
    v_lshrrev_b32 v243, 18, v250
    v_or_b32 v241, 256, v240
    v_cmp_eq_u32 s[44:45], v242, v241
    v_cmp_eq_u32 s[54:55], v243, v241
    s_nop 0
    v_cndmask_b32 v242, 0, v249, s[44:45]
    v_cndmask_b32 v243, 0, v251, s[54:55]
    s_nop 1
    v_smfmac_f32_16x16x32_bf16 v[140:143], v[242:243], v[244:247], v10
    v_smfmac_f32_16x16x32_bf16 v[176:179], v[242:243], v[244:247], v10 abid:2
M_sle4:
    s_bitcmp1_b32 s27, 5
    s_cbranch_scc0 M_sle5
    v_lshrrev_b32 v242, 18, v248
    v_lshrrev_b32 v243, 18, v250
    v_or_b32 v241, 320, v240
    v_cmp_eq_u32 s[44:45], v242, v241
    v_cmp_eq_u32 s[54:55], v243, v241
    s_nop 0
    v_cndmask_b32 v242, 0, v249, s[44:45]
    v_cndmask_b32 v243, 0, v251, s[54:55]
    s_nop 1
    v_smfmac_f32_16x16x32_bf16 v[144:147], v[242:243], v[244:247], v10
    v_smfmac_f32_16x16x32_bf16 v[180:183], v[242:243], v[244:247], v10 abid:2
M_sle5:
    s_bitcmp1_b32 s27, 6
    s_cbranch_scc0 M_sle6
    v_lshrrev_b32 v242, 18, v248
    v_lshrrev_b32 v243, 18, v250
    v_or_b32 v241, 384, v240
    v_cmp_eq_u32 s[44:45], v242, v241
    v_cmp_eq_u32 s[54:55], v243, v241
    s_nop 0
    v_cndmask_b32 v242, 0, v249, s[44:45]
    v_cndmask_b32 v243, 0, v251, s[54:55]
    s_nop 1
    v_smfmac_f32_16x16x32_bf16 v[148:151], v[242:243], v[244:247], v10
    v_smfmac_f32_16x16x32_bf16 v[184:187], v[242:243], v[244:247], v10 abid:2
M_sle6:
    s_bitcmp1_b32 s27, 7
    s_cbranch_scc0 M_sle7
    v_lshrrev_b32 v242, 18, v248
    v_lshrrev_b32 v243, 18, v250
    v_or_b32 v241, 448, v240
    v_cmp_eq_u32 s[44:45], v242, v241
    v_cmp_eq_u32 s[54:55], v243, v241
    s_nop 0
    v_cndmask_b32 v242, 0, v249, s[44:45]
    v_cndmask_b32 v243, 0, v251, s[54:55]
    s_nop 1
    v_smfmac_f32_16x16x32_bf16 v[152:155], v[242:243], v[244:247], v10
    v_smfmac_f32_16x16x32_bf16 v[188:191], v[242:243], v[244:247], v10 abid:2
M_sle7:
    s_bitcmp1_b32 s27, 8
    s_cbranch_scc0 M_sle8
    v_lshrrev_b32 v242, 18, v248
    v_lshrrev_b32 v243, 18, v250
    v_or_b32 v241, 512, v240
    v_cmp_eq_u32 s[44:45], v242, v241
    v_cmp_eq_u32 s[54:55], v243, v241
    s_nop 0
    v_cndmask_b32 v242, 0, v249, s[44:45]
    v_cndmask_b32 v243, 0, v251, s[54:55]
    s_nop 1
    v_smfmac_f32_16x16x32_bf16 v[156:159], v[242:243], v[244:247], v10
    v_smfmac_f32_16x16x32_bf16 v[192:195], v[242:243], v[244:247], v10 abid:2
M_sle8:
    s_add_u32 s56, s56, 1
    s_cmp_lt_u32 s56, s46
    s_cbranch_scc1 M_sl
M_slx:
    s_nop 7
    s_cmp_eq_u32 s21, 1
    s_cbranch_scc1 M_slowrL
    s_cmp_eq_u32 s21, 2
    s_cbranch_scc1 M_slowrE0
    s_cmp_eq_u32 s21, 3
    s_cbranch_scc1 M_slowrQ
    s_cmp_eq_u32 s21, 4
    s_cbranch_scc1 M_slowrF
    s_branch M_slowr0
M_dense:
    s_mul_i32 s57, s20, 82944
    s_add_u32 s57, s57, 393216
    s_mov_b32 s56, 0
    v_mov_b32 v54, v1
    v_mov_b32 v55, v2
    v_subrev_u32 v252, s29, v8
M_dn0:
    ds_read_b128 v[244:247], v54 offset:0
    ds_read_b128 v[248:251], v55 offset:0
    v_add_u32 v54, 1024, v54
    v_add_u32 v55, 1024, v55
    buffer_load_dwordx4 v[240:243], v252, s[16:19], s57 offen sc1
    s_add_u32 s57, s57, 1024
    s_waitcnt vmcnt(0) lgkmcnt(0)
    v_smfmac_f32_16x16x64_bf16 v[124:127], v[240:243], v[244:251], v10
    buffer_load_dwordx4 v[240:243], v252, s[16:19], s57 offen sc1
    s_add_u32 s57, s57, 1024
    s_waitcnt vmcnt(0) lgkmcnt(0)
    v_smfmac_f32_16x16x64_bf16 v[128:131], v[240:243], v[244:251], v10
    buffer_load_dwordx4 v[240:243], v252, s[16:19], s57 offen sc1
    s_add_u32 s57, s57, 1024
    s_waitcnt vmcnt(0) lgkmcnt(0)
    v_smfmac_f32_16x16x64_bf16 v[132:135], v[240:243], v[244:251], v10
    buffer_load_dwordx4 v[240:243], v252, s[16:19], s57 offen sc1
    s_add_u32 s57, s57, 1024
    s_waitcnt vmcnt(0) lgkmcnt(0)
    v_smfmac_f32_16x16x64_bf16 v[136:139], v[240:243], v[244:251], v10
    buffer_load_dwordx4 v[240:243], v252, s[16:19], s57 offen sc1
    s_add_u32 s57, s57, 1024
    s_waitcnt vmcnt(0) lgkmcnt(0)
    v_smfmac_f32_16x16x64_bf16 v[140:143], v[240:243], v[244:251], v10
    buffer_load_dwordx4 v[240:243], v252, s[16:19], s57 offen sc1
    s_add_u32 s57, s57, 1024
    s_waitcnt vmcnt(0) lgkmcnt(0)
    v_smfmac_f32_16x16x64_bf16 v[144:147], v[240:243], v[244:251], v10
    buffer_load_dwordx4 v[240:243], v252, s[16:19], s57 offen sc1
    s_add_u32 s57, s57, 1024
    s_waitcnt vmcnt(0) lgkmcnt(0)
    v_smfmac_f32_16x16x64_bf16 v[148:151], v[240:243], v[244:251], v10
    buffer_load_dwordx4 v[240:243], v252, s[16:19], s57 offen sc1
    s_add_u32 s57, s57, 1024
    s_waitcnt vmcnt(0) lgkmcnt(0)
    v_smfmac_f32_16x16x64_bf16 v[152:155], v[240:243], v[244:251], v10
    buffer_load_dwordx4 v[240:243], v252, s[16:19], s57 offen sc1
    s_add_u32 s57, s57, 1024
    s_waitcnt vmcnt(0) lgkmcnt(0)
    v_smfmac_f32_16x16x64_bf16 v[156:159], v[240:243], v[244:251], v10
    s_add_u32 s56, s56, 1
    s_cmp_lt_u32 s56, 9
    s_cbranch_scc1 M_dn0
    s_mul_i32 s57, s20, 82944
    s_add_u32 s57, s57, 393216
    s_mov_b32 s56, 0
    v_mov_b32 v54, v1
    v_mov_b32 v55, v2
    v_subrev_u32 v252, s29, v8
M_dn1:
    ds_read_b128 v[244:247], v54 offset:18432
    ds_read_b128 v[248:251], v55 offset:18432
    v_add_u32 v54, 1024, v54
    v_add_u32 v55, 1024, v55
    buffer_load_dwordx4 v[240:243], v252, s[16:19], s57 offen sc1
    s_add_u32 s57, s57, 1024
    s_waitcnt vmcnt(0) lgkmcnt(0)
    v_smfmac_f32_16x16x64_bf16 v[160:163], v[240:243], v[244:251], v10
    buffer_load_dwordx4 v[240:243], v252, s[16:19], s57 offen sc1
    s_add_u32 s57, s57, 1024
    s_waitcnt vmcnt(0) lgkmcnt(0)
    v_smfmac_f32_16x16x64_bf16 v[164:167], v[240:243], v[244:251], v10
    buffer_load_dwordx4 v[240:243], v252, s[16:19], s57 offen sc1
    s_add_u32 s57, s57, 1024
    s_waitcnt vmcnt(0) lgkmcnt(0)
    v_smfmac_f32_16x16x64_bf16 v[168:171], v[240:243], v[244:251], v10
    buffer_load_dwordx4 v[240:243], v252, s[16:19], s57 offen sc1
    s_add_u32 s57, s57, 1024
    s_waitcnt vmcnt(0) lgkmcnt(0)
    v_smfmac_f32_16x16x64_bf16 v[172:175], v[240:243], v[244:251], v10
    buffer_load_dwordx4 v[240:243], v252, s[16:19], s57 offen sc1
    s_add_u32 s57, s57, 1024
    s_waitcnt vmcnt(0) lgkmcnt(0)
    v_smfmac_f32_16x16x64_bf16 v[176:179], v[240:243], v[244:251], v10
    buffer_load_dwordx4 v[240:243], v252, s[16:19], s57 offen sc1
    s_add_u32 s57, s57, 1024
    s_waitcnt vmcnt(0) lgkmcnt(0)
    v_smfmac_f32_16x16x64_bf16 v[180:183], v[240:243], v[244:251], v10
    buffer_load_dwordx4 v[240:243], v252, s[16:19], s57 offen sc1
    s_add_u32 s57, s57, 1024
    s_waitcnt vmcnt(0) lgkmcnt(0)
    v_smfmac_f32_16x16x64_bf16 v[184:187], v[240:243], v[244:251], v10
    buffer_load_dwordx4 v[240:243], v252, s[16:19], s57 offen sc1
    s_add_u32 s57, s57, 1024
    s_waitcnt vmcnt(0) lgkmcnt(0)
    v_smfmac_f32_16x16x64_bf16 v[188:191], v[240:243], v[244:251], v10
    buffer_load_dwordx4 v[240:243], v252, s[16:19], s57 offen sc1
    s_add_u32 s57, s57, 1024
    s_waitcnt vmcnt(0) lgkmcnt(0)
    v_smfmac_f32_16x16x64_bf16 v[192:195], v[240:243], v[244:251], v10
    s_add_u32 s56, s56, 1
    s_cmp_lt_u32 s56, 9
    s_cbranch_scc1 M_dn1
    s_branch M_slx
M_codeend:
.section .rodata,"a"
.p2align 6
.amdhsa_kernel standalone__structured_sparse_n_m__ragged_kernel
  .amdhsa_next_free_vgpr 512
  .amdhsa_next_free_sgpr 102
  .amdhsa_accum_offset 256
  .amdhsa_group_segment_fixed_size 0
  .amdhsa_kernarg_size 48
  .amdhsa_user_sgpr_count 2
  .amdhsa_user_sgpr_kernarg_segment_ptr 1
  .amdhsa_system_sgpr_workgroup_id_x 1
  .amdhsa_float_denorm_mode_32 3
.end_amdhsa_kernel
```

```asm
; @launch grid=(256,1,1) block=(256,1,1) lds=162064
.amdgcn_target "amdgcn-amd-amdhsa--gfx950"
.text
.globl standalone__structured_sparse_n_m__ragged_kernel
.p2align 8
.type standalone__structured_sparse_n_m__ragged_kernel,@function
standalone__structured_sparse_n_m__ragged_kernel:
    s_cmp_ge_u32 s2, 256
    s_cbranch_scc1 M_end
    s_load_dwordx8 s[72:79], s[0:1], 0
    s_load_dwordx4 s[80:83], s[0:1], 32
    s_getpc_b64 s[84:85]
    s_lshr_b32 s30, s2, 3
    s_and_b32 s30, s30, 15
    s_lshl_b32 s30, s30, 11
    s_and_b32 s84, s84, 0xffffff00
    s_cmp_ge_u32 s2, 88
    s_cselect_b32 s86, M_codeend-standalone__structured_sparse_n_m__ragged_kernel, 0
    s_mov_b32 s87, 0x20000
    v_lshlrev_b32 v254, 3, v0
    s_mov_b32 exec_lo, 0x00010001
    s_mov_b32 exec_hi, 0x00010001
    buffer_load_dword v254, v254, s[84:87], s30 offen
    s_mov_b64 exec, -1
    v_lshrrev_b32 v20, 6, v0
    v_and_b32 v12, 63, v0
    v_readfirstlane_b32 s20, v20
    v_lshrrev_b32 v22, 3, v0
    v_mul_u32_u24 v22, 1152, v22
    v_lshrrev_b32 v23, 4, v0
    v_xor_b32 v23, v23, v0
    v_and_b32 v23, 7, v23
    v_lshl_add_u32 v5, v23, 4, v22
    v_lshrrev_b32 v13, 4, v12
    v_and_b32 v14, 15, v12
    v_lshlrev_b32 v11, 4, v12
    v_lshlrev_b32 v54, 3, v12
    v_lshlrev_b32 v25, 4, v13
    v_lshlrev_b32 v26, 3, v13
    s_mov_b32 s6, 663552
    s_mov_b32 s7, 0x20000
    s_mov_b32 s10, 75497472
    s_mov_b32 s11, s7
    s_mov_b32 s18, 791552
    s_mov_b32 s19, s7
    s_movk_i32 s70, 256
    s_mov_b32 s71, s7
    s_movk_i32 s86, 1152
    s_mov_b32 s87, s7
    s_mov_b32 s98, 0
    s_mul_i32 s96, s20, 16
    s_and_b32 s97, s2, 15
    s_add_u32 s96, s96, s97
    s_lshl_b32 s96, s96, 8
    s_add_u32 s96, s96, 726016
    s_mul_i32 s22, s2, 36864
    s_mul_i32 s26, s20, 9216
    s_mov_b32 s24, s22
    s_mov_b32 s42, s26
    s_lshl_b32 s28, s20, 8
    s_lshl_b32 s97, s20, 5
    s_cmp_lt_u32 s2, 81
    s_cbranch_scc0 M_x1
    s_mul_i32 s32, s2, 57
    s_lshr_b32 s32, s32, 9
    s_mul_i32 s33, s32, 9
    s_sub_u32 s33, s2, s33
    s_mul_i32 s54, s32, 73728
    s_lshl_b32 s35, s33, 7
    s_add_u32 s54, s54, s35
    s_add_u32 s55, s54, 36864
    s_lshl_b32 s36, s20, 10
    s_add_u32 m0, s36, 73728
    s_lshr_b32 s30, s33, 1
    s_and_b32 s31, s33, 1
    s_lshl1_add_u32 s37, s32, s31
    s_mul_i32 s37, s37, 176
    s_mul_i32 s38, s32, 96
    s_add_u32 s38, s38, 3168
    s_cmp_lt_u32 s33, 8
    s_cselect_b32 s30, s30, s20
    s_cselect_b32 s37, s37, s38
    s_cselect_b32 s44, 2047, 63
    s_cselect_b32 s45, s20, 3
    s_cmp_eq_u32 s45, 3
    s_cselect_b32 s99, 791552, 0
    s_mul_i32 s48, s30, 98304
    s_add_u32 s37, s37, s48
    v_mov_b32 v44, 2.0
    v_mov_b32 v45, 0
    v_mov_b32 v46, 2.0
    v_mov_b32 v47, 0
    s_waitcnt lgkmcnt(0)
    s_mov_b64 s[4:5], s[74:75]
    buffer_load_dwordx4 v5, s[4:7], s54 offen lds
    s_add_u32 m0, m0, 4096
    s_mov_b32 s45, 0
    buffer_load_dwordx4 v5, s[4:7], s55 offen lds
    s_mov_b64 s[16:17], s[82:83]
    s_mov_b64 s[8:9], s[72:73]
    s_mov_b64 s[84:85], s[76:77]
    s_mov_b64 s[68:69], s[80:81]
    v_mov_b32 v10, 0
    s_mov_b64 exec, 1
    buffer_atomic_add v10, off, s[16:19], s96 sc0 sc1
    s_mov_b64 exec, -1
    s_mov_b64 exec, s[44:45]
    s_mov_b32 s18, s99
    buffer_store_dwordx4 v[44:47], v11, s[16:19], s37 offen sc1
    s_mov_b32 s18, 791552
    s_mov_b64 exec, -1
    s_mov_b32 m0, s42
    s_nop 0
    buffer_load_dwordx4 v5, s[8:11], s22 offen offset:0 nt lds
    s_add_u32 m0, m0, 896
    s_nop 0
    buffer_load_dwordx4 v5, s[8:11], s22 offen offset:128 nt lds
    s_add_u32 m0, m0, 896
    s_nop 0
    buffer_load_dwordx4 v5, s[8:11], s22 offen offset:256 nt lds
    s_lshl_b32 s34, s31, 2
    s_add_u32 s34, s34, s20
    s_lshr_b32 s35, s20, 1
    s_lshl_b32 s35, s35, 6
    s_and_b32 s36, s20, 1
    s_lshl_b32 s36, s36, 3
    s_add_u32 s35, s35, s36
    s_lshl_b32 s36, s20, 5
    s_mul_i32 s39, s32, 10240
    s_add_u32 s39, s39, 6144
    s_lshl_b32 s40, s34, 1
    s_add_u32 s40, s40, s39
    s_lshl_b32 s38, s32, 1
    s_cmp_eq_u32 s32, 8
    s_cselect_b32 s38, 1024, s38
    s_add_u32 s38, s38, 4096
    s_cmp_lt_u32 s33, 8
    s_cselect_b32 s34, s34, 8
    s_cselect_b32 s35, s35, s36
    s_cselect_b32 s36, 4, 3
    s_cselect_b32 s40, s40, s38
    s_cselect_b32 s46, 0, s20
    s_cselect_b32 s47, 22, 12
    s_add_u32 s40, s40, s48
    s_lshl_b32 s38, s34, 10
    s_add_u32 s39, s39, s38
    s_add_u32 s39, s39, s48
    s_add_u32 s39, s39, 1024
    v_and_b32 v15, 3, v14
    v_lshlrev_b32 v15, s36, v15
    v_add_u32 v15, s35, v15
    v_lshrrev_b32 v16, 3, v14
    v_lshlrev_b32 v16, 4, v16
    v_xor_b32 v15, v15, v16
    v_lshrrev_b32 v16, 2, v14
    v_lshl_add_u32 v16, v13, 4, v16
    v_lshl_add_u32 v15, v16, 7, v15
    v_add_u32 v24, 73728, v15
    v_xor_b32 v27, 32, v24
    v_xor_b32 v28, 64, v24
    v_xor_b32 v29, 0x60, v24
    s_lshl_b32 s31, s46, 2
    s_add_u32 s31, s31, 81920
    v_mov_b32 v60, s31
    v_mov_b32 v61, 1
    ds_write_b32 v60, v61
    s_mul_i32 s49, s30, 81
    s_mul_i32 s31, s32, 9
    s_add_u32 s49, s49, s31
    s_add_u32 s49, s49, s34
    s_lshl_b32 s49, s49, 10
    s_add_u32 s49, s49, 393216
    s_lshl_b32 s31, s34, 24
    s_lshl_b32 s38, s32, 10
    s_add_u32 s31, s31, s38
    v_lshlrev_b32 v31, 18, v14
    v_lshl_add_u32 v31, v13, 5, v31
    v_add_u32 v31, s31, v31
    s_mov_b32 s50, 3437096686
    s_mov_b32 s51, 1150609561
    s_mov_b32 s52, 0x00010001
    s_mov_b32 s53, 0x00200010
    s_mov_b32 s38, 0x0202
    s_mul_i32 s57, s30, 4096
    s_add_u32 s57, s57, 726016
    s_cmp_eq_u32 s33, 8
    s_cselect_b32 s56, 0, s20
    s_cmp_eq_u32 s20, 0
    s_cselect_b32 s98, 1, 0
    v_add_u32 v74, 81984, v54
    v_lshl_add_u32 v73, s20, 1, v74
    v_mov_b32 v41, 0x01000100
    v_mov_b32 v40, 0
    v_mov_b32 v63, -2.0
    s_waitcnt vmcnt(5) lgkmcnt(0)
    s_barrier
    ds_read_b64_tr_b16 v[16:17], v24
    ds_read_b64_tr_b16 v[18:19], v27 offset:512
    ds_read_b64_tr_b16 v[20:21], v28 offset:1024
    ds_read_b64_tr_b16 v[22:23], v29 offset:1536
    s_waitcnt lgkmcnt(3)
    v_and_b32 v44, 0x7fff7fff, v16
    v_and_b32 v45, 0x7fff7fff, v17
    v_pk_max_u16 v46, v44, v45
    v_pk_min_u16 v47, v44, v45
    v_pk_min_u16 v46, v46, v46 op_sel:[0,1] op_sel_hi:[1,0]
    v_pk_max_u16 v47, v47, v47 op_sel:[0,1] op_sel_hi:[1,0]
    v_pk_max_u16 v46, v46, s52
    v_pk_max_u16 v46, v46, v47
    v_pk_sub_i16 v44, v44, v46
    v_pk_sub_i16 v45, v45, v46
    v_pk_ashrrev_i16 v44, 15, v44 op_sel_hi:[0,1]
    v_pk_ashrrev_i16 v45, 15, v45 op_sel_hi:[0,1]
    v_alignbit_b32 v47, -1, v44, 16
    v_alignbit_b32 v46, v45, v45, 16
    v_and_b32 v48, 0x00080004, v44
    v_bitop3_b32 v46, v45, v46, v47 bitop3:0xe8
    v_and_or_b32 v64, v45, s53, v48
    v_bitop3_b32 v36, v16, v44, v46 bitop3:0x10
    v_min_u32 v68, 1, v36
    s_waitcnt lgkmcnt(2)
    v_and_b32 v44, 0x7fff7fff, v18
    v_and_b32 v45, 0x7fff7fff, v19
    v_pk_max_u16 v46, v44, v45
    v_pk_min_u16 v47, v44, v45
    v_pk_min_u16 v46, v46, v46 op_sel:[0,1] op_sel_hi:[1,0]
    v_pk_max_u16 v47, v47, v47 op_sel:[0,1] op_sel_hi:[1,0]
    v_pk_max_u16 v46, v46, s52
    v_pk_max_u16 v46, v46, v47
    v_pk_sub_i16 v44, v44, v46
    v_pk_sub_i16 v45, v45, v46
    v_pk_ashrrev_i16 v44, 15, v44 op_sel_hi:[0,1]
    v_pk_ashrrev_i16 v45, 15, v45 op_sel_hi:[0,1]
    v_alignbit_b32 v47, -1, v44, 16
    v_alignbit_b32 v46, v45, v45, 16
    v_and_b32 v48, 0x00080004, v44
    v_bitop3_b32 v46, v45, v46, v47 bitop3:0xe8
    v_and_or_b32 v65, v45, s53, v48
    v_bitop3_b32 v37, v18, v44, v46 bitop3:0x10
    v_min_u32 v69, 1, v37
    s_waitcnt lgkmcnt(1)
    v_and_b32 v44, 0x7fff7fff, v20
    v_and_b32 v45, 0x7fff7fff, v21
    v_pk_max_u16 v46, v44, v45
    v_pk_min_u16 v47, v44, v45
    v_pk_min_u16 v46, v46, v46 op_sel:[0,1] op_sel_hi:[1,0]
    v_pk_max_u16 v47, v47, v47 op_sel:[0,1] op_sel_hi:[1,0]
    v_pk_max_u16 v46, v46, s52
    v_pk_max_u16 v46, v46, v47
    v_pk_sub_i16 v44, v44, v46
    v_pk_sub_i16 v45, v45, v46
    v_pk_ashrrev_i16 v44, 15, v44 op_sel_hi:[0,1]
    v_pk_ashrrev_i16 v45, 15, v45 op_sel_hi:[0,1]
    v_alignbit_b32 v47, -1, v44, 16
    v_alignbit_b32 v46, v45, v45, 16
    v_and_b32 v48, 0x00080004, v44
    v_bitop3_b32 v46, v45, v46, v47 bitop3:0xe8
    v_and_or_b32 v66, v45, s53, v48
    v_bitop3_b32 v38, v20, v44, v46 bitop3:0x10
    v_min_u32 v70, 1, v38
    s_waitcnt lgkmcnt(0)
    v_and_b32 v44, 0x7fff7fff, v22
    v_and_b32 v45, 0x7fff7fff, v23
    v_pk_max_u16 v46, v44, v45
    v_pk_min_u16 v47, v44, v45
    v_pk_min_u16 v46, v46, v46 op_sel:[0,1] op_sel_hi:[1,0]
    v_pk_max_u16 v47, v47, v47 op_sel:[0,1] op_sel_hi:[1,0]
    v_pk_max_u16 v46, v46, s52
    v_pk_max_u16 v46, v46, v47
    v_pk_sub_i16 v44, v44, v46
    v_pk_sub_i16 v45, v45, v46
    v_pk_ashrrev_i16 v44, 15, v44 op_sel_hi:[0,1]
    v_pk_ashrrev_i16 v45, 15, v45 op_sel_hi:[0,1]
    v_alignbit_b32 v47, -1, v44, 16
    v_alignbit_b32 v46, v45, v45, 16
    v_and_b32 v48, 0x00080004, v44
    v_bitop3_b32 v46, v45, v46, v47 bitop3:0xe8
    v_and_or_b32 v67, v45, s53, v48
    v_bitop3_b32 v39, v22, v44, v46 bitop3:0x10
    v_min_u32 v71, 1, v39
    v_add_u32 v72, v68, v69
    v_add3_u32 v72, v72, v70, v71
    buffer_store_dwordx4 v[36:39], v11, s[16:19], s49 offen sc1
    v_cmp_ne_u32 vcc, 0, v72
    s_and_saveexec_b64 s[44:45], vcc
    ds_add_rtn_u32 v62, v60, v72
    s_mov_b64 exec, -1
    v_lshrrev_b32 v48, 16, v64
    v_or_b32 v48, v48, v64
    v_lshrrev_b64 v[52:53], v48, s[50:51]
    v_and_b32 v64, 15, v52
    v_lshl_or_b32 v40, v64, 0, v40
    v_lshrrev_b32 v48, 16, v65
    v_or_b32 v48, v48, v65
    v_lshrrev_b64 v[52:53], v48, s[50:51]
    v_and_b32 v65, 15, v52
    v_lshl_or_b32 v40, v65, 4, v40
    v_lshrrev_b32 v48, 16, v66
    v_or_b32 v48, v48, v66
    v_lshrrev_b64 v[52:53], v48, s[50:51]
    v_and_b32 v66, 15, v52
    v_lshl_or_b32 v40, v66, 8, v40
    v_lshrrev_b32 v48, 16, v67
    v_or_b32 v48, v48, v67
    v_lshrrev_b64 v[52:53], v48, s[50:51]
    v_and_b32 v67, 15, v52
    v_lshl_or_b32 v40, v67, 12, v40
    v_lshrrev_b32 v44, 2, v40
    v_lshlrev_b32 v45, 2, v40
    s_movk_i32 s31, 0x3333
    v_not_b32 v47, v40
    v_bfi_b32 v44, s31, v44, v45
    s_movk_i32 s31, 0x1111
    s_nop 0
    v_mov_b32_dpp v47, v44 row_shr:4 row_mask:0xf bank_mask:0xf
    v_xor_b32 v47, v47, v40
    v_lshrrev_b32 v45, 1, v47
    v_or_b32 v47, v47, v45
    v_lshrrev_b32 v45, 2, v47
    v_bitop3_b32 v47, v47, v45, s31 bitop3:0x2a
    s_nop 1
    v_xor_b32_dpp v47, v47, v47 row_shr:4 row_mask:0xf bank_mask:0xe
    s_nop 1
    v_xor_b32_dpp v47, v47, v47 row_shr:8 row_mask:0xf bank_mask:0xc
    v_mul_u32_u24 v47, 15, v47
    v_bfi_b32 v40, v47, v44, v40
    ds_write_b16 v73, v40
    v_bfe_u32 v64, v40, 0, 4
    v_mul_u32_u24 v46, 0x4001, v64
    v_and_b32 v46, 0x30003, v46
    v_mad_u32_u24 v46, v46, s38, v41
    v_perm_b32 v32, v17, v16, v46
    v_bfe_u32 v65, v40, 4, 4
    v_mul_u32_u24 v46, 0x4001, v65
    v_and_b32 v46, 0x30003, v46
    v_mad_u32_u24 v46, v46, s38, v41
    v_perm_b32 v33, v19, v18, v46
    s_waitcnt vmcnt(4) lgkmcnt(0)
    s_barrier
    ds_read_b64 v[50:51], v74
    v_bfe_u32 v66, v40, 8, 4
    v_mul_u32_u24 v46, 0x4001, v66
    v_and_b32 v46, 0x30003, v46
    v_mad_u32_u24 v46, v46, s38, v41
    v_perm_b32 v34, v21, v20, v46
    v_bfe_u32 v67, v40, 12, 4
    v_mul_u32_u24 v46, 0x4001, v67
    v_and_b32 v46, 0x30003, v46
    v_mad_u32_u24 v46, v46, s38, v41
    v_perm_b32 v35, v23, v22, v46
    buffer_store_dwordx4 v[32:35], v11, s[16:19], s39 offen sc1
    s_cmp_eq_u32 s33, 8
    s_cbranch_scc0 F_i1
    buffer_store_short v40, v11, s[16:19], s40 offen sc1
    s_branch F_i2
F_i1:
    s_cmp_eq_u32 s20, 0
    s_cbranch_scc0 F_i2
    s_waitcnt lgkmcnt(0)
    buffer_store_dwordx2 v[50:51], v11, s[16:19], s40 offen sc1
F_i2:
    s_cbranch_vccz F_z
    v_cmp_ne_u32 vcc, 0, v36
    s_and_saveexec_b64 s[44:45], vcc
    s_cbranch_execz F_e0
    v_cmp_gt_u32 vcc, s47, v62
    v_add_u32 v42, 0, v31
    v_lshlrev_b32 v44, 3, v62
    v_add_u32 v62, 1, v62
    v_cndmask_b32 v42, v63, v42, vcc
    v_cndmask_b32 v43, 0, v36, vcc
    v_cndmask_b32 v44, 0, v44, vcc
    buffer_store_dwordx2 v[42:43], v44, s[16:19], s37 offen sc1
F_e0:
    s_mov_b64 exec, -1
    v_cmp_ne_u32 vcc, 0, v37
    s_and_saveexec_b64 s[44:45], vcc
    s_cbranch_execz F_e1
    v_cmp_gt_u32 vcc, s47, v62
    v_add_u32 v42, 8, v31
    v_lshlrev_b32 v44, 3, v62
    v_add_u32 v62, 1, v62
    v_cndmask_b32 v42, v63, v42, vcc
    v_cndmask_b32 v43, 0, v37, vcc
    v_cndmask_b32 v44, 0, v44, vcc
    buffer_store_dwordx2 v[42:43], v44, s[16:19], s37 offen sc1
F_e1:
    s_mov_b64 exec, -1
    v_cmp_ne_u32 vcc, 0, v38
    s_and_saveexec_b64 s[44:45], vcc
    s_cbranch_execz F_e2
    v_cmp_gt_u32 vcc, s47, v62
    v_add_u32 v42, 16, v31
    v_lshlrev_b32 v44, 3, v62
    v_add_u32 v62, 1, v62
    v_cndmask_b32 v42, v63, v42, vcc
    v_cndmask_b32 v43, 0, v38, vcc
    v_cndmask_b32 v44, 0, v44, vcc
    buffer_store_dwordx2 v[42:43], v44, s[16:19], s37 offen sc1
F_e2:
    s_mov_b64 exec, -1
    v_cmp_ne_u32 vcc, 0, v39
    s_and_saveexec_b64 s[44:45], vcc
    s_cbranch_execz F_e3
    v_cmp_gt_u32 vcc, s47, v62
    v_add_u32 v42, 24, v31
    v_lshlrev_b32 v44, 3, v62
    v_add_u32 v62, 1, v62
    v_cndmask_b32 v42, v63, v42, vcc
    v_cndmask_b32 v43, 0, v39, vcc
    v_cndmask_b32 v44, 0, v44, vcc
    buffer_store_dwordx2 v[42:43], v44, s[16:19], s37 offen sc1
F_e3:
    s_mov_b64 exec, -1
F_z:
    s_cmp_lg_u32 s2, 0
    s_cbranch_scc1 M_set
    v_mov_b32 v64, 0
    v_mov_b32 v65, 0
    v_mov_b32 v66, 0
    v_mov_b32 v67, 0
    s_mov_b32 s40, 724992
    buffer_store_dwordx4 v[64:67], v11, s[16:19], s40 offen sc1
    s_branch M_set
F_sig:
    v_lshlrev_b32 v30, 8, v12
    s_waitcnt vmcnt(0)
    s_barrier
    s_cmp_lg_u32 s56, 0
    s_cbranch_scc1 F_end
    s_bfm_b64 exec, 16, 0
    buffer_atomic_add v61, v30, s[16:19], s57 offen sc1
    s_mov_b64 exec, -1
    s_cmp_eq_u32 s98, 0
    s_cbranch_scc1 F_cnt
    s_mov_b32 s98, 0
    v_mov_b32 v250, 1
    s_mov_b64 exec, 1
    buffer_atomic_add v250, off, s[68:71], 0 offset:0 sc1
    s_mov_b64 exec, -1
    s_nop 3
F_cnt:
F_end:
    s_add_u32 m0, m0, 896
    s_nop 0
    buffer_load_dwordx4 v5, s[8:11], s22 offen offset:384 nt lds
    s_add_u32 m0, m0, 896
    s_nop 0
    buffer_load_dwordx4 v5, s[8:11], s22 offen offset:512 nt lds
    s_branch M_x2
M_x1:
    s_waitcnt lgkmcnt(0)
    s_mov_b64 s[4:5], s[74:75]
    s_mov_b64 s[16:17], s[82:83]
    s_mov_b64 s[8:9], s[72:73]
    s_mov_b64 s[84:85], s[76:77]
    s_mov_b64 s[68:69], s[80:81]
    v_mov_b32 v10, 0
    s_mov_b64 exec, 1
    buffer_atomic_add v10, off, s[16:19], s96 sc0 sc1
    s_mov_b64 exec, -1
    s_mov_b32 m0, s42
    s_nop 0
    buffer_load_dwordx4 v5, s[8:11], s22 offen offset:0 nt lds
    s_add_u32 m0, m0, 896
    s_nop 0
    buffer_load_dwordx4 v5, s[8:11], s22 offen offset:128 nt lds
    s_add_u32 m0, m0, 896
    s_nop 0
    buffer_load_dwordx4 v5, s[8:11], s22 offen offset:256 nt lds
    s_add_u32 m0, m0, 896
    s_nop 0
    buffer_load_dwordx4 v5, s[8:11], s22 offen offset:384 nt lds
    s_add_u32 m0, m0, 896
    s_nop 0
    buffer_load_dwordx4 v5, s[8:11], s22 offen offset:512 nt lds
M_set:
    s_mov_b32 s12, s78
    s_mov_b32 s13, s79
    s_mov_b32 s14, 75497472
    s_mov_b32 s15, 0x20000
    s_mul_i32 s29, s20, 12864
    s_add_u32 s29, s29, 110592
    v_lshrrev_b32 v24, 1, v14
    v_and_b32 v27, 7, v14
    v_lshlrev_b32 v22, 7, v27
    v_lshl_or_b32 v3, v24, 4, v22
    v_lshrrev_b32 v23, 3, v14
    v_mul_u32_u24 v4, 9216, v23
    v_xad_u32 v1, v25, v3, v4
    v_xor_b32 v2, 64, v1
    v_add_u32 v9, s29, v25
    v_add_u32 v8, s29, v11
    v_mul_u32_u24 v24, 1152, v27
    v_lshl_add_u32 v24, v23, 6, v24
    v_add3_u32 v6, v24, v25, s28
    v_lshrrev_b32 v24, 3, v12
    v_xor_b32 v28, v24, v12
    v_and_b32 v28, 7, v28
    v_mul_u32_u24 v24, 1152, v24
    v_lshl_add_u32 v24, v28, 4, v24
    v_add_u32 v7, 1024, v24
    s_lshl_b32 s30, s20, 1
    v_lshrrev_b32 v24, 1, v13
    v_add_u32 v24, s30, v24
    v_xor_b32 v24, v24, v27
    v_lshl_add_u32 v24, v24, 4, v22
    v_and_b32 v28, 8, v26
    v_mul_u32_u24 v29, 12864, v23
    v_add3_u32 v24, v24, v28, v29
    v_add_u32 v53, 121408, v24
    s_lshr_b32 s30, s2, 3
    s_and_b32 s30, s30, 1
    s_mul_i32 s92, s30, 256
    s_add_u32 s92, s92, 562944
    s_add_u32 s30, s30, 768
    s_mul_i32 s93, s30, 36864
    s_mov_b32 s94, 73728
    s_and_b32 s95, s20, 1
    s_mul_i32 s95, s95, 9216
    s_add_u32 s59, s24, 9216
    s_mul_i32 s43, s20, 98304
    s_add_u32 s47, s29, 9216
    s_add_u32 s48, s29, 9792
    s_add_u32 s49, s29, 10112
    s_add_u32 s54, s29, 1073751872
    s_add_u32 s38, s26, 73728
    s_add_u32 s35, s38, 1024
    s_add_u32 s39, s38, 1536
    s_mov_b32 s40, s48
    s_add_u32 s41, s48, 256
    s_mov_b32 s50, 3130536464
    s_mov_b32 s51, 1164430831
    s_mov_b32 s52, 3696531472
    s_mov_b32 s53, 598435823
    v_mov_b32 v16, 0
    v_mov_b32 v17, 0
    v_mov_b32 v18, 0
    v_mov_b32 v19, 0
    v_cmp_gt_u32 s[44:45], 36, v12
    v_mov_b32 v20, 2.0
    s_nop 0
    v_cndmask_b32 v20, 0, v20, s[44:45]
    v_mov_b32 v21, v20
    v_mov_b32 v22, v20
    v_mov_b32 v23, v20
    v_mov_b32 v104, 1073741824
    v_mov_b32 v105, 0
    v_mov_b32 v106, 1073741824
    v_mov_b32 v107, 0
    v_lshl_add_u32 v121, v12, 2, s49
    v_add_u32 v55, s38, v54
    v_add_u32 v24, s38, v11
    ds_write_b128 v8, v[16:19] offset:0
    ds_write_b128 v8, v[16:19] offset:1024
    ds_write_b128 v8, v[16:19] offset:2048
    ds_write_b128 v8, v[16:19] offset:3072
    ds_write_b128 v8, v[16:19] offset:4096
    ds_write_b128 v8, v[16:19] offset:5120
    ds_write_b128 v8, v[16:19] offset:6144
    ds_write_b128 v8, v[16:19] offset:7168
    ds_write_b128 v8, v[16:19] offset:8192
    ds_write_b128 v24, v[104:107]
    ds_write_b128 v24, v[104:107] offset:1024
    ds_write_b128 v8, v[20:23] offset:9216
    s_cmp_lt_u32 s2, 81
    s_cbranch_scc1 F_sig
M_x2:
    s_add_u32 m0, m0, 896
    s_nop 0
    buffer_load_dwordx4 v5, s[8:11], s22 offen offset:640 nt lds
    s_add_u32 m0, m0, 896
    s_nop 0
    buffer_load_dwordx4 v5, s[8:11], s22 offen offset:768 nt lds
    s_add_u32 m0, m0, 896
    s_nop 0
    buffer_load_dwordx4 v5, s[8:11], s22 offen offset:896 nt lds
    s_add_u32 m0, m0, 896
    s_nop 0
    buffer_load_dwordx4 v5, s[8:11], s22 offen offset:1024 nt lds
    s_add_u32 s22, s22, 9437184
    s_add_u32 s42, s42, 36864
    buffer_load_dwordx4 v[196:199], v25, s[84:87], s28 offen offset:0
    buffer_load_dwordx4 v[200:203], v25, s[84:87], s28 offen offset:64
    buffer_load_dwordx4 v[204:207], v25, s[84:87], s28 offen offset:128
    buffer_load_dwordx4 v[208:211], v25, s[84:87], s28 offen offset:192
    buffer_load_dwordx2 v[212:213], v26, s[84:87], s97 offen offset:1024
    s_mov_b32 m0, s42
    s_nop 0
    buffer_load_dwordx4 v5, s[8:11], s22 offen offset:0 nt lds
    s_add_u32 m0, m0, 896
    s_nop 0
    buffer_load_dwordx4 v5, s[8:11], s22 offen offset:128 nt lds
    s_add_u32 m0, m0, 896
    s_nop 0
    buffer_load_dwordx4 v5, s[8:11], s22 offen offset:256 nt lds
    s_add_u32 m0, m0, 896
    s_nop 0
    buffer_load_dwordx4 v5, s[8:11], s22 offen offset:384 nt lds
    s_add_u32 m0, m0, 896
    s_nop 0
    buffer_load_dwordx4 v5, s[8:11], s22 offen offset:512 nt lds
    s_add_u32 m0, m0, 896
    s_nop 0
    buffer_load_dwordx4 v5, s[8:11], s22 offen offset:640 nt lds
    s_add_u32 m0, m0, 896
    s_nop 0
    buffer_load_dwordx4 v5, s[8:11], s22 offen offset:768 nt lds
    s_add_u32 m0, m0, 896
    s_nop 0
    buffer_load_dwordx4 v5, s[8:11], s22 offen offset:896 nt lds
    s_add_u32 m0, m0, 896
    s_nop 0
    buffer_load_dwordx4 v5, s[8:11], s22 offen offset:1024 nt lds
    s_add_u32 s22, s22, 9437184
    s_add_u32 s42, s42, 36864
    s_waitcnt vmcnt(3)
    v_mov_b32 v0, 0
    s_mov_b64 exec, 1
    buffer_atomic_add v0, off, s[16:19], s96 sc0 sc1
    s_mov_b64 exec, -1
    v_readlane_b32 s100, v10, 0
    v_mov_b32 v10, 0xeeee4444
    v_lshlrev_b32 v124, 16, v196
    v_and_b32 v125, 0xffff0000, v196
    v_lshlrev_b32 v126, 16, v197
    v_and_b32 v127, 0xffff0000, v197
    v_lshlrev_b32 v128, 16, v198
    v_and_b32 v129, 0xffff0000, v198
    v_lshlrev_b32 v130, 16, v199
    v_and_b32 v131, 0xffff0000, v199
    v_lshlrev_b32 v132, 16, v200
    v_and_b32 v133, 0xffff0000, v200
    v_lshlrev_b32 v134, 16, v201
    v_and_b32 v135, 0xffff0000, v201
    v_lshlrev_b32 v136, 16, v202
    v_and_b32 v137, 0xffff0000, v202
    v_lshlrev_b32 v138, 16, v203
    v_and_b32 v139, 0xffff0000, v203
    v_lshlrev_b32 v140, 16, v204
    v_and_b32 v141, 0xffff0000, v204
    v_lshlrev_b32 v142, 16, v205
    v_and_b32 v143, 0xffff0000, v205
    v_lshlrev_b32 v144, 16, v206
    v_and_b32 v145, 0xffff0000, v206
    v_lshlrev_b32 v146, 16, v207
    v_and_b32 v147, 0xffff0000, v207
    v_lshlrev_b32 v148, 16, v208
    v_and_b32 v149, 0xffff0000, v208
    v_lshlrev_b32 v150, 16, v209
    v_and_b32 v151, 0xffff0000, v209
    v_lshlrev_b32 v152, 16, v210
    v_and_b32 v153, 0xffff0000, v210
    v_lshlrev_b32 v154, 16, v211
    v_and_b32 v155, 0xffff0000, v211
    v_lshlrev_b32 v156, 16, v212
    v_and_b32 v157, 0xffff0000, v212
    v_lshlrev_b32 v158, 16, v213
    v_and_b32 v159, 0xffff0000, v213
    s_mov_b32 exec_lo, 0x00010001
    s_mov_b32 exec_hi, 0x00010001
    ds_write_b128 v9, v[124:127] offset:10240
    ds_write_b128 v9, v[128:131] offset:10304
    ds_write_b128 v9, v[132:135] offset:10368
    ds_write_b128 v9, v[136:139] offset:10432
    ds_write_b128 v9, v[140:143] offset:10496
    ds_write_b128 v9, v[144:147] offset:10560
    ds_write_b128 v9, v[148:151] offset:10624
    ds_write_b128 v9, v[152:155] offset:10688
    ds_write_b128 v9, v[156:159] offset:10752
    s_mov_b64 exec, -1
    s_mul_i32 s30, s20, 256
    s_xor_b32 s31, s2, 0
    s_add_u32 s30, s30, s31
    s_sub_u32 s30, s30, 0
    s_cmp_lt_u32 s2, 0
    s_cselect_b32 s30, 1023, s30
    s_lshl_b32 s30, s30, 1
    v_lshrrev_b32 v244, 5, v12
    v_add_u32 v248, s30, v244
    v_mov_b32 v244, -1
    v_mov_b32 v245, 0
    v_subrev_u32 v246, 682, v248
    v_cmp_gt_u32 vcc, 20, v246
    v_mov_b32 v247, 0
    s_nop 0
    v_cndmask_b32 v244, v244, v246, vcc
    v_cndmask_b32 v245, v245, v247, vcc
    v_subrev_u32 v246, 648, v248
    v_cmp_gt_u32 vcc, 34, v246
    v_mov_b32 v247, 1
    s_nop 0
    v_cndmask_b32 v244, v244, v246, vcc
    v_cndmask_b32 v245, v245, v247, vcc
    v_subrev_u32 v246, 600, v248
    v_cmp_gt_u32 vcc, 48, v246
    v_mov_b32 v247, 2
    s_nop 0
    v_cndmask_b32 v244, v244, v246, vcc
    v_cndmask_b32 v245, v245, v247, vcc
    v_subrev_u32 v246, 538, v248
    v_cmp_gt_u32 vcc, 62, v246
    v_mov_b32 v247, 3
    s_nop 0
    v_cndmask_b32 v244, v244, v246, vcc
    v_cndmask_b32 v245, v245, v247, vcc
    v_subrev_u32 v246, 460, v248
    v_cmp_gt_u32 vcc, 78, v246
    v_mov_b32 v247, 4
    s_nop 0
    v_cndmask_b32 v244, v244, v246, vcc
    v_cndmask_b32 v245, v245, v247, vcc
    v_subrev_u32 v246, 366, v248
    v_cmp_gt_u32 vcc, 94, v246
    v_mov_b32 v247, 5
    s_nop 0
    v_cndmask_b32 v244, v244, v246, vcc
    v_cndmask_b32 v245, v245, v247, vcc
    v_subrev_u32 v246, 258, v248
    v_cmp_gt_u32 vcc, 108, v246
    v_mov_b32 v247, 6
    s_nop 0
    v_cndmask_b32 v244, v244, v246, vcc
    v_cndmask_b32 v245, v245, v247, vcc
    v_subrev_u32 v246, 136, v248
    v_cmp_gt_u32 vcc, 122, v246
    v_mov_b32 v247, 7
    s_nop 0
    v_cndmask_b32 v244, v244, v246, vcc
    v_cndmask_b32 v245, v245, v247, vcc
    v_subrev_u32 v246, 0, v248
    v_cmp_gt_u32 vcc, 136, v246
    v_mov_b32 v247, 8
    s_nop 0
    v_cndmask_b32 v244, v244, v246, vcc
    v_cndmask_b32 v245, v245, v247, vcc
    v_sub_u32 v244, 2047, v244
    v_mul_u32_u24 v244, 36864, v244
    v_lshl_add_u32 v244, v245, 7, v244
    v_and_b32 v245, 31, v12
    v_mul_u32_u24 v245, 1152, v245
    v_add_u32 v249, v244, v245
    s_mov_b32 vcc_lo, 0xff00ff00
    s_mov_b32 vcc_hi, 0xff00ff00
    s_waitcnt vmcnt(0)
    v_readfirstlane_b32 s30, v0
    s_mov_b32 s31, 0
    s_sub_u32 s30, s30, s100
    s_cmp_eq_u32 s30, 27
    s_cbranch_scc0 M_pf_spin
M_pf_ok:
    s_lshr_b32 s30, s2, 3
    s_sub_u32 s31, s30, 11
    s_cselect_b32 s30, s30, s31
    s_mul_i32 s30, s30, 3072
    s_add_u32 s30, s30, s43
    s_add_u32 s30, s30, 33792
    v_lshlrev_b32 v244, 3, v11
    v_mov_b32 v0, v249
    buffer_load_dwordx4 v[92:95], v11, s[16:19], s43 offen offset:0 sc1
    buffer_load_dwordx4 v[96:99], v11, s[16:19], s43 offen offset:1024 sc1
    buffer_load_dwordx4 v[100:103], v11, s[16:19], s43 offen offset:2048 sc1
    s_mov_b32 exec_hi, 268435455
    buffer_load_dwordx4 v[104:107], v11, s[16:19], s43 offen offset:3072 sc1
    s_mov_b32 exec_hi, -1
    s_add_u32 s43, s43, 4096
    buffer_load_dwordx4 v[48:51], v11, s[16:19], s43 offen offset:0 sc1
    buffer_load_dword v52, v11, s[16:19], s43 offen offset:1024 sc1
    buffer_load_dwordx4 v[12:15], v11, s[16:19], s43 offen offset:2048 sc1
    buffer_load_dwordx4 a[0:3], v11, s[16:19], s43 offen offset:3072 sc1
    s_add_u32 s43, s43, 4096
    buffer_load_dwordx4 a[4:7], v11, s[16:19], s43 offen offset:0 sc1
    buffer_load_dwordx4 a[8:11], v11, s[16:19], s43 offen offset:1024 sc1
    buffer_load_dwordx4 a[12:15], v11, s[16:19], s43 offen offset:2048 sc1
    buffer_load_dwordx4 a[16:19], v11, s[16:19], s43 offen offset:3072 sc1
    s_add_u32 s43, s43, 4096
    s_bfm_b64 exec, 24, 0
    buffer_load_dword v244, v244, s[16:19], s30 offen sc1
    s_mov_b64 exec, -1
    buffer_load_dwordx4 a[20:23], v11, s[16:19], s43 offen offset:0 sc1
    buffer_load_dwordx4 a[24:27], v11, s[16:19], s43 offen offset:1024 sc1
    buffer_load_dwordx4 a[28:31], v11, s[16:19], s43 offen offset:2048 sc1
    buffer_load_dwordx4 a[32:35], v11, s[16:19], s43 offen offset:3072 sc1
    s_add_u32 s43, s43, 4096
    buffer_load_dwordx4 v[16:19], v11, s[16:19], s43 offen offset:0 sc1
    buffer_load_dwordx4 a[36:39], v11, s[16:19], s43 offen offset:1024 sc1
    buffer_load_dwordx4 a[40:43], v11, s[16:19], s43 offen offset:2048 sc1
    buffer_load_dwordx4 a[44:47], v11, s[16:19], s43 offen offset:3072 sc1
    s_add_u32 s43, s43, 4096
    buffer_load_dwordx4 a[48:51], v11, s[16:19], s43 offen offset:0 sc1
    buffer_load_dwordx4 a[52:55], v11, s[16:19], s43 offen offset:1024 sc1
    buffer_load_dwordx4 a[56:59], v11, s[16:19], s43 offen offset:2048 sc1
    buffer_load_dwordx4 a[60:63], v11, s[16:19], s43 offen offset:3072 sc1
    s_add_u32 s43, s43, 4096
    buffer_load_dwordx4 a[64:67], v11, s[16:19], s43 offen offset:0 sc1
    buffer_load_dwordx4 a[68:71], v11, s[16:19], s43 offen offset:1024 sc1
    buffer_load_dwordx4 v[20:23], v11, s[16:19], s43 offen offset:2048 sc1
    buffer_load_dwordx4 a[72:75], v11, s[16:19], s43 offen offset:3072 sc1
    s_add_u32 s43, s43, 4096
    buffer_load_dwordx4 a[76:79], v11, s[16:19], s43 offen offset:0 sc1
    buffer_load_dwordx4 a[80:83], v11, s[16:19], s43 offen offset:1024 sc1
    buffer_load_dwordx4 a[84:87], v11, s[16:19], s43 offen offset:2048 sc1
    buffer_load_dwordx4 a[88:91], v11, s[16:19], s43 offen offset:3072 sc1
    s_add_u32 s43, s43, 4096
    buffer_load_dwordx4 a[92:95], v11, s[16:19], s43 offen offset:0 sc1
    buffer_load_dwordx4 a[96:99], v11, s[16:19], s43 offen offset:1024 sc1
    buffer_load_dwordx4 a[100:103], v11, s[16:19], s43 offen offset:2048 sc1
    buffer_load_dwordx4 a[104:107], v11, s[16:19], s43 offen offset:3072 sc1
    s_add_u32 s43, s43, 4096
    buffer_load_dwordx4 v[24:27], v11, s[16:19], s43 offen offset:0 sc1
    buffer_load_dwordx4 a[108:111], v11, s[16:19], s43 offen offset:1024 sc1
    ds_read_b128 v[160:163], v9 offset:10240
    ds_read_b128 v[164:167], v9 offset:10304
    ds_read_b128 v[168:171], v9 offset:10368
    ds_read_b128 v[172:175], v9 offset:10432
    ds_read_b128 v[176:179], v9 offset:10496
    ds_read_b128 v[180:183], v9 offset:10560
    ds_read_b128 v[184:187], v9 offset:10624
    ds_read_b128 v[188:191], v9 offset:10688
    ds_read_b128 v[192:195], v9 offset:10752
    s_waitcnt vmcnt(31)
    s_barrier
    ds_read_b128 v[196:199], v1 offset:0
    ds_read_b128 v[200:203], v2 offset:0
    ds_read_b128 v[228:231], v1 offset:18432
    ds_read_b128 v[232:235], v2 offset:18432
    s_waitcnt lgkmcnt(2)
    v_smfmac_f32_16x16x64_bf16 v[124:127], a[0:3], v[196:203], v12
    buffer_load_dwordx4 a[112:115], v11, s[16:19], s43 offen offset:2048 sc1
    s_waitcnt lgkmcnt(0)
    v_mov_b32 v118, s54
    v_smfmac_f32_16x16x64_bf16 v[160:163], a[0:3], v[228:235], v12
    ds_read_b128 v[204:207], v1 offset:1024
    ds_read_b128 v[208:211], v2 offset:1024
    v_or3_b32 v114, v92, v96, v100
    v_or_b32 v114, v114, v104
    v_cmp_gt_i32 s[32:33], 0, v114
    v_cmp_gt_u32 s[36:37], 2.0, v92
    s_nop 1
    v_mbcnt_lo_u32_b32 v110, s36, 0
    s_waitcnt vmcnt(31)
    v_mbcnt_hi_u32_b32 v110, s37, v110
    v_smfmac_f32_16x16x64_bf16 v[128:131], a[4:7], v[196:203], v12 abid:1
    buffer_load_dwordx4 a[116:119], v11, s[16:19], s43 offen offset:3072 sc1
    v_lshl_add_u32 v110, v110, 3, s38
    v_smfmac_f32_16x16x64_bf16 v[164:167], a[4:7], v[228:235], v12 abid:1
    ds_read_b128 v[220:223], v1 offset:19456
    ds_read_b128 v[224:227], v2 offset:19456
    v_min_u32 v110, s39, v110
    s_waitcnt vmcnt(31)
    v_cndmask_b32 v110, v118, v110, s[36:37]
    v_smfmac_f32_16x16x64_bf16 v[132:135], a[8:11], v[196:203], v13
    s_add_u32 s43, s43, 4096
    buffer_load_dwordx4 a[120:123], v11, s[16:19], s43 offen offset:0 sc1
    ds_write_b64 v110, v[92:93]
    s_bcnt1_i32_b64 s30, s[36:37]
    s_lshl3_add_u32 s38, s30, s38
    v_cmp_gt_u32 s[44:45], 2.0, v94
    v_smfmac_f32_16x16x64_bf16 v[168:171], a[8:11], v[228:235], v13
    s_nop 0
    v_mbcnt_lo_u32_b32 v111, s44, 0
    v_mbcnt_hi_u32_b32 v111, s45, v111
    v_lshl_add_u32 v111, v111, 3, s38
    v_min_u32 v111, s39, v111
    s_waitcnt vmcnt(31)
    v_cndmask_b32 v111, v118, v111, s[44:45]
    v_smfmac_f32_16x16x64_bf16 v[136:139], a[12:15], v[196:203], v13 abid:1
    buffer_load_dwordx4 a[124:127], v11, s[16:19], s43 offen offset:1024 sc1
    ds_write_b64 v111, v[94:95]
    s_bcnt1_i32_b64 s30, s[44:45]
    s_lshl3_add_u32 s38, s30, s38
    v_cmp_gt_u32 s[36:37], 2.0, v96
    v_smfmac_f32_16x16x64_bf16 v[172:175], a[12:15], v[228:235], v13 abid:1
    s_nop 0
    v_mbcnt_lo_u32_b32 v110, s36, 0
    v_mbcnt_hi_u32_b32 v110, s37, v110
    v_lshl_add_u32 v110, v110, 3, s38
    s_waitcnt vmcnt(31)
    v_min_u32 v110, s39, v110
    v_smfmac_f32_16x16x64_bf16 v[140:143], a[16:19], v[196:203], v14
    buffer_load_dwordx4 a[128:131], v11, s[16:19], s43 offen offset:2048 sc1
    v_cndmask_b32 v110, v118, v110, s[36:37]
    v_smfmac_f32_16x16x64_bf16 v[176:179], a[16:19], v[228:235], v14
    ds_write_b64 v110, v[96:97]
    s_bcnt1_i32_b64 s30, s[36:37]
    s_lshl3_add_u32 s38, s30, s38
    v_cmp_gt_u32 s[44:45], 2.0, v98
    s_nop 1
    v_mbcnt_lo_u32_b32 v111, s44, 0
    s_waitcnt vmcnt(30)
    v_mbcnt_hi_u32_b32 v111, s45, v111
    v_smfmac_f32_16x16x64_bf16 v[144:147], a[20:23], v[196:203], v14 abid:1
    buffer_load_dwordx4 a[132:135], v11, s[16:19], s43 offen offset:3072 sc1
    v_lshl_add_u32 v111, v111, 3, s38
    v_smfmac_f32_16x16x64_bf16 v[180:183], a[20:23], v[228:235], v14 abid:1
    v_min_u32 v111, s39, v111
    s_waitcnt vmcnt(30)
    v_cndmask_b32 v111, v118, v111, s[44:45]
    v_smfmac_f32_16x16x64_bf16 v[148:151], a[24:27], v[196:203], v15
    s_add_u32 s43, s43, 4096
    buffer_load_dwordx4 a[136:139], v11, s[16:19], s43 offen offset:0 sc1
    ds_write_b64 v111, v[98:99]
    s_bcnt1_i32_b64 s30, s[44:45]
    s_lshl3_add_u32 s38, s30, s38
    v_cmp_gt_u32 s[36:37], 2.0, v100
    v_smfmac_f32_16x16x64_bf16 v[184:187], a[24:27], v[228:235], v15
    s_nop 0
    v_mbcnt_lo_u32_b32 v110, s36, 0
    v_mbcnt_hi_u32_b32 v110, s37, v110
    v_lshl_add_u32 v110, v110, 3, s38
    v_min_u32 v110, s39, v110
    s_waitcnt vmcnt(30)
    v_cndmask_b32 v110, v118, v110, s[36:37]
    v_smfmac_f32_16x16x64_bf16 v[152:155], a[28:31], v[196:203], v15 abid:1
    buffer_load_dwordx4 a[140:143], v11, s[16:19], s43 offen offset:1024 sc1
    ds_write_b64 v110, v[100:101]
    s_bcnt1_i32_b64 s30, s[36:37]
    s_lshl3_add_u32 s38, s30, s38
    v_cmp_gt_u32 s[44:45], 2.0, v102
    v_smfmac_f32_16x16x64_bf16 v[188:191], a[28:31], v[228:235], v15 abid:1
    s_nop 0
    v_mbcnt_lo_u32_b32 v111, s44, 0
    v_mbcnt_hi_u32_b32 v111, s45, v111
    v_lshl_add_u32 v111, v111, 3, s38
    s_waitcnt vmcnt(30)
    v_min_u32 v111, s39, v111
    v_smfmac_f32_16x16x64_bf16 v[156:159], a[32:35], v[196:203], v48
    buffer_load_dwordx4 v[28:31], v11, s[16:19], s43 offen offset:2048 sc1
    buffer_load_dwordx4 a[144:147], v11, s[16:19], s43 offen offset:3072 sc1
    v_cndmask_b32 v111, v118, v111, s[44:45]
    v_smfmac_f32_16x16x64_bf16 v[192:195], a[32:35], v[228:235], v48
    ds_write_b64 v111, v[102:103]
    s_bcnt1_i32_b64 s30, s[44:45]
    s_lshl3_add_u32 s38, s30, s38
    v_cmp_gt_u32 s[36:37], 2.0, v104
    s_nop 1
    s_waitcnt vmcnt(30)
    s_waitcnt lgkmcnt(8)
    v_mbcnt_lo_u32_b32 v110, s36, 0
    v_smfmac_f32_16x16x64_bf16 v[124:127], a[36:39], v[204:211], v16
    s_add_u32 s43, s43, 4096
    buffer_load_dwordx4 a[148:151], v11, s[16:19], s43 offen offset:0 sc1
    s_waitcnt lgkmcnt(6)
    v_mbcnt_hi_u32_b32 v110, s37, v110
    v_smfmac_f32_16x16x64_bf16 v[160:163], a[36:39], v[220:227], v16
    ds_read_b128 v[196:199], v1 offset:2048
    ds_read_b128 v[200:203], v2 offset:2048
    v_lshl_add_u32 v110, v110, 3, s38
    v_min_u32 v110, s39, v110
    s_waitcnt vmcnt(30)
    v_cndmask_b32 v110, v118, v110, s[36:37]
    v_smfmac_f32_16x16x64_bf16 v[128:131], a[40:43], v[204:211], v16 abid:1
    buffer_load_dwordx4 a[152:155], v11, s[16:19], s43 offen offset:1024 sc1
    ds_write_b64 v110, v[104:105]
    s_bcnt1_i32_b64 s30, s[36:37]
    s_lshl3_add_u32 s38, s30, s38
    v_cmp_gt_u32 s[44:45], 2.0, v106
    v_smfmac_f32_16x16x64_bf16 v[164:167], a[40:43], v[220:227], v16 abid:1
    ds_read_b128 v[228:231], v1 offset:20480
    ds_read_b128 v[232:235], v2 offset:20480
    v_mbcnt_lo_u32_b32 v111, s44, 0
    v_mbcnt_hi_u32_b32 v111, s45, v111
    v_lshl_add_u32 v111, v111, 3, s38
    v_min_u32 v111, s39, v111
    s_waitcnt vmcnt(30)
    v_cndmask_b32 v111, v118, v111, s[44:45]
    v_smfmac_f32_16x16x64_bf16 v[132:135], a[44:47], v[204:211], v17
    buffer_load_dwordx4 a[156:159], v11, s[16:19], s43 offen offset:2048 sc1
    ds_write_b64 v111, v[106:107]
    s_bcnt1_i32_b64 s30, s[44:45]
    s_lshl3_add_u32 s38, s30, s38
    ds_read_b64 v[92:93], v55 offset:0
    ds_read_b64 v[94:95], v55 offset:512
    ds_read_b64 v[96:97], v55 offset:1024
    v_smfmac_f32_16x16x64_bf16 v[168:171], a[44:47], v[220:227], v17
    s_waitcnt vmcnt(30)
    v_smfmac_f32_16x16x64_bf16 v[136:139], a[48:51], v[204:211], v17 abid:1
    buffer_load_dwordx4 a[160:163], v11, s[16:19], s43 offen offset:3072 sc1
    v_smfmac_f32_16x16x64_bf16 v[172:175], a[48:51], v[220:227], v17 abid:1
    s_waitcnt vmcnt(30)
    v_smfmac_f32_16x16x64_bf16 v[140:143], a[52:55], v[204:211], v18
    s_add_u32 s43, s43, 4096
    buffer_load_dwordx4 a[164:167], v11, s[16:19], s43 offen offset:0 sc1
    s_waitcnt lgkmcnt(2)
    v_bfe_u32 v110, v92, 24, 4
    v_smfmac_f32_16x16x64_bf16 v[176:179], a[52:55], v[220:227], v18
    v_lshlrev_b32 v111, 1, v92
    v_lshl_add_u32 v110, v110, 2, s49
    v_and_b32 v111, 16, v111
    s_waitcnt vmcnt(30)
    v_and_or_b32 v110, v92, 2.0, v110
    v_smfmac_f32_16x16x64_bf16 v[144:147], a[56:59], v[204:211], v18 abid:1
    buffer_load_dwordx4 a[168:171], v11, s[16:19], s43 offen offset:1024 sc1
    v_lshlrev_b32 v111, v111, 1
    v_smfmac_f32_16x16x64_bf16 v[180:183], a[56:59], v[220:227], v18 abid:1
    ds_add_rtn_u32 v98, v110, v111
    s_waitcnt lgkmcnt(2)
    v_bfe_u32 v112, v94, 24, 4
    v_lshlrev_b32 v113, 1, v94
    v_lshl_add_u32 v112, v112, 2, s49
    s_waitcnt vmcnt(30)
    v_and_b32 v113, 16, v113
    v_smfmac_f32_16x16x64_bf16 v[148:151], a[60:63], v[204:211], v19
    buffer_load_dwordx4 a[172:175], v11, s[16:19], s43 offen offset:2048 sc1
    v_and_or_b32 v112, v94, 2.0, v112
    v_smfmac_f32_16x16x64_bf16 v[184:187], a[60:63], v[220:227], v19
    s_waitcnt vmcnt(30)
    v_lshlrev_b32 v113, v113, 1
    v_smfmac_f32_16x16x64_bf16 v[152:155], a[64:67], v[204:211], v19 abid:1
    buffer_load_dwordx4 a[176:179], v11, s[16:19], s43 offen offset:3072 sc1
    ds_add_rtn_u32 v99, v112, v113
    s_waitcnt lgkmcnt(2)
    s_cmp_gt_u32 s38, s35
    s_cbranch_scc1 M_r3
M_r3r:
    ds_read_b32 v117, v121
    v_and_b32 v110, 8, v92
    v_smfmac_f32_16x16x64_bf16 v[188:191], a[64:67], v[220:227], v19 abid:1
    v_lshrrev_b32 v113, 14, v92
    v_cmp_ne_u32 s[44:45], 0, v110
    v_and_b32 v116, 0x3cf0, v113
    s_waitcnt lgkmcnt(2)
    v_lshrrev_b32 v111, 16, v98
    v_and_b32 v112, 0xffff, v98
    s_waitcnt vmcnt(30)
    v_sub_u32 v110, 15, v111
    v_smfmac_f32_16x16x64_bf16 v[156:159], a[68:71], v[204:211], v48 abid:1
    s_add_u32 s43, s43, 4096
    buffer_load_dwordx4 v[32:35], v11, s[16:19], s43 offen offset:0 sc1
    buffer_load_dwordx4 a[180:183], v11, s[16:19], s43 offen offset:1024 sc1
    v_and_b32 v98, 2.0, v92
    v_smfmac_f32_16x16x64_bf16 v[192:195], a[68:71], v[220:227], v48 abid:1
    v_add3_u32 v98, v112, v111, v98
    v_cndmask_b32 v110, v112, v110, s[44:45]
    v_cmp_gt_u32 s[44:45], 16, v98
    v_cmp_gt_u32 s[36:37], 2.0, v98
    v_lshlrev_b32 v110, 2, v110
    s_waitcnt vmcnt(30)
    v_lshrrev_b64 v[112:113], v110, s[50:51]
    v_smfmac_f32_16x16x64_bf16 v[124:127], a[72:75], v[196:203], v20
    buffer_load_dwordx4 a[184:187], v11, s[16:19], s43 offen offset:2048 sc1
    s_andn2_b64 s[36:37], s[36:37], s[44:45]
    v_lshrrev_b64 v[114:115], v110, s[52:53]
    v_smfmac_f32_16x16x64_bf16 v[160:163], a[72:75], v[228:235], v20
    ds_read_b128 v[204:207], v1 offset:3072
    ds_read_b128 v[208:211], v2 offset:3072
    v_bfe_u32 v110, v92, 24, 4
    v_mbcnt_lo_u32_b32 v111, s36, 0
    v_and_b32 v112, 15, v112
    v_mbcnt_hi_u32_b32 v111, s37, v111
    v_and_b32 v114, 15, v114
    s_waitcnt vmcnt(30)
    v_lshl_add_u32 v111, v111, 3, s40
    v_smfmac_f32_16x16x64_bf16 v[128:131], a[76:79], v[196:203], v20 abid:1
    buffer_load_dwordx4 a[188:191], v11, s[16:19], s43 offen offset:3072 sc1
    v_lshl_add_u32 v112, v110, 4, v112
    v_smfmac_f32_16x16x64_bf16 v[164:167], a[76:79], v[228:235], v20 abid:1
    ds_read_b128 v[220:223], v1 offset:21504
    ds_read_b128 v[224:227], v2 offset:21504
    v_min_u32 v111, s41, v111
    v_mul_u32_u24 v114, 68, v114
    s_waitcnt vmcnt(30)
    v_cndmask_b32 v111, v118, v111, s[36:37]
    v_smfmac_f32_16x16x64_bf16 v[132:135], a[80:83], v[196:203], v21
    s_add_u32 s43, s43, 4096
    buffer_load_dwordx4 a[192:195], v11, s[16:19], s43 offen offset:0 sc1
    ds_write_b64 v111, v[92:93]
    s_bcnt1_i32_b64 s30, s[36:37]
    s_lshl3_add_u32 s40, s30, s40
    v_lshl_add_u32 v112, v112, 2, s47
    v_smfmac_f32_16x16x64_bf16 v[168:171], a[80:83], v[228:235], v21
    v_and_b32 v114, 0x30c, v114
    v_cndmask_b32 v112, v118, v112, s[44:45]
    v_add3_u32 v113, v116, v114, s29
    v_and_b32 v114, 0x3fff, v92
    s_waitcnt vmcnt(30)
    v_cndmask_b32 v110, v118, v113, s[44:45]
    v_smfmac_f32_16x16x64_bf16 v[136:139], a[84:87], v[196:203], v21 abid:1
    buffer_load_dwordx4 a[196:199], v11, s[16:19], s43 offen offset:1024 sc1
    ds_write_b32 v112, v114
    ds_write_b32 v110, v93
    v_and_b32 v110, 8, v94
    v_smfmac_f32_16x16x64_bf16 v[172:175], a[84:87], v[228:235], v21 abid:1
    v_lshrrev_b32 v113, 14, v94
    v_cmp_ne_u32 s[44:45], 0, v110
    v_and_b32 v116, 0x3cf0, v113
    s_waitcnt lgkmcnt(8)
    s_waitcnt vmcnt(30)
    v_lshrrev_b32 v111, 16, v99
    v_smfmac_f32_16x16x64_bf16 v[140:143], a[88:91], v[196:203], v22
    buffer_load_dwordx4 a[200:203], v11, s[16:19], s43 offen offset:2048 sc1
    v_and_b32 v112, 0xffff, v99
    v_smfmac_f32_16x16x64_bf16 v[176:179], a[88:91], v[228:235], v22
    v_sub_u32 v110, 15, v111
    v_and_b32 v99, 2.0, v94
    v_add3_u32 v99, v112, v111, v99
    v_cndmask_b32 v110, v112, v110, s[44:45]
    s_waitcnt vmcnt(30)
    v_cmp_gt_u32 s[44:45], 16, v99
    v_smfmac_f32_16x16x64_bf16 v[144:147], a[92:95], v[196:203], v22 abid:1
    buffer_load_dwordx4 a[204:207], v11, s[16:19], s43 offen offset:3072 sc1
    v_cmp_gt_u32 s[36:37], 2.0, v99
    v_smfmac_f32_16x16x64_bf16 v[180:183], a[92:95], v[228:235], v22 abid:1
    v_lshlrev_b32 v110, 2, v110
    s_waitcnt vmcnt(30)
    v_lshrrev_b64 v[112:113], v110, s[50:51]
    v_smfmac_f32_16x16x64_bf16 v[148:151], a[96:99], v[196:203], v23
    s_add_u32 s43, s43, 4096
    buffer_load_dwordx4 a[208:211], v11, s[16:19], s43 offen offset:0 sc1
    s_andn2_b64 s[36:37], s[36:37], s[44:45]
    v_lshrrev_b64 v[114:115], v110, s[52:53]
    v_smfmac_f32_16x16x64_bf16 v[184:187], a[96:99], v[228:235], v23
    v_bfe_u32 v110, v94, 24, 4
    v_mbcnt_lo_u32_b32 v111, s36, 0
    v_and_b32 v112, 15, v112
    v_mbcnt_hi_u32_b32 v111, s37, v111
    v_and_b32 v114, 15, v114
    s_waitcnt vmcnt(30)
    v_lshl_add_u32 v111, v111, 3, s40
    v_smfmac_f32_16x16x64_bf16 v[152:155], a[100:103], v[196:203], v23 abid:1
    buffer_load_dwordx4 a[212:215], v11, s[16:19], s43 offen offset:1024 sc1
    v_lshl_add_u32 v112, v110, 4, v112
    v_smfmac_f32_16x16x64_bf16 v[188:191], a[100:103], v[228:235], v23 abid:1
    v_min_u32 v111, s41, v111
    v_mul_u32_u24 v114, 68, v114
    s_waitcnt vmcnt(30)
    v_cndmask_b32 v111, v118, v111, s[36:37]
    v_smfmac_f32_16x16x64_bf16 v[156:159], a[104:107], v[196:203], v49
    buffer_load_dwordx4 v[36:39], v11, s[16:19], s43 offen offset:2048 sc1
    buffer_load_dwordx4 a[216:219], v11, s[16:19], s43 offen offset:3072 sc1
    ds_write_b64 v111, v[94:95]
    s_bcnt1_i32_b64 s30, s[36:37]
    s_lshl3_add_u32 s40, s30, s40
    v_lshl_add_u32 v112, v112, 2, s47
    v_smfmac_f32_16x16x64_bf16 v[192:195], a[104:107], v[228:235], v49
    v_and_b32 v114, 0x30c, v114
    v_cndmask_b32 v112, v118, v112, s[44:45]
    v_add3_u32 v113, v116, v114, s29
    v_and_b32 v114, 0x3fff, v94
    s_waitcnt vmcnt(30)
    s_waitcnt lgkmcnt(6)
    v_cndmask_b32 v110, v118, v113, s[44:45]
    v_smfmac_f32_16x16x64_bf16 v[124:127], a[108:111], v[204:211], v24
    s_add_u32 s43, s43, 4096
    buffer_load_dwordx4 a[220:223], v11, s[16:19], s43 offen offset:0 sc1
    ds_write_b32 v112, v114
    ds_write_b32 v110, v95
    s_waitcnt lgkmcnt(6)
    v_lshrrev_b32 v110, 16, v117
    v_smfmac_f32_16x16x64_bf16 v[160:163], a[108:111], v[220:227], v24
    ds_read_b128 v[196:199], v1 offset:4096
    ds_read_b128 v[200:203], v2 offset:4096
    v_and_b32 v117, 0xffff, v117
    v_add_u32 v117, v117, v110
    s_waitcnt vmcnt(30)
    v_cmp_lt_u32 s[34:35], 16, v117
    v_smfmac_f32_16x16x64_bf16 v[128:131], a[112:115], v[204:211], v24 abid:1
    buffer_load_dwordx4 a[224:227], v11, s[16:19], s43 offen offset:1024 sc1
    s_sub_u32 s46, s40, s48
    s_add_u32 s46, s46, 56
    s_lshr_b32 s46, s46, 6
    s_mov_b32 s21, 0
    s_and_b32 s27, s34, 0x1ff
    s_cmp_gt_u32 s46, 4
    s_cselect_b32 s32, 1, s32
    s_or_b32 s32, s32, s33
    s_cbranch_scc1 M_dn
M_dnr:
    ds_read_b128 v[92:95], v9 offset:9792
    s_bcnt1_i32_b32 s30, s27
    s_cmp_gt_u32 s30, 3
    s_cselect_b32 s34, 0, s27
    s_cselect_b32 s80, 0, 1
    s_getpc_b64 s[36:37]
M_pc:
    v_bfe_u32 v110, v11, 4, 4
    v_smfmac_f32_16x16x64_bf16 v[164:167], a[112:115], v[220:227], v24 abid:1
    ds_read_b128 v[228:231], v1 offset:22528
    ds_read_b128 v[232:235], v2 offset:22528
    s_waitcnt vmcnt(30)
    v_smfmac_f32_16x16x64_bf16 v[132:135], a[116:119], v[204:211], v25
    buffer_load_dwordx4 a[228:231], v11, s[16:19], s43 offen offset:2048 sc1
    s_ff1_i32_b32 s81, s34
    s_bitset0_b32 s34, s81
    s_mul_i32 s30, s81, 20
    s_add_u32 s31, s30, M_ovc0-M_pc
    s_add_u32 s30, s30, M_ovl0-M_pc
    s_cmp_lg_u32 s34, 0
    s_cselect_b32 s30, s31, s30
    s_cmp_lt_i32 s81, 0
    s_cselect_b32 s30, M_ovn-M_pc, s30
    s_add_u32 s72, s36, s30
    s_addc_u32 s73, s37, 0
    s_ff1_i32_b32 s82, s34
    s_bitset0_b32 s34, s82
    s_mul_i32 s30, s82, 20
    s_add_u32 s31, s30, M_ovc1-M_pc
    s_add_u32 s30, s30, M_ovl1-M_pc
    s_cmp_lg_u32 s34, 0
    s_cselect_b32 s30, s31, s30
    s_cmp_lt_i32 s82, 0
    s_cselect_b32 s30, M_ovn-M_pc, s30
    v_smfmac_f32_16x16x64_bf16 v[168:171], a[116:119], v[220:227], v25
    s_waitcnt vmcnt(30)
    v_smfmac_f32_16x16x64_bf16 v[136:139], a[120:123], v[204:211], v25 abid:1
    buffer_load_dwordx4 a[232:235], v11, s[16:19], s43 offen offset:3072 sc1
    s_add_u32 s74, s36, s30
    s_addc_u32 s75, s37, 0
    s_ff1_i32_b32 s83, s34
    s_bitset0_b32 s34, s83
    s_mul_i32 s30, s83, 20
    s_add_u32 s31, s30, M_ovc1-M_pc
    s_add_u32 s30, s30, M_ovl2-M_pc
    s_cmp_lg_u32 s34, 0
    s_cselect_b32 s30, s31, s30
    s_cmp_lt_i32 s83, 0
    s_cselect_b32 s30, M_ovn-M_pc, s30
    s_add_u32 s76, s36, s30
    s_addc_u32 s77, s37, 0
    s_waitcnt lgkmcnt(2)
    v_lshrrev_b32 v112, 18, v92
    v_smfmac_f32_16x16x64_bf16 v[172:175], a[120:123], v[220:227], v25 abid:1
    s_waitcnt vmcnt(30)
    v_lshrrev_b32 v113, 18, v94
    v_smfmac_f32_16x16x64_bf16 v[140:143], a[124:127], v[204:211], v26
    s_add_u32 s43, s43, 4096
    buffer_load_dwordx4 a[236:239], v11, s[16:19], s43 offen offset:0 sc1
    v_and_b32 v114, 0x3fff, v92
    v_smfmac_f32_16x16x64_bf16 v[176:179], a[124:127], v[220:227], v26
    s_waitcnt vmcnt(30)
    v_and_b32 v115, 0x3fff, v94
    v_smfmac_f32_16x16x64_bf16 v[144:147], a[128:131], v[204:211], v26 abid:1
    buffer_load_dwordx4 a[240:243], v11, s[16:19], s43 offen offset:1024 sc1
    ds_write_b64 v9, v[114:115] offset:10056
    v_lshl_or_b32 v111, s81, 6, v110
    v_smfmac_f32_16x16x64_bf16 v[180:183], a[128:131], v[220:227], v26 abid:1
    v_cmp_eq_u32 s[44:45], v112, v111
    v_cmp_eq_u32 s[36:37], v113, v111
    s_nop 0
    v_cndmask_b32 v54, 0, v93, s[44:45]
    v_cndmask_b32 v55, 0, v95, s[36:37]
    v_lshl_or_b32 v111, s82, 6, v110
    s_waitcnt vmcnt(30)
    v_cmp_eq_u32 s[44:45], v112, v111
    v_smfmac_f32_16x16x64_bf16 v[148:151], a[132:135], v[204:211], v27
    buffer_load_dwordx4 a[244:247], v11, s[16:19], s43 offen offset:2048 sc1
    v_cmp_eq_u32 s[36:37], v113, v111
    v_smfmac_f32_16x16x64_bf16 v[184:187], a[132:135], v[220:227], v27
    v_cndmask_b32 v252, 0, v93, s[44:45]
    v_cndmask_b32 v253, 0, v95, s[36:37]
    v_lshl_or_b32 v111, s83, 6, v110
    v_cmp_eq_u32 s[44:45], v112, v111
    v_cmp_eq_u32 s[36:37], v113, v111
    s_nop 0
    s_waitcnt vmcnt(30)
    v_cndmask_b32 v254, 0, v93, s[44:45]
    v_smfmac_f32_16x16x64_bf16 v[152:155], a[136:139], v[204:211], v27 abid:1
    buffer_load_dwordx4 a[248:251], v11, s[16:19], s43 offen offset:3072 sc1
    v_cndmask_b32 v255, 0, v95, s[36:37]
    v_smfmac_f32_16x16x64_bf16 v[188:191], a[136:139], v[220:227], v27 abid:1
    ds_read_b128 v[236:239], v9 offset:9408
    ds_read_b64 v[216:217], v9 offset:10056
    s_waitcnt vmcnt(30)
    v_smfmac_f32_16x16x64_bf16 v[156:159], a[140:143], v[204:211], v49 abid:1
    s_add_u32 s43, s43, 4096
    buffer_load_dwordx4 v[40:43], v11, s[16:19], s43 offen offset:0 sc1
    buffer_load_dwordx4 a[252:255], v11, s[16:19], s43 offen offset:1024 sc1
    s_waitcnt lgkmcnt(1)
    v_xad_u32 v236, v236, v3, v4
    v_smfmac_f32_16x16x64_bf16 v[192:195], a[140:143], v[220:227], v49 abid:1
    s_waitcnt vmcnt(30)
    v_xad_u32 v237, v237, v3, v4
    v_smfmac_f32_16x16x64_bf16 v[124:127], a[144:147], v[196:203], v28
    buffer_load_dwordx4 v[56:59], v11, s[16:19], s43 offen offset:2048 sc1
    ds_read2st64_b32 v[244:245], v236 offset0:0 offset1:72
    ds_read2st64_b32 v[246:247], v237 offset0:0 offset1:72
    v_xad_u32 v238, v238, v3, v4
    v_smfmac_f32_16x16x64_bf16 v[160:163], a[144:147], v[228:235], v28
    ds_read_b128 v[204:207], v1 offset:5120
    ds_read_b128 v[208:211], v2 offset:5120
    s_waitcnt vmcnt(30)
    v_xad_u32 v239, v239, v3, v4
    v_smfmac_f32_16x16x64_bf16 v[128:131], a[148:151], v[196:203], v28 abid:1
    buffer_load_dwordx4 v[60:63], v11, s[16:19], s43 offen offset:3072 sc1
    ds_read2st64_b32 v[248:249], v238 offset0:0 offset1:72
    ds_read2st64_b32 v[250:251], v239 offset0:0 offset1:72
    ds_read_b128 v[240:243], v8 offset:3072
    ds_read_b128 v[236:239], v9 offset:9280
    s_waitcnt lgkmcnt(8)
    v_xad_u32 v212, v216, v3, v4
    v_smfmac_f32_16x16x64_bf16 v[164:167], a[148:151], v[228:235], v28 abid:1
    ds_read_b128 v[220:223], v1 offset:23552
    ds_read_b128 v[224:227], v2 offset:23552
    ds_read2st64_b32 v[212:213], v212 offset0:0 offset1:72
    s_waitcnt vmcnt(30)
    v_xad_u32 v214, v217, v3, v4
    v_smfmac_f32_16x16x64_bf16 v[132:135], a[152:155], v[196:203], v29
    s_add_u32 s43, s43, 4096
    buffer_load_dwordx4 v[64:67], v11, s[16:19], s43 offen offset:0 sc1
    ds_read2st64_b32 v[214:215], v214 offset0:0 offset1:72
    v_smfmac_f32_16x16x64_bf16 v[168:171], a[152:155], v[228:235], v29
    s_waitcnt vmcnt(30)
    v_smfmac_f32_16x16x64_bf16 v[136:139], a[156:159], v[196:203], v29 abid:1
    buffer_load_dwordx4 v[68:71], v11, s[16:19], s43 offen offset:1024 sc1
    v_smfmac_f32_16x16x64_bf16 v[172:175], a[156:159], v[228:235], v29 abid:1
    s_waitcnt vmcnt(30)
    v_smfmac_f32_16x16x64_bf16 v[140:143], a[160:163], v[196:203], v30
    buffer_load_dwordx4 v[72:75], v11, s[16:19], s43 offen offset:2048 sc1
    s_waitcnt lgkmcnt(5)
    v_smfmac_f32_16x16x64_bf16 v[136:139], v[240:243], v[244:251], v10
    v_smfmac_f32_16x16x64_bf16 v[172:175], v[240:243], v[244:251], v10 abid:1
    s_waitcnt lgkmcnt(4)
    v_xad_u32 v236, v236, v3, v4
    v_smfmac_f32_16x16x64_bf16 v[176:179], a[160:163], v[228:235], v30
    s_waitcnt vmcnt(30)
    v_xad_u32 v237, v237, v3, v4
    v_smfmac_f32_16x16x64_bf16 v[144:147], a[164:167], v[196:203], v30 abid:1
    buffer_load_dwordx4 v[76:79], v11, s[16:19], s43 offen offset:3072 sc1
    ds_read2st64_b32 v[244:245], v236 offset0:0 offset1:72
    ds_read2st64_b32 v[246:247], v237 offset0:0 offset1:72
    v_xad_u32 v238, v238, v3, v4
    v_smfmac_f32_16x16x64_bf16 v[180:183], a[164:167], v[228:235], v30 abid:1
    s_waitcnt vmcnt(30)
    v_xad_u32 v239, v239, v3, v4
    v_smfmac_f32_16x16x64_bf16 v[148:151], a[168:171], v[196:203], v31
    s_add_u32 s43, s43, 4096
    buffer_load_dwordx4 v[80:83], v11, s[16:19], s43 offen offset:0 sc1
    ds_read2st64_b32 v[248:249], v238 offset0:0 offset1:72
    ds_read2st64_b32 v[250:251], v239 offset0:0 offset1:72
    ds_read_b128 v[240:243], v8 offset:1024
    ds_read_b128 v[236:239], v9 offset:9344
    v_smfmac_f32_16x16x64_bf16 v[184:187], a[168:171], v[228:235], v31
    s_waitcnt vmcnt(30)
    v_smfmac_f32_16x16x64_bf16 v[152:155], a[172:175], v[196:203], v31 abid:1
    buffer_load_dwordx4 v[84:87], v11, s[16:19], s43 offen offset:1024 sc1
    s_waitcnt lgkmcnt(6)
    s_cmp_lt_i32 s81, 0
    s_cbranch_scc1 M_ovr0
    s_swappc_b64 s[78:79], s[72:73]
M_ovr0:
    v_smfmac_f32_16x16x64_bf16 v[188:191], a[172:175], v[228:235], v31 abid:1
    s_waitcnt vmcnt(30)
    v_smfmac_f32_16x16x64_bf16 v[156:159], a[176:179], v[196:203], v50
    buffer_load_dwordx4 v[44:47], v11, s[16:19], s43 offen offset:2048 sc1
    buffer_load_dwordx4 v[88:91], v11, s[16:19], s43 offen offset:3072 sc1
    v_smfmac_f32_16x16x64_bf16 v[192:195], a[176:179], v[228:235], v50
    s_waitcnt vmcnt(30)
    v_smfmac_f32_16x16x64_bf16 v[124:127], a[180:183], v[204:211], v32
    s_add_u32 s43, s43, 4096
    buffer_load_dwordx4 v[92:95], v11, s[16:19], s43 offen offset:0 sc1
    s_waitcnt lgkmcnt(1)
    v_smfmac_f32_16x16x64_bf16 v[128:131], v[240:243], v[244:251], v10
    v_smfmac_f32_16x16x64_bf16 v[164:167], v[240:243], v[244:251], v10 abid:1
    s_waitcnt lgkmcnt(0)
    v_xad_u32 v236, v236, v3, v4
    v_smfmac_f32_16x16x64_bf16 v[160:163], a[180:183], v[220:227], v32
    ds_read_b128 v[196:199], v1 offset:6144
    ds_read_b128 v[200:203], v2 offset:6144
    s_waitcnt vmcnt(30)
    v_xad_u32 v237, v237, v3, v4
    v_smfmac_f32_16x16x64_bf16 v[128:131], a[184:187], v[204:211], v32 abid:1
    buffer_load_dwordx4 v[96:99], v11, s[16:19], s43 offen offset:1024 sc1
    ds_read2st64_b32 v[244:245], v236 offset0:0 offset1:72
    ds_read2st64_b32 v[246:247], v237 offset0:0 offset1:72
    v_xad_u32 v238, v238, v3, v4
    v_smfmac_f32_16x16x64_bf16 v[164:167], a[184:187], v[220:227], v32 abid:1
    ds_read_b128 v[228:231], v1 offset:24576
    ds_read_b128 v[232:235], v2 offset:24576
    s_waitcnt vmcnt(30)
    v_xad_u32 v239, v239, v3, v4
    v_smfmac_f32_16x16x64_bf16 v[132:135], a[188:191], v[204:211], v33
    buffer_load_dwordx4 v[100:103], v11, s[16:19], s43 offen offset:2048 sc1
    ds_read2st64_b32 v[248:249], v238 offset0:0 offset1:72
    ds_read2st64_b32 v[250:251], v239 offset0:0 offset1:72
    ds_read_b128 v[240:243], v8 offset:2048
    ds_read_b128 v[236:239], v9 offset:9216
    v_smfmac_f32_16x16x64_bf16 v[168:171], a[188:191], v[220:227], v33
    s_waitcnt vmcnt(30)
    v_smfmac_f32_16x16x64_bf16 v[136:139], a[192:195], v[204:211], v33 abid:1
    buffer_load_dwordx4 v[104:107], v11, s[16:19], s43 offen offset:3072 sc1
    v_smfmac_f32_16x16x64_bf16 v[172:175], a[192:195], v[220:227], v33 abid:1
    s_waitcnt vmcnt(30)
    v_smfmac_f32_16x16x64_bf16 v[140:143], a[196:199], v[204:211], v34
    s_add_u32 s43, s43, 4096
    buffer_load_dwordx4 v[108:111], v11, s[16:19], s43 offen offset:0 sc1
    v_smfmac_f32_16x16x64_bf16 v[176:179], a[196:199], v[220:227], v34
    s_waitcnt vmcnt(30)
    v_smfmac_f32_16x16x64_bf16 v[144:147], a[200:203], v[204:211], v34 abid:1
    buffer_load_dwordx4 v[112:115], v11, s[16:19], s43 offen offset:1024 sc1
    s_waitcnt lgkmcnt(1)
    v_smfmac_f32_16x16x64_bf16 v[132:135], v[240:243], v[244:251], v10
    v_smfmac_f32_16x16x64_bf16 v[168:171], v[240:243], v[244:251], v10 abid:1
    s_waitcnt lgkmcnt(0)
    v_xad_u32 v236, v236, v3, v4
    v_smfmac_f32_16x16x64_bf16 v[180:183], a[200:203], v[220:227], v34 abid:1
    s_waitcnt vmcnt(30)
    v_xad_u32 v237, v237, v3, v4
    v_smfmac_f32_16x16x64_bf16 v[148:151], a[204:207], v[204:211], v35
    buffer_load_dwordx4 v[116:119], v11, s[16:19], s43 offen offset:2048 sc1
    ds_read2st64_b32 v[244:245], v236 offset0:0 offset1:72
    ds_read2st64_b32 v[246:247], v237 offset0:0 offset1:72
    v_xad_u32 v238, v238, v3, v4
    v_smfmac_f32_16x16x64_bf16 v[184:187], a[204:207], v[220:227], v35
    s_waitcnt vmcnt(30)
    v_xad_u32 v239, v239, v3, v4
    v_smfmac_f32_16x16x64_bf16 v[152:155], a[208:211], v[204:211], v35 abid:1
    buffer_load_dwordx4 v[120:123], v11, s[16:19], s43 offen offset:3072 sc1
    ds_read2st64_b32 v[248:249], v238 offset0:0 offset1:72
    ds_read2st64_b32 v[250:251], v239 offset0:0 offset1:72
    ds_read_b128 v[240:243], v8 offset:0
    ds_read_b128 v[236:239], v9 offset:9728
    v_smfmac_f32_16x16x64_bf16 v[188:191], a[208:211], v[220:227], v35 abid:1
    s_waitcnt vmcnt(30)
    v_smfmac_f32_16x16x64_bf16 v[156:159], a[212:215], v[204:211], v50 abid:1
    s_add_u32 m0, s29, 11840
    s_nop 0
    buffer_load_dword v0, s[8:11], 0 offen lds
    v_smfmac_f32_16x16x64_bf16 v[192:195], a[212:215], v[220:227], v50 abid:1
    s_waitcnt vmcnt(29)
    v_smfmac_f32_16x16x64_bf16 v[124:127], a[216:219], v[196:203], v36
    v_smfmac_f32_16x16x64_bf16 v[160:163], a[216:219], v[228:235], v36
    ds_read_b128 v[204:207], v1 offset:7168
    ds_read_b128 v[208:211], v2 offset:7168
    s_waitcnt vmcnt(28)
    v_smfmac_f32_16x16x64_bf16 v[128:131], a[220:223], v[196:203], v36 abid:1
    s_waitcnt lgkmcnt(3)
    v_smfmac_f32_16x16x64_bf16 v[124:127], v[240:243], v[244:251], v10
    v_smfmac_f32_16x16x64_bf16 v[160:163], v[240:243], v[244:251], v10 abid:1
    s_waitcnt lgkmcnt(2)
    v_xad_u32 v236, v236, v3, v4
    v_smfmac_f32_16x16x64_bf16 v[164:167], a[220:223], v[228:235], v36 abid:1
    ds_read_b128 v[220:223], v1 offset:25600
    ds_read_b128 v[224:227], v2 offset:25600
    s_waitcnt vmcnt(27)
    v_xad_u32 v237, v237, v3, v4
    v_smfmac_f32_16x16x64_bf16 v[132:135], a[224:227], v[196:203], v37
    ds_read2st64_b32 v[244:245], v236 offset0:0 offset1:72
    ds_read2st64_b32 v[246:247], v237 offset0:0 offset1:72
    v_xad_u32 v238, v238, v3, v4
    v_smfmac_f32_16x16x64_bf16 v[168:171], a[224:227], v[228:235], v37
    s_waitcnt vmcnt(26)
    v_xad_u32 v239, v239, v3, v4
    v_smfmac_f32_16x16x64_bf16 v[136:139], a[228:231], v[196:203], v37 abid:1
    ds_read2st64_b32 v[248:249], v238 offset0:0 offset1:72
    ds_read2st64_b32 v[250:251], v239 offset0:0 offset1:72
    ds_read_b128 v[240:243], v8 offset:8192
    ds_read_b128 v[236:239], v9 offset:9664
    v_smfmac_f32_16x16x64_bf16 v[172:175], a[228:231], v[228:235], v37 abid:1
    s_waitcnt vmcnt(25)
    v_smfmac_f32_16x16x64_bf16 v[140:143], a[232:235], v[196:203], v38
    v_smfmac_f32_16x16x64_bf16 v[176:179], a[232:235], v[228:235], v38
    s_waitcnt vmcnt(24)
    v_smfmac_f32_16x16x64_bf16 v[144:147], a[236:239], v[196:203], v38 abid:1
    v_smfmac_f32_16x16x64_bf16 v[180:183], a[236:239], v[228:235], v38 abid:1
    s_waitcnt vmcnt(23)
    v_smfmac_f32_16x16x64_bf16 v[148:151], a[240:243], v[196:203], v39
    s_mov_b32 m0, s42
    s_nop 0
    buffer_load_dwordx4 v5, s[8:11], s22 offen offset:0 nt lds
    s_waitcnt lgkmcnt(1)
    v_smfmac_f32_16x16x64_bf16 v[156:159], v[240:243], v[244:251], v10
    v_smfmac_f32_16x16x64_bf16 v[192:195], v[240:243], v[244:251], v10 abid:1
    s_waitcnt lgkmcnt(0)
    v_xad_u32 v236, v236, v3, v4
    v_smfmac_f32_16x16x64_bf16 v[184:187], a[240:243], v[228:235], v39
    s_waitcnt vmcnt(23)
    v_xad_u32 v237, v237, v3, v4
    v_smfmac_f32_16x16x64_bf16 v[152:155], a[244:247], v[196:203], v39 abid:1
    ds_read2st64_b32 v[244:245], v236 offset0:0 offset1:72
    ds_read2st64_b32 v[246:247], v237 offset0:0 offset1:72
    v_xad_u32 v238, v238, v3, v4
    v_smfmac_f32_16x16x64_bf16 v[188:191], a[244:247], v[228:235], v39 abid:1
    s_waitcnt vmcnt(22)
    v_xad_u32 v239, v239, v3, v4
    v_smfmac_f32_16x16x64_bf16 v[156:159], a[248:251], v[196:203], v51
    s_add_u32 m0, m0, 896
    s_nop 0
    buffer_load_dwordx4 v5, s[8:11], s22 offen offset:128 nt lds
    ds_read2st64_b32 v[248:249], v238 offset0:0 offset1:72
    ds_read2st64_b32 v[250:251], v239 offset0:0 offset1:72
    ds_read_b128 v[240:243], v8 offset:7168
    ds_read_b128 v[236:239], v9 offset:9536
    v_smfmac_f32_16x16x64_bf16 v[192:195], a[248:251], v[228:235], v51
    s_waitcnt vmcnt(21)
    v_smfmac_f32_16x16x64_bf16 v[124:127], a[252:255], v[204:211], v40
    ds_read_b128 v[196:199], v1 offset:8192
    ds_read_b128 v[200:203], v2 offset:8192
    s_waitcnt vmcnt(20)
    v_smfmac_f32_16x16x64_bf16 v[128:131], v[56:59], v[204:211], v40 abid:1
    s_add_u32 m0, m0, 896
    s_nop 0
    buffer_load_dwordx4 v5, s[8:11], s22 offen offset:256 nt lds
    ds_read_b128 v[228:231], v1 offset:26624
    ds_read_b128 v[232:235], v2 offset:26624
    s_waitcnt vmcnt(20)
    v_smfmac_f32_16x16x64_bf16 v[132:135], v[60:63], v[204:211], v41
    s_waitcnt lgkmcnt(5)
    v_smfmac_f32_16x16x64_bf16 v[152:155], v[240:243], v[244:251], v10
    v_smfmac_f32_16x16x64_bf16 v[188:191], v[240:243], v[244:251], v10 abid:1
    s_waitcnt lgkmcnt(4)
    v_xad_u32 v236, v236, v3, v4
    s_waitcnt vmcnt(19)
    v_xad_u32 v237, v237, v3, v4
    v_smfmac_f32_16x16x64_bf16 v[136:139], v[64:67], v[204:211], v41 abid:1
    s_add_u32 m0, m0, 896
    s_nop 0
    buffer_load_dwordx4 v5, s[8:11], s22 offen offset:384 nt lds
    ds_read2st64_b32 v[244:245], v236 offset0:0 offset1:72
    ds_read2st64_b32 v[246:247], v237 offset0:0 offset1:72
    v_xad_u32 v238, v238, v3, v4
    s_waitcnt vmcnt(19)
    v_xad_u32 v239, v239, v3, v4
    v_smfmac_f32_16x16x64_bf16 v[140:143], v[68:71], v[204:211], v42
    ds_read2st64_b32 v[248:249], v238 offset0:0 offset1:72
    ds_read2st64_b32 v[250:251], v239 offset0:0 offset1:72
    ds_read_b128 v[240:243], v8 offset:5120
    ds_read_b128 v[236:239], v9 offset:9600
    s_waitcnt vmcnt(18)
    v_smfmac_f32_16x16x64_bf16 v[144:147], v[72:75], v[204:211], v42 abid:1
    s_waitcnt vmcnt(17)
    v_smfmac_f32_16x16x64_bf16 v[148:151], v[76:79], v[204:211], v43
    s_waitcnt vmcnt(16)
    v_smfmac_f32_16x16x64_bf16 v[152:155], v[80:83], v[204:211], v43 abid:1
    s_waitcnt lgkmcnt(1)
    v_smfmac_f32_16x16x64_bf16 v[144:147], v[240:243], v[244:251], v10
    v_smfmac_f32_16x16x64_bf16 v[180:183], v[240:243], v[244:251], v10 abid:1
    s_waitcnt lgkmcnt(0)
    v_xad_u32 v236, v236, v3, v4
    s_waitcnt vmcnt(15)
    v_xad_u32 v237, v237, v3, v4
    v_smfmac_f32_16x16x64_bf16 v[156:159], v[84:87], v[204:211], v51 abid:1
    ds_read2st64_b32 v[244:245], v236 offset0:0 offset1:72
    ds_read2st64_b32 v[246:247], v237 offset0:0 offset1:72
    v_xad_u32 v238, v238, v3, v4
    s_waitcnt vmcnt(13)
    v_xad_u32 v239, v239, v3, v4
    v_smfmac_f32_16x16x64_bf16 v[124:127], v[88:91], v[196:203], v44
    ds_read2st64_b32 v[248:249], v238 offset0:0 offset1:72
    ds_read2st64_b32 v[250:251], v239 offset0:0 offset1:72
    ds_read_b128 v[240:243], v8 offset:6144
    ds_read_b128 v[236:239], v9 offset:9472
    s_waitcnt vmcnt(12)
    v_smfmac_f32_16x16x64_bf16 v[128:131], v[92:95], v[196:203], v44 abid:1
    s_waitcnt vmcnt(11)
    v_smfmac_f32_16x16x64_bf16 v[132:135], v[96:99], v[196:203], v45
    s_waitcnt vmcnt(10)
    v_smfmac_f32_16x16x64_bf16 v[136:139], v[100:103], v[196:203], v45 abid:1
    s_waitcnt lgkmcnt(1)
    v_smfmac_f32_16x16x64_bf16 v[148:151], v[240:243], v[244:251], v10
    v_smfmac_f32_16x16x64_bf16 v[184:187], v[240:243], v[244:251], v10 abid:1
    s_waitcnt lgkmcnt(0)
    v_xad_u32 v236, v236, v3, v4
    s_waitcnt vmcnt(9)
    v_xad_u32 v237, v237, v3, v4
    v_smfmac_f32_16x16x64_bf16 v[140:143], v[104:107], v[196:203], v46
    ds_read2st64_b32 v[244:245], v236 offset0:0 offset1:72
    ds_read2st64_b32 v[246:247], v237 offset0:0 offset1:72
    v_xad_u32 v238, v238, v3, v4
    s_waitcnt vmcnt(8)
    v_xad_u32 v239, v239, v3, v4
    v_smfmac_f32_16x16x64_bf16 v[144:147], v[108:111], v[196:203], v46 abid:1
    ds_read2st64_b32 v[248:249], v238 offset0:0 offset1:72
    ds_read2st64_b32 v[250:251], v239 offset0:0 offset1:72
    ds_read_b128 v[240:243], v8 offset:4096
    s_waitcnt vmcnt(7)
    v_smfmac_f32_16x16x64_bf16 v[148:151], v[112:115], v[196:203], v47
    s_waitcnt vmcnt(6)
    v_smfmac_f32_16x16x64_bf16 v[152:155], v[116:119], v[196:203], v47 abid:1
    s_waitcnt vmcnt(5)
    v_smfmac_f32_16x16x64_bf16 v[156:159], v[120:123], v[196:203], v52
    s_waitcnt lgkmcnt(0)
    v_smfmac_f32_16x16x64_bf16 v[140:143], v[240:243], v[244:251], v10
    v_smfmac_f32_16x16x64_bf16 v[176:179], v[240:243], v[244:251], v10 abid:1
    s_cmp_gt_u32 s46, s80
    s_cbranch_scc1 M_slow
M_slowr0:
    s_cmp_eq_u32 s20, 0
    s_mov_b32 s31, 1073903880
    s_cselect_b32 s30, 162048, s31
    v_mov_b32 v11, s31
    v_writelane_b32 v11, s30, 0
    v_cvt_pk_bf16_f32 v124, v124, v125
    v_cvt_pk_bf16_f32 v125, v126, v127
    v_cvt_pk_bf16_f32 v126, v128, v129
    v_cvt_pk_bf16_f32 v127, v130, v131
    v_cvt_pk_bf16_f32 v132, v132, v133
    v_cvt_pk_bf16_f32 v133, v134, v135
    v_cvt_pk_bf16_f32 v134, v136, v137
    v_cvt_pk_bf16_f32 v135, v138, v139
    ds_read_b128 v[136:139], v9 offset:10432
    v_cndmask_b32_dpp v128, v124, v132, vcc row_ror:8 row_mask:0xf bank_mask:0xf
    v_cndmask_b32_dpp v129, v125, v133, vcc row_ror:8 row_mask:0xf bank_mask:0xf
    v_cndmask_b32_dpp v130, v126, v134, vcc row_ror:8 row_mask:0xf bank_mask:0xf
    v_cndmask_b32_dpp v131, v127, v135, vcc row_ror:8 row_mask:0xf bank_mask:0xf
    buffer_store_dwordx4 v[128:131], v6, s[12:15], s59 offen offset:0 sc1
    v_mov_b32_dpp v124, v132 row_ror:8 row_mask:0xf bank_mask:0xc
    v_mov_b32_dpp v125, v133 row_ror:8 row_mask:0xf bank_mask:0xc
    v_mov_b32_dpp v126, v134 row_ror:8 row_mask:0xf bank_mask:0xc
    v_mov_b32_dpp v127, v135 row_ror:8 row_mask:0xf bank_mask:0xc
    buffer_store_dwordx4 v[124:127], v6, s[12:15], s24 offen offset:0 sc1
    ds_read_b128 v[128:131], v9 offset:10304
    ds_read_b128 v[132:135], v9 offset:10368
    ds_read_b128 v[124:127], v9 offset:10240
    v_cvt_pk_bf16_f32 v140, v140, v141
    v_cvt_pk_bf16_f32 v141, v142, v143
    v_cvt_pk_bf16_f32 v142, v144, v145
    v_cvt_pk_bf16_f32 v143, v146, v147
    v_cvt_pk_bf16_f32 v148, v148, v149
    v_cvt_pk_bf16_f32 v149, v150, v151
    v_cvt_pk_bf16_f32 v150, v152, v153
    v_cvt_pk_bf16_f32 v151, v154, v155
    ds_read_b128 v[152:155], v9 offset:10688
    v_cndmask_b32_dpp v144, v140, v148, vcc row_ror:8 row_mask:0xf bank_mask:0xf
    v_cndmask_b32_dpp v145, v141, v149, vcc row_ror:8 row_mask:0xf bank_mask:0xf
    v_cndmask_b32_dpp v146, v142, v150, vcc row_ror:8 row_mask:0xf bank_mask:0xf
    v_cndmask_b32_dpp v147, v143, v151, vcc row_ror:8 row_mask:0xf bank_mask:0xf
    buffer_store_dwordx4 v[144:147], v6, s[12:15], s59 offen offset:128 sc1
    v_mov_b32_dpp v140, v148 row_ror:8 row_mask:0xf bank_mask:0xc
    v_mov_b32_dpp v141, v149 row_ror:8 row_mask:0xf bank_mask:0xc
    v_mov_b32_dpp v142, v150 row_ror:8 row_mask:0xf bank_mask:0xc
    v_mov_b32_dpp v143, v151 row_ror:8 row_mask:0xf bank_mask:0xc
    buffer_store_dwordx4 v[140:143], v6, s[12:15], s24 offen offset:128 sc1
    ds_read_b128 v[144:147], v9 offset:10560
    ds_read_b128 v[148:151], v9 offset:10624
    ds_read_b128 v[140:143], v9 offset:10496
    v_cvt_pk_bf16_f32 v156, v156, v157
    v_cvt_pk_bf16_f32 v157, v158, v159
    ds_write_b64 v53, v[156:157] offset:25728
    ds_read_b128 v[156:159], v9 offset:10752
    s_mov_b32 s89, 0
    s_mov_b32 s101, 34209792
    s_mov_b32 s91, 0
    s_mov_b32 s25, 36864
    s_add_u32 s90, s24, 9437184
    s_mov_b32 s28, s26
    s_add_u32 s23, s24, 18432
    s_cmp_lt_u32 s20, 2
    s_cselect_b32 s66, s23, s24
    s_cselect_b32 s99, s14, 75497472
    s_add_u32 s66, s66, s95
    v_add_u32 v4, 36864, v4
    v_add_u32 v1, 36864, v1
    v_add_u32 v2, 36864, v2
M_top:
M_top1:
    s_add_u32 s23, s24, 18432
    s_add_u32 s58, s24, 27648
    s_mov_b32 s24, s90
    s_add_u32 s59, s90, 9216
    s_waitcnt lgkmcnt(0)
    s_barrier
    ds_read_b128 v[244:247], v8 offset:10816
    v_smfmac_f32_16x16x64_bf16 v[160:163], a[252:255], v[220:227], v40
    ds_read_b128 v[196:199], v1 offset:0
    v_smfmac_f32_16x16x64_bf16 v[160:163], v[88:91], v[228:235], v44
    ds_read_b128 v[200:203], v2 offset:0
    s_cmp_lt_u32 s22, 75497472
    s_cbranch_scc0 M_bF
    s_cmp_eq_u32 s91, 1
    s_cbranch_scc1 M_bE0
M_bL:
    v_smfmac_f32_16x16x64_bf16 v[164:167], v[56:59], v[220:227], v40 abid:1
    ds_read_b128 v[204:207], v1 offset:1024
    v_smfmac_f32_16x16x64_bf16 v[164:167], v[92:95], v[228:235], v44 abid:1
    ds_read_b128 v[208:211], v2 offset:1024
    v_mov_b32 v0, 1
    v_smfmac_f32_16x16x64_bf16 v[168:171], v[60:63], v[220:227], v41
    ds_read_b128 v[212:215], v1 offset:2048
    v_smfmac_f32_16x16x64_bf16 v[168:171], v[96:99], v[228:235], v45
    ds_read_b128 v[216:219], v2 offset:2048
    v_smfmac_f32_16x16x64_bf16 v[172:175], v[64:67], v[220:227], v41 abid:1
    s_waitcnt vmcnt(6)
    s_waitcnt lgkmcnt(6)
    buffer_store_dwordx4 v[244:247], v7, s[12:15], s66 offen sc1
    v_smfmac_f32_16x16x64_bf16 v[172:175], v[100:103], v[228:235], v45 abid:1
    ds_read_b128 v[236:239], v9 offset:9408
    v_smfmac_f32_16x16x64_bf16 v[176:179], v[68:71], v[220:227], v42
    s_waitcnt vmcnt(6)
    buffer_atomic_add v0, v11, s[16:19], s92 offen sc0 sc1
    s_mov_b32 s21, 1
    v_smfmac_f32_16x16x64_bf16 v[176:179], v[104:107], v[228:235], v46
    v_smfmac_f32_16x16x64_bf16 v[180:183], v[72:75], v[220:227], v42 abid:1
    v_cvt_pk_bf16_f32 v160, v160, v161
    v_smfmac_f32_16x16x64_bf16 v[180:183], v[108:111], v[228:235], v46 abid:1
    v_cvt_pk_bf16_f32 v161, v162, v163
    v_smfmac_f32_16x16x64_bf16 v[184:187], v[76:79], v[220:227], v43
    v_cvt_pk_bf16_f32 v162, v164, v165
    v_smfmac_f32_16x16x64_bf16 v[184:187], v[112:115], v[228:235], v47
    v_cvt_pk_bf16_f32 v163, v166, v167
    v_smfmac_f32_16x16x64_bf16 v[188:191], v[80:83], v[220:227], v43 abid:1
    s_add_u32 m0, m0, 896
    v_cvt_pk_bf16_f32 v168, v168, v169
    v_smfmac_f32_16x16x64_bf16 v[188:191], v[116:119], v[228:235], v47 abid:1
    s_waitcnt vmcnt(6)
    buffer_load_dwordx4 v5, s[8:11], s22 offen offset:512 nt lds
    v_cvt_pk_bf16_f32 v169, v170, v171
    v_smfmac_f32_16x16x64_bf16 v[192:195], v[84:87], v[220:227], v51 abid:1
    v_cvt_pk_bf16_f32 v170, v172, v173
    v_smfmac_f32_16x16x64_bf16 v[192:195], v[120:123], v[228:235], v52
    ds_read_b128 v[220:223], v1 offset:3072
    s_waitcnt lgkmcnt(6)
    v_cvt_pk_bf16_f32 v171, v174, v175
    v_smfmac_f32_16x16x64_bf16 v[124:127], a[0:3], v[196:203], v12
    ds_read_b128 v[224:227], v2 offset:3072
    ds_read_b128 v[172:175], v9 offset:10432
    s_waitcnt lgkmcnt(6)
    v_cndmask_b32_dpp v164, v160, v168, vcc row_ror:8 row_mask:0xf bank_mask:0xf
    v_smfmac_f32_16x16x64_bf16 v[124:127], a[36:39], v[204:211], v16
    ds_read_b128 v[228:231], v1 offset:4096
    s_waitcnt lgkmcnt(5)
    v_cndmask_b32_dpp v165, v161, v169, vcc row_ror:8 row_mask:0xf bank_mask:0xf
    v_smfmac_f32_16x16x64_bf16 v[124:127], a[72:75], v[212:219], v20
    ds_read_b128 v[232:235], v2 offset:4096
    v_cndmask_b32_dpp v166, v162, v170, vcc row_ror:8 row_mask:0xf bank_mask:0xf
    v_smfmac_f32_16x16x64_bf16 v[128:131], a[4:7], v[196:203], v12 abid:1
    s_barrier
    v_cndmask_b32_dpp v167, v163, v171, vcc row_ror:8 row_mask:0xf bank_mask:0xf
    v_smfmac_f32_16x16x64_bf16 v[128:131], a[40:43], v[204:211], v16 abid:1
    s_waitcnt vmcnt(6)
    buffer_store_dwordx4 v[164:167], v6, s[12:15], s58 offen offset:0 sc1
    s_waitcnt lgkmcnt(5)
    v_xad_u32 v236, v236, v3, v4
    v_smfmac_f32_16x16x64_bf16 v[128:131], a[76:79], v[212:219], v20 abid:1
    v_xad_u32 v237, v237, v3, v4
    v_smfmac_f32_16x16x64_bf16 v[132:135], a[8:11], v[196:203], v13
    ds_read2st64_b32 v[244:245], v236 offset0:0 offset1:72
    ds_read_b128 v[240:243], v8 offset:3072
    v_xad_u32 v238, v238, v3, v4
    v_smfmac_f32_16x16x64_bf16 v[132:135], a[44:47], v[204:211], v17
    ds_read2st64_b32 v[246:247], v237 offset0:0 offset1:72
    v_xad_u32 v239, v239, v3, v4
    v_smfmac_f32_16x16x64_bf16 v[132:135], a[80:83], v[212:219], v21
    ds_read2st64_b32 v[248:249], v238 offset0:0 offset1:72
    v_mov_b32_dpp v160, v168 row_ror:8 row_mask:0xf bank_mask:0xc
    v_smfmac_f32_16x16x64_bf16 v[144:147], a[20:23], v[196:203], v14 abid:1
    ds_read2st64_b32 v[250:251], v239 offset0:0 offset1:72
    ds_read_b128 v[236:239], v9 offset:9280
    v_mov_b32_dpp v161, v169 row_ror:8 row_mask:0xf bank_mask:0xc
    v_smfmac_f32_16x16x64_bf16 v[144:147], a[56:59], v[204:211], v18 abid:1
    v_mov_b32_dpp v162, v170 row_ror:8 row_mask:0xf bank_mask:0xc
    v_smfmac_f32_16x16x64_bf16 v[144:147], a[92:95], v[212:219], v22 abid:1
    v_mov_b32_dpp v163, v171 row_ror:8 row_mask:0xf bank_mask:0xc
    v_smfmac_f32_16x16x64_bf16 v[140:143], a[16:19], v[196:203], v14
    s_waitcnt vmcnt(6)
    buffer_store_dwordx4 v[160:163], v6, s[12:15], s23 offen offset:0 sc1
    ds_read_b128 v[164:167], v9 offset:10304
    v_smfmac_f32_16x16x64_bf16 v[140:143], a[52:55], v[204:211], v18
    ds_read_b128 v[168:171], v9 offset:10368
    ds_read_b128 v[160:163], v9 offset:10240
    v_smfmac_f32_16x16x64_bf16 v[140:143], a[88:91], v[212:219], v22
    v_smfmac_f32_16x16x64_bf16 v[136:139], a[12:15], v[196:203], v13 abid:1
    v_smfmac_f32_16x16x64_bf16 v[136:139], a[48:51], v[204:211], v17 abid:1
    v_smfmac_f32_16x16x64_bf16 v[136:139], a[84:87], v[212:219], v21 abid:1
    s_waitcnt lgkmcnt(3)
    v_xad_u32 v236, v236, v3, v4
    v_smfmac_f32_16x16x64_bf16 v[136:139], v[240:243], v[244:251], v10
    v_xad_u32 v237, v237, v3, v4
    v_smfmac_f32_16x16x64_bf16 v[172:175], v[240:243], v[244:251], v10 abid:1
    ds_read2st64_b32 v[244:245], v236 offset0:0 offset1:72
    ds_read_b128 v[240:243], v8 offset:1024
    v_xad_u32 v238, v238, v3, v4
    v_smfmac_f32_16x16x64_bf16 v[148:151], a[24:27], v[196:203], v15
    ds_read2st64_b32 v[246:247], v237 offset0:0 offset1:72
    v_xad_u32 v239, v239, v3, v4
    v_smfmac_f32_16x16x64_bf16 v[148:151], a[60:63], v[204:211], v19
    ds_read2st64_b32 v[248:249], v238 offset0:0 offset1:72
    v_cvt_pk_bf16_f32 v192, v192, v193
    v_smfmac_f32_16x16x64_bf16 v[148:151], a[96:99], v[212:219], v23
    ds_read2st64_b32 v[250:251], v239 offset0:0 offset1:72
    ds_read_b128 v[236:239], v9 offset:9344
    v_cvt_pk_bf16_f32 v193, v194, v195
    v_smfmac_f32_16x16x64_bf16 v[152:155], a[28:31], v[196:203], v15 abid:1
    ds_write_b64 v53, v[192:193] offset:0
    ds_read_b128 v[192:195], v9 offset:10752
    v_smfmac_f32_16x16x64_bf16 v[152:155], a[64:67], v[204:211], v19 abid:1
    s_add_u32 m0, m0, 896
    v_smfmac_f32_16x16x64_bf16 v[152:155], a[100:103], v[212:219], v23 abid:1
    s_waitcnt vmcnt(6)
    buffer_load_dwordx4 v5, s[8:11], s22 offen offset:640 nt lds
    v_smfmac_f32_16x16x64_bf16 v[156:159], a[32:35], v[196:203], v48
    v_smfmac_f32_16x16x64_bf16 v[156:159], a[68:71], v[204:211], v48 abid:1
    v_smfmac_f32_16x16x64_bf16 v[156:159], a[104:107], v[212:219], v49
    ds_read_b128 v[196:199], v1 offset:5120
    v_cvt_pk_bf16_f32 v176, v176, v177
    v_smfmac_f32_16x16x64_bf16 v[124:127], a[108:111], v[220:227], v24
    ds_read_b128 v[200:203], v2 offset:5120
    v_cvt_pk_bf16_f32 v177, v178, v179
    v_smfmac_f32_16x16x64_bf16 v[124:127], a[144:147], v[228:235], v28
    ds_read_b128 v[204:207], v1 offset:6144
    ds_read_b64 v[216:217], v9 offset:10056
    v_cvt_pk_bf16_f32 v178, v180, v181
    v_smfmac_f32_16x16x64_bf16 v[128:131], a[112:115], v[220:227], v24 abid:1
    ds_read_b128 v[208:211], v2 offset:6144
    v_cvt_pk_bf16_f32 v179, v182, v183
    v_smfmac_f32_16x16x64_bf16 v[128:131], a[148:151], v[228:235], v28 abid:1
    s_waitcnt lgkmcnt(7)
    v_xad_u32 v236, v236, v3, v4
    v_smfmac_f32_16x16x64_bf16 v[128:131], v[240:243], v[244:251], v10
    s_add_u32 m0, m0, 896
    v_xad_u32 v237, v237, v3, v4
    v_smfmac_f32_16x16x64_bf16 v[164:167], v[240:243], v[244:251], v10 abid:1
    ds_read2st64_b32 v[244:245], v236 offset0:0 offset1:72
    ds_read_b128 v[240:243], v8 offset:2048
    v_xad_u32 v238, v238, v3, v4
    v_smfmac_f32_16x16x64_bf16 v[152:155], a[136:139], v[220:227], v27 abid:1
    ds_read2st64_b32 v[246:247], v237 offset0:0 offset1:72
    s_waitcnt vmcnt(6)
    v_xad_u32 v239, v239, v3, v4
    v_smfmac_f32_16x16x64_bf16 v[152:155], a[172:175], v[228:235], v31 abid:1
    ds_read2st64_b32 v[248:249], v238 offset0:0 offset1:72
    buffer_load_dwordx4 v5, s[8:11], s22 offen offset:768 nt lds
    v_cvt_pk_bf16_f32 v184, v184, v185
    v_smfmac_f32_16x16x64_bf16 v[136:139], a[120:123], v[220:227], v25 abid:1
    ds_read2st64_b32 v[250:251], v239 offset0:0 offset1:72
    ds_read_b128 v[236:239], v9 offset:9216
    v_cvt_pk_bf16_f32 v185, v186, v187
    v_smfmac_f32_16x16x64_bf16 v[136:139], a[156:159], v[228:235], v29 abid:1
    v_cvt_pk_bf16_f32 v186, v188, v189
    v_smfmac_f32_16x16x64_bf16 v[140:143], a[124:127], v[220:227], v26
    v_cvt_pk_bf16_f32 v187, v190, v191
    v_smfmac_f32_16x16x64_bf16 v[140:143], a[160:163], v[228:235], v30
    ds_read_b128 v[188:191], v9 offset:10688
    v_cndmask_b32_dpp v180, v176, v184, vcc row_ror:8 row_mask:0xf bank_mask:0xf
    v_smfmac_f32_16x16x64_bf16 v[144:147], a[128:131], v[220:227], v26 abid:1
    v_cndmask_b32_dpp v181, v177, v185, vcc row_ror:8 row_mask:0xf bank_mask:0xf
    v_smfmac_f32_16x16x64_bf16 v[144:147], a[164:167], v[228:235], v30 abid:1
    v_cndmask_b32_dpp v182, v178, v186, vcc row_ror:8 row_mask:0xf bank_mask:0xf
    v_smfmac_f32_16x16x64_bf16 v[148:151], a[132:135], v[220:227], v27
    v_cndmask_b32_dpp v183, v179, v187, vcc row_ror:8 row_mask:0xf bank_mask:0xf
    v_smfmac_f32_16x16x64_bf16 v[148:151], a[168:171], v[228:235], v31
    s_waitcnt vmcnt(6)
    buffer_store_dwordx4 v[180:183], v6, s[12:15], s58 offen offset:128 sc1
    s_waitcnt lgkmcnt(8)
    v_xad_u32 v212, v216, v3, v4
    v_smfmac_f32_16x16x64_bf16 v[132:135], a[116:119], v[220:227], v25
    ds_read2st64_b32 v[212:213], v212 offset0:0 offset1:72
    v_xad_u32 v214, v217, v3, v4
    v_smfmac_f32_16x16x64_bf16 v[132:135], a[152:155], v[228:235], v29
    ds_read2st64_b32 v[214:215], v214 offset0:0 offset1:72
    s_waitcnt lgkmcnt(3)
    v_xad_u32 v236, v236, v3, v4
    v_smfmac_f32_16x16x64_bf16 v[132:135], v[240:243], v[244:251], v10
    v_xad_u32 v237, v237, v3, v4
    v_smfmac_f32_16x16x64_bf16 v[168:171], v[240:243], v[244:251], v10 abid:1
    ds_read2st64_b32 v[244:245], v236 offset0:0 offset1:72
    ds_read_b128 v[240:243], v8 offset:0
    v_xad_u32 v238, v238, v3, v4
    v_smfmac_f32_16x16x64_bf16 v[156:159], a[140:143], v[220:227], v49 abid:1
    ds_read2st64_b32 v[246:247], v237 offset0:0 offset1:72
    v_xad_u32 v239, v239, v3, v4
    v_smfmac_f32_16x16x64_bf16 v[156:159], a[176:179], v[228:235], v50
    ds_read2st64_b32 v[248:249], v238 offset0:0 offset1:72
    v_mov_b32_dpp v176, v184 row_ror:8 row_mask:0xf bank_mask:0xc
    v_smfmac_f32_16x16x64_bf16 v[140:143], a[196:199], v[196:203], v34
    ds_read2st64_b32 v[250:251], v239 offset0:0 offset1:72
    ds_read_b128 v[236:239], v9 offset:9728
    v_mov_b32_dpp v177, v185 row_ror:8 row_mask:0xf bank_mask:0xc
    v_smfmac_f32_16x16x64_bf16 v[140:143], a[232:235], v[204:211], v38
    v_mov_b32_dpp v178, v186 row_ror:8 row_mask:0xf bank_mask:0xc
    v_smfmac_f32_16x16x64_bf16 v[128:131], a[184:187], v[196:203], v32 abid:1
    v_mov_b32_dpp v179, v187 row_ror:8 row_mask:0xf bank_mask:0xc
    v_smfmac_f32_16x16x64_bf16 v[128:131], a[220:223], v[204:211], v36 abid:1
    s_waitcnt vmcnt(6)
    buffer_store_dwordx4 v[176:179], v6, s[12:15], s23 offen offset:128 sc1
    ds_read_b128 v[180:183], v9 offset:10560
    v_smfmac_f32_16x16x64_bf16 v[132:135], a[188:191], v[196:203], v33
    ds_read_b128 v[184:187], v9 offset:10624
    ds_read_b128 v[176:179], v9 offset:10496
    v_smfmac_f32_16x16x64_bf16 v[132:135], a[224:227], v[204:211], v37
    v_smfmac_f32_16x16x64_bf16 v[136:139], a[192:195], v[196:203], v33 abid:1
    ds_read_b128 v[220:223], v1 offset:7168
    v_smfmac_f32_16x16x64_bf16 v[136:139], a[228:231], v[204:211], v37 abid:1
    ds_read_b128 v[224:227], v2 offset:7168
    v_smfmac_f32_16x16x64_bf16 v[124:127], a[180:183], v[196:203], v32
    ds_read_b128 v[228:231], v1 offset:8192
    v_smfmac_f32_16x16x64_bf16 v[124:127], a[216:219], v[204:211], v36
    s_waitcnt vmcnt(7)
    s_waitcnt lgkmcnt(6)
    v_xad_u32 v236, v236, v3, v4
    v_smfmac_f32_16x16x64_bf16 v[124:127], v[240:243], v[244:251], v10
    ds_read_b128 v[232:235], v2 offset:8192
    v_xad_u32 v237, v237, v3, v4
    v_smfmac_f32_16x16x64_bf16 v[160:163], v[240:243], v[244:251], v10 abid:1
    ds_read2st64_b32 v[244:245], v236 offset0:0 offset1:72
    ds_read_b128 v[240:243], v8 offset:8192
    v_xad_u32 v238, v238, v3, v4
    v_smfmac_f32_16x16x64_bf16 v[144:147], a[200:203], v[196:203], v34 abid:1
    ds_read2st64_b32 v[246:247], v237 offset0:0 offset1:72
    v_xad_u32 v239, v239, v3, v4
    v_smfmac_f32_16x16x64_bf16 v[144:147], a[236:239], v[204:211], v38 abid:1
    ds_read2st64_b32 v[248:249], v238 offset0:0 offset1:72
    v_mul_u32_u24 v0, s94, v0
    v_smfmac_f32_16x16x64_bf16 v[148:151], a[204:207], v[196:203], v35
    ds_read2st64_b32 v[250:251], v239 offset0:0 offset1:72
    ds_read_b128 v[236:239], v9 offset:9664
    v_add_u32 v0, s93, v0
    v_smfmac_f32_16x16x64_bf16 v[148:151], a[240:243], v[204:211], v39
    s_waitcnt lgkmcnt(10)
    s_cmp_lt_i32 s81, 0
    s_cbranch_scc1 M_ovrL
    s_swappc_b64 s[78:79], s[72:73]
M_ovrL:
    v_smfmac_f32_16x16x64_bf16 v[152:155], a[208:211], v[196:203], v35 abid:1
    s_add_u32 m0, m0, 896
    v_min_u32 v0, 75497472, v0
    v_smfmac_f32_16x16x64_bf16 v[152:155], a[244:247], v[204:211], v39 abid:1
    ds_write_b32 v11, v0
    s_waitcnt vmcnt(6)
    v_mov_b32 v0, 162048
    v_smfmac_f32_16x16x64_bf16 v[156:159], a[212:215], v[196:203], v50 abid:1
    buffer_load_dwordx4 v5, s[8:11], s22 offen offset:896 nt lds
    v_smfmac_f32_16x16x64_bf16 v[156:159], a[248:251], v[204:211], v51
    s_waitcnt lgkmcnt(9)
    v_smfmac_f32_16x16x64_bf16 v[124:127], a[252:255], v[220:227], v40
    ds_read_b128 v[196:199], v1 offset:18432
    s_waitcnt lgkmcnt(8)
    v_smfmac_f32_16x16x64_bf16 v[124:127], v[88:91], v[228:235], v44
    ds_read_b128 v[200:203], v2 offset:18432
    v_smfmac_f32_16x16x64_bf16 v[156:159], v[84:87], v[220:227], v51 abid:1
    ds_read_b128 v[204:207], v1 offset:19456
    v_smfmac_f32_16x16x64_bf16 v[156:159], v[120:123], v[228:235], v52
    s_waitcnt lgkmcnt(3)
    s_barrier
    v_xad_u32 v236, v236, v3, v4
    v_smfmac_f32_16x16x64_bf16 v[156:159], v[240:243], v[244:251], v10
    ds_read_b128 v[208:211], v2 offset:19456
    ds_read_b32 v0, v0
    v_xad_u32 v237, v237, v3, v4
    v_smfmac_f32_16x16x64_bf16 v[192:195], v[240:243], v[244:251], v10 abid:1
    ds_read2st64_b32 v[244:245], v236 offset0:0 offset1:72
    ds_read_b128 v[240:243], v8 offset:7168
    v_xad_u32 v238, v238, v3, v4
    v_smfmac_f32_16x16x64_bf16 v[132:135], v[60:63], v[220:227], v41
    ds_read2st64_b32 v[246:247], v237 offset0:0 offset1:72
    v_xad_u32 v239, v239, v3, v4
    v_smfmac_f32_16x16x64_bf16 v[132:135], v[96:99], v[228:235], v45
    ds_read2st64_b32 v[248:249], v238 offset0:0 offset1:72
    s_add_u32 m0, m0, 896
    v_smfmac_f32_16x16x64_bf16 v[136:139], v[64:67], v[220:227], v41 abid:1
    ds_read2st64_b32 v[250:251], v239 offset0:0 offset1:72
    ds_read_b128 v[236:239], v9 offset:9536
    s_waitcnt vmcnt(6)
    v_smfmac_f32_16x16x64_bf16 v[136:139], v[100:103], v[228:235], v45 abid:1
    buffer_load_dwordx4 v5, s[8:11], s22 offen offset:1024 nt lds
    s_waitcnt lgkmcnt(6)
    v_readfirstlane_b32 s88, v0
    v_smfmac_f32_16x16x64_bf16 v[140:143], v[68:71], v[220:227], v42
    s_cmp_lt_u32 s88, s99
    s_cselect_b32 s10, 75497472, 0
    v_smfmac_f32_16x16x64_bf16 v[140:143], v[104:107], v[228:235], v46
    s_cmp_lt_u32 s88, s14
    s_cbranch_scc0 M_q
M_nq:
    v_smfmac_f32_16x16x64_bf16 v[144:147], v[72:75], v[220:227], v42 abid:1
    ds_read_b128 v[212:215], v1 offset:20480
    v_smfmac_f32_16x16x64_bf16 v[144:147], v[108:111], v[228:235], v46 abid:1
    ds_read_b128 v[216:219], v2 offset:20480
    v_smfmac_f32_16x16x64_bf16 v[148:151], v[76:79], v[220:227], v43
    v_smfmac_f32_16x16x64_bf16 v[148:151], v[112:115], v[228:235], v47
    v_smfmac_f32_16x16x64_bf16 v[152:155], v[80:83], v[220:227], v43 abid:1
    v_smfmac_f32_16x16x64_bf16 v[152:155], v[116:119], v[228:235], v47 abid:1
    s_waitcnt lgkmcnt(2)
    v_xad_u32 v236, v236, v3, v4
    v_smfmac_f32_16x16x64_bf16 v[152:155], v[240:243], v[244:251], v10
    v_xad_u32 v237, v237, v3, v4
    v_smfmac_f32_16x16x64_bf16 v[188:191], v[240:243], v[244:251], v10 abid:1
    s_cmp_gt_u32 s46, s80
    s_cbranch_scc1 M_slow
M_slowrL:
    v_xad_u32 v238, v238, v3, v4
    v_smfmac_f32_16x16x64_bf16 v[128:131], v[56:59], v[220:227], v40 abid:1
    ds_read2st64_b32 v[244:245], v236 offset0:0 offset1:72
    ds_read_b128 v[240:243], v8 offset:5120
    v_xad_u32 v239, v239, v3, v4
    v_smfmac_f32_16x16x64_bf16 v[128:131], v[92:95], v[228:235], v44 abid:1
    ds_read2st64_b32 v[246:247], v237 offset0:0 offset1:72
    v_smfmac_f32_16x16x64_bf16 v[160:163], a[0:3], v[196:203], v12
    ds_read2st64_b32 v[248:249], v238 offset0:0 offset1:72
    v_smfmac_f32_16x16x64_bf16 v[160:163], a[36:39], v[204:211], v16
    ds_read2st64_b32 v[250:251], v239 offset0:0 offset1:72
    ds_read_b128 v[236:239], v9 offset:9600
    s_waitcnt lgkmcnt(6)
    v_smfmac_f32_16x16x64_bf16 v[160:163], a[72:75], v[212:219], v20
    v_smfmac_f32_16x16x64_bf16 v[164:167], a[4:7], v[196:203], v12 abid:1
    s_mov_b32 m0, s28
    v_cvt_pk_bf16_f32 v156, v156, v157
    v_smfmac_f32_16x16x64_bf16 v[164:167], a[40:43], v[204:211], v16 abid:1
    s_waitcnt vmcnt(6)
    buffer_load_dwordx4 v5, s[8:11], s88 offen offset:0 nt lds
    v_cvt_pk_bf16_f32 v157, v158, v159
    v_smfmac_f32_16x16x64_bf16 v[164:167], a[76:79], v[212:219], v20 abid:1
    ds_write_b64 v53, v[156:157] offset:25728
    ds_read_b128 v[156:159], v9 offset:10752
    v_smfmac_f32_16x16x64_bf16 v[180:183], a[20:23], v[196:203], v14 abid:1
    v_smfmac_f32_16x16x64_bf16 v[180:183], a[56:59], v[204:211], v18 abid:1
    ds_read_b128 v[220:223], v1 offset:21504
    v_cvt_pk_bf16_f32 v124, v124, v125
    v_smfmac_f32_16x16x64_bf16 v[180:183], a[92:95], v[212:219], v22 abid:1
    s_waitcnt lgkmcnt(3)
    v_xad_u32 v236, v236, v3, v4
    v_smfmac_f32_16x16x64_bf16 v[180:183], v[240:243], v[244:251], v10 abid:1
    v_xad_u32 v237, v237, v3, v4
    v_smfmac_f32_16x16x64_bf16 v[144:147], v[240:243], v[244:251], v10
    ds_read2st64_b32 v[244:245], v236 offset0:0 offset1:72
    ds_read_b128 v[240:243], v8 offset:6144
    v_xad_u32 v238, v238, v3, v4
    v_smfmac_f32_16x16x64_bf16 v[172:175], a[12:15], v[196:203], v13 abid:1
    ds_read2st64_b32 v[246:247], v237 offset0:0 offset1:72
    v_xad_u32 v239, v239, v3, v4
    v_smfmac_f32_16x16x64_bf16 v[172:175], a[48:51], v[204:211], v17 abid:1
    ds_read2st64_b32 v[248:249], v238 offset0:0 offset1:72
    v_cvt_pk_bf16_f32 v125, v126, v127
    v_smfmac_f32_16x16x64_bf16 v[172:175], a[84:87], v[212:219], v21 abid:1
    ds_read2st64_b32 v[250:251], v239 offset0:0 offset1:72
    ds_read_b128 v[236:239], v9 offset:9472
    v_cvt_pk_bf16_f32 v126, v128, v129
    v_smfmac_f32_16x16x64_bf16 v[176:179], a[16:19], v[196:203], v14
    v_cvt_pk_bf16_f32 v127, v130, v131
    v_smfmac_f32_16x16x64_bf16 v[176:179], a[52:55], v[204:211], v18
    v_cvt_pk_bf16_f32 v132, v132, v133
    v_smfmac_f32_16x16x64_bf16 v[176:179], a[88:91], v[212:219], v22
    v_cvt_pk_bf16_f32 v133, v134, v135
    v_smfmac_f32_16x16x64_bf16 v[168:171], a[8:11], v[196:203], v13
    s_add_u32 m0, m0, 896
    v_cvt_pk_bf16_f32 v134, v136, v137
    v_smfmac_f32_16x16x64_bf16 v[168:171], a[44:47], v[204:211], v17
    s_waitcnt vmcnt(6)
    buffer_load_dwordx4 v5, s[8:11], s88 offen offset:128 nt lds
    v_cvt_pk_bf16_f32 v135, v138, v139
    v_smfmac_f32_16x16x64_bf16 v[168:171], a[80:83], v[212:219], v21
    ds_read_b128 v[224:227], v2 offset:21504
    ds_read_b128 v[136:139], v9 offset:10432
    v_cndmask_b32_dpp v128, v124, v132, vcc row_ror:8 row_mask:0xf bank_mask:0xf
    v_smfmac_f32_16x16x64_bf16 v[184:187], a[24:27], v[196:203], v15
    ds_read_b128 v[228:231], v1 offset:22528
    v_cndmask_b32_dpp v129, v125, v133, vcc row_ror:8 row_mask:0xf bank_mask:0xf
    v_smfmac_f32_16x16x64_bf16 v[184:187], a[60:63], v[204:211], v19
    ds_read_b128 v[232:235], v2 offset:22528
    v_cndmask_b32_dpp v130, v126, v134, vcc row_ror:8 row_mask:0xf bank_mask:0xf
    v_smfmac_f32_16x16x64_bf16 v[184:187], a[96:99], v[212:219], v23
    s_waitcnt lgkmcnt(4)
    v_xad_u32 v236, v236, v3, v4
    v_smfmac_f32_16x16x64_bf16 v[184:187], v[240:243], v[244:251], v10 abid:1
    v_xad_u32 v237, v237, v3, v4
    v_smfmac_f32_16x16x64_bf16 v[148:151], v[240:243], v[244:251], v10
    ds_read2st64_b32 v[244:245], v236 offset0:0 offset1:72
    ds_read_b128 v[240:243], v8 offset:4096
    v_xad_u32 v238, v238, v3, v4
    v_smfmac_f32_16x16x64_bf16 v[188:191], a[28:31], v[196:203], v15 abid:1
    ds_read2st64_b32 v[246:247], v237 offset0:0 offset1:72
    v_xad_u32 v239, v239, v3, v4
    v_smfmac_f32_16x16x64_bf16 v[188:191], a[64:67], v[204:211], v19 abid:1
    ds_read2st64_b32 v[248:249], v238 offset0:0 offset1:72
    v_cndmask_b32_dpp v131, v127, v135, vcc row_ror:8 row_mask:0xf bank_mask:0xf
    v_smfmac_f32_16x16x64_bf16 v[188:191], a[100:103], v[212:219], v23 abid:1
    ds_read2st64_b32 v[250:251], v239 offset0:0 offset1:72
    s_waitcnt vmcnt(6)
    buffer_store_dwordx4 v[128:131], v6, s[12:15], s59 offen offset:0 sc1
    v_smfmac_f32_16x16x64_bf16 v[192:195], a[32:35], v[196:203], v48
    v_mov_b32_dpp v124, v132 row_ror:8 row_mask:0xf bank_mask:0xc
    v_smfmac_f32_16x16x64_bf16 v[192:195], a[68:71], v[204:211], v48 abid:1
    v_mov_b32_dpp v125, v133 row_ror:8 row_mask:0xf bank_mask:0xc
    v_smfmac_f32_16x16x64_bf16 v[192:195], a[104:107], v[212:219], v49
    s_waitcnt lgkmcnt(8)
    v_mov_b32_dpp v126, v134 row_ror:8 row_mask:0xf bank_mask:0xc
    v_smfmac_f32_16x16x64_bf16 v[160:163], a[108:111], v[220:227], v24
    s_waitcnt lgkmcnt(5)
    v_mov_b32_dpp v127, v135 row_ror:8 row_mask:0xf bank_mask:0xc
    v_smfmac_f32_16x16x64_bf16 v[160:163], a[144:147], v[228:235], v28
    ds_read_b128 v[196:199], v1 offset:23552
    s_waitcnt vmcnt(6)
    buffer_store_dwordx4 v[124:127], v6, s[12:15], s24 offen offset:0 sc1
    v_smfmac_f32_16x16x64_bf16 v[164:167], a[112:115], v[220:227], v24 abid:1
    ds_read_b128 v[200:203], v2 offset:23552
    ds_read_b128 v[128:131], v9 offset:10304
    ds_read_b128 v[132:135], v9 offset:10368
    v_smfmac_f32_16x16x64_bf16 v[164:167], a[148:151], v[228:235], v28 abid:1
    ds_read_b128 v[204:207], v1 offset:24576
    ds_read_b128 v[124:127], v9 offset:10240
    v_smfmac_f32_16x16x64_bf16 v[176:179], a[124:127], v[220:227], v26
    ds_read_b128 v[208:211], v2 offset:24576
    v_smfmac_f32_16x16x64_bf16 v[176:179], a[160:163], v[228:235], v30
    s_waitcnt lgkmcnt(7)
    v_smfmac_f32_16x16x64_bf16 v[176:179], v[240:243], v[244:251], v10 abid:1
    v_smfmac_f32_16x16x64_bf16 v[140:143], v[240:243], v[244:251], v10
    v_smfmac_f32_16x16x64_bf16 v[172:175], a[120:123], v[220:227], v25 abid:1
    s_add_u32 s28, s28, 36864
    s_cmp_ge_u32 s28, 110592
    s_cselect_b32 s28, s26, s28
    v_smfmac_f32_16x16x64_bf16 v[172:175], a[156:159], v[228:235], v29 abid:1
    s_add_u32 s30, s25, 36864
    s_cmp_eq_u32 s30, 110592
    s_cselect_b32 s30, 0, s30
    v_smfmac_f32_16x16x64_bf16 v[168:171], a[116:119], v[220:227], v25
    s_sub_u32 s31, s30, s25
    s_mov_b32 s25, s30
    s_mov_b32 s90, s22
    v_smfmac_f32_16x16x64_bf16 v[168:171], a[152:155], v[228:235], v29
    s_mov_b32 s22, s88
    s_add_u32 s91, s91, 1
    s_cmp_lt_u32 s20, 2
    v_smfmac_f32_16x16x64_bf16 v[180:183], a[128:131], v[220:227], v26 abid:1
    s_cselect_b32 s66, s23, s24
    s_add_u32 s66, s66, s95
    v_smfmac_f32_16x16x64_bf16 v[180:183], a[164:167], v[228:235], v30 abid:1
    v_cvt_pk_bf16_f32 v140, v140, v141
    v_smfmac_f32_16x16x64_bf16 v[184:187], a[132:135], v[220:227], v27
    s_add_u32 m0, m0, 896
    v_cvt_pk_bf16_f32 v141, v142, v143
    v_smfmac_f32_16x16x64_bf16 v[184:187], a[168:171], v[228:235], v31
    s_waitcnt vmcnt(6)
    buffer_load_dwordx4 v5, s[8:11], s88 offen offset:256 nt lds
    v_cvt_pk_bf16_f32 v142, v144, v145
    v_smfmac_f32_16x16x64_bf16 v[188:191], a[136:139], v[220:227], v27 abid:1
    v_cvt_pk_bf16_f32 v143, v146, v147
    v_smfmac_f32_16x16x64_bf16 v[188:191], a[172:175], v[228:235], v31 abid:1
    v_cvt_pk_bf16_f32 v148, v148, v149
    v_smfmac_f32_16x16x64_bf16 v[192:195], a[140:143], v[220:227], v49 abid:1
    v_cvt_pk_bf16_f32 v149, v150, v151
    v_smfmac_f32_16x16x64_bf16 v[192:195], a[176:179], v[228:235], v50
    ds_read_b128 v[220:223], v1 offset:25600
    s_waitcnt lgkmcnt(6)
    v_cvt_pk_bf16_f32 v150, v152, v153
    v_smfmac_f32_16x16x64_bf16 v[160:163], a[180:183], v[196:203], v32
    ds_read_b128 v[224:227], v2 offset:25600
    s_waitcnt lgkmcnt(2)
    v_cvt_pk_bf16_f32 v151, v154, v155
    v_smfmac_f32_16x16x64_bf16 v[160:163], a[216:219], v[204:211], v36
    ds_read_b128 v[228:231], v1 offset:26624
    ds_read_b128 v[152:155], v9 offset:10688
    v_cndmask_b32_dpp v144, v140, v148, vcc row_ror:8 row_mask:0xf bank_mask:0xf
    v_smfmac_f32_16x16x64_bf16 v[164:167], a[184:187], v[196:203], v32 abid:1
    ds_read_b128 v[232:235], v2 offset:26624
    v_cndmask_b32_dpp v145, v141, v149, vcc row_ror:8 row_mask:0xf bank_mask:0xf
    v_smfmac_f32_16x16x64_bf16 v[164:167], a[220:223], v[204:211], v36 abid:1
    s_add_u32 m0, m0, 896
    v_cndmask_b32_dpp v146, v142, v150, vcc row_ror:8 row_mask:0xf bank_mask:0xf
    v_smfmac_f32_16x16x64_bf16 v[168:171], a[188:191], v[196:203], v33
    s_waitcnt vmcnt(6)
    buffer_load_dwordx4 v5, s[8:11], s88 offen offset:384 nt lds
    v_cndmask_b32_dpp v147, v143, v151, vcc row_ror:8 row_mask:0xf bank_mask:0xf
    v_smfmac_f32_16x16x64_bf16 v[168:171], a[224:227], v[204:211], v37
    s_waitcnt vmcnt(6)
    buffer_store_dwordx4 v[144:147], v6, s[12:15], s59 offen offset:128 sc1
    v_mov_b32_dpp v140, v148 row_ror:8 row_mask:0xf bank_mask:0xc
    v_smfmac_f32_16x16x64_bf16 v[172:175], a[192:195], v[196:203], v33 abid:1
    v_mov_b32_dpp v141, v149 row_ror:8 row_mask:0xf bank_mask:0xc
    v_smfmac_f32_16x16x64_bf16 v[172:175], a[228:231], v[204:211], v37 abid:1
    v_mov_b32_dpp v142, v150 row_ror:8 row_mask:0xf bank_mask:0xc
    v_smfmac_f32_16x16x64_bf16 v[176:179], a[196:199], v[196:203], v34
    v_mov_b32_dpp v143, v151 row_ror:8 row_mask:0xf bank_mask:0xc
    v_smfmac_f32_16x16x64_bf16 v[176:179], a[232:235], v[204:211], v38
    s_waitcnt vmcnt(6)
    buffer_store_dwordx4 v[140:143], v6, s[12:15], s24 offen offset:128 sc1
    ds_read_b128 v[144:147], v9 offset:10560
    v_smfmac_f32_16x16x64_bf16 v[180:183], a[200:203], v[196:203], v34 abid:1
    ds_read_b128 v[148:151], v9 offset:10624
    ds_read_b128 v[140:143], v9 offset:10496
    v_add_u32 v4, s31, v4
    v_smfmac_f32_16x16x64_bf16 v[180:183], a[236:239], v[204:211], v38 abid:1
    v_add_u32 v1, s31, v1
    v_smfmac_f32_16x16x64_bf16 v[184:187], a[204:207], v[196:203], v35
    v_add_u32 v2, s31, v2
    v_smfmac_f32_16x16x64_bf16 v[184:187], a[240:243], v[204:211], v39
    v_smfmac_f32_16x16x64_bf16 v[188:191], a[208:211], v[196:203], v35 abid:1
    v_smfmac_f32_16x16x64_bf16 v[188:191], a[244:247], v[204:211], v39 abid:1
    v_smfmac_f32_16x16x64_bf16 v[192:195], a[212:215], v[196:203], v50 abid:1
    v_smfmac_f32_16x16x64_bf16 v[192:195], a[248:251], v[204:211], v51
    s_waitcnt vmcnt(8)
    s_branch M_top1
M_bE0:
    v_smfmac_f32_16x16x64_bf16 v[164:167], v[56:59], v[220:227], v40 abid:1
    ds_read_b128 v[204:207], v1 offset:1024
    v_smfmac_f32_16x16x64_bf16 v[164:167], v[92:95], v[228:235], v44 abid:1
    ds_read_b128 v[208:211], v2 offset:1024
    v_mov_b32 v0, 1
    v_smfmac_f32_16x16x64_bf16 v[168:171], v[60:63], v[220:227], v41
    ds_read_b128 v[212:215], v1 offset:2048
    v_smfmac_f32_16x16x64_bf16 v[168:171], v[96:99], v[228:235], v45
    ds_read_b128 v[216:219], v2 offset:2048
    v_smfmac_f32_16x16x64_bf16 v[172:175], v[64:67], v[220:227], v41 abid:1
    s_waitcnt vmcnt(5)
    s_waitcnt lgkmcnt(6)
    buffer_store_dwordx4 v[244:247], v7, s[12:15], s66 offen sc1
    v_smfmac_f32_16x16x64_bf16 v[172:175], v[100:103], v[228:235], v45 abid:1
    ds_read_b128 v[236:239], v9 offset:9408
    v_smfmac_f32_16x16x64_bf16 v[176:179], v[68:71], v[220:227], v42
    s_waitcnt vmcnt(6)
    buffer_atomic_add v0, v11, s[16:19], s92 offen sc0 sc1
    s_mov_b32 s21, 2
    v_smfmac_f32_16x16x64_bf16 v[176:179], v[104:107], v[228:235], v46
    v_smfmac_f32_16x16x64_bf16 v[180:183], v[72:75], v[220:227], v42 abid:1
    v_cvt_pk_bf16_f32 v160, v160, v161
    v_smfmac_f32_16x16x64_bf16 v[180:183], v[108:111], v[228:235], v46 abid:1
    v_cvt_pk_bf16_f32 v161, v162, v163
    v_smfmac_f32_16x16x64_bf16 v[184:187], v[76:79], v[220:227], v43
    v_cvt_pk_bf16_f32 v162, v164, v165
    v_smfmac_f32_16x16x64_bf16 v[184:187], v[112:115], v[228:235], v47
    v_cvt_pk_bf16_f32 v163, v166, v167
    v_smfmac_f32_16x16x64_bf16 v[188:191], v[80:83], v[220:227], v43 abid:1
    s_add_u32 m0, m0, 896
    v_cvt_pk_bf16_f32 v168, v168, v169
    v_smfmac_f32_16x16x64_bf16 v[188:191], v[116:119], v[228:235], v47 abid:1
    s_waitcnt vmcnt(5)
    buffer_load_dwordx4 v5, s[8:11], s22 offen offset:512 nt lds
    v_cvt_pk_bf16_f32 v169, v170, v171
    v_smfmac_f32_16x16x64_bf16 v[192:195], v[84:87], v[220:227], v51 abid:1
    v_cvt_pk_bf16_f32 v170, v172, v173
    v_smfmac_f32_16x16x64_bf16 v[192:195], v[120:123], v[228:235], v52
    ds_read_b128 v[220:223], v1 offset:3072
    s_waitcnt lgkmcnt(6)
    v_cvt_pk_bf16_f32 v171, v174, v175
    v_smfmac_f32_16x16x64_bf16 v[124:127], a[0:3], v[196:203], v12
    ds_read_b128 v[224:227], v2 offset:3072
    ds_read_b128 v[172:175], v9 offset:10432
    s_waitcnt lgkmcnt(6)
    v_cndmask_b32_dpp v164, v160, v168, vcc row_ror:8 row_mask:0xf bank_mask:0xf
    v_smfmac_f32_16x16x64_bf16 v[124:127], a[36:39], v[204:211], v16
    ds_read_b128 v[228:231], v1 offset:4096
    s_waitcnt lgkmcnt(5)
    v_cndmask_b32_dpp v165, v161, v169, vcc row_ror:8 row_mask:0xf bank_mask:0xf
    v_smfmac_f32_16x16x64_bf16 v[124:127], a[72:75], v[212:219], v20
    ds_read_b128 v[232:235], v2 offset:4096
    v_cndmask_b32_dpp v166, v162, v170, vcc row_ror:8 row_mask:0xf bank_mask:0xf
    v_smfmac_f32_16x16x64_bf16 v[128:131], a[4:7], v[196:203], v12 abid:1
    s_barrier
    v_cndmask_b32_dpp v167, v163, v171, vcc row_ror:8 row_mask:0xf bank_mask:0xf
    v_smfmac_f32_16x16x64_bf16 v[128:131], a[40:43], v[204:211], v16 abid:1
    s_waitcnt vmcnt(6)
    buffer_store_dwordx4 v[164:167], v6, s[12:15], s58 offen offset:0 sc1
    s_waitcnt lgkmcnt(5)
    v_xad_u32 v236, v236, v3, v4
    v_smfmac_f32_16x16x64_bf16 v[128:131], a[76:79], v[212:219], v20 abid:1
    v_xad_u32 v237, v237, v3, v4
    v_smfmac_f32_16x16x64_bf16 v[132:135], a[8:11], v[196:203], v13
    ds_read2st64_b32 v[244:245], v236 offset0:0 offset1:72
    ds_read_b128 v[240:243], v8 offset:3072
    v_xad_u32 v238, v238, v3, v4
    v_smfmac_f32_16x16x64_bf16 v[132:135], a[44:47], v[204:211], v17
    ds_read2st64_b32 v[246:247], v237 offset0:0 offset1:72
    v_xad_u32 v239, v239, v3, v4
    v_smfmac_f32_16x16x64_bf16 v[132:135], a[80:83], v[212:219], v21
    ds_read2st64_b32 v[248:249], v238 offset0:0 offset1:72
    v_mov_b32_dpp v160, v168 row_ror:8 row_mask:0xf bank_mask:0xc
    v_smfmac_f32_16x16x64_bf16 v[144:147], a[20:23], v[196:203], v14 abid:1
    ds_read2st64_b32 v[250:251], v239 offset0:0 offset1:72
    ds_read_b128 v[236:239], v9 offset:9280
    v_mov_b32_dpp v161, v169 row_ror:8 row_mask:0xf bank_mask:0xc
    v_smfmac_f32_16x16x64_bf16 v[144:147], a[56:59], v[204:211], v18 abid:1
    v_mov_b32_dpp v162, v170 row_ror:8 row_mask:0xf bank_mask:0xc
    v_smfmac_f32_16x16x64_bf16 v[144:147], a[92:95], v[212:219], v22 abid:1
    v_mov_b32_dpp v163, v171 row_ror:8 row_mask:0xf bank_mask:0xc
    v_smfmac_f32_16x16x64_bf16 v[140:143], a[16:19], v[196:203], v14
    s_waitcnt vmcnt(5)
    buffer_store_dwordx4 v[160:163], v6, s[12:15], s23 offen offset:0 sc1
    ds_read_b128 v[164:167], v9 offset:10304
    v_smfmac_f32_16x16x64_bf16 v[140:143], a[52:55], v[204:211], v18
    ds_read_b128 v[168:171], v9 offset:10368
    ds_read_b128 v[160:163], v9 offset:10240
    v_smfmac_f32_16x16x64_bf16 v[140:143], a[88:91], v[212:219], v22
    v_smfmac_f32_16x16x64_bf16 v[136:139], a[12:15], v[196:203], v13 abid:1
    v_smfmac_f32_16x16x64_bf16 v[136:139], a[48:51], v[204:211], v17 abid:1
    v_smfmac_f32_16x16x64_bf16 v[136:139], a[84:87], v[212:219], v21 abid:1
    s_waitcnt lgkmcnt(3)
    v_xad_u32 v236, v236, v3, v4
    v_smfmac_f32_16x16x64_bf16 v[136:139], v[240:243], v[244:251], v10
    v_xad_u32 v237, v237, v3, v4
    v_smfmac_f32_16x16x64_bf16 v[172:175], v[240:243], v[244:251], v10 abid:1
    ds_read2st64_b32 v[244:245], v236 offset0:0 offset1:72
    ds_read_b128 v[240:243], v8 offset:1024
    v_xad_u32 v238, v238, v3, v4
    v_smfmac_f32_16x16x64_bf16 v[148:151], a[24:27], v[196:203], v15
    ds_read2st64_b32 v[246:247], v237 offset0:0 offset1:72
    v_xad_u32 v239, v239, v3, v4
    v_smfmac_f32_16x16x64_bf16 v[148:151], a[60:63], v[204:211], v19
    ds_read2st64_b32 v[248:249], v238 offset0:0 offset1:72
    v_cvt_pk_bf16_f32 v192, v192, v193
    v_smfmac_f32_16x16x64_bf16 v[148:151], a[96:99], v[212:219], v23
    ds_read2st64_b32 v[250:251], v239 offset0:0 offset1:72
    ds_read_b128 v[236:239], v9 offset:9344
    v_cvt_pk_bf16_f32 v193, v194, v195
    v_smfmac_f32_16x16x64_bf16 v[152:155], a[28:31], v[196:203], v15 abid:1
    ds_write_b64 v53, v[192:193] offset:0
    ds_read_b128 v[192:195], v9 offset:10752
    v_smfmac_f32_16x16x64_bf16 v[152:155], a[64:67], v[204:211], v19 abid:1
    s_add_u32 m0, m0, 896
    v_smfmac_f32_16x16x64_bf16 v[152:155], a[100:103], v[212:219], v23 abid:1
    s_waitcnt vmcnt(6)
    buffer_load_dwordx4 v5, s[8:11], s22 offen offset:640 nt lds
    v_smfmac_f32_16x16x64_bf16 v[156:159], a[32:35], v[196:203], v48
    v_smfmac_f32_16x16x64_bf16 v[156:159], a[68:71], v[204:211], v48 abid:1
    v_smfmac_f32_16x16x64_bf16 v[156:159], a[104:107], v[212:219], v49
    ds_read_b128 v[196:199], v1 offset:5120
    v_cvt_pk_bf16_f32 v176, v176, v177
    v_smfmac_f32_16x16x64_bf16 v[124:127], a[108:111], v[220:227], v24
    ds_read_b128 v[200:203], v2 offset:5120
    v_cvt_pk_bf16_f32 v177, v178, v179
    v_smfmac_f32_16x16x64_bf16 v[124:127], a[144:147], v[228:235], v28
    ds_read_b128 v[204:207], v1 offset:6144
    ds_read_b64 v[216:217], v9 offset:10056
    v_cvt_pk_bf16_f32 v178, v180, v181
    v_smfmac_f32_16x16x64_bf16 v[128:131], a[112:115], v[220:227], v24 abid:1
    ds_read_b128 v[208:211], v2 offset:6144
    v_cvt_pk_bf16_f32 v179, v182, v183
    v_smfmac_f32_16x16x64_bf16 v[128:131], a[148:151], v[228:235], v28 abid:1
    s_waitcnt lgkmcnt(7)
    v_xad_u32 v236, v236, v3, v4
    v_smfmac_f32_16x16x64_bf16 v[128:131], v[240:243], v[244:251], v10
    s_add_u32 m0, m0, 896
    v_xad_u32 v237, v237, v3, v4
    v_smfmac_f32_16x16x64_bf16 v[164:167], v[240:243], v[244:251], v10 abid:1
    ds_read2st64_b32 v[244:245], v236 offset0:0 offset1:72
    ds_read_b128 v[240:243], v8 offset:2048
    v_xad_u32 v238, v238, v3, v4
    v_smfmac_f32_16x16x64_bf16 v[152:155], a[136:139], v[220:227], v27 abid:1
    ds_read2st64_b32 v[246:247], v237 offset0:0 offset1:72
    s_waitcnt vmcnt(5)
    v_xad_u32 v239, v239, v3, v4
    v_smfmac_f32_16x16x64_bf16 v[152:155], a[172:175], v[228:235], v31 abid:1
    ds_read2st64_b32 v[248:249], v238 offset0:0 offset1:72
    buffer_load_dwordx4 v5, s[8:11], s22 offen offset:768 nt lds
    v_cvt_pk_bf16_f32 v184, v184, v185
    v_smfmac_f32_16x16x64_bf16 v[136:139], a[120:123], v[220:227], v25 abid:1
    ds_read2st64_b32 v[250:251], v239 offset0:0 offset1:72
    ds_read_b128 v[236:239], v9 offset:9216
    v_cvt_pk_bf16_f32 v185, v186, v187
    v_smfmac_f32_16x16x64_bf16 v[136:139], a[156:159], v[228:235], v29 abid:1
    v_cvt_pk_bf16_f32 v186, v188, v189
    v_smfmac_f32_16x16x64_bf16 v[140:143], a[124:127], v[220:227], v26
    v_cvt_pk_bf16_f32 v187, v190, v191
    v_smfmac_f32_16x16x64_bf16 v[140:143], a[160:163], v[228:235], v30
    ds_read_b128 v[188:191], v9 offset:10688
    v_cndmask_b32_dpp v180, v176, v184, vcc row_ror:8 row_mask:0xf bank_mask:0xf
    v_smfmac_f32_16x16x64_bf16 v[144:147], a[128:131], v[220:227], v26 abid:1
    v_cndmask_b32_dpp v181, v177, v185, vcc row_ror:8 row_mask:0xf bank_mask:0xf
    v_smfmac_f32_16x16x64_bf16 v[144:147], a[164:167], v[228:235], v30 abid:1
    v_cndmask_b32_dpp v182, v178, v186, vcc row_ror:8 row_mask:0xf bank_mask:0xf
    v_smfmac_f32_16x16x64_bf16 v[148:151], a[132:135], v[220:227], v27
    v_cndmask_b32_dpp v183, v179, v187, vcc row_ror:8 row_mask:0xf bank_mask:0xf
    v_smfmac_f32_16x16x64_bf16 v[148:151], a[168:171], v[228:235], v31
    s_waitcnt vmcnt(6)
    buffer_store_dwordx4 v[180:183], v6, s[12:15], s58 offen offset:128 sc1
    s_waitcnt lgkmcnt(8)
    v_xad_u32 v212, v216, v3, v4
    v_smfmac_f32_16x16x64_bf16 v[132:135], a[116:119], v[220:227], v25
    ds_read2st64_b32 v[212:213], v212 offset0:0 offset1:72
    v_xad_u32 v214, v217, v3, v4
    v_smfmac_f32_16x16x64_bf16 v[132:135], a[152:155], v[228:235], v29
    ds_read2st64_b32 v[214:215], v214 offset0:0 offset1:72
    s_waitcnt lgkmcnt(3)
    v_xad_u32 v236, v236, v3, v4
    v_smfmac_f32_16x16x64_bf16 v[132:135], v[240:243], v[244:251], v10
    v_xad_u32 v237, v237, v3, v4
    v_smfmac_f32_16x16x64_bf16 v[168:171], v[240:243], v[244:251], v10 abid:1
    ds_read2st64_b32 v[244:245], v236 offset0:0 offset1:72
    ds_read_b128 v[240:243], v8 offset:0
    v_xad_u32 v238, v238, v3, v4
    v_smfmac_f32_16x16x64_bf16 v[156:159], a[140:143], v[220:227], v49 abid:1
    ds_read2st64_b32 v[246:247], v237 offset0:0 offset1:72
    v_xad_u32 v239, v239, v3, v4
    v_smfmac_f32_16x16x64_bf16 v[156:159], a[176:179], v[228:235], v50
    ds_read2st64_b32 v[248:249], v238 offset0:0 offset1:72
    v_mov_b32_dpp v176, v184 row_ror:8 row_mask:0xf bank_mask:0xc
    v_smfmac_f32_16x16x64_bf16 v[140:143], a[196:199], v[196:203], v34
    ds_read2st64_b32 v[250:251], v239 offset0:0 offset1:72
    ds_read_b128 v[236:239], v9 offset:9728
    v_mov_b32_dpp v177, v185 row_ror:8 row_mask:0xf bank_mask:0xc
    v_smfmac_f32_16x16x64_bf16 v[140:143], a[232:235], v[204:211], v38
    v_mov_b32_dpp v178, v186 row_ror:8 row_mask:0xf bank_mask:0xc
    v_smfmac_f32_16x16x64_bf16 v[128:131], a[184:187], v[196:203], v32 abid:1
    v_mov_b32_dpp v179, v187 row_ror:8 row_mask:0xf bank_mask:0xc
    v_smfmac_f32_16x16x64_bf16 v[128:131], a[220:223], v[204:211], v36 abid:1
    s_waitcnt vmcnt(5)
    buffer_store_dwordx4 v[176:179], v6, s[12:15], s23 offen offset:128 sc1
    ds_read_b128 v[180:183], v9 offset:10560
    v_smfmac_f32_16x16x64_bf16 v[132:135], a[188:191], v[196:203], v33
    ds_read_b128 v[184:187], v9 offset:10624
    ds_read_b128 v[176:179], v9 offset:10496
    v_smfmac_f32_16x16x64_bf16 v[132:135], a[224:227], v[204:211], v37
    v_smfmac_f32_16x16x64_bf16 v[136:139], a[192:195], v[196:203], v33 abid:1
    ds_read_b128 v[220:223], v1 offset:7168
    v_smfmac_f32_16x16x64_bf16 v[136:139], a[228:231], v[204:211], v37 abid:1
    ds_read_b128 v[224:227], v2 offset:7168
    v_smfmac_f32_16x16x64_bf16 v[124:127], a[180:183], v[196:203], v32
    ds_read_b128 v[228:231], v1 offset:8192
    v_smfmac_f32_16x16x64_bf16 v[124:127], a[216:219], v[204:211], v36
    s_waitcnt vmcnt(7)
    s_waitcnt lgkmcnt(6)
    v_xad_u32 v236, v236, v3, v4
    v_smfmac_f32_16x16x64_bf16 v[124:127], v[240:243], v[244:251], v10
    ds_read_b128 v[232:235], v2 offset:8192
    v_xad_u32 v237, v237, v3, v4
    v_smfmac_f32_16x16x64_bf16 v[160:163], v[240:243], v[244:251], v10 abid:1
    ds_read2st64_b32 v[244:245], v236 offset0:0 offset1:72
    ds_read_b128 v[240:243], v8 offset:8192
    v_xad_u32 v238, v238, v3, v4
    v_smfmac_f32_16x16x64_bf16 v[144:147], a[200:203], v[196:203], v34 abid:1
    ds_read2st64_b32 v[246:247], v237 offset0:0 offset1:72
    v_xad_u32 v239, v239, v3, v4
    v_smfmac_f32_16x16x64_bf16 v[144:147], a[236:239], v[204:211], v38 abid:1
    ds_read2st64_b32 v[248:249], v238 offset0:0 offset1:72
    v_mul_u32_u24 v0, s94, v0
    v_smfmac_f32_16x16x64_bf16 v[148:151], a[204:207], v[196:203], v35
    ds_read2st64_b32 v[250:251], v239 offset0:0 offset1:72
    ds_read_b128 v[236:239], v9 offset:9664
    v_add_u32 v0, s93, v0
    v_smfmac_f32_16x16x64_bf16 v[148:151], a[240:243], v[204:211], v39
    s_waitcnt lgkmcnt(10)
    s_cmp_lt_i32 s81, 0
    s_cbranch_scc1 M_ovrE0
    s_swappc_b64 s[78:79], s[72:73]
M_ovrE0:
    v_smfmac_f32_16x16x64_bf16 v[152:155], a[208:211], v[196:203], v35 abid:1
    s_add_u32 m0, m0, 896
    v_min_u32 v0, 75497472, v0
    v_smfmac_f32_16x16x64_bf16 v[152:155], a[244:247], v[204:211], v39 abid:1
    ds_write_b32 v11, v0
    s_waitcnt vmcnt(6)
    v_mov_b32 v0, 162048
    v_smfmac_f32_16x16x64_bf16 v[156:159], a[212:215], v[196:203], v50 abid:1
    buffer_load_dwordx4 v5, s[8:11], s22 offen offset:896 nt lds
    v_smfmac_f32_16x16x64_bf16 v[156:159], a[248:251], v[204:211], v51
    s_waitcnt lgkmcnt(9)
    v_smfmac_f32_16x16x64_bf16 v[124:127], a[252:255], v[220:227], v40
    ds_read_b128 v[196:199], v1 offset:18432
    s_waitcnt lgkmcnt(8)
    v_smfmac_f32_16x16x64_bf16 v[124:127], v[88:91], v[228:235], v44
    ds_read_b128 v[200:203], v2 offset:18432
    v_smfmac_f32_16x16x64_bf16 v[156:159], v[84:87], v[220:227], v51 abid:1
    ds_read_b128 v[204:207], v1 offset:19456
    v_smfmac_f32_16x16x64_bf16 v[156:159], v[120:123], v[228:235], v52
    s_waitcnt lgkmcnt(3)
    s_barrier
    v_xad_u32 v236, v236, v3, v4
    v_smfmac_f32_16x16x64_bf16 v[156:159], v[240:243], v[244:251], v10
    ds_read_b128 v[208:211], v2 offset:19456
    ds_read_b32 v0, v0
    v_xad_u32 v237, v237, v3, v4
    v_smfmac_f32_16x16x64_bf16 v[192:195], v[240:243], v[244:251], v10 abid:1
    ds_read2st64_b32 v[244:245], v236 offset0:0 offset1:72
    ds_read_b128 v[240:243], v8 offset:7168
    v_xad_u32 v238, v238, v3, v4
    v_smfmac_f32_16x16x64_bf16 v[132:135], v[60:63], v[220:227], v41
    ds_read2st64_b32 v[246:247], v237 offset0:0 offset1:72
    v_xad_u32 v239, v239, v3, v4
    v_smfmac_f32_16x16x64_bf16 v[132:135], v[96:99], v[228:235], v45
    ds_read2st64_b32 v[248:249], v238 offset0:0 offset1:72
    s_add_u32 m0, m0, 896
    v_smfmac_f32_16x16x64_bf16 v[136:139], v[64:67], v[220:227], v41 abid:1
    ds_read2st64_b32 v[250:251], v239 offset0:0 offset1:72
    ds_read_b128 v[236:239], v9 offset:9536
    s_waitcnt vmcnt(5)
    v_smfmac_f32_16x16x64_bf16 v[136:139], v[100:103], v[228:235], v45 abid:1
    buffer_load_dwordx4 v5, s[8:11], s22 offen offset:1024 nt lds
    s_waitcnt lgkmcnt(6)
    v_readfirstlane_b32 s88, v0
    v_smfmac_f32_16x16x64_bf16 v[140:143], v[68:71], v[220:227], v42
    s_cmp_lt_u32 s88, s99
    s_cselect_b32 s10, 75497472, 0
    v_smfmac_f32_16x16x64_bf16 v[140:143], v[104:107], v[228:235], v46
    v_smfmac_f32_16x16x64_bf16 v[144:147], v[72:75], v[220:227], v42 abid:1
    ds_read_b128 v[212:215], v1 offset:20480
    v_smfmac_f32_16x16x64_bf16 v[144:147], v[108:111], v[228:235], v46 abid:1
    ds_read_b128 v[216:219], v2 offset:20480
    v_smfmac_f32_16x16x64_bf16 v[148:151], v[76:79], v[220:227], v43
    v_smfmac_f32_16x16x64_bf16 v[148:151], v[112:115], v[228:235], v47
    v_smfmac_f32_16x16x64_bf16 v[152:155], v[80:83], v[220:227], v43 abid:1
    v_smfmac_f32_16x16x64_bf16 v[152:155], v[116:119], v[228:235], v47 abid:1
    s_waitcnt lgkmcnt(2)
    v_xad_u32 v236, v236, v3, v4
    v_smfmac_f32_16x16x64_bf16 v[152:155], v[240:243], v[244:251], v10
    v_xad_u32 v237, v237, v3, v4
    v_smfmac_f32_16x16x64_bf16 v[188:191], v[240:243], v[244:251], v10 abid:1
    s_cmp_gt_u32 s46, s80
    s_cbranch_scc1 M_slow
M_slowrE0:
    v_xad_u32 v238, v238, v3, v4
    v_smfmac_f32_16x16x64_bf16 v[128:131], v[56:59], v[220:227], v40 abid:1
    ds_read2st64_b32 v[244:245], v236 offset0:0 offset1:72
    ds_read_b128 v[240:243], v8 offset:5120
    v_xad_u32 v239, v239, v3, v4
    v_smfmac_f32_16x16x64_bf16 v[128:131], v[92:95], v[228:235], v44 abid:1
    ds_read2st64_b32 v[246:247], v237 offset0:0 offset1:72
    v_smfmac_f32_16x16x64_bf16 v[160:163], a[0:3], v[196:203], v12
    ds_read2st64_b32 v[248:249], v238 offset0:0 offset1:72
    v_smfmac_f32_16x16x64_bf16 v[160:163], a[36:39], v[204:211], v16
    ds_read2st64_b32 v[250:251], v239 offset0:0 offset1:72
    ds_read_b128 v[236:239], v9 offset:9600
    s_waitcnt lgkmcnt(6)
    v_smfmac_f32_16x16x64_bf16 v[160:163], a[72:75], v[212:219], v20
    v_smfmac_f32_16x16x64_bf16 v[164:167], a[4:7], v[196:203], v12 abid:1
    s_mov_b32 m0, s28
    v_cvt_pk_bf16_f32 v156, v156, v157
    v_smfmac_f32_16x16x64_bf16 v[164:167], a[40:43], v[204:211], v16 abid:1
    s_waitcnt vmcnt(6)
    buffer_load_dwordx4 v5, s[8:11], s88 offen offset:0 nt lds
    v_cvt_pk_bf16_f32 v157, v158, v159
    v_smfmac_f32_16x16x64_bf16 v[164:167], a[76:79], v[212:219], v20 abid:1
    ds_write_b64 v53, v[156:157] offset:25728
    ds_read_b128 v[156:159], v9 offset:10752
    v_smfmac_f32_16x16x64_bf16 v[180:183], a[20:23], v[196:203], v14 abid:1
    v_smfmac_f32_16x16x64_bf16 v[180:183], a[56:59], v[204:211], v18 abid:1
    ds_read_b128 v[220:223], v1 offset:21504
    v_cvt_pk_bf16_f32 v124, v124, v125
    v_smfmac_f32_16x16x64_bf16 v[180:183], a[92:95], v[212:219], v22 abid:1
    s_waitcnt lgkmcnt(3)
    v_xad_u32 v236, v236, v3, v4
    v_smfmac_f32_16x16x64_bf16 v[180:183], v[240:243], v[244:251], v10 abid:1
    v_xad_u32 v237, v237, v3, v4
    v_smfmac_f32_16x16x64_bf16 v[144:147], v[240:243], v[244:251], v10
    ds_read2st64_b32 v[244:245], v236 offset0:0 offset1:72
    ds_read_b128 v[240:243], v8 offset:6144
    v_xad_u32 v238, v238, v3, v4
    v_smfmac_f32_16x16x64_bf16 v[172:175], a[12:15], v[196:203], v13 abid:1
    ds_read2st64_b32 v[246:247], v237 offset0:0 offset1:72
    v_xad_u32 v239, v239, v3, v4
    v_smfmac_f32_16x16x64_bf16 v[172:175], a[48:51], v[204:211], v17 abid:1
    ds_read2st64_b32 v[248:249], v238 offset0:0 offset1:72
    v_cvt_pk_bf16_f32 v125, v126, v127
    v_smfmac_f32_16x16x64_bf16 v[172:175], a[84:87], v[212:219], v21 abid:1
    ds_read2st64_b32 v[250:251], v239 offset0:0 offset1:72
    ds_read_b128 v[236:239], v9 offset:9472
    v_cvt_pk_bf16_f32 v126, v128, v129
    v_smfmac_f32_16x16x64_bf16 v[176:179], a[16:19], v[196:203], v14
    v_cvt_pk_bf16_f32 v127, v130, v131
    v_smfmac_f32_16x16x64_bf16 v[176:179], a[52:55], v[204:211], v18
    v_cvt_pk_bf16_f32 v132, v132, v133
    v_smfmac_f32_16x16x64_bf16 v[176:179], a[88:91], v[212:219], v22
    v_cvt_pk_bf16_f32 v133, v134, v135
    v_smfmac_f32_16x16x64_bf16 v[168:171], a[8:11], v[196:203], v13
    s_add_u32 m0, m0, 896
    v_cvt_pk_bf16_f32 v134, v136, v137
    v_smfmac_f32_16x16x64_bf16 v[168:171], a[44:47], v[204:211], v17
    s_waitcnt vmcnt(5)
    buffer_load_dwordx4 v5, s[8:11], s88 offen offset:128 nt lds
    v_cvt_pk_bf16_f32 v135, v138, v139
    v_smfmac_f32_16x16x64_bf16 v[168:171], a[80:83], v[212:219], v21
    ds_read_b128 v[224:227], v2 offset:21504
    ds_read_b128 v[136:139], v9 offset:10432
    v_cndmask_b32_dpp v128, v124, v132, vcc row_ror:8 row_mask:0xf bank_mask:0xf
    v_smfmac_f32_16x16x64_bf16 v[184:187], a[24:27], v[196:203], v15
    ds_read_b128 v[228:231], v1 offset:22528
    v_cndmask_b32_dpp v129, v125, v133, vcc row_ror:8 row_mask:0xf bank_mask:0xf
    v_smfmac_f32_16x16x64_bf16 v[184:187], a[60:63], v[204:211], v19
    ds_read_b128 v[232:235], v2 offset:22528
    v_cndmask_b32_dpp v130, v126, v134, vcc row_ror:8 row_mask:0xf bank_mask:0xf
    v_smfmac_f32_16x16x64_bf16 v[184:187], a[96:99], v[212:219], v23
    s_waitcnt lgkmcnt(4)
    v_xad_u32 v236, v236, v3, v4
    v_smfmac_f32_16x16x64_bf16 v[184:187], v[240:243], v[244:251], v10 abid:1
    v_xad_u32 v237, v237, v3, v4
    v_smfmac_f32_16x16x64_bf16 v[148:151], v[240:243], v[244:251], v10
    ds_read2st64_b32 v[244:245], v236 offset0:0 offset1:72
    ds_read_b128 v[240:243], v8 offset:4096
    v_xad_u32 v238, v238, v3, v4
    v_smfmac_f32_16x16x64_bf16 v[188:191], a[28:31], v[196:203], v15 abid:1
    ds_read2st64_b32 v[246:247], v237 offset0:0 offset1:72
    v_xad_u32 v239, v239, v3, v4
    v_smfmac_f32_16x16x64_bf16 v[188:191], a[64:67], v[204:211], v19 abid:1
    ds_read2st64_b32 v[248:249], v238 offset0:0 offset1:72
    v_cndmask_b32_dpp v131, v127, v135, vcc row_ror:8 row_mask:0xf bank_mask:0xf
    v_smfmac_f32_16x16x64_bf16 v[188:191], a[100:103], v[212:219], v23 abid:1
    ds_read2st64_b32 v[250:251], v239 offset0:0 offset1:72
    s_waitcnt vmcnt(6)
    buffer_store_dwordx4 v[128:131], v6, s[12:15], s59 offen offset:0 sc1
    v_smfmac_f32_16x16x64_bf16 v[192:195], a[32:35], v[196:203], v48
    v_mov_b32_dpp v124, v132 row_ror:8 row_mask:0xf bank_mask:0xc
    v_smfmac_f32_16x16x64_bf16 v[192:195], a[68:71], v[204:211], v48 abid:1
    v_mov_b32_dpp v125, v133 row_ror:8 row_mask:0xf bank_mask:0xc
    v_smfmac_f32_16x16x64_bf16 v[192:195], a[104:107], v[212:219], v49
    s_waitcnt lgkmcnt(8)
    v_mov_b32_dpp v126, v134 row_ror:8 row_mask:0xf bank_mask:0xc
    v_smfmac_f32_16x16x64_bf16 v[160:163], a[108:111], v[220:227], v24
    s_waitcnt lgkmcnt(5)
    v_mov_b32_dpp v127, v135 row_ror:8 row_mask:0xf bank_mask:0xc
    v_smfmac_f32_16x16x64_bf16 v[160:163], a[144:147], v[228:235], v28
    ds_read_b128 v[196:199], v1 offset:23552
    s_waitcnt vmcnt(5)
    buffer_store_dwordx4 v[124:127], v6, s[12:15], s24 offen offset:0 sc1
    v_smfmac_f32_16x16x64_bf16 v[164:167], a[112:115], v[220:227], v24 abid:1
    ds_read_b128 v[200:203], v2 offset:23552
    ds_read_b128 v[128:131], v9 offset:10304
    ds_read_b128 v[132:135], v9 offset:10368
    v_smfmac_f32_16x16x64_bf16 v[164:167], a[148:151], v[228:235], v28 abid:1
    ds_read_b128 v[204:207], v1 offset:24576
    ds_read_b128 v[124:127], v9 offset:10240
    v_smfmac_f32_16x16x64_bf16 v[176:179], a[124:127], v[220:227], v26
    ds_read_b128 v[208:211], v2 offset:24576
    v_smfmac_f32_16x16x64_bf16 v[176:179], a[160:163], v[228:235], v30
    s_waitcnt lgkmcnt(7)
    v_smfmac_f32_16x16x64_bf16 v[176:179], v[240:243], v[244:251], v10 abid:1
    v_smfmac_f32_16x16x64_bf16 v[140:143], v[240:243], v[244:251], v10
    v_smfmac_f32_16x16x64_bf16 v[172:175], a[120:123], v[220:227], v25 abid:1
    s_add_u32 s28, s28, 36864
    s_cmp_ge_u32 s28, 110592
    s_cselect_b32 s28, s26, s28
    v_smfmac_f32_16x16x64_bf16 v[172:175], a[156:159], v[228:235], v29 abid:1
    s_add_u32 s30, s25, 36864
    s_cmp_eq_u32 s30, 110592
    s_cselect_b32 s30, 0, s30
    v_smfmac_f32_16x16x64_bf16 v[168:171], a[116:119], v[220:227], v25
    s_sub_u32 s31, s30, s25
    s_mov_b32 s25, s30
    s_mov_b32 s90, s22
    v_smfmac_f32_16x16x64_bf16 v[168:171], a[152:155], v[228:235], v29
    s_mov_b32 s22, s88
    s_add_u32 s91, s91, 1
    s_cmp_lt_u32 s20, 2
    v_smfmac_f32_16x16x64_bf16 v[180:183], a[128:131], v[220:227], v26 abid:1
    s_cselect_b32 s66, s23, s24
    s_add_u32 s66, s66, s95
    v_smfmac_f32_16x16x64_bf16 v[180:183], a[164:167], v[228:235], v30 abid:1
    v_cvt_pk_bf16_f32 v140, v140, v141
    v_smfmac_f32_16x16x64_bf16 v[184:187], a[132:135], v[220:227], v27
    s_add_u32 m0, m0, 896
    v_cvt_pk_bf16_f32 v141, v142, v143
    v_smfmac_f32_16x16x64_bf16 v[184:187], a[168:171], v[228:235], v31
    s_waitcnt vmcnt(6)
    buffer_load_dwordx4 v5, s[8:11], s88 offen offset:256 nt lds
    v_cvt_pk_bf16_f32 v142, v144, v145
    v_smfmac_f32_16x16x64_bf16 v[188:191], a[136:139], v[220:227], v27 abid:1
    v_cvt_pk_bf16_f32 v143, v146, v147
    v_smfmac_f32_16x16x64_bf16 v[188:191], a[172:175], v[228:235], v31 abid:1
    v_cvt_pk_bf16_f32 v148, v148, v149
    v_smfmac_f32_16x16x64_bf16 v[192:195], a[140:143], v[220:227], v49 abid:1
    v_cvt_pk_bf16_f32 v149, v150, v151
    v_smfmac_f32_16x16x64_bf16 v[192:195], a[176:179], v[228:235], v50
    ds_read_b128 v[220:223], v1 offset:25600
    s_waitcnt lgkmcnt(6)
    v_cvt_pk_bf16_f32 v150, v152, v153
    v_smfmac_f32_16x16x64_bf16 v[160:163], a[180:183], v[196:203], v32
    ds_read_b128 v[224:227], v2 offset:25600
    s_waitcnt lgkmcnt(2)
    v_cvt_pk_bf16_f32 v151, v154, v155
    v_smfmac_f32_16x16x64_bf16 v[160:163], a[216:219], v[204:211], v36
    ds_read_b128 v[228:231], v1 offset:26624
    ds_read_b128 v[152:155], v9 offset:10688
    v_cndmask_b32_dpp v144, v140, v148, vcc row_ror:8 row_mask:0xf bank_mask:0xf
    v_smfmac_f32_16x16x64_bf16 v[164:167], a[184:187], v[196:203], v32 abid:1
    ds_read_b128 v[232:235], v2 offset:26624
    v_cndmask_b32_dpp v145, v141, v149, vcc row_ror:8 row_mask:0xf bank_mask:0xf
    v_smfmac_f32_16x16x64_bf16 v[164:167], a[220:223], v[204:211], v36 abid:1
    s_add_u32 m0, m0, 896
    v_cndmask_b32_dpp v146, v142, v150, vcc row_ror:8 row_mask:0xf bank_mask:0xf
    v_smfmac_f32_16x16x64_bf16 v[168:171], a[188:191], v[196:203], v33
    s_waitcnt vmcnt(5)
    buffer_load_dwordx4 v5, s[8:11], s88 offen offset:384 nt lds
    v_cndmask_b32_dpp v147, v143, v151, vcc row_ror:8 row_mask:0xf bank_mask:0xf
    v_smfmac_f32_16x16x64_bf16 v[168:171], a[224:227], v[204:211], v37
    s_waitcnt vmcnt(6)
    buffer_store_dwordx4 v[144:147], v6, s[12:15], s59 offen offset:128 sc1
    v_mov_b32_dpp v140, v148 row_ror:8 row_mask:0xf bank_mask:0xc
    v_smfmac_f32_16x16x64_bf16 v[172:175], a[192:195], v[196:203], v33 abid:1
    v_mov_b32_dpp v141, v149 row_ror:8 row_mask:0xf bank_mask:0xc
    v_smfmac_f32_16x16x64_bf16 v[172:175], a[228:231], v[204:211], v37 abid:1
    v_mov_b32_dpp v142, v150 row_ror:8 row_mask:0xf bank_mask:0xc
    v_smfmac_f32_16x16x64_bf16 v[176:179], a[196:199], v[196:203], v34
    v_mov_b32_dpp v143, v151 row_ror:8 row_mask:0xf bank_mask:0xc
    v_smfmac_f32_16x16x64_bf16 v[176:179], a[232:235], v[204:211], v38
    s_waitcnt vmcnt(5)
    buffer_store_dwordx4 v[140:143], v6, s[12:15], s24 offen offset:128 sc1
    ds_read_b128 v[144:147], v9 offset:10560
    v_smfmac_f32_16x16x64_bf16 v[180:183], a[200:203], v[196:203], v34 abid:1
    ds_read_b128 v[148:151], v9 offset:10624
    ds_read_b128 v[140:143], v9 offset:10496
    v_add_u32 v4, s31, v4
    v_smfmac_f32_16x16x64_bf16 v[180:183], a[236:239], v[204:211], v38 abid:1
    v_add_u32 v1, s31, v1
    v_smfmac_f32_16x16x64_bf16 v[184:187], a[204:207], v[196:203], v35
    v_add_u32 v2, s31, v2
    v_smfmac_f32_16x16x64_bf16 v[184:187], a[240:243], v[204:211], v39
    v_smfmac_f32_16x16x64_bf16 v[188:191], a[208:211], v[196:203], v35 abid:1
    v_smfmac_f32_16x16x64_bf16 v[188:191], a[244:247], v[204:211], v39 abid:1
    v_smfmac_f32_16x16x64_bf16 v[192:195], a[212:215], v[196:203], v50 abid:1
    v_smfmac_f32_16x16x64_bf16 v[192:195], a[248:251], v[204:211], v51
    s_waitcnt vmcnt(8)
    s_branch M_top1
M_q:
    s_mov_b32 s21, 3
    v_smfmac_f32_16x16x64_bf16 v[144:147], v[72:75], v[220:227], v42 abid:1
    ds_read_b128 v[212:215], v1 offset:20480
    v_smfmac_f32_16x16x64_bf16 v[144:147], v[108:111], v[228:235], v46 abid:1
    ds_read_b128 v[216:219], v2 offset:20480
    v_smfmac_f32_16x16x64_bf16 v[148:151], v[76:79], v[220:227], v43
    v_smfmac_f32_16x16x64_bf16 v[148:151], v[112:115], v[228:235], v47
    v_smfmac_f32_16x16x64_bf16 v[152:155], v[80:83], v[220:227], v43 abid:1
    v_smfmac_f32_16x16x64_bf16 v[152:155], v[116:119], v[228:235], v47 abid:1
    s_waitcnt lgkmcnt(2)
    v_xad_u32 v236, v236, v3, v4
    v_smfmac_f32_16x16x64_bf16 v[152:155], v[240:243], v[244:251], v10
    v_xad_u32 v237, v237, v3, v4
    v_smfmac_f32_16x16x64_bf16 v[188:191], v[240:243], v[244:251], v10 abid:1
    s_cmp_gt_u32 s46, s80
    s_cbranch_scc1 M_slow
M_slowrQ:
    v_xad_u32 v238, v238, v3, v4
    v_smfmac_f32_16x16x64_bf16 v[128:131], v[56:59], v[220:227], v40 abid:1
    ds_read2st64_b32 v[244:245], v236 offset0:0 offset1:72
    ds_read_b128 v[240:243], v8 offset:5120
    v_xad_u32 v239, v239, v3, v4
    v_smfmac_f32_16x16x64_bf16 v[128:131], v[92:95], v[228:235], v44 abid:1
    ds_read2st64_b32 v[246:247], v237 offset0:0 offset1:72
    v_smfmac_f32_16x16x64_bf16 v[160:163], a[0:3], v[196:203], v12
    ds_read2st64_b32 v[248:249], v238 offset0:0 offset1:72
    v_smfmac_f32_16x16x64_bf16 v[160:163], a[36:39], v[204:211], v16
    ds_read2st64_b32 v[250:251], v239 offset0:0 offset1:72
    ds_read_b128 v[236:239], v9 offset:9600
    s_waitcnt lgkmcnt(6)
    v_smfmac_f32_16x16x64_bf16 v[160:163], a[72:75], v[212:219], v20
    v_smfmac_f32_16x16x64_bf16 v[164:167], a[4:7], v[196:203], v12 abid:1
    v_cvt_pk_bf16_f32 v156, v156, v157
    v_smfmac_f32_16x16x64_bf16 v[164:167], a[40:43], v[204:211], v16 abid:1
    v_cvt_pk_bf16_f32 v157, v158, v159
    v_smfmac_f32_16x16x64_bf16 v[164:167], a[76:79], v[212:219], v20 abid:1
    ds_write_b64 v53, v[156:157] offset:25728
    ds_read_b128 v[156:159], v9 offset:10752
    v_smfmac_f32_16x16x64_bf16 v[180:183], a[20:23], v[196:203], v14 abid:1
    v_smfmac_f32_16x16x64_bf16 v[180:183], a[56:59], v[204:211], v18 abid:1
    ds_read_b128 v[220:223], v1 offset:21504
    v_cvt_pk_bf16_f32 v124, v124, v125
    v_smfmac_f32_16x16x64_bf16 v[180:183], a[92:95], v[212:219], v22 abid:1
    s_waitcnt lgkmcnt(3)
    v_xad_u32 v236, v236, v3, v4
    v_smfmac_f32_16x16x64_bf16 v[180:183], v[240:243], v[244:251], v10 abid:1
    v_xad_u32 v237, v237, v3, v4
    v_smfmac_f32_16x16x64_bf16 v[144:147], v[240:243], v[244:251], v10
    ds_read2st64_b32 v[244:245], v236 offset0:0 offset1:72
    ds_read_b128 v[240:243], v8 offset:6144
    v_xad_u32 v238, v238, v3, v4
    v_smfmac_f32_16x16x64_bf16 v[172:175], a[12:15], v[196:203], v13 abid:1
    ds_read2st64_b32 v[246:247], v237 offset0:0 offset1:72
    v_xad_u32 v239, v239, v3, v4
    v_smfmac_f32_16x16x64_bf16 v[172:175], a[48:51], v[204:211], v17 abid:1
    ds_read2st64_b32 v[248:249], v238 offset0:0 offset1:72
    v_cvt_pk_bf16_f32 v125, v126, v127
    v_smfmac_f32_16x16x64_bf16 v[172:175], a[84:87], v[212:219], v21 abid:1
    ds_read2st64_b32 v[250:251], v239 offset0:0 offset1:72
    ds_read_b128 v[236:239], v9 offset:9472
    v_cvt_pk_bf16_f32 v126, v128, v129
    v_smfmac_f32_16x16x64_bf16 v[176:179], a[16:19], v[196:203], v14
    v_cvt_pk_bf16_f32 v127, v130, v131
    v_smfmac_f32_16x16x64_bf16 v[176:179], a[52:55], v[204:211], v18
    v_cvt_pk_bf16_f32 v132, v132, v133
    v_smfmac_f32_16x16x64_bf16 v[176:179], a[88:91], v[212:219], v22
    v_cvt_pk_bf16_f32 v133, v134, v135
    v_smfmac_f32_16x16x64_bf16 v[168:171], a[8:11], v[196:203], v13
    v_cvt_pk_bf16_f32 v134, v136, v137
    v_smfmac_f32_16x16x64_bf16 v[168:171], a[44:47], v[204:211], v17
    v_cvt_pk_bf16_f32 v135, v138, v139
    v_smfmac_f32_16x16x64_bf16 v[168:171], a[80:83], v[212:219], v21
    ds_read_b128 v[224:227], v2 offset:21504
    ds_read_b128 v[136:139], v9 offset:10432
    v_cndmask_b32_dpp v128, v124, v132, vcc row_ror:8 row_mask:0xf bank_mask:0xf
    v_smfmac_f32_16x16x64_bf16 v[184:187], a[24:27], v[196:203], v15
    ds_read_b128 v[228:231], v1 offset:22528
    v_cndmask_b32_dpp v129, v125, v133, vcc row_ror:8 row_mask:0xf bank_mask:0xf
    v_smfmac_f32_16x16x64_bf16 v[184:187], a[60:63], v[204:211], v19
    ds_read_b128 v[232:235], v2 offset:22528
    v_cndmask_b32_dpp v130, v126, v134, vcc row_ror:8 row_mask:0xf bank_mask:0xf
    v_smfmac_f32_16x16x64_bf16 v[184:187], a[96:99], v[212:219], v23
    s_waitcnt lgkmcnt(4)
    v_xad_u32 v236, v236, v3, v4
    v_smfmac_f32_16x16x64_bf16 v[184:187], v[240:243], v[244:251], v10 abid:1
    v_xad_u32 v237, v237, v3, v4
    v_smfmac_f32_16x16x64_bf16 v[148:151], v[240:243], v[244:251], v10
    ds_read2st64_b32 v[244:245], v236 offset0:0 offset1:72
    ds_read_b128 v[240:243], v8 offset:4096
    v_xad_u32 v238, v238, v3, v4
    v_smfmac_f32_16x16x64_bf16 v[188:191], a[28:31], v[196:203], v15 abid:1
    ds_read2st64_b32 v[246:247], v237 offset0:0 offset1:72
    v_xad_u32 v239, v239, v3, v4
    v_smfmac_f32_16x16x64_bf16 v[188:191], a[64:67], v[204:211], v19 abid:1
    ds_read2st64_b32 v[248:249], v238 offset0:0 offset1:72
    v_cndmask_b32_dpp v131, v127, v135, vcc row_ror:8 row_mask:0xf bank_mask:0xf
    v_smfmac_f32_16x16x64_bf16 v[188:191], a[100:103], v[212:219], v23 abid:1
    ds_read2st64_b32 v[250:251], v239 offset0:0 offset1:72
    buffer_store_dwordx4 v[128:131], v6, s[12:15], s59 offen offset:0 sc1
    v_smfmac_f32_16x16x64_bf16 v[192:195], a[32:35], v[196:203], v48
    v_mov_b32_dpp v124, v132 row_ror:8 row_mask:0xf bank_mask:0xc
    v_smfmac_f32_16x16x64_bf16 v[192:195], a[68:71], v[204:211], v48 abid:1
    v_mov_b32_dpp v125, v133 row_ror:8 row_mask:0xf bank_mask:0xc
    v_smfmac_f32_16x16x64_bf16 v[192:195], a[104:107], v[212:219], v49
    s_waitcnt lgkmcnt(8)
    v_mov_b32_dpp v126, v134 row_ror:8 row_mask:0xf bank_mask:0xc
    v_smfmac_f32_16x16x64_bf16 v[160:163], a[108:111], v[220:227], v24
    s_waitcnt lgkmcnt(5)
    v_mov_b32_dpp v127, v135 row_ror:8 row_mask:0xf bank_mask:0xc
    v_smfmac_f32_16x16x64_bf16 v[160:163], a[144:147], v[228:235], v28
    ds_read_b128 v[196:199], v1 offset:23552
    buffer_store_dwordx4 v[124:127], v6, s[12:15], s24 offen offset:0 sc1
    v_smfmac_f32_16x16x64_bf16 v[164:167], a[112:115], v[220:227], v24 abid:1
    ds_read_b128 v[200:203], v2 offset:23552
    ds_read_b128 v[128:131], v9 offset:10304
    ds_read_b128 v[132:135], v9 offset:10368
    v_smfmac_f32_16x16x64_bf16 v[164:167], a[148:151], v[228:235], v28 abid:1
    ds_read_b128 v[204:207], v1 offset:24576
    ds_read_b128 v[124:127], v9 offset:10240
    v_smfmac_f32_16x16x64_bf16 v[176:179], a[124:127], v[220:227], v26
    ds_read_b128 v[208:211], v2 offset:24576
    v_smfmac_f32_16x16x64_bf16 v[176:179], a[160:163], v[228:235], v30
    s_waitcnt lgkmcnt(7)
    v_smfmac_f32_16x16x64_bf16 v[176:179], v[240:243], v[244:251], v10 abid:1
    v_smfmac_f32_16x16x64_bf16 v[140:143], v[240:243], v[244:251], v10
    v_smfmac_f32_16x16x64_bf16 v[172:175], a[120:123], v[220:227], v25 abid:1
    s_add_u32 s28, s28, 36864
    s_cmp_ge_u32 s28, 110592
    s_cselect_b32 s28, s26, s28
    v_smfmac_f32_16x16x64_bf16 v[172:175], a[156:159], v[228:235], v29 abid:1
    s_add_u32 s30, s25, 36864
    s_cmp_eq_u32 s30, 110592
    s_cselect_b32 s30, 0, s30
    v_smfmac_f32_16x16x64_bf16 v[168:171], a[116:119], v[220:227], v25
    s_sub_u32 s31, s30, s25
    s_mov_b32 s25, s30
    s_mov_b32 s90, s22
    v_smfmac_f32_16x16x64_bf16 v[168:171], a[152:155], v[228:235], v29
    s_mov_b32 s22, s88
    s_add_u32 s91, s91, 1
    s_cmp_lt_u32 s20, 2
    v_smfmac_f32_16x16x64_bf16 v[180:183], a[128:131], v[220:227], v26 abid:1
    s_cselect_b32 s66, s23, s24
    s_add_u32 s66, s66, s95
    v_smfmac_f32_16x16x64_bf16 v[180:183], a[164:167], v[228:235], v30 abid:1
    v_cvt_pk_bf16_f32 v140, v140, v141
    v_smfmac_f32_16x16x64_bf16 v[184:187], a[132:135], v[220:227], v27
    v_cvt_pk_bf16_f32 v141, v142, v143
    v_smfmac_f32_16x16x64_bf16 v[184:187], a[168:171], v[228:235], v31
    v_cvt_pk_bf16_f32 v142, v144, v145
    v_smfmac_f32_16x16x64_bf16 v[188:191], a[136:139], v[220:227], v27 abid:1
    v_cvt_pk_bf16_f32 v143, v146, v147
    v_smfmac_f32_16x16x64_bf16 v[188:191], a[172:175], v[228:235], v31 abid:1
    v_cvt_pk_bf16_f32 v148, v148, v149
    v_smfmac_f32_16x16x64_bf16 v[192:195], a[140:143], v[220:227], v49 abid:1
    v_cvt_pk_bf16_f32 v149, v150, v151
    v_smfmac_f32_16x16x64_bf16 v[192:195], a[176:179], v[228:235], v50
    ds_read_b128 v[220:223], v1 offset:25600
    s_waitcnt lgkmcnt(6)
    v_cvt_pk_bf16_f32 v150, v152, v153
    v_smfmac_f32_16x16x64_bf16 v[160:163], a[180:183], v[196:203], v32
    ds_read_b128 v[224:227], v2 offset:25600
    s_waitcnt lgkmcnt(2)
    v_cvt_pk_bf16_f32 v151, v154, v155
    v_smfmac_f32_16x16x64_bf16 v[160:163], a[216:219], v[204:211], v36
    ds_read_b128 v[228:231], v1 offset:26624
    ds_read_b128 v[152:155], v9 offset:10688
    v_cndmask_b32_dpp v144, v140, v148, vcc row_ror:8 row_mask:0xf bank_mask:0xf
    v_smfmac_f32_16x16x64_bf16 v[164:167], a[184:187], v[196:203], v32 abid:1
    ds_read_b128 v[232:235], v2 offset:26624
    v_cndmask_b32_dpp v145, v141, v149, vcc row_ror:8 row_mask:0xf bank_mask:0xf
    v_smfmac_f32_16x16x64_bf16 v[164:167], a[220:223], v[204:211], v36 abid:1
    v_cndmask_b32_dpp v146, v142, v150, vcc row_ror:8 row_mask:0xf bank_mask:0xf
    v_smfmac_f32_16x16x64_bf16 v[168:171], a[188:191], v[196:203], v33
    v_cndmask_b32_dpp v147, v143, v151, vcc row_ror:8 row_mask:0xf bank_mask:0xf
    v_smfmac_f32_16x16x64_bf16 v[168:171], a[224:227], v[204:211], v37
    buffer_store_dwordx4 v[144:147], v6, s[12:15], s59 offen offset:128 sc1
    v_mov_b32_dpp v140, v148 row_ror:8 row_mask:0xf bank_mask:0xc
    v_smfmac_f32_16x16x64_bf16 v[172:175], a[192:195], v[196:203], v33 abid:1
    v_mov_b32_dpp v141, v149 row_ror:8 row_mask:0xf bank_mask:0xc
    v_smfmac_f32_16x16x64_bf16 v[172:175], a[228:231], v[204:211], v37 abid:1
    v_mov_b32_dpp v142, v150 row_ror:8 row_mask:0xf bank_mask:0xc
    v_smfmac_f32_16x16x64_bf16 v[176:179], a[196:199], v[196:203], v34
    v_mov_b32_dpp v143, v151 row_ror:8 row_mask:0xf bank_mask:0xc
    v_smfmac_f32_16x16x64_bf16 v[176:179], a[232:235], v[204:211], v38
    buffer_store_dwordx4 v[140:143], v6, s[12:15], s24 offen offset:128 sc1
    ds_read_b128 v[144:147], v9 offset:10560
    v_smfmac_f32_16x16x64_bf16 v[180:183], a[200:203], v[196:203], v34 abid:1
    ds_read_b128 v[148:151], v9 offset:10624
    ds_read_b128 v[140:143], v9 offset:10496
    v_add_u32 v4, s31, v4
    v_smfmac_f32_16x16x64_bf16 v[180:183], a[236:239], v[204:211], v38 abid:1
    v_add_u32 v1, s31, v1
    v_smfmac_f32_16x16x64_bf16 v[184:187], a[204:207], v[196:203], v35
    v_add_u32 v2, s31, v2
    v_smfmac_f32_16x16x64_bf16 v[184:187], a[240:243], v[204:211], v39
    v_smfmac_f32_16x16x64_bf16 v[188:191], a[208:211], v[196:203], v35 abid:1
    v_smfmac_f32_16x16x64_bf16 v[188:191], a[244:247], v[204:211], v39 abid:1
    v_smfmac_f32_16x16x64_bf16 v[192:195], a[212:215], v[196:203], v50 abid:1
    v_smfmac_f32_16x16x64_bf16 v[192:195], a[248:251], v[204:211], v51
    s_waitcnt vmcnt(4)
    s_branch M_top1
M_bF:
    v_smfmac_f32_16x16x64_bf16 v[164:167], v[56:59], v[220:227], v40 abid:1
    ds_read_b128 v[204:207], v1 offset:1024
    v_smfmac_f32_16x16x64_bf16 v[164:167], v[92:95], v[228:235], v44 abid:1
    ds_read_b128 v[208:211], v2 offset:1024
    v_smfmac_f32_16x16x64_bf16 v[168:171], v[60:63], v[220:227], v41
    ds_read_b128 v[212:215], v1 offset:2048
    v_smfmac_f32_16x16x64_bf16 v[168:171], v[96:99], v[228:235], v45
    ds_read_b128 v[216:219], v2 offset:2048
    v_smfmac_f32_16x16x64_bf16 v[172:175], v[64:67], v[220:227], v41 abid:1
    s_waitcnt lgkmcnt(6)
    buffer_store_dwordx4 v[244:247], v7, s[12:15], s66 offen sc1
    v_smfmac_f32_16x16x64_bf16 v[172:175], v[100:103], v[228:235], v45 abid:1
    ds_read_b128 v[236:239], v9 offset:9408
    v_smfmac_f32_16x16x64_bf16 v[176:179], v[68:71], v[220:227], v42
    s_mov_b32 s21, 4
    v_smfmac_f32_16x16x64_bf16 v[176:179], v[104:107], v[228:235], v46
    v_smfmac_f32_16x16x64_bf16 v[180:183], v[72:75], v[220:227], v42 abid:1
    v_cvt_pk_bf16_f32 v160, v160, v161
    v_smfmac_f32_16x16x64_bf16 v[180:183], v[108:111], v[228:235], v46 abid:1
    v_cvt_pk_bf16_f32 v161, v162, v163
    v_smfmac_f32_16x16x64_bf16 v[184:187], v[76:79], v[220:227], v43
    v_cvt_pk_bf16_f32 v162, v164, v165
    v_smfmac_f32_16x16x64_bf16 v[184:187], v[112:115], v[228:235], v47
    v_cvt_pk_bf16_f32 v163, v166, v167
    v_smfmac_f32_16x16x64_bf16 v[188:191], v[80:83], v[220:227], v43 abid:1
    v_cvt_pk_bf16_f32 v168, v168, v169
    v_smfmac_f32_16x16x64_bf16 v[188:191], v[116:119], v[228:235], v47 abid:1
    v_cvt_pk_bf16_f32 v169, v170, v171
    v_smfmac_f32_16x16x64_bf16 v[192:195], v[84:87], v[220:227], v51 abid:1
    v_cvt_pk_bf16_f32 v170, v172, v173
    v_smfmac_f32_16x16x64_bf16 v[192:195], v[120:123], v[228:235], v52
    ds_read_b128 v[220:223], v1 offset:3072
    s_waitcnt lgkmcnt(6)
    v_cvt_pk_bf16_f32 v171, v174, v175
    v_smfmac_f32_16x16x64_bf16 v[124:127], a[0:3], v[196:203], v12
    ds_read_b128 v[224:227], v2 offset:3072
    ds_read_b128 v[172:175], v9 offset:10432
    s_waitcnt lgkmcnt(6)
    v_cndmask_b32_dpp v164, v160, v168, vcc row_ror:8 row_mask:0xf bank_mask:0xf
    v_smfmac_f32_16x16x64_bf16 v[124:127], a[36:39], v[204:211], v16
    ds_read_b128 v[228:231], v1 offset:4096
    s_waitcnt lgkmcnt(5)
    v_cndmask_b32_dpp v165, v161, v169, vcc row_ror:8 row_mask:0xf bank_mask:0xf
    v_smfmac_f32_16x16x64_bf16 v[124:127], a[72:75], v[212:219], v20
    ds_read_b128 v[232:235], v2 offset:4096
    s_waitcnt lgkmcnt(5)
    v_xad_u32 v236, v236, v3, v4
    v_smfmac_f32_16x16x64_bf16 v[156:159], a[32:35], v[196:203], v48
    s_barrier
    v_xad_u32 v237, v237, v3, v4
    v_smfmac_f32_16x16x64_bf16 v[156:159], a[68:71], v[204:211], v48 abid:1
    ds_read2st64_b32 v[244:245], v236 offset0:0 offset1:72
    ds_read_b128 v[240:243], v8 offset:3072
    v_xad_u32 v238, v238, v3, v4
    v_smfmac_f32_16x16x64_bf16 v[156:159], a[104:107], v[212:219], v49
    ds_read2st64_b32 v[246:247], v237 offset0:0 offset1:72
    v_xad_u32 v239, v239, v3, v4
    v_smfmac_f32_16x16x64_bf16 v[132:135], a[8:11], v[196:203], v13
    ds_read2st64_b32 v[248:249], v238 offset0:0 offset1:72
    v_cndmask_b32_dpp v166, v162, v170, vcc row_ror:8 row_mask:0xf bank_mask:0xf
    v_smfmac_f32_16x16x64_bf16 v[132:135], a[44:47], v[204:211], v17
    ds_read2st64_b32 v[250:251], v239 offset0:0 offset1:72
    ds_read_b128 v[236:239], v9 offset:9280
    v_cndmask_b32_dpp v167, v163, v171, vcc row_ror:8 row_mask:0xf bank_mask:0xf
    v_smfmac_f32_16x16x64_bf16 v[132:135], a[80:83], v[212:219], v21
    buffer_store_dwordx4 v[164:167], v6, s[12:15], s58 offen offset:0 sc1
    v_mov_b32_dpp v160, v168 row_ror:8 row_mask:0xf bank_mask:0xc
    v_smfmac_f32_16x16x64_bf16 v[140:143], a[16:19], v[196:203], v14
    v_mov_b32_dpp v161, v169 row_ror:8 row_mask:0xf bank_mask:0xc
    v_smfmac_f32_16x16x64_bf16 v[140:143], a[52:55], v[204:211], v18
    v_mov_b32_dpp v162, v170 row_ror:8 row_mask:0xf bank_mask:0xc
    v_smfmac_f32_16x16x64_bf16 v[140:143], a[88:91], v[212:219], v22
    v_mov_b32_dpp v163, v171 row_ror:8 row_mask:0xf bank_mask:0xc
    v_smfmac_f32_16x16x64_bf16 v[136:139], a[12:15], v[196:203], v13 abid:1
    buffer_store_dwordx4 v[160:163], v6, s[12:15], s23 offen offset:0 sc1
    ds_read_b128 v[164:167], v9 offset:10304
    ds_read_b128 v[168:171], v9 offset:10368
    v_smfmac_f32_16x16x64_bf16 v[136:139], a[48:51], v[204:211], v17 abid:1
    ds_read_b128 v[160:163], v9 offset:10240
    v_smfmac_f32_16x16x64_bf16 v[136:139], a[84:87], v[212:219], v21 abid:1
    s_waitcnt lgkmcnt(3)
    v_xad_u32 v236, v236, v3, v4
    v_smfmac_f32_16x16x64_bf16 v[136:139], v[240:243], v[244:251], v10
    v_xad_u32 v237, v237, v3, v4
    v_smfmac_f32_16x16x64_bf16 v[172:175], v[240:243], v[244:251], v10 abid:1
    ds_read2st64_b32 v[244:245], v236 offset0:0 offset1:72
    ds_read_b128 v[240:243], v8 offset:1024
    v_xad_u32 v238, v238, v3, v4
    v_smfmac_f32_16x16x64_bf16 v[144:147], a[20:23], v[196:203], v14 abid:1
    ds_read2st64_b32 v[246:247], v237 offset0:0 offset1:72
    v_xad_u32 v239, v239, v3, v4
    v_smfmac_f32_16x16x64_bf16 v[144:147], a[56:59], v[204:211], v18 abid:1
    ds_read2st64_b32 v[248:249], v238 offset0:0 offset1:72
    v_smfmac_f32_16x16x64_bf16 v[144:147], a[92:95], v[212:219], v22 abid:1
    ds_read2st64_b32 v[250:251], v239 offset0:0 offset1:72
    ds_read_b128 v[236:239], v9 offset:9344
    v_smfmac_f32_16x16x64_bf16 v[148:151], a[24:27], v[196:203], v15
    v_cvt_pk_bf16_f32 v192, v192, v193
    v_smfmac_f32_16x16x64_bf16 v[148:151], a[60:63], v[204:211], v19
    v_cvt_pk_bf16_f32 v193, v194, v195
    v_smfmac_f32_16x16x64_bf16 v[148:151], a[96:99], v[212:219], v23
    ds_write_b64 v53, v[192:193] offset:0
    ds_read_b128 v[192:195], v9 offset:10752
    v_smfmac_f32_16x16x64_bf16 v[152:155], a[28:31], v[196:203], v15 abid:1
    v_smfmac_f32_16x16x64_bf16 v[152:155], a[64:67], v[204:211], v19 abid:1
    v_smfmac_f32_16x16x64_bf16 v[152:155], a[100:103], v[212:219], v23 abid:1
    v_smfmac_f32_16x16x64_bf16 v[128:131], a[4:7], v[196:203], v12 abid:1
    v_smfmac_f32_16x16x64_bf16 v[128:131], a[40:43], v[204:211], v16 abid:1
    v_smfmac_f32_16x16x64_bf16 v[128:131], a[76:79], v[212:219], v20 abid:1
    s_waitcnt lgkmcnt(2)
    v_xad_u32 v236, v236, v3, v4
    v_smfmac_f32_16x16x64_bf16 v[128:131], v[240:243], v[244:251], v10
    v_xad_u32 v237, v237, v3, v4
    v_smfmac_f32_16x16x64_bf16 v[164:167], v[240:243], v[244:251], v10 abid:1
    ds_read2st64_b32 v[244:245], v236 offset0:0 offset1:72
    ds_read_b128 v[240:243], v8 offset:2048
    v_xad_u32 v238, v238, v3, v4
    v_smfmac_f32_16x16x64_bf16 v[124:127], a[108:111], v[220:227], v24
    ds_read2st64_b32 v[246:247], v237 offset0:0 offset1:72
    v_xad_u32 v239, v239, v3, v4
    v_smfmac_f32_16x16x64_bf16 v[124:127], a[144:147], v[228:235], v28
    ds_read2st64_b32 v[248:249], v238 offset0:0 offset1:72
    ds_read_b64 v[216:217], v9 offset:10056
    v_cvt_pk_bf16_f32 v176, v176, v177
    v_smfmac_f32_16x16x64_bf16 v[128:131], a[112:115], v[220:227], v24 abid:1
    ds_read2st64_b32 v[250:251], v239 offset0:0 offset1:72
    ds_read_b128 v[236:239], v9 offset:9216
    v_cvt_pk_bf16_f32 v177, v178, v179
    v_smfmac_f32_16x16x64_bf16 v[128:131], a[148:151], v[228:235], v28 abid:1
    v_cvt_pk_bf16_f32 v178, v180, v181
    v_smfmac_f32_16x16x64_bf16 v[140:143], a[124:127], v[220:227], v26
    v_cvt_pk_bf16_f32 v179, v182, v183
    v_smfmac_f32_16x16x64_bf16 v[140:143], a[160:163], v[228:235], v30
    v_cvt_pk_bf16_f32 v184, v184, v185
    v_smfmac_f32_16x16x64_bf16 v[136:139], a[120:123], v[220:227], v25 abid:1
    v_cvt_pk_bf16_f32 v185, v186, v187
    v_smfmac_f32_16x16x64_bf16 v[136:139], a[156:159], v[228:235], v29 abid:1
    ds_read_b128 v[196:199], v1 offset:5120
    v_cvt_pk_bf16_f32 v186, v188, v189
    v_smfmac_f32_16x16x64_bf16 v[132:135], a[116:119], v[220:227], v25
    ds_read_b128 v[200:203], v2 offset:5120
    v_cvt_pk_bf16_f32 v187, v190, v191
    v_smfmac_f32_16x16x64_bf16 v[132:135], a[152:155], v[228:235], v29
    ds_read_b128 v[188:191], v9 offset:10688
    s_waitcnt lgkmcnt(3)
    v_xad_u32 v236, v236, v3, v4
    v_smfmac_f32_16x16x64_bf16 v[132:135], v[240:243], v[244:251], v10
    ds_read_b128 v[204:207], v1 offset:6144
    v_xad_u32 v237, v237, v3, v4
    v_smfmac_f32_16x16x64_bf16 v[168:171], v[240:243], v[244:251], v10 abid:1
    ds_read2st64_b32 v[244:245], v236 offset0:0 offset1:72
    ds_read_b128 v[240:243], v8 offset:0
    v_xad_u32 v238, v238, v3, v4
    v_smfmac_f32_16x16x64_bf16 v[144:147], a[128:131], v[220:227], v26 abid:1
    ds_read2st64_b32 v[246:247], v237 offset0:0 offset1:72
    v_xad_u32 v239, v239, v3, v4
    v_smfmac_f32_16x16x64_bf16 v[144:147], a[164:167], v[228:235], v30 abid:1
    ds_read2st64_b32 v[248:249], v238 offset0:0 offset1:72
    ds_read_b128 v[208:211], v2 offset:6144
    v_cndmask_b32_dpp v180, v176, v184, vcc row_ror:8 row_mask:0xf bank_mask:0xf
    v_smfmac_f32_16x16x64_bf16 v[148:151], a[132:135], v[220:227], v27
    ds_read2st64_b32 v[250:251], v239 offset0:0 offset1:72
    ds_read_b128 v[236:239], v9 offset:9728
    v_cndmask_b32_dpp v181, v177, v185, vcc row_ror:8 row_mask:0xf bank_mask:0xf
    v_smfmac_f32_16x16x64_bf16 v[148:151], a[168:171], v[228:235], v31
    v_xad_u32 v212, v216, v3, v4
    v_smfmac_f32_16x16x64_bf16 v[152:155], a[136:139], v[220:227], v27 abid:1
    ds_read2st64_b32 v[212:213], v212 offset0:0 offset1:72
    v_xad_u32 v214, v217, v3, v4
    v_smfmac_f32_16x16x64_bf16 v[152:155], a[172:175], v[228:235], v31 abid:1
    ds_read2st64_b32 v[214:215], v214 offset0:0 offset1:72
    v_cndmask_b32_dpp v182, v178, v186, vcc row_ror:8 row_mask:0xf bank_mask:0xf
    v_smfmac_f32_16x16x64_bf16 v[156:159], a[140:143], v[220:227], v49 abid:1
    v_cndmask_b32_dpp v183, v179, v187, vcc row_ror:8 row_mask:0xf bank_mask:0xf
    v_smfmac_f32_16x16x64_bf16 v[156:159], a[176:179], v[228:235], v50
    buffer_store_dwordx4 v[180:183], v6, s[12:15], s58 offen offset:128 sc1
    s_waitcnt lgkmcnt(11)
    v_mov_b32_dpp v176, v184 row_ror:8 row_mask:0xf bank_mask:0xc
    v_smfmac_f32_16x16x64_bf16 v[128:131], a[184:187], v[196:203], v32 abid:1
    s_waitcnt lgkmcnt(4)
    v_mov_b32_dpp v177, v185 row_ror:8 row_mask:0xf bank_mask:0xc
    v_smfmac_f32_16x16x64_bf16 v[128:131], a[220:223], v[204:211], v36 abid:1
    v_mov_b32_dpp v178, v186 row_ror:8 row_mask:0xf bank_mask:0xc
    v_smfmac_f32_16x16x64_bf16 v[124:127], a[180:183], v[196:203], v32
    ds_read_b128 v[220:223], v1 offset:7168
    v_mov_b32_dpp v179, v187 row_ror:8 row_mask:0xf bank_mask:0xc
    v_smfmac_f32_16x16x64_bf16 v[124:127], a[216:219], v[204:211], v36
    buffer_store_dwordx4 v[176:179], v6, s[12:15], s23 offen offset:128 sc1
    s_waitcnt lgkmcnt(3)
    v_xad_u32 v236, v236, v3, v4
    v_smfmac_f32_16x16x64_bf16 v[124:127], v[240:243], v[244:251], v10
    ds_read_b128 v[224:227], v2 offset:7168
    ds_read_b128 v[180:183], v9 offset:10560
    v_xad_u32 v237, v237, v3, v4
    v_smfmac_f32_16x16x64_bf16 v[160:163], v[240:243], v[244:251], v10 abid:1
    ds_read2st64_b32 v[244:245], v236 offset0:0 offset1:72
    ds_read_b128 v[240:243], v8 offset:8192
    v_xad_u32 v238, v238, v3, v4
    v_smfmac_f32_16x16x64_bf16 v[132:135], a[188:191], v[196:203], v33
    ds_read2st64_b32 v[246:247], v237 offset0:0 offset1:72
    ds_read_b128 v[184:187], v9 offset:10624
    v_xad_u32 v239, v239, v3, v4
    v_smfmac_f32_16x16x64_bf16 v[132:135], a[224:227], v[204:211], v37
    ds_read2st64_b32 v[248:249], v238 offset0:0 offset1:72
    ds_read_b128 v[176:179], v9 offset:10496
    v_smfmac_f32_16x16x64_bf16 v[136:139], a[192:195], v[196:203], v33 abid:1
    ds_read2st64_b32 v[250:251], v239 offset0:0 offset1:72
    ds_read_b128 v[236:239], v9 offset:9664
    v_smfmac_f32_16x16x64_bf16 v[136:139], a[228:231], v[204:211], v37 abid:1
    v_smfmac_f32_16x16x64_bf16 v[140:143], a[196:199], v[196:203], v34
    v_smfmac_f32_16x16x64_bf16 v[140:143], a[232:235], v[204:211], v38
    ds_read_b128 v[228:231], v1 offset:8192
    v_smfmac_f32_16x16x64_bf16 v[144:147], a[200:203], v[196:203], v34 abid:1
    ds_read_b128 v[232:235], v2 offset:8192
    v_smfmac_f32_16x16x64_bf16 v[144:147], a[236:239], v[204:211], v38 abid:1
    s_waitcnt lgkmcnt(4)
    s_cmp_lt_i32 s81, 0
    s_cbranch_scc1 M_ovrF
    s_swappc_b64 s[78:79], s[72:73]
M_ovrF:
    v_smfmac_f32_16x16x64_bf16 v[156:159], a[212:215], v[196:203], v50 abid:1
    v_smfmac_f32_16x16x64_bf16 v[156:159], a[248:251], v[204:211], v51
    s_waitcnt lgkmcnt(2)
    v_xad_u32 v236, v236, v3, v4
    v_smfmac_f32_16x16x64_bf16 v[156:159], v[240:243], v[244:251], v10
    v_xad_u32 v237, v237, v3, v4
    v_smfmac_f32_16x16x64_bf16 v[192:195], v[240:243], v[244:251], v10 abid:1
    ds_read2st64_b32 v[244:245], v236 offset0:0 offset1:72
    ds_read_b128 v[240:243], v8 offset:7168
    v_xad_u32 v238, v238, v3, v4
    v_smfmac_f32_16x16x64_bf16 v[152:155], a[208:211], v[196:203], v35 abid:1
    ds_read2st64_b32 v[246:247], v237 offset0:0 offset1:72
    v_xad_u32 v239, v239, v3, v4
    v_smfmac_f32_16x16x64_bf16 v[152:155], a[244:247], v[204:211], v39 abid:1
    ds_read2st64_b32 v[248:249], v238 offset0:0 offset1:72
    v_smfmac_f32_16x16x64_bf16 v[148:151], a[204:207], v[196:203], v35
    ds_read2st64_b32 v[250:251], v239 offset0:0 offset1:72
    ds_read_b128 v[236:239], v9 offset:9536
    v_smfmac_f32_16x16x64_bf16 v[148:151], a[240:243], v[204:211], v39
    v_smfmac_f32_16x16x64_bf16 v[124:127], a[252:255], v[220:227], v40
    s_waitcnt lgkmcnt(6)
    v_smfmac_f32_16x16x64_bf16 v[124:127], v[88:91], v[228:235], v44
    v_smfmac_f32_16x16x64_bf16 v[128:131], v[56:59], v[220:227], v40 abid:1
    v_smfmac_f32_16x16x64_bf16 v[128:131], v[92:95], v[228:235], v44 abid:1
    s_cmp_lt_u32 s20, 2
    s_cselect_b32 s66, s23, s24
    s_add_u32 s66, s66, s95
    v_smfmac_f32_16x16x64_bf16 v[132:135], v[60:63], v[220:227], v41
    ds_read_b128 v[196:199], v1 offset:18432
    s_add_u32 s23, s24, 18432
    s_add_u32 s58, s24, 27648
    v_smfmac_f32_16x16x64_bf16 v[132:135], v[96:99], v[228:235], v45
    ds_read_b128 v[200:203], v2 offset:18432
    s_add_u32 s67, s23, s95
    v_smfmac_f32_16x16x64_bf16 v[152:155], v[80:83], v[220:227], v43 abid:1
    ds_read_b128 v[204:207], v1 offset:19456
    v_smfmac_f32_16x16x64_bf16 v[152:155], v[116:119], v[228:235], v47 abid:1
    s_waitcnt lgkmcnt(3)
    v_xad_u32 v236, v236, v3, v4
    v_smfmac_f32_16x16x64_bf16 v[152:155], v[240:243], v[244:251], v10
    ds_read_b128 v[208:211], v2 offset:19456
    v_xad_u32 v237, v237, v3, v4
    v_smfmac_f32_16x16x64_bf16 v[188:191], v[240:243], v[244:251], v10 abid:1
    s_cmp_gt_u32 s46, s80
    s_cbranch_scc1 M_slow
M_slowrF:
    v_xad_u32 v238, v238, v3, v4
    v_smfmac_f32_16x16x64_bf16 v[140:143], v[68:71], v[220:227], v42
    ds_read2st64_b32 v[244:245], v236 offset0:0 offset1:72
    ds_read_b128 v[240:243], v8 offset:5120
    v_xad_u32 v239, v239, v3, v4
    v_smfmac_f32_16x16x64_bf16 v[140:143], v[104:107], v[228:235], v46
    ds_read2st64_b32 v[246:247], v237 offset0:0 offset1:72
    v_smfmac_f32_16x16x64_bf16 v[156:159], v[84:87], v[220:227], v51 abid:1
    ds_read2st64_b32 v[248:249], v238 offset0:0 offset1:72
    ds_read_b128 v[212:215], v1 offset:20480
    v_smfmac_f32_16x16x64_bf16 v[156:159], v[120:123], v[228:235], v52
    ds_read2st64_b32 v[250:251], v239 offset0:0 offset1:72
    ds_read_b128 v[236:239], v9 offset:9600
    v_smfmac_f32_16x16x64_bf16 v[148:151], v[76:79], v[220:227], v43
    ds_read_b128 v[216:219], v2 offset:20480
    v_smfmac_f32_16x16x64_bf16 v[148:151], v[112:115], v[228:235], v47
    v_smfmac_f32_16x16x64_bf16 v[136:139], v[64:67], v[220:227], v41 abid:1
    v_smfmac_f32_16x16x64_bf16 v[136:139], v[100:103], v[228:235], v45 abid:1
    v_smfmac_f32_16x16x64_bf16 v[144:147], v[72:75], v[220:227], v42 abid:1
    v_smfmac_f32_16x16x64_bf16 v[144:147], v[108:111], v[228:235], v46 abid:1
    ds_read_b128 v[220:223], v1 offset:21504
    s_waitcnt lgkmcnt(2)
    v_xad_u32 v236, v236, v3, v4
    v_smfmac_f32_16x16x64_bf16 v[144:147], v[240:243], v[244:251], v10
    ds_read_b128 v[224:227], v2 offset:21504
    v_xad_u32 v237, v237, v3, v4
    v_smfmac_f32_16x16x64_bf16 v[180:183], v[240:243], v[244:251], v10 abid:1
    ds_read2st64_b32 v[244:245], v236 offset0:0 offset1:72
    ds_read_b128 v[240:243], v8 offset:6144
    v_xad_u32 v238, v238, v3, v4
    v_smfmac_f32_16x16x64_bf16 v[192:195], a[32:35], v[196:203], v48
    ds_read2st64_b32 v[246:247], v237 offset0:0 offset1:72
    ds_read_b128 v[228:231], v1 offset:22528
    v_xad_u32 v239, v239, v3, v4
    v_smfmac_f32_16x16x64_bf16 v[192:195], a[68:71], v[204:211], v48 abid:1
    ds_read2st64_b32 v[248:249], v238 offset0:0 offset1:72
    ds_read_b128 v[232:235], v2 offset:22528
    s_waitcnt lgkmcnt(8)
    v_cvt_pk_bf16_f32 v124, v124, v125
    v_smfmac_f32_16x16x64_bf16 v[192:195], a[104:107], v[212:219], v49
    ds_read2st64_b32 v[250:251], v239 offset0:0 offset1:72
    ds_read_b128 v[236:239], v9 offset:9472
    v_cvt_pk_bf16_f32 v125, v126, v127
    v_smfmac_f32_16x16x64_bf16 v[160:163], a[0:3], v[196:203], v12
    v_cvt_pk_bf16_f32 v126, v128, v129
    v_smfmac_f32_16x16x64_bf16 v[160:163], a[36:39], v[204:211], v16
    v_cvt_pk_bf16_f32 v127, v130, v131
    v_smfmac_f32_16x16x64_bf16 v[160:163], a[72:75], v[212:219], v20
    v_cvt_pk_bf16_f32 v156, v156, v157
    v_smfmac_f32_16x16x64_bf16 v[164:167], a[4:7], v[196:203], v12 abid:1
    v_cvt_pk_bf16_f32 v157, v158, v159
    v_smfmac_f32_16x16x64_bf16 v[164:167], a[40:43], v[204:211], v16 abid:1
    ds_write_b64 v53, v[156:157] offset:25728
    v_cvt_pk_bf16_f32 v132, v132, v133
    v_smfmac_f32_16x16x64_bf16 v[164:167], a[76:79], v[212:219], v20 abid:1
    v_cvt_pk_bf16_f32 v133, v134, v135
    v_smfmac_f32_16x16x64_bf16 v[168:171], a[8:11], v[196:203], v13
    v_cvt_pk_bf16_f32 v134, v136, v137
    v_smfmac_f32_16x16x64_bf16 v[168:171], a[44:47], v[204:211], v17
    v_cvt_pk_bf16_f32 v135, v138, v139
    v_smfmac_f32_16x16x64_bf16 v[168:171], a[80:83], v[212:219], v21
    s_waitcnt lgkmcnt(1)
    v_xad_u32 v236, v236, v3, v4
    v_smfmac_f32_16x16x64_bf16 v[184:187], v[240:243], v[244:251], v10 abid:1
    v_xad_u32 v237, v237, v3, v4
    v_smfmac_f32_16x16x64_bf16 v[148:151], v[240:243], v[244:251], v10
    ds_read2st64_b32 v[244:245], v236 offset0:0 offset1:72
    ds_read_b128 v[240:243], v8 offset:4096
    v_xad_u32 v238, v238, v3, v4
    v_smfmac_f32_16x16x64_bf16 v[172:175], a[12:15], v[196:203], v13 abid:1
    ds_read2st64_b32 v[246:247], v237 offset0:0 offset1:72
    v_xad_u32 v239, v239, v3, v4
    v_smfmac_f32_16x16x64_bf16 v[172:175], a[48:51], v[204:211], v17 abid:1
    ds_read2st64_b32 v[248:249], v238 offset0:0 offset1:72
    v_cndmask_b32_dpp v128, v124, v132, vcc row_ror:8 row_mask:0xf bank_mask:0xf
    v_smfmac_f32_16x16x64_bf16 v[172:175], a[84:87], v[212:219], v21 abid:1
    ds_read2st64_b32 v[250:251], v239 offset0:0 offset1:72
    ds_read_b128 v[196:199], v1 offset:23552
    v_cndmask_b32_dpp v129, v125, v133, vcc row_ror:8 row_mask:0xf bank_mask:0xf
    v_smfmac_f32_16x16x64_bf16 v[192:195], a[140:143], v[220:227], v49 abid:1
    ds_read_b128 v[200:203], v2 offset:23552
    v_cndmask_b32_dpp v130, v126, v134, vcc row_ror:8 row_mask:0xf bank_mask:0xf
    v_smfmac_f32_16x16x64_bf16 v[192:195], a[176:179], v[228:235], v50
    ds_read_b128 v[204:207], v1 offset:24576
    v_cndmask_b32_dpp v131, v127, v135, vcc row_ror:8 row_mask:0xf bank_mask:0xf
    v_smfmac_f32_16x16x64_bf16 v[160:163], a[108:111], v[220:227], v24
    ds_read_b128 v[208:211], v2 offset:24576
    buffer_store_dwordx4 v[128:131], v6, s[12:15], s59 offen offset:0 sc1
    v_mov_b32_dpp v124, v132 row_ror:8 row_mask:0xf bank_mask:0xc
    v_smfmac_f32_16x16x64_bf16 v[160:163], a[144:147], v[228:235], v28
    s_waitcnt lgkmcnt(9)
    s_barrier
    ds_read_b128 v[236:239], v8 offset:10816
    v_mov_b32_dpp v125, v133 row_ror:8 row_mask:0xf bank_mask:0xc
    v_smfmac_f32_16x16x64_bf16 v[164:167], a[112:115], v[220:227], v24 abid:1
    ds_read_b128 v[212:215], v1 offset:20480
    v_mov_b32_dpp v126, v134 row_ror:8 row_mask:0xf bank_mask:0xc
    v_smfmac_f32_16x16x64_bf16 v[164:167], a[148:151], v[228:235], v28 abid:1
    ds_read_b128 v[216:219], v2 offset:20480
    v_mov_b32_dpp v127, v135 row_ror:8 row_mask:0xf bank_mask:0xc
    v_smfmac_f32_16x16x64_bf16 v[168:171], a[116:119], v[220:227], v25
    buffer_store_dwordx4 v[124:127], v6, s[12:15], s24 offen offset:0 sc1
    v_smfmac_f32_16x16x64_bf16 v[168:171], a[152:155], v[228:235], v29
    s_waitcnt lgkmcnt(7)
    v_smfmac_f32_16x16x64_bf16 v[176:179], v[240:243], v[244:251], v10 abid:1
    v_smfmac_f32_16x16x64_bf16 v[140:143], v[240:243], v[244:251], v10
    s_waitcnt lgkmcnt(2)
    buffer_store_dwordx4 v[236:239], v7, s[12:15], s66 offen sc1
    v_smfmac_f32_16x16x64_bf16 v[172:175], a[120:123], v[220:227], v25 abid:1
    v_smfmac_f32_16x16x64_bf16 v[172:175], a[156:159], v[228:235], v29 abid:1
    ds_read_b128 v[220:223], v1 offset:25600
    v_smfmac_f32_16x16x64_bf16 v[192:195], a[212:215], v[196:203], v50 abid:1
    ds_read_b128 v[224:227], v2 offset:25600
    s_nop 0
    v_cvt_pk_bf16_f32 v140, v140, v141
    v_smfmac_f32_16x16x64_bf16 v[192:195], a[248:251], v[204:211], v51
    ds_read_b128 v[228:231], v1 offset:26624
    v_cvt_pk_bf16_f32 v141, v142, v143
    v_smfmac_f32_16x16x64_bf16 v[160:163], a[180:183], v[196:203], v32
    ds_read_b128 v[232:235], v2 offset:26624
    v_cvt_pk_bf16_f32 v142, v144, v145
    v_smfmac_f32_16x16x64_bf16 v[160:163], a[216:219], v[204:211], v36
    v_cvt_pk_bf16_f32 v143, v146, v147
    v_smfmac_f32_16x16x64_bf16 v[164:167], a[184:187], v[196:203], v32 abid:1
    v_cvt_pk_bf16_f32 v148, v148, v149
    v_smfmac_f32_16x16x64_bf16 v[164:167], a[220:223], v[204:211], v36 abid:1
    v_cvt_pk_bf16_f32 v149, v150, v151
    v_smfmac_f32_16x16x64_bf16 v[168:171], a[188:191], v[196:203], v33
    v_cvt_pk_bf16_f32 v150, v152, v153
    v_smfmac_f32_16x16x64_bf16 v[168:171], a[224:227], v[204:211], v37
    v_cvt_pk_bf16_f32 v151, v154, v155
    v_smfmac_f32_16x16x64_bf16 v[172:175], a[192:195], v[196:203], v33 abid:1
    v_cndmask_b32_dpp v144, v140, v148, vcc row_ror:8 row_mask:0xf bank_mask:0xf
    v_smfmac_f32_16x16x64_bf16 v[172:175], a[228:231], v[204:211], v37 abid:1
    ds_read_b128 v[196:199], v1 offset:18432
    s_waitcnt lgkmcnt(3)
    v_cndmask_b32_dpp v145, v141, v149, vcc row_ror:8 row_mask:0xf bank_mask:0xf
    v_smfmac_f32_16x16x64_bf16 v[192:195], v[84:87], v[220:227], v51 abid:1
    ds_read_b128 v[200:203], v2 offset:18432
    s_waitcnt lgkmcnt(2)
    v_cndmask_b32_dpp v146, v142, v150, vcc row_ror:8 row_mask:0xf bank_mask:0xf
    v_smfmac_f32_16x16x64_bf16 v[192:195], v[120:123], v[228:235], v52
    ds_read_b128 v[204:207], v1 offset:19456
    v_cndmask_b32_dpp v147, v143, v151, vcc row_ror:8 row_mask:0xf bank_mask:0xf
    v_smfmac_f32_16x16x64_bf16 v[160:163], a[252:255], v[220:227], v40
    ds_read_b128 v[208:211], v2 offset:19456
    buffer_store_dwordx4 v[144:147], v6, s[12:15], s59 offen offset:128 sc1
    v_mov_b32_dpp v140, v148 row_ror:8 row_mask:0xf bank_mask:0xc
    v_smfmac_f32_16x16x64_bf16 v[160:163], v[88:91], v[228:235], v44
    v_mov_b32_dpp v141, v149 row_ror:8 row_mask:0xf bank_mask:0xc
    v_smfmac_f32_16x16x64_bf16 v[164:167], v[56:59], v[220:227], v40 abid:1
    v_mov_b32_dpp v142, v150 row_ror:8 row_mask:0xf bank_mask:0xc
    v_smfmac_f32_16x16x64_bf16 v[164:167], v[92:95], v[228:235], v44 abid:1
    v_mov_b32_dpp v143, v151 row_ror:8 row_mask:0xf bank_mask:0xc
    v_smfmac_f32_16x16x64_bf16 v[168:171], v[60:63], v[220:227], v41
    buffer_store_dwordx4 v[140:143], v6, s[12:15], s24 offen offset:128 sc1
    v_cvt_pk_bf16_f32 v192, v192, v193
    v_smfmac_f32_16x16x64_bf16 v[168:171], v[96:99], v[228:235], v45
    v_cvt_pk_bf16_f32 v193, v194, v195
    v_smfmac_f32_16x16x64_bf16 v[172:175], v[64:67], v[220:227], v41 abid:1
    ds_write_b64 v53, v[192:193] offset:1024
    v_smfmac_f32_16x16x64_bf16 v[172:175], v[100:103], v[228:235], v45 abid:1
    ds_read_b128 v[220:223], v1 offset:21504
    s_waitcnt lgkmcnt(4)
    v_smfmac_f32_16x16x64_bf16 v[176:179], a[16:19], v[196:203], v14
    ds_read_b128 v[224:227], v2 offset:21504
    s_waitcnt lgkmcnt(3)
    v_smfmac_f32_16x16x64_bf16 v[176:179], a[52:55], v[204:211], v18
    ds_read_b128 v[228:231], v1 offset:22528
    v_smfmac_f32_16x16x64_bf16 v[176:179], a[88:91], v[212:219], v22
    ds_read_b128 v[232:235], v2 offset:22528
    s_waitcnt lgkmcnt(4)
    s_barrier
    ds_read_b128 v[236:239], v8 offset:11840
    v_smfmac_f32_16x16x64_bf16 v[180:183], a[20:23], v[196:203], v14 abid:1
    v_cvt_pk_bf16_f32 v160, v160, v161
    v_smfmac_f32_16x16x64_bf16 v[180:183], a[56:59], v[204:211], v18 abid:1
    v_cvt_pk_bf16_f32 v161, v162, v163
    v_smfmac_f32_16x16x64_bf16 v[180:183], a[92:95], v[212:219], v22 abid:1
    v_cvt_pk_bf16_f32 v162, v164, v165
    v_smfmac_f32_16x16x64_bf16 v[184:187], a[24:27], v[196:203], v15
    v_cvt_pk_bf16_f32 v163, v166, v167
    v_smfmac_f32_16x16x64_bf16 v[184:187], a[60:63], v[204:211], v19
    v_cvt_pk_bf16_f32 v168, v168, v169
    v_smfmac_f32_16x16x64_bf16 v[184:187], a[96:99], v[212:219], v23
    s_cmp_lt_u32 s20, 2
    s_waitcnt lgkmcnt(0)
    s_cbranch_scc0 M_fx
    buffer_store_dwordx4 v[236:239], v7, s[12:15], s67 offen sc1
M_fx:
    v_smfmac_f32_16x16x64_bf16 v[188:191], a[28:31], v[196:203], v15 abid:1
    v_cvt_pk_bf16_f32 v169, v170, v171
    v_smfmac_f32_16x16x64_bf16 v[188:191], a[64:67], v[204:211], v19 abid:1
    v_cvt_pk_bf16_f32 v170, v172, v173
    v_smfmac_f32_16x16x64_bf16 v[188:191], a[100:103], v[212:219], v23 abid:1
    ds_read_b128 v[196:199], v1 offset:23552
    v_cvt_pk_bf16_f32 v171, v174, v175
    v_smfmac_f32_16x16x64_bf16 v[176:179], a[124:127], v[220:227], v26
    ds_read_b128 v[200:203], v2 offset:23552
    v_cndmask_b32_dpp v164, v160, v168, vcc row_ror:8 row_mask:0xf bank_mask:0xf
    v_smfmac_f32_16x16x64_bf16 v[176:179], a[160:163], v[228:235], v30
    ds_read_b128 v[204:207], v1 offset:24576
    v_cndmask_b32_dpp v165, v161, v169, vcc row_ror:8 row_mask:0xf bank_mask:0xf
    v_smfmac_f32_16x16x64_bf16 v[180:183], a[128:131], v[220:227], v26 abid:1
    ds_read_b128 v[208:211], v2 offset:24576
    v_cndmask_b32_dpp v166, v162, v170, vcc row_ror:8 row_mask:0xf bank_mask:0xf
    v_smfmac_f32_16x16x64_bf16 v[180:183], a[164:167], v[228:235], v30 abid:1
    v_cndmask_b32_dpp v167, v163, v171, vcc row_ror:8 row_mask:0xf bank_mask:0xf
    v_smfmac_f32_16x16x64_bf16 v[184:187], a[132:135], v[220:227], v27
    buffer_store_dwordx4 v[164:167], v6, s[12:15], s58 offen offset:0 sc1
    v_mov_b32_dpp v160, v168 row_ror:8 row_mask:0xf bank_mask:0xc
    v_smfmac_f32_16x16x64_bf16 v[184:187], a[168:171], v[228:235], v31
    v_mov_b32_dpp v161, v169 row_ror:8 row_mask:0xf bank_mask:0xc
    v_smfmac_f32_16x16x64_bf16 v[188:191], a[136:139], v[220:227], v27 abid:1
    v_mov_b32_dpp v162, v170 row_ror:8 row_mask:0xf bank_mask:0xc
    v_smfmac_f32_16x16x64_bf16 v[188:191], a[172:175], v[228:235], v31 abid:1
    ds_read_b128 v[220:223], v1 offset:25600
    s_waitcnt lgkmcnt(3)
    v_mov_b32_dpp v163, v171 row_ror:8 row_mask:0xf bank_mask:0xc
    v_smfmac_f32_16x16x64_bf16 v[176:179], a[196:199], v[196:203], v34
    ds_read_b128 v[224:227], v2 offset:25600
    buffer_store_dwordx4 v[160:163], v6, s[12:15], s23 offen offset:0 sc1
    s_waitcnt lgkmcnt(2)
    v_smfmac_f32_16x16x64_bf16 v[176:179], a[232:235], v[204:211], v38
    ds_read_b128 v[228:231], v1 offset:26624
    v_smfmac_f32_16x16x64_bf16 v[180:183], a[200:203], v[196:203], v34 abid:1
    ds_read_b128 v[232:235], v2 offset:26624
    v_smfmac_f32_16x16x64_bf16 v[180:183], a[236:239], v[204:211], v38 abid:1
    v_smfmac_f32_16x16x64_bf16 v[184:187], a[204:207], v[196:203], v35
    v_smfmac_f32_16x16x64_bf16 v[184:187], a[240:243], v[204:211], v39
    v_smfmac_f32_16x16x64_bf16 v[188:191], a[208:211], v[196:203], v35 abid:1
    v_smfmac_f32_16x16x64_bf16 v[188:191], a[244:247], v[204:211], v39 abid:1
    s_waitcnt lgkmcnt(2)
    v_smfmac_f32_16x16x64_bf16 v[176:179], v[68:71], v[220:227], v42
    s_waitcnt lgkmcnt(0)
    v_smfmac_f32_16x16x64_bf16 v[176:179], v[104:107], v[228:235], v46
    v_smfmac_f32_16x16x64_bf16 v[180:183], v[72:75], v[220:227], v42 abid:1
    v_smfmac_f32_16x16x64_bf16 v[180:183], v[108:111], v[228:235], v46 abid:1
    v_smfmac_f32_16x16x64_bf16 v[184:187], v[76:79], v[220:227], v43
    v_smfmac_f32_16x16x64_bf16 v[184:187], v[112:115], v[228:235], v47
    v_smfmac_f32_16x16x64_bf16 v[188:191], v[80:83], v[220:227], v43 abid:1
    v_smfmac_f32_16x16x64_bf16 v[188:191], v[116:119], v[228:235], v47 abid:1
    s_nop 1
    v_cvt_pk_bf16_f32 v176, v176, v177
    v_cvt_pk_bf16_f32 v177, v178, v179
    v_cvt_pk_bf16_f32 v178, v180, v181
    v_cvt_pk_bf16_f32 v179, v182, v183
    v_cvt_pk_bf16_f32 v184, v184, v185
    v_cvt_pk_bf16_f32 v185, v186, v187
    v_cvt_pk_bf16_f32 v186, v188, v189
    v_cvt_pk_bf16_f32 v187, v190, v191
    v_cndmask_b32_dpp v180, v176, v184, vcc row_ror:8 row_mask:0xf bank_mask:0xf
    v_cndmask_b32_dpp v181, v177, v185, vcc row_ror:8 row_mask:0xf bank_mask:0xf
    v_cndmask_b32_dpp v182, v178, v186, vcc row_ror:8 row_mask:0xf bank_mask:0xf
    v_cndmask_b32_dpp v183, v179, v187, vcc row_ror:8 row_mask:0xf bank_mask:0xf
    buffer_store_dwordx4 v[180:183], v6, s[12:15], s58 offen offset:128 sc1
    v_mov_b32_dpp v176, v184 row_ror:8 row_mask:0xf bank_mask:0xc
    v_mov_b32_dpp v177, v185 row_ror:8 row_mask:0xf bank_mask:0xc
    v_mov_b32_dpp v178, v186 row_ror:8 row_mask:0xf bank_mask:0xc
    v_mov_b32_dpp v179, v187 row_ror:8 row_mask:0xf bank_mask:0xc
    buffer_store_dwordx4 v[176:179], v6, s[12:15], s23 offen offset:128 sc1
M_done:
M_end:
    s_endpgm
M_pf_spin:
    s_sleep 4
    v_mov_b32 v0, 0
    s_mov_b64 exec, 1
    buffer_atomic_add v0, off, s[16:19], s96 sc0 sc1
    s_mov_b64 exec, -1
    s_add_u32 s31, s31, 1
    s_waitcnt vmcnt(0)
    v_readfirstlane_b32 s30, v0
    s_nop 0
    s_sub_u32 s30, s30, s100
    s_cmp_eq_u32 s30, 27
    s_cbranch_scc1 M_pf_ok
    s_cmp_lt_u32 s31, 6
    s_cbranch_scc1 M_pf_spin
    s_cmp_eq_u32 s98, 0
    s_cbranch_scc1 M_pf_spin2
    s_mov_b32 s98, 0
    v_mov_b32 v250, 1
    s_mov_b64 exec, 1
    buffer_atomic_add v250, off, s[68:71], 0 offset:0 sc1
    s_mov_b64 exec, -1
    s_nop 3
M_pf_spin2:
    buffer_load_dword v0, off, s[68:71], 0 offset:0 sc1
    s_cmp_ge_u32 s31, 131072
    s_cbranch_scc1 M_end
    s_waitcnt vmcnt(0)
    v_readfirstlane_b32 s30, v0
    s_nop 0
    s_cmp_eq_u32 s30, 81
    s_cbranch_scc0 M_pf_spin
    s_branch M_pf_ok
M_r3:
    v_bfe_u32 v110, v96, 24, 4
    v_lshlrev_b32 v111, 1, v96
    v_lshl_add_u32 v110, v110, 2, s49
    v_and_b32 v111, 16, v111
    v_and_or_b32 v110, v96, 2.0, v110
    v_lshlrev_b32 v111, v111, 1
    ds_add_rtn_u32 v100, v110, v111
    v_and_b32 v110, 8, v96
    v_lshrrev_b32 v113, 14, v96
    v_cmp_ne_u32 s[44:45], 0, v110
    v_and_b32 v116, 0x3cf0, v113
    s_waitcnt lgkmcnt(0)
    v_lshrrev_b32 v111, 16, v100
    v_and_b32 v112, 0xffff, v100
    v_sub_u32 v110, 15, v111
    v_and_b32 v100, 2.0, v96
    v_add3_u32 v100, v112, v111, v100
    v_cndmask_b32 v110, v112, v110, s[44:45]
    v_cmp_gt_u32 s[44:45], 16, v100
    v_cmp_gt_u32 s[36:37], 2.0, v100
    v_lshlrev_b32 v110, 2, v110
    v_lshrrev_b64 v[112:113], v110, s[50:51]
    s_andn2_b64 s[36:37], s[36:37], s[44:45]
    v_lshrrev_b64 v[114:115], v110, s[52:53]
    v_bfe_u32 v110, v96, 24, 4
    v_mbcnt_lo_u32_b32 v111, s36, 0
    v_and_b32 v112, 15, v112
    v_mbcnt_hi_u32_b32 v111, s37, v111
    v_and_b32 v114, 15, v114
    v_lshl_add_u32 v111, v111, 3, s40
    v_lshl_add_u32 v112, v110, 4, v112
    v_min_u32 v111, s41, v111
    v_mul_u32_u24 v114, 68, v114
    v_cndmask_b32 v111, v118, v111, s[36:37]
    ds_write_b64 v111, v[96:97]
    s_bcnt1_i32_b64 s30, s[36:37]
    s_lshl3_add_u32 s40, s30, s40
    v_lshl_add_u32 v112, v112, 2, s47
    v_and_b32 v114, 0x30c, v114
    v_cndmask_b32 v112, v118, v112, s[44:45]
    v_add3_u32 v113, v116, v114, s29
    v_and_b32 v114, 0x3fff, v96
    v_cndmask_b32 v110, v118, v113, s[44:45]
    ds_write_b32 v112, v114
    ds_write_b32 v110, v97
    s_cmp_gt_u32 s38, s39
    s_cselect_b32 s32, 1, s32
    s_branch M_r3r
M_dn:
    s_mov_b32 s27, 0
    s_mov_b32 s46, 0x80000000
    v_mov_b32 v244, 0
    v_mov_b32 v245, 0
    v_mov_b32 v246, 0
    v_mov_b32 v247, 0
    ds_write_b128 v8, v[244:247] offset:0
    ds_write_b128 v8, v[244:247] offset:1024
    ds_write_b128 v8, v[244:247] offset:2048
    ds_write_b128 v8, v[244:247] offset:3072
    ds_write_b128 v8, v[244:247] offset:4096
    ds_write_b128 v8, v[244:247] offset:5120
    ds_write_b128 v8, v[244:247] offset:6144
    ds_write_b128 v8, v[244:247] offset:7168
    ds_write_b128 v8, v[244:247] offset:8192
    s_waitcnt lgkmcnt(0)
    s_branch M_dnr
M_ovc0:
    v_smfmac_f32_16x16x32_bf16 v[124:127], v[54:55], v[212:215], v10
    v_smfmac_f32_16x16x32_bf16 v[160:163], v[54:55], v[212:215], v10 abid:2
    s_setpc_b64 s[74:75]
    v_smfmac_f32_16x16x32_bf16 v[128:131], v[54:55], v[212:215], v10
    v_smfmac_f32_16x16x32_bf16 v[164:167], v[54:55], v[212:215], v10 abid:2
    s_setpc_b64 s[74:75]
    v_smfmac_f32_16x16x32_bf16 v[132:135], v[54:55], v[212:215], v10
    v_smfmac_f32_16x16x32_bf16 v[168:171], v[54:55], v[212:215], v10 abid:2
    s_setpc_b64 s[74:75]
    v_smfmac_f32_16x16x32_bf16 v[136:139], v[54:55], v[212:215], v10
    v_smfmac_f32_16x16x32_bf16 v[172:175], v[54:55], v[212:215], v10 abid:2
    s_setpc_b64 s[74:75]
    v_smfmac_f32_16x16x32_bf16 v[140:143], v[54:55], v[212:215], v10
    v_smfmac_f32_16x16x32_bf16 v[176:179], v[54:55], v[212:215], v10 abid:2
    s_setpc_b64 s[74:75]
    v_smfmac_f32_16x16x32_bf16 v[144:147], v[54:55], v[212:215], v10
    v_smfmac_f32_16x16x32_bf16 v[180:183], v[54:55], v[212:215], v10 abid:2
    s_setpc_b64 s[74:75]
    v_smfmac_f32_16x16x32_bf16 v[148:151], v[54:55], v[212:215], v10
    v_smfmac_f32_16x16x32_bf16 v[184:187], v[54:55], v[212:215], v10 abid:2
    s_setpc_b64 s[74:75]
    v_smfmac_f32_16x16x32_bf16 v[152:155], v[54:55], v[212:215], v10
    v_smfmac_f32_16x16x32_bf16 v[188:191], v[54:55], v[212:215], v10 abid:2
    s_setpc_b64 s[74:75]
    v_smfmac_f32_16x16x32_bf16 v[156:159], v[54:55], v[212:215], v10
    v_smfmac_f32_16x16x32_bf16 v[192:195], v[54:55], v[212:215], v10 abid:2
    s_setpc_b64 s[74:75]
M_ovl0:
    v_smfmac_f32_16x16x32_bf16 v[124:127], v[54:55], v[212:215], v10
    v_smfmac_f32_16x16x32_bf16 v[160:163], v[54:55], v[212:215], v10 abid:2
    s_setpc_b64 s[78:79]
    v_smfmac_f32_16x16x32_bf16 v[128:131], v[54:55], v[212:215], v10
    v_smfmac_f32_16x16x32_bf16 v[164:167], v[54:55], v[212:215], v10 abid:2
    s_setpc_b64 s[78:79]
    v_smfmac_f32_16x16x32_bf16 v[132:135], v[54:55], v[212:215], v10
    v_smfmac_f32_16x16x32_bf16 v[168:171], v[54:55], v[212:215], v10 abid:2
    s_setpc_b64 s[78:79]
    v_smfmac_f32_16x16x32_bf16 v[136:139], v[54:55], v[212:215], v10
    v_smfmac_f32_16x16x32_bf16 v[172:175], v[54:55], v[212:215], v10 abid:2
    s_setpc_b64 s[78:79]
    v_smfmac_f32_16x16x32_bf16 v[140:143], v[54:55], v[212:215], v10
    v_smfmac_f32_16x16x32_bf16 v[176:179], v[54:55], v[212:215], v10 abid:2
    s_setpc_b64 s[78:79]
    v_smfmac_f32_16x16x32_bf16 v[144:147], v[54:55], v[212:215], v10
    v_smfmac_f32_16x16x32_bf16 v[180:183], v[54:55], v[212:215], v10 abid:2
    s_setpc_b64 s[78:79]
    v_smfmac_f32_16x16x32_bf16 v[148:151], v[54:55], v[212:215], v10
    v_smfmac_f32_16x16x32_bf16 v[184:187], v[54:55], v[212:215], v10 abid:2
    s_setpc_b64 s[78:79]
    v_smfmac_f32_16x16x32_bf16 v[152:155], v[54:55], v[212:215], v10
    v_smfmac_f32_16x16x32_bf16 v[188:191], v[54:55], v[212:215], v10 abid:2
    s_setpc_b64 s[78:79]
    v_smfmac_f32_16x16x32_bf16 v[156:159], v[54:55], v[212:215], v10
    v_smfmac_f32_16x16x32_bf16 v[192:195], v[54:55], v[212:215], v10 abid:2
    s_setpc_b64 s[78:79]
M_ovc1:
    v_smfmac_f32_16x16x32_bf16 v[124:127], v[252:253], v[212:215], v10
    v_smfmac_f32_16x16x32_bf16 v[160:163], v[252:253], v[212:215], v10 abid:2
    s_setpc_b64 s[76:77]
    v_smfmac_f32_16x16x32_bf16 v[128:131], v[252:253], v[212:215], v10
    v_smfmac_f32_16x16x32_bf16 v[164:167], v[252:253], v[212:215], v10 abid:2
    s_setpc_b64 s[76:77]
    v_smfmac_f32_16x16x32_bf16 v[132:135], v[252:253], v[212:215], v10
    v_smfmac_f32_16x16x32_bf16 v[168:171], v[252:253], v[212:215], v10 abid:2
    s_setpc_b64 s[76:77]
    v_smfmac_f32_16x16x32_bf16 v[136:139], v[252:253], v[212:215], v10
    v_smfmac_f32_16x16x32_bf16 v[172:175], v[252:253], v[212:215], v10 abid:2
    s_setpc_b64 s[76:77]
    v_smfmac_f32_16x16x32_bf16 v[140:143], v[252:253], v[212:215], v10
    v_smfmac_f32_16x16x32_bf16 v[176:179], v[252:253], v[212:215], v10 abid:2
    s_setpc_b64 s[76:77]
    v_smfmac_f32_16x16x32_bf16 v[144:147], v[252:253], v[212:215], v10
    v_smfmac_f32_16x16x32_bf16 v[180:183], v[252:253], v[212:215], v10 abid:2
    s_setpc_b64 s[76:77]
    v_smfmac_f32_16x16x32_bf16 v[148:151], v[252:253], v[212:215], v10
    v_smfmac_f32_16x16x32_bf16 v[184:187], v[252:253], v[212:215], v10 abid:2
    s_setpc_b64 s[76:77]
    v_smfmac_f32_16x16x32_bf16 v[152:155], v[252:253], v[212:215], v10
    v_smfmac_f32_16x16x32_bf16 v[188:191], v[252:253], v[212:215], v10 abid:2
    s_setpc_b64 s[76:77]
    v_smfmac_f32_16x16x32_bf16 v[156:159], v[252:253], v[212:215], v10
    v_smfmac_f32_16x16x32_bf16 v[192:195], v[252:253], v[212:215], v10 abid:2
    s_setpc_b64 s[76:77]
M_ovl1:
    v_smfmac_f32_16x16x32_bf16 v[124:127], v[252:253], v[212:215], v10
    v_smfmac_f32_16x16x32_bf16 v[160:163], v[252:253], v[212:215], v10 abid:2
    s_setpc_b64 s[78:79]
    v_smfmac_f32_16x16x32_bf16 v[128:131], v[252:253], v[212:215], v10
    v_smfmac_f32_16x16x32_bf16 v[164:167], v[252:253], v[212:215], v10 abid:2
    s_setpc_b64 s[78:79]
    v_smfmac_f32_16x16x32_bf16 v[132:135], v[252:253], v[212:215], v10
    v_smfmac_f32_16x16x32_bf16 v[168:171], v[252:253], v[212:215], v10 abid:2
    s_setpc_b64 s[78:79]
    v_smfmac_f32_16x16x32_bf16 v[136:139], v[252:253], v[212:215], v10
    v_smfmac_f32_16x16x32_bf16 v[172:175], v[252:253], v[212:215], v10 abid:2
    s_setpc_b64 s[78:79]
    v_smfmac_f32_16x16x32_bf16 v[140:143], v[252:253], v[212:215], v10
    v_smfmac_f32_16x16x32_bf16 v[176:179], v[252:253], v[212:215], v10 abid:2
    s_setpc_b64 s[78:79]
    v_smfmac_f32_16x16x32_bf16 v[144:147], v[252:253], v[212:215], v10
    v_smfmac_f32_16x16x32_bf16 v[180:183], v[252:253], v[212:215], v10 abid:2
    s_setpc_b64 s[78:79]
    v_smfmac_f32_16x16x32_bf16 v[148:151], v[252:253], v[212:215], v10
    v_smfmac_f32_16x16x32_bf16 v[184:187], v[252:253], v[212:215], v10 abid:2
    s_setpc_b64 s[78:79]
    v_smfmac_f32_16x16x32_bf16 v[152:155], v[252:253], v[212:215], v10
    v_smfmac_f32_16x16x32_bf16 v[188:191], v[252:253], v[212:215], v10 abid:2
    s_setpc_b64 s[78:79]
    v_smfmac_f32_16x16x32_bf16 v[156:159], v[252:253], v[212:215], v10
    v_smfmac_f32_16x16x32_bf16 v[192:195], v[252:253], v[212:215], v10 abid:2
    s_setpc_b64 s[78:79]
M_ovl2:
    v_smfmac_f32_16x16x32_bf16 v[124:127], v[254:255], v[212:215], v10
    v_smfmac_f32_16x16x32_bf16 v[160:163], v[254:255], v[212:215], v10 abid:2
    s_setpc_b64 s[78:79]
    v_smfmac_f32_16x16x32_bf16 v[128:131], v[254:255], v[212:215], v10
    v_smfmac_f32_16x16x32_bf16 v[164:167], v[254:255], v[212:215], v10 abid:2
    s_setpc_b64 s[78:79]
    v_smfmac_f32_16x16x32_bf16 v[132:135], v[254:255], v[212:215], v10
    v_smfmac_f32_16x16x32_bf16 v[168:171], v[254:255], v[212:215], v10 abid:2
    s_setpc_b64 s[78:79]
    v_smfmac_f32_16x16x32_bf16 v[136:139], v[254:255], v[212:215], v10
    v_smfmac_f32_16x16x32_bf16 v[172:175], v[254:255], v[212:215], v10 abid:2
    s_setpc_b64 s[78:79]
    v_smfmac_f32_16x16x32_bf16 v[140:143], v[254:255], v[212:215], v10
    v_smfmac_f32_16x16x32_bf16 v[176:179], v[254:255], v[212:215], v10 abid:2
    s_setpc_b64 s[78:79]
    v_smfmac_f32_16x16x32_bf16 v[144:147], v[254:255], v[212:215], v10
    v_smfmac_f32_16x16x32_bf16 v[180:183], v[254:255], v[212:215], v10 abid:2
    s_setpc_b64 s[78:79]
    v_smfmac_f32_16x16x32_bf16 v[148:151], v[254:255], v[212:215], v10
    v_smfmac_f32_16x16x32_bf16 v[184:187], v[254:255], v[212:215], v10 abid:2
    s_setpc_b64 s[78:79]
    v_smfmac_f32_16x16x32_bf16 v[152:155], v[254:255], v[212:215], v10
    v_smfmac_f32_16x16x32_bf16 v[188:191], v[254:255], v[212:215], v10 abid:2
    s_setpc_b64 s[78:79]
    v_smfmac_f32_16x16x32_bf16 v[156:159], v[254:255], v[212:215], v10
    v_smfmac_f32_16x16x32_bf16 v[192:195], v[254:255], v[212:215], v10 abid:2
    s_setpc_b64 s[78:79]
M_ovn:
    s_setpc_b64 s[78:79]
M_slow:
    s_bitcmp1_b32 s46, 31
    s_cbranch_scc1 M_dense
    s_mov_b32 s56, s80
M_sl:
    s_lshl_b32 s57, s56, 6
    v_add_u32 v240, s57, v9
    ds_read_b128 v[248:251], v240 offset:9792
    s_waitcnt lgkmcnt(0)
    v_and_b32 v240, 0x3fff, v248
    v_and_b32 v241, 0x3fff, v250
    v_xad_u32 v240, v240, v3, v4
    v_xad_u32 v241, v241, v3, v4
    ds_read2st64_b32 v[244:245], v240 offset0:0 offset1:72
    ds_read2st64_b32 v[246:247], v241 offset0:0 offset1:72
    v_subrev_u32 v240, s29, v8
    v_bfe_u32 v240, v240, 4, 4
    s_waitcnt lgkmcnt(0)
    s_bitcmp1_b32 s27, 0
    s_cbranch_scc0 M_sle0
    v_lshrrev_b32 v242, 18, v248
    v_lshrrev_b32 v243, 18, v250
    v_or_b32 v241, 0, v240
    v_cmp_eq_u32 s[44:45], v242, v241
    v_cmp_eq_u32 s[54:55], v243, v241
    s_nop 0
    v_cndmask_b32 v242, 0, v249, s[44:45]
    v_cndmask_b32 v243, 0, v251, s[54:55]
    s_nop 1
    v_smfmac_f32_16x16x32_bf16 v[124:127], v[242:243], v[244:247], v10
    v_smfmac_f32_16x16x32_bf16 v[160:163], v[242:243], v[244:247], v10 abid:2
M_sle0:
    s_bitcmp1_b32 s27, 1
    s_cbranch_scc0 M_sle1
    v_lshrrev_b32 v242, 18, v248
    v_lshrrev_b32 v243, 18, v250
    v_or_b32 v241, 64, v240
    v_cmp_eq_u32 s[44:45], v242, v241
    v_cmp_eq_u32 s[54:55], v243, v241
    s_nop 0
    v_cndmask_b32 v242, 0, v249, s[44:45]
    v_cndmask_b32 v243, 0, v251, s[54:55]
    s_nop 1
    v_smfmac_f32_16x16x32_bf16 v[128:131], v[242:243], v[244:247], v10
    v_smfmac_f32_16x16x32_bf16 v[164:167], v[242:243], v[244:247], v10 abid:2
M_sle1:
    s_bitcmp1_b32 s27, 2
    s_cbranch_scc0 M_sle2
    v_lshrrev_b32 v242, 18, v248
    v_lshrrev_b32 v243, 18, v250
    v_or_b32 v241, 128, v240
    v_cmp_eq_u32 s[44:45], v242, v241
    v_cmp_eq_u32 s[54:55], v243, v241
    s_nop 0
    v_cndmask_b32 v242, 0, v249, s[44:45]
    v_cndmask_b32 v243, 0, v251, s[54:55]
    s_nop 1
    v_smfmac_f32_16x16x32_bf16 v[132:135], v[242:243], v[244:247], v10
    v_smfmac_f32_16x16x32_bf16 v[168:171], v[242:243], v[244:247], v10 abid:2
M_sle2:
    s_bitcmp1_b32 s27, 3
    s_cbranch_scc0 M_sle3
    v_lshrrev_b32 v242, 18, v248
    v_lshrrev_b32 v243, 18, v250
    v_or_b32 v241, 192, v240
    v_cmp_eq_u32 s[44:45], v242, v241
    v_cmp_eq_u32 s[54:55], v243, v241
    s_nop 0
    v_cndmask_b32 v242, 0, v249, s[44:45]
    v_cndmask_b32 v243, 0, v251, s[54:55]
    s_nop 1
    v_smfmac_f32_16x16x32_bf16 v[136:139], v[242:243], v[244:247], v10
    v_smfmac_f32_16x16x32_bf16 v[172:175], v[242:243], v[244:247], v10 abid:2
M_sle3:
    s_bitcmp1_b32 s27, 4
    s_cbranch_scc0 M_sle4
    v_lshrrev_b32 v242, 18, v248
    v_lshrrev_b32 v243, 18, v250
    v_or_b32 v241, 256, v240
    v_cmp_eq_u32 s[44:45], v242, v241
    v_cmp_eq_u32 s[54:55], v243, v241
    s_nop 0
    v_cndmask_b32 v242, 0, v249, s[44:45]
    v_cndmask_b32 v243, 0, v251, s[54:55]
    s_nop 1
    v_smfmac_f32_16x16x32_bf16 v[140:143], v[242:243], v[244:247], v10
    v_smfmac_f32_16x16x32_bf16 v[176:179], v[242:243], v[244:247], v10 abid:2
M_sle4:
    s_bitcmp1_b32 s27, 5
    s_cbranch_scc0 M_sle5
    v_lshrrev_b32 v242, 18, v248
    v_lshrrev_b32 v243, 18, v250
    v_or_b32 v241, 320, v240
    v_cmp_eq_u32 s[44:45], v242, v241
    v_cmp_eq_u32 s[54:55], v243, v241
    s_nop 0
    v_cndmask_b32 v242, 0, v249, s[44:45]
    v_cndmask_b32 v243, 0, v251, s[54:55]
    s_nop 1
    v_smfmac_f32_16x16x32_bf16 v[144:147], v[242:243], v[244:247], v10
    v_smfmac_f32_16x16x32_bf16 v[180:183], v[242:243], v[244:247], v10 abid:2
M_sle5:
    s_bitcmp1_b32 s27, 6
    s_cbranch_scc0 M_sle6
    v_lshrrev_b32 v242, 18, v248
    v_lshrrev_b32 v243, 18, v250
    v_or_b32 v241, 384, v240
    v_cmp_eq_u32 s[44:45], v242, v241
    v_cmp_eq_u32 s[54:55], v243, v241
    s_nop 0
    v_cndmask_b32 v242, 0, v249, s[44:45]
    v_cndmask_b32 v243, 0, v251, s[54:55]
    s_nop 1
    v_smfmac_f32_16x16x32_bf16 v[148:151], v[242:243], v[244:247], v10
    v_smfmac_f32_16x16x32_bf16 v[184:187], v[242:243], v[244:247], v10 abid:2
M_sle6:
    s_bitcmp1_b32 s27, 7
    s_cbranch_scc0 M_sle7
    v_lshrrev_b32 v242, 18, v248
    v_lshrrev_b32 v243, 18, v250
    v_or_b32 v241, 448, v240
    v_cmp_eq_u32 s[44:45], v242, v241
    v_cmp_eq_u32 s[54:55], v243, v241
    s_nop 0
    v_cndmask_b32 v242, 0, v249, s[44:45]
    v_cndmask_b32 v243, 0, v251, s[54:55]
    s_nop 1
    v_smfmac_f32_16x16x32_bf16 v[152:155], v[242:243], v[244:247], v10
    v_smfmac_f32_16x16x32_bf16 v[188:191], v[242:243], v[244:247], v10 abid:2
M_sle7:
    s_bitcmp1_b32 s27, 8
    s_cbranch_scc0 M_sle8
    v_lshrrev_b32 v242, 18, v248
    v_lshrrev_b32 v243, 18, v250
    v_or_b32 v241, 512, v240
    v_cmp_eq_u32 s[44:45], v242, v241
    v_cmp_eq_u32 s[54:55], v243, v241
    s_nop 0
    v_cndmask_b32 v242, 0, v249, s[44:45]
    v_cndmask_b32 v243, 0, v251, s[54:55]
    s_nop 1
    v_smfmac_f32_16x16x32_bf16 v[156:159], v[242:243], v[244:247], v10
    v_smfmac_f32_16x16x32_bf16 v[192:195], v[242:243], v[244:247], v10 abid:2
M_sle8:
    s_add_u32 s56, s56, 1
    s_cmp_lt_u32 s56, s46
    s_cbranch_scc1 M_sl
M_slx:
    s_nop 7
    s_cmp_eq_u32 s21, 1
    s_cbranch_scc1 M_slowrL
    s_cmp_eq_u32 s21, 2
    s_cbranch_scc1 M_slowrE0
    s_cmp_eq_u32 s21, 3
    s_cbranch_scc1 M_slowrQ
    s_cmp_eq_u32 s21, 4
    s_cbranch_scc1 M_slowrF
    s_branch M_slowr0
M_dense:
    s_mul_i32 s57, s20, 82944
    s_add_u32 s57, s57, 393216
    s_mov_b32 s56, 0
    v_mov_b32 v54, v1
    v_mov_b32 v55, v2
    v_subrev_u32 v252, s29, v8
M_dn0:
    ds_read_b128 v[244:247], v54 offset:0
    ds_read_b128 v[248:251], v55 offset:0
    v_add_u32 v54, 1024, v54
    v_add_u32 v55, 1024, v55
    buffer_load_dwordx4 v[240:243], v252, s[16:19], s57 offen sc1
    s_add_u32 s57, s57, 1024
    s_waitcnt vmcnt(0) lgkmcnt(0)
    v_smfmac_f32_16x16x64_bf16 v[124:127], v[240:243], v[244:251], v10
    buffer_load_dwordx4 v[240:243], v252, s[16:19], s57 offen sc1
    s_add_u32 s57, s57, 1024
    s_waitcnt vmcnt(0) lgkmcnt(0)
    v_smfmac_f32_16x16x64_bf16 v[128:131], v[240:243], v[244:251], v10
    buffer_load_dwordx4 v[240:243], v252, s[16:19], s57 offen sc1
    s_add_u32 s57, s57, 1024
    s_waitcnt vmcnt(0) lgkmcnt(0)
    v_smfmac_f32_16x16x64_bf16 v[132:135], v[240:243], v[244:251], v10
    buffer_load_dwordx4 v[240:243], v252, s[16:19], s57 offen sc1
    s_add_u32 s57, s57, 1024
    s_waitcnt vmcnt(0) lgkmcnt(0)
    v_smfmac_f32_16x16x64_bf16 v[136:139], v[240:243], v[244:251], v10
    buffer_load_dwordx4 v[240:243], v252, s[16:19], s57 offen sc1
    s_add_u32 s57, s57, 1024
    s_waitcnt vmcnt(0) lgkmcnt(0)
    v_smfmac_f32_16x16x64_bf16 v[140:143], v[240:243], v[244:251], v10
    buffer_load_dwordx4 v[240:243], v252, s[16:19], s57 offen sc1
    s_add_u32 s57, s57, 1024
    s_waitcnt vmcnt(0) lgkmcnt(0)
    v_smfmac_f32_16x16x64_bf16 v[144:147], v[240:243], v[244:251], v10
    buffer_load_dwordx4 v[240:243], v252, s[16:19], s57 offen sc1
    s_add_u32 s57, s57, 1024
    s_waitcnt vmcnt(0) lgkmcnt(0)
    v_smfmac_f32_16x16x64_bf16 v[148:151], v[240:243], v[244:251], v10
    buffer_load_dwordx4 v[240:243], v252, s[16:19], s57 offen sc1
    s_add_u32 s57, s57, 1024
    s_waitcnt vmcnt(0) lgkmcnt(0)
    v_smfmac_f32_16x16x64_bf16 v[152:155], v[240:243], v[244:251], v10
    buffer_load_dwordx4 v[240:243], v252, s[16:19], s57 offen sc1
    s_add_u32 s57, s57, 1024
    s_waitcnt vmcnt(0) lgkmcnt(0)
    v_smfmac_f32_16x16x64_bf16 v[156:159], v[240:243], v[244:251], v10
    s_add_u32 s56, s56, 1
    s_cmp_lt_u32 s56, 9
    s_cbranch_scc1 M_dn0
    s_mul_i32 s57, s20, 82944
    s_add_u32 s57, s57, 393216
    s_mov_b32 s56, 0
    v_mov_b32 v54, v1
    v_mov_b32 v55, v2
    v_subrev_u32 v252, s29, v8
M_dn1:
    ds_read_b128 v[244:247], v54 offset:18432
    ds_read_b128 v[248:251], v55 offset:18432
    v_add_u32 v54, 1024, v54
    v_add_u32 v55, 1024, v55
    buffer_load_dwordx4 v[240:243], v252, s[16:19], s57 offen sc1
    s_add_u32 s57, s57, 1024
    s_waitcnt vmcnt(0) lgkmcnt(0)
    v_smfmac_f32_16x16x64_bf16 v[160:163], v[240:243], v[244:251], v10
    buffer_load_dwordx4 v[240:243], v252, s[16:19], s57 offen sc1
    s_add_u32 s57, s57, 1024
    s_waitcnt vmcnt(0) lgkmcnt(0)
    v_smfmac_f32_16x16x64_bf16 v[164:167], v[240:243], v[244:251], v10
    buffer_load_dwordx4 v[240:243], v252, s[16:19], s57 offen sc1
    s_add_u32 s57, s57, 1024
    s_waitcnt vmcnt(0) lgkmcnt(0)
    v_smfmac_f32_16x16x64_bf16 v[168:171], v[240:243], v[244:251], v10
    buffer_load_dwordx4 v[240:243], v252, s[16:19], s57 offen sc1
    s_add_u32 s57, s57, 1024
    s_waitcnt vmcnt(0) lgkmcnt(0)
    v_smfmac_f32_16x16x64_bf16 v[172:175], v[240:243], v[244:251], v10
    buffer_load_dwordx4 v[240:243], v252, s[16:19], s57 offen sc1
    s_add_u32 s57, s57, 1024
    s_waitcnt vmcnt(0) lgkmcnt(0)
    v_smfmac_f32_16x16x64_bf16 v[176:179], v[240:243], v[244:251], v10
    buffer_load_dwordx4 v[240:243], v252, s[16:19], s57 offen sc1
    s_add_u32 s57, s57, 1024
    s_waitcnt vmcnt(0) lgkmcnt(0)
    v_smfmac_f32_16x16x64_bf16 v[180:183], v[240:243], v[244:251], v10
    buffer_load_dwordx4 v[240:243], v252, s[16:19], s57 offen sc1
    s_add_u32 s57, s57, 1024
    s_waitcnt vmcnt(0) lgkmcnt(0)
    v_smfmac_f32_16x16x64_bf16 v[184:187], v[240:243], v[244:251], v10
    buffer_load_dwordx4 v[240:243], v252, s[16:19], s57 offen sc1
    s_add_u32 s57, s57, 1024
    s_waitcnt vmcnt(0) lgkmcnt(0)
    v_smfmac_f32_16x16x64_bf16 v[188:191], v[240:243], v[244:251], v10
    buffer_load_dwordx4 v[240:243], v252, s[16:19], s57 offen sc1
    s_add_u32 s57, s57, 1024
    s_waitcnt vmcnt(0) lgkmcnt(0)
    v_smfmac_f32_16x16x64_bf16 v[192:195], v[240:243], v[244:251], v10
    s_add_u32 s56, s56, 1
    s_cmp_lt_u32 s56, 9
    s_cbranch_scc1 M_dn1
    s_branch M_slx
M_codeend:
.section .rodata,"a"
.p2align 6
.amdhsa_kernel standalone__structured_sparse_n_m__ragged_kernel
  .amdhsa_next_free_vgpr 512
  .amdhsa_next_free_sgpr 102
  .amdhsa_accum_offset 256
  .amdhsa_group_segment_fixed_size 0
  .amdhsa_kernarg_size 48
  .amdhsa_user_sgpr_count 2
  .amdhsa_user_sgpr_kernarg_segment_ptr 1
  .amdhsa_system_sgpr_workgroup_id_x 1
  .amdhsa_float_denorm_mode_32 3
.end_amdhsa_kernel
```

```asm
; @launch grid=(256,1,1) block=(256,1,1) lds=162064
.amdgcn_target "amdgcn-amd-amdhsa--gfx950"
.text
.globl standalone__structured_sparse_n_m__ragged_kernel
.p2align 8
.type standalone__structured_sparse_n_m__ragged_kernel,@function
standalone__structured_sparse_n_m__ragged_kernel:
    s_cmp_ge_u32 s2, 256
    s_cbranch_scc1 M_end
    s_load_dwordx8 s[72:79], s[0:1], 0
    s_load_dwordx4 s[80:83], s[0:1], 32
    s_getpc_b64 s[32:33]
    s_lshr_b32 s30, s2, 3
    s_and_b32 s30, s30, 15
    s_lshl_b32 s30, s30, 11
    s_and_b32 s32, s32, 0xffffff00
    s_cmp_ge_u32 s2, 88
    s_cselect_b32 s31, M_codeend-standalone__structured_sparse_n_m__ragged_kernel-4, 0
    v_lshl_add_u32 v252, v0, 3, s30
    v_mov_b32 v253, 0
    v_min_u32 v252, s31, v252
    s_mov_b32 exec_lo, 0x00010001
    s_mov_b32 exec_hi, 0x00010001
    v_lshl_add_u64 v[252:253], v[252:253], 0, s[32:33]
    global_load_dword v254, v[252:253], off
    s_mov_b64 exec, -1
    v_lshrrev_b32 v20, 6, v0
    v_and_b32 v12, 63, v0
    v_readfirstlane_b32 s20, v20
    v_lshrrev_b32 v22, 3, v0
    v_mul_u32_u24 v22, 1152, v22
    v_lshrrev_b32 v23, 4, v0
    v_xor_b32 v23, v23, v0
    v_and_b32 v23, 7, v23
    v_lshl_add_u32 v5, v23, 4, v22
    v_lshrrev_b32 v13, 4, v12
    v_and_b32 v14, 15, v12
    v_lshlrev_b32 v11, 4, v12
    v_lshlrev_b32 v54, 3, v12
    v_lshlrev_b32 v25, 4, v13
    v_lshlrev_b32 v26, 3, v13
    s_mov_b32 s6, 663552
    s_mov_b32 s7, 0x20000
    s_mov_b32 s10, 75497472
    s_mov_b32 s11, s7
    s_mov_b32 s18, 791552
    s_mov_b32 s19, s7
    s_movk_i32 s70, 256
    s_mov_b32 s71, s7
    s_movk_i32 s86, 1152
    s_mov_b32 s87, s7
    s_mov_b32 s98, 0
    s_mul_i32 s96, s20, 16
    s_and_b32 s97, s2, 15
    s_add_u32 s96, s96, s97
    s_lshl_b32 s96, s96, 8
    s_add_u32 s96, s96, 726016
    s_mul_i32 s22, s2, 36864
    s_mul_i32 s26, s20, 9216
    s_mov_b32 s24, s22
    s_mov_b32 s42, s26
    s_lshl_b32 s28, s20, 8
    s_lshl_b32 s97, s20, 5
    s_cmp_lt_u32 s2, 81
    s_cbranch_scc0 M_x1
    s_mul_i32 s32, s2, 57
    s_lshr_b32 s32, s32, 9
    s_mul_i32 s33, s32, 9
    s_sub_u32 s33, s2, s33
    s_mul_i32 s54, s32, 73728
    s_lshl_b32 s35, s33, 7
    s_add_u32 s54, s54, s35
    s_add_u32 s55, s54, 36864
    s_lshl_b32 s36, s20, 10
    s_add_u32 m0, s36, 73728
    s_lshr_b32 s30, s33, 1
    s_and_b32 s31, s33, 1
    s_lshl1_add_u32 s37, s32, s31
    s_mul_i32 s37, s37, 176
    s_mul_i32 s38, s32, 96
    s_add_u32 s38, s38, 3168
    s_cmp_lt_u32 s33, 8
    s_cselect_b32 s30, s30, s20
    s_cselect_b32 s37, s37, s38
    s_cselect_b32 s44, 2047, 63
    s_cselect_b32 s45, s20, 3
    s_cmp_eq_u32 s45, 3
    s_cselect_b32 s99, 791552, 0
    s_mul_i32 s48, s30, 98304
    s_add_u32 s37, s37, s48
    v_mov_b32 v44, 2.0
    v_mov_b32 v45, 0
    v_mov_b32 v46, 2.0
    v_mov_b32 v47, 0
    s_waitcnt lgkmcnt(0)
    s_mov_b64 s[4:5], s[74:75]
    buffer_load_dwordx4 v5, s[4:7], s54 offen lds
    s_add_u32 m0, m0, 4096
    s_mov_b32 s45, 0
    buffer_load_dwordx4 v5, s[4:7], s55 offen lds
    s_mov_b64 s[16:17], s[82:83]
    s_mov_b64 s[8:9], s[72:73]
    s_mov_b64 s[84:85], s[76:77]
    s_mov_b64 s[68:69], s[80:81]
    v_mov_b32 v10, 0
    s_mov_b64 exec, 1
    buffer_atomic_add v10, off, s[16:19], s96 sc0 sc1
    s_mov_b64 exec, -1
    s_mov_b64 exec, s[44:45]
    s_mov_b32 s18, s99
    buffer_store_dwordx4 v[44:47], v11, s[16:19], s37 offen sc1
    s_mov_b32 s18, 791552
    s_mov_b64 exec, -1
    s_mov_b32 m0, s42
    s_nop 0
    buffer_load_dwordx4 v5, s[8:11], s22 offen offset:0 nt lds
    s_add_u32 m0, m0, 896
    s_nop 0
    buffer_load_dwordx4 v5, s[8:11], s22 offen offset:128 nt lds
    s_add_u32 m0, m0, 896
    s_nop 0
    buffer_load_dwordx4 v5, s[8:11], s22 offen offset:256 nt lds
    s_lshl_b32 s34, s31, 2
    s_add_u32 s34, s34, s20
    s_lshr_b32 s35, s20, 1
    s_lshl_b32 s35, s35, 6
    s_and_b32 s36, s20, 1
    s_lshl_b32 s36, s36, 3
    s_add_u32 s35, s35, s36
    s_lshl_b32 s36, s20, 5
    s_mul_i32 s39, s32, 10240
    s_add_u32 s39, s39, 6144
    s_lshl_b32 s40, s34, 1
    s_add_u32 s40, s40, s39
    s_lshl_b32 s38, s32, 1
    s_cmp_eq_u32 s32, 8
    s_cselect_b32 s38, 1024, s38
    s_add_u32 s38, s38, 4096
    s_cmp_lt_u32 s33, 8
    s_cselect_b32 s34, s34, 8
    s_cselect_b32 s35, s35, s36
    s_cselect_b32 s36, 4, 3
    s_cselect_b32 s40, s40, s38
    s_cselect_b32 s46, 0, s20
    s_cselect_b32 s47, 22, 12
    s_add_u32 s40, s40, s48
    s_lshl_b32 s38, s34, 10
    s_add_u32 s39, s39, s38
    s_add_u32 s39, s39, s48
    s_add_u32 s39, s39, 1024
    v_and_b32 v15, 3, v14
    v_lshlrev_b32 v15, s36, v15
    v_add_u32 v15, s35, v15
    v_lshrrev_b32 v16, 3, v14
    v_lshlrev_b32 v16, 4, v16
    v_xor_b32 v15, v15, v16
    v_lshrrev_b32 v16, 2, v14
    v_lshl_add_u32 v16, v13, 4, v16
    v_lshl_add_u32 v15, v16, 7, v15
    v_add_u32 v24, 73728, v15
    v_xor_b32 v27, 32, v24
    v_xor_b32 v28, 64, v24
    v_xor_b32 v29, 0x60, v24
    s_lshl_b32 s31, s46, 2
    s_add_u32 s31, s31, 81920
    v_mov_b32 v60, s31
    v_mov_b32 v61, 1
    ds_write_b32 v60, v61
    s_mul_i32 s49, s30, 81
    s_mul_i32 s31, s32, 9
    s_add_u32 s49, s49, s31
    s_add_u32 s49, s49, s34
    s_lshl_b32 s49, s49, 10
    s_add_u32 s49, s49, 393216
    s_lshl_b32 s31, s34, 24
    s_lshl_b32 s38, s32, 10
    s_add_u32 s31, s31, s38
    v_lshlrev_b32 v31, 18, v14
    v_lshl_add_u32 v31, v13, 5, v31
    v_add_u32 v31, s31, v31
    s_mov_b32 s50, 3437096686
    s_mov_b32 s51, 1150609561
    s_mov_b32 s52, 0x00010001
    s_mov_b32 s53, 0x00200010
    s_mov_b32 s38, 0x0202
    s_mul_i32 s57, s30, 4096
    s_add_u32 s57, s57, 726016
    s_cmp_eq_u32 s33, 8
    s_cselect_b32 s56, 0, s20
    s_cmp_eq_u32 s20, 0
    s_cselect_b32 s98, 1, 0
    v_add_u32 v74, 81984, v54
    v_lshl_add_u32 v73, s20, 1, v74
    v_mov_b32 v41, 0x01000100
    v_mov_b32 v40, 0
    v_mov_b32 v63, -2.0
    s_waitcnt vmcnt(5) lgkmcnt(0)
    s_barrier
    ds_read_b64_tr_b16 v[16:17], v24
    ds_read_b64_tr_b16 v[18:19], v27 offset:512
    ds_read_b64_tr_b16 v[20:21], v28 offset:1024
    ds_read_b64_tr_b16 v[22:23], v29 offset:1536
    s_waitcnt lgkmcnt(3)
    v_and_b32 v44, 0x7fff7fff, v16
    v_and_b32 v45, 0x7fff7fff, v17
    v_pk_max_u16 v46, v44, v45
    v_pk_min_u16 v47, v44, v45
    v_pk_min_u16 v46, v46, v46 op_sel:[0,1] op_sel_hi:[1,0]
    v_pk_max_u16 v47, v47, v47 op_sel:[0,1] op_sel_hi:[1,0]
    v_pk_max_u16 v46, v46, s52
    v_pk_max_u16 v46, v46, v47
    v_pk_sub_i16 v44, v44, v46
    v_pk_sub_i16 v45, v45, v46
    v_pk_ashrrev_i16 v44, 15, v44 op_sel_hi:[0,1]
    v_pk_ashrrev_i16 v45, 15, v45 op_sel_hi:[0,1]
    v_alignbit_b32 v47, -1, v44, 16
    v_alignbit_b32 v46, v45, v45, 16
    v_and_b32 v48, 0x00080004, v44
    v_bitop3_b32 v46, v45, v46, v47 bitop3:0xe8
    v_and_or_b32 v64, v45, s53, v48
    v_bitop3_b32 v36, v16, v44, v46 bitop3:0x10
    v_min_u32 v68, 1, v36
    s_waitcnt lgkmcnt(2)
    v_and_b32 v44, 0x7fff7fff, v18
    v_and_b32 v45, 0x7fff7fff, v19
    v_pk_max_u16 v46, v44, v45
    v_pk_min_u16 v47, v44, v45
    v_pk_min_u16 v46, v46, v46 op_sel:[0,1] op_sel_hi:[1,0]
    v_pk_max_u16 v47, v47, v47 op_sel:[0,1] op_sel_hi:[1,0]
    v_pk_max_u16 v46, v46, s52
    v_pk_max_u16 v46, v46, v47
    v_pk_sub_i16 v44, v44, v46
    v_pk_sub_i16 v45, v45, v46
    v_pk_ashrrev_i16 v44, 15, v44 op_sel_hi:[0,1]
    v_pk_ashrrev_i16 v45, 15, v45 op_sel_hi:[0,1]
    v_alignbit_b32 v47, -1, v44, 16
    v_alignbit_b32 v46, v45, v45, 16
    v_and_b32 v48, 0x00080004, v44
    v_bitop3_b32 v46, v45, v46, v47 bitop3:0xe8
    v_and_or_b32 v65, v45, s53, v48
    v_bitop3_b32 v37, v18, v44, v46 bitop3:0x10
    v_min_u32 v69, 1, v37
    s_waitcnt lgkmcnt(1)
    v_and_b32 v44, 0x7fff7fff, v20
    v_and_b32 v45, 0x7fff7fff, v21
    v_pk_max_u16 v46, v44, v45
    v_pk_min_u16 v47, v44, v45
    v_pk_min_u16 v46, v46, v46 op_sel:[0,1] op_sel_hi:[1,0]
    v_pk_max_u16 v47, v47, v47 op_sel:[0,1] op_sel_hi:[1,0]
    v_pk_max_u16 v46, v46, s52
    v_pk_max_u16 v46, v46, v47
    v_pk_sub_i16 v44, v44, v46
    v_pk_sub_i16 v45, v45, v46
    v_pk_ashrrev_i16 v44, 15, v44 op_sel_hi:[0,1]
    v_pk_ashrrev_i16 v45, 15, v45 op_sel_hi:[0,1]
    v_alignbit_b32 v47, -1, v44, 16
    v_alignbit_b32 v46, v45, v45, 16
    v_and_b32 v48, 0x00080004, v44
    v_bitop3_b32 v46, v45, v46, v47 bitop3:0xe8
    v_and_or_b32 v66, v45, s53, v48
    v_bitop3_b32 v38, v20, v44, v46 bitop3:0x10
    v_min_u32 v70, 1, v38
    s_waitcnt lgkmcnt(0)
    v_and_b32 v44, 0x7fff7fff, v22
    v_and_b32 v45, 0x7fff7fff, v23
    v_pk_max_u16 v46, v44, v45
    v_pk_min_u16 v47, v44, v45
    v_pk_min_u16 v46, v46, v46 op_sel:[0,1] op_sel_hi:[1,0]
    v_pk_max_u16 v47, v47, v47 op_sel:[0,1] op_sel_hi:[1,0]
    v_pk_max_u16 v46, v46, s52
    v_pk_max_u16 v46, v46, v47
    v_pk_sub_i16 v44, v44, v46
    v_pk_sub_i16 v45, v45, v46
    v_pk_ashrrev_i16 v44, 15, v44 op_sel_hi:[0,1]
    v_pk_ashrrev_i16 v45, 15, v45 op_sel_hi:[0,1]
    v_alignbit_b32 v47, -1, v44, 16
    v_alignbit_b32 v46, v45, v45, 16
    v_and_b32 v48, 0x00080004, v44
    v_bitop3_b32 v46, v45, v46, v47 bitop3:0xe8
    v_and_or_b32 v67, v45, s53, v48
    v_bitop3_b32 v39, v22, v44, v46 bitop3:0x10
    v_min_u32 v71, 1, v39
    v_add_u32 v72, v68, v69
    v_add3_u32 v72, v72, v70, v71
    buffer_store_dwordx4 v[36:39], v11, s[16:19], s49 offen sc1
    v_cmp_ne_u32 vcc, 0, v72
    s_and_saveexec_b64 s[44:45], vcc
    ds_add_rtn_u32 v62, v60, v72
    s_mov_b64 exec, -1
    v_lshrrev_b32 v48, 16, v64
    v_or_b32 v48, v48, v64
    v_lshrrev_b64 v[52:53], v48, s[50:51]
    v_and_b32 v64, 15, v52
    v_lshl_or_b32 v40, v64, 0, v40
    v_lshrrev_b32 v48, 16, v65
    v_or_b32 v48, v48, v65
    v_lshrrev_b64 v[52:53], v48, s[50:51]
    v_and_b32 v65, 15, v52
    v_lshl_or_b32 v40, v65, 4, v40
    v_lshrrev_b32 v48, 16, v66
    v_or_b32 v48, v48, v66
    v_lshrrev_b64 v[52:53], v48, s[50:51]
    v_and_b32 v66, 15, v52
    v_lshl_or_b32 v40, v66, 8, v40
    v_lshrrev_b32 v48, 16, v67
    v_or_b32 v48, v48, v67
    v_lshrrev_b64 v[52:53], v48, s[50:51]
    v_and_b32 v67, 15, v52
    v_lshl_or_b32 v40, v67, 12, v40
    v_lshrrev_b32 v44, 2, v40
    v_lshlrev_b32 v45, 2, v40
    s_movk_i32 s31, 0x3333
    v_not_b32 v47, v40
    v_bfi_b32 v44, s31, v44, v45
    s_movk_i32 s31, 0x1111
    s_nop 0
    v_mov_b32_dpp v47, v44 row_shr:4 row_mask:0xf bank_mask:0xf
    v_xor_b32 v47, v47, v40
    v_lshrrev_b32 v45, 1, v47
    v_or_b32 v47, v47, v45
    v_lshrrev_b32 v45, 2, v47
    v_bitop3_b32 v47, v47, v45, s31 bitop3:0x2a
    s_nop 1
    v_xor_b32_dpp v47, v47, v47 row_shr:4 row_mask:0xf bank_mask:0xe
    s_nop 1
    v_xor_b32_dpp v47, v47, v47 row_shr:8 row_mask:0xf bank_mask:0xc
    v_mul_u32_u24 v47, 15, v47
    v_bfi_b32 v40, v47, v44, v40
    ds_write_b16 v73, v40
    v_bfe_u32 v64, v40, 0, 4
    v_mul_u32_u24 v46, 0x4001, v64
    v_and_b32 v46, 0x30003, v46
    v_mad_u32_u24 v46, v46, s38, v41
    v_perm_b32 v32, v17, v16, v46
    v_bfe_u32 v65, v40, 4, 4
    v_mul_u32_u24 v46, 0x4001, v65
    v_and_b32 v46, 0x30003, v46
    v_mad_u32_u24 v46, v46, s38, v41
    v_perm_b32 v33, v19, v18, v46
    s_waitcnt vmcnt(4) lgkmcnt(0)
    s_barrier
    ds_read_b64 v[50:51], v74
    v_bfe_u32 v66, v40, 8, 4
    v_mul_u32_u24 v46, 0x4001, v66
    v_and_b32 v46, 0x30003, v46
    v_mad_u32_u24 v46, v46, s38, v41
    v_perm_b32 v34, v21, v20, v46
    v_bfe_u32 v67, v40, 12, 4
    v_mul_u32_u24 v46, 0x4001, v67
    v_and_b32 v46, 0x30003, v46
    v_mad_u32_u24 v46, v46, s38, v41
    v_perm_b32 v35, v23, v22, v46
    buffer_store_dwordx4 v[32:35], v11, s[16:19], s39 offen sc1
    s_cmp_eq_u32 s33, 8
    s_cbranch_scc0 F_i1
    buffer_store_short v40, v11, s[16:19], s40 offen sc1
    s_branch F_i2
F_i1:
    s_cmp_eq_u32 s20, 0
    s_cbranch_scc0 F_i2
    s_waitcnt lgkmcnt(0)
    buffer_store_dwordx2 v[50:51], v11, s[16:19], s40 offen sc1
F_i2:
    s_cbranch_vccz F_z
    v_cmp_ne_u32 vcc, 0, v36
    s_and_saveexec_b64 s[44:45], vcc
    s_cbranch_execz F_e0
    v_cmp_gt_u32 vcc, s47, v62
    v_add_u32 v42, 0, v31
    v_lshlrev_b32 v44, 3, v62
    v_add_u32 v62, 1, v62
    v_cndmask_b32 v42, v63, v42, vcc
    v_cndmask_b32 v43, 0, v36, vcc
    v_cndmask_b32 v44, 0, v44, vcc
    buffer_store_dwordx2 v[42:43], v44, s[16:19], s37 offen sc1
F_e0:
    s_mov_b64 exec, -1
    v_cmp_ne_u32 vcc, 0, v37
    s_and_saveexec_b64 s[44:45], vcc
    s_cbranch_execz F_e1
    v_cmp_gt_u32 vcc, s47, v62
    v_add_u32 v42, 8, v31
    v_lshlrev_b32 v44, 3, v62
    v_add_u32 v62, 1, v62
    v_cndmask_b32 v42, v63, v42, vcc
    v_cndmask_b32 v43, 0, v37, vcc
    v_cndmask_b32 v44, 0, v44, vcc
    buffer_store_dwordx2 v[42:43], v44, s[16:19], s37 offen sc1
F_e1:
    s_mov_b64 exec, -1
    v_cmp_ne_u32 vcc, 0, v38
    s_and_saveexec_b64 s[44:45], vcc
    s_cbranch_execz F_e2
    v_cmp_gt_u32 vcc, s47, v62
    v_add_u32 v42, 16, v31
    v_lshlrev_b32 v44, 3, v62
    v_add_u32 v62, 1, v62
    v_cndmask_b32 v42, v63, v42, vcc
    v_cndmask_b32 v43, 0, v38, vcc
    v_cndmask_b32 v44, 0, v44, vcc
    buffer_store_dwordx2 v[42:43], v44, s[16:19], s37 offen sc1
F_e2:
    s_mov_b64 exec, -1
    v_cmp_ne_u32 vcc, 0, v39
    s_and_saveexec_b64 s[44:45], vcc
    s_cbranch_execz F_e3
    v_cmp_gt_u32 vcc, s47, v62
    v_add_u32 v42, 24, v31
    v_lshlrev_b32 v44, 3, v62
    v_add_u32 v62, 1, v62
    v_cndmask_b32 v42, v63, v42, vcc
    v_cndmask_b32 v43, 0, v39, vcc
    v_cndmask_b32 v44, 0, v44, vcc
    buffer_store_dwordx2 v[42:43], v44, s[16:19], s37 offen sc1
F_e3:
    s_mov_b64 exec, -1
F_z:
    s_cmp_lg_u32 s2, 0
    s_cbranch_scc1 M_set
    v_mov_b32 v64, 0
    v_mov_b32 v65, 0
    v_mov_b32 v66, 0
    v_mov_b32 v67, 0
    s_mov_b32 s40, 724992
    buffer_store_dwordx4 v[64:67], v11, s[16:19], s40 offen sc1
    s_branch M_set
F_sig:
    v_lshlrev_b32 v30, 8, v12
    s_waitcnt vmcnt(0)
    s_barrier
    s_cmp_lg_u32 s56, 0
    s_cbranch_scc1 F_end
    s_bfm_b64 exec, 16, 0
    buffer_atomic_add v61, v30, s[16:19], s57 offen sc1
    s_mov_b64 exec, -1
    s_cmp_eq_u32 s98, 0
    s_cbranch_scc1 F_cnt
    s_mov_b32 s98, 0
    v_mov_b32 v250, 1
    s_mov_b64 exec, 1
    buffer_atomic_add v250, off, s[68:71], 0 offset:0 sc1
    s_mov_b64 exec, -1
    s_nop 3
F_cnt:
F_end:
    s_add_u32 m0, m0, 896
    s_nop 0
    buffer_load_dwordx4 v5, s[8:11], s22 offen offset:384 nt lds
    s_add_u32 m0, m0, 896
    s_nop 0
    buffer_load_dwordx4 v5, s[8:11], s22 offen offset:512 nt lds
    s_branch M_x2
M_x1:
    s_waitcnt lgkmcnt(0)
    s_mov_b64 s[4:5], s[74:75]
    s_mov_b64 s[16:17], s[82:83]
    s_mov_b64 s[8:9], s[72:73]
    s_mov_b64 s[84:85], s[76:77]
    s_mov_b64 s[68:69], s[80:81]
    v_mov_b32 v10, 0
    s_mov_b64 exec, 1
    buffer_atomic_add v10, off, s[16:19], s96 sc0 sc1
    s_mov_b64 exec, -1
    s_mov_b32 m0, s42
    s_nop 0
    buffer_load_dwordx4 v5, s[8:11], s22 offen offset:0 nt lds
    s_add_u32 m0, m0, 896
    s_nop 0
    buffer_load_dwordx4 v5, s[8:11], s22 offen offset:128 nt lds
    s_add_u32 m0, m0, 896
    s_nop 0
    buffer_load_dwordx4 v5, s[8:11], s22 offen offset:256 nt lds
    s_add_u32 m0, m0, 896
    s_nop 0
    buffer_load_dwordx4 v5, s[8:11], s22 offen offset:384 nt lds
    s_add_u32 m0, m0, 896
    s_nop 0
    buffer_load_dwordx4 v5, s[8:11], s22 offen offset:512 nt lds
M_set:
    s_mov_b32 s12, s78
    s_mov_b32 s13, s79
    s_mov_b32 s14, 75497472
    s_mov_b32 s15, 0x20000
    s_mul_i32 s29, s20, 12864
    s_add_u32 s29, s29, 110592
    v_lshrrev_b32 v24, 1, v14
    v_and_b32 v27, 7, v14
    v_lshlrev_b32 v22, 7, v27
    v_lshl_or_b32 v3, v24, 4, v22
    v_lshrrev_b32 v23, 3, v14
    v_mul_u32_u24 v4, 9216, v23
    v_xad_u32 v1, v25, v3, v4
    v_xor_b32 v2, 64, v1
    v_add_u32 v9, s29, v25
    v_add_u32 v8, s29, v11
    v_mul_u32_u24 v24, 1152, v27
    v_lshl_add_u32 v24, v23, 6, v24
    v_add3_u32 v6, v24, v25, s28
    v_lshrrev_b32 v24, 3, v12
    v_xor_b32 v28, v24, v12
    v_and_b32 v28, 7, v28
    v_mul_u32_u24 v24, 1152, v24
    v_lshl_add_u32 v24, v28, 4, v24
    v_add_u32 v7, 1024, v24
    s_lshl_b32 s30, s20, 1
    v_lshrrev_b32 v24, 1, v13
    v_add_u32 v24, s30, v24
    v_xor_b32 v24, v24, v27
    v_lshl_add_u32 v24, v24, 4, v22
    v_and_b32 v28, 8, v26
    v_mul_u32_u24 v29, 12864, v23
    v_add3_u32 v24, v24, v28, v29
    v_add_u32 v53, 121408, v24
    s_lshr_b32 s30, s2, 3
    s_and_b32 s30, s30, 1
    s_mul_i32 s92, s30, 256
    s_add_u32 s92, s92, 562944
    s_add_u32 s30, s30, 768
    s_mul_i32 s93, s30, 36864
    s_mov_b32 s94, 73728
    s_and_b32 s95, s20, 1
    s_mul_i32 s95, s95, 9216
    s_add_u32 s59, s24, 9216
    s_mul_i32 s43, s20, 98304
    s_add_u32 s47, s29, 9216
    s_add_u32 s48, s29, 9792
    s_add_u32 s49, s29, 10112
    s_add_u32 s54, s29, 1073751872
    s_add_u32 s38, s26, 73728
    s_add_u32 s35, s38, 1024
    s_add_u32 s39, s38, 1536
    s_mov_b32 s40, s48
    s_add_u32 s41, s48, 256
    s_mov_b32 s50, 3130536464
    s_mov_b32 s51, 1164430831
    s_mov_b32 s52, 3696531472
    s_mov_b32 s53, 598435823
    v_mov_b32 v16, 0
    v_mov_b32 v17, 0
    v_mov_b32 v18, 0
    v_mov_b32 v19, 0
    v_cmp_gt_u32 s[44:45], 36, v12
    v_mov_b32 v20, 2.0
    s_nop 0
    v_cndmask_b32 v20, 0, v20, s[44:45]
    v_mov_b32 v21, v20
    v_mov_b32 v22, v20
    v_mov_b32 v23, v20
    v_mov_b32 v104, 1073741824
    v_mov_b32 v105, 0
    v_mov_b32 v106, 1073741824
    v_mov_b32 v107, 0
    v_lshl_add_u32 v121, v12, 2, s49
    v_add_u32 v55, s38, v54
    v_add_u32 v24, s38, v11
    ds_write_b128 v8, v[16:19] offset:0
    ds_write_b128 v8, v[16:19] offset:1024
    ds_write_b128 v8, v[16:19] offset:2048
    ds_write_b128 v8, v[16:19] offset:3072
    ds_write_b128 v8, v[16:19] offset:4096
    ds_write_b128 v8, v[16:19] offset:5120
    ds_write_b128 v8, v[16:19] offset:6144
    ds_write_b128 v8, v[16:19] offset:7168
    ds_write_b128 v8, v[16:19] offset:8192
    ds_write_b128 v24, v[104:107]
    ds_write_b128 v24, v[104:107] offset:1024
    ds_write_b128 v8, v[20:23] offset:9216
    s_cmp_lt_u32 s2, 81
    s_cbranch_scc1 F_sig
M_x2:
    s_add_u32 m0, m0, 896
    s_nop 0
    buffer_load_dwordx4 v5, s[8:11], s22 offen offset:640 nt lds
    s_add_u32 m0, m0, 896
    s_nop 0
    buffer_load_dwordx4 v5, s[8:11], s22 offen offset:768 nt lds
    s_add_u32 m0, m0, 896
    s_nop 0
    buffer_load_dwordx4 v5, s[8:11], s22 offen offset:896 nt lds
    s_add_u32 m0, m0, 896
    s_nop 0
    buffer_load_dwordx4 v5, s[8:11], s22 offen offset:1024 nt lds
    s_add_u32 s22, s22, 9437184
    s_add_u32 s42, s42, 36864
    buffer_load_dwordx4 v[196:199], v25, s[84:87], s28 offen offset:0
    buffer_load_dwordx4 v[200:203], v25, s[84:87], s28 offen offset:64
    buffer_load_dwordx4 v[204:207], v25, s[84:87], s28 offen offset:128
    buffer_load_dwordx4 v[208:211], v25, s[84:87], s28 offen offset:192
    buffer_load_dwordx2 v[212:213], v26, s[84:87], s97 offen offset:1024
    s_mov_b32 m0, s42
    s_nop 0
    buffer_load_dwordx4 v5, s[8:11], s22 offen offset:0 nt lds
    s_add_u32 m0, m0, 896
    s_nop 0
    buffer_load_dwordx4 v5, s[8:11], s22 offen offset:128 nt lds
    s_add_u32 m0, m0, 896
    s_nop 0
    buffer_load_dwordx4 v5, s[8:11], s22 offen offset:256 nt lds
    s_add_u32 m0, m0, 896
    s_nop 0
    buffer_load_dwordx4 v5, s[8:11], s22 offen offset:384 nt lds
    s_add_u32 m0, m0, 896
    s_nop 0
    buffer_load_dwordx4 v5, s[8:11], s22 offen offset:512 nt lds
    s_add_u32 m0, m0, 896
    s_nop 0
    buffer_load_dwordx4 v5, s[8:11], s22 offen offset:640 nt lds
    s_add_u32 m0, m0, 896
    s_nop 0
    buffer_load_dwordx4 v5, s[8:11], s22 offen offset:768 nt lds
    s_add_u32 m0, m0, 896
    s_nop 0
    buffer_load_dwordx4 v5, s[8:11], s22 offen offset:896 nt lds
    s_add_u32 m0, m0, 896
    s_nop 0
    buffer_load_dwordx4 v5, s[8:11], s22 offen offset:1024 nt lds
    s_add_u32 s22, s22, 9437184
    s_add_u32 s42, s42, 36864
    s_waitcnt vmcnt(3)
    v_mov_b32 v0, 0
    s_mov_b64 exec, 1
    buffer_atomic_add v0, off, s[16:19], s96 sc0 sc1
    s_mov_b64 exec, -1
    v_readlane_b32 s100, v10, 0
    v_mov_b32 v10, 0xeeee4444
    v_lshlrev_b32 v124, 16, v196
    v_and_b32 v125, 0xffff0000, v196
    v_lshlrev_b32 v126, 16, v197
    v_and_b32 v127, 0xffff0000, v197
    v_lshlrev_b32 v128, 16, v198
    v_and_b32 v129, 0xffff0000, v198
    v_lshlrev_b32 v130, 16, v199
    v_and_b32 v131, 0xffff0000, v199
    v_lshlrev_b32 v132, 16, v200
    v_and_b32 v133, 0xffff0000, v200
    v_lshlrev_b32 v134, 16, v201
    v_and_b32 v135, 0xffff0000, v201
    v_lshlrev_b32 v136, 16, v202
    v_and_b32 v137, 0xffff0000, v202
    v_lshlrev_b32 v138, 16, v203
    v_and_b32 v139, 0xffff0000, v203
    v_lshlrev_b32 v140, 16, v204
    v_and_b32 v141, 0xffff0000, v204
    v_lshlrev_b32 v142, 16, v205
    v_and_b32 v143, 0xffff0000, v205
    v_lshlrev_b32 v144, 16, v206
    v_and_b32 v145, 0xffff0000, v206
    v_lshlrev_b32 v146, 16, v207
    v_and_b32 v147, 0xffff0000, v207
    v_lshlrev_b32 v148, 16, v208
    v_and_b32 v149, 0xffff0000, v208
    v_lshlrev_b32 v150, 16, v209
    v_and_b32 v151, 0xffff0000, v209
    v_lshlrev_b32 v152, 16, v210
    v_and_b32 v153, 0xffff0000, v210
    v_lshlrev_b32 v154, 16, v211
    v_and_b32 v155, 0xffff0000, v211
    v_lshlrev_b32 v156, 16, v212
    v_and_b32 v157, 0xffff0000, v212
    v_lshlrev_b32 v158, 16, v213
    v_and_b32 v159, 0xffff0000, v213
    s_mov_b32 exec_lo, 0x00010001
    s_mov_b32 exec_hi, 0x00010001
    ds_write_b128 v9, v[124:127] offset:10240
    ds_write_b128 v9, v[128:131] offset:10304
    ds_write_b128 v9, v[132:135] offset:10368
    ds_write_b128 v9, v[136:139] offset:10432
    ds_write_b128 v9, v[140:143] offset:10496
    ds_write_b128 v9, v[144:147] offset:10560
    ds_write_b128 v9, v[148:151] offset:10624
    ds_write_b128 v9, v[152:155] offset:10688
    ds_write_b128 v9, v[156:159] offset:10752
    s_mov_b64 exec, -1
    s_mul_i32 s30, s20, 256
    s_xor_b32 s31, s2, 0
    s_add_u32 s30, s30, s31
    s_sub_u32 s30, s30, 0
    s_cmp_lt_u32 s2, 0
    s_cselect_b32 s30, 1023, s30
    s_lshl_b32 s30, s30, 1
    v_lshrrev_b32 v244, 5, v12
    v_add_u32 v248, s30, v244
    v_mov_b32 v244, -1
    v_mov_b32 v245, 0
    v_subrev_u32 v246, 682, v248
    v_cmp_gt_u32 vcc, 20, v246
    v_mov_b32 v247, 0
    s_nop 0
    v_cndmask_b32 v244, v244, v246, vcc
    v_cndmask_b32 v245, v245, v247, vcc
    v_subrev_u32 v246, 648, v248
    v_cmp_gt_u32 vcc, 34, v246
    v_mov_b32 v247, 1
    s_nop 0
    v_cndmask_b32 v244, v244, v246, vcc
    v_cndmask_b32 v245, v245, v247, vcc
    v_subrev_u32 v246, 600, v248
    v_cmp_gt_u32 vcc, 48, v246
    v_mov_b32 v247, 2
    s_nop 0
    v_cndmask_b32 v244, v244, v246, vcc
    v_cndmask_b32 v245, v245, v247, vcc
    v_subrev_u32 v246, 538, v248
    v_cmp_gt_u32 vcc, 62, v246
    v_mov_b32 v247, 3
    s_nop 0
    v_cndmask_b32 v244, v244, v246, vcc
    v_cndmask_b32 v245, v245, v247, vcc
    v_subrev_u32 v246, 460, v248
    v_cmp_gt_u32 vcc, 78, v246
    v_mov_b32 v247, 4
    s_nop 0
    v_cndmask_b32 v244, v244, v246, vcc
    v_cndmask_b32 v245, v245, v247, vcc
    v_subrev_u32 v246, 366, v248
    v_cmp_gt_u32 vcc, 94, v246
    v_mov_b32 v247, 5
    s_nop 0
    v_cndmask_b32 v244, v244, v246, vcc
    v_cndmask_b32 v245, v245, v247, vcc
    v_subrev_u32 v246, 258, v248
    v_cmp_gt_u32 vcc, 108, v246
    v_mov_b32 v247, 6
    s_nop 0
    v_cndmask_b32 v244, v244, v246, vcc
    v_cndmask_b32 v245, v245, v247, vcc
    v_subrev_u32 v246, 136, v248
    v_cmp_gt_u32 vcc, 122, v246
    v_mov_b32 v247, 7
    s_nop 0
    v_cndmask_b32 v244, v244, v246, vcc
    v_cndmask_b32 v245, v245, v247, vcc
    v_subrev_u32 v246, 0, v248
    v_cmp_gt_u32 vcc, 136, v246
    v_mov_b32 v247, 8
    s_nop 0
    v_cndmask_b32 v244, v244, v246, vcc
    v_cndmask_b32 v245, v245, v247, vcc
    v_sub_u32 v244, 2047, v244
    v_mul_u32_u24 v244, 36864, v244
    v_lshl_add_u32 v244, v245, 7, v244
    v_and_b32 v245, 31, v12
    v_mul_u32_u24 v245, 1152, v245
    v_add_u32 v249, v244, v245
    s_mov_b32 vcc_lo, 0xff00ff00
    s_mov_b32 vcc_hi, 0xff00ff00
    s_waitcnt vmcnt(0)
    v_readfirstlane_b32 s30, v0
    s_mov_b32 s31, 0
    s_sub_u32 s30, s30, s100
    s_cmp_eq_u32 s30, 27
    s_cbranch_scc0 M_pf_spin
M_pf_ok:
    s_lshr_b32 s30, s2, 3
    s_sub_u32 s31, s30, 11
    s_cselect_b32 s30, s30, s31
    s_mul_i32 s30, s30, 3072
    s_add_u32 s30, s30, s43
    s_add_u32 s30, s30, 33792
    v_lshlrev_b32 v244, 3, v11
    v_mov_b32 v0, v249
    buffer_load_dwordx4 v[92:95], v11, s[16:19], s43 offen offset:0 sc1
    buffer_load_dwordx4 v[96:99], v11, s[16:19], s43 offen offset:1024 sc1
    buffer_load_dwordx4 v[100:103], v11, s[16:19], s43 offen offset:2048 sc1
    s_mov_b32 exec_hi, 268435455
    buffer_load_dwordx4 v[104:107], v11, s[16:19], s43 offen offset:3072 sc1
    s_mov_b32 exec_hi, -1
    s_add_u32 s43, s43, 4096
    buffer_load_dwordx4 v[48:51], v11, s[16:19], s43 offen offset:0 sc1
    buffer_load_dword v52, v11, s[16:19], s43 offen offset:1024 sc1
    buffer_load_dwordx4 v[12:15], v11, s[16:19], s43 offen offset:2048 sc1
    buffer_load_dwordx4 a[0:3], v11, s[16:19], s43 offen offset:3072 sc1
    s_add_u32 s43, s43, 4096
    buffer_load_dwordx4 a[4:7], v11, s[16:19], s43 offen offset:0 sc1
    buffer_load_dwordx4 a[8:11], v11, s[16:19], s43 offen offset:1024 sc1
    buffer_load_dwordx4 a[12:15], v11, s[16:19], s43 offen offset:2048 sc1
    buffer_load_dwordx4 a[16:19], v11, s[16:19], s43 offen offset:3072 sc1
    s_add_u32 s43, s43, 4096
    s_bfm_b64 exec, 24, 0
    buffer_load_dword v244, v244, s[16:19], s30 offen sc1
    s_mov_b64 exec, -1
    buffer_load_dwordx4 a[20:23], v11, s[16:19], s43 offen offset:0 sc1
    buffer_load_dwordx4 a[24:27], v11, s[16:19], s43 offen offset:1024 sc1
    buffer_load_dwordx4 a[28:31], v11, s[16:19], s43 offen offset:2048 sc1
    buffer_load_dwordx4 a[32:35], v11, s[16:19], s43 offen offset:3072 sc1
    s_add_u32 s43, s43, 4096
    buffer_load_dwordx4 v[16:19], v11, s[16:19], s43 offen offset:0 sc1
    buffer_load_dwordx4 a[36:39], v11, s[16:19], s43 offen offset:1024 sc1
    buffer_load_dwordx4 a[40:43], v11, s[16:19], s43 offen offset:2048 sc1
    buffer_load_dwordx4 a[44:47], v11, s[16:19], s43 offen offset:3072 sc1
    s_add_u32 s43, s43, 4096
    buffer_load_dwordx4 a[48:51], v11, s[16:19], s43 offen offset:0 sc1
    buffer_load_dwordx4 a[52:55], v11, s[16:19], s43 offen offset:1024 sc1
    buffer_load_dwordx4 a[56:59], v11, s[16:19], s43 offen offset:2048 sc1
    buffer_load_dwordx4 a[60:63], v11, s[16:19], s43 offen offset:3072 sc1
    s_add_u32 s43, s43, 4096
    buffer_load_dwordx4 a[64:67], v11, s[16:19], s43 offen offset:0 sc1
    buffer_load_dwordx4 a[68:71], v11, s[16:19], s43 offen offset:1024 sc1
    buffer_load_dwordx4 v[20:23], v11, s[16:19], s43 offen offset:2048 sc1
    buffer_load_dwordx4 a[72:75], v11, s[16:19], s43 offen offset:3072 sc1
    s_add_u32 s43, s43, 4096
    buffer_load_dwordx4 a[76:79], v11, s[16:19], s43 offen offset:0 sc1
    buffer_load_dwordx4 a[80:83], v11, s[16:19], s43 offen offset:1024 sc1
    buffer_load_dwordx4 a[84:87], v11, s[16:19], s43 offen offset:2048 sc1
    buffer_load_dwordx4 a[88:91], v11, s[16:19], s43 offen offset:3072 sc1
    s_add_u32 s43, s43, 4096
    buffer_load_dwordx4 a[92:95], v11, s[16:19], s43 offen offset:0 sc1
    buffer_load_dwordx4 a[96:99], v11, s[16:19], s43 offen offset:1024 sc1
    buffer_load_dwordx4 a[100:103], v11, s[16:19], s43 offen offset:2048 sc1
    buffer_load_dwordx4 a[104:107], v11, s[16:19], s43 offen offset:3072 sc1
    s_add_u32 s43, s43, 4096
    buffer_load_dwordx4 v[24:27], v11, s[16:19], s43 offen offset:0 sc1
    buffer_load_dwordx4 a[108:111], v11, s[16:19], s43 offen offset:1024 sc1
    ds_read_b128 v[160:163], v9 offset:10240
    ds_read_b128 v[164:167], v9 offset:10304
    ds_read_b128 v[168:171], v9 offset:10368
    ds_read_b128 v[172:175], v9 offset:10432
    ds_read_b128 v[176:179], v9 offset:10496
    ds_read_b128 v[180:183], v9 offset:10560
    ds_read_b128 v[184:187], v9 offset:10624
    ds_read_b128 v[188:191], v9 offset:10688
    ds_read_b128 v[192:195], v9 offset:10752
    s_waitcnt vmcnt(31)
    s_barrier
    ds_read_b128 v[196:199], v1 offset:0
    ds_read_b128 v[200:203], v2 offset:0
    ds_read_b128 v[228:231], v1 offset:18432
    ds_read_b128 v[232:235], v2 offset:18432
    s_waitcnt lgkmcnt(2)
    v_smfmac_f32_16x16x64_bf16 v[124:127], a[0:3], v[196:203], v12
    buffer_load_dwordx4 a[112:115], v11, s[16:19], s43 offen offset:2048 sc1
    s_waitcnt lgkmcnt(0)
    v_mov_b32 v118, s54
    v_smfmac_f32_16x16x64_bf16 v[160:163], a[0:3], v[228:235], v12
    ds_read_b128 v[204:207], v1 offset:1024
    ds_read_b128 v[208:211], v2 offset:1024
    v_or3_b32 v114, v92, v96, v100
    v_or_b32 v114, v114, v104
    v_cmp_gt_i32 s[32:33], 0, v114
    v_cmp_gt_u32 s[36:37], 2.0, v92
    s_nop 1
    v_mbcnt_lo_u32_b32 v110, s36, 0
    s_waitcnt vmcnt(31)
    v_mbcnt_hi_u32_b32 v110, s37, v110
    v_smfmac_f32_16x16x64_bf16 v[128:131], a[4:7], v[196:203], v12 abid:1
    buffer_load_dwordx4 a[116:119], v11, s[16:19], s43 offen offset:3072 sc1
    v_lshl_add_u32 v110, v110, 3, s38
    v_smfmac_f32_16x16x64_bf16 v[164:167], a[4:7], v[228:235], v12 abid:1
    ds_read_b128 v[220:223], v1 offset:19456
    ds_read_b128 v[224:227], v2 offset:19456
    v_min_u32 v110, s39, v110
    s_waitcnt vmcnt(31)
    v_cndmask_b32 v110, v118, v110, s[36:37]
    v_smfmac_f32_16x16x64_bf16 v[132:135], a[8:11], v[196:203], v13
    s_add_u32 s43, s43, 4096
    buffer_load_dwordx4 a[120:123], v11, s[16:19], s43 offen offset:0 sc1
    ds_write_b64 v110, v[92:93]
    s_bcnt1_i32_b64 s30, s[36:37]
    s_lshl3_add_u32 s38, s30, s38
    v_cmp_gt_u32 s[44:45], 2.0, v94
    v_smfmac_f32_16x16x64_bf16 v[168:171], a[8:11], v[228:235], v13
    s_nop 0
    v_mbcnt_lo_u32_b32 v111, s44, 0
    v_mbcnt_hi_u32_b32 v111, s45, v111
    v_lshl_add_u32 v111, v111, 3, s38
    v_min_u32 v111, s39, v111
    s_waitcnt vmcnt(31)
    v_cndmask_b32 v111, v118, v111, s[44:45]
    v_smfmac_f32_16x16x64_bf16 v[136:139], a[12:15], v[196:203], v13 abid:1
    buffer_load_dwordx4 a[124:127], v11, s[16:19], s43 offen offset:1024 sc1
    ds_write_b64 v111, v[94:95]
    s_bcnt1_i32_b64 s30, s[44:45]
    s_lshl3_add_u32 s38, s30, s38
    v_cmp_gt_u32 s[36:37], 2.0, v96
    v_smfmac_f32_16x16x64_bf16 v[172:175], a[12:15], v[228:235], v13 abid:1
    s_nop 0
    v_mbcnt_lo_u32_b32 v110, s36, 0
    v_mbcnt_hi_u32_b32 v110, s37, v110
    v_lshl_add_u32 v110, v110, 3, s38
    s_waitcnt vmcnt(31)
    v_min_u32 v110, s39, v110
    v_smfmac_f32_16x16x64_bf16 v[140:143], a[16:19], v[196:203], v14
    buffer_load_dwordx4 a[128:131], v11, s[16:19], s43 offen offset:2048 sc1
    v_cndmask_b32 v110, v118, v110, s[36:37]
    v_smfmac_f32_16x16x64_bf16 v[176:179], a[16:19], v[228:235], v14
    ds_write_b64 v110, v[96:97]
    s_bcnt1_i32_b64 s30, s[36:37]
    s_lshl3_add_u32 s38, s30, s38
    v_cmp_gt_u32 s[44:45], 2.0, v98
    s_nop 1
    v_mbcnt_lo_u32_b32 v111, s44, 0
    s_waitcnt vmcnt(30)
    v_mbcnt_hi_u32_b32 v111, s45, v111
    v_smfmac_f32_16x16x64_bf16 v[144:147], a[20:23], v[196:203], v14 abid:1
    buffer_load_dwordx4 a[132:135], v11, s[16:19], s43 offen offset:3072 sc1
    v_lshl_add_u32 v111, v111, 3, s38
    v_smfmac_f32_16x16x64_bf16 v[180:183], a[20:23], v[228:235], v14 abid:1
    v_min_u32 v111, s39, v111
    s_waitcnt vmcnt(30)
    v_cndmask_b32 v111, v118, v111, s[44:45]
    v_smfmac_f32_16x16x64_bf16 v[148:151], a[24:27], v[196:203], v15
    s_add_u32 s43, s43, 4096
    buffer_load_dwordx4 a[136:139], v11, s[16:19], s43 offen offset:0 sc1
    ds_write_b64 v111, v[98:99]
    s_bcnt1_i32_b64 s30, s[44:45]
    s_lshl3_add_u32 s38, s30, s38
    v_cmp_gt_u32 s[36:37], 2.0, v100
    v_smfmac_f32_16x16x64_bf16 v[184:187], a[24:27], v[228:235], v15
    s_nop 0
    v_mbcnt_lo_u32_b32 v110, s36, 0
    v_mbcnt_hi_u32_b32 v110, s37, v110
    v_lshl_add_u32 v110, v110, 3, s38
    v_min_u32 v110, s39, v110
    s_waitcnt vmcnt(30)
    v_cndmask_b32 v110, v118, v110, s[36:37]
    v_smfmac_f32_16x16x64_bf16 v[152:155], a[28:31], v[196:203], v15 abid:1
    buffer_load_dwordx4 a[140:143], v11, s[16:19], s43 offen offset:1024 sc1
    ds_write_b64 v110, v[100:101]
    s_bcnt1_i32_b64 s30, s[36:37]
    s_lshl3_add_u32 s38, s30, s38
    v_cmp_gt_u32 s[44:45], 2.0, v102
    v_smfmac_f32_16x16x64_bf16 v[188:191], a[28:31], v[228:235], v15 abid:1
    s_nop 0
    v_mbcnt_lo_u32_b32 v111, s44, 0
    v_mbcnt_hi_u32_b32 v111, s45, v111
    v_lshl_add_u32 v111, v111, 3, s38
    s_waitcnt vmcnt(30)
    v_min_u32 v111, s39, v111
    v_smfmac_f32_16x16x64_bf16 v[156:159], a[32:35], v[196:203], v48
    buffer_load_dwordx4 v[28:31], v11, s[16:19], s43 offen offset:2048 sc1
    buffer_load_dwordx4 a[144:147], v11, s[16:19], s43 offen offset:3072 sc1
    v_cndmask_b32 v111, v118, v111, s[44:45]
    v_smfmac_f32_16x16x64_bf16 v[192:195], a[32:35], v[228:235], v48
    ds_write_b64 v111, v[102:103]
    s_bcnt1_i32_b64 s30, s[44:45]
    s_lshl3_add_u32 s38, s30, s38
    v_cmp_gt_u32 s[36:37], 2.0, v104
    s_nop 1
    s_waitcnt vmcnt(30)
    s_waitcnt lgkmcnt(8)
    v_mbcnt_lo_u32_b32 v110, s36, 0
    v_smfmac_f32_16x16x64_bf16 v[124:127], a[36:39], v[204:211], v16
    s_add_u32 s43, s43, 4096
    buffer_load_dwordx4 a[148:151], v11, s[16:19], s43 offen offset:0 sc1
    s_waitcnt lgkmcnt(6)
    v_mbcnt_hi_u32_b32 v110, s37, v110
    v_smfmac_f32_16x16x64_bf16 v[160:163], a[36:39], v[220:227], v16
    ds_read_b128 v[196:199], v1 offset:2048
    ds_read_b128 v[200:203], v2 offset:2048
    v_lshl_add_u32 v110, v110, 3, s38
    v_min_u32 v110, s39, v110
    s_waitcnt vmcnt(30)
    v_cndmask_b32 v110, v118, v110, s[36:37]
    v_smfmac_f32_16x16x64_bf16 v[128:131], a[40:43], v[204:211], v16 abid:1
    buffer_load_dwordx4 a[152:155], v11, s[16:19], s43 offen offset:1024 sc1
    ds_write_b64 v110, v[104:105]
    s_bcnt1_i32_b64 s30, s[36:37]
    s_lshl3_add_u32 s38, s30, s38
    v_cmp_gt_u32 s[44:45], 2.0, v106
    v_smfmac_f32_16x16x64_bf16 v[164:167], a[40:43], v[220:227], v16 abid:1
    ds_read_b128 v[228:231], v1 offset:20480
    ds_read_b128 v[232:235], v2 offset:20480
    v_mbcnt_lo_u32_b32 v111, s44, 0
    v_mbcnt_hi_u32_b32 v111, s45, v111
    v_lshl_add_u32 v111, v111, 3, s38
    v_min_u32 v111, s39, v111
    s_waitcnt vmcnt(30)
    v_cndmask_b32 v111, v118, v111, s[44:45]
    v_smfmac_f32_16x16x64_bf16 v[132:135], a[44:47], v[204:211], v17
    buffer_load_dwordx4 a[156:159], v11, s[16:19], s43 offen offset:2048 sc1
    ds_write_b64 v111, v[106:107]
    s_bcnt1_i32_b64 s30, s[44:45]
    s_lshl3_add_u32 s38, s30, s38
    ds_read_b64 v[92:93], v55 offset:0
    ds_read_b64 v[94:95], v55 offset:512
    ds_read_b64 v[96:97], v55 offset:1024
    v_smfmac_f32_16x16x64_bf16 v[168:171], a[44:47], v[220:227], v17
    s_waitcnt vmcnt(30)
    v_smfmac_f32_16x16x64_bf16 v[136:139], a[48:51], v[204:211], v17 abid:1
    buffer_load_dwordx4 a[160:163], v11, s[16:19], s43 offen offset:3072 sc1
    v_smfmac_f32_16x16x64_bf16 v[172:175], a[48:51], v[220:227], v17 abid:1
    s_waitcnt vmcnt(30)
    v_smfmac_f32_16x16x64_bf16 v[140:143], a[52:55], v[204:211], v18
    s_add_u32 s43, s43, 4096
    buffer_load_dwordx4 a[164:167], v11, s[16:19], s43 offen offset:0 sc1
    s_waitcnt lgkmcnt(2)
    v_bfe_u32 v110, v92, 24, 4
    v_smfmac_f32_16x16x64_bf16 v[176:179], a[52:55], v[220:227], v18
    v_lshlrev_b32 v111, 1, v92
    v_lshl_add_u32 v110, v110, 2, s49
    v_and_b32 v111, 16, v111
    s_waitcnt vmcnt(30)
    v_and_or_b32 v110, v92, 2.0, v110
    v_smfmac_f32_16x16x64_bf16 v[144:147], a[56:59], v[204:211], v18 abid:1
    buffer_load_dwordx4 a[168:171], v11, s[16:19], s43 offen offset:1024 sc1
    v_lshlrev_b32 v111, v111, 1
    v_smfmac_f32_16x16x64_bf16 v[180:183], a[56:59], v[220:227], v18 abid:1
    ds_add_rtn_u32 v98, v110, v111
    s_waitcnt lgkmcnt(2)
    v_bfe_u32 v112, v94, 24, 4
    v_lshlrev_b32 v113, 1, v94
    v_lshl_add_u32 v112, v112, 2, s49
    s_waitcnt vmcnt(30)
    v_and_b32 v113, 16, v113
    v_smfmac_f32_16x16x64_bf16 v[148:151], a[60:63], v[204:211], v19
    buffer_load_dwordx4 a[172:175], v11, s[16:19], s43 offen offset:2048 sc1
    v_and_or_b32 v112, v94, 2.0, v112
    v_smfmac_f32_16x16x64_bf16 v[184:187], a[60:63], v[220:227], v19
    s_waitcnt vmcnt(30)
    v_lshlrev_b32 v113, v113, 1
    v_smfmac_f32_16x16x64_bf16 v[152:155], a[64:67], v[204:211], v19 abid:1
    buffer_load_dwordx4 a[176:179], v11, s[16:19], s43 offen offset:3072 sc1
    ds_add_rtn_u32 v99, v112, v113
    s_waitcnt lgkmcnt(2)
    s_cmp_gt_u32 s38, s35
    s_cbranch_scc1 M_r3
M_r3r:
    ds_read_b32 v117, v121
    v_and_b32 v110, 8, v92
    v_smfmac_f32_16x16x64_bf16 v[188:191], a[64:67], v[220:227], v19 abid:1
    v_lshrrev_b32 v113, 14, v92
    v_cmp_ne_u32 s[44:45], 0, v110
    v_and_b32 v116, 0x3cf0, v113
    s_waitcnt lgkmcnt(2)
    v_lshrrev_b32 v111, 16, v98
    v_and_b32 v112, 0xffff, v98
    s_waitcnt vmcnt(30)
    v_sub_u32 v110, 15, v111
    v_smfmac_f32_16x16x64_bf16 v[156:159], a[68:71], v[204:211], v48 abid:1
    s_add_u32 s43, s43, 4096
    buffer_load_dwordx4 v[32:35], v11, s[16:19], s43 offen offset:0 sc1
    buffer_load_dwordx4 a[180:183], v11, s[16:19], s43 offen offset:1024 sc1
    v_and_b32 v98, 2.0, v92
    v_smfmac_f32_16x16x64_bf16 v[192:195], a[68:71], v[220:227], v48 abid:1
    v_add3_u32 v98, v112, v111, v98
    v_cndmask_b32 v110, v112, v110, s[44:45]
    v_cmp_gt_u32 s[44:45], 16, v98
    v_cmp_gt_u32 s[36:37], 2.0, v98
    v_lshlrev_b32 v110, 2, v110
    s_waitcnt vmcnt(30)
    v_lshrrev_b64 v[112:113], v110, s[50:51]
    v_smfmac_f32_16x16x64_bf16 v[124:127], a[72:75], v[196:203], v20
    buffer_load_dwordx4 a[184:187], v11, s[16:19], s43 offen offset:2048 sc1
    s_andn2_b64 s[36:37], s[36:37], s[44:45]
    v_lshrrev_b64 v[114:115], v110, s[52:53]
    v_smfmac_f32_16x16x64_bf16 v[160:163], a[72:75], v[228:235], v20
    ds_read_b128 v[204:207], v1 offset:3072
    ds_read_b128 v[208:211], v2 offset:3072
    v_bfe_u32 v110, v92, 24, 4
    v_mbcnt_lo_u32_b32 v111, s36, 0
    v_and_b32 v112, 15, v112
    v_mbcnt_hi_u32_b32 v111, s37, v111
    v_and_b32 v114, 15, v114
    s_waitcnt vmcnt(30)
    v_lshl_add_u32 v111, v111, 3, s40
    v_smfmac_f32_16x16x64_bf16 v[128:131], a[76:79], v[196:203], v20 abid:1
    buffer_load_dwordx4 a[188:191], v11, s[16:19], s43 offen offset:3072 sc1
    v_lshl_add_u32 v112, v110, 4, v112
    v_smfmac_f32_16x16x64_bf16 v[164:167], a[76:79], v[228:235], v20 abid:1
    ds_read_b128 v[220:223], v1 offset:21504
    ds_read_b128 v[224:227], v2 offset:21504
    v_min_u32 v111, s41, v111
    v_mul_u32_u24 v114, 68, v114
    s_waitcnt vmcnt(30)
    v_cndmask_b32 v111, v118, v111, s[36:37]
    v_smfmac_f32_16x16x64_bf16 v[132:135], a[80:83], v[196:203], v21
    s_add_u32 s43, s43, 4096
    buffer_load_dwordx4 a[192:195], v11, s[16:19], s43 offen offset:0 sc1
    ds_write_b64 v111, v[92:93]
    s_bcnt1_i32_b64 s30, s[36:37]
    s_lshl3_add_u32 s40, s30, s40
    v_lshl_add_u32 v112, v112, 2, s47
    v_smfmac_f32_16x16x64_bf16 v[168:171], a[80:83], v[228:235], v21
    v_and_b32 v114, 0x30c, v114
    v_cndmask_b32 v112, v118, v112, s[44:45]
    v_add3_u32 v113, v116, v114, s29
    v_and_b32 v114, 0x3fff, v92
    s_waitcnt vmcnt(30)
    v_cndmask_b32 v110, v118, v113, s[44:45]
    v_smfmac_f32_16x16x64_bf16 v[136:139], a[84:87], v[196:203], v21 abid:1
    buffer_load_dwordx4 a[196:199], v11, s[16:19], s43 offen offset:1024 sc1
    ds_write_b32 v112, v114
    ds_write_b32 v110, v93
    v_and_b32 v110, 8, v94
    v_smfmac_f32_16x16x64_bf16 v[172:175], a[84:87], v[228:235], v21 abid:1
    v_lshrrev_b32 v113, 14, v94
    v_cmp_ne_u32 s[44:45], 0, v110
    v_and_b32 v116, 0x3cf0, v113
    s_waitcnt lgkmcnt(8)
    s_waitcnt vmcnt(30)
    v_lshrrev_b32 v111, 16, v99
    v_smfmac_f32_16x16x64_bf16 v[140:143], a[88:91], v[196:203], v22
    buffer_load_dwordx4 a[200:203], v11, s[16:19], s43 offen offset:2048 sc1
    v_and_b32 v112, 0xffff, v99
    v_smfmac_f32_16x16x64_bf16 v[176:179], a[88:91], v[228:235], v22
    v_sub_u32 v110, 15, v111
    v_and_b32 v99, 2.0, v94
    v_add3_u32 v99, v112, v111, v99
    v_cndmask_b32 v110, v112, v110, s[44:45]
    s_waitcnt vmcnt(30)
    v_cmp_gt_u32 s[44:45], 16, v99
    v_smfmac_f32_16x16x64_bf16 v[144:147], a[92:95], v[196:203], v22 abid:1
    buffer_load_dwordx4 a[204:207], v11, s[16:19], s43 offen offset:3072 sc1
    v_cmp_gt_u32 s[36:37], 2.0, v99
    v_smfmac_f32_16x16x64_bf16 v[180:183], a[92:95], v[228:235], v22 abid:1
    v_lshlrev_b32 v110, 2, v110
    s_waitcnt vmcnt(30)
    v_lshrrev_b64 v[112:113], v110, s[50:51]
    v_smfmac_f32_16x16x64_bf16 v[148:151], a[96:99], v[196:203], v23
    s_add_u32 s43, s43, 4096
    buffer_load_dwordx4 a[208:211], v11, s[16:19], s43 offen offset:0 sc1
    s_andn2_b64 s[36:37], s[36:37], s[44:45]
    v_lshrrev_b64 v[114:115], v110, s[52:53]
    v_smfmac_f32_16x16x64_bf16 v[184:187], a[96:99], v[228:235], v23
    v_bfe_u32 v110, v94, 24, 4
    v_mbcnt_lo_u32_b32 v111, s36, 0
    v_and_b32 v112, 15, v112
    v_mbcnt_hi_u32_b32 v111, s37, v111
    v_and_b32 v114, 15, v114
    s_waitcnt vmcnt(30)
    v_lshl_add_u32 v111, v111, 3, s40
    v_smfmac_f32_16x16x64_bf16 v[152:155], a[100:103], v[196:203], v23 abid:1
    buffer_load_dwordx4 a[212:215], v11, s[16:19], s43 offen offset:1024 sc1
    v_lshl_add_u32 v112, v110, 4, v112
    v_smfmac_f32_16x16x64_bf16 v[188:191], a[100:103], v[228:235], v23 abid:1
    v_min_u32 v111, s41, v111
    v_mul_u32_u24 v114, 68, v114
    s_waitcnt vmcnt(30)
    v_cndmask_b32 v111, v118, v111, s[36:37]
    v_smfmac_f32_16x16x64_bf16 v[156:159], a[104:107], v[196:203], v49
    buffer_load_dwordx4 v[36:39], v11, s[16:19], s43 offen offset:2048 sc1
    buffer_load_dwordx4 a[216:219], v11, s[16:19], s43 offen offset:3072 sc1
    ds_write_b64 v111, v[94:95]
    s_bcnt1_i32_b64 s30, s[36:37]
    s_lshl3_add_u32 s40, s30, s40
    v_lshl_add_u32 v112, v112, 2, s47
    v_smfmac_f32_16x16x64_bf16 v[192:195], a[104:107], v[228:235], v49
    v_and_b32 v114, 0x30c, v114
    v_cndmask_b32 v112, v118, v112, s[44:45]
    v_add3_u32 v113, v116, v114, s29
    v_and_b32 v114, 0x3fff, v94
    s_waitcnt vmcnt(30)
    s_waitcnt lgkmcnt(6)
    v_cndmask_b32 v110, v118, v113, s[44:45]
    v_smfmac_f32_16x16x64_bf16 v[124:127], a[108:111], v[204:211], v24
    s_add_u32 s43, s43, 4096
    buffer_load_dwordx4 a[220:223], v11, s[16:19], s43 offen offset:0 sc1
    ds_write_b32 v112, v114
    ds_write_b32 v110, v95
    s_waitcnt lgkmcnt(6)
    v_lshrrev_b32 v110, 16, v117
    v_smfmac_f32_16x16x64_bf16 v[160:163], a[108:111], v[220:227], v24
    ds_read_b128 v[196:199], v1 offset:4096
    ds_read_b128 v[200:203], v2 offset:4096
    v_and_b32 v117, 0xffff, v117
    v_add_u32 v117, v117, v110
    s_waitcnt vmcnt(30)
    v_cmp_lt_u32 s[34:35], 16, v117
    v_smfmac_f32_16x16x64_bf16 v[128:131], a[112:115], v[204:211], v24 abid:1
    buffer_load_dwordx4 a[224:227], v11, s[16:19], s43 offen offset:1024 sc1
    s_sub_u32 s46, s40, s48
    s_add_u32 s46, s46, 56
    s_lshr_b32 s46, s46, 6
    s_mov_b32 s21, 0
    s_and_b32 s27, s34, 0x1ff
    s_cmp_gt_u32 s46, 4
    s_cselect_b32 s32, 1, s32
    s_or_b32 s32, s32, s33
    s_cbranch_scc1 M_dn
M_dnr:
    ds_read_b128 v[92:95], v9 offset:9792
    s_bcnt1_i32_b32 s30, s27
    s_cmp_gt_u32 s30, 3
    s_cselect_b32 s34, 0, s27
    s_cselect_b32 s80, 0, 1
    s_getpc_b64 s[36:37]
M_pc:
    v_bfe_u32 v110, v11, 4, 4
    v_smfmac_f32_16x16x64_bf16 v[164:167], a[112:115], v[220:227], v24 abid:1
    ds_read_b128 v[228:231], v1 offset:22528
    ds_read_b128 v[232:235], v2 offset:22528
    s_waitcnt vmcnt(30)
    v_smfmac_f32_16x16x64_bf16 v[132:135], a[116:119], v[204:211], v25
    buffer_load_dwordx4 a[228:231], v11, s[16:19], s43 offen offset:2048 sc1
    s_ff1_i32_b32 s81, s34
    s_bitset0_b32 s34, s81
    s_mul_i32 s30, s81, 20
    s_add_u32 s31, s30, M_ovc0-M_pc
    s_add_u32 s30, s30, M_ovl0-M_pc
    s_cmp_lg_u32 s34, 0
    s_cselect_b32 s30, s31, s30
    s_cmp_lt_i32 s81, 0
    s_cselect_b32 s30, M_ovn-M_pc, s30
    s_add_u32 s72, s36, s30
    s_addc_u32 s73, s37, 0
    s_ff1_i32_b32 s82, s34
    s_bitset0_b32 s34, s82
    s_mul_i32 s30, s82, 20
    s_add_u32 s31, s30, M_ovc1-M_pc
    s_add_u32 s30, s30, M_ovl1-M_pc
    s_cmp_lg_u32 s34, 0
    s_cselect_b32 s30, s31, s30
    s_cmp_lt_i32 s82, 0
    s_cselect_b32 s30, M_ovn-M_pc, s30
    v_smfmac_f32_16x16x64_bf16 v[168:171], a[116:119], v[220:227], v25
    s_waitcnt vmcnt(30)
    v_smfmac_f32_16x16x64_bf16 v[136:139], a[120:123], v[204:211], v25 abid:1
    buffer_load_dwordx4 a[232:235], v11, s[16:19], s43 offen offset:3072 sc1
    s_add_u32 s74, s36, s30
    s_addc_u32 s75, s37, 0
    s_ff1_i32_b32 s83, s34
    s_bitset0_b32 s34, s83
    s_mul_i32 s30, s83, 20
    s_add_u32 s31, s30, M_ovc1-M_pc
    s_add_u32 s30, s30, M_ovl2-M_pc
    s_cmp_lg_u32 s34, 0
    s_cselect_b32 s30, s31, s30
    s_cmp_lt_i32 s83, 0
    s_cselect_b32 s30, M_ovn-M_pc, s30
    s_add_u32 s76, s36, s30
    s_addc_u32 s77, s37, 0
    s_waitcnt lgkmcnt(2)
    v_lshrrev_b32 v112, 18, v92
    v_smfmac_f32_16x16x64_bf16 v[172:175], a[120:123], v[220:227], v25 abid:1
    s_waitcnt vmcnt(30)
    v_lshrrev_b32 v113, 18, v94
    v_smfmac_f32_16x16x64_bf16 v[140:143], a[124:127], v[204:211], v26
    s_add_u32 s43, s43, 4096
    buffer_load_dwordx4 a[236:239], v11, s[16:19], s43 offen offset:0 sc1
    v_and_b32 v114, 0x3fff, v92
    v_smfmac_f32_16x16x64_bf16 v[176:179], a[124:127], v[220:227], v26
    s_waitcnt vmcnt(30)
    v_and_b32 v115, 0x3fff, v94
    v_smfmac_f32_16x16x64_bf16 v[144:147], a[128:131], v[204:211], v26 abid:1
    buffer_load_dwordx4 a[240:243], v11, s[16:19], s43 offen offset:1024 sc1
    ds_write_b64 v9, v[114:115] offset:10056
    v_lshl_or_b32 v111, s81, 6, v110
    v_smfmac_f32_16x16x64_bf16 v[180:183], a[128:131], v[220:227], v26 abid:1
    v_cmp_eq_u32 s[44:45], v112, v111
    v_cmp_eq_u32 s[36:37], v113, v111
    s_nop 0
    v_cndmask_b32 v54, 0, v93, s[44:45]
    v_cndmask_b32 v55, 0, v95, s[36:37]
    v_lshl_or_b32 v111, s82, 6, v110
    s_waitcnt vmcnt(30)
    v_cmp_eq_u32 s[44:45], v112, v111
    v_smfmac_f32_16x16x64_bf16 v[148:151], a[132:135], v[204:211], v27
    buffer_load_dwordx4 a[244:247], v11, s[16:19], s43 offen offset:2048 sc1
    v_cmp_eq_u32 s[36:37], v113, v111
    v_smfmac_f32_16x16x64_bf16 v[184:187], a[132:135], v[220:227], v27
    v_cndmask_b32 v252, 0, v93, s[44:45]
    v_cndmask_b32 v253, 0, v95, s[36:37]
    v_lshl_or_b32 v111, s83, 6, v110
    v_cmp_eq_u32 s[44:45], v112, v111
    v_cmp_eq_u32 s[36:37], v113, v111
    s_nop 0
    s_waitcnt vmcnt(30)
    v_cndmask_b32 v254, 0, v93, s[44:45]
    v_smfmac_f32_16x16x64_bf16 v[152:155], a[136:139], v[204:211], v27 abid:1
    buffer_load_dwordx4 a[248:251], v11, s[16:19], s43 offen offset:3072 sc1
    v_cndmask_b32 v255, 0, v95, s[36:37]
    v_smfmac_f32_16x16x64_bf16 v[188:191], a[136:139], v[220:227], v27 abid:1
    ds_read_b128 v[236:239], v9 offset:9408
    ds_read_b64 v[216:217], v9 offset:10056
    s_waitcnt vmcnt(30)
    v_smfmac_f32_16x16x64_bf16 v[156:159], a[140:143], v[204:211], v49 abid:1
    s_add_u32 s43, s43, 4096
    buffer_load_dwordx4 v[40:43], v11, s[16:19], s43 offen offset:0 sc1
    buffer_load_dwordx4 a[252:255], v11, s[16:19], s43 offen offset:1024 sc1
    s_waitcnt lgkmcnt(1)
    v_xad_u32 v236, v236, v3, v4
    v_smfmac_f32_16x16x64_bf16 v[192:195], a[140:143], v[220:227], v49 abid:1
    s_waitcnt vmcnt(30)
    v_xad_u32 v237, v237, v3, v4
    v_smfmac_f32_16x16x64_bf16 v[124:127], a[144:147], v[196:203], v28
    buffer_load_dwordx4 v[56:59], v11, s[16:19], s43 offen offset:2048 sc1
    ds_read2st64_b32 v[244:245], v236 offset0:0 offset1:72
    ds_read2st64_b32 v[246:247], v237 offset0:0 offset1:72
    v_xad_u32 v238, v238, v3, v4
    v_smfmac_f32_16x16x64_bf16 v[160:163], a[144:147], v[228:235], v28
    ds_read_b128 v[204:207], v1 offset:5120
    ds_read_b128 v[208:211], v2 offset:5120
    s_waitcnt vmcnt(30)
    v_xad_u32 v239, v239, v3, v4
    v_smfmac_f32_16x16x64_bf16 v[128:131], a[148:151], v[196:203], v28 abid:1
    buffer_load_dwordx4 v[60:63], v11, s[16:19], s43 offen offset:3072 sc1
    ds_read2st64_b32 v[248:249], v238 offset0:0 offset1:72
    ds_read2st64_b32 v[250:251], v239 offset0:0 offset1:72
    ds_read_b128 v[240:243], v8 offset:3072
    ds_read_b128 v[236:239], v9 offset:9280
    s_waitcnt lgkmcnt(8)
    v_xad_u32 v212, v216, v3, v4
    v_smfmac_f32_16x16x64_bf16 v[164:167], a[148:151], v[228:235], v28 abid:1
    ds_read_b128 v[220:223], v1 offset:23552
    ds_read_b128 v[224:227], v2 offset:23552
    ds_read2st64_b32 v[212:213], v212 offset0:0 offset1:72
    s_waitcnt vmcnt(30)
    v_xad_u32 v214, v217, v3, v4
    v_smfmac_f32_16x16x64_bf16 v[132:135], a[152:155], v[196:203], v29
    s_add_u32 s43, s43, 4096
    buffer_load_dwordx4 v[64:67], v11, s[16:19], s43 offen offset:0 sc1
    ds_read2st64_b32 v[214:215], v214 offset0:0 offset1:72
    v_smfmac_f32_16x16x64_bf16 v[168:171], a[152:155], v[228:235], v29
    s_waitcnt vmcnt(30)
    v_smfmac_f32_16x16x64_bf16 v[136:139], a[156:159], v[196:203], v29 abid:1
    buffer_load_dwordx4 v[68:71], v11, s[16:19], s43 offen offset:1024 sc1
    v_smfmac_f32_16x16x64_bf16 v[172:175], a[156:159], v[228:235], v29 abid:1
    s_waitcnt vmcnt(30)
    v_smfmac_f32_16x16x64_bf16 v[140:143], a[160:163], v[196:203], v30
    buffer_load_dwordx4 v[72:75], v11, s[16:19], s43 offen offset:2048 sc1
    s_waitcnt lgkmcnt(5)
    v_smfmac_f32_16x16x64_bf16 v[136:139], v[240:243], v[244:251], v10
    v_smfmac_f32_16x16x64_bf16 v[172:175], v[240:243], v[244:251], v10 abid:1
    s_waitcnt lgkmcnt(4)
    v_xad_u32 v236, v236, v3, v4
    v_smfmac_f32_16x16x64_bf16 v[176:179], a[160:163], v[228:235], v30
    s_waitcnt vmcnt(30)
    v_xad_u32 v237, v237, v3, v4
    v_smfmac_f32_16x16x64_bf16 v[144:147], a[164:167], v[196:203], v30 abid:1
    buffer_load_dwordx4 v[76:79], v11, s[16:19], s43 offen offset:3072 sc1
    ds_read2st64_b32 v[244:245], v236 offset0:0 offset1:72
    ds_read2st64_b32 v[246:247], v237 offset0:0 offset1:72
    v_xad_u32 v238, v238, v3, v4
    v_smfmac_f32_16x16x64_bf16 v[180:183], a[164:167], v[228:235], v30 abid:1
    s_waitcnt vmcnt(30)
    v_xad_u32 v239, v239, v3, v4
    v_smfmac_f32_16x16x64_bf16 v[148:151], a[168:171], v[196:203], v31
    s_add_u32 s43, s43, 4096
    buffer_load_dwordx4 v[80:83], v11, s[16:19], s43 offen offset:0 sc1
    ds_read2st64_b32 v[248:249], v238 offset0:0 offset1:72
    ds_read2st64_b32 v[250:251], v239 offset0:0 offset1:72
    ds_read_b128 v[240:243], v8 offset:1024
    ds_read_b128 v[236:239], v9 offset:9344
    v_smfmac_f32_16x16x64_bf16 v[184:187], a[168:171], v[228:235], v31
    s_waitcnt vmcnt(30)
    v_smfmac_f32_16x16x64_bf16 v[152:155], a[172:175], v[196:203], v31 abid:1
    buffer_load_dwordx4 v[84:87], v11, s[16:19], s43 offen offset:1024 sc1
    s_waitcnt lgkmcnt(6)
    s_cmp_lt_i32 s81, 0
    s_cbranch_scc1 M_ovr0
    s_swappc_b64 s[78:79], s[72:73]
M_ovr0:
    v_smfmac_f32_16x16x64_bf16 v[188:191], a[172:175], v[228:235], v31 abid:1
    s_waitcnt vmcnt(30)
    v_smfmac_f32_16x16x64_bf16 v[156:159], a[176:179], v[196:203], v50
    buffer_load_dwordx4 v[44:47], v11, s[16:19], s43 offen offset:2048 sc1
    buffer_load_dwordx4 v[88:91], v11, s[16:19], s43 offen offset:3072 sc1
    v_smfmac_f32_16x16x64_bf16 v[192:195], a[176:179], v[228:235], v50
    s_waitcnt vmcnt(30)
    v_smfmac_f32_16x16x64_bf16 v[124:127], a[180:183], v[204:211], v32
    s_add_u32 s43, s43, 4096
    buffer_load_dwordx4 v[92:95], v11, s[16:19], s43 offen offset:0 sc1
    s_waitcnt lgkmcnt(1)
    v_smfmac_f32_16x16x64_bf16 v[128:131], v[240:243], v[244:251], v10
    v_smfmac_f32_16x16x64_bf16 v[164:167], v[240:243], v[244:251], v10 abid:1
    s_waitcnt lgkmcnt(0)
    v_xad_u32 v236, v236, v3, v4
    v_smfmac_f32_16x16x64_bf16 v[160:163], a[180:183], v[220:227], v32
    ds_read_b128 v[196:199], v1 offset:6144
    ds_read_b128 v[200:203], v2 offset:6144
    s_waitcnt vmcnt(30)
    v_xad_u32 v237, v237, v3, v4
    v_smfmac_f32_16x16x64_bf16 v[128:131], a[184:187], v[204:211], v32 abid:1
    buffer_load_dwordx4 v[96:99], v11, s[16:19], s43 offen offset:1024 sc1
    ds_read2st64_b32 v[244:245], v236 offset0:0 offset1:72
    ds_read2st64_b32 v[246:247], v237 offset0:0 offset1:72
    v_xad_u32 v238, v238, v3, v4
    v_smfmac_f32_16x16x64_bf16 v[164:167], a[184:187], v[220:227], v32 abid:1
    ds_read_b128 v[228:231], v1 offset:24576
    ds_read_b128 v[232:235], v2 offset:24576
    s_waitcnt vmcnt(30)
    v_xad_u32 v239, v239, v3, v4
    v_smfmac_f32_16x16x64_bf16 v[132:135], a[188:191], v[204:211], v33
    buffer_load_dwordx4 v[100:103], v11, s[16:19], s43 offen offset:2048 sc1
    ds_read2st64_b32 v[248:249], v238 offset0:0 offset1:72
    ds_read2st64_b32 v[250:251], v239 offset0:0 offset1:72
    ds_read_b128 v[240:243], v8 offset:2048
    ds_read_b128 v[236:239], v9 offset:9216
    v_smfmac_f32_16x16x64_bf16 v[168:171], a[188:191], v[220:227], v33
    s_waitcnt vmcnt(30)
    v_smfmac_f32_16x16x64_bf16 v[136:139], a[192:195], v[204:211], v33 abid:1
    buffer_load_dwordx4 v[104:107], v11, s[16:19], s43 offen offset:3072 sc1
    v_smfmac_f32_16x16x64_bf16 v[172:175], a[192:195], v[220:227], v33 abid:1
    s_waitcnt vmcnt(30)
    v_smfmac_f32_16x16x64_bf16 v[140:143], a[196:199], v[204:211], v34
    s_add_u32 s43, s43, 4096
    buffer_load_dwordx4 v[108:111], v11, s[16:19], s43 offen offset:0 sc1
    v_smfmac_f32_16x16x64_bf16 v[176:179], a[196:199], v[220:227], v34
    s_waitcnt vmcnt(30)
    v_smfmac_f32_16x16x64_bf16 v[144:147], a[200:203], v[204:211], v34 abid:1
    buffer_load_dwordx4 v[112:115], v11, s[16:19], s43 offen offset:1024 sc1
    s_waitcnt lgkmcnt(1)
    v_smfmac_f32_16x16x64_bf16 v[132:135], v[240:243], v[244:251], v10
    v_smfmac_f32_16x16x64_bf16 v[168:171], v[240:243], v[244:251], v10 abid:1
    s_waitcnt lgkmcnt(0)
    v_xad_u32 v236, v236, v3, v4
    v_smfmac_f32_16x16x64_bf16 v[180:183], a[200:203], v[220:227], v34 abid:1
    s_waitcnt vmcnt(30)
    v_xad_u32 v237, v237, v3, v4
    v_smfmac_f32_16x16x64_bf16 v[148:151], a[204:207], v[204:211], v35
    buffer_load_dwordx4 v[116:119], v11, s[16:19], s43 offen offset:2048 sc1
    ds_read2st64_b32 v[244:245], v236 offset0:0 offset1:72
    ds_read2st64_b32 v[246:247], v237 offset0:0 offset1:72
    v_xad_u32 v238, v238, v3, v4
    v_smfmac_f32_16x16x64_bf16 v[184:187], a[204:207], v[220:227], v35
    s_waitcnt vmcnt(30)
    v_xad_u32 v239, v239, v3, v4
    v_smfmac_f32_16x16x64_bf16 v[152:155], a[208:211], v[204:211], v35 abid:1
    buffer_load_dwordx4 v[120:123], v11, s[16:19], s43 offen offset:3072 sc1
    ds_read2st64_b32 v[248:249], v238 offset0:0 offset1:72
    ds_read2st64_b32 v[250:251], v239 offset0:0 offset1:72
    ds_read_b128 v[240:243], v8 offset:0
    ds_read_b128 v[236:239], v9 offset:9728
    v_smfmac_f32_16x16x64_bf16 v[188:191], a[208:211], v[220:227], v35 abid:1
    s_waitcnt vmcnt(30)
    v_smfmac_f32_16x16x64_bf16 v[156:159], a[212:215], v[204:211], v50 abid:1
    s_add_u32 m0, s29, 11840
    s_nop 0
    buffer_load_dword v0, s[8:11], 0 offen lds
    v_smfmac_f32_16x16x64_bf16 v[192:195], a[212:215], v[220:227], v50 abid:1
    s_waitcnt vmcnt(29)
    v_smfmac_f32_16x16x64_bf16 v[124:127], a[216:219], v[196:203], v36
    v_smfmac_f32_16x16x64_bf16 v[160:163], a[216:219], v[228:235], v36
    ds_read_b128 v[204:207], v1 offset:7168
    ds_read_b128 v[208:211], v2 offset:7168
    s_waitcnt vmcnt(28)
    v_smfmac_f32_16x16x64_bf16 v[128:131], a[220:223], v[196:203], v36 abid:1
    s_waitcnt lgkmcnt(3)
    v_smfmac_f32_16x16x64_bf16 v[124:127], v[240:243], v[244:251], v10
    v_smfmac_f32_16x16x64_bf16 v[160:163], v[240:243], v[244:251], v10 abid:1
    s_waitcnt lgkmcnt(2)
    v_xad_u32 v236, v236, v3, v4
    v_smfmac_f32_16x16x64_bf16 v[164:167], a[220:223], v[228:235], v36 abid:1
    ds_read_b128 v[220:223], v1 offset:25600
    ds_read_b128 v[224:227], v2 offset:25600
    s_waitcnt vmcnt(27)
    v_xad_u32 v237, v237, v3, v4
    v_smfmac_f32_16x16x64_bf16 v[132:135], a[224:227], v[196:203], v37
    ds_read2st64_b32 v[244:245], v236 offset0:0 offset1:72
    ds_read2st64_b32 v[246:247], v237 offset0:0 offset1:72
    v_xad_u32 v238, v238, v3, v4
    v_smfmac_f32_16x16x64_bf16 v[168:171], a[224:227], v[228:235], v37
    s_waitcnt vmcnt(26)
    v_xad_u32 v239, v239, v3, v4
    v_smfmac_f32_16x16x64_bf16 v[136:139], a[228:231], v[196:203], v37 abid:1
    ds_read2st64_b32 v[248:249], v238 offset0:0 offset1:72
    ds_read2st64_b32 v[250:251], v239 offset0:0 offset1:72
    ds_read_b128 v[240:243], v8 offset:8192
    ds_read_b128 v[236:239], v9 offset:9664
    v_smfmac_f32_16x16x64_bf16 v[172:175], a[228:231], v[228:235], v37 abid:1
    s_waitcnt vmcnt(25)
    v_smfmac_f32_16x16x64_bf16 v[140:143], a[232:235], v[196:203], v38
    v_smfmac_f32_16x16x64_bf16 v[176:179], a[232:235], v[228:235], v38
    s_waitcnt vmcnt(24)
    v_smfmac_f32_16x16x64_bf16 v[144:147], a[236:239], v[196:203], v38 abid:1
    v_smfmac_f32_16x16x64_bf16 v[180:183], a[236:239], v[228:235], v38 abid:1
    s_waitcnt vmcnt(23)
    v_smfmac_f32_16x16x64_bf16 v[148:151], a[240:243], v[196:203], v39
    s_mov_b32 m0, s42
    s_nop 0
    buffer_load_dwordx4 v5, s[8:11], s22 offen offset:0 nt lds
    s_waitcnt lgkmcnt(1)
    v_smfmac_f32_16x16x64_bf16 v[156:159], v[240:243], v[244:251], v10
    v_smfmac_f32_16x16x64_bf16 v[192:195], v[240:243], v[244:251], v10 abid:1
    s_waitcnt lgkmcnt(0)
    v_xad_u32 v236, v236, v3, v4
    v_smfmac_f32_16x16x64_bf16 v[184:187], a[240:243], v[228:235], v39
    s_waitcnt vmcnt(23)
    v_xad_u32 v237, v237, v3, v4
    v_smfmac_f32_16x16x64_bf16 v[152:155], a[244:247], v[196:203], v39 abid:1
    ds_read2st64_b32 v[244:245], v236 offset0:0 offset1:72
    ds_read2st64_b32 v[246:247], v237 offset0:0 offset1:72
    v_xad_u32 v238, v238, v3, v4
    v_smfmac_f32_16x16x64_bf16 v[188:191], a[244:247], v[228:235], v39 abid:1
    s_waitcnt vmcnt(22)
    v_xad_u32 v239, v239, v3, v4
    v_smfmac_f32_16x16x64_bf16 v[156:159], a[248:251], v[196:203], v51
    s_add_u32 m0, m0, 896
    s_nop 0
    buffer_load_dwordx4 v5, s[8:11], s22 offen offset:128 nt lds
    ds_read2st64_b32 v[248:249], v238 offset0:0 offset1:72
    ds_read2st64_b32 v[250:251], v239 offset0:0 offset1:72
    ds_read_b128 v[240:243], v8 offset:7168
    ds_read_b128 v[236:239], v9 offset:9536
    v_smfmac_f32_16x16x64_bf16 v[192:195], a[248:251], v[228:235], v51
    s_waitcnt vmcnt(21)
    v_smfmac_f32_16x16x64_bf16 v[124:127], a[252:255], v[204:211], v40
    ds_read_b128 v[196:199], v1 offset:8192
    ds_read_b128 v[200:203], v2 offset:8192
    s_waitcnt vmcnt(20)
    v_smfmac_f32_16x16x64_bf16 v[128:131], v[56:59], v[204:211], v40 abid:1
    s_add_u32 m0, m0, 896
    s_nop 0
    buffer_load_dwordx4 v5, s[8:11], s22 offen offset:256 nt lds
    ds_read_b128 v[228:231], v1 offset:26624
    ds_read_b128 v[232:235], v2 offset:26624
    s_waitcnt vmcnt(20)
    v_smfmac_f32_16x16x64_bf16 v[132:135], v[60:63], v[204:211], v41
    s_waitcnt lgkmcnt(5)
    v_smfmac_f32_16x16x64_bf16 v[152:155], v[240:243], v[244:251], v10
    v_smfmac_f32_16x16x64_bf16 v[188:191], v[240:243], v[244:251], v10 abid:1
    s_waitcnt lgkmcnt(4)
    v_xad_u32 v236, v236, v3, v4
    s_waitcnt vmcnt(19)
    v_xad_u32 v237, v237, v3, v4
    v_smfmac_f32_16x16x64_bf16 v[136:139], v[64:67], v[204:211], v41 abid:1
    s_add_u32 m0, m0, 896
    s_nop 0
    buffer_load_dwordx4 v5, s[8:11], s22 offen offset:384 nt lds
    ds_read2st64_b32 v[244:245], v236 offset0:0 offset1:72
    ds_read2st64_b32 v[246:247], v237 offset0:0 offset1:72
    v_xad_u32 v238, v238, v3, v4
    s_waitcnt vmcnt(19)
    v_xad_u32 v239, v239, v3, v4
    v_smfmac_f32_16x16x64_bf16 v[140:143], v[68:71], v[204:211], v42
    ds_read2st64_b32 v[248:249], v238 offset0:0 offset1:72
    ds_read2st64_b32 v[250:251], v239 offset0:0 offset1:72
    ds_read_b128 v[240:243], v8 offset:5120
    ds_read_b128 v[236:239], v9 offset:9600
    s_waitcnt vmcnt(18)
    v_smfmac_f32_16x16x64_bf16 v[144:147], v[72:75], v[204:211], v42 abid:1
    s_waitcnt vmcnt(17)
    v_smfmac_f32_16x16x64_bf16 v[148:151], v[76:79], v[204:211], v43
    s_waitcnt vmcnt(16)
    v_smfmac_f32_16x16x64_bf16 v[152:155], v[80:83], v[204:211], v43 abid:1
    s_waitcnt lgkmcnt(1)
    v_smfmac_f32_16x16x64_bf16 v[144:147], v[240:243], v[244:251], v10
    v_smfmac_f32_16x16x64_bf16 v[180:183], v[240:243], v[244:251], v10 abid:1
    s_waitcnt lgkmcnt(0)
    v_xad_u32 v236, v236, v3, v4
    s_waitcnt vmcnt(15)
    v_xad_u32 v237, v237, v3, v4
    v_smfmac_f32_16x16x64_bf16 v[156:159], v[84:87], v[204:211], v51 abid:1
    ds_read2st64_b32 v[244:245], v236 offset0:0 offset1:72
    ds_read2st64_b32 v[246:247], v237 offset0:0 offset1:72
    v_xad_u32 v238, v238, v3, v4
    s_waitcnt vmcnt(13)
    v_xad_u32 v239, v239, v3, v4
    v_smfmac_f32_16x16x64_bf16 v[124:127], v[88:91], v[196:203], v44
    ds_read2st64_b32 v[248:249], v238 offset0:0 offset1:72
    ds_read2st64_b32 v[250:251], v239 offset0:0 offset1:72
    ds_read_b128 v[240:243], v8 offset:6144
    ds_read_b128 v[236:239], v9 offset:9472
    s_waitcnt vmcnt(12)
    v_smfmac_f32_16x16x64_bf16 v[128:131], v[92:95], v[196:203], v44 abid:1
    s_waitcnt vmcnt(11)
    v_smfmac_f32_16x16x64_bf16 v[132:135], v[96:99], v[196:203], v45
    s_waitcnt vmcnt(10)
    v_smfmac_f32_16x16x64_bf16 v[136:139], v[100:103], v[196:203], v45 abid:1
    s_waitcnt lgkmcnt(1)
    v_smfmac_f32_16x16x64_bf16 v[148:151], v[240:243], v[244:251], v10
    v_smfmac_f32_16x16x64_bf16 v[184:187], v[240:243], v[244:251], v10 abid:1
    s_waitcnt lgkmcnt(0)
    v_xad_u32 v236, v236, v3, v4
    s_waitcnt vmcnt(9)
    v_xad_u32 v237, v237, v3, v4
    v_smfmac_f32_16x16x64_bf16 v[140:143], v[104:107], v[196:203], v46
    ds_read2st64_b32 v[244:245], v236 offset0:0 offset1:72
    ds_read2st64_b32 v[246:247], v237 offset0:0 offset1:72
    v_xad_u32 v238, v238, v3, v4
    s_waitcnt vmcnt(8)
    v_xad_u32 v239, v239, v3, v4
    v_smfmac_f32_16x16x64_bf16 v[144:147], v[108:111], v[196:203], v46 abid:1
    ds_read2st64_b32 v[248:249], v238 offset0:0 offset1:72
    ds_read2st64_b32 v[250:251], v239 offset0:0 offset1:72
    ds_read_b128 v[240:243], v8 offset:4096
    s_waitcnt vmcnt(7)
    v_smfmac_f32_16x16x64_bf16 v[148:151], v[112:115], v[196:203], v47
    s_waitcnt vmcnt(6)
    v_smfmac_f32_16x16x64_bf16 v[152:155], v[116:119], v[196:203], v47 abid:1
    s_waitcnt vmcnt(5)
    v_smfmac_f32_16x16x64_bf16 v[156:159], v[120:123], v[196:203], v52
    s_waitcnt lgkmcnt(0)
    v_smfmac_f32_16x16x64_bf16 v[140:143], v[240:243], v[244:251], v10
    v_smfmac_f32_16x16x64_bf16 v[176:179], v[240:243], v[244:251], v10 abid:1
    s_cmp_gt_u32 s46, s80
    s_cbranch_scc1 M_slow
M_slowr0:
    s_cmp_eq_u32 s20, 0
    s_mov_b32 s31, 1073903880
    s_cselect_b32 s30, 162048, s31
    v_mov_b32 v11, s31
    v_writelane_b32 v11, s30, 0
    v_cvt_pk_bf16_f32 v124, v124, v125
    v_cvt_pk_bf16_f32 v125, v126, v127
    v_cvt_pk_bf16_f32 v126, v128, v129
    v_cvt_pk_bf16_f32 v127, v130, v131
    v_cvt_pk_bf16_f32 v132, v132, v133
    v_cvt_pk_bf16_f32 v133, v134, v135
    v_cvt_pk_bf16_f32 v134, v136, v137
    v_cvt_pk_bf16_f32 v135, v138, v139
    ds_read_b128 v[136:139], v9 offset:10432
    v_cndmask_b32_dpp v128, v124, v132, vcc row_ror:8 row_mask:0xf bank_mask:0xf
    v_cndmask_b32_dpp v129, v125, v133, vcc row_ror:8 row_mask:0xf bank_mask:0xf
    v_cndmask_b32_dpp v130, v126, v134, vcc row_ror:8 row_mask:0xf bank_mask:0xf
    v_cndmask_b32_dpp v131, v127, v135, vcc row_ror:8 row_mask:0xf bank_mask:0xf
    buffer_store_dwordx4 v[128:131], v6, s[12:15], s59 offen offset:0 sc1
    v_mov_b32_dpp v124, v132 row_ror:8 row_mask:0xf bank_mask:0xc
    v_mov_b32_dpp v125, v133 row_ror:8 row_mask:0xf bank_mask:0xc
    v_mov_b32_dpp v126, v134 row_ror:8 row_mask:0xf bank_mask:0xc
    v_mov_b32_dpp v127, v135 row_ror:8 row_mask:0xf bank_mask:0xc
    buffer_store_dwordx4 v[124:127], v6, s[12:15], s24 offen offset:0 sc1
    ds_read_b128 v[128:131], v9 offset:10304
    ds_read_b128 v[132:135], v9 offset:10368
    ds_read_b128 v[124:127], v9 offset:10240
    v_cvt_pk_bf16_f32 v140, v140, v141
    v_cvt_pk_bf16_f32 v141, v142, v143
    v_cvt_pk_bf16_f32 v142, v144, v145
    v_cvt_pk_bf16_f32 v143, v146, v147
    v_cvt_pk_bf16_f32 v148, v148, v149
    v_cvt_pk_bf16_f32 v149, v150, v151
    v_cvt_pk_bf16_f32 v150, v152, v153
    v_cvt_pk_bf16_f32 v151, v154, v155
    ds_read_b128 v[152:155], v9 offset:10688
    v_cndmask_b32_dpp v144, v140, v148, vcc row_ror:8 row_mask:0xf bank_mask:0xf
    v_cndmask_b32_dpp v145, v141, v149, vcc row_ror:8 row_mask:0xf bank_mask:0xf
    v_cndmask_b32_dpp v146, v142, v150, vcc row_ror:8 row_mask:0xf bank_mask:0xf
    v_cndmask_b32_dpp v147, v143, v151, vcc row_ror:8 row_mask:0xf bank_mask:0xf
    buffer_store_dwordx4 v[144:147], v6, s[12:15], s59 offen offset:128 sc1
    v_mov_b32_dpp v140, v148 row_ror:8 row_mask:0xf bank_mask:0xc
    v_mov_b32_dpp v141, v149 row_ror:8 row_mask:0xf bank_mask:0xc
    v_mov_b32_dpp v142, v150 row_ror:8 row_mask:0xf bank_mask:0xc
    v_mov_b32_dpp v143, v151 row_ror:8 row_mask:0xf bank_mask:0xc
    buffer_store_dwordx4 v[140:143], v6, s[12:15], s24 offen offset:128 sc1
    ds_read_b128 v[144:147], v9 offset:10560
    ds_read_b128 v[148:151], v9 offset:10624
    ds_read_b128 v[140:143], v9 offset:10496
    v_cvt_pk_bf16_f32 v156, v156, v157
    v_cvt_pk_bf16_f32 v157, v158, v159
    ds_write_b64 v53, v[156:157] offset:25728
    ds_read_b128 v[156:159], v9 offset:10752
    s_mov_b32 s89, 0
    s_mov_b32 s101, 34209792
    s_mov_b32 s91, 0
    s_mov_b32 s25, 36864
    s_add_u32 s90, s24, 9437184
    s_mov_b32 s28, s26
    s_add_u32 s23, s24, 18432
    s_cmp_lt_u32 s20, 2
    s_cselect_b32 s66, s23, s24
    s_cselect_b32 s99, s14, 75497472
    s_add_u32 s66, s66, s95
    v_add_u32 v4, 36864, v4
    v_add_u32 v1, 36864, v1
    v_add_u32 v2, 36864, v2
M_top:
M_top1:
    s_add_u32 s23, s24, 18432
    s_add_u32 s58, s24, 27648
    s_mov_b32 s24, s90
    s_add_u32 s59, s90, 9216
    s_waitcnt lgkmcnt(0)
    s_barrier
    ds_read_b128 v[244:247], v8 offset:10816
    v_smfmac_f32_16x16x64_bf16 v[160:163], a[252:255], v[220:227], v40
    ds_read_b128 v[196:199], v1 offset:0
    v_smfmac_f32_16x16x64_bf16 v[160:163], v[88:91], v[228:235], v44
    ds_read_b128 v[200:203], v2 offset:0
    s_cmp_lt_u32 s22, 75497472
    s_cbranch_scc0 M_bF
    s_cmp_eq_u32 s91, 1
    s_cbranch_scc1 M_bE0
M_bL:
    v_smfmac_f32_16x16x64_bf16 v[164:167], v[56:59], v[220:227], v40 abid:1
    ds_read_b128 v[204:207], v1 offset:1024
    v_smfmac_f32_16x16x64_bf16 v[164:167], v[92:95], v[228:235], v44 abid:1
    ds_read_b128 v[208:211], v2 offset:1024
    v_mov_b32 v0, 1
    v_smfmac_f32_16x16x64_bf16 v[168:171], v[60:63], v[220:227], v41
    ds_read_b128 v[212:215], v1 offset:2048
    v_smfmac_f32_16x16x64_bf16 v[168:171], v[96:99], v[228:235], v45
    ds_read_b128 v[216:219], v2 offset:2048
    v_smfmac_f32_16x16x64_bf16 v[172:175], v[64:67], v[220:227], v41 abid:1
    s_waitcnt vmcnt(6)
    s_waitcnt lgkmcnt(6)
    buffer_store_dwordx4 v[244:247], v7, s[12:15], s66 offen sc1
    v_smfmac_f32_16x16x64_bf16 v[172:175], v[100:103], v[228:235], v45 abid:1
    ds_read_b128 v[236:239], v9 offset:9408
    v_smfmac_f32_16x16x64_bf16 v[176:179], v[68:71], v[220:227], v42
    s_waitcnt vmcnt(6)
    buffer_atomic_add v0, v11, s[16:19], s92 offen sc0 sc1
    s_mov_b32 s21, 1
    v_smfmac_f32_16x16x64_bf16 v[176:179], v[104:107], v[228:235], v46
    v_smfmac_f32_16x16x64_bf16 v[180:183], v[72:75], v[220:227], v42 abid:1
    v_cvt_pk_bf16_f32 v160, v160, v161
    v_smfmac_f32_16x16x64_bf16 v[180:183], v[108:111], v[228:235], v46 abid:1
    v_cvt_pk_bf16_f32 v161, v162, v163
    v_smfmac_f32_16x16x64_bf16 v[184:187], v[76:79], v[220:227], v43
    v_cvt_pk_bf16_f32 v162, v164, v165
    v_smfmac_f32_16x16x64_bf16 v[184:187], v[112:115], v[228:235], v47
    v_cvt_pk_bf16_f32 v163, v166, v167
    v_smfmac_f32_16x16x64_bf16 v[188:191], v[80:83], v[220:227], v43 abid:1
    s_add_u32 m0, m0, 896
    v_cvt_pk_bf16_f32 v168, v168, v169
    v_smfmac_f32_16x16x64_bf16 v[188:191], v[116:119], v[228:235], v47 abid:1
    s_waitcnt vmcnt(6)
    buffer_load_dwordx4 v5, s[8:11], s22 offen offset:512 nt lds
    v_cvt_pk_bf16_f32 v169, v170, v171
    v_smfmac_f32_16x16x64_bf16 v[192:195], v[84:87], v[220:227], v51 abid:1
    v_cvt_pk_bf16_f32 v170, v172, v173
    v_smfmac_f32_16x16x64_bf16 v[192:195], v[120:123], v[228:235], v52
    ds_read_b128 v[220:223], v1 offset:3072
    s_waitcnt lgkmcnt(6)
    v_cvt_pk_bf16_f32 v171, v174, v175
    v_smfmac_f32_16x16x64_bf16 v[124:127], a[0:3], v[196:203], v12
    ds_read_b128 v[224:227], v2 offset:3072
    ds_read_b128 v[172:175], v9 offset:10432
    s_waitcnt lgkmcnt(6)
    v_cndmask_b32_dpp v164, v160, v168, vcc row_ror:8 row_mask:0xf bank_mask:0xf
    v_smfmac_f32_16x16x64_bf16 v[124:127], a[36:39], v[204:211], v16
    ds_read_b128 v[228:231], v1 offset:4096
    s_waitcnt lgkmcnt(5)
    v_cndmask_b32_dpp v165, v161, v169, vcc row_ror:8 row_mask:0xf bank_mask:0xf
    v_smfmac_f32_16x16x64_bf16 v[124:127], a[72:75], v[212:219], v20
    ds_read_b128 v[232:235], v2 offset:4096
    v_cndmask_b32_dpp v166, v162, v170, vcc row_ror:8 row_mask:0xf bank_mask:0xf
    v_smfmac_f32_16x16x64_bf16 v[128:131], a[4:7], v[196:203], v12 abid:1
    s_barrier
    v_cndmask_b32_dpp v167, v163, v171, vcc row_ror:8 row_mask:0xf bank_mask:0xf
    v_smfmac_f32_16x16x64_bf16 v[128:131], a[40:43], v[204:211], v16 abid:1
    s_waitcnt vmcnt(6)
    buffer_store_dwordx4 v[164:167], v6, s[12:15], s58 offen offset:0 sc1
    s_waitcnt lgkmcnt(5)
    v_xad_u32 v236, v236, v3, v4
    v_smfmac_f32_16x16x64_bf16 v[128:131], a[76:79], v[212:219], v20 abid:1
    v_xad_u32 v237, v237, v3, v4
    v_smfmac_f32_16x16x64_bf16 v[132:135], a[8:11], v[196:203], v13
    ds_read2st64_b32 v[244:245], v236 offset0:0 offset1:72
    ds_read_b128 v[240:243], v8 offset:3072
    v_xad_u32 v238, v238, v3, v4
    v_smfmac_f32_16x16x64_bf16 v[132:135], a[44:47], v[204:211], v17
    ds_read2st64_b32 v[246:247], v237 offset0:0 offset1:72
    v_xad_u32 v239, v239, v3, v4
    v_smfmac_f32_16x16x64_bf16 v[132:135], a[80:83], v[212:219], v21
    ds_read2st64_b32 v[248:249], v238 offset0:0 offset1:72
    v_mov_b32_dpp v160, v168 row_ror:8 row_mask:0xf bank_mask:0xc
    v_smfmac_f32_16x16x64_bf16 v[144:147], a[20:23], v[196:203], v14 abid:1
    ds_read2st64_b32 v[250:251], v239 offset0:0 offset1:72
    ds_read_b128 v[236:239], v9 offset:9280
    v_mov_b32_dpp v161, v169 row_ror:8 row_mask:0xf bank_mask:0xc
    v_smfmac_f32_16x16x64_bf16 v[144:147], a[56:59], v[204:211], v18 abid:1
    v_mov_b32_dpp v162, v170 row_ror:8 row_mask:0xf bank_mask:0xc
    v_smfmac_f32_16x16x64_bf16 v[144:147], a[92:95], v[212:219], v22 abid:1
    v_mov_b32_dpp v163, v171 row_ror:8 row_mask:0xf bank_mask:0xc
    v_smfmac_f32_16x16x64_bf16 v[140:143], a[16:19], v[196:203], v14
    s_waitcnt vmcnt(6)
    buffer_store_dwordx4 v[160:163], v6, s[12:15], s23 offen offset:0 sc1
    ds_read_b128 v[164:167], v9 offset:10304
    v_smfmac_f32_16x16x64_bf16 v[140:143], a[52:55], v[204:211], v18
    ds_read_b128 v[168:171], v9 offset:10368
    ds_read_b128 v[160:163], v9 offset:10240
    v_smfmac_f32_16x16x64_bf16 v[140:143], a[88:91], v[212:219], v22
    v_smfmac_f32_16x16x64_bf16 v[136:139], a[12:15], v[196:203], v13 abid:1
    v_smfmac_f32_16x16x64_bf16 v[136:139], a[48:51], v[204:211], v17 abid:1
    v_smfmac_f32_16x16x64_bf16 v[136:139], a[84:87], v[212:219], v21 abid:1
    s_waitcnt lgkmcnt(3)
    v_xad_u32 v236, v236, v3, v4
    v_smfmac_f32_16x16x64_bf16 v[136:139], v[240:243], v[244:251], v10
    v_xad_u32 v237, v237, v3, v4
    v_smfmac_f32_16x16x64_bf16 v[172:175], v[240:243], v[244:251], v10 abid:1
    ds_read2st64_b32 v[244:245], v236 offset0:0 offset1:72
    ds_read_b128 v[240:243], v8 offset:1024
    v_xad_u32 v238, v238, v3, v4
    v_smfmac_f32_16x16x64_bf16 v[148:151], a[24:27], v[196:203], v15
    ds_read2st64_b32 v[246:247], v237 offset0:0 offset1:72
    v_xad_u32 v239, v239, v3, v4
    v_smfmac_f32_16x16x64_bf16 v[148:151], a[60:63], v[204:211], v19
    ds_read2st64_b32 v[248:249], v238 offset0:0 offset1:72
    v_cvt_pk_bf16_f32 v192, v192, v193
    v_smfmac_f32_16x16x64_bf16 v[148:151], a[96:99], v[212:219], v23
    ds_read2st64_b32 v[250:251], v239 offset0:0 offset1:72
    ds_read_b128 v[236:239], v9 offset:9344
    v_cvt_pk_bf16_f32 v193, v194, v195
    v_smfmac_f32_16x16x64_bf16 v[152:155], a[28:31], v[196:203], v15 abid:1
    ds_write_b64 v53, v[192:193] offset:0
    ds_read_b128 v[192:195], v9 offset:10752
    v_smfmac_f32_16x16x64_bf16 v[152:155], a[64:67], v[204:211], v19 abid:1
    s_add_u32 m0, m0, 896
    v_smfmac_f32_16x16x64_bf16 v[152:155], a[100:103], v[212:219], v23 abid:1
    s_waitcnt vmcnt(6)
    buffer_load_dwordx4 v5, s[8:11], s22 offen offset:640 nt lds
    v_smfmac_f32_16x16x64_bf16 v[156:159], a[32:35], v[196:203], v48
    v_smfmac_f32_16x16x64_bf16 v[156:159], a[68:71], v[204:211], v48 abid:1
    v_smfmac_f32_16x16x64_bf16 v[156:159], a[104:107], v[212:219], v49
    ds_read_b128 v[196:199], v1 offset:5120
    v_cvt_pk_bf16_f32 v176, v176, v177
    v_smfmac_f32_16x16x64_bf16 v[124:127], a[108:111], v[220:227], v24
    ds_read_b128 v[200:203], v2 offset:5120
    v_cvt_pk_bf16_f32 v177, v178, v179
    v_smfmac_f32_16x16x64_bf16 v[124:127], a[144:147], v[228:235], v28
    ds_read_b128 v[204:207], v1 offset:6144
    ds_read_b64 v[216:217], v9 offset:10056
    v_cvt_pk_bf16_f32 v178, v180, v181
    v_smfmac_f32_16x16x64_bf16 v[128:131], a[112:115], v[220:227], v24 abid:1
    ds_read_b128 v[208:211], v2 offset:6144
    v_cvt_pk_bf16_f32 v179, v182, v183
    v_smfmac_f32_16x16x64_bf16 v[128:131], a[148:151], v[228:235], v28 abid:1
    s_waitcnt lgkmcnt(7)
    v_xad_u32 v236, v236, v3, v4
    v_smfmac_f32_16x16x64_bf16 v[128:131], v[240:243], v[244:251], v10
    s_add_u32 m0, m0, 896
    v_xad_u32 v237, v237, v3, v4
    v_smfmac_f32_16x16x64_bf16 v[164:167], v[240:243], v[244:251], v10 abid:1
    ds_read2st64_b32 v[244:245], v236 offset0:0 offset1:72
    ds_read_b128 v[240:243], v8 offset:2048
    v_xad_u32 v238, v238, v3, v4
    v_smfmac_f32_16x16x64_bf16 v[152:155], a[136:139], v[220:227], v27 abid:1
    ds_read2st64_b32 v[246:247], v237 offset0:0 offset1:72
    s_waitcnt vmcnt(6)
    v_xad_u32 v239, v239, v3, v4
    v_smfmac_f32_16x16x64_bf16 v[152:155], a[172:175], v[228:235], v31 abid:1
    ds_read2st64_b32 v[248:249], v238 offset0:0 offset1:72
    buffer_load_dwordx4 v5, s[8:11], s22 offen offset:768 nt lds
    v_cvt_pk_bf16_f32 v184, v184, v185
    v_smfmac_f32_16x16x64_bf16 v[136:139], a[120:123], v[220:227], v25 abid:1
    ds_read2st64_b32 v[250:251], v239 offset0:0 offset1:72
    ds_read_b128 v[236:239], v9 offset:9216
    v_cvt_pk_bf16_f32 v185, v186, v187
    v_smfmac_f32_16x16x64_bf16 v[136:139], a[156:159], v[228:235], v29 abid:1
    v_cvt_pk_bf16_f32 v186, v188, v189
    v_smfmac_f32_16x16x64_bf16 v[140:143], a[124:127], v[220:227], v26
    v_cvt_pk_bf16_f32 v187, v190, v191
    v_smfmac_f32_16x16x64_bf16 v[140:143], a[160:163], v[228:235], v30
    ds_read_b128 v[188:191], v9 offset:10688
    v_cndmask_b32_dpp v180, v176, v184, vcc row_ror:8 row_mask:0xf bank_mask:0xf
    v_smfmac_f32_16x16x64_bf16 v[144:147], a[128:131], v[220:227], v26 abid:1
    v_cndmask_b32_dpp v181, v177, v185, vcc row_ror:8 row_mask:0xf bank_mask:0xf
    v_smfmac_f32_16x16x64_bf16 v[144:147], a[164:167], v[228:235], v30 abid:1
    v_cndmask_b32_dpp v182, v178, v186, vcc row_ror:8 row_mask:0xf bank_mask:0xf
    v_smfmac_f32_16x16x64_bf16 v[148:151], a[132:135], v[220:227], v27
    v_cndmask_b32_dpp v183, v179, v187, vcc row_ror:8 row_mask:0xf bank_mask:0xf
    v_smfmac_f32_16x16x64_bf16 v[148:151], a[168:171], v[228:235], v31
    s_waitcnt vmcnt(6)
    buffer_store_dwordx4 v[180:183], v6, s[12:15], s58 offen offset:128 sc1
    s_waitcnt lgkmcnt(8)
    v_xad_u32 v212, v216, v3, v4
    v_smfmac_f32_16x16x64_bf16 v[132:135], a[116:119], v[220:227], v25
    ds_read2st64_b32 v[212:213], v212 offset0:0 offset1:72
    v_xad_u32 v214, v217, v3, v4
    v_smfmac_f32_16x16x64_bf16 v[132:135], a[152:155], v[228:235], v29
    ds_read2st64_b32 v[214:215], v214 offset0:0 offset1:72
    s_waitcnt lgkmcnt(3)
    v_xad_u32 v236, v236, v3, v4
    v_smfmac_f32_16x16x64_bf16 v[132:135], v[240:243], v[244:251], v10
    v_xad_u32 v237, v237, v3, v4
    v_smfmac_f32_16x16x64_bf16 v[168:171], v[240:243], v[244:251], v10 abid:1
    ds_read2st64_b32 v[244:245], v236 offset0:0 offset1:72
    ds_read_b128 v[240:243], v8 offset:0
    v_xad_u32 v238, v238, v3, v4
    v_smfmac_f32_16x16x64_bf16 v[156:159], a[140:143], v[220:227], v49 abid:1
    ds_read2st64_b32 v[246:247], v237 offset0:0 offset1:72
    v_xad_u32 v239, v239, v3, v4
    v_smfmac_f32_16x16x64_bf16 v[156:159], a[176:179], v[228:235], v50
    ds_read2st64_b32 v[248:249], v238 offset0:0 offset1:72
    v_mov_b32_dpp v176, v184 row_ror:8 row_mask:0xf bank_mask:0xc
    v_smfmac_f32_16x16x64_bf16 v[140:143], a[196:199], v[196:203], v34
    ds_read2st64_b32 v[250:251], v239 offset0:0 offset1:72
    ds_read_b128 v[236:239], v9 offset:9728
    v_mov_b32_dpp v177, v185 row_ror:8 row_mask:0xf bank_mask:0xc
    v_smfmac_f32_16x16x64_bf16 v[140:143], a[232:235], v[204:211], v38
    v_mov_b32_dpp v178, v186 row_ror:8 row_mask:0xf bank_mask:0xc
    v_smfmac_f32_16x16x64_bf16 v[128:131], a[184:187], v[196:203], v32 abid:1
    v_mov_b32_dpp v179, v187 row_ror:8 row_mask:0xf bank_mask:0xc
    v_smfmac_f32_16x16x64_bf16 v[128:131], a[220:223], v[204:211], v36 abid:1
    s_waitcnt vmcnt(6)
    buffer_store_dwordx4 v[176:179], v6, s[12:15], s23 offen offset:128 sc1
    ds_read_b128 v[180:183], v9 offset:10560
    v_smfmac_f32_16x16x64_bf16 v[132:135], a[188:191], v[196:203], v33
    ds_read_b128 v[184:187], v9 offset:10624
    ds_read_b128 v[176:179], v9 offset:10496
    v_smfmac_f32_16x16x64_bf16 v[132:135], a[224:227], v[204:211], v37
    v_smfmac_f32_16x16x64_bf16 v[136:139], a[192:195], v[196:203], v33 abid:1
    ds_read_b128 v[220:223], v1 offset:7168
    v_smfmac_f32_16x16x64_bf16 v[136:139], a[228:231], v[204:211], v37 abid:1
    ds_read_b128 v[224:227], v2 offset:7168
    v_smfmac_f32_16x16x64_bf16 v[124:127], a[180:183], v[196:203], v32
    ds_read_b128 v[228:231], v1 offset:8192
    v_smfmac_f32_16x16x64_bf16 v[124:127], a[216:219], v[204:211], v36
    s_waitcnt vmcnt(7)
    s_waitcnt lgkmcnt(6)
    v_xad_u32 v236, v236, v3, v4
    v_smfmac_f32_16x16x64_bf16 v[124:127], v[240:243], v[244:251], v10
    ds_read_b128 v[232:235], v2 offset:8192
    v_xad_u32 v237, v237, v3, v4
    v_smfmac_f32_16x16x64_bf16 v[160:163], v[240:243], v[244:251], v10 abid:1
    ds_read2st64_b32 v[244:245], v236 offset0:0 offset1:72
    ds_read_b128 v[240:243], v8 offset:8192
    v_xad_u32 v238, v238, v3, v4
    v_smfmac_f32_16x16x64_bf16 v[144:147], a[200:203], v[196:203], v34 abid:1
    ds_read2st64_b32 v[246:247], v237 offset0:0 offset1:72
    v_xad_u32 v239, v239, v3, v4
    v_smfmac_f32_16x16x64_bf16 v[144:147], a[236:239], v[204:211], v38 abid:1
    ds_read2st64_b32 v[248:249], v238 offset0:0 offset1:72
    v_mul_u32_u24 v0, s94, v0
    v_smfmac_f32_16x16x64_bf16 v[148:151], a[204:207], v[196:203], v35
    ds_read2st64_b32 v[250:251], v239 offset0:0 offset1:72
    ds_read_b128 v[236:239], v9 offset:9664
    v_add_u32 v0, s93, v0
    v_smfmac_f32_16x16x64_bf16 v[148:151], a[240:243], v[204:211], v39
    s_waitcnt lgkmcnt(10)
    s_cmp_lt_i32 s81, 0
    s_cbranch_scc1 M_ovrL
    s_swappc_b64 s[78:79], s[72:73]
M_ovrL:
    v_smfmac_f32_16x16x64_bf16 v[152:155], a[208:211], v[196:203], v35 abid:1
    s_add_u32 m0, m0, 896
    v_min_u32 v0, 75497472, v0
    v_smfmac_f32_16x16x64_bf16 v[152:155], a[244:247], v[204:211], v39 abid:1
    ds_write_b32 v11, v0
    s_waitcnt vmcnt(6)
    v_mov_b32 v0, 162048
    v_smfmac_f32_16x16x64_bf16 v[156:159], a[212:215], v[196:203], v50 abid:1
    buffer_load_dwordx4 v5, s[8:11], s22 offen offset:896 nt lds
    v_smfmac_f32_16x16x64_bf16 v[156:159], a[248:251], v[204:211], v51
    s_waitcnt lgkmcnt(9)
    v_smfmac_f32_16x16x64_bf16 v[124:127], a[252:255], v[220:227], v40
    ds_read_b128 v[196:199], v1 offset:18432
    s_waitcnt lgkmcnt(8)
    v_smfmac_f32_16x16x64_bf16 v[124:127], v[88:91], v[228:235], v44
    ds_read_b128 v[200:203], v2 offset:18432
    v_smfmac_f32_16x16x64_bf16 v[156:159], v[84:87], v[220:227], v51 abid:1
    ds_read_b128 v[204:207], v1 offset:19456
    v_smfmac_f32_16x16x64_bf16 v[156:159], v[120:123], v[228:235], v52
    s_waitcnt lgkmcnt(3)
    s_barrier
    v_xad_u32 v236, v236, v3, v4
    v_smfmac_f32_16x16x64_bf16 v[156:159], v[240:243], v[244:251], v10
    ds_read_b128 v[208:211], v2 offset:19456
    ds_read_b32 v0, v0
    v_xad_u32 v237, v237, v3, v4
    v_smfmac_f32_16x16x64_bf16 v[192:195], v[240:243], v[244:251], v10 abid:1
    ds_read2st64_b32 v[244:245], v236 offset0:0 offset1:72
    ds_read_b128 v[240:243], v8 offset:7168
    v_xad_u32 v238, v238, v3, v4
    v_smfmac_f32_16x16x64_bf16 v[132:135], v[60:63], v[220:227], v41
    ds_read2st64_b32 v[246:247], v237 offset0:0 offset1:72
    v_xad_u32 v239, v239, v3, v4
    v_smfmac_f32_16x16x64_bf16 v[132:135], v[96:99], v[228:235], v45
    ds_read2st64_b32 v[248:249], v238 offset0:0 offset1:72
    s_add_u32 m0, m0, 896
    v_smfmac_f32_16x16x64_bf16 v[136:139], v[64:67], v[220:227], v41 abid:1
    ds_read2st64_b32 v[250:251], v239 offset0:0 offset1:72
    ds_read_b128 v[236:239], v9 offset:9536
    s_waitcnt vmcnt(6)
    v_smfmac_f32_16x16x64_bf16 v[136:139], v[100:103], v[228:235], v45 abid:1
    buffer_load_dwordx4 v5, s[8:11], s22 offen offset:1024 nt lds
    s_waitcnt lgkmcnt(6)
    v_readfirstlane_b32 s88, v0
    v_smfmac_f32_16x16x64_bf16 v[140:143], v[68:71], v[220:227], v42
    s_cmp_lt_u32 s88, s99
    s_cselect_b32 s10, 75497472, 0
    v_smfmac_f32_16x16x64_bf16 v[140:143], v[104:107], v[228:235], v46
    s_cmp_lt_u32 s88, s14
    s_cbranch_scc0 M_q
M_nq:
    v_smfmac_f32_16x16x64_bf16 v[144:147], v[72:75], v[220:227], v42 abid:1
    ds_read_b128 v[212:215], v1 offset:20480
    v_smfmac_f32_16x16x64_bf16 v[144:147], v[108:111], v[228:235], v46 abid:1
    ds_read_b128 v[216:219], v2 offset:20480
    v_smfmac_f32_16x16x64_bf16 v[148:151], v[76:79], v[220:227], v43
    v_smfmac_f32_16x16x64_bf16 v[148:151], v[112:115], v[228:235], v47
    v_smfmac_f32_16x16x64_bf16 v[152:155], v[80:83], v[220:227], v43 abid:1
    v_smfmac_f32_16x16x64_bf16 v[152:155], v[116:119], v[228:235], v47 abid:1
    s_waitcnt lgkmcnt(2)
    v_xad_u32 v236, v236, v3, v4
    v_smfmac_f32_16x16x64_bf16 v[152:155], v[240:243], v[244:251], v10
    v_xad_u32 v237, v237, v3, v4
    v_smfmac_f32_16x16x64_bf16 v[188:191], v[240:243], v[244:251], v10 abid:1
    s_cmp_gt_u32 s46, s80
    s_cbranch_scc1 M_slow
M_slowrL:
    v_xad_u32 v238, v238, v3, v4
    v_smfmac_f32_16x16x64_bf16 v[128:131], v[56:59], v[220:227], v40 abid:1
    ds_read2st64_b32 v[244:245], v236 offset0:0 offset1:72
    ds_read_b128 v[240:243], v8 offset:5120
    v_xad_u32 v239, v239, v3, v4
    v_smfmac_f32_16x16x64_bf16 v[128:131], v[92:95], v[228:235], v44 abid:1
    ds_read2st64_b32 v[246:247], v237 offset0:0 offset1:72
    v_smfmac_f32_16x16x64_bf16 v[160:163], a[0:3], v[196:203], v12
    ds_read2st64_b32 v[248:249], v238 offset0:0 offset1:72
    v_smfmac_f32_16x16x64_bf16 v[160:163], a[36:39], v[204:211], v16
    ds_read2st64_b32 v[250:251], v239 offset0:0 offset1:72
    ds_read_b128 v[236:239], v9 offset:9600
    s_waitcnt lgkmcnt(6)
    v_smfmac_f32_16x16x64_bf16 v[160:163], a[72:75], v[212:219], v20
    v_smfmac_f32_16x16x64_bf16 v[164:167], a[4:7], v[196:203], v12 abid:1
    s_mov_b32 m0, s28
    v_cvt_pk_bf16_f32 v156, v156, v157
    v_smfmac_f32_16x16x64_bf16 v[164:167], a[40:43], v[204:211], v16 abid:1
    s_waitcnt vmcnt(6)
    buffer_load_dwordx4 v5, s[8:11], s88 offen offset:0 nt lds
    v_cvt_pk_bf16_f32 v157, v158, v159
    v_smfmac_f32_16x16x64_bf16 v[164:167], a[76:79], v[212:219], v20 abid:1
    ds_write_b64 v53, v[156:157] offset:25728
    ds_read_b128 v[156:159], v9 offset:10752
    v_smfmac_f32_16x16x64_bf16 v[180:183], a[20:23], v[196:203], v14 abid:1
    v_smfmac_f32_16x16x64_bf16 v[180:183], a[56:59], v[204:211], v18 abid:1
    ds_read_b128 v[220:223], v1 offset:21504
    v_cvt_pk_bf16_f32 v124, v124, v125
    v_smfmac_f32_16x16x64_bf16 v[180:183], a[92:95], v[212:219], v22 abid:1
    s_waitcnt lgkmcnt(3)
    v_xad_u32 v236, v236, v3, v4
    v_smfmac_f32_16x16x64_bf16 v[180:183], v[240:243], v[244:251], v10 abid:1
    v_xad_u32 v237, v237, v3, v4
    v_smfmac_f32_16x16x64_bf16 v[144:147], v[240:243], v[244:251], v10
    ds_read2st64_b32 v[244:245], v236 offset0:0 offset1:72
    ds_read_b128 v[240:243], v8 offset:6144
    v_xad_u32 v238, v238, v3, v4
    v_smfmac_f32_16x16x64_bf16 v[172:175], a[12:15], v[196:203], v13 abid:1
    ds_read2st64_b32 v[246:247], v237 offset0:0 offset1:72
    v_xad_u32 v239, v239, v3, v4
    v_smfmac_f32_16x16x64_bf16 v[172:175], a[48:51], v[204:211], v17 abid:1
    ds_read2st64_b32 v[248:249], v238 offset0:0 offset1:72
    v_cvt_pk_bf16_f32 v125, v126, v127
    v_smfmac_f32_16x16x64_bf16 v[172:175], a[84:87], v[212:219], v21 abid:1
    ds_read2st64_b32 v[250:251], v239 offset0:0 offset1:72
    ds_read_b128 v[236:239], v9 offset:9472
    v_cvt_pk_bf16_f32 v126, v128, v129
    v_smfmac_f32_16x16x64_bf16 v[176:179], a[16:19], v[196:203], v14
    v_cvt_pk_bf16_f32 v127, v130, v131
    v_smfmac_f32_16x16x64_bf16 v[176:179], a[52:55], v[204:211], v18
    v_cvt_pk_bf16_f32 v132, v132, v133
    v_smfmac_f32_16x16x64_bf16 v[176:179], a[88:91], v[212:219], v22
    v_cvt_pk_bf16_f32 v133, v134, v135
    v_smfmac_f32_16x16x64_bf16 v[168:171], a[8:11], v[196:203], v13
    s_add_u32 m0, m0, 896
    v_cvt_pk_bf16_f32 v134, v136, v137
    v_smfmac_f32_16x16x64_bf16 v[168:171], a[44:47], v[204:211], v17
    s_waitcnt vmcnt(6)
    buffer_load_dwordx4 v5, s[8:11], s88 offen offset:128 nt lds
    v_cvt_pk_bf16_f32 v135, v138, v139
    v_smfmac_f32_16x16x64_bf16 v[168:171], a[80:83], v[212:219], v21
    ds_read_b128 v[224:227], v2 offset:21504
    ds_read_b128 v[136:139], v9 offset:10432
    v_cndmask_b32_dpp v128, v124, v132, vcc row_ror:8 row_mask:0xf bank_mask:0xf
    v_smfmac_f32_16x16x64_bf16 v[184:187], a[24:27], v[196:203], v15
    ds_read_b128 v[228:231], v1 offset:22528
    v_cndmask_b32_dpp v129, v125, v133, vcc row_ror:8 row_mask:0xf bank_mask:0xf
    v_smfmac_f32_16x16x64_bf16 v[184:187], a[60:63], v[204:211], v19
    ds_read_b128 v[232:235], v2 offset:22528
    v_cndmask_b32_dpp v130, v126, v134, vcc row_ror:8 row_mask:0xf bank_mask:0xf
    v_smfmac_f32_16x16x64_bf16 v[184:187], a[96:99], v[212:219], v23
    s_waitcnt lgkmcnt(4)
    v_xad_u32 v236, v236, v3, v4
    v_smfmac_f32_16x16x64_bf16 v[184:187], v[240:243], v[244:251], v10 abid:1
    v_xad_u32 v237, v237, v3, v4
    v_smfmac_f32_16x16x64_bf16 v[148:151], v[240:243], v[244:251], v10
    ds_read2st64_b32 v[244:245], v236 offset0:0 offset1:72
    ds_read_b128 v[240:243], v8 offset:4096
    v_xad_u32 v238, v238, v3, v4
    v_smfmac_f32_16x16x64_bf16 v[188:191], a[28:31], v[196:203], v15 abid:1
    ds_read2st64_b32 v[246:247], v237 offset0:0 offset1:72
    v_xad_u32 v239, v239, v3, v4
    v_smfmac_f32_16x16x64_bf16 v[188:191], a[64:67], v[204:211], v19 abid:1
    ds_read2st64_b32 v[248:249], v238 offset0:0 offset1:72
    v_cndmask_b32_dpp v131, v127, v135, vcc row_ror:8 row_mask:0xf bank_mask:0xf
    v_smfmac_f32_16x16x64_bf16 v[188:191], a[100:103], v[212:219], v23 abid:1
    ds_read2st64_b32 v[250:251], v239 offset0:0 offset1:72
    s_waitcnt vmcnt(6)
    buffer_store_dwordx4 v[128:131], v6, s[12:15], s59 offen offset:0 sc1
    v_smfmac_f32_16x16x64_bf16 v[192:195], a[32:35], v[196:203], v48
    v_mov_b32_dpp v124, v132 row_ror:8 row_mask:0xf bank_mask:0xc
    v_smfmac_f32_16x16x64_bf16 v[192:195], a[68:71], v[204:211], v48 abid:1
    v_mov_b32_dpp v125, v133 row_ror:8 row_mask:0xf bank_mask:0xc
    v_smfmac_f32_16x16x64_bf16 v[192:195], a[104:107], v[212:219], v49
    s_waitcnt lgkmcnt(8)
    v_mov_b32_dpp v126, v134 row_ror:8 row_mask:0xf bank_mask:0xc
    v_smfmac_f32_16x16x64_bf16 v[160:163], a[108:111], v[220:227], v24
    s_waitcnt lgkmcnt(5)
    v_mov_b32_dpp v127, v135 row_ror:8 row_mask:0xf bank_mask:0xc
    v_smfmac_f32_16x16x64_bf16 v[160:163], a[144:147], v[228:235], v28
    ds_read_b128 v[196:199], v1 offset:23552
    s_waitcnt vmcnt(6)
    buffer_store_dwordx4 v[124:127], v6, s[12:15], s24 offen offset:0 sc1
    v_smfmac_f32_16x16x64_bf16 v[164:167], a[112:115], v[220:227], v24 abid:1
    ds_read_b128 v[200:203], v2 offset:23552
    ds_read_b128 v[128:131], v9 offset:10304
    ds_read_b128 v[132:135], v9 offset:10368
    v_smfmac_f32_16x16x64_bf16 v[164:167], a[148:151], v[228:235], v28 abid:1
    ds_read_b128 v[204:207], v1 offset:24576
    ds_read_b128 v[124:127], v9 offset:10240
    v_smfmac_f32_16x16x64_bf16 v[176:179], a[124:127], v[220:227], v26
    ds_read_b128 v[208:211], v2 offset:24576
    v_smfmac_f32_16x16x64_bf16 v[176:179], a[160:163], v[228:235], v30
    s_waitcnt lgkmcnt(7)
    v_smfmac_f32_16x16x64_bf16 v[176:179], v[240:243], v[244:251], v10 abid:1
    v_smfmac_f32_16x16x64_bf16 v[140:143], v[240:243], v[244:251], v10
    v_smfmac_f32_16x16x64_bf16 v[172:175], a[120:123], v[220:227], v25 abid:1
    s_add_u32 s28, s28, 36864
    s_cmp_ge_u32 s28, 110592
    s_cselect_b32 s28, s26, s28
    v_smfmac_f32_16x16x64_bf16 v[172:175], a[156:159], v[228:235], v29 abid:1
    s_add_u32 s30, s25, 36864
    s_cmp_eq_u32 s30, 110592
    s_cselect_b32 s30, 0, s30
    v_smfmac_f32_16x16x64_bf16 v[168:171], a[116:119], v[220:227], v25
    s_sub_u32 s31, s30, s25
    s_mov_b32 s25, s30
    s_mov_b32 s90, s22
    v_smfmac_f32_16x16x64_bf16 v[168:171], a[152:155], v[228:235], v29
    s_mov_b32 s22, s88
    s_add_u32 s91, s91, 1
    s_cmp_lt_u32 s20, 2
    v_smfmac_f32_16x16x64_bf16 v[180:183], a[128:131], v[220:227], v26 abid:1
    s_cselect_b32 s66, s23, s24
    s_add_u32 s66, s66, s95
    v_smfmac_f32_16x16x64_bf16 v[180:183], a[164:167], v[228:235], v30 abid:1
    v_cvt_pk_bf16_f32 v140, v140, v141
    v_smfmac_f32_16x16x64_bf16 v[184:187], a[132:135], v[220:227], v27
    s_add_u32 m0, m0, 896
    v_cvt_pk_bf16_f32 v141, v142, v143
    v_smfmac_f32_16x16x64_bf16 v[184:187], a[168:171], v[228:235], v31
    s_waitcnt vmcnt(6)
    buffer_load_dwordx4 v5, s[8:11], s88 offen offset:256 nt lds
    v_cvt_pk_bf16_f32 v142, v144, v145
    v_smfmac_f32_16x16x64_bf16 v[188:191], a[136:139], v[220:227], v27 abid:1
    v_cvt_pk_bf16_f32 v143, v146, v147
    v_smfmac_f32_16x16x64_bf16 v[188:191], a[172:175], v[228:235], v31 abid:1
    v_cvt_pk_bf16_f32 v148, v148, v149
    v_smfmac_f32_16x16x64_bf16 v[192:195], a[140:143], v[220:227], v49 abid:1
    v_cvt_pk_bf16_f32 v149, v150, v151
    v_smfmac_f32_16x16x64_bf16 v[192:195], a[176:179], v[228:235], v50
    ds_read_b128 v[220:223], v1 offset:25600
    s_waitcnt lgkmcnt(6)
    v_cvt_pk_bf16_f32 v150, v152, v153
    v_smfmac_f32_16x16x64_bf16 v[160:163], a[180:183], v[196:203], v32
    ds_read_b128 v[224:227], v2 offset:25600
    s_waitcnt lgkmcnt(2)
    v_cvt_pk_bf16_f32 v151, v154, v155
    v_smfmac_f32_16x16x64_bf16 v[160:163], a[216:219], v[204:211], v36
    ds_read_b128 v[228:231], v1 offset:26624
    ds_read_b128 v[152:155], v9 offset:10688
    v_cndmask_b32_dpp v144, v140, v148, vcc row_ror:8 row_mask:0xf bank_mask:0xf
    v_smfmac_f32_16x16x64_bf16 v[164:167], a[184:187], v[196:203], v32 abid:1
    ds_read_b128 v[232:235], v2 offset:26624
    v_cndmask_b32_dpp v145, v141, v149, vcc row_ror:8 row_mask:0xf bank_mask:0xf
    v_smfmac_f32_16x16x64_bf16 v[164:167], a[220:223], v[204:211], v36 abid:1
    s_add_u32 m0, m0, 896
    v_cndmask_b32_dpp v146, v142, v150, vcc row_ror:8 row_mask:0xf bank_mask:0xf
    v_smfmac_f32_16x16x64_bf16 v[168:171], a[188:191], v[196:203], v33
    s_waitcnt vmcnt(6)
    buffer_load_dwordx4 v5, s[8:11], s88 offen offset:384 nt lds
    v_cndmask_b32_dpp v147, v143, v151, vcc row_ror:8 row_mask:0xf bank_mask:0xf
    v_smfmac_f32_16x16x64_bf16 v[168:171], a[224:227], v[204:211], v37
    s_waitcnt vmcnt(6)
    buffer_store_dwordx4 v[144:147], v6, s[12:15], s59 offen offset:128 sc1
    v_mov_b32_dpp v140, v148 row_ror:8 row_mask:0xf bank_mask:0xc
    v_smfmac_f32_16x16x64_bf16 v[172:175], a[192:195], v[196:203], v33 abid:1
    v_mov_b32_dpp v141, v149 row_ror:8 row_mask:0xf bank_mask:0xc
    v_smfmac_f32_16x16x64_bf16 v[172:175], a[228:231], v[204:211], v37 abid:1
    v_mov_b32_dpp v142, v150 row_ror:8 row_mask:0xf bank_mask:0xc
    v_smfmac_f32_16x16x64_bf16 v[176:179], a[196:199], v[196:203], v34
    v_mov_b32_dpp v143, v151 row_ror:8 row_mask:0xf bank_mask:0xc
    v_smfmac_f32_16x16x64_bf16 v[176:179], a[232:235], v[204:211], v38
    s_waitcnt vmcnt(6)
    buffer_store_dwordx4 v[140:143], v6, s[12:15], s24 offen offset:128 sc1
    ds_read_b128 v[144:147], v9 offset:10560
    v_smfmac_f32_16x16x64_bf16 v[180:183], a[200:203], v[196:203], v34 abid:1
    ds_read_b128 v[148:151], v9 offset:10624
    ds_read_b128 v[140:143], v9 offset:10496
    v_add_u32 v4, s31, v4
    v_smfmac_f32_16x16x64_bf16 v[180:183], a[236:239], v[204:211], v38 abid:1
    v_add_u32 v1, s31, v1
    v_smfmac_f32_16x16x64_bf16 v[184:187], a[204:207], v[196:203], v35
    v_add_u32 v2, s31, v2
    v_smfmac_f32_16x16x64_bf16 v[184:187], a[240:243], v[204:211], v39
    v_smfmac_f32_16x16x64_bf16 v[188:191], a[208:211], v[196:203], v35 abid:1
    v_smfmac_f32_16x16x64_bf16 v[188:191], a[244:247], v[204:211], v39 abid:1
    v_smfmac_f32_16x16x64_bf16 v[192:195], a[212:215], v[196:203], v50 abid:1
    v_smfmac_f32_16x16x64_bf16 v[192:195], a[248:251], v[204:211], v51
    s_waitcnt vmcnt(8)
    s_branch M_top1
M_bE0:
    v_smfmac_f32_16x16x64_bf16 v[164:167], v[56:59], v[220:227], v40 abid:1
    ds_read_b128 v[204:207], v1 offset:1024
    v_smfmac_f32_16x16x64_bf16 v[164:167], v[92:95], v[228:235], v44 abid:1
    ds_read_b128 v[208:211], v2 offset:1024
    v_mov_b32 v0, 1
    v_smfmac_f32_16x16x64_bf16 v[168:171], v[60:63], v[220:227], v41
    ds_read_b128 v[212:215], v1 offset:2048
    v_smfmac_f32_16x16x64_bf16 v[168:171], v[96:99], v[228:235], v45
    ds_read_b128 v[216:219], v2 offset:2048
    v_smfmac_f32_16x16x64_bf16 v[172:175], v[64:67], v[220:227], v41 abid:1
    s_waitcnt vmcnt(5)
    s_waitcnt lgkmcnt(6)
    buffer_store_dwordx4 v[244:247], v7, s[12:15], s66 offen sc1
    v_smfmac_f32_16x16x64_bf16 v[172:175], v[100:103], v[228:235], v45 abid:1
    ds_read_b128 v[236:239], v9 offset:9408
    v_smfmac_f32_16x16x64_bf16 v[176:179], v[68:71], v[220:227], v42
    s_waitcnt vmcnt(6)
    buffer_atomic_add v0, v11, s[16:19], s92 offen sc0 sc1
    s_mov_b32 s21, 2
    v_smfmac_f32_16x16x64_bf16 v[176:179], v[104:107], v[228:235], v46
    v_smfmac_f32_16x16x64_bf16 v[180:183], v[72:75], v[220:227], v42 abid:1
    v_cvt_pk_bf16_f32 v160, v160, v161
    v_smfmac_f32_16x16x64_bf16 v[180:183], v[108:111], v[228:235], v46 abid:1
    v_cvt_pk_bf16_f32 v161, v162, v163
    v_smfmac_f32_16x16x64_bf16 v[184:187], v[76:79], v[220:227], v43
    v_cvt_pk_bf16_f32 v162, v164, v165
    v_smfmac_f32_16x16x64_bf16 v[184:187], v[112:115], v[228:235], v47
    v_cvt_pk_bf16_f32 v163, v166, v167
    v_smfmac_f32_16x16x64_bf16 v[188:191], v[80:83], v[220:227], v43 abid:1
    s_add_u32 m0, m0, 896
    v_cvt_pk_bf16_f32 v168, v168, v169
    v_smfmac_f32_16x16x64_bf16 v[188:191], v[116:119], v[228:235], v47 abid:1
    s_waitcnt vmcnt(5)
    buffer_load_dwordx4 v5, s[8:11], s22 offen offset:512 nt lds
    v_cvt_pk_bf16_f32 v169, v170, v171
    v_smfmac_f32_16x16x64_bf16 v[192:195], v[84:87], v[220:227], v51 abid:1
    v_cvt_pk_bf16_f32 v170, v172, v173
    v_smfmac_f32_16x16x64_bf16 v[192:195], v[120:123], v[228:235], v52
    ds_read_b128 v[220:223], v1 offset:3072
    s_waitcnt lgkmcnt(6)
    v_cvt_pk_bf16_f32 v171, v174, v175
    v_smfmac_f32_16x16x64_bf16 v[124:127], a[0:3], v[196:203], v12
    ds_read_b128 v[224:227], v2 offset:3072
    ds_read_b128 v[172:175], v9 offset:10432
    s_waitcnt lgkmcnt(6)
    v_cndmask_b32_dpp v164, v160, v168, vcc row_ror:8 row_mask:0xf bank_mask:0xf
    v_smfmac_f32_16x16x64_bf16 v[124:127], a[36:39], v[204:211], v16
    ds_read_b128 v[228:231], v1 offset:4096
    s_waitcnt lgkmcnt(5)
    v_cndmask_b32_dpp v165, v161, v169, vcc row_ror:8 row_mask:0xf bank_mask:0xf
    v_smfmac_f32_16x16x64_bf16 v[124:127], a[72:75], v[212:219], v20
    ds_read_b128 v[232:235], v2 offset:4096
    v_cndmask_b32_dpp v166, v162, v170, vcc row_ror:8 row_mask:0xf bank_mask:0xf
    v_smfmac_f32_16x16x64_bf16 v[128:131], a[4:7], v[196:203], v12 abid:1
    s_barrier
    v_cndmask_b32_dpp v167, v163, v171, vcc row_ror:8 row_mask:0xf bank_mask:0xf
    v_smfmac_f32_16x16x64_bf16 v[128:131], a[40:43], v[204:211], v16 abid:1
    s_waitcnt vmcnt(6)
    buffer_store_dwordx4 v[164:167], v6, s[12:15], s58 offen offset:0 sc1
    s_waitcnt lgkmcnt(5)
    v_xad_u32 v236, v236, v3, v4
    v_smfmac_f32_16x16x64_bf16 v[128:131], a[76:79], v[212:219], v20 abid:1
    v_xad_u32 v237, v237, v3, v4
    v_smfmac_f32_16x16x64_bf16 v[132:135], a[8:11], v[196:203], v13
    ds_read2st64_b32 v[244:245], v236 offset0:0 offset1:72
    ds_read_b128 v[240:243], v8 offset:3072
    v_xad_u32 v238, v238, v3, v4
    v_smfmac_f32_16x16x64_bf16 v[132:135], a[44:47], v[204:211], v17
    ds_read2st64_b32 v[246:247], v237 offset0:0 offset1:72
    v_xad_u32 v239, v239, v3, v4
    v_smfmac_f32_16x16x64_bf16 v[132:135], a[80:83], v[212:219], v21
    ds_read2st64_b32 v[248:249], v238 offset0:0 offset1:72
    v_mov_b32_dpp v160, v168 row_ror:8 row_mask:0xf bank_mask:0xc
    v_smfmac_f32_16x16x64_bf16 v[144:147], a[20:23], v[196:203], v14 abid:1
    ds_read2st64_b32 v[250:251], v239 offset0:0 offset1:72
    ds_read_b128 v[236:239], v9 offset:9280
    v_mov_b32_dpp v161, v169 row_ror:8 row_mask:0xf bank_mask:0xc
    v_smfmac_f32_16x16x64_bf16 v[144:147], a[56:59], v[204:211], v18 abid:1
    v_mov_b32_dpp v162, v170 row_ror:8 row_mask:0xf bank_mask:0xc
    v_smfmac_f32_16x16x64_bf16 v[144:147], a[92:95], v[212:219], v22 abid:1
    v_mov_b32_dpp v163, v171 row_ror:8 row_mask:0xf bank_mask:0xc
    v_smfmac_f32_16x16x64_bf16 v[140:143], a[16:19], v[196:203], v14
    s_waitcnt vmcnt(5)
    buffer_store_dwordx4 v[160:163], v6, s[12:15], s23 offen offset:0 sc1
    ds_read_b128 v[164:167], v9 offset:10304
    v_smfmac_f32_16x16x64_bf16 v[140:143], a[52:55], v[204:211], v18
    ds_read_b128 v[168:171], v9 offset:10368
    ds_read_b128 v[160:163], v9 offset:10240
    v_smfmac_f32_16x16x64_bf16 v[140:143], a[88:91], v[212:219], v22
    v_smfmac_f32_16x16x64_bf16 v[136:139], a[12:15], v[196:203], v13 abid:1
    v_smfmac_f32_16x16x64_bf16 v[136:139], a[48:51], v[204:211], v17 abid:1
    v_smfmac_f32_16x16x64_bf16 v[136:139], a[84:87], v[212:219], v21 abid:1
    s_waitcnt lgkmcnt(3)
    v_xad_u32 v236, v236, v3, v4
    v_smfmac_f32_16x16x64_bf16 v[136:139], v[240:243], v[244:251], v10
    v_xad_u32 v237, v237, v3, v4
    v_smfmac_f32_16x16x64_bf16 v[172:175], v[240:243], v[244:251], v10 abid:1
    ds_read2st64_b32 v[244:245], v236 offset0:0 offset1:72
    ds_read_b128 v[240:243], v8 offset:1024
    v_xad_u32 v238, v238, v3, v4
    v_smfmac_f32_16x16x64_bf16 v[148:151], a[24:27], v[196:203], v15
    ds_read2st64_b32 v[246:247], v237 offset0:0 offset1:72
    v_xad_u32 v239, v239, v3, v4
    v_smfmac_f32_16x16x64_bf16 v[148:151], a[60:63], v[204:211], v19
    ds_read2st64_b32 v[248:249], v238 offset0:0 offset1:72
    v_cvt_pk_bf16_f32 v192, v192, v193
    v_smfmac_f32_16x16x64_bf16 v[148:151], a[96:99], v[212:219], v23
    ds_read2st64_b32 v[250:251], v239 offset0:0 offset1:72
    ds_read_b128 v[236:239], v9 offset:9344
    v_cvt_pk_bf16_f32 v193, v194, v195
    v_smfmac_f32_16x16x64_bf16 v[152:155], a[28:31], v[196:203], v15 abid:1
    ds_write_b64 v53, v[192:193] offset:0
    ds_read_b128 v[192:195], v9 offset:10752
    v_smfmac_f32_16x16x64_bf16 v[152:155], a[64:67], v[204:211], v19 abid:1
    s_add_u32 m0, m0, 896
    v_smfmac_f32_16x16x64_bf16 v[152:155], a[100:103], v[212:219], v23 abid:1
    s_waitcnt vmcnt(6)
    buffer_load_dwordx4 v5, s[8:11], s22 offen offset:640 nt lds
    v_smfmac_f32_16x16x64_bf16 v[156:159], a[32:35], v[196:203], v48
    v_smfmac_f32_16x16x64_bf16 v[156:159], a[68:71], v[204:211], v48 abid:1
    v_smfmac_f32_16x16x64_bf16 v[156:159], a[104:107], v[212:219], v49
    ds_read_b128 v[196:199], v1 offset:5120
    v_cvt_pk_bf16_f32 v176, v176, v177
    v_smfmac_f32_16x16x64_bf16 v[124:127], a[108:111], v[220:227], v24
    ds_read_b128 v[200:203], v2 offset:5120
    v_cvt_pk_bf16_f32 v177, v178, v179
    v_smfmac_f32_16x16x64_bf16 v[124:127], a[144:147], v[228:235], v28
    ds_read_b128 v[204:207], v1 offset:6144
    ds_read_b64 v[216:217], v9 offset:10056
    v_cvt_pk_bf16_f32 v178, v180, v181
    v_smfmac_f32_16x16x64_bf16 v[128:131], a[112:115], v[220:227], v24 abid:1
    ds_read_b128 v[208:211], v2 offset:6144
    v_cvt_pk_bf16_f32 v179, v182, v183
    v_smfmac_f32_16x16x64_bf16 v[128:131], a[148:151], v[228:235], v28 abid:1
    s_waitcnt lgkmcnt(7)
    v_xad_u32 v236, v236, v3, v4
    v_smfmac_f32_16x16x64_bf16 v[128:131], v[240:243], v[244:251], v10
    s_add_u32 m0, m0, 896
    v_xad_u32 v237, v237, v3, v4
    v_smfmac_f32_16x16x64_bf16 v[164:167], v[240:243], v[244:251], v10 abid:1
    ds_read2st64_b32 v[244:245], v236 offset0:0 offset1:72
    ds_read_b128 v[240:243], v8 offset:2048
    v_xad_u32 v238, v238, v3, v4
    v_smfmac_f32_16x16x64_bf16 v[152:155], a[136:139], v[220:227], v27 abid:1
    ds_read2st64_b32 v[246:247], v237 offset0:0 offset1:72
    s_waitcnt vmcnt(5)
    v_xad_u32 v239, v239, v3, v4
    v_smfmac_f32_16x16x64_bf16 v[152:155], a[172:175], v[228:235], v31 abid:1
    ds_read2st64_b32 v[248:249], v238 offset0:0 offset1:72
    buffer_load_dwordx4 v5, s[8:11], s22 offen offset:768 nt lds
    v_cvt_pk_bf16_f32 v184, v184, v185
    v_smfmac_f32_16x16x64_bf16 v[136:139], a[120:123], v[220:227], v25 abid:1
    ds_read2st64_b32 v[250:251], v239 offset0:0 offset1:72
    ds_read_b128 v[236:239], v9 offset:9216
    v_cvt_pk_bf16_f32 v185, v186, v187
    v_smfmac_f32_16x16x64_bf16 v[136:139], a[156:159], v[228:235], v29 abid:1
    v_cvt_pk_bf16_f32 v186, v188, v189
    v_smfmac_f32_16x16x64_bf16 v[140:143], a[124:127], v[220:227], v26
    v_cvt_pk_bf16_f32 v187, v190, v191
    v_smfmac_f32_16x16x64_bf16 v[140:143], a[160:163], v[228:235], v30
    ds_read_b128 v[188:191], v9 offset:10688
    v_cndmask_b32_dpp v180, v176, v184, vcc row_ror:8 row_mask:0xf bank_mask:0xf
    v_smfmac_f32_16x16x64_bf16 v[144:147], a[128:131], v[220:227], v26 abid:1
    v_cndmask_b32_dpp v181, v177, v185, vcc row_ror:8 row_mask:0xf bank_mask:0xf
    v_smfmac_f32_16x16x64_bf16 v[144:147], a[164:167], v[228:235], v30 abid:1
    v_cndmask_b32_dpp v182, v178, v186, vcc row_ror:8 row_mask:0xf bank_mask:0xf
    v_smfmac_f32_16x16x64_bf16 v[148:151], a[132:135], v[220:227], v27
    v_cndmask_b32_dpp v183, v179, v187, vcc row_ror:8 row_mask:0xf bank_mask:0xf
    v_smfmac_f32_16x16x64_bf16 v[148:151], a[168:171], v[228:235], v31
    s_waitcnt vmcnt(6)
    buffer_store_dwordx4 v[180:183], v6, s[12:15], s58 offen offset:128 sc1
    s_waitcnt lgkmcnt(8)
    v_xad_u32 v212, v216, v3, v4
    v_smfmac_f32_16x16x64_bf16 v[132:135], a[116:119], v[220:227], v25
    ds_read2st64_b32 v[212:213], v212 offset0:0 offset1:72
    v_xad_u32 v214, v217, v3, v4
    v_smfmac_f32_16x16x64_bf16 v[132:135], a[152:155], v[228:235], v29
    ds_read2st64_b32 v[214:215], v214 offset0:0 offset1:72
    s_waitcnt lgkmcnt(3)
    v_xad_u32 v236, v236, v3, v4
    v_smfmac_f32_16x16x64_bf16 v[132:135], v[240:243], v[244:251], v10
    v_xad_u32 v237, v237, v3, v4
    v_smfmac_f32_16x16x64_bf16 v[168:171], v[240:243], v[244:251], v10 abid:1
    ds_read2st64_b32 v[244:245], v236 offset0:0 offset1:72
    ds_read_b128 v[240:243], v8 offset:0
    v_xad_u32 v238, v238, v3, v4
    v_smfmac_f32_16x16x64_bf16 v[156:159], a[140:143], v[220:227], v49 abid:1
    ds_read2st64_b32 v[246:247], v237 offset0:0 offset1:72
    v_xad_u32 v239, v239, v3, v4
    v_smfmac_f32_16x16x64_bf16 v[156:159], a[176:179], v[228:235], v50
    ds_read2st64_b32 v[248:249], v238 offset0:0 offset1:72
    v_mov_b32_dpp v176, v184 row_ror:8 row_mask:0xf bank_mask:0xc
    v_smfmac_f32_16x16x64_bf16 v[140:143], a[196:199], v[196:203], v34
    ds_read2st64_b32 v[250:251], v239 offset0:0 offset1:72
    ds_read_b128 v[236:239], v9 offset:9728
    v_mov_b32_dpp v177, v185 row_ror:8 row_mask:0xf bank_mask:0xc
    v_smfmac_f32_16x16x64_bf16 v[140:143], a[232:235], v[204:211], v38
    v_mov_b32_dpp v178, v186 row_ror:8 row_mask:0xf bank_mask:0xc
    v_smfmac_f32_16x16x64_bf16 v[128:131], a[184:187], v[196:203], v32 abid:1
    v_mov_b32_dpp v179, v187 row_ror:8 row_mask:0xf bank_mask:0xc
    v_smfmac_f32_16x16x64_bf16 v[128:131], a[220:223], v[204:211], v36 abid:1
    s_waitcnt vmcnt(5)
    buffer_store_dwordx4 v[176:179], v6, s[12:15], s23 offen offset:128 sc1
    ds_read_b128 v[180:183], v9 offset:10560
    v_smfmac_f32_16x16x64_bf16 v[132:135], a[188:191], v[196:203], v33
    ds_read_b128 v[184:187], v9 offset:10624
    ds_read_b128 v[176:179], v9 offset:10496
    v_smfmac_f32_16x16x64_bf16 v[132:135], a[224:227], v[204:211], v37
    v_smfmac_f32_16x16x64_bf16 v[136:139], a[192:195], v[196:203], v33 abid:1
    ds_read_b128 v[220:223], v1 offset:7168
    v_smfmac_f32_16x16x64_bf16 v[136:139], a[228:231], v[204:211], v37 abid:1
    ds_read_b128 v[224:227], v2 offset:7168
    v_smfmac_f32_16x16x64_bf16 v[124:127], a[180:183], v[196:203], v32
    ds_read_b128 v[228:231], v1 offset:8192
    v_smfmac_f32_16x16x64_bf16 v[124:127], a[216:219], v[204:211], v36
    s_waitcnt vmcnt(7)
    s_waitcnt lgkmcnt(6)
    v_xad_u32 v236, v236, v3, v4
    v_smfmac_f32_16x16x64_bf16 v[124:127], v[240:243], v[244:251], v10
    ds_read_b128 v[232:235], v2 offset:8192
    v_xad_u32 v237, v237, v3, v4
    v_smfmac_f32_16x16x64_bf16 v[160:163], v[240:243], v[244:251], v10 abid:1
    ds_read2st64_b32 v[244:245], v236 offset0:0 offset1:72
    ds_read_b128 v[240:243], v8 offset:8192
    v_xad_u32 v238, v238, v3, v4
    v_smfmac_f32_16x16x64_bf16 v[144:147], a[200:203], v[196:203], v34 abid:1
    ds_read2st64_b32 v[246:247], v237 offset0:0 offset1:72
    v_xad_u32 v239, v239, v3, v4
    v_smfmac_f32_16x16x64_bf16 v[144:147], a[236:239], v[204:211], v38 abid:1
    ds_read2st64_b32 v[248:249], v238 offset0:0 offset1:72
    v_mul_u32_u24 v0, s94, v0
    v_smfmac_f32_16x16x64_bf16 v[148:151], a[204:207], v[196:203], v35
    ds_read2st64_b32 v[250:251], v239 offset0:0 offset1:72
    ds_read_b128 v[236:239], v9 offset:9664
    v_add_u32 v0, s93, v0
    v_smfmac_f32_16x16x64_bf16 v[148:151], a[240:243], v[204:211], v39
    s_waitcnt lgkmcnt(10)
    s_cmp_lt_i32 s81, 0
    s_cbranch_scc1 M_ovrE0
    s_swappc_b64 s[78:79], s[72:73]
M_ovrE0:
    v_smfmac_f32_16x16x64_bf16 v[152:155], a[208:211], v[196:203], v35 abid:1
    s_add_u32 m0, m0, 896
    v_min_u32 v0, 75497472, v0
    v_smfmac_f32_16x16x64_bf16 v[152:155], a[244:247], v[204:211], v39 abid:1
    ds_write_b32 v11, v0
    s_waitcnt vmcnt(6)
    v_mov_b32 v0, 162048
    v_smfmac_f32_16x16x64_bf16 v[156:159], a[212:215], v[196:203], v50 abid:1
    buffer_load_dwordx4 v5, s[8:11], s22 offen offset:896 nt lds
    v_smfmac_f32_16x16x64_bf16 v[156:159], a[248:251], v[204:211], v51
    s_waitcnt lgkmcnt(9)
    v_smfmac_f32_16x16x64_bf16 v[124:127], a[252:255], v[220:227], v40
    ds_read_b128 v[196:199], v1 offset:18432
    s_waitcnt lgkmcnt(8)
    v_smfmac_f32_16x16x64_bf16 v[124:127], v[88:91], v[228:235], v44
    ds_read_b128 v[200:203], v2 offset:18432
    v_smfmac_f32_16x16x64_bf16 v[156:159], v[84:87], v[220:227], v51 abid:1
    ds_read_b128 v[204:207], v1 offset:19456
    v_smfmac_f32_16x16x64_bf16 v[156:159], v[120:123], v[228:235], v52
    s_waitcnt lgkmcnt(3)
    s_barrier
    v_xad_u32 v236, v236, v3, v4
    v_smfmac_f32_16x16x64_bf16 v[156:159], v[240:243], v[244:251], v10
    ds_read_b128 v[208:211], v2 offset:19456
    ds_read_b32 v0, v0
    v_xad_u32 v237, v237, v3, v4
    v_smfmac_f32_16x16x64_bf16 v[192:195], v[240:243], v[244:251], v10 abid:1
    ds_read2st64_b32 v[244:245], v236 offset0:0 offset1:72
    ds_read_b128 v[240:243], v8 offset:7168
    v_xad_u32 v238, v238, v3, v4
    v_smfmac_f32_16x16x64_bf16 v[132:135], v[60:63], v[220:227], v41
    ds_read2st64_b32 v[246:247], v237 offset0:0 offset1:72
    v_xad_u32 v239, v239, v3, v4
    v_smfmac_f32_16x16x64_bf16 v[132:135], v[96:99], v[228:235], v45
    ds_read2st64_b32 v[248:249], v238 offset0:0 offset1:72
    s_add_u32 m0, m0, 896
    v_smfmac_f32_16x16x64_bf16 v[136:139], v[64:67], v[220:227], v41 abid:1
    ds_read2st64_b32 v[250:251], v239 offset0:0 offset1:72
    ds_read_b128 v[236:239], v9 offset:9536
    s_waitcnt vmcnt(5)
    v_smfmac_f32_16x16x64_bf16 v[136:139], v[100:103], v[228:235], v45 abid:1
    buffer_load_dwordx4 v5, s[8:11], s22 offen offset:1024 nt lds
    s_waitcnt lgkmcnt(6)
    v_readfirstlane_b32 s88, v0
    v_smfmac_f32_16x16x64_bf16 v[140:143], v[68:71], v[220:227], v42
    s_cmp_lt_u32 s88, s99
    s_cselect_b32 s10, 75497472, 0
    v_smfmac_f32_16x16x64_bf16 v[140:143], v[104:107], v[228:235], v46
    v_smfmac_f32_16x16x64_bf16 v[144:147], v[72:75], v[220:227], v42 abid:1
    ds_read_b128 v[212:215], v1 offset:20480
    v_smfmac_f32_16x16x64_bf16 v[144:147], v[108:111], v[228:235], v46 abid:1
    ds_read_b128 v[216:219], v2 offset:20480
    v_smfmac_f32_16x16x64_bf16 v[148:151], v[76:79], v[220:227], v43
    v_smfmac_f32_16x16x64_bf16 v[148:151], v[112:115], v[228:235], v47
    v_smfmac_f32_16x16x64_bf16 v[152:155], v[80:83], v[220:227], v43 abid:1
    v_smfmac_f32_16x16x64_bf16 v[152:155], v[116:119], v[228:235], v47 abid:1
    s_waitcnt lgkmcnt(2)
    v_xad_u32 v236, v236, v3, v4
    v_smfmac_f32_16x16x64_bf16 v[152:155], v[240:243], v[244:251], v10
    v_xad_u32 v237, v237, v3, v4
    v_smfmac_f32_16x16x64_bf16 v[188:191], v[240:243], v[244:251], v10 abid:1
    s_cmp_gt_u32 s46, s80
    s_cbranch_scc1 M_slow
M_slowrE0:
    v_xad_u32 v238, v238, v3, v4
    v_smfmac_f32_16x16x64_bf16 v[128:131], v[56:59], v[220:227], v40 abid:1
    ds_read2st64_b32 v[244:245], v236 offset0:0 offset1:72
    ds_read_b128 v[240:243], v8 offset:5120
    v_xad_u32 v239, v239, v3, v4
    v_smfmac_f32_16x16x64_bf16 v[128:131], v[92:95], v[228:235], v44 abid:1
    ds_read2st64_b32 v[246:247], v237 offset0:0 offset1:72
    v_smfmac_f32_16x16x64_bf16 v[160:163], a[0:3], v[196:203], v12
    ds_read2st64_b32 v[248:249], v238 offset0:0 offset1:72
    v_smfmac_f32_16x16x64_bf16 v[160:163], a[36:39], v[204:211], v16
    ds_read2st64_b32 v[250:251], v239 offset0:0 offset1:72
    ds_read_b128 v[236:239], v9 offset:9600
    s_waitcnt lgkmcnt(6)
    v_smfmac_f32_16x16x64_bf16 v[160:163], a[72:75], v[212:219], v20
    v_smfmac_f32_16x16x64_bf16 v[164:167], a[4:7], v[196:203], v12 abid:1
    s_mov_b32 m0, s28
    v_cvt_pk_bf16_f32 v156, v156, v157
    v_smfmac_f32_16x16x64_bf16 v[164:167], a[40:43], v[204:211], v16 abid:1
    s_waitcnt vmcnt(6)
    buffer_load_dwordx4 v5, s[8:11], s88 offen offset:0 nt lds
    v_cvt_pk_bf16_f32 v157, v158, v159
    v_smfmac_f32_16x16x64_bf16 v[164:167], a[76:79], v[212:219], v20 abid:1
    ds_write_b64 v53, v[156:157] offset:25728
    ds_read_b128 v[156:159], v9 offset:10752
    v_smfmac_f32_16x16x64_bf16 v[180:183], a[20:23], v[196:203], v14 abid:1
    v_smfmac_f32_16x16x64_bf16 v[180:183], a[56:59], v[204:211], v18 abid:1
    ds_read_b128 v[220:223], v1 offset:21504
    v_cvt_pk_bf16_f32 v124, v124, v125
    v_smfmac_f32_16x16x64_bf16 v[180:183], a[92:95], v[212:219], v22 abid:1
    s_waitcnt lgkmcnt(3)
    v_xad_u32 v236, v236, v3, v4
    v_smfmac_f32_16x16x64_bf16 v[180:183], v[240:243], v[244:251], v10 abid:1
    v_xad_u32 v237, v237, v3, v4
    v_smfmac_f32_16x16x64_bf16 v[144:147], v[240:243], v[244:251], v10
    ds_read2st64_b32 v[244:245], v236 offset0:0 offset1:72
    ds_read_b128 v[240:243], v8 offset:6144
    v_xad_u32 v238, v238, v3, v4
    v_smfmac_f32_16x16x64_bf16 v[172:175], a[12:15], v[196:203], v13 abid:1
    ds_read2st64_b32 v[246:247], v237 offset0:0 offset1:72
    v_xad_u32 v239, v239, v3, v4
    v_smfmac_f32_16x16x64_bf16 v[172:175], a[48:51], v[204:211], v17 abid:1
    ds_read2st64_b32 v[248:249], v238 offset0:0 offset1:72
    v_cvt_pk_bf16_f32 v125, v126, v127
    v_smfmac_f32_16x16x64_bf16 v[172:175], a[84:87], v[212:219], v21 abid:1
    ds_read2st64_b32 v[250:251], v239 offset0:0 offset1:72
    ds_read_b128 v[236:239], v9 offset:9472
    v_cvt_pk_bf16_f32 v126, v128, v129
    v_smfmac_f32_16x16x64_bf16 v[176:179], a[16:19], v[196:203], v14
    v_cvt_pk_bf16_f32 v127, v130, v131
    v_smfmac_f32_16x16x64_bf16 v[176:179], a[52:55], v[204:211], v18
    v_cvt_pk_bf16_f32 v132, v132, v133
    v_smfmac_f32_16x16x64_bf16 v[176:179], a[88:91], v[212:219], v22
    v_cvt_pk_bf16_f32 v133, v134, v135
    v_smfmac_f32_16x16x64_bf16 v[168:171], a[8:11], v[196:203], v13
    s_add_u32 m0, m0, 896
    v_cvt_pk_bf16_f32 v134, v136, v137
    v_smfmac_f32_16x16x64_bf16 v[168:171], a[44:47], v[204:211], v17
    s_waitcnt vmcnt(5)
    buffer_load_dwordx4 v5, s[8:11], s88 offen offset:128 nt lds
    v_cvt_pk_bf16_f32 v135, v138, v139
    v_smfmac_f32_16x16x64_bf16 v[168:171], a[80:83], v[212:219], v21
    ds_read_b128 v[224:227], v2 offset:21504
    ds_read_b128 v[136:139], v9 offset:10432
    v_cndmask_b32_dpp v128, v124, v132, vcc row_ror:8 row_mask:0xf bank_mask:0xf
    v_smfmac_f32_16x16x64_bf16 v[184:187], a[24:27], v[196:203], v15
    ds_read_b128 v[228:231], v1 offset:22528
    v_cndmask_b32_dpp v129, v125, v133, vcc row_ror:8 row_mask:0xf bank_mask:0xf
    v_smfmac_f32_16x16x64_bf16 v[184:187], a[60:63], v[204:211], v19
    ds_read_b128 v[232:235], v2 offset:22528
    v_cndmask_b32_dpp v130, v126, v134, vcc row_ror:8 row_mask:0xf bank_mask:0xf
    v_smfmac_f32_16x16x64_bf16 v[184:187], a[96:99], v[212:219], v23
    s_waitcnt lgkmcnt(4)
    v_xad_u32 v236, v236, v3, v4
    v_smfmac_f32_16x16x64_bf16 v[184:187], v[240:243], v[244:251], v10 abid:1
    v_xad_u32 v237, v237, v3, v4
    v_smfmac_f32_16x16x64_bf16 v[148:151], v[240:243], v[244:251], v10
    ds_read2st64_b32 v[244:245], v236 offset0:0 offset1:72
    ds_read_b128 v[240:243], v8 offset:4096
    v_xad_u32 v238, v238, v3, v4
    v_smfmac_f32_16x16x64_bf16 v[188:191], a[28:31], v[196:203], v15 abid:1
    ds_read2st64_b32 v[246:247], v237 offset0:0 offset1:72
    v_xad_u32 v239, v239, v3, v4
    v_smfmac_f32_16x16x64_bf16 v[188:191], a[64:67], v[204:211], v19 abid:1
    ds_read2st64_b32 v[248:249], v238 offset0:0 offset1:72
    v_cndmask_b32_dpp v131, v127, v135, vcc row_ror:8 row_mask:0xf bank_mask:0xf
    v_smfmac_f32_16x16x64_bf16 v[188:191], a[100:103], v[212:219], v23 abid:1
    ds_read2st64_b32 v[250:251], v239 offset0:0 offset1:72
    s_waitcnt vmcnt(6)
    buffer_store_dwordx4 v[128:131], v6, s[12:15], s59 offen offset:0 sc1
    v_smfmac_f32_16x16x64_bf16 v[192:195], a[32:35], v[196:203], v48
    v_mov_b32_dpp v124, v132 row_ror:8 row_mask:0xf bank_mask:0xc
    v_smfmac_f32_16x16x64_bf16 v[192:195], a[68:71], v[204:211], v48 abid:1
    v_mov_b32_dpp v125, v133 row_ror:8 row_mask:0xf bank_mask:0xc
    v_smfmac_f32_16x16x64_bf16 v[192:195], a[104:107], v[212:219], v49
    s_waitcnt lgkmcnt(8)
    v_mov_b32_dpp v126, v134 row_ror:8 row_mask:0xf bank_mask:0xc
    v_smfmac_f32_16x16x64_bf16 v[160:163], a[108:111], v[220:227], v24
    s_waitcnt lgkmcnt(5)
    v_mov_b32_dpp v127, v135 row_ror:8 row_mask:0xf bank_mask:0xc
    v_smfmac_f32_16x16x64_bf16 v[160:163], a[144:147], v[228:235], v28
    ds_read_b128 v[196:199], v1 offset:23552
    s_waitcnt vmcnt(5)
    buffer_store_dwordx4 v[124:127], v6, s[12:15], s24 offen offset:0 sc1
    v_smfmac_f32_16x16x64_bf16 v[164:167], a[112:115], v[220:227], v24 abid:1
    ds_read_b128 v[200:203], v2 offset:23552
    ds_read_b128 v[128:131], v9 offset:10304
    ds_read_b128 v[132:135], v9 offset:10368
    v_smfmac_f32_16x16x64_bf16 v[164:167], a[148:151], v[228:235], v28 abid:1
    ds_read_b128 v[204:207], v1 offset:24576
    ds_read_b128 v[124:127], v9 offset:10240
    v_smfmac_f32_16x16x64_bf16 v[176:179], a[124:127], v[220:227], v26
    ds_read_b128 v[208:211], v2 offset:24576
    v_smfmac_f32_16x16x64_bf16 v[176:179], a[160:163], v[228:235], v30
    s_waitcnt lgkmcnt(7)
    v_smfmac_f32_16x16x64_bf16 v[176:179], v[240:243], v[244:251], v10 abid:1
    v_smfmac_f32_16x16x64_bf16 v[140:143], v[240:243], v[244:251], v10
    v_smfmac_f32_16x16x64_bf16 v[172:175], a[120:123], v[220:227], v25 abid:1
    s_add_u32 s28, s28, 36864
    s_cmp_ge_u32 s28, 110592
    s_cselect_b32 s28, s26, s28
    v_smfmac_f32_16x16x64_bf16 v[172:175], a[156:159], v[228:235], v29 abid:1
    s_add_u32 s30, s25, 36864
    s_cmp_eq_u32 s30, 110592
    s_cselect_b32 s30, 0, s30
    v_smfmac_f32_16x16x64_bf16 v[168:171], a[116:119], v[220:227], v25
    s_sub_u32 s31, s30, s25
    s_mov_b32 s25, s30
    s_mov_b32 s90, s22
    v_smfmac_f32_16x16x64_bf16 v[168:171], a[152:155], v[228:235], v29
    s_mov_b32 s22, s88
    s_add_u32 s91, s91, 1
    s_cmp_lt_u32 s20, 2
    v_smfmac_f32_16x16x64_bf16 v[180:183], a[128:131], v[220:227], v26 abid:1
    s_cselect_b32 s66, s23, s24
    s_add_u32 s66, s66, s95
    v_smfmac_f32_16x16x64_bf16 v[180:183], a[164:167], v[228:235], v30 abid:1
    v_cvt_pk_bf16_f32 v140, v140, v141
    v_smfmac_f32_16x16x64_bf16 v[184:187], a[132:135], v[220:227], v27
    s_add_u32 m0, m0, 896
    v_cvt_pk_bf16_f32 v141, v142, v143
    v_smfmac_f32_16x16x64_bf16 v[184:187], a[168:171], v[228:235], v31
    s_waitcnt vmcnt(6)
    buffer_load_dwordx4 v5, s[8:11], s88 offen offset:256 nt lds
    v_cvt_pk_bf16_f32 v142, v144, v145
    v_smfmac_f32_16x16x64_bf16 v[188:191], a[136:139], v[220:227], v27 abid:1
    v_cvt_pk_bf16_f32 v143, v146, v147
    v_smfmac_f32_16x16x64_bf16 v[188:191], a[172:175], v[228:235], v31 abid:1
    v_cvt_pk_bf16_f32 v148, v148, v149
    v_smfmac_f32_16x16x64_bf16 v[192:195], a[140:143], v[220:227], v49 abid:1
    v_cvt_pk_bf16_f32 v149, v150, v151
    v_smfmac_f32_16x16x64_bf16 v[192:195], a[176:179], v[228:235], v50
    ds_read_b128 v[220:223], v1 offset:25600
    s_waitcnt lgkmcnt(6)
    v_cvt_pk_bf16_f32 v150, v152, v153
    v_smfmac_f32_16x16x64_bf16 v[160:163], a[180:183], v[196:203], v32
    ds_read_b128 v[224:227], v2 offset:25600
    s_waitcnt lgkmcnt(2)
    v_cvt_pk_bf16_f32 v151, v154, v155
    v_smfmac_f32_16x16x64_bf16 v[160:163], a[216:219], v[204:211], v36
    ds_read_b128 v[228:231], v1 offset:26624
    ds_read_b128 v[152:155], v9 offset:10688
    v_cndmask_b32_dpp v144, v140, v148, vcc row_ror:8 row_mask:0xf bank_mask:0xf
    v_smfmac_f32_16x16x64_bf16 v[164:167], a[184:187], v[196:203], v32 abid:1
    ds_read_b128 v[232:235], v2 offset:26624
    v_cndmask_b32_dpp v145, v141, v149, vcc row_ror:8 row_mask:0xf bank_mask:0xf
    v_smfmac_f32_16x16x64_bf16 v[164:167], a[220:223], v[204:211], v36 abid:1
    s_add_u32 m0, m0, 896
    v_cndmask_b32_dpp v146, v142, v150, vcc row_ror:8 row_mask:0xf bank_mask:0xf
    v_smfmac_f32_16x16x64_bf16 v[168:171], a[188:191], v[196:203], v33
    s_waitcnt vmcnt(5)
    buffer_load_dwordx4 v5, s[8:11], s88 offen offset:384 nt lds
    v_cndmask_b32_dpp v147, v143, v151, vcc row_ror:8 row_mask:0xf bank_mask:0xf
    v_smfmac_f32_16x16x64_bf16 v[168:171], a[224:227], v[204:211], v37
    s_waitcnt vmcnt(6)
    buffer_store_dwordx4 v[144:147], v6, s[12:15], s59 offen offset:128 sc1
    v_mov_b32_dpp v140, v148 row_ror:8 row_mask:0xf bank_mask:0xc
    v_smfmac_f32_16x16x64_bf16 v[172:175], a[192:195], v[196:203], v33 abid:1
    v_mov_b32_dpp v141, v149 row_ror:8 row_mask:0xf bank_mask:0xc
    v_smfmac_f32_16x16x64_bf16 v[172:175], a[228:231], v[204:211], v37 abid:1
    v_mov_b32_dpp v142, v150 row_ror:8 row_mask:0xf bank_mask:0xc
    v_smfmac_f32_16x16x64_bf16 v[176:179], a[196:199], v[196:203], v34
    v_mov_b32_dpp v143, v151 row_ror:8 row_mask:0xf bank_mask:0xc
    v_smfmac_f32_16x16x64_bf16 v[176:179], a[232:235], v[204:211], v38
    s_waitcnt vmcnt(5)
    buffer_store_dwordx4 v[140:143], v6, s[12:15], s24 offen offset:128 sc1
    ds_read_b128 v[144:147], v9 offset:10560
    v_smfmac_f32_16x16x64_bf16 v[180:183], a[200:203], v[196:203], v34 abid:1
    ds_read_b128 v[148:151], v9 offset:10624
    ds_read_b128 v[140:143], v9 offset:10496
    v_add_u32 v4, s31, v4
    v_smfmac_f32_16x16x64_bf16 v[180:183], a[236:239], v[204:211], v38 abid:1
    v_add_u32 v1, s31, v1
    v_smfmac_f32_16x16x64_bf16 v[184:187], a[204:207], v[196:203], v35
    v_add_u32 v2, s31, v2
    v_smfmac_f32_16x16x64_bf16 v[184:187], a[240:243], v[204:211], v39
    v_smfmac_f32_16x16x64_bf16 v[188:191], a[208:211], v[196:203], v35 abid:1
    v_smfmac_f32_16x16x64_bf16 v[188:191], a[244:247], v[204:211], v39 abid:1
    v_smfmac_f32_16x16x64_bf16 v[192:195], a[212:215], v[196:203], v50 abid:1
    v_smfmac_f32_16x16x64_bf16 v[192:195], a[248:251], v[204:211], v51
    s_waitcnt vmcnt(8)
    s_branch M_top1
M_q:
    s_mov_b32 s21, 3
    v_smfmac_f32_16x16x64_bf16 v[144:147], v[72:75], v[220:227], v42 abid:1
    ds_read_b128 v[212:215], v1 offset:20480
    v_smfmac_f32_16x16x64_bf16 v[144:147], v[108:111], v[228:235], v46 abid:1
    ds_read_b128 v[216:219], v2 offset:20480
    v_smfmac_f32_16x16x64_bf16 v[148:151], v[76:79], v[220:227], v43
    v_smfmac_f32_16x16x64_bf16 v[148:151], v[112:115], v[228:235], v47
    v_smfmac_f32_16x16x64_bf16 v[152:155], v[80:83], v[220:227], v43 abid:1
    v_smfmac_f32_16x16x64_bf16 v[152:155], v[116:119], v[228:235], v47 abid:1
    s_waitcnt lgkmcnt(2)
    v_xad_u32 v236, v236, v3, v4
    v_smfmac_f32_16x16x64_bf16 v[152:155], v[240:243], v[244:251], v10
    v_xad_u32 v237, v237, v3, v4
    v_smfmac_f32_16x16x64_bf16 v[188:191], v[240:243], v[244:251], v10 abid:1
    s_cmp_gt_u32 s46, s80
    s_cbranch_scc1 M_slow
M_slowrQ:
    v_xad_u32 v238, v238, v3, v4
    v_smfmac_f32_16x16x64_bf16 v[128:131], v[56:59], v[220:227], v40 abid:1
    ds_read2st64_b32 v[244:245], v236 offset0:0 offset1:72
    ds_read_b128 v[240:243], v8 offset:5120
    v_xad_u32 v239, v239, v3, v4
    v_smfmac_f32_16x16x64_bf16 v[128:131], v[92:95], v[228:235], v44 abid:1
    ds_read2st64_b32 v[246:247], v237 offset0:0 offset1:72
    v_smfmac_f32_16x16x64_bf16 v[160:163], a[0:3], v[196:203], v12
    ds_read2st64_b32 v[248:249], v238 offset0:0 offset1:72
    v_smfmac_f32_16x16x64_bf16 v[160:163], a[36:39], v[204:211], v16
    ds_read2st64_b32 v[250:251], v239 offset0:0 offset1:72
    ds_read_b128 v[236:239], v9 offset:9600
    s_waitcnt lgkmcnt(6)
    v_smfmac_f32_16x16x64_bf16 v[160:163], a[72:75], v[212:219], v20
    v_smfmac_f32_16x16x64_bf16 v[164:167], a[4:7], v[196:203], v12 abid:1
    v_cvt_pk_bf16_f32 v156, v156, v157
    v_smfmac_f32_16x16x64_bf16 v[164:167], a[40:43], v[204:211], v16 abid:1
    v_cvt_pk_bf16_f32 v157, v158, v159
    v_smfmac_f32_16x16x64_bf16 v[164:167], a[76:79], v[212:219], v20 abid:1
    ds_write_b64 v53, v[156:157] offset:25728
    ds_read_b128 v[156:159], v9 offset:10752
    v_smfmac_f32_16x16x64_bf16 v[180:183], a[20:23], v[196:203], v14 abid:1
    v_smfmac_f32_16x16x64_bf16 v[180:183], a[56:59], v[204:211], v18 abid:1
    ds_read_b128 v[220:223], v1 offset:21504
    v_cvt_pk_bf16_f32 v124, v124, v125
    v_smfmac_f32_16x16x64_bf16 v[180:183], a[92:95], v[212:219], v22 abid:1
    s_waitcnt lgkmcnt(3)
    v_xad_u32 v236, v236, v3, v4
    v_smfmac_f32_16x16x64_bf16 v[180:183], v[240:243], v[244:251], v10 abid:1
    v_xad_u32 v237, v237, v3, v4
    v_smfmac_f32_16x16x64_bf16 v[144:147], v[240:243], v[244:251], v10
    ds_read2st64_b32 v[244:245], v236 offset0:0 offset1:72
    ds_read_b128 v[240:243], v8 offset:6144
    v_xad_u32 v238, v238, v3, v4
    v_smfmac_f32_16x16x64_bf16 v[172:175], a[12:15], v[196:203], v13 abid:1
    ds_read2st64_b32 v[246:247], v237 offset0:0 offset1:72
    v_xad_u32 v239, v239, v3, v4
    v_smfmac_f32_16x16x64_bf16 v[172:175], a[48:51], v[204:211], v17 abid:1
    ds_read2st64_b32 v[248:249], v238 offset0:0 offset1:72
    v_cvt_pk_bf16_f32 v125, v126, v127
    v_smfmac_f32_16x16x64_bf16 v[172:175], a[84:87], v[212:219], v21 abid:1
    ds_read2st64_b32 v[250:251], v239 offset0:0 offset1:72
    ds_read_b128 v[236:239], v9 offset:9472
    v_cvt_pk_bf16_f32 v126, v128, v129
    v_smfmac_f32_16x16x64_bf16 v[176:179], a[16:19], v[196:203], v14
    v_cvt_pk_bf16_f32 v127, v130, v131
    v_smfmac_f32_16x16x64_bf16 v[176:179], a[52:55], v[204:211], v18
    v_cvt_pk_bf16_f32 v132, v132, v133
    v_smfmac_f32_16x16x64_bf16 v[176:179], a[88:91], v[212:219], v22
    v_cvt_pk_bf16_f32 v133, v134, v135
    v_smfmac_f32_16x16x64_bf16 v[168:171], a[8:11], v[196:203], v13
    v_cvt_pk_bf16_f32 v134, v136, v137
    v_smfmac_f32_16x16x64_bf16 v[168:171], a[44:47], v[204:211], v17
    v_cvt_pk_bf16_f32 v135, v138, v139
    v_smfmac_f32_16x16x64_bf16 v[168:171], a[80:83], v[212:219], v21
    ds_read_b128 v[224:227], v2 offset:21504
    ds_read_b128 v[136:139], v9 offset:10432
    v_cndmask_b32_dpp v128, v124, v132, vcc row_ror:8 row_mask:0xf bank_mask:0xf
    v_smfmac_f32_16x16x64_bf16 v[184:187], a[24:27], v[196:203], v15
    ds_read_b128 v[228:231], v1 offset:22528
    v_cndmask_b32_dpp v129, v125, v133, vcc row_ror:8 row_mask:0xf bank_mask:0xf
    v_smfmac_f32_16x16x64_bf16 v[184:187], a[60:63], v[204:211], v19
    ds_read_b128 v[232:235], v2 offset:22528
    v_cndmask_b32_dpp v130, v126, v134, vcc row_ror:8 row_mask:0xf bank_mask:0xf
    v_smfmac_f32_16x16x64_bf16 v[184:187], a[96:99], v[212:219], v23
    s_waitcnt lgkmcnt(4)
    v_xad_u32 v236, v236, v3, v4
    v_smfmac_f32_16x16x64_bf16 v[184:187], v[240:243], v[244:251], v10 abid:1
    v_xad_u32 v237, v237, v3, v4
    v_smfmac_f32_16x16x64_bf16 v[148:151], v[240:243], v[244:251], v10
    ds_read2st64_b32 v[244:245], v236 offset0:0 offset1:72
    ds_read_b128 v[240:243], v8 offset:4096
    v_xad_u32 v238, v238, v3, v4
    v_smfmac_f32_16x16x64_bf16 v[188:191], a[28:31], v[196:203], v15 abid:1
    ds_read2st64_b32 v[246:247], v237 offset0:0 offset1:72
    v_xad_u32 v239, v239, v3, v4
    v_smfmac_f32_16x16x64_bf16 v[188:191], a[64:67], v[204:211], v19 abid:1
    ds_read2st64_b32 v[248:249], v238 offset0:0 offset1:72
    v_cndmask_b32_dpp v131, v127, v135, vcc row_ror:8 row_mask:0xf bank_mask:0xf
    v_smfmac_f32_16x16x64_bf16 v[188:191], a[100:103], v[212:219], v23 abid:1
    ds_read2st64_b32 v[250:251], v239 offset0:0 offset1:72
    buffer_store_dwordx4 v[128:131], v6, s[12:15], s59 offen offset:0 sc1
    v_smfmac_f32_16x16x64_bf16 v[192:195], a[32:35], v[196:203], v48
    v_mov_b32_dpp v124, v132 row_ror:8 row_mask:0xf bank_mask:0xc
    v_smfmac_f32_16x16x64_bf16 v[192:195], a[68:71], v[204:211], v48 abid:1
    v_mov_b32_dpp v125, v133 row_ror:8 row_mask:0xf bank_mask:0xc
    v_smfmac_f32_16x16x64_bf16 v[192:195], a[104:107], v[212:219], v49
    s_waitcnt lgkmcnt(8)
    v_mov_b32_dpp v126, v134 row_ror:8 row_mask:0xf bank_mask:0xc
    v_smfmac_f32_16x16x64_bf16 v[160:163], a[108:111], v[220:227], v24
    s_waitcnt lgkmcnt(5)
    v_mov_b32_dpp v127, v135 row_ror:8 row_mask:0xf bank_mask:0xc
    v_smfmac_f32_16x16x64_bf16 v[160:163], a[144:147], v[228:235], v28
    ds_read_b128 v[196:199], v1 offset:23552
    buffer_store_dwordx4 v[124:127], v6, s[12:15], s24 offen offset:0 sc1
    v_smfmac_f32_16x16x64_bf16 v[164:167], a[112:115], v[220:227], v24 abid:1
    ds_read_b128 v[200:203], v2 offset:23552
    ds_read_b128 v[128:131], v9 offset:10304
    ds_read_b128 v[132:135], v9 offset:10368
    v_smfmac_f32_16x16x64_bf16 v[164:167], a[148:151], v[228:235], v28 abid:1
    ds_read_b128 v[204:207], v1 offset:24576
    ds_read_b128 v[124:127], v9 offset:10240
    v_smfmac_f32_16x16x64_bf16 v[176:179], a[124:127], v[220:227], v26
    ds_read_b128 v[208:211], v2 offset:24576
    v_smfmac_f32_16x16x64_bf16 v[176:179], a[160:163], v[228:235], v30
    s_waitcnt lgkmcnt(7)
    v_smfmac_f32_16x16x64_bf16 v[176:179], v[240:243], v[244:251], v10 abid:1
    v_smfmac_f32_16x16x64_bf16 v[140:143], v[240:243], v[244:251], v10
    v_smfmac_f32_16x16x64_bf16 v[172:175], a[120:123], v[220:227], v25 abid:1
    s_add_u32 s28, s28, 36864
    s_cmp_ge_u32 s28, 110592
    s_cselect_b32 s28, s26, s28
    v_smfmac_f32_16x16x64_bf16 v[172:175], a[156:159], v[228:235], v29 abid:1
    s_add_u32 s30, s25, 36864
    s_cmp_eq_u32 s30, 110592
    s_cselect_b32 s30, 0, s30
    v_smfmac_f32_16x16x64_bf16 v[168:171], a[116:119], v[220:227], v25
    s_sub_u32 s31, s30, s25
    s_mov_b32 s25, s30
    s_mov_b32 s90, s22
    v_smfmac_f32_16x16x64_bf16 v[168:171], a[152:155], v[228:235], v29
    s_mov_b32 s22, s88
    s_add_u32 s91, s91, 1
    s_cmp_lt_u32 s20, 2
    v_smfmac_f32_16x16x64_bf16 v[180:183], a[128:131], v[220:227], v26 abid:1
    s_cselect_b32 s66, s23, s24
    s_add_u32 s66, s66, s95
    v_smfmac_f32_16x16x64_bf16 v[180:183], a[164:167], v[228:235], v30 abid:1
    v_cvt_pk_bf16_f32 v140, v140, v141
    v_smfmac_f32_16x16x64_bf16 v[184:187], a[132:135], v[220:227], v27
    v_cvt_pk_bf16_f32 v141, v142, v143
    v_smfmac_f32_16x16x64_bf16 v[184:187], a[168:171], v[228:235], v31
    v_cvt_pk_bf16_f32 v142, v144, v145
    v_smfmac_f32_16x16x64_bf16 v[188:191], a[136:139], v[220:227], v27 abid:1
    v_cvt_pk_bf16_f32 v143, v146, v147
    v_smfmac_f32_16x16x64_bf16 v[188:191], a[172:175], v[228:235], v31 abid:1
    v_cvt_pk_bf16_f32 v148, v148, v149
    v_smfmac_f32_16x16x64_bf16 v[192:195], a[140:143], v[220:227], v49 abid:1
    v_cvt_pk_bf16_f32 v149, v150, v151
    v_smfmac_f32_16x16x64_bf16 v[192:195], a[176:179], v[228:235], v50
    ds_read_b128 v[220:223], v1 offset:25600
    s_waitcnt lgkmcnt(6)
    v_cvt_pk_bf16_f32 v150, v152, v153
    v_smfmac_f32_16x16x64_bf16 v[160:163], a[180:183], v[196:203], v32
    ds_read_b128 v[224:227], v2 offset:25600
    s_waitcnt lgkmcnt(2)
    v_cvt_pk_bf16_f32 v151, v154, v155
    v_smfmac_f32_16x16x64_bf16 v[160:163], a[216:219], v[204:211], v36
    ds_read_b128 v[228:231], v1 offset:26624
    ds_read_b128 v[152:155], v9 offset:10688
    v_cndmask_b32_dpp v144, v140, v148, vcc row_ror:8 row_mask:0xf bank_mask:0xf
    v_smfmac_f32_16x16x64_bf16 v[164:167], a[184:187], v[196:203], v32 abid:1
    ds_read_b128 v[232:235], v2 offset:26624
    v_cndmask_b32_dpp v145, v141, v149, vcc row_ror:8 row_mask:0xf bank_mask:0xf
    v_smfmac_f32_16x16x64_bf16 v[164:167], a[220:223], v[204:211], v36 abid:1
    v_cndmask_b32_dpp v146, v142, v150, vcc row_ror:8 row_mask:0xf bank_mask:0xf
    v_smfmac_f32_16x16x64_bf16 v[168:171], a[188:191], v[196:203], v33
    v_cndmask_b32_dpp v147, v143, v151, vcc row_ror:8 row_mask:0xf bank_mask:0xf
    v_smfmac_f32_16x16x64_bf16 v[168:171], a[224:227], v[204:211], v37
    buffer_store_dwordx4 v[144:147], v6, s[12:15], s59 offen offset:128 sc1
    v_mov_b32_dpp v140, v148 row_ror:8 row_mask:0xf bank_mask:0xc
    v_smfmac_f32_16x16x64_bf16 v[172:175], a[192:195], v[196:203], v33 abid:1
    v_mov_b32_dpp v141, v149 row_ror:8 row_mask:0xf bank_mask:0xc
    v_smfmac_f32_16x16x64_bf16 v[172:175], a[228:231], v[204:211], v37 abid:1
    v_mov_b32_dpp v142, v150 row_ror:8 row_mask:0xf bank_mask:0xc
    v_smfmac_f32_16x16x64_bf16 v[176:179], a[196:199], v[196:203], v34
    v_mov_b32_dpp v143, v151 row_ror:8 row_mask:0xf bank_mask:0xc
    v_smfmac_f32_16x16x64_bf16 v[176:179], a[232:235], v[204:211], v38
    buffer_store_dwordx4 v[140:143], v6, s[12:15], s24 offen offset:128 sc1
    ds_read_b128 v[144:147], v9 offset:10560
    v_smfmac_f32_16x16x64_bf16 v[180:183], a[200:203], v[196:203], v34 abid:1
    ds_read_b128 v[148:151], v9 offset:10624
    ds_read_b128 v[140:143], v9 offset:10496
    v_add_u32 v4, s31, v4
    v_smfmac_f32_16x16x64_bf16 v[180:183], a[236:239], v[204:211], v38 abid:1
    v_add_u32 v1, s31, v1
    v_smfmac_f32_16x16x64_bf16 v[184:187], a[204:207], v[196:203], v35
    v_add_u32 v2, s31, v2
    v_smfmac_f32_16x16x64_bf16 v[184:187], a[240:243], v[204:211], v39
    v_smfmac_f32_16x16x64_bf16 v[188:191], a[208:211], v[196:203], v35 abid:1
    v_smfmac_f32_16x16x64_bf16 v[188:191], a[244:247], v[204:211], v39 abid:1
    v_smfmac_f32_16x16x64_bf16 v[192:195], a[212:215], v[196:203], v50 abid:1
    v_smfmac_f32_16x16x64_bf16 v[192:195], a[248:251], v[204:211], v51
    s_waitcnt vmcnt(4)
    s_branch M_top1
M_bF:
    v_smfmac_f32_16x16x64_bf16 v[164:167], v[56:59], v[220:227], v40 abid:1
    ds_read_b128 v[204:207], v1 offset:1024
    v_smfmac_f32_16x16x64_bf16 v[164:167], v[92:95], v[228:235], v44 abid:1
    ds_read_b128 v[208:211], v2 offset:1024
    v_smfmac_f32_16x16x64_bf16 v[168:171], v[60:63], v[220:227], v41
    ds_read_b128 v[212:215], v1 offset:2048
    v_smfmac_f32_16x16x64_bf16 v[168:171], v[96:99], v[228:235], v45
    ds_read_b128 v[216:219], v2 offset:2048
    v_smfmac_f32_16x16x64_bf16 v[172:175], v[64:67], v[220:227], v41 abid:1
    s_waitcnt lgkmcnt(6)
    buffer_store_dwordx4 v[244:247], v7, s[12:15], s66 offen sc1
    v_smfmac_f32_16x16x64_bf16 v[172:175], v[100:103], v[228:235], v45 abid:1
    ds_read_b128 v[236:239], v9 offset:9408
    v_smfmac_f32_16x16x64_bf16 v[176:179], v[68:71], v[220:227], v42
    s_mov_b32 s21, 4
    v_smfmac_f32_16x16x64_bf16 v[176:179], v[104:107], v[228:235], v46
    v_smfmac_f32_16x16x64_bf16 v[180:183], v[72:75], v[220:227], v42 abid:1
    v_cvt_pk_bf16_f32 v160, v160, v161
    v_smfmac_f32_16x16x64_bf16 v[180:183], v[108:111], v[228:235], v46 abid:1
    v_cvt_pk_bf16_f32 v161, v162, v163
    v_smfmac_f32_16x16x64_bf16 v[184:187], v[76:79], v[220:227], v43
    v_cvt_pk_bf16_f32 v162, v164, v165
    v_smfmac_f32_16x16x64_bf16 v[184:187], v[112:115], v[228:235], v47
    v_cvt_pk_bf16_f32 v163, v166, v167
    v_smfmac_f32_16x16x64_bf16 v[188:191], v[80:83], v[220:227], v43 abid:1
    v_cvt_pk_bf16_f32 v168, v168, v169
    v_smfmac_f32_16x16x64_bf16 v[188:191], v[116:119], v[228:235], v47 abid:1
    v_cvt_pk_bf16_f32 v169, v170, v171
    v_smfmac_f32_16x16x64_bf16 v[192:195], v[84:87], v[220:227], v51 abid:1
    v_cvt_pk_bf16_f32 v170, v172, v173
    v_smfmac_f32_16x16x64_bf16 v[192:195], v[120:123], v[228:235], v52
    ds_read_b128 v[220:223], v1 offset:3072
    s_waitcnt lgkmcnt(6)
    v_cvt_pk_bf16_f32 v171, v174, v175
    v_smfmac_f32_16x16x64_bf16 v[124:127], a[0:3], v[196:203], v12
    ds_read_b128 v[224:227], v2 offset:3072
    ds_read_b128 v[172:175], v9 offset:10432
    s_waitcnt lgkmcnt(6)
    v_cndmask_b32_dpp v164, v160, v168, vcc row_ror:8 row_mask:0xf bank_mask:0xf
    v_smfmac_f32_16x16x64_bf16 v[124:127], a[36:39], v[204:211], v16
    ds_read_b128 v[228:231], v1 offset:4096
    s_waitcnt lgkmcnt(5)
    v_cndmask_b32_dpp v165, v161, v169, vcc row_ror:8 row_mask:0xf bank_mask:0xf
    v_smfmac_f32_16x16x64_bf16 v[124:127], a[72:75], v[212:219], v20
    ds_read_b128 v[232:235], v2 offset:4096
    s_waitcnt lgkmcnt(5)
    v_xad_u32 v236, v236, v3, v4
    v_smfmac_f32_16x16x64_bf16 v[156:159], a[32:35], v[196:203], v48
    s_barrier
    v_xad_u32 v237, v237, v3, v4
    v_smfmac_f32_16x16x64_bf16 v[156:159], a[68:71], v[204:211], v48 abid:1
    ds_read2st64_b32 v[244:245], v236 offset0:0 offset1:72
    ds_read_b128 v[240:243], v8 offset:3072
    v_xad_u32 v238, v238, v3, v4
    v_smfmac_f32_16x16x64_bf16 v[156:159], a[104:107], v[212:219], v49
    ds_read2st64_b32 v[246:247], v237 offset0:0 offset1:72
    v_xad_u32 v239, v239, v3, v4
    v_smfmac_f32_16x16x64_bf16 v[132:135], a[8:11], v[196:203], v13
    ds_read2st64_b32 v[248:249], v238 offset0:0 offset1:72
    v_cndmask_b32_dpp v166, v162, v170, vcc row_ror:8 row_mask:0xf bank_mask:0xf
    v_smfmac_f32_16x16x64_bf16 v[132:135], a[44:47], v[204:211], v17
    ds_read2st64_b32 v[250:251], v239 offset0:0 offset1:72
    ds_read_b128 v[236:239], v9 offset:9280
    v_cndmask_b32_dpp v167, v163, v171, vcc row_ror:8 row_mask:0xf bank_mask:0xf
    v_smfmac_f32_16x16x64_bf16 v[132:135], a[80:83], v[212:219], v21
    buffer_store_dwordx4 v[164:167], v6, s[12:15], s58 offen offset:0 sc1
    v_mov_b32_dpp v160, v168 row_ror:8 row_mask:0xf bank_mask:0xc
    v_smfmac_f32_16x16x64_bf16 v[140:143], a[16:19], v[196:203], v14
    v_mov_b32_dpp v161, v169 row_ror:8 row_mask:0xf bank_mask:0xc
    v_smfmac_f32_16x16x64_bf16 v[140:143], a[52:55], v[204:211], v18
    v_mov_b32_dpp v162, v170 row_ror:8 row_mask:0xf bank_mask:0xc
    v_smfmac_f32_16x16x64_bf16 v[140:143], a[88:91], v[212:219], v22
    v_mov_b32_dpp v163, v171 row_ror:8 row_mask:0xf bank_mask:0xc
    v_smfmac_f32_16x16x64_bf16 v[136:139], a[12:15], v[196:203], v13 abid:1
    buffer_store_dwordx4 v[160:163], v6, s[12:15], s23 offen offset:0 sc1
    ds_read_b128 v[164:167], v9 offset:10304
    ds_read_b128 v[168:171], v9 offset:10368
    v_smfmac_f32_16x16x64_bf16 v[136:139], a[48:51], v[204:211], v17 abid:1
    ds_read_b128 v[160:163], v9 offset:10240
    v_smfmac_f32_16x16x64_bf16 v[136:139], a[84:87], v[212:219], v21 abid:1
    s_waitcnt lgkmcnt(3)
    v_xad_u32 v236, v236, v3, v4
    v_smfmac_f32_16x16x64_bf16 v[136:139], v[240:243], v[244:251], v10
    v_xad_u32 v237, v237, v3, v4
    v_smfmac_f32_16x16x64_bf16 v[172:175], v[240:243], v[244:251], v10 abid:1
    ds_read2st64_b32 v[244:245], v236 offset0:0 offset1:72
    ds_read_b128 v[240:243], v8 offset:1024
    v_xad_u32 v238, v238, v3, v4
    v_smfmac_f32_16x16x64_bf16 v[144:147], a[20:23], v[196:203], v14 abid:1
    ds_read2st64_b32 v[246:247], v237 offset0:0 offset1:72
    v_xad_u32 v239, v239, v3, v4
    v_smfmac_f32_16x16x64_bf16 v[144:147], a[56:59], v[204:211], v18 abid:1
    ds_read2st64_b32 v[248:249], v238 offset0:0 offset1:72
    v_smfmac_f32_16x16x64_bf16 v[144:147], a[92:95], v[212:219], v22 abid:1
    ds_read2st64_b32 v[250:251], v239 offset0:0 offset1:72
    ds_read_b128 v[236:239], v9 offset:9344
    v_smfmac_f32_16x16x64_bf16 v[148:151], a[24:27], v[196:203], v15
    v_cvt_pk_bf16_f32 v192, v192, v193
    v_smfmac_f32_16x16x64_bf16 v[148:151], a[60:63], v[204:211], v19
    v_cvt_pk_bf16_f32 v193, v194, v195
    v_smfmac_f32_16x16x64_bf16 v[148:151], a[96:99], v[212:219], v23
    ds_write_b64 v53, v[192:193] offset:0
    ds_read_b128 v[192:195], v9 offset:10752
    v_smfmac_f32_16x16x64_bf16 v[152:155], a[28:31], v[196:203], v15 abid:1
    v_smfmac_f32_16x16x64_bf16 v[152:155], a[64:67], v[204:211], v19 abid:1
    v_smfmac_f32_16x16x64_bf16 v[152:155], a[100:103], v[212:219], v23 abid:1
    v_smfmac_f32_16x16x64_bf16 v[128:131], a[4:7], v[196:203], v12 abid:1
    v_smfmac_f32_16x16x64_bf16 v[128:131], a[40:43], v[204:211], v16 abid:1
    v_smfmac_f32_16x16x64_bf16 v[128:131], a[76:79], v[212:219], v20 abid:1
    s_waitcnt lgkmcnt(2)
    v_xad_u32 v236, v236, v3, v4
    v_smfmac_f32_16x16x64_bf16 v[128:131], v[240:243], v[244:251], v10
    v_xad_u32 v237, v237, v3, v4
    v_smfmac_f32_16x16x64_bf16 v[164:167], v[240:243], v[244:251], v10 abid:1
    ds_read2st64_b32 v[244:245], v236 offset0:0 offset1:72
    ds_read_b128 v[240:243], v8 offset:2048
    v_xad_u32 v238, v238, v3, v4
    v_smfmac_f32_16x16x64_bf16 v[124:127], a[108:111], v[220:227], v24
    ds_read2st64_b32 v[246:247], v237 offset0:0 offset1:72
    v_xad_u32 v239, v239, v3, v4
    v_smfmac_f32_16x16x64_bf16 v[124:127], a[144:147], v[228:235], v28
    ds_read2st64_b32 v[248:249], v238 offset0:0 offset1:72
    ds_read_b64 v[216:217], v9 offset:10056
    v_cvt_pk_bf16_f32 v176, v176, v177
    v_smfmac_f32_16x16x64_bf16 v[128:131], a[112:115], v[220:227], v24 abid:1
    ds_read2st64_b32 v[250:251], v239 offset0:0 offset1:72
    ds_read_b128 v[236:239], v9 offset:9216
    v_cvt_pk_bf16_f32 v177, v178, v179
    v_smfmac_f32_16x16x64_bf16 v[128:131], a[148:151], v[228:235], v28 abid:1
    v_cvt_pk_bf16_f32 v178, v180, v181
    v_smfmac_f32_16x16x64_bf16 v[140:143], a[124:127], v[220:227], v26
    v_cvt_pk_bf16_f32 v179, v182, v183
    v_smfmac_f32_16x16x64_bf16 v[140:143], a[160:163], v[228:235], v30
    v_cvt_pk_bf16_f32 v184, v184, v185
    v_smfmac_f32_16x16x64_bf16 v[136:139], a[120:123], v[220:227], v25 abid:1
    v_cvt_pk_bf16_f32 v185, v186, v187
    v_smfmac_f32_16x16x64_bf16 v[136:139], a[156:159], v[228:235], v29 abid:1
    ds_read_b128 v[196:199], v1 offset:5120
    v_cvt_pk_bf16_f32 v186, v188, v189
    v_smfmac_f32_16x16x64_bf16 v[132:135], a[116:119], v[220:227], v25
    ds_read_b128 v[200:203], v2 offset:5120
    v_cvt_pk_bf16_f32 v187, v190, v191
    v_smfmac_f32_16x16x64_bf16 v[132:135], a[152:155], v[228:235], v29
    ds_read_b128 v[188:191], v9 offset:10688
    s_waitcnt lgkmcnt(3)
    v_xad_u32 v236, v236, v3, v4
    v_smfmac_f32_16x16x64_bf16 v[132:135], v[240:243], v[244:251], v10
    ds_read_b128 v[204:207], v1 offset:6144
    v_xad_u32 v237, v237, v3, v4
    v_smfmac_f32_16x16x64_bf16 v[168:171], v[240:243], v[244:251], v10 abid:1
    ds_read2st64_b32 v[244:245], v236 offset0:0 offset1:72
    ds_read_b128 v[240:243], v8 offset:0
    v_xad_u32 v238, v238, v3, v4
    v_smfmac_f32_16x16x64_bf16 v[144:147], a[128:131], v[220:227], v26 abid:1
    ds_read2st64_b32 v[246:247], v237 offset0:0 offset1:72
    v_xad_u32 v239, v239, v3, v4
    v_smfmac_f32_16x16x64_bf16 v[144:147], a[164:167], v[228:235], v30 abid:1
    ds_read2st64_b32 v[248:249], v238 offset0:0 offset1:72
    ds_read_b128 v[208:211], v2 offset:6144
    v_cndmask_b32_dpp v180, v176, v184, vcc row_ror:8 row_mask:0xf bank_mask:0xf
    v_smfmac_f32_16x16x64_bf16 v[148:151], a[132:135], v[220:227], v27
    ds_read2st64_b32 v[250:251], v239 offset0:0 offset1:72
    ds_read_b128 v[236:239], v9 offset:9728
    v_cndmask_b32_dpp v181, v177, v185, vcc row_ror:8 row_mask:0xf bank_mask:0xf
    v_smfmac_f32_16x16x64_bf16 v[148:151], a[168:171], v[228:235], v31
    v_xad_u32 v212, v216, v3, v4
    v_smfmac_f32_16x16x64_bf16 v[152:155], a[136:139], v[220:227], v27 abid:1
    ds_read2st64_b32 v[212:213], v212 offset0:0 offset1:72
    v_xad_u32 v214, v217, v3, v4
    v_smfmac_f32_16x16x64_bf16 v[152:155], a[172:175], v[228:235], v31 abid:1
    ds_read2st64_b32 v[214:215], v214 offset0:0 offset1:72
    v_cndmask_b32_dpp v182, v178, v186, vcc row_ror:8 row_mask:0xf bank_mask:0xf
    v_smfmac_f32_16x16x64_bf16 v[156:159], a[140:143], v[220:227], v49 abid:1
    v_cndmask_b32_dpp v183, v179, v187, vcc row_ror:8 row_mask:0xf bank_mask:0xf
    v_smfmac_f32_16x16x64_bf16 v[156:159], a[176:179], v[228:235], v50
    buffer_store_dwordx4 v[180:183], v6, s[12:15], s58 offen offset:128 sc1
    s_waitcnt lgkmcnt(11)
    v_mov_b32_dpp v176, v184 row_ror:8 row_mask:0xf bank_mask:0xc
    v_smfmac_f32_16x16x64_bf16 v[128:131], a[184:187], v[196:203], v32 abid:1
    s_waitcnt lgkmcnt(4)
    v_mov_b32_dpp v177, v185 row_ror:8 row_mask:0xf bank_mask:0xc
    v_smfmac_f32_16x16x64_bf16 v[128:131], a[220:223], v[204:211], v36 abid:1
    v_mov_b32_dpp v178, v186 row_ror:8 row_mask:0xf bank_mask:0xc
    v_smfmac_f32_16x16x64_bf16 v[124:127], a[180:183], v[196:203], v32
    ds_read_b128 v[220:223], v1 offset:7168
    v_mov_b32_dpp v179, v187 row_ror:8 row_mask:0xf bank_mask:0xc
    v_smfmac_f32_16x16x64_bf16 v[124:127], a[216:219], v[204:211], v36
    buffer_store_dwordx4 v[176:179], v6, s[12:15], s23 offen offset:128 sc1
    s_waitcnt lgkmcnt(3)
    v_xad_u32 v236, v236, v3, v4
    v_smfmac_f32_16x16x64_bf16 v[124:127], v[240:243], v[244:251], v10
    ds_read_b128 v[224:227], v2 offset:7168
    ds_read_b128 v[180:183], v9 offset:10560
    v_xad_u32 v237, v237, v3, v4
    v_smfmac_f32_16x16x64_bf16 v[160:163], v[240:243], v[244:251], v10 abid:1
    ds_read2st64_b32 v[244:245], v236 offset0:0 offset1:72
    ds_read_b128 v[240:243], v8 offset:8192
    v_xad_u32 v238, v238, v3, v4
    v_smfmac_f32_16x16x64_bf16 v[132:135], a[188:191], v[196:203], v33
    ds_read2st64_b32 v[246:247], v237 offset0:0 offset1:72
    ds_read_b128 v[184:187], v9 offset:10624
    v_xad_u32 v239, v239, v3, v4
    v_smfmac_f32_16x16x64_bf16 v[132:135], a[224:227], v[204:211], v37
    ds_read2st64_b32 v[248:249], v238 offset0:0 offset1:72
    ds_read_b128 v[176:179], v9 offset:10496
    v_smfmac_f32_16x16x64_bf16 v[136:139], a[192:195], v[196:203], v33 abid:1
    ds_read2st64_b32 v[250:251], v239 offset0:0 offset1:72
    ds_read_b128 v[236:239], v9 offset:9664
    v_smfmac_f32_16x16x64_bf16 v[136:139], a[228:231], v[204:211], v37 abid:1
    v_smfmac_f32_16x16x64_bf16 v[140:143], a[196:199], v[196:203], v34
    v_smfmac_f32_16x16x64_bf16 v[140:143], a[232:235], v[204:211], v38
    ds_read_b128 v[228:231], v1 offset:8192
    v_smfmac_f32_16x16x64_bf16 v[144:147], a[200:203], v[196:203], v34 abid:1
    ds_read_b128 v[232:235], v2 offset:8192
    v_smfmac_f32_16x16x64_bf16 v[144:147], a[236:239], v[204:211], v38 abid:1
    s_waitcnt lgkmcnt(4)
    s_cmp_lt_i32 s81, 0
    s_cbranch_scc1 M_ovrF
    s_swappc_b64 s[78:79], s[72:73]
M_ovrF:
    v_smfmac_f32_16x16x64_bf16 v[156:159], a[212:215], v[196:203], v50 abid:1
    v_smfmac_f32_16x16x64_bf16 v[156:159], a[248:251], v[204:211], v51
    s_waitcnt lgkmcnt(2)
    v_xad_u32 v236, v236, v3, v4
    v_smfmac_f32_16x16x64_bf16 v[156:159], v[240:243], v[244:251], v10
    v_xad_u32 v237, v237, v3, v4
    v_smfmac_f32_16x16x64_bf16 v[192:195], v[240:243], v[244:251], v10 abid:1
    ds_read2st64_b32 v[244:245], v236 offset0:0 offset1:72
    ds_read_b128 v[240:243], v8 offset:7168
    v_xad_u32 v238, v238, v3, v4
    v_smfmac_f32_16x16x64_bf16 v[152:155], a[208:211], v[196:203], v35 abid:1
    ds_read2st64_b32 v[246:247], v237 offset0:0 offset1:72
    v_xad_u32 v239, v239, v3, v4
    v_smfmac_f32_16x16x64_bf16 v[152:155], a[244:247], v[204:211], v39 abid:1
    ds_read2st64_b32 v[248:249], v238 offset0:0 offset1:72
    v_smfmac_f32_16x16x64_bf16 v[148:151], a[204:207], v[196:203], v35
    ds_read2st64_b32 v[250:251], v239 offset0:0 offset1:72
    ds_read_b128 v[236:239], v9 offset:9536
    v_smfmac_f32_16x16x64_bf16 v[148:151], a[240:243], v[204:211], v39
    v_smfmac_f32_16x16x64_bf16 v[124:127], a[252:255], v[220:227], v40
    s_waitcnt lgkmcnt(6)
    v_smfmac_f32_16x16x64_bf16 v[124:127], v[88:91], v[228:235], v44
    v_smfmac_f32_16x16x64_bf16 v[128:131], v[56:59], v[220:227], v40 abid:1
    v_smfmac_f32_16x16x64_bf16 v[128:131], v[92:95], v[228:235], v44 abid:1
    s_cmp_lt_u32 s20, 2
    s_cselect_b32 s66, s23, s24
    s_add_u32 s66, s66, s95
    v_smfmac_f32_16x16x64_bf16 v[132:135], v[60:63], v[220:227], v41
    ds_read_b128 v[196:199], v1 offset:18432
    s_add_u32 s23, s24, 18432
    s_add_u32 s58, s24, 27648
    v_smfmac_f32_16x16x64_bf16 v[132:135], v[96:99], v[228:235], v45
    ds_read_b128 v[200:203], v2 offset:18432
    s_add_u32 s67, s23, s95
    v_smfmac_f32_16x16x64_bf16 v[152:155], v[80:83], v[220:227], v43 abid:1
    ds_read_b128 v[204:207], v1 offset:19456
    v_smfmac_f32_16x16x64_bf16 v[152:155], v[116:119], v[228:235], v47 abid:1
    s_waitcnt lgkmcnt(3)
    v_xad_u32 v236, v236, v3, v4
    v_smfmac_f32_16x16x64_bf16 v[152:155], v[240:243], v[244:251], v10
    ds_read_b128 v[208:211], v2 offset:19456
    v_xad_u32 v237, v237, v3, v4
    v_smfmac_f32_16x16x64_bf16 v[188:191], v[240:243], v[244:251], v10 abid:1
    s_cmp_gt_u32 s46, s80
    s_cbranch_scc1 M_slow
M_slowrF:
    v_xad_u32 v238, v238, v3, v4
    v_smfmac_f32_16x16x64_bf16 v[140:143], v[68:71], v[220:227], v42
    ds_read2st64_b32 v[244:245], v236 offset0:0 offset1:72
    ds_read_b128 v[240:243], v8 offset:5120
    v_xad_u32 v239, v239, v3, v4
    v_smfmac_f32_16x16x64_bf16 v[140:143], v[104:107], v[228:235], v46
    ds_read2st64_b32 v[246:247], v237 offset0:0 offset1:72
    v_smfmac_f32_16x16x64_bf16 v[156:159], v[84:87], v[220:227], v51 abid:1
    ds_read2st64_b32 v[248:249], v238 offset0:0 offset1:72
    ds_read_b128 v[212:215], v1 offset:20480
    v_smfmac_f32_16x16x64_bf16 v[156:159], v[120:123], v[228:235], v52
    ds_read2st64_b32 v[250:251], v239 offset0:0 offset1:72
    ds_read_b128 v[236:239], v9 offset:9600
    v_smfmac_f32_16x16x64_bf16 v[148:151], v[76:79], v[220:227], v43
    ds_read_b128 v[216:219], v2 offset:20480
    v_smfmac_f32_16x16x64_bf16 v[148:151], v[112:115], v[228:235], v47
    v_smfmac_f32_16x16x64_bf16 v[136:139], v[64:67], v[220:227], v41 abid:1
    v_smfmac_f32_16x16x64_bf16 v[136:139], v[100:103], v[228:235], v45 abid:1
    v_smfmac_f32_16x16x64_bf16 v[144:147], v[72:75], v[220:227], v42 abid:1
    v_smfmac_f32_16x16x64_bf16 v[144:147], v[108:111], v[228:235], v46 abid:1
    ds_read_b128 v[220:223], v1 offset:21504
    s_waitcnt lgkmcnt(2)
    v_xad_u32 v236, v236, v3, v4
    v_smfmac_f32_16x16x64_bf16 v[144:147], v[240:243], v[244:251], v10
    ds_read_b128 v[224:227], v2 offset:21504
    v_xad_u32 v237, v237, v3, v4
    v_smfmac_f32_16x16x64_bf16 v[180:183], v[240:243], v[244:251], v10 abid:1
    ds_read2st64_b32 v[244:245], v236 offset0:0 offset1:72
    ds_read_b128 v[240:243], v8 offset:6144
    v_xad_u32 v238, v238, v3, v4
    v_smfmac_f32_16x16x64_bf16 v[192:195], a[32:35], v[196:203], v48
    ds_read2st64_b32 v[246:247], v237 offset0:0 offset1:72
    ds_read_b128 v[228:231], v1 offset:22528
    v_xad_u32 v239, v239, v3, v4
    v_smfmac_f32_16x16x64_bf16 v[192:195], a[68:71], v[204:211], v48 abid:1
    ds_read2st64_b32 v[248:249], v238 offset0:0 offset1:72
    ds_read_b128 v[232:235], v2 offset:22528
    s_waitcnt lgkmcnt(8)
    v_cvt_pk_bf16_f32 v124, v124, v125
    v_smfmac_f32_16x16x64_bf16 v[192:195], a[104:107], v[212:219], v49
    ds_read2st64_b32 v[250:251], v239 offset0:0 offset1:72
    ds_read_b128 v[236:239], v9 offset:9472
    v_cvt_pk_bf16_f32 v125, v126, v127
    v_smfmac_f32_16x16x64_bf16 v[160:163], a[0:3], v[196:203], v12
    v_cvt_pk_bf16_f32 v126, v128, v129
    v_smfmac_f32_16x16x64_bf16 v[160:163], a[36:39], v[204:211], v16
    v_cvt_pk_bf16_f32 v127, v130, v131
    v_smfmac_f32_16x16x64_bf16 v[160:163], a[72:75], v[212:219], v20
    v_cvt_pk_bf16_f32 v156, v156, v157
    v_smfmac_f32_16x16x64_bf16 v[164:167], a[4:7], v[196:203], v12 abid:1
    v_cvt_pk_bf16_f32 v157, v158, v159
    v_smfmac_f32_16x16x64_bf16 v[164:167], a[40:43], v[204:211], v16 abid:1
    ds_write_b64 v53, v[156:157] offset:25728
    v_cvt_pk_bf16_f32 v132, v132, v133
    v_smfmac_f32_16x16x64_bf16 v[164:167], a[76:79], v[212:219], v20 abid:1
    v_cvt_pk_bf16_f32 v133, v134, v135
    v_smfmac_f32_16x16x64_bf16 v[168:171], a[8:11], v[196:203], v13
    v_cvt_pk_bf16_f32 v134, v136, v137
    v_smfmac_f32_16x16x64_bf16 v[168:171], a[44:47], v[204:211], v17
    v_cvt_pk_bf16_f32 v135, v138, v139
    v_smfmac_f32_16x16x64_bf16 v[168:171], a[80:83], v[212:219], v21
    s_waitcnt lgkmcnt(1)
    v_xad_u32 v236, v236, v3, v4
    v_smfmac_f32_16x16x64_bf16 v[184:187], v[240:243], v[244:251], v10 abid:1
    v_xad_u32 v237, v237, v3, v4
    v_smfmac_f32_16x16x64_bf16 v[148:151], v[240:243], v[244:251], v10
    ds_read2st64_b32 v[244:245], v236 offset0:0 offset1:72
    ds_read_b128 v[240:243], v8 offset:4096
    v_xad_u32 v238, v238, v3, v4
    v_smfmac_f32_16x16x64_bf16 v[172:175], a[12:15], v[196:203], v13 abid:1
    ds_read2st64_b32 v[246:247], v237 offset0:0 offset1:72
    v_xad_u32 v239, v239, v3, v4
    v_smfmac_f32_16x16x64_bf16 v[172:175], a[48:51], v[204:211], v17 abid:1
    ds_read2st64_b32 v[248:249], v238 offset0:0 offset1:72
    v_cndmask_b32_dpp v128, v124, v132, vcc row_ror:8 row_mask:0xf bank_mask:0xf
    v_smfmac_f32_16x16x64_bf16 v[172:175], a[84:87], v[212:219], v21 abid:1
    ds_read2st64_b32 v[250:251], v239 offset0:0 offset1:72
    ds_read_b128 v[196:199], v1 offset:23552
    v_cndmask_b32_dpp v129, v125, v133, vcc row_ror:8 row_mask:0xf bank_mask:0xf
    v_smfmac_f32_16x16x64_bf16 v[192:195], a[140:143], v[220:227], v49 abid:1
    ds_read_b128 v[200:203], v2 offset:23552
    v_cndmask_b32_dpp v130, v126, v134, vcc row_ror:8 row_mask:0xf bank_mask:0xf
    v_smfmac_f32_16x16x64_bf16 v[192:195], a[176:179], v[228:235], v50
    ds_read_b128 v[204:207], v1 offset:24576
    v_cndmask_b32_dpp v131, v127, v135, vcc row_ror:8 row_mask:0xf bank_mask:0xf
    v_smfmac_f32_16x16x64_bf16 v[160:163], a[108:111], v[220:227], v24
    ds_read_b128 v[208:211], v2 offset:24576
    buffer_store_dwordx4 v[128:131], v6, s[12:15], s59 offen offset:0 sc1
    v_mov_b32_dpp v124, v132 row_ror:8 row_mask:0xf bank_mask:0xc
    v_smfmac_f32_16x16x64_bf16 v[160:163], a[144:147], v[228:235], v28
    s_waitcnt lgkmcnt(9)
    s_barrier
    ds_read_b128 v[236:239], v8 offset:10816
    v_mov_b32_dpp v125, v133 row_ror:8 row_mask:0xf bank_mask:0xc
    v_smfmac_f32_16x16x64_bf16 v[164:167], a[112:115], v[220:227], v24 abid:1
    ds_read_b128 v[212:215], v1 offset:20480
    v_mov_b32_dpp v126, v134 row_ror:8 row_mask:0xf bank_mask:0xc
    v_smfmac_f32_16x16x64_bf16 v[164:167], a[148:151], v[228:235], v28 abid:1
    ds_read_b128 v[216:219], v2 offset:20480
    v_mov_b32_dpp v127, v135 row_ror:8 row_mask:0xf bank_mask:0xc
    v_smfmac_f32_16x16x64_bf16 v[168:171], a[116:119], v[220:227], v25
    buffer_store_dwordx4 v[124:127], v6, s[12:15], s24 offen offset:0 sc1
    v_smfmac_f32_16x16x64_bf16 v[168:171], a[152:155], v[228:235], v29
    s_waitcnt lgkmcnt(7)
    v_smfmac_f32_16x16x64_bf16 v[176:179], v[240:243], v[244:251], v10 abid:1
    v_smfmac_f32_16x16x64_bf16 v[140:143], v[240:243], v[244:251], v10
    s_waitcnt lgkmcnt(2)
    buffer_store_dwordx4 v[236:239], v7, s[12:15], s66 offen sc1
    v_smfmac_f32_16x16x64_bf16 v[172:175], a[120:123], v[220:227], v25 abid:1
    v_smfmac_f32_16x16x64_bf16 v[172:175], a[156:159], v[228:235], v29 abid:1
    ds_read_b128 v[220:223], v1 offset:25600
    v_smfmac_f32_16x16x64_bf16 v[192:195], a[212:215], v[196:203], v50 abid:1
    ds_read_b128 v[224:227], v2 offset:25600
    s_nop 0
    v_cvt_pk_bf16_f32 v140, v140, v141
    v_smfmac_f32_16x16x64_bf16 v[192:195], a[248:251], v[204:211], v51
    ds_read_b128 v[228:231], v1 offset:26624
    v_cvt_pk_bf16_f32 v141, v142, v143
    v_smfmac_f32_16x16x64_bf16 v[160:163], a[180:183], v[196:203], v32
    ds_read_b128 v[232:235], v2 offset:26624
    v_cvt_pk_bf16_f32 v142, v144, v145
    v_smfmac_f32_16x16x64_bf16 v[160:163], a[216:219], v[204:211], v36
    v_cvt_pk_bf16_f32 v143, v146, v147
    v_smfmac_f32_16x16x64_bf16 v[164:167], a[184:187], v[196:203], v32 abid:1
    v_cvt_pk_bf16_f32 v148, v148, v149
    v_smfmac_f32_16x16x64_bf16 v[164:167], a[220:223], v[204:211], v36 abid:1
    v_cvt_pk_bf16_f32 v149, v150, v151
    v_smfmac_f32_16x16x64_bf16 v[168:171], a[188:191], v[196:203], v33
    v_cvt_pk_bf16_f32 v150, v152, v153
    v_smfmac_f32_16x16x64_bf16 v[168:171], a[224:227], v[204:211], v37
    v_cvt_pk_bf16_f32 v151, v154, v155
    v_smfmac_f32_16x16x64_bf16 v[172:175], a[192:195], v[196:203], v33 abid:1
    v_cndmask_b32_dpp v144, v140, v148, vcc row_ror:8 row_mask:0xf bank_mask:0xf
    v_smfmac_f32_16x16x64_bf16 v[172:175], a[228:231], v[204:211], v37 abid:1
    ds_read_b128 v[196:199], v1 offset:18432
    s_waitcnt lgkmcnt(3)
    v_cndmask_b32_dpp v145, v141, v149, vcc row_ror:8 row_mask:0xf bank_mask:0xf
    v_smfmac_f32_16x16x64_bf16 v[192:195], v[84:87], v[220:227], v51 abid:1
    ds_read_b128 v[200:203], v2 offset:18432
    s_waitcnt lgkmcnt(2)
    v_cndmask_b32_dpp v146, v142, v150, vcc row_ror:8 row_mask:0xf bank_mask:0xf
    v_smfmac_f32_16x16x64_bf16 v[192:195], v[120:123], v[228:235], v52
    ds_read_b128 v[204:207], v1 offset:19456
    v_cndmask_b32_dpp v147, v143, v151, vcc row_ror:8 row_mask:0xf bank_mask:0xf
    v_smfmac_f32_16x16x64_bf16 v[160:163], a[252:255], v[220:227], v40
    ds_read_b128 v[208:211], v2 offset:19456
    buffer_store_dwordx4 v[144:147], v6, s[12:15], s59 offen offset:128 sc1
    v_mov_b32_dpp v140, v148 row_ror:8 row_mask:0xf bank_mask:0xc
    v_smfmac_f32_16x16x64_bf16 v[160:163], v[88:91], v[228:235], v44
    v_mov_b32_dpp v141, v149 row_ror:8 row_mask:0xf bank_mask:0xc
    v_smfmac_f32_16x16x64_bf16 v[164:167], v[56:59], v[220:227], v40 abid:1
    v_mov_b32_dpp v142, v150 row_ror:8 row_mask:0xf bank_mask:0xc
    v_smfmac_f32_16x16x64_bf16 v[164:167], v[92:95], v[228:235], v44 abid:1
    v_mov_b32_dpp v143, v151 row_ror:8 row_mask:0xf bank_mask:0xc
    v_smfmac_f32_16x16x64_bf16 v[168:171], v[60:63], v[220:227], v41
    buffer_store_dwordx4 v[140:143], v6, s[12:15], s24 offen offset:128 sc1
    v_cvt_pk_bf16_f32 v192, v192, v193
    v_smfmac_f32_16x16x64_bf16 v[168:171], v[96:99], v[228:235], v45
    v_cvt_pk_bf16_f32 v193, v194, v195
    v_smfmac_f32_16x16x64_bf16 v[172:175], v[64:67], v[220:227], v41 abid:1
    ds_write_b64 v53, v[192:193] offset:1024
    v_smfmac_f32_16x16x64_bf16 v[172:175], v[100:103], v[228:235], v45 abid:1
    ds_read_b128 v[220:223], v1 offset:21504
    s_waitcnt lgkmcnt(4)
    v_smfmac_f32_16x16x64_bf16 v[176:179], a[16:19], v[196:203], v14
    ds_read_b128 v[224:227], v2 offset:21504
    s_waitcnt lgkmcnt(3)
    v_smfmac_f32_16x16x64_bf16 v[176:179], a[52:55], v[204:211], v18
    ds_read_b128 v[228:231], v1 offset:22528
    v_smfmac_f32_16x16x64_bf16 v[176:179], a[88:91], v[212:219], v22
    ds_read_b128 v[232:235], v2 offset:22528
    s_waitcnt lgkmcnt(4)
    s_barrier
    ds_read_b128 v[236:239], v8 offset:11840
    v_smfmac_f32_16x16x64_bf16 v[180:183], a[20:23], v[196:203], v14 abid:1
    v_cvt_pk_bf16_f32 v160, v160, v161
    v_smfmac_f32_16x16x64_bf16 v[180:183], a[56:59], v[204:211], v18 abid:1
    v_cvt_pk_bf16_f32 v161, v162, v163
    v_smfmac_f32_16x16x64_bf16 v[180:183], a[92:95], v[212:219], v22 abid:1
    v_cvt_pk_bf16_f32 v162, v164, v165
    v_smfmac_f32_16x16x64_bf16 v[184:187], a[24:27], v[196:203], v15
    v_cvt_pk_bf16_f32 v163, v166, v167
    v_smfmac_f32_16x16x64_bf16 v[184:187], a[60:63], v[204:211], v19
    v_cvt_pk_bf16_f32 v168, v168, v169
    v_smfmac_f32_16x16x64_bf16 v[184:187], a[96:99], v[212:219], v23
    s_cmp_lt_u32 s20, 2
    s_waitcnt lgkmcnt(0)
    s_cbranch_scc0 M_fx
    buffer_store_dwordx4 v[236:239], v7, s[12:15], s67 offen sc1
M_fx:
    v_smfmac_f32_16x16x64_bf16 v[188:191], a[28:31], v[196:203], v15 abid:1
    v_cvt_pk_bf16_f32 v169, v170, v171
    v_smfmac_f32_16x16x64_bf16 v[188:191], a[64:67], v[204:211], v19 abid:1
    v_cvt_pk_bf16_f32 v170, v172, v173
    v_smfmac_f32_16x16x64_bf16 v[188:191], a[100:103], v[212:219], v23 abid:1
    ds_read_b128 v[196:199], v1 offset:23552
    v_cvt_pk_bf16_f32 v171, v174, v175
    v_smfmac_f32_16x16x64_bf16 v[176:179], a[124:127], v[220:227], v26
    ds_read_b128 v[200:203], v2 offset:23552
    v_cndmask_b32_dpp v164, v160, v168, vcc row_ror:8 row_mask:0xf bank_mask:0xf
    v_smfmac_f32_16x16x64_bf16 v[176:179], a[160:163], v[228:235], v30
    ds_read_b128 v[204:207], v1 offset:24576
    v_cndmask_b32_dpp v165, v161, v169, vcc row_ror:8 row_mask:0xf bank_mask:0xf
    v_smfmac_f32_16x16x64_bf16 v[180:183], a[128:131], v[220:227], v26 abid:1
    ds_read_b128 v[208:211], v2 offset:24576
    v_cndmask_b32_dpp v166, v162, v170, vcc row_ror:8 row_mask:0xf bank_mask:0xf
    v_smfmac_f32_16x16x64_bf16 v[180:183], a[164:167], v[228:235], v30 abid:1
    v_cndmask_b32_dpp v167, v163, v171, vcc row_ror:8 row_mask:0xf bank_mask:0xf
    v_smfmac_f32_16x16x64_bf16 v[184:187], a[132:135], v[220:227], v27
    buffer_store_dwordx4 v[164:167], v6, s[12:15], s58 offen offset:0 sc1
    v_mov_b32_dpp v160, v168 row_ror:8 row_mask:0xf bank_mask:0xc
    v_smfmac_f32_16x16x64_bf16 v[184:187], a[168:171], v[228:235], v31
    v_mov_b32_dpp v161, v169 row_ror:8 row_mask:0xf bank_mask:0xc
    v_smfmac_f32_16x16x64_bf16 v[188:191], a[136:139], v[220:227], v27 abid:1
    v_mov_b32_dpp v162, v170 row_ror:8 row_mask:0xf bank_mask:0xc
    v_smfmac_f32_16x16x64_bf16 v[188:191], a[172:175], v[228:235], v31 abid:1
    ds_read_b128 v[220:223], v1 offset:25600
    s_waitcnt lgkmcnt(3)
    v_mov_b32_dpp v163, v171 row_ror:8 row_mask:0xf bank_mask:0xc
    v_smfmac_f32_16x16x64_bf16 v[176:179], a[196:199], v[196:203], v34
    ds_read_b128 v[224:227], v2 offset:25600
    buffer_store_dwordx4 v[160:163], v6, s[12:15], s23 offen offset:0 sc1
    s_waitcnt lgkmcnt(2)
    v_smfmac_f32_16x16x64_bf16 v[176:179], a[232:235], v[204:211], v38
    ds_read_b128 v[228:231], v1 offset:26624
    v_smfmac_f32_16x16x64_bf16 v[180:183], a[200:203], v[196:203], v34 abid:1
    ds_read_b128 v[232:235], v2 offset:26624
    v_smfmac_f32_16x16x64_bf16 v[180:183], a[236:239], v[204:211], v38 abid:1
    v_smfmac_f32_16x16x64_bf16 v[184:187], a[204:207], v[196:203], v35
    v_smfmac_f32_16x16x64_bf16 v[184:187], a[240:243], v[204:211], v39
    v_smfmac_f32_16x16x64_bf16 v[188:191], a[208:211], v[196:203], v35 abid:1
    v_smfmac_f32_16x16x64_bf16 v[188:191], a[244:247], v[204:211], v39 abid:1
    s_waitcnt lgkmcnt(2)
    v_smfmac_f32_16x16x64_bf16 v[176:179], v[68:71], v[220:227], v42
    s_waitcnt lgkmcnt(0)
    v_smfmac_f32_16x16x64_bf16 v[176:179], v[104:107], v[228:235], v46
    v_smfmac_f32_16x16x64_bf16 v[180:183], v[72:75], v[220:227], v42 abid:1
    v_smfmac_f32_16x16x64_bf16 v[180:183], v[108:111], v[228:235], v46 abid:1
    v_smfmac_f32_16x16x64_bf16 v[184:187], v[76:79], v[220:227], v43
    v_smfmac_f32_16x16x64_bf16 v[184:187], v[112:115], v[228:235], v47
    v_smfmac_f32_16x16x64_bf16 v[188:191], v[80:83], v[220:227], v43 abid:1
    v_smfmac_f32_16x16x64_bf16 v[188:191], v[116:119], v[228:235], v47 abid:1
    s_nop 1
    v_cvt_pk_bf16_f32 v176, v176, v177
    v_cvt_pk_bf16_f32 v177, v178, v179
    v_cvt_pk_bf16_f32 v178, v180, v181
    v_cvt_pk_bf16_f32 v179, v182, v183
    v_cvt_pk_bf16_f32 v184, v184, v185
    v_cvt_pk_bf16_f32 v185, v186, v187
    v_cvt_pk_bf16_f32 v186, v188, v189
    v_cvt_pk_bf16_f32 v187, v190, v191
    v_cndmask_b32_dpp v180, v176, v184, vcc row_ror:8 row_mask:0xf bank_mask:0xf
    v_cndmask_b32_dpp v181, v177, v185, vcc row_ror:8 row_mask:0xf bank_mask:0xf
    v_cndmask_b32_dpp v182, v178, v186, vcc row_ror:8 row_mask:0xf bank_mask:0xf
    v_cndmask_b32_dpp v183, v179, v187, vcc row_ror:8 row_mask:0xf bank_mask:0xf
    buffer_store_dwordx4 v[180:183], v6, s[12:15], s58 offen offset:128 sc1
    v_mov_b32_dpp v176, v184 row_ror:8 row_mask:0xf bank_mask:0xc
    v_mov_b32_dpp v177, v185 row_ror:8 row_mask:0xf bank_mask:0xc
    v_mov_b32_dpp v178, v186 row_ror:8 row_mask:0xf bank_mask:0xc
    v_mov_b32_dpp v179, v187 row_ror:8 row_mask:0xf bank_mask:0xc
    buffer_store_dwordx4 v[176:179], v6, s[12:15], s23 offen offset:128 sc1
M_done:
M_end:
    s_endpgm
M_pf_spin:
    s_sleep 4
    v_mov_b32 v0, 0
    s_mov_b64 exec, 1
    buffer_atomic_add v0, off, s[16:19], s96 sc0 sc1
    s_mov_b64 exec, -1
    s_add_u32 s31, s31, 1
    s_waitcnt vmcnt(0)
    v_readfirstlane_b32 s30, v0
    s_nop 0
    s_sub_u32 s30, s30, s100
    s_cmp_eq_u32 s30, 27
    s_cbranch_scc1 M_pf_ok
    s_cmp_lt_u32 s31, 6
    s_cbranch_scc1 M_pf_spin
    s_cmp_eq_u32 s98, 0
    s_cbranch_scc1 M_pf_spin2
    s_mov_b32 s98, 0
    v_mov_b32 v250, 1
    s_mov_b64 exec, 1
    buffer_atomic_add v250, off, s[68:71], 0 offset:0 sc1
    s_mov_b64 exec, -1
    s_nop 3
M_pf_spin2:
    buffer_load_dword v0, off, s[68:71], 0 offset:0 sc1
    s_cmp_ge_u32 s31, 131072
    s_cbranch_scc1 M_end
    s_waitcnt vmcnt(0)
    v_readfirstlane_b32 s30, v0
    s_nop 0
    s_cmp_eq_u32 s30, 81
    s_cbranch_scc0 M_pf_spin
    s_branch M_pf_ok
M_r3:
    v_bfe_u32 v110, v96, 24, 4
    v_lshlrev_b32 v111, 1, v96
    v_lshl_add_u32 v110, v110, 2, s49
    v_and_b32 v111, 16, v111
    v_and_or_b32 v110, v96, 2.0, v110
    v_lshlrev_b32 v111, v111, 1
    ds_add_rtn_u32 v100, v110, v111
    v_and_b32 v110, 8, v96
    v_lshrrev_b32 v113, 14, v96
    v_cmp_ne_u32 s[44:45], 0, v110
    v_and_b32 v116, 0x3cf0, v113
    s_waitcnt lgkmcnt(0)
    v_lshrrev_b32 v111, 16, v100
    v_and_b32 v112, 0xffff, v100
    v_sub_u32 v110, 15, v111
    v_and_b32 v100, 2.0, v96
    v_add3_u32 v100, v112, v111, v100
    v_cndmask_b32 v110, v112, v110, s[44:45]
    v_cmp_gt_u32 s[44:45], 16, v100
    v_cmp_gt_u32 s[36:37], 2.0, v100
    v_lshlrev_b32 v110, 2, v110
    v_lshrrev_b64 v[112:113], v110, s[50:51]
    s_andn2_b64 s[36:37], s[36:37], s[44:45]
    v_lshrrev_b64 v[114:115], v110, s[52:53]
    v_bfe_u32 v110, v96, 24, 4
    v_mbcnt_lo_u32_b32 v111, s36, 0
    v_and_b32 v112, 15, v112
    v_mbcnt_hi_u32_b32 v111, s37, v111
    v_and_b32 v114, 15, v114
    v_lshl_add_u32 v111, v111, 3, s40
    v_lshl_add_u32 v112, v110, 4, v112
    v_min_u32 v111, s41, v111
    v_mul_u32_u24 v114, 68, v114
    v_cndmask_b32 v111, v118, v111, s[36:37]
    ds_write_b64 v111, v[96:97]
    s_bcnt1_i32_b64 s30, s[36:37]
    s_lshl3_add_u32 s40, s30, s40
    v_lshl_add_u32 v112, v112, 2, s47
    v_and_b32 v114, 0x30c, v114
    v_cndmask_b32 v112, v118, v112, s[44:45]
    v_add3_u32 v113, v116, v114, s29
    v_and_b32 v114, 0x3fff, v96
    v_cndmask_b32 v110, v118, v113, s[44:45]
    ds_write_b32 v112, v114
    ds_write_b32 v110, v97
    s_cmp_gt_u32 s38, s39
    s_cselect_b32 s32, 1, s32
    s_branch M_r3r
M_dn:
    s_mov_b32 s27, 0
    s_mov_b32 s46, 0x80000000
    v_mov_b32 v244, 0
    v_mov_b32 v245, 0
    v_mov_b32 v246, 0
    v_mov_b32 v247, 0
    ds_write_b128 v8, v[244:247] offset:0
    ds_write_b128 v8, v[244:247] offset:1024
    ds_write_b128 v8, v[244:247] offset:2048
    ds_write_b128 v8, v[244:247] offset:3072
    ds_write_b128 v8, v[244:247] offset:4096
    ds_write_b128 v8, v[244:247] offset:5120
    ds_write_b128 v8, v[244:247] offset:6144
    ds_write_b128 v8, v[244:247] offset:7168
    ds_write_b128 v8, v[244:247] offset:8192
    s_waitcnt lgkmcnt(0)
    s_branch M_dnr
M_ovc0:
    v_smfmac_f32_16x16x32_bf16 v[124:127], v[54:55], v[212:215], v10
    v_smfmac_f32_16x16x32_bf16 v[160:163], v[54:55], v[212:215], v10 abid:2
    s_setpc_b64 s[74:75]
    v_smfmac_f32_16x16x32_bf16 v[128:131], v[54:55], v[212:215], v10
    v_smfmac_f32_16x16x32_bf16 v[164:167], v[54:55], v[212:215], v10 abid:2
    s_setpc_b64 s[74:75]
    v_smfmac_f32_16x16x32_bf16 v[132:135], v[54:55], v[212:215], v10
    v_smfmac_f32_16x16x32_bf16 v[168:171], v[54:55], v[212:215], v10 abid:2
    s_setpc_b64 s[74:75]
    v_smfmac_f32_16x16x32_bf16 v[136:139], v[54:55], v[212:215], v10
    v_smfmac_f32_16x16x32_bf16 v[172:175], v[54:55], v[212:215], v10 abid:2
    s_setpc_b64 s[74:75]
    v_smfmac_f32_16x16x32_bf16 v[140:143], v[54:55], v[212:215], v10
    v_smfmac_f32_16x16x32_bf16 v[176:179], v[54:55], v[212:215], v10 abid:2
    s_setpc_b64 s[74:75]
    v_smfmac_f32_16x16x32_bf16 v[144:147], v[54:55], v[212:215], v10
    v_smfmac_f32_16x16x32_bf16 v[180:183], v[54:55], v[212:215], v10 abid:2
    s_setpc_b64 s[74:75]
    v_smfmac_f32_16x16x32_bf16 v[148:151], v[54:55], v[212:215], v10
    v_smfmac_f32_16x16x32_bf16 v[184:187], v[54:55], v[212:215], v10 abid:2
    s_setpc_b64 s[74:75]
    v_smfmac_f32_16x16x32_bf16 v[152:155], v[54:55], v[212:215], v10
    v_smfmac_f32_16x16x32_bf16 v[188:191], v[54:55], v[212:215], v10 abid:2
    s_setpc_b64 s[74:75]
    v_smfmac_f32_16x16x32_bf16 v[156:159], v[54:55], v[212:215], v10
    v_smfmac_f32_16x16x32_bf16 v[192:195], v[54:55], v[212:215], v10 abid:2
    s_setpc_b64 s[74:75]
M_ovl0:
    v_smfmac_f32_16x16x32_bf16 v[124:127], v[54:55], v[212:215], v10
    v_smfmac_f32_16x16x32_bf16 v[160:163], v[54:55], v[212:215], v10 abid:2
    s_setpc_b64 s[78:79]
    v_smfmac_f32_16x16x32_bf16 v[128:131], v[54:55], v[212:215], v10
    v_smfmac_f32_16x16x32_bf16 v[164:167], v[54:55], v[212:215], v10 abid:2
    s_setpc_b64 s[78:79]
    v_smfmac_f32_16x16x32_bf16 v[132:135], v[54:55], v[212:215], v10
    v_smfmac_f32_16x16x32_bf16 v[168:171], v[54:55], v[212:215], v10 abid:2
    s_setpc_b64 s[78:79]
    v_smfmac_f32_16x16x32_bf16 v[136:139], v[54:55], v[212:215], v10
    v_smfmac_f32_16x16x32_bf16 v[172:175], v[54:55], v[212:215], v10 abid:2
    s_setpc_b64 s[78:79]
    v_smfmac_f32_16x16x32_bf16 v[140:143], v[54:55], v[212:215], v10
    v_smfmac_f32_16x16x32_bf16 v[176:179], v[54:55], v[212:215], v10 abid:2
    s_setpc_b64 s[78:79]
    v_smfmac_f32_16x16x32_bf16 v[144:147], v[54:55], v[212:215], v10
    v_smfmac_f32_16x16x32_bf16 v[180:183], v[54:55], v[212:215], v10 abid:2
    s_setpc_b64 s[78:79]
    v_smfmac_f32_16x16x32_bf16 v[148:151], v[54:55], v[212:215], v10
    v_smfmac_f32_16x16x32_bf16 v[184:187], v[54:55], v[212:215], v10 abid:2
    s_setpc_b64 s[78:79]
    v_smfmac_f32_16x16x32_bf16 v[152:155], v[54:55], v[212:215], v10
    v_smfmac_f32_16x16x32_bf16 v[188:191], v[54:55], v[212:215], v10 abid:2
    s_setpc_b64 s[78:79]
    v_smfmac_f32_16x16x32_bf16 v[156:159], v[54:55], v[212:215], v10
    v_smfmac_f32_16x16x32_bf16 v[192:195], v[54:55], v[212:215], v10 abid:2
    s_setpc_b64 s[78:79]
M_ovc1:
    v_smfmac_f32_16x16x32_bf16 v[124:127], v[252:253], v[212:215], v10
    v_smfmac_f32_16x16x32_bf16 v[160:163], v[252:253], v[212:215], v10 abid:2
    s_setpc_b64 s[76:77]
    v_smfmac_f32_16x16x32_bf16 v[128:131], v[252:253], v[212:215], v10
    v_smfmac_f32_16x16x32_bf16 v[164:167], v[252:253], v[212:215], v10 abid:2
    s_setpc_b64 s[76:77]
    v_smfmac_f32_16x16x32_bf16 v[132:135], v[252:253], v[212:215], v10
    v_smfmac_f32_16x16x32_bf16 v[168:171], v[252:253], v[212:215], v10 abid:2
    s_setpc_b64 s[76:77]
    v_smfmac_f32_16x16x32_bf16 v[136:139], v[252:253], v[212:215], v10
    v_smfmac_f32_16x16x32_bf16 v[172:175], v[252:253], v[212:215], v10 abid:2
    s_setpc_b64 s[76:77]
    v_smfmac_f32_16x16x32_bf16 v[140:143], v[252:253], v[212:215], v10
    v_smfmac_f32_16x16x32_bf16 v[176:179], v[252:253], v[212:215], v10 abid:2
    s_setpc_b64 s[76:77]
    v_smfmac_f32_16x16x32_bf16 v[144:147], v[252:253], v[212:215], v10
    v_smfmac_f32_16x16x32_bf16 v[180:183], v[252:253], v[212:215], v10 abid:2
    s_setpc_b64 s[76:77]
    v_smfmac_f32_16x16x32_bf16 v[148:151], v[252:253], v[212:215], v10
    v_smfmac_f32_16x16x32_bf16 v[184:187], v[252:253], v[212:215], v10 abid:2
    s_setpc_b64 s[76:77]
    v_smfmac_f32_16x16x32_bf16 v[152:155], v[252:253], v[212:215], v10
    v_smfmac_f32_16x16x32_bf16 v[188:191], v[252:253], v[212:215], v10 abid:2
    s_setpc_b64 s[76:77]
    v_smfmac_f32_16x16x32_bf16 v[156:159], v[252:253], v[212:215], v10
    v_smfmac_f32_16x16x32_bf16 v[192:195], v[252:253], v[212:215], v10 abid:2
    s_setpc_b64 s[76:77]
M_ovl1:
    v_smfmac_f32_16x16x32_bf16 v[124:127], v[252:253], v[212:215], v10
    v_smfmac_f32_16x16x32_bf16 v[160:163], v[252:253], v[212:215], v10 abid:2
    s_setpc_b64 s[78:79]
    v_smfmac_f32_16x16x32_bf16 v[128:131], v[252:253], v[212:215], v10
    v_smfmac_f32_16x16x32_bf16 v[164:167], v[252:253], v[212:215], v10 abid:2
    s_setpc_b64 s[78:79]
    v_smfmac_f32_16x16x32_bf16 v[132:135], v[252:253], v[212:215], v10
    v_smfmac_f32_16x16x32_bf16 v[168:171], v[252:253], v[212:215], v10 abid:2
    s_setpc_b64 s[78:79]
    v_smfmac_f32_16x16x32_bf16 v[136:139], v[252:253], v[212:215], v10
    v_smfmac_f32_16x16x32_bf16 v[172:175], v[252:253], v[212:215], v10 abid:2
    s_setpc_b64 s[78:79]
    v_smfmac_f32_16x16x32_bf16 v[140:143], v[252:253], v[212:215], v10
    v_smfmac_f32_16x16x32_bf16 v[176:179], v[252:253], v[212:215], v10 abid:2
    s_setpc_b64 s[78:79]
    v_smfmac_f32_16x16x32_bf16 v[144:147], v[252:253], v[212:215], v10
    v_smfmac_f32_16x16x32_bf16 v[180:183], v[252:253], v[212:215], v10 abid:2
    s_setpc_b64 s[78:79]
    v_smfmac_f32_16x16x32_bf16 v[148:151], v[252:253], v[212:215], v10
    v_smfmac_f32_16x16x32_bf16 v[184:187], v[252:253], v[212:215], v10 abid:2
    s_setpc_b64 s[78:79]
    v_smfmac_f32_16x16x32_bf16 v[152:155], v[252:253], v[212:215], v10
    v_smfmac_f32_16x16x32_bf16 v[188:191], v[252:253], v[212:215], v10 abid:2
    s_setpc_b64 s[78:79]
    v_smfmac_f32_16x16x32_bf16 v[156:159], v[252:253], v[212:215], v10
    v_smfmac_f32_16x16x32_bf16 v[192:195], v[252:253], v[212:215], v10 abid:2
    s_setpc_b64 s[78:79]
M_ovl2:
    v_smfmac_f32_16x16x32_bf16 v[124:127], v[254:255], v[212:215], v10
    v_smfmac_f32_16x16x32_bf16 v[160:163], v[254:255], v[212:215], v10 abid:2
    s_setpc_b64 s[78:79]
    v_smfmac_f32_16x16x32_bf16 v[128:131], v[254:255], v[212:215], v10
    v_smfmac_f32_16x16x32_bf16 v[164:167], v[254:255], v[212:215], v10 abid:2
    s_setpc_b64 s[78:79]
    v_smfmac_f32_16x16x32_bf16 v[132:135], v[254:255], v[212:215], v10
    v_smfmac_f32_16x16x32_bf16 v[168:171], v[254:255], v[212:215], v10 abid:2
    s_setpc_b64 s[78:79]
    v_smfmac_f32_16x16x32_bf16 v[136:139], v[254:255], v[212:215], v10
    v_smfmac_f32_16x16x32_bf16 v[172:175], v[254:255], v[212:215], v10 abid:2
    s_setpc_b64 s[78:79]
    v_smfmac_f32_16x16x32_bf16 v[140:143], v[254:255], v[212:215], v10
    v_smfmac_f32_16x16x32_bf16 v[176:179], v[254:255], v[212:215], v10 abid:2
    s_setpc_b64 s[78:79]
    v_smfmac_f32_16x16x32_bf16 v[144:147], v[254:255], v[212:215], v10
    v_smfmac_f32_16x16x32_bf16 v[180:183], v[254:255], v[212:215], v10 abid:2
    s_setpc_b64 s[78:79]
    v_smfmac_f32_16x16x32_bf16 v[148:151], v[254:255], v[212:215], v10
    v_smfmac_f32_16x16x32_bf16 v[184:187], v[254:255], v[212:215], v10 abid:2
    s_setpc_b64 s[78:79]
    v_smfmac_f32_16x16x32_bf16 v[152:155], v[254:255], v[212:215], v10
    v_smfmac_f32_16x16x32_bf16 v[188:191], v[254:255], v[212:215], v10 abid:2
    s_setpc_b64 s[78:79]
    v_smfmac_f32_16x16x32_bf16 v[156:159], v[254:255], v[212:215], v10
    v_smfmac_f32_16x16x32_bf16 v[192:195], v[254:255], v[212:215], v10 abid:2
    s_setpc_b64 s[78:79]
M_ovn:
    s_setpc_b64 s[78:79]
M_slow:
    s_bitcmp1_b32 s46, 31
    s_cbranch_scc1 M_dense
    s_mov_b32 s56, s80
M_sl:
    s_lshl_b32 s57, s56, 6
    v_add_u32 v240, s57, v9
    ds_read_b128 v[248:251], v240 offset:9792
    s_waitcnt lgkmcnt(0)
    v_and_b32 v240, 0x3fff, v248
    v_and_b32 v241, 0x3fff, v250
    v_xad_u32 v240, v240, v3, v4
    v_xad_u32 v241, v241, v3, v4
    ds_read2st64_b32 v[244:245], v240 offset0:0 offset1:72
    ds_read2st64_b32 v[246:247], v241 offset0:0 offset1:72
    v_subrev_u32 v240, s29, v8
    v_bfe_u32 v240, v240, 4, 4
    s_waitcnt lgkmcnt(0)
    s_bitcmp1_b32 s27, 0
    s_cbranch_scc0 M_sle0
    v_lshrrev_b32 v242, 18, v248
    v_lshrrev_b32 v243, 18, v250
    v_or_b32 v241, 0, v240
    v_cmp_eq_u32 s[44:45], v242, v241
    v_cmp_eq_u32 s[54:55], v243, v241
    s_nop 0
    v_cndmask_b32 v242, 0, v249, s[44:45]
    v_cndmask_b32 v243, 0, v251, s[54:55]
    s_nop 1
    v_smfmac_f32_16x16x32_bf16 v[124:127], v[242:243], v[244:247], v10
    v_smfmac_f32_16x16x32_bf16 v[160:163], v[242:243], v[244:247], v10 abid:2
M_sle0:
    s_bitcmp1_b32 s27, 1
    s_cbranch_scc0 M_sle1
    v_lshrrev_b32 v242, 18, v248
    v_lshrrev_b32 v243, 18, v250
    v_or_b32 v241, 64, v240
    v_cmp_eq_u32 s[44:45], v242, v241
    v_cmp_eq_u32 s[54:55], v243, v241
    s_nop 0
    v_cndmask_b32 v242, 0, v249, s[44:45]
    v_cndmask_b32 v243, 0, v251, s[54:55]
    s_nop 1
    v_smfmac_f32_16x16x32_bf16 v[128:131], v[242:243], v[244:247], v10
    v_smfmac_f32_16x16x32_bf16 v[164:167], v[242:243], v[244:247], v10 abid:2
M_sle1:
    s_bitcmp1_b32 s27, 2
    s_cbranch_scc0 M_sle2
    v_lshrrev_b32 v242, 18, v248
    v_lshrrev_b32 v243, 18, v250
    v_or_b32 v241, 128, v240
    v_cmp_eq_u32 s[44:45], v242, v241
    v_cmp_eq_u32 s[54:55], v243, v241
    s_nop 0
    v_cndmask_b32 v242, 0, v249, s[44:45]
    v_cndmask_b32 v243, 0, v251, s[54:55]
    s_nop 1
    v_smfmac_f32_16x16x32_bf16 v[132:135], v[242:243], v[244:247], v10
    v_smfmac_f32_16x16x32_bf16 v[168:171], v[242:243], v[244:247], v10 abid:2
M_sle2:
    s_bitcmp1_b32 s27, 3
    s_cbranch_scc0 M_sle3
    v_lshrrev_b32 v242, 18, v248
    v_lshrrev_b32 v243, 18, v250
    v_or_b32 v241, 192, v240
    v_cmp_eq_u32 s[44:45], v242, v241
    v_cmp_eq_u32 s[54:55], v243, v241
    s_nop 0
    v_cndmask_b32 v242, 0, v249, s[44:45]
    v_cndmask_b32 v243, 0, v251, s[54:55]
    s_nop 1
    v_smfmac_f32_16x16x32_bf16 v[136:139], v[242:243], v[244:247], v10
    v_smfmac_f32_16x16x32_bf16 v[172:175], v[242:243], v[244:247], v10 abid:2
M_sle3:
    s_bitcmp1_b32 s27, 4
    s_cbranch_scc0 M_sle4
    v_lshrrev_b32 v242, 18, v248
    v_lshrrev_b32 v243, 18, v250
    v_or_b32 v241, 256, v240
    v_cmp_eq_u32 s[44:45], v242, v241
    v_cmp_eq_u32 s[54:55], v243, v241
    s_nop 0
    v_cndmask_b32 v242, 0, v249, s[44:45]
    v_cndmask_b32 v243, 0, v251, s[54:55]
    s_nop 1
    v_smfmac_f32_16x16x32_bf16 v[140:143], v[242:243], v[244:247], v10
    v_smfmac_f32_16x16x32_bf16 v[176:179], v[242:243], v[244:247], v10 abid:2
M_sle4:
    s_bitcmp1_b32 s27, 5
    s_cbranch_scc0 M_sle5
    v_lshrrev_b32 v242, 18, v248
    v_lshrrev_b32 v243, 18, v250
    v_or_b32 v241, 320, v240
    v_cmp_eq_u32 s[44:45], v242, v241
    v_cmp_eq_u32 s[54:55], v243, v241
    s_nop 0
    v_cndmask_b32 v242, 0, v249, s[44:45]
    v_cndmask_b32 v243, 0, v251, s[54:55]
    s_nop 1
    v_smfmac_f32_16x16x32_bf16 v[144:147], v[242:243], v[244:247], v10
    v_smfmac_f32_16x16x32_bf16 v[180:183], v[242:243], v[244:247], v10 abid:2
M_sle5:
    s_bitcmp1_b32 s27, 6
    s_cbranch_scc0 M_sle6
    v_lshrrev_b32 v242, 18, v248
    v_lshrrev_b32 v243, 18, v250
    v_or_b32 v241, 384, v240
    v_cmp_eq_u32 s[44:45], v242, v241
    v_cmp_eq_u32 s[54:55], v243, v241
    s_nop 0
    v_cndmask_b32 v242, 0, v249, s[44:45]
    v_cndmask_b32 v243, 0, v251, s[54:55]
    s_nop 1
    v_smfmac_f32_16x16x32_bf16 v[148:151], v[242:243], v[244:247], v10
    v_smfmac_f32_16x16x32_bf16 v[184:187], v[242:243], v[244:247], v10 abid:2
M_sle6:
    s_bitcmp1_b32 s27, 7
    s_cbranch_scc0 M_sle7
    v_lshrrev_b32 v242, 18, v248
    v_lshrrev_b32 v243, 18, v250
    v_or_b32 v241, 448, v240
    v_cmp_eq_u32 s[44:45], v242, v241
    v_cmp_eq_u32 s[54:55], v243, v241
    s_nop 0
    v_cndmask_b32 v242, 0, v249, s[44:45]
    v_cndmask_b32 v243, 0, v251, s[54:55]
    s_nop 1
    v_smfmac_f32_16x16x32_bf16 v[152:155], v[242:243], v[244:247], v10
    v_smfmac_f32_16x16x32_bf16 v[188:191], v[242:243], v[244:247], v10 abid:2
M_sle7:
    s_bitcmp1_b32 s27, 8
    s_cbranch_scc0 M_sle8
    v_lshrrev_b32 v242, 18, v248
    v_lshrrev_b32 v243, 18, v250
    v_or_b32 v241, 512, v240
    v_cmp_eq_u32 s[44:45], v242, v241
    v_cmp_eq_u32 s[54:55], v243, v241
    s_nop 0
    v_cndmask_b32 v242, 0, v249, s[44:45]
    v_cndmask_b32 v243, 0, v251, s[54:55]
    s_nop 1
    v_smfmac_f32_16x16x32_bf16 v[156:159], v[242:243], v[244:247], v10
    v_smfmac_f32_16x16x32_bf16 v[192:195], v[242:243], v[244:247], v10 abid:2
M_sle8:
    s_add_u32 s56, s56, 1
    s_cmp_lt_u32 s56, s46
    s_cbranch_scc1 M_sl
M_slx:
    s_nop 7
    s_cmp_eq_u32 s21, 1
    s_cbranch_scc1 M_slowrL
    s_cmp_eq_u32 s21, 2
    s_cbranch_scc1 M_slowrE0
    s_cmp_eq_u32 s21, 3
    s_cbranch_scc1 M_slowrQ
    s_cmp_eq_u32 s21, 4
    s_cbranch_scc1 M_slowrF
    s_branch M_slowr0
M_dense:
    s_mul_i32 s57, s20, 82944
    s_add_u32 s57, s57, 393216
    s_mov_b32 s56, 0
    v_mov_b32 v54, v1
    v_mov_b32 v55, v2
    v_subrev_u32 v252, s29, v8
M_dn0:
    ds_read_b128 v[244:247], v54 offset:0
    ds_read_b128 v[248:251], v55 offset:0
    v_add_u32 v54, 1024, v54
    v_add_u32 v55, 1024, v55
    buffer_load_dwordx4 v[240:243], v252, s[16:19], s57 offen sc1
    s_add_u32 s57, s57, 1024
    s_waitcnt vmcnt(0) lgkmcnt(0)
    v_smfmac_f32_16x16x64_bf16 v[124:127], v[240:243], v[244:251], v10
    buffer_load_dwordx4 v[240:243], v252, s[16:19], s57 offen sc1
    s_add_u32 s57, s57, 1024
    s_waitcnt vmcnt(0) lgkmcnt(0)
    v_smfmac_f32_16x16x64_bf16 v[128:131], v[240:243], v[244:251], v10
    buffer_load_dwordx4 v[240:243], v252, s[16:19], s57 offen sc1
    s_add_u32 s57, s57, 1024
    s_waitcnt vmcnt(0) lgkmcnt(0)
    v_smfmac_f32_16x16x64_bf16 v[132:135], v[240:243], v[244:251], v10
    buffer_load_dwordx4 v[240:243], v252, s[16:19], s57 offen sc1
    s_add_u32 s57, s57, 1024
    s_waitcnt vmcnt(0) lgkmcnt(0)
    v_smfmac_f32_16x16x64_bf16 v[136:139], v[240:243], v[244:251], v10
    buffer_load_dwordx4 v[240:243], v252, s[16:19], s57 offen sc1
    s_add_u32 s57, s57, 1024
    s_waitcnt vmcnt(0) lgkmcnt(0)
    v_smfmac_f32_16x16x64_bf16 v[140:143], v[240:243], v[244:251], v10
    buffer_load_dwordx4 v[240:243], v252, s[16:19], s57 offen sc1
    s_add_u32 s57, s57, 1024
    s_waitcnt vmcnt(0) lgkmcnt(0)
    v_smfmac_f32_16x16x64_bf16 v[144:147], v[240:243], v[244:251], v10
    buffer_load_dwordx4 v[240:243], v252, s[16:19], s57 offen sc1
    s_add_u32 s57, s57, 1024
    s_waitcnt vmcnt(0) lgkmcnt(0)
    v_smfmac_f32_16x16x64_bf16 v[148:151], v[240:243], v[244:251], v10
    buffer_load_dwordx4 v[240:243], v252, s[16:19], s57 offen sc1
    s_add_u32 s57, s57, 1024
    s_waitcnt vmcnt(0) lgkmcnt(0)
    v_smfmac_f32_16x16x64_bf16 v[152:155], v[240:243], v[244:251], v10
    buffer_load_dwordx4 v[240:243], v252, s[16:19], s57 offen sc1
    s_add_u32 s57, s57, 1024
    s_waitcnt vmcnt(0) lgkmcnt(0)
    v_smfmac_f32_16x16x64_bf16 v[156:159], v[240:243], v[244:251], v10
    s_add_u32 s56, s56, 1
    s_cmp_lt_u32 s56, 9
    s_cbranch_scc1 M_dn0
    s_mul_i32 s57, s20, 82944
    s_add_u32 s57, s57, 393216
    s_mov_b32 s56, 0
    v_mov_b32 v54, v1
    v_mov_b32 v55, v2
    v_subrev_u32 v252, s29, v8
M_dn1:
    ds_read_b128 v[244:247], v54 offset:18432
    ds_read_b128 v[248:251], v55 offset:18432
    v_add_u32 v54, 1024, v54
    v_add_u32 v55, 1024, v55
    buffer_load_dwordx4 v[240:243], v252, s[16:19], s57 offen sc1
    s_add_u32 s57, s57, 1024
    s_waitcnt vmcnt(0) lgkmcnt(0)
    v_smfmac_f32_16x16x64_bf16 v[160:163], v[240:243], v[244:251], v10
    buffer_load_dwordx4 v[240:243], v252, s[16:19], s57 offen sc1
    s_add_u32 s57, s57, 1024
    s_waitcnt vmcnt(0) lgkmcnt(0)
    v_smfmac_f32_16x16x64_bf16 v[164:167], v[240:243], v[244:251], v10
    buffer_load_dwordx4 v[240:243], v252, s[16:19], s57 offen sc1
    s_add_u32 s57, s57, 1024
    s_waitcnt vmcnt(0) lgkmcnt(0)
    v_smfmac_f32_16x16x64_bf16 v[168:171], v[240:243], v[244:251], v10
    buffer_load_dwordx4 v[240:243], v252, s[16:19], s57 offen sc1
    s_add_u32 s57, s57, 1024
    s_waitcnt vmcnt(0) lgkmcnt(0)
    v_smfmac_f32_16x16x64_bf16 v[172:175], v[240:243], v[244:251], v10
    buffer_load_dwordx4 v[240:243], v252, s[16:19], s57 offen sc1
    s_add_u32 s57, s57, 1024
    s_waitcnt vmcnt(0) lgkmcnt(0)
    v_smfmac_f32_16x16x64_bf16 v[176:179], v[240:243], v[244:251], v10
    buffer_load_dwordx4 v[240:243], v252, s[16:19], s57 offen sc1
    s_add_u32 s57, s57, 1024
    s_waitcnt vmcnt(0) lgkmcnt(0)
    v_smfmac_f32_16x16x64_bf16 v[180:183], v[240:243], v[244:251], v10
    buffer_load_dwordx4 v[240:243], v252, s[16:19], s57 offen sc1
    s_add_u32 s57, s57, 1024
    s_waitcnt vmcnt(0) lgkmcnt(0)
    v_smfmac_f32_16x16x64_bf16 v[184:187], v[240:243], v[244:251], v10
    buffer_load_dwordx4 v[240:243], v252, s[16:19], s57 offen sc1
    s_add_u32 s57, s57, 1024
    s_waitcnt vmcnt(0) lgkmcnt(0)
    v_smfmac_f32_16x16x64_bf16 v[188:191], v[240:243], v[244:251], v10
    buffer_load_dwordx4 v[240:243], v252, s[16:19], s57 offen sc1
    s_add_u32 s57, s57, 1024
    s_waitcnt vmcnt(0) lgkmcnt(0)
    v_smfmac_f32_16x16x64_bf16 v[192:195], v[240:243], v[244:251], v10
    s_add_u32 s56, s56, 1
    s_cmp_lt_u32 s56, 9
    s_cbranch_scc1 M_dn1
    s_branch M_slx
M_codeend:
.section .rodata,"a"
.p2align 6
.amdhsa_kernel standalone__structured_sparse_n_m__ragged_kernel
  .amdhsa_next_free_vgpr 512
  .amdhsa_next_free_sgpr 102
  .amdhsa_accum_offset 256
  .amdhsa_group_segment_fixed_size 0
  .amdhsa_kernarg_size 48
  .amdhsa_user_sgpr_count 2
  .amdhsa_user_sgpr_kernarg_segment_ptr 1
  .amdhsa_system_sgpr_workgroup_id_x 1
  .amdhsa_float_denorm_mode_32 3
.end_amdhsa_kernel
```
